```python
import torch

def _softmax(x, axis=-1):
    return torch.softmax(x, dim=axis)

def _gelu(x):
    return torch.nn.functional.gelu(x, approximate='tanh')

def _silu(x):
    return torch.nn.functional.silu(x)

def _sigmoid(x):
    return torch.sigmoid(x)

def _layernorm(x, axis=-1, eps=1e-05):
    m = x.mean(dim=axis, keepdim=True)
    v = x.var(dim=axis, keepdim=True, unbiased=False)
    return (x - m) / torch.sqrt(v + eps)

def _scatter_add(tgt, idx, src, axis=0):
    return tgt.clone().index_add_(axis, idx, src)

def _segment_sum(src, seg, n):
    out = torch.zeros((n,) + src.shape[1:], dtype=src.dtype)
    return out.index_add_(0, seg, src)

def _pad(x, pw):
    flat = tuple((v for pair in reversed(pw) for v in pair))
    return torch.nn.functional.pad(x, flat)
kernel_name = 'interleave_layers__sliding_local_dilated__memory_aug_recurrent_mem_tr__prompt'

def setup_inputs():

    _w = lambda a: (lambda t: t.to(torch.bfloat16) if t.is_floating_point() else t)(torch.as_tensor(a))

    def _A_setup():
        B, S, D = (1, 2048, 576)
        return {'x': _w((lambda *s: torch.randn(*s, dtype=torch.bfloat16) * 0.05)(B, S, D)), 'wqkv': _w((lambda *s: torch.randn(*s, dtype=torch.bfloat16) * 0.05)(D, 3 * D)), 'wo': _w((lambda *s: torch.randn(*s, dtype=torch.bfloat16) * 0.05)(D, D))}
    _A_in = _A_setup()

    def _B_setup():
        B, S, Dm = (1, 2048, 576)
        H, Dh = (32, 128)
        M, seg = (8, 32)
        seg = min(seg, S)
        S = S // seg * seg
        return {'x': _w((lambda *s: torch.randn(*s, dtype=torch.bfloat16) * 0.05)(B, S, Dm)), 'mem0': _w((lambda *s: torch.randn(*s, dtype=torch.bfloat16) * 0.8)(B, M, Dm)), 'Wq': _w((lambda *s: torch.randn(*s, dtype=torch.bfloat16) * 1.6)(Dm, H, Dh) * Dm ** (-0.5)), 'Wk': _w((lambda *s: torch.randn(*s, dtype=torch.bfloat16) * 1.6)(Dm, H, Dh) * Dm ** (-0.5)), 'Wv': _w((lambda *s: torch.randn(*s, dtype=torch.bfloat16) * 0.8)(Dm, H, Dh) * Dm ** (-0.5)), 'Wo': _w((lambda *s: torch.randn(*s, dtype=torch.bfloat16) * 0.8)(H, Dh, Dm) * (H * Dh) ** (-0.5)), 'seg_len': seg}
    _B_in = _B_setup()
    return {'A_x': _A_in['x'], 'A_wqkv': _A_in['wqkv'], 'A_wo': _A_in['wo'], 'B_x': _B_in['x'], 'B_mem0': _B_in['mem0'], 'B_Wq': _B_in['Wq'], 'B_Wk': _B_in['Wk'], 'B_Wv': _B_in['Wv'], 'B_Wo': _B_in['Wo'], 'B_seg_len': _B_in['seg_len']}

def reference(A_x, A_wqkv, A_wo, B_x, B_mem0, B_Wq, B_Wk, B_Wv, B_Wo, B_seg_len):

    def _A_ref(x, wqkv, wo):
        B, S, D = x.shape
        H = 32
        Dh = D // H
        W, dil = (8, 2)
        qkv = (lambda x, *d: x.permute(*d))((x @ wqkv).reshape(B, S, 3, H, Dh), 2, 0, 3, 1, 4)
        q, k, v = (qkv[0], qkv[1], qkv[2])
        scale = Dh ** (-0.5)
        pos = torch.arange(S)
        off = torch.arange(W) * dil
        idx = pos[:, None] - off[None, :]
        mask = idx >= 0
        idx_c = torch.where(mask, idx, 0).reshape(-1)
        kg = k[:, :, idx_c, :].reshape(B, H, S, W, Dh)
        vg = v[:, :, idx_c, :].reshape(B, H, S, W, Dh)
        logits = torch.einsum('bhsd,bhswd->bhsw', q, kg) * scale
        logits = torch.where(mask[None, None, :, :], logits, -1000000000.0)
        attn = _softmax(logits, axis=-1)
        o = torch.einsum('bhsw,bhswd->bhsd', attn, vg)
        return (lambda x, *d: x.permute(*d))(o, 0, 2, 1, 3).reshape(B, S, D) @ wo

    def _B_ref(x, mem0, Wq, Wk, Wv, Wo, seg_len):
        B, S, Dm = x.shape
        H, Dh = (Wq.shape[1], Wq.shape[2])
        M = mem0.shape[1]
        scale = Dh ** (-0.5)
        n_seg = S // seg_len
        L = M + seg_len
        idx = torch.arange(L)
        mask = (idx[:, None] < M) | (idx[:, None] >= idx[None, :])
        mem = mem0
        outs = []
        for s in range(n_seg):
            xs = x[:, s * seg_len:(s + 1) * seg_len, :].clone()
            h = torch.concatenate([mem, xs], axis=1)
            q = torch.einsum('btd,dhe->bhte', h, Wq)
            k = torch.einsum('btd,dhe->bhte', h, Wk)
            v = torch.einsum('btd,dhe->bhte', h, Wv)
            scores = torch.einsum('bhqe,bhke->bhqk', q, k) * scale
            scores = torch.where(mask[None, None], scores, -1000000000.0)
            p = _softmax(scores, axis=-1)
            o = torch.einsum('bhqk,bhke->bhqe', p, v)
            o = torch.einsum('bhte,hed->btd', o, Wo)
            mem = o[:, :M, :].clone()
            outs.append(o[:, M:, :])
        return torch.concatenate(outs, axis=1)
    x = A_x
    x = x + _A_ref(_layernorm(x, axis=-1), A_wqkv, A_wo)
    x = x + _B_ref(_layernorm(x, axis=-1), B_mem0, B_Wq, B_Wk, B_Wv, B_Wo, B_seg_len)
    x = x + _A_ref(_layernorm(x, axis=-1), A_wqkv, A_wo)
    x = x + _B_ref(_layernorm(x, axis=-1), B_mem0, B_Wq, B_Wk, B_Wv, B_Wo, B_seg_len)
    return x
```

```asm
; @launch grid=(256,1,1) block=(256,1,1) lds=163840
.amdgcn_target "amdgcn-amd-amdhsa--gfx950"
.text
.globl interleave_layers__sliding_local_dilated__memory_aug_recurrent_mem_tr__prompt_kernel
.p2align 8
.type interleave_layers__sliding_local_dilated__memory_aug_recurrent_mem_tr__prompt_kernel,@function
interleave_layers__sliding_local_dilated__memory_aug_recurrent_mem_tr__prompt_kernel:
    s_cmp_ge_u32 s2, 256
    s_cbranch_scc1 L_exit
    s_load_dwordx2 s[8:9], s[0:1], 96
    s_mov_b32 s10, 268435456
    s_mov_b32 s11, 0x00020000
    s_waitcnt lgkmcnt(0)
    s_and_b32 s9, s9, 0xffff
    s_load_dwordx2 s[12:13], s[0:1], 88
    v_lshrrev_b32 v1, 6, v0
    s_getreg_b32 s3, hwreg(HW_REG_XCC_ID)
    v_readfirstlane_b32 s14, v1
    s_and_b32 s3, s3, 7
    s_and_b32 s17, s3, 1
    s_lshl_b32 s17, s17, 7
    s_lshl_b32 s18, s3, 1
    s_and_b32 s18, s18, 12
    s_add_u32 s17, s17, s18
    v_mov_b32 v2, 0
    v_mov_b32 v3, 1
    v_mov_b32 v4, s17
    s_mov_b32 s33, 0
    s_waitcnt lgkmcnt(0)
    s_cmp_lg_u32 s14, 0
    s_cbranch_scc1 L_tk_wait
    s_mov_b64 exec, 1
    global_atomic_add v3, v4, v3, s[12:13] sc0
    s_waitcnt vmcnt(0)
    v_readfirstlane_b32 s4, v3
    s_nop 0
    s_cmp_lt_u32 s4, 32
    s_cbranch_scc1 L_tk_have
    v_mov_b32 v3, 1
    v_mov_b32 v4, 32
    global_atomic_add v3, v4, v3, s[12:13] sc0
    s_waitcnt vmcnt(0)
    v_readfirstlane_b32 s5, v3
    s_mov_b64 exec, 0xff
    v_and_b32 v4, 1, v0
    v_lshlrev_b32 v4, 7, v4
    v_lshlrev_b32 v5, 1, v0
    v_and_or_b32 v4, v5, 12, v4
    s_mov_b32 s16, 0
L_hl_poll:
    global_load_dword v5, v4, s[12:13] sc1
    s_add_u32 s16, s16, 1
    s_cmp_gt_u32 s16, 100000
    s_cbranch_scc1 L_abort
    s_mov_b32 s6, 0
    s_waitcnt vmcnt(0)
    v_readlane_b32 s40, v5, 0
    s_nop 0
    s_add_u32 s6, s6, s40
    v_readlane_b32 s41, v5, 1
    s_nop 0
    s_add_u32 s6, s6, s41
    v_readlane_b32 s42, v5, 2
    s_nop 0
    s_add_u32 s6, s6, s42
    v_readlane_b32 s43, v5, 3
    s_nop 0
    s_add_u32 s6, s6, s43
    v_readlane_b32 s44, v5, 4
    s_nop 0
    s_add_u32 s6, s6, s44
    v_readlane_b32 s45, v5, 5
    s_nop 0
    s_add_u32 s6, s6, s45
    v_readlane_b32 s46, v5, 6
    s_nop 0
    s_add_u32 s6, s6, s46
    v_readlane_b32 s47, v5, 7
    s_nop 0
    s_add_u32 s6, s6, s47
    s_cmp_lt_u32 s6, 256
    s_cbranch_scc1 L_hl_poll
    s_mov_b32 s3, 0
    s_mov_b32 s4, 0
    s_min_u32 s6, s47, 32
    s_sub_u32 s7, 32, s6
    s_cmp_lt_u32 s5, s7
    s_cselect_b32 s3, 7, s3
    s_add_u32 s6, s6, s5
    s_cmp_lt_u32 s5, s7
    s_cselect_b32 s4, s6, s4
    s_sub_u32 s5, s5, s7
    s_min_u32 s6, s46, 32
    s_sub_u32 s7, 32, s6
    s_cmp_lt_u32 s5, s7
    s_cselect_b32 s3, 6, s3
    s_add_u32 s6, s6, s5
    s_cmp_lt_u32 s5, s7
    s_cselect_b32 s4, s6, s4
    s_sub_u32 s5, s5, s7
    s_min_u32 s6, s45, 32
    s_sub_u32 s7, 32, s6
    s_cmp_lt_u32 s5, s7
    s_cselect_b32 s3, 5, s3
    s_add_u32 s6, s6, s5
    s_cmp_lt_u32 s5, s7
    s_cselect_b32 s4, s6, s4
    s_sub_u32 s5, s5, s7
    s_min_u32 s6, s44, 32
    s_sub_u32 s7, 32, s6
    s_cmp_lt_u32 s5, s7
    s_cselect_b32 s3, 4, s3
    s_add_u32 s6, s6, s5
    s_cmp_lt_u32 s5, s7
    s_cselect_b32 s4, s6, s4
    s_sub_u32 s5, s5, s7
    s_min_u32 s6, s43, 32
    s_sub_u32 s7, 32, s6
    s_cmp_lt_u32 s5, s7
    s_cselect_b32 s3, 3, s3
    s_add_u32 s6, s6, s5
    s_cmp_lt_u32 s5, s7
    s_cselect_b32 s4, s6, s4
    s_sub_u32 s5, s5, s7
    s_min_u32 s6, s42, 32
    s_sub_u32 s7, 32, s6
    s_cmp_lt_u32 s5, s7
    s_cselect_b32 s3, 2, s3
    s_add_u32 s6, s6, s5
    s_cmp_lt_u32 s5, s7
    s_cselect_b32 s4, s6, s4
    s_sub_u32 s5, s5, s7
    s_min_u32 s6, s41, 32
    s_sub_u32 s7, 32, s6
    s_cmp_lt_u32 s5, s7
    s_cselect_b32 s3, 1, s3
    s_add_u32 s6, s6, s5
    s_cmp_lt_u32 s5, s7
    s_cselect_b32 s4, s6, s4
    s_sub_u32 s5, s5, s7
    s_min_u32 s6, s40, 32
    s_sub_u32 s7, 32, s6
    s_cmp_lt_u32 s5, s7
    s_cselect_b32 s3, 0, s3
    s_add_u32 s6, s6, s5
    s_cmp_lt_u32 s5, s7
    s_cselect_b32 s4, s6, s4
    s_sub_u32 s5, s5, s7
L_tk_have:
    s_lshl_b32 s5, s3, 8
    s_or_b32 s5, s5, s4
    v_mov_b32 v3, s5
    s_mov_b64 exec, 1
    ds_write_b32 v2, v3
    s_mov_b64 exec, -1
L_tk_wait:
    s_waitcnt vmcnt(0) lgkmcnt(0)
    s_barrier
    ds_read_b32 v3, v2
    s_waitcnt lgkmcnt(0)
    v_readfirstlane_b32 s5, v3
    s_nop 0
    s_lshr_b32 s3, s5, 8
    s_and_b32 s4, s5, 255
    s_barrier
    s_cmp_lt_u32 s3, 2
    s_cbranch_scc1 L_role_r
    s_cmp_lg_u32 s3, 2
    s_cbranch_scc1 L_ii2_no
    s_cmp_lt_u32 s4, 32
    s_cbranch_scc1 L_noinit
L_ii2_no:
    s_cmp_lg_u32 s3, 3
    s_cbranch_scc1 L_ii3_no
    s_cmp_lt_u32 s4, 16
    s_cbranch_scc1 L_noinit
    s_cmp_lt_u32 s4, 32
    s_add_u32 s6, s4, 4294967280
    s_cmp_lt_u32 s4, 32
    s_cbranch_scc1 L_doinit
L_ii3_no:
    s_cmp_lg_u32 s3, 4
    s_cbranch_scc1 L_ii4_no
    s_cmp_lt_u32 s4, 21
    s_cbranch_scc1 L_noinit
    s_cmp_lt_u32 s4, 32
    s_add_u32 s6, s4, 4294967291
    s_cmp_lt_u32 s4, 32
    s_cbranch_scc1 L_doinit
L_ii4_no:
    s_cmp_lg_u32 s3, 5
    s_cbranch_scc1 L_ii5_no
    s_cmp_lt_u32 s4, 32
    s_add_u32 s6, s4, 27
    s_cmp_lt_u32 s4, 32
    s_cbranch_scc1 L_doinit
L_ii5_no:
    s_cmp_lg_u32 s3, 6
    s_cbranch_scc1 L_ii6_no
    s_cmp_lt_u32 s4, 32
    s_add_u32 s6, s4, 59
    s_cmp_lt_u32 s4, 32
    s_cbranch_scc1 L_doinit
L_ii6_no:
    s_cmp_lg_u32 s3, 7
    s_cbranch_scc1 L_ii7_no
    s_cmp_lt_u32 s4, 32
    s_add_u32 s6, s4, 91
    s_cmp_lt_u32 s4, 32
    s_cbranch_scc1 L_doinit
L_ii7_no:
    s_endpgm
L_doinit:
    s_load_dwordx2 s[20:21], s[0:1], 0
    s_mov_b32 s22, 2359296
    s_mov_b32 s23, 0x00020000
    s_waitcnt lgkmcnt(0)
    s_and_b32 s21, s21, 0xffff
    v_lshlrev_b32 v7, 4, v0
    v_mov_b32 v12, 0
    v_mov_b32 v13, 0
    v_mov_b32 v14, 0
    v_mov_b32 v15, 0
    s_mov_b32 s46, s6
Li_loop:
    s_cmp_ge_u32 s46, 136
    s_cbranch_scc1 Li_nofl
    s_mul_i32 s41, s46, 22528
    s_add_u32 s41, s41, 180224
    s_sub_u32 s42, s46, 128
    s_lshl_b32 s42, s42, 12
    s_add_u32 s42, s42, 3080192
    s_cmp_ge_u32 s46, 128
    s_cselect_b32 s41, s42, s41
    buffer_store_dwordx4 v[12:15], v7, s[8:11], s41 offen sc1
    s_cbranch_scc1 Li_nofl
    s_add_u32 s41, s41, 4096
    buffer_store_dwordx4 v[12:15], v7, s[8:11], s41 offen sc1
    s_add_u32 s41, s41, 4096
    buffer_store_dwordx4 v[12:15], v7, s[8:11], s41 offen sc1
    s_add_u32 s41, s41, 4096
    buffer_store_dwordx4 v[12:15], v7, s[8:11], s41 offen sc1
    s_add_u32 s41, s41, 4096
    buffer_store_dwordx4 v[12:15], v7, s[8:11], s41 offen sc1
    s_add_u32 s41, s41, 4096
    v_cmp_gt_u32 vcc, 128, v0
    s_nop 0
    s_and_saveexec_b64 s[42:43], vcc
    s_cbranch_execz Li_fl5
    buffer_store_dwordx4 v[12:15], v7, s[8:11], s41 offen sc1
Li_fl5:
    s_mov_b64 exec, s[42:43]
Li_nofl:
    s_cmp_ge_u32 s46, 64
    s_cbranch_scc1 Li_rest
    s_mul_i32 s42, s46, 6144
    s_add_u32 s42, s42, 15728640
    s_add_u32 s43, s42, 2048
    buffer_store_dwordx4 v[12:15], v7, s[8:11], s43 offen sc1
    s_branch Li_done
Li_rest:
    s_cmp_ge_u32 s46, 192
    s_cbranch_scc1 Li_done
    s_sub_u32 s41, s46, 64
    s_lshr_b32 s42, s41, 6
    s_and_b32 s41, s41, 63
    s_mul_i32 s42, s42, 786432
    s_mul_i32 s41, s41, 6144
    s_add_u32 s41, s41, s42
    s_add_u32 s41, s41, 16126464
    v_cmp_gt_u32 vcc, 96, v0
    s_nop 0
    s_and_saveexec_b64 s[44:45], vcc
    s_cbranch_execz Li_rest2
    buffer_store_dwordx4 v[12:15], v7, s[8:11], s41 offen sc1
Li_rest2:
    s_mov_b64 exec, s[44:45]
Li_done:
    s_add_u32 s46, s46, 123
    s_cmp_lt_u32 s46, 192
    s_cbranch_scc1 Li_loop
    v_and_b32 v1, 31, v0
    v_lshrrev_b32 v2, 5, v0
    v_mul_u32_u24 v3, 1152, v1
    v_mul_u32_u24 v5, 144, v2
    v_add_u32 v3, v3, v5
    s_sub_u32 s47, s6, 59
    s_mul_i32 s41, s47, 36864
    s_cmp_lt_u32 s6, 59
    s_cselect_b32 s41, 0x7f000000, s41
    buffer_load_dwordx4 v[64:67], v3, s[20:23], s41 offen offset:0
    buffer_load_dwordx4 v[68:71], v3, s[20:23], s41 offen offset:16
    buffer_load_dwordx4 v[72:75], v3, s[20:23], s41 offen offset:32
    buffer_load_dwordx4 v[76:79], v3, s[20:23], s41 offen offset:48
    buffer_load_dwordx4 v[80:83], v3, s[20:23], s41 offen offset:64
    buffer_load_dwordx4 v[84:87], v3, s[20:23], s41 offen offset:80
    buffer_load_dwordx4 v[88:91], v3, s[20:23], s41 offen offset:96
    buffer_load_dwordx4 v[92:95], v3, s[20:23], s41 offen offset:112
    buffer_load_dwordx4 v[96:99], v3, s[20:23], s41 offen offset:128
    s_waitcnt vmcnt(9)
    s_barrier
    s_cmp_lg_u32 s14, 0
    s_cbranch_scc1 Li_mid
    v_mov_b32 v2, 160
    v_mov_b32 v3, 1
    s_mov_b64 exec, 1
    global_atomic_add v2, v3, s[12:13]
    s_mov_b64 exec, -1
Li_mid:
    s_cmp_lt_u32 s6, 59
    s_cbranch_scc1 Li_end
    s_waitcnt vmcnt(0)
    v_and_b32 v1, 31, v0
    v_lshrrev_b32 v2, 5, v0
    v_mul_u32_u24 v4, 4608, v2
    v_lshl_add_u32 v4, v1, 4, v4
    s_mul_i32 s41, s47, 36864
    s_add_u32 s41, s41, 6291456
    s_mul_i32 s42, s47, 6144
    s_add_u32 s42, s42, 15728640
    v_mov_b32 v60, 0
    v_mov_b32 v61, 0
    buffer_store_dwordx4 v[64:67], v4, s[8:11], s41 offen offset:0 sc1
    buffer_store_dwordx4 v[68:71], v4, s[8:11], s41 offen offset:512 sc1
    buffer_store_dwordx4 v[72:75], v4, s[8:11], s41 offen offset:1024 sc1
    buffer_store_dwordx4 v[76:79], v4, s[8:11], s41 offen offset:1536 sc1
    buffer_store_dwordx4 v[80:83], v4, s[8:11], s41 offen offset:2048 sc1
    buffer_store_dwordx4 v[84:87], v4, s[8:11], s41 offen offset:2560 sc1
    buffer_store_dwordx4 v[88:91], v4, s[8:11], s41 offen offset:3072 sc1
    buffer_store_dwordx4 v[92:95], v4, s[8:11], s41 offen offset:3584 sc1
    v_add_u32 v4, 4096, v4
    buffer_store_dwordx4 v[96:99], v4, s[8:11], s41 offen offset:0 sc1
    v_mov_b32 v62, 0x3f803f80
    v_dot2c_f32_bf16 v60, v64, v62
    v_dot2c_f32_bf16 v61, v64, v64
    v_dot2c_f32_bf16 v60, v65, v62
    v_dot2c_f32_bf16 v61, v65, v65
    v_dot2c_f32_bf16 v60, v66, v62
    v_dot2c_f32_bf16 v61, v66, v66
    v_dot2c_f32_bf16 v60, v67, v62
    v_dot2c_f32_bf16 v61, v67, v67
    v_dot2c_f32_bf16 v60, v68, v62
    v_dot2c_f32_bf16 v61, v68, v68
    v_dot2c_f32_bf16 v60, v69, v62
    v_dot2c_f32_bf16 v61, v69, v69
    v_dot2c_f32_bf16 v60, v70, v62
    v_dot2c_f32_bf16 v61, v70, v70
    v_dot2c_f32_bf16 v60, v71, v62
    v_dot2c_f32_bf16 v61, v71, v71
    v_dot2c_f32_bf16 v60, v72, v62
    v_dot2c_f32_bf16 v61, v72, v72
    v_dot2c_f32_bf16 v60, v73, v62
    v_dot2c_f32_bf16 v61, v73, v73
    v_dot2c_f32_bf16 v60, v74, v62
    v_dot2c_f32_bf16 v61, v74, v74
    v_dot2c_f32_bf16 v60, v75, v62
    v_dot2c_f32_bf16 v61, v75, v75
    v_dot2c_f32_bf16 v60, v76, v62
    v_dot2c_f32_bf16 v61, v76, v76
    v_dot2c_f32_bf16 v60, v77, v62
    v_dot2c_f32_bf16 v61, v77, v77
    v_dot2c_f32_bf16 v60, v78, v62
    v_dot2c_f32_bf16 v61, v78, v78
    v_dot2c_f32_bf16 v60, v79, v62
    v_dot2c_f32_bf16 v61, v79, v79
    v_dot2c_f32_bf16 v60, v80, v62
    v_dot2c_f32_bf16 v61, v80, v80
    v_dot2c_f32_bf16 v60, v81, v62
    v_dot2c_f32_bf16 v61, v81, v81
    v_dot2c_f32_bf16 v60, v82, v62
    v_dot2c_f32_bf16 v61, v82, v82
    v_dot2c_f32_bf16 v60, v83, v62
    v_dot2c_f32_bf16 v61, v83, v83
    v_dot2c_f32_bf16 v60, v84, v62
    v_dot2c_f32_bf16 v61, v84, v84
    v_dot2c_f32_bf16 v60, v85, v62
    v_dot2c_f32_bf16 v61, v85, v85
    v_dot2c_f32_bf16 v60, v86, v62
    v_dot2c_f32_bf16 v61, v86, v86
    v_dot2c_f32_bf16 v60, v87, v62
    v_dot2c_f32_bf16 v61, v87, v87
    v_dot2c_f32_bf16 v60, v88, v62
    v_dot2c_f32_bf16 v61, v88, v88
    v_dot2c_f32_bf16 v60, v89, v62
    v_dot2c_f32_bf16 v61, v89, v89
    v_dot2c_f32_bf16 v60, v90, v62
    v_dot2c_f32_bf16 v61, v90, v90
    v_dot2c_f32_bf16 v60, v91, v62
    v_dot2c_f32_bf16 v61, v91, v91
    v_dot2c_f32_bf16 v60, v92, v62
    v_dot2c_f32_bf16 v61, v92, v92
    v_dot2c_f32_bf16 v60, v93, v62
    v_dot2c_f32_bf16 v61, v93, v93
    v_dot2c_f32_bf16 v60, v94, v62
    v_dot2c_f32_bf16 v61, v94, v94
    v_dot2c_f32_bf16 v60, v95, v62
    v_dot2c_f32_bf16 v61, v95, v95
    v_dot2c_f32_bf16 v60, v96, v62
    v_dot2c_f32_bf16 v61, v96, v96
    v_dot2c_f32_bf16 v60, v97, v62
    v_dot2c_f32_bf16 v61, v97, v97
    v_dot2c_f32_bf16 v60, v98, v62
    v_dot2c_f32_bf16 v61, v98, v98
    v_dot2c_f32_bf16 v60, v99, v62
    v_dot2c_f32_bf16 v61, v99, v99
    s_nop 3
    v_lshrrev_b32 v5, 1, v2
    v_lshlrev_b32 v5, 9, v5
    v_lshl_add_u32 v5, v1, 4, v5
    v_and_b32 v6, 1, v2
    v_lshl_add_u32 v5, v6, 3, v5
    buffer_store_dwordx2 v[60:61], v5, s[8:11], s42 offen sc1
    s_waitcnt vmcnt(0)
    s_cmp_lg_u32 s14, 0
    s_cbranch_scc1 Li_pw_d
    v_mov_b32 v5, 160
    s_mov_b32 s16, 0
Li_pw:
    global_load_dword v6, v5, s[12:13] sc1
    s_add_u32 s16, s16, 1
    s_cmp_gt_u32 s16, 100000
    s_cbranch_scc1 L_abort
    s_waitcnt vmcnt(0)
    v_cmp_gt_u32 vcc, 123, v6
    s_nop 0
    s_cbranch_vccz Li_pw_d
    s_sleep 2
    s_branch Li_pw
Li_pw_d:
    s_barrier
    s_cmp_lg_u32 s14, 0
    s_cbranch_scc1 Li_end
    v_lshrrev_b32 v5, 2, v0
    v_lshlrev_b32 v5, 7, v5
    v_and_b32 v6, 3, v0
    v_lshl_add_u32 v5, v6, 2, v5
    v_mov_b32 v6, 1
    s_mul_i32 s41, s47, 22528
    s_mov_b32 exec_lo, -1
    s_mov_b32 exec_hi, 0xffff
    s_add_u32 s41, s41, 180224
    buffer_store_dword v6, v5, s[8:11], s41 offen offset:0 sc1
    s_mov_b64 exec, -1
Li_end:
L_noinit:
    s_cmp_lg_u32 s3, 2
    s_cbranch_scc1 L_cls2_no
    s_add_u32 s15, s4, 0
    s_cmp_lt_u32 s4, 32
    s_cbranch_scc1 L_role_p
    s_endpgm
L_cls2_no:
    s_cmp_lg_u32 s3, 3
    s_cbranch_scc1 L_cls3_no
    s_add_u32 s15, s4, 32
    s_cmp_lt_u32 s4, 32
    s_cbranch_scc1 L_role_p
    s_endpgm
L_cls3_no:
    s_cmp_lg_u32 s3, 4
    s_cbranch_scc1 L_cls4_no
    s_add_u32 s15, s4, 0
    s_cmp_lt_u32 s4, 16
    s_cbranch_scc1 L_role_aq
    s_add_u32 s15, s4, 4294967280
    s_cmp_lt_u32 s4, 21
    s_cbranch_scc1 L_role_awo
    s_add_u32 s15, s4, 43
    s_cmp_lt_u32 s4, 32
    s_cbranch_scc1 L_role_p
    s_endpgm
L_cls4_no:
    s_cmp_lg_u32 s3, 5
    s_cbranch_scc1 L_cls5_no
    s_add_u32 s15, s4, 16
    s_cmp_lt_u32 s4, 16
    s_cbranch_scc1 L_role_aq
    s_add_u32 s15, s4, 4294967285
    s_cmp_lt_u32 s4, 21
    s_cbranch_scc1 L_role_awo
    s_add_u32 s15, s4, 54
    s_cmp_lt_u32 s4, 32
    s_cbranch_scc1 L_role_p
    s_endpgm
L_cls5_no:
    s_cmp_lg_u32 s3, 6
    s_cbranch_scc1 L_cls6_no
    s_add_u32 s15, s4, 0
    s_cmp_lt_u32 s4, 8
    s_cbranch_scc1 L_role_ta
    s_add_u32 s15, s4, 4294967288
    s_cmp_lt_u32 s4, 32
    s_cbranch_scc1 L_role_tw
    s_endpgm
L_cls6_no:
    s_cmp_lg_u32 s3, 7
    s_cbranch_scc1 L_cls7_no
    s_add_u32 s15, s4, 8
    s_cmp_lt_u32 s4, 8
    s_cbranch_scc1 L_role_ta
    s_add_u32 s15, s4, 16
    s_cmp_lt_u32 s4, 20
    s_cbranch_scc1 L_role_tw
    s_add_u32 s15, s4, 66
    s_cmp_lt_u32 s4, 30
    s_cbranch_scc1 L_role_p
    s_endpgm
L_cls7_no:
L_exit:
    s_endpgm
L_abort:
    s_waitcnt lgkmcnt(0)
    s_mov_b64 exec, -1
    v_mov_b32 v0, 60
    s_lshl_b32 s5, s3, 8
    s_or_b32 s5, s5, s4
    s_or_b32 s5, s5, 0x10000
    v_mov_b32 v1, s5
    global_store_dword v0, v1, s[12:13]
    s_endpgm
.p2align 6
L_role_p:
    v_and_b32 v5, 63, v0
    v_lshlrev_b32 v0, 4, v5
    v_and_b32 v7, 15, v5
    v_lshrrev_b32 v8, 4, v5
    v_min_u32 v1, 17, v5
    v_lshrrev_b32 v6, 2, v1
    v_and_b32 v1, 3, v1
    v_lshlrev_b32 v1, 2, v1
    v_lshl_add_u32 v1, v6, 7, v1
    v_mov_b32 v3, 1
    v_mov_b32 v4, 0
    s_mov_b32 s44, 0x05040100
    s_mov_b32 s45, 0x07060302
    s_cmp_ge_u32 s15, 48
    s_cselect_b32 s63, 1, 0
    s_cselect_b32 s17, 48, 0
    s_sub_u32 s15, s15, s17
    s_lshr_b32 s50, s15, 4
    s_and_b32 s51, s15, 15
    s_lshl_b32 s51, s51, 1
    s_lshr_b32 s17, s14, 1
    s_add_u32 s51, s51, s17
    s_and_b32 s47, s14, 1
    s_lshl_b32 s17, s50, 3
    s_add_u32 s17, s17, 40
    s_load_dwordx2 s[20:21], s[0:1], s17
    s_mov_b32 s22, 4718592
    s_mov_b32 s23, 0x00020000
    s_lshl_b32 s49, s51, 8
    s_lshl_b32 s17, s47, 7
    s_add_u32 s49, s49, s17
    s_cmp_eq_u32 s63, 0
    s_cbranch_scc1 Lp_noord
    s_cmp_lg_u32 s14, 0
    s_cbranch_scc1 Lp_ord_d
    v_mov_b32 v5, 48
    s_mov_b32 s16, 0
Lp_ord:
    global_load_dword v6, v5, s[12:13] sc1
    s_add_u32 s16, s16, 1
    s_cmp_gt_u32 s16, 100000
    s_cbranch_scc1 L_role_p_abort
    s_waitcnt vmcnt(0)
    v_cmp_gt_u32 vcc, 1, v6
    s_nop 0
    s_cbranch_vccz Lp_ord_d
    s_sleep 64
    s_branch Lp_ord
Lp_ord_d:
    s_barrier
Lp_noord:
    v_lshrrev_b32 v5, 4, v0
    v_lshrrev_b32 v211, 3, v5
    v_lshlrev_b32 v211, 13, v211
    v_and_b32 v6, 7, v5
    v_lshl_add_u32 v211, v6, 4, v211
    v_lshrrev_b32 v210, 1, v8
    v_lshlrev_b32 v210, 3, v210
    v_lshrrev_b32 v6, 2, v7
    v_add_u32 v210, v210, v6
    v_lshlrev_b32 v210, 7, v210
    s_lshl_b32 s17, s14, 15
    v_add_u32 v210, s17, v210
    v_and_b32 v13, 1, v8
    v_and_b32 v6, 1, v7
    v_lshlrev_b32 v6, 3, v6
    v_lshl_add_u32 v6, v13, 4, v6
    v_bfe_u32 v9, v7, 1, 1
    v_lshl_add_u32 v6, v9, 5, v6
    v_and_b32 v9, 3, v7
    v_lshlrev_b32 v9, 3, v9
    v_lshl_add_u32 v13, v13, 5, v9
    s_cmp_eq_u32 s50, 2
    s_cselect_b64 vcc, -1, 0
    v_cndmask_b32 v6, v6, v13, vcc
    v_add_u32 v210, v210, v6
    s_waitcnt lgkmcnt(0)
    s_and_b32 s21, s21, 0xffff
    s_lshl_b32 s46, s14, 15
    s_add_u32 m0, s46, 0
    s_add_u32 s17, s49, 0
    buffer_load_dwordx4 v211, s[20:23], s17 offen lds
    s_add_u32 m0, s46, 1024
    s_add_u32 s17, s49, 65536
    buffer_load_dwordx4 v211, s[20:23], s17 offen lds
    s_add_u32 m0, s46, 2048
    s_add_u32 s17, s49, 131072
    buffer_load_dwordx4 v211, s[20:23], s17 offen lds
    s_add_u32 m0, s46, 3072
    s_add_u32 s17, s49, 196608
    buffer_load_dwordx4 v211, s[20:23], s17 offen lds
    s_add_u32 m0, s46, 4096
    s_add_u32 s17, s49, 262144
    buffer_load_dwordx4 v211, s[20:23], s17 offen lds
    s_add_u32 m0, s46, 5120
    s_add_u32 s17, s49, 327680
    buffer_load_dwordx4 v211, s[20:23], s17 offen lds
    s_add_u32 m0, s46, 6144
    s_add_u32 s17, s49, 393216
    buffer_load_dwordx4 v211, s[20:23], s17 offen lds
    s_add_u32 m0, s46, 7168
    s_add_u32 s17, s49, 458752
    buffer_load_dwordx4 v211, s[20:23], s17 offen lds
    s_add_u32 m0, s46, 8192
    s_add_u32 s17, s49, 524288
    buffer_load_dwordx4 v211, s[20:23], s17 offen lds
    s_add_u32 m0, s46, 9216
    s_add_u32 s17, s49, 589824
    buffer_load_dwordx4 v211, s[20:23], s17 offen lds
    s_add_u32 m0, s46, 10240
    s_add_u32 s17, s49, 655360
    buffer_load_dwordx4 v211, s[20:23], s17 offen lds
    s_add_u32 m0, s46, 11264
    s_add_u32 s17, s49, 720896
    buffer_load_dwordx4 v211, s[20:23], s17 offen lds
    s_add_u32 m0, s46, 12288
    s_add_u32 s17, s49, 786432
    buffer_load_dwordx4 v211, s[20:23], s17 offen lds
    s_add_u32 m0, s46, 13312
    s_add_u32 s17, s49, 851968
    buffer_load_dwordx4 v211, s[20:23], s17 offen lds
    s_add_u32 m0, s46, 14336
    s_add_u32 s17, s49, 917504
    buffer_load_dwordx4 v211, s[20:23], s17 offen lds
    s_add_u32 m0, s46, 15360
    s_add_u32 s17, s49, 983040
    buffer_load_dwordx4 v211, s[20:23], s17 offen lds
    s_add_u32 m0, s46, 16384
    s_add_u32 s17, s49, 1048576
    buffer_load_dwordx4 v211, s[20:23], s17 offen lds
    s_add_u32 m0, s46, 17408
    s_add_u32 s17, s49, 1114112
    buffer_load_dwordx4 v211, s[20:23], s17 offen lds
    s_add_u32 m0, s46, 18432
    s_add_u32 s17, s49, 1179648
    buffer_load_dwordx4 v211, s[20:23], s17 offen lds
    s_add_u32 m0, s46, 19456
    s_add_u32 s17, s49, 1245184
    buffer_load_dwordx4 v211, s[20:23], s17 offen lds
    s_add_u32 m0, s46, 20480
    s_add_u32 s17, s49, 1310720
    buffer_load_dwordx4 v211, s[20:23], s17 offen lds
    s_add_u32 m0, s46, 21504
    s_add_u32 s17, s49, 1376256
    buffer_load_dwordx4 v211, s[20:23], s17 offen lds
    s_add_u32 m0, s46, 22528
    s_add_u32 s17, s49, 1441792
    buffer_load_dwordx4 v211, s[20:23], s17 offen lds
    s_add_u32 m0, s46, 23552
    s_add_u32 s17, s49, 1507328
    buffer_load_dwordx4 v211, s[20:23], s17 offen lds
    s_add_u32 m0, s46, 24576
    s_add_u32 s17, s49, 1572864
    buffer_load_dwordx4 v211, s[20:23], s17 offen lds
    s_add_u32 m0, s46, 25600
    s_add_u32 s17, s49, 1638400
    buffer_load_dwordx4 v211, s[20:23], s17 offen lds
    s_add_u32 m0, s46, 26624
    s_add_u32 s17, s49, 1703936
    buffer_load_dwordx4 v211, s[20:23], s17 offen lds
    s_add_u32 m0, s46, 27648
    s_add_u32 s17, s49, 1769472
    buffer_load_dwordx4 v211, s[20:23], s17 offen lds
    s_add_u32 m0, s46, 28672
    s_add_u32 s17, s49, 1835008
    buffer_load_dwordx4 v211, s[20:23], s17 offen lds
    s_add_u32 m0, s46, 29696
    s_add_u32 s17, s49, 1900544
    buffer_load_dwordx4 v211, s[20:23], s17 offen lds
    s_add_u32 m0, s46, 30720
    s_add_u32 s17, s49, 1966080
    buffer_load_dwordx4 v211, s[20:23], s17 offen lds
    s_add_u32 m0, s46, 31744
    s_add_u32 s17, s49, 2031616
    buffer_load_dwordx4 v211, s[20:23], s17 offen lds
    s_waitcnt vmcnt(30)
    ds_read_b64_tr_b16 a[0:1], v210 offset:0
    ds_read_b64_tr_b16 a[2:3], v210 offset:512
    ds_read_b64_tr_b16 a[144:145], v210 offset:64
    ds_read_b64_tr_b16 a[146:147], v210 offset:576
    s_waitcnt lgkmcnt(0)
    s_add_u32 m0, s46, 0
    s_add_u32 s17, s49, 2097152
    buffer_load_dwordx4 v211, s[20:23], s17 offen lds
    s_add_u32 m0, s46, 1024
    s_add_u32 s17, s49, 2162688
    buffer_load_dwordx4 v211, s[20:23], s17 offen lds
    s_waitcnt vmcnt(30)
    ds_read_b64_tr_b16 a[4:5], v210 offset:2048
    ds_read_b64_tr_b16 a[6:7], v210 offset:2560
    ds_read_b64_tr_b16 a[148:149], v210 offset:2112
    ds_read_b64_tr_b16 a[150:151], v210 offset:2624
    s_waitcnt lgkmcnt(0)
    s_add_u32 m0, s46, 2048
    s_add_u32 s17, s49, 2228224
    buffer_load_dwordx4 v211, s[20:23], s17 offen lds
    s_add_u32 m0, s46, 3072
    s_add_u32 s17, s49, 2293760
    buffer_load_dwordx4 v211, s[20:23], s17 offen lds
    s_waitcnt vmcnt(30)
    ds_read_b64_tr_b16 a[8:9], v210 offset:4096
    ds_read_b64_tr_b16 a[10:11], v210 offset:4608
    ds_read_b64_tr_b16 a[152:153], v210 offset:4160
    ds_read_b64_tr_b16 a[154:155], v210 offset:4672
    s_waitcnt lgkmcnt(0)
    s_add_u32 m0, s46, 4096
    s_add_u32 s17, s49, 2359296
    buffer_load_dwordx4 v211, s[20:23], s17 offen lds
    s_add_u32 m0, s46, 5120
    s_add_u32 s17, s49, 2424832
    buffer_load_dwordx4 v211, s[20:23], s17 offen lds
    s_waitcnt vmcnt(30)
    ds_read_b64_tr_b16 a[12:13], v210 offset:6144
    ds_read_b64_tr_b16 a[14:15], v210 offset:6656
    ds_read_b64_tr_b16 a[156:157], v210 offset:6208
    ds_read_b64_tr_b16 a[158:159], v210 offset:6720
    s_waitcnt lgkmcnt(0)
    s_add_u32 m0, s46, 6144
    s_add_u32 s17, s49, 2490368
    buffer_load_dwordx4 v211, s[20:23], s17 offen lds
    s_add_u32 m0, s46, 7168
    s_add_u32 s17, s49, 2555904
    buffer_load_dwordx4 v211, s[20:23], s17 offen lds
    s_waitcnt vmcnt(30)
    ds_read_b64_tr_b16 a[16:17], v210 offset:8192
    ds_read_b64_tr_b16 a[18:19], v210 offset:8704
    ds_read_b64_tr_b16 a[160:161], v210 offset:8256
    ds_read_b64_tr_b16 a[162:163], v210 offset:8768
    s_waitcnt lgkmcnt(0)
    s_add_u32 m0, s46, 8192
    s_add_u32 s17, s49, 2621440
    buffer_load_dwordx4 v211, s[20:23], s17 offen lds
    s_add_u32 m0, s46, 9216
    s_add_u32 s17, s49, 2686976
    buffer_load_dwordx4 v211, s[20:23], s17 offen lds
    s_waitcnt vmcnt(30)
    ds_read_b64_tr_b16 a[20:21], v210 offset:10240
    ds_read_b64_tr_b16 a[22:23], v210 offset:10752
    ds_read_b64_tr_b16 a[164:165], v210 offset:10304
    ds_read_b64_tr_b16 a[166:167], v210 offset:10816
    s_waitcnt lgkmcnt(0)
    s_add_u32 m0, s46, 10240
    s_add_u32 s17, s49, 2752512
    buffer_load_dwordx4 v211, s[20:23], s17 offen lds
    s_add_u32 m0, s46, 11264
    s_add_u32 s17, s49, 2818048
    buffer_load_dwordx4 v211, s[20:23], s17 offen lds
    s_waitcnt vmcnt(30)
    ds_read_b64_tr_b16 a[24:25], v210 offset:12288
    ds_read_b64_tr_b16 a[26:27], v210 offset:12800
    ds_read_b64_tr_b16 a[168:169], v210 offset:12352
    ds_read_b64_tr_b16 a[170:171], v210 offset:12864
    s_waitcnt lgkmcnt(0)
    s_add_u32 m0, s46, 12288
    s_add_u32 s17, s49, 2883584
    buffer_load_dwordx4 v211, s[20:23], s17 offen lds
    s_add_u32 m0, s46, 13312
    s_add_u32 s17, s49, 2949120
    buffer_load_dwordx4 v211, s[20:23], s17 offen lds
    s_waitcnt vmcnt(30)
    ds_read_b64_tr_b16 a[28:29], v210 offset:14336
    ds_read_b64_tr_b16 a[30:31], v210 offset:14848
    ds_read_b64_tr_b16 a[172:173], v210 offset:14400
    ds_read_b64_tr_b16 a[174:175], v210 offset:14912
    s_waitcnt lgkmcnt(0)
    s_add_u32 m0, s46, 14336
    s_add_u32 s17, s49, 3014656
    buffer_load_dwordx4 v211, s[20:23], s17 offen lds
    s_add_u32 m0, s46, 15360
    s_add_u32 s17, s49, 3080192
    buffer_load_dwordx4 v211, s[20:23], s17 offen lds
    s_waitcnt vmcnt(30)
    ds_read_b64_tr_b16 a[32:33], v210 offset:16384
    ds_read_b64_tr_b16 a[34:35], v210 offset:16896
    ds_read_b64_tr_b16 a[176:177], v210 offset:16448
    ds_read_b64_tr_b16 a[178:179], v210 offset:16960
    s_waitcnt lgkmcnt(0)
    s_add_u32 m0, s46, 16384
    s_add_u32 s17, s49, 3145728
    buffer_load_dwordx4 v211, s[20:23], s17 offen lds
    s_add_u32 m0, s46, 17408
    s_add_u32 s17, s49, 3211264
    buffer_load_dwordx4 v211, s[20:23], s17 offen lds
    s_waitcnt vmcnt(30)
    ds_read_b64_tr_b16 a[36:37], v210 offset:18432
    ds_read_b64_tr_b16 a[38:39], v210 offset:18944
    ds_read_b64_tr_b16 a[180:181], v210 offset:18496
    ds_read_b64_tr_b16 a[182:183], v210 offset:19008
    s_waitcnt lgkmcnt(0)
    s_add_u32 m0, s46, 18432
    s_add_u32 s17, s49, 3276800
    buffer_load_dwordx4 v211, s[20:23], s17 offen lds
    s_add_u32 m0, s46, 19456
    s_add_u32 s17, s49, 3342336
    buffer_load_dwordx4 v211, s[20:23], s17 offen lds
    s_waitcnt vmcnt(30)
    ds_read_b64_tr_b16 a[40:41], v210 offset:20480
    ds_read_b64_tr_b16 a[42:43], v210 offset:20992
    ds_read_b64_tr_b16 a[184:185], v210 offset:20544
    ds_read_b64_tr_b16 a[186:187], v210 offset:21056
    s_waitcnt lgkmcnt(0)
    s_add_u32 m0, s46, 20480
    s_add_u32 s17, s49, 3407872
    buffer_load_dwordx4 v211, s[20:23], s17 offen lds
    s_add_u32 m0, s46, 21504
    s_add_u32 s17, s49, 3473408
    buffer_load_dwordx4 v211, s[20:23], s17 offen lds
    s_waitcnt vmcnt(30)
    ds_read_b64_tr_b16 a[44:45], v210 offset:22528
    ds_read_b64_tr_b16 a[46:47], v210 offset:23040
    ds_read_b64_tr_b16 a[188:189], v210 offset:22592
    ds_read_b64_tr_b16 a[190:191], v210 offset:23104
    s_waitcnt lgkmcnt(0)
    s_add_u32 m0, s46, 22528
    s_add_u32 s17, s49, 3538944
    buffer_load_dwordx4 v211, s[20:23], s17 offen lds
    s_add_u32 m0, s46, 23552
    s_add_u32 s17, s49, 3604480
    buffer_load_dwordx4 v211, s[20:23], s17 offen lds
    s_waitcnt vmcnt(30)
    ds_read_b64_tr_b16 a[48:49], v210 offset:24576
    ds_read_b64_tr_b16 a[50:51], v210 offset:25088
    ds_read_b64_tr_b16 a[192:193], v210 offset:24640
    ds_read_b64_tr_b16 a[194:195], v210 offset:25152
    s_waitcnt lgkmcnt(0)
    s_add_u32 m0, s46, 24576
    s_add_u32 s17, s49, 3670016
    buffer_load_dwordx4 v211, s[20:23], s17 offen lds
    s_add_u32 m0, s46, 25600
    s_add_u32 s17, s49, 3735552
    buffer_load_dwordx4 v211, s[20:23], s17 offen lds
    s_waitcnt vmcnt(30)
    ds_read_b64_tr_b16 a[52:53], v210 offset:26624
    ds_read_b64_tr_b16 a[54:55], v210 offset:27136
    ds_read_b64_tr_b16 a[196:197], v210 offset:26688
    ds_read_b64_tr_b16 a[198:199], v210 offset:27200
    s_waitcnt lgkmcnt(0)
    s_add_u32 m0, s46, 26624
    s_add_u32 s17, s49, 3801088
    buffer_load_dwordx4 v211, s[20:23], s17 offen lds
    s_add_u32 m0, s46, 27648
    s_add_u32 s17, s49, 3866624
    buffer_load_dwordx4 v211, s[20:23], s17 offen lds
    s_waitcnt vmcnt(30)
    ds_read_b64_tr_b16 a[56:57], v210 offset:28672
    ds_read_b64_tr_b16 a[58:59], v210 offset:29184
    ds_read_b64_tr_b16 a[200:201], v210 offset:28736
    ds_read_b64_tr_b16 a[202:203], v210 offset:29248
    s_waitcnt lgkmcnt(0)
    s_add_u32 m0, s46, 28672
    s_add_u32 s17, s49, 3932160
    buffer_load_dwordx4 v211, s[20:23], s17 offen lds
    s_add_u32 m0, s46, 29696
    s_add_u32 s17, s49, 3997696
    buffer_load_dwordx4 v211, s[20:23], s17 offen lds
    s_waitcnt vmcnt(30)
    ds_read_b64_tr_b16 a[60:61], v210 offset:30720
    ds_read_b64_tr_b16 a[62:63], v210 offset:31232
    ds_read_b64_tr_b16 a[204:205], v210 offset:30784
    ds_read_b64_tr_b16 a[206:207], v210 offset:31296
    s_waitcnt lgkmcnt(0)
    s_add_u32 m0, s46, 30720
    s_add_u32 s17, s49, 4063232
    buffer_load_dwordx4 v211, s[20:23], s17 offen lds
    s_add_u32 m0, s46, 31744
    s_add_u32 s17, s49, 4128768
    buffer_load_dwordx4 v211, s[20:23], s17 offen lds
    s_waitcnt vmcnt(30)
    ds_read_b64_tr_b16 a[64:65], v210 offset:0
    ds_read_b64_tr_b16 a[66:67], v210 offset:512
    ds_read_b64_tr_b16 a[208:209], v210 offset:64
    ds_read_b64_tr_b16 a[210:211], v210 offset:576
    s_waitcnt lgkmcnt(0)
    s_add_u32 m0, s46, 0
    s_add_u32 s17, s49, 4194304
    buffer_load_dwordx4 v211, s[20:23], s17 offen lds
    s_add_u32 m0, s46, 1024
    s_add_u32 s17, s49, 4259840
    buffer_load_dwordx4 v211, s[20:23], s17 offen lds
    s_waitcnt vmcnt(30)
    ds_read_b64_tr_b16 a[68:69], v210 offset:2048
    ds_read_b64_tr_b16 a[70:71], v210 offset:2560
    ds_read_b64_tr_b16 a[212:213], v210 offset:2112
    ds_read_b64_tr_b16 a[214:215], v210 offset:2624
    s_waitcnt lgkmcnt(0)
    s_add_u32 m0, s46, 2048
    s_add_u32 s17, s49, 4325376
    buffer_load_dwordx4 v211, s[20:23], s17 offen lds
    s_add_u32 m0, s46, 3072
    s_add_u32 s17, s49, 4390912
    buffer_load_dwordx4 v211, s[20:23], s17 offen lds
    s_waitcnt vmcnt(30)
    ds_read_b64_tr_b16 a[72:73], v210 offset:4096
    ds_read_b64_tr_b16 a[74:75], v210 offset:4608
    ds_read_b64_tr_b16 a[216:217], v210 offset:4160
    ds_read_b64_tr_b16 a[218:219], v210 offset:4672
    s_waitcnt lgkmcnt(0)
    s_add_u32 m0, s46, 4096
    s_add_u32 s17, s49, 4456448
    buffer_load_dwordx4 v211, s[20:23], s17 offen lds
    s_add_u32 m0, s46, 5120
    s_add_u32 s17, s49, 4521984
    buffer_load_dwordx4 v211, s[20:23], s17 offen lds
    s_waitcnt vmcnt(30)
    ds_read_b64_tr_b16 a[76:77], v210 offset:6144
    ds_read_b64_tr_b16 a[78:79], v210 offset:6656
    ds_read_b64_tr_b16 a[220:221], v210 offset:6208
    ds_read_b64_tr_b16 a[222:223], v210 offset:6720
    s_waitcnt lgkmcnt(0)
    s_add_u32 m0, s46, 6144
    s_add_u32 s17, s49, 4587520
    buffer_load_dwordx4 v211, s[20:23], s17 offen lds
    s_add_u32 m0, s46, 7168
    s_add_u32 s17, s49, 4653056
    buffer_load_dwordx4 v211, s[20:23], s17 offen lds
    s_waitcnt vmcnt(30)
    ds_read_b64_tr_b16 a[80:81], v210 offset:8192
    ds_read_b64_tr_b16 a[82:83], v210 offset:8704
    ds_read_b64_tr_b16 a[224:225], v210 offset:8256
    ds_read_b64_tr_b16 a[226:227], v210 offset:8768
    s_waitcnt vmcnt(28)
    ds_read_b64_tr_b16 a[84:85], v210 offset:10240
    ds_read_b64_tr_b16 a[86:87], v210 offset:10752
    ds_read_b64_tr_b16 a[228:229], v210 offset:10304
    ds_read_b64_tr_b16 a[230:231], v210 offset:10816
    s_waitcnt vmcnt(26)
    ds_read_b64_tr_b16 a[88:89], v210 offset:12288
    ds_read_b64_tr_b16 a[90:91], v210 offset:12800
    ds_read_b64_tr_b16 a[232:233], v210 offset:12352
    ds_read_b64_tr_b16 a[234:235], v210 offset:12864
    s_waitcnt vmcnt(24)
    ds_read_b64_tr_b16 a[92:93], v210 offset:14336
    ds_read_b64_tr_b16 a[94:95], v210 offset:14848
    ds_read_b64_tr_b16 a[236:237], v210 offset:14400
    ds_read_b64_tr_b16 a[238:239], v210 offset:14912
    s_waitcnt vmcnt(22)
    ds_read_b64_tr_b16 a[96:97], v210 offset:16384
    ds_read_b64_tr_b16 a[98:99], v210 offset:16896
    ds_read_b64_tr_b16 a[240:241], v210 offset:16448
    ds_read_b64_tr_b16 a[242:243], v210 offset:16960
    s_waitcnt vmcnt(20)
    ds_read_b64_tr_b16 a[100:101], v210 offset:18432
    ds_read_b64_tr_b16 a[102:103], v210 offset:18944
    ds_read_b64_tr_b16 a[244:245], v210 offset:18496
    ds_read_b64_tr_b16 a[246:247], v210 offset:19008
    s_waitcnt vmcnt(18)
    ds_read_b64_tr_b16 a[104:105], v210 offset:20480
    ds_read_b64_tr_b16 a[106:107], v210 offset:20992
    ds_read_b64_tr_b16 a[248:249], v210 offset:20544
    ds_read_b64_tr_b16 a[250:251], v210 offset:21056
    s_waitcnt vmcnt(16)
    ds_read_b64_tr_b16 a[108:109], v210 offset:22528
    ds_read_b64_tr_b16 a[110:111], v210 offset:23040
    ds_read_b64_tr_b16 a[252:253], v210 offset:22592
    ds_read_b64_tr_b16 a[254:255], v210 offset:23104
    s_waitcnt vmcnt(14)
    ds_read_b64_tr_b16 a[112:113], v210 offset:24576
    ds_read_b64_tr_b16 a[114:115], v210 offset:25088
    ds_read_b64_tr_b16 v[224:225], v210 offset:24640
    ds_read_b64_tr_b16 v[226:227], v210 offset:25152
    s_waitcnt vmcnt(12)
    ds_read_b64_tr_b16 a[116:117], v210 offset:26624
    ds_read_b64_tr_b16 a[118:119], v210 offset:27136
    ds_read_b64_tr_b16 v[228:229], v210 offset:26688
    ds_read_b64_tr_b16 v[230:231], v210 offset:27200
    s_waitcnt vmcnt(10)
    ds_read_b64_tr_b16 a[120:121], v210 offset:28672
    ds_read_b64_tr_b16 a[122:123], v210 offset:29184
    ds_read_b64_tr_b16 v[232:233], v210 offset:28736
    ds_read_b64_tr_b16 v[234:235], v210 offset:29248
    s_waitcnt vmcnt(8)
    ds_read_b64_tr_b16 a[124:125], v210 offset:30720
    ds_read_b64_tr_b16 a[126:127], v210 offset:31232
    ds_read_b64_tr_b16 v[236:237], v210 offset:30784
    ds_read_b64_tr_b16 v[238:239], v210 offset:31296
    s_waitcnt vmcnt(6)
    ds_read_b64_tr_b16 a[128:129], v210 offset:0
    ds_read_b64_tr_b16 a[130:131], v210 offset:512
    ds_read_b64_tr_b16 v[240:241], v210 offset:64
    ds_read_b64_tr_b16 v[242:243], v210 offset:576
    s_waitcnt vmcnt(4)
    ds_read_b64_tr_b16 a[132:133], v210 offset:2048
    ds_read_b64_tr_b16 a[134:135], v210 offset:2560
    ds_read_b64_tr_b16 v[244:245], v210 offset:2112
    ds_read_b64_tr_b16 v[246:247], v210 offset:2624
    s_waitcnt vmcnt(2)
    ds_read_b64_tr_b16 a[136:137], v210 offset:4096
    ds_read_b64_tr_b16 a[138:139], v210 offset:4608
    ds_read_b64_tr_b16 v[248:249], v210 offset:4160
    ds_read_b64_tr_b16 v[250:251], v210 offset:4672
    s_waitcnt vmcnt(0)
    ds_read_b64_tr_b16 a[140:141], v210 offset:6144
    ds_read_b64_tr_b16 a[142:143], v210 offset:6656
    ds_read_b64_tr_b16 v[252:253], v210 offset:6208
    ds_read_b64_tr_b16 v[254:255], v210 offset:6720
    s_waitcnt vmcnt(0) lgkmcnt(0)
    v_bfe_u32 v10, v0, 4, 5
    v_lshrrev_b32 v5, 9, v0
    v_lshlrev_b32 v10, 4, v10
    v_mul_u32_u24 v6, 2560, v5
    v_add_u32 v10, v10, v6
    v_add_u32 v10, 114688, v10
    s_lshl_b32 s67, s14, 10
    v_bfe_u32 v6, v0, 8, 1
    v_lshlrev_b32 v13, 10, v6
    v_lshl_add_u32 v13, v7, 4, v13
    v_lshl_add_u32 v13, v5, 8, v13
    v_mov_b32 v212, 1
    v_mov_b32 v213, 1
    s_mul_i32 s52, s50, 16777216
    s_lshl_b32 s17, s51, 13
    s_add_u32 s52, s52, s17
    s_lshl_b32 s17, s47, 12
    s_add_u32 s52, s52, s17
    s_add_u32 s52, s52, 44040192
    s_lshl_b32 s49, s51, 9
    s_lshl_b32 s17, s50, 7
    s_add_u32 s49, s49, s17
    s_lshl_b32 s17, s47, 3
    s_add_u32 s49, s49, s17
    s_add_u32 s49, s49, 185600
    v_mov_b32 v48, 0x3f803f80
    v_mov_b32 v49, 0x3f803f80
    v_mov_b32 v50, 0x3f803f80
    v_mov_b32 v51, 0x3f803f80
    s_lshl_b32 s17, s14, 8
    s_add_u32 s17, s17, 110592
    v_bfe_u32 v5, v0, 4, 5
    v_lshl_add_u32 v14, v5, 2, s17
    v_lshrrev_b32 v5, 9, v0
    v_lshl_add_u32 v214, v5, 4, s17
    s_cmp_eq_u32 s50, 2
    s_cbranch_scc1 Lp_v
    v_mfma_f32_32x32x16_bf16 v[148:163], a[0:3], v[48:51], 0
    v_mfma_f32_32x32x16_bf16 v[148:163], a[4:7], v[48:51], v[148:163]
    v_mfma_f32_32x32x16_bf16 v[148:163], a[8:11], v[48:51], v[148:163]
    v_mfma_f32_32x32x16_bf16 v[148:163], a[12:15], v[48:51], v[148:163]
    v_mfma_f32_32x32x16_bf16 v[148:163], a[16:19], v[48:51], v[148:163]
    v_mfma_f32_32x32x16_bf16 v[148:163], a[20:23], v[48:51], v[148:163]
    v_mfma_f32_32x32x16_bf16 v[148:163], a[24:27], v[48:51], v[148:163]
    v_mfma_f32_32x32x16_bf16 v[148:163], a[28:31], v[48:51], v[148:163]
    v_mfma_f32_32x32x16_bf16 v[148:163], a[32:35], v[48:51], v[148:163]
    v_mfma_f32_32x32x16_bf16 v[148:163], a[36:39], v[48:51], v[148:163]
    v_mfma_f32_32x32x16_bf16 v[148:163], a[40:43], v[48:51], v[148:163]
    v_mfma_f32_32x32x16_bf16 v[148:163], a[44:47], v[48:51], v[148:163]
    v_mfma_f32_32x32x16_bf16 v[148:163], a[48:51], v[48:51], v[148:163]
    v_mfma_f32_32x32x16_bf16 v[148:163], a[52:55], v[48:51], v[148:163]
    v_mfma_f32_32x32x16_bf16 v[148:163], a[56:59], v[48:51], v[148:163]
    v_mfma_f32_32x32x16_bf16 v[148:163], a[60:63], v[48:51], v[148:163]
    v_mfma_f32_32x32x16_bf16 v[148:163], a[64:67], v[48:51], v[148:163]
    v_mfma_f32_32x32x16_bf16 v[148:163], a[68:71], v[48:51], v[148:163]
    v_mfma_f32_32x32x16_bf16 v[148:163], a[72:75], v[48:51], v[148:163]
    v_mfma_f32_32x32x16_bf16 v[148:163], a[76:79], v[48:51], v[148:163]
    v_mfma_f32_32x32x16_bf16 v[148:163], a[80:83], v[48:51], v[148:163]
    v_mfma_f32_32x32x16_bf16 v[148:163], a[84:87], v[48:51], v[148:163]
    v_mfma_f32_32x32x16_bf16 v[148:163], a[88:91], v[48:51], v[148:163]
    v_mfma_f32_32x32x16_bf16 v[148:163], a[92:95], v[48:51], v[148:163]
    v_mfma_f32_32x32x16_bf16 v[148:163], a[96:99], v[48:51], v[148:163]
    v_mfma_f32_32x32x16_bf16 v[148:163], a[100:103], v[48:51], v[148:163]
    v_mfma_f32_32x32x16_bf16 v[148:163], a[104:107], v[48:51], v[148:163]
    v_mfma_f32_32x32x16_bf16 v[148:163], a[108:111], v[48:51], v[148:163]
    v_mfma_f32_32x32x16_bf16 v[148:163], a[112:115], v[48:51], v[148:163]
    v_mfma_f32_32x32x16_bf16 v[148:163], a[116:119], v[48:51], v[148:163]
    v_mfma_f32_32x32x16_bf16 v[148:163], a[120:123], v[48:51], v[148:163]
    v_mfma_f32_32x32x16_bf16 v[148:163], a[124:127], v[48:51], v[148:163]
    v_mfma_f32_32x32x16_bf16 v[148:163], a[128:131], v[48:51], v[148:163]
    v_mfma_f32_32x32x16_bf16 v[148:163], a[132:135], v[48:51], v[148:163]
    v_mfma_f32_32x32x16_bf16 v[148:163], a[136:139], v[48:51], v[148:163]
    v_mfma_f32_32x32x16_bf16 v[148:163], a[140:143], v[48:51], v[148:163]
    v_mfma_f32_32x32x16_bf16 v[164:179], a[144:147], v[48:51], 0
    v_mfma_f32_32x32x16_bf16 v[164:179], a[148:151], v[48:51], v[164:179]
    v_mfma_f32_32x32x16_bf16 v[164:179], a[152:155], v[48:51], v[164:179]
    v_mfma_f32_32x32x16_bf16 v[164:179], a[156:159], v[48:51], v[164:179]
    v_mfma_f32_32x32x16_bf16 v[164:179], a[160:163], v[48:51], v[164:179]
    v_mfma_f32_32x32x16_bf16 v[164:179], a[164:167], v[48:51], v[164:179]
    v_mfma_f32_32x32x16_bf16 v[164:179], a[168:171], v[48:51], v[164:179]
    v_mfma_f32_32x32x16_bf16 v[164:179], a[172:175], v[48:51], v[164:179]
    v_mfma_f32_32x32x16_bf16 v[164:179], a[176:179], v[48:51], v[164:179]
    v_mfma_f32_32x32x16_bf16 v[164:179], a[180:183], v[48:51], v[164:179]
    v_mfma_f32_32x32x16_bf16 v[164:179], a[184:187], v[48:51], v[164:179]
    v_mfma_f32_32x32x16_bf16 v[164:179], a[188:191], v[48:51], v[164:179]
    v_mfma_f32_32x32x16_bf16 v[164:179], a[192:195], v[48:51], v[164:179]
    v_mfma_f32_32x32x16_bf16 v[164:179], a[196:199], v[48:51], v[164:179]
    v_mfma_f32_32x32x16_bf16 v[164:179], a[200:203], v[48:51], v[164:179]
    v_mfma_f32_32x32x16_bf16 v[164:179], a[204:207], v[48:51], v[164:179]
    v_mfma_f32_32x32x16_bf16 v[164:179], a[208:211], v[48:51], v[164:179]
    v_mfma_f32_32x32x16_bf16 v[164:179], a[212:215], v[48:51], v[164:179]
    v_mfma_f32_32x32x16_bf16 v[164:179], a[216:219], v[48:51], v[164:179]
    v_mfma_f32_32x32x16_bf16 v[164:179], a[220:223], v[48:51], v[164:179]
    v_mfma_f32_32x32x16_bf16 v[164:179], a[224:227], v[48:51], v[164:179]
    v_mfma_f32_32x32x16_bf16 v[164:179], a[228:231], v[48:51], v[164:179]
    v_mfma_f32_32x32x16_bf16 v[164:179], a[232:235], v[48:51], v[164:179]
    v_mfma_f32_32x32x16_bf16 v[164:179], a[236:239], v[48:51], v[164:179]
    v_mfma_f32_32x32x16_bf16 v[164:179], a[240:243], v[48:51], v[164:179]
    v_mfma_f32_32x32x16_bf16 v[164:179], a[244:247], v[48:51], v[164:179]
    v_mfma_f32_32x32x16_bf16 v[164:179], a[248:251], v[48:51], v[164:179]
    v_mfma_f32_32x32x16_bf16 v[164:179], a[252:255], v[48:51], v[164:179]
    v_mfma_f32_32x32x16_bf16 v[164:179], v[224:227], v[48:51], v[164:179]
    v_mfma_f32_32x32x16_bf16 v[164:179], v[228:231], v[48:51], v[164:179]
    v_mfma_f32_32x32x16_bf16 v[164:179], v[232:235], v[48:51], v[164:179]
    v_mfma_f32_32x32x16_bf16 v[164:179], v[236:239], v[48:51], v[164:179]
    v_mfma_f32_32x32x16_bf16 v[164:179], v[240:243], v[48:51], v[164:179]
    v_mfma_f32_32x32x16_bf16 v[164:179], v[244:247], v[48:51], v[164:179]
    v_mfma_f32_32x32x16_bf16 v[164:179], v[248:251], v[48:51], v[164:179]
    v_mfma_f32_32x32x16_bf16 v[164:179], v[252:255], v[48:51], v[164:179]
    s_mov_b32 s66, 114688
    s_mov_b32 s71, 0x2000
    s_mov_b32 s36, s63
    s_mov_b32 s34, s63
    s_mov_b32 s37, 0
    s_lshl_b32 s56, s63, 6
    s_mul_i32 s58, s14, 9216
    s_mov_b32 s40, 36864
    s_mov_b32 s59, s58
    s_mov_b32 s43, 0
    s_mov_b32 s28, s8
    s_mov_b32 s29, s9
    s_mov_b32 s30, 0
    s_mov_b32 s31, 0x00020000
    s_mul_i32 s41, s63, 4718592
    s_add_u32 s41, s41, s58
    s_add_u32 s41, s41, 8650752
    s_mul_i32 s42, s56, 22528
    s_add_u32 s42, s42, 183808
    s_cmp_lg_u32 s14, 0
    s_cbranch_scc1 LpQ_ini_d
    v_mov_b32 v5, 160
    s_mov_b32 s16, 0
LpQ_ini:
    global_load_dword v6, v5, s[12:13] sc1
    s_add_u32 s16, s16, 1
    s_cmp_gt_u32 s16, 100000
    s_cbranch_scc1 L_role_p_abort
    s_waitcnt vmcnt(0)
    v_cmp_gt_u32 vcc, 123, v6
    s_nop 0
    s_cbranch_vccz LpQ_ini_d
    s_sleep 8
    s_branch LpQ_ini
LpQ_ini_d:
    s_barrier
    s_branch LpQ_poll
LpQ_item:
    s_waitcnt vmcnt(4)
LpQ_go:
    s_barrier
    s_xor_b32 s40, s40, 36864
    s_xor_b32 s59, s59, 36864
    s_xor_b32 s66, s66, 0x2000
    s_xor_b32 s71, s71, 0x2000
    s_mov_b32 s35, s37
    s_mov_b32 s57, s56
    s_add_u32 s37, s37, 1
    s_add_u32 s56, s56, 1
    s_add_u32 s41, s41, 36864
    s_add_u32 s42, s42, 22528
    s_mov_b32 s62, 0
    v_add_u32 v9, s40, v0
    v_add_u32 v5, s71, v10
    ds_read_b128 v[48:51], v9 offset:0
    ds_read_b128 v[52:55], v9 offset:1024
    ds_read_b128 v[56:59], v9 offset:2048
    s_waitcnt lgkmcnt(2)
    v_mfma_f32_32x32x16_bf16 v[16:31], a[0:3], v[48:51], 0
    ds_read_b128 v[60:63], v9 offset:3072
    ds_read_b128 v[96:99], v5 offset:0
    ds_read_b128 v[100:103], v5 offset:512
    s_waitcnt lgkmcnt(4)
    v_mfma_f32_32x32x16_bf16 v[16:31], a[4:7], v[52:55], v[16:31]
    ds_read_b128 v[64:67], v9 offset:4096
    ds_read_b128 v[104:107], v5 offset:1024
    ds_read_b128 v[108:111], v5 offset:1536
    s_waitcnt lgkmcnt(6)
    v_mfma_f32_32x32x16_bf16 v[16:31], a[8:11], v[56:59], v[16:31]
    ds_read_b128 v[68:71], v9 offset:5120
    ds_read_b128 v[112:115], v5 offset:2048
    s_waitcnt lgkmcnt(7)
    v_mfma_f32_32x32x16_bf16 v[16:31], a[12:15], v[60:63], v[16:31]
    ds_read_b128 v[72:75], v9 offset:6144
    s_waitcnt lgkmcnt(6)
    v_add_f32 v96, v96, v100
    s_waitcnt lgkmcnt(5)
    v_mfma_f32_32x32x16_bf16 v[16:31], a[16:19], v[64:67], v[16:31]
    ds_read_b128 v[76:79], v9 offset:7168
    v_add_f32 v97, v97, v101
    v_add_f32 v98, v98, v102
    s_waitcnt lgkmcnt(3)
    v_mfma_f32_32x32x16_bf16 v[16:31], a[20:23], v[68:71], v[16:31]
    ds_read_b128 v[80:83], v9 offset:8192
    v_add_f32 v99, v99, v103
    v_add_f32 v96, v96, v104
    s_waitcnt lgkmcnt(2)
    v_mfma_f32_32x32x16_bf16 v[16:31], a[24:27], v[72:75], v[16:31]
    ds_read_b128 v[84:87], v9 offset:9216
    v_add_f32 v97, v97, v105
    v_add_f32 v98, v98, v106
    s_waitcnt lgkmcnt(2)
    v_mfma_f32_32x32x16_bf16 v[16:31], a[28:31], v[76:79], v[16:31]
    ds_read_b128 v[88:91], v9 offset:10240
    v_add_f32 v99, v99, v107
    v_add_f32 v96, v96, v108
    s_waitcnt lgkmcnt(2)
    v_mfma_f32_32x32x16_bf16 v[16:31], a[32:35], v[80:83], v[16:31]
    ds_read_b128 v[92:95], v9 offset:11264
    v_add_f32 v97, v97, v109
    v_add_f32 v98, v98, v110
    v_mfma_f32_32x32x16_bf16 v[32:47], a[144:147], v[48:51], 0
    v_add_f32 v99, v99, v111
    v_add_f32 v96, v96, v112
    s_waitcnt lgkmcnt(2)
    v_mfma_f32_32x32x16_bf16 v[16:31], a[36:39], v[84:87], v[16:31]
    ds_read_b128 v[48:51], v9 offset:12288
    v_add_f32 v97, v97, v113
    v_add_f32 v98, v98, v114
    v_mfma_f32_32x32x16_bf16 v[32:47], a[148:151], v[52:55], v[32:47]
    v_add_f32 v99, v99, v115
    v_add_f32 v96, v96, v98
    s_waitcnt lgkmcnt(2)
    v_mfma_f32_32x32x16_bf16 v[16:31], a[40:43], v[88:91], v[16:31]
    ds_read_b128 v[52:55], v9 offset:13312
    v_add_f32 v97, v97, v99
    v_mov_b32 v98, v96
    v_mfma_f32_32x32x16_bf16 v[32:47], a[152:155], v[56:59], v[32:47]
    v_mov_b32 v99, v97
    v_permlane32_swap_b32 v96, v98
    s_waitcnt lgkmcnt(2)
    v_mfma_f32_32x32x16_bf16 v[16:31], a[44:47], v[92:95], v[16:31]
    ds_read_b128 v[56:59], v9 offset:14336
    v_permlane32_swap_b32 v97, v99
    v_add_f32 v96, v96, v98
    v_mfma_f32_32x32x16_bf16 v[32:47], a[156:159], v[60:63], v[32:47]
    v_add_f32 v97, v97, v99
    v_mul_f32 v96, 0x3ae38e39, v96
    s_waitcnt lgkmcnt(2)
    v_mfma_f32_32x32x16_bf16 v[16:31], a[48:51], v[48:51], v[16:31]
    ds_read_b128 v[60:63], v9 offset:15360
    v_mul_f32 v97, 0x3ae38e39, v97
    v_fma_f32 v97, -v96, v96, v97
    v_mfma_f32_32x32x16_bf16 v[32:47], a[160:163], v[64:67], v[32:47]
    v_max_f32 v97, 0, v97
    v_add_f32 v97, 0x3727c5ac, v97
    s_waitcnt lgkmcnt(2)
    v_mfma_f32_32x32x16_bf16 v[16:31], a[52:55], v[52:55], v[16:31]
    ds_read_b128 v[64:67], v9 offset:16384
    v_rsq_f32 v116, v97
    s_nop 0
    v_mul_f32 v117, v96, v116
    v_mfma_f32_32x32x16_bf16 v[32:47], a[164:167], v[68:71], v[32:47]
    s_mul_i32 s46, s34, 50331648
    s_lshl_b32 s19, s35, 18
    s_waitcnt lgkmcnt(2)
    v_mfma_f32_32x32x16_bf16 v[16:31], a[56:59], v[56:59], v[16:31]
    ds_read_b128 v[68:71], v9 offset:17408
    s_waitcnt vmcnt(0)
    buffer_load_dword v2, v1, s[8:11], s42 offen sc1
    s_cmp_lg_u32 s43, 0
    s_cselect_b64 exec, 1, 0
    buffer_store_dwordx2 v[212:213], v4, s[8:11], s43 offen sc1
    s_mov_b64 exec, -1
    s_mov_b32 s43, 0
    v_mfma_f32_32x32x16_bf16 v[32:47], a[168:171], v[72:75], v[32:47]
    s_add_u32 s46, s46, s19
    s_add_u32 s46, s46, s52
    s_waitcnt lgkmcnt(2)
    v_mfma_f32_32x32x16_bf16 v[16:31], a[60:63], v[60:63], v[16:31]
    ds_read_b128 v[72:75], v9 offset:18432
    v_mfma_f32_32x32x16_bf16 v[32:47], a[172:175], v[76:79], v[32:47]
    s_waitcnt lgkmcnt(2)
    v_mfma_f32_32x32x16_bf16 v[16:31], a[64:67], v[64:67], v[16:31]
    ds_read_b128 v[76:79], v9 offset:19456
    v_mfma_f32_32x32x16_bf16 v[32:47], a[176:179], v[80:83], v[32:47]
    s_waitcnt lgkmcnt(2)
    v_mfma_f32_32x32x16_bf16 v[16:31], a[68:71], v[68:71], v[16:31]
    ds_read_b128 v[80:83], v9 offset:20480
    v_mfma_f32_32x32x16_bf16 v[32:47], a[180:183], v[84:87], v[32:47]
    s_waitcnt lgkmcnt(2)
    v_mfma_f32_32x32x16_bf16 v[16:31], a[72:75], v[72:75], v[16:31]
    ds_read_b128 v[84:87], v9 offset:21504
    v_mfma_f32_32x32x16_bf16 v[32:47], a[184:187], v[88:91], v[32:47]
    s_waitcnt lgkmcnt(2)
    v_mfma_f32_32x32x16_bf16 v[16:31], a[76:79], v[76:79], v[16:31]
    ds_read_b128 v[88:91], v9 offset:22528
    v_mfma_f32_32x32x16_bf16 v[32:47], a[188:191], v[92:95], v[32:47]
    s_waitcnt lgkmcnt(2)
    v_mfma_f32_32x32x16_bf16 v[16:31], a[80:83], v[80:83], v[16:31]
    ds_read_b128 v[92:95], v9 offset:23552
    v_mfma_f32_32x32x16_bf16 v[32:47], a[192:195], v[48:51], v[32:47]
    s_waitcnt lgkmcnt(2)
    v_mfma_f32_32x32x16_bf16 v[16:31], a[84:87], v[84:87], v[16:31]
    ds_read_b128 v[48:51], v9 offset:24576
    v_mfma_f32_32x32x16_bf16 v[32:47], a[196:199], v[52:55], v[32:47]
    s_waitcnt lgkmcnt(2)
    v_mfma_f32_32x32x16_bf16 v[16:31], a[88:91], v[88:91], v[16:31]
    ds_read_b128 v[52:55], v9 offset:25600
    v_mfma_f32_32x32x16_bf16 v[32:47], a[200:203], v[56:59], v[32:47]
    s_waitcnt lgkmcnt(2)
    v_mfma_f32_32x32x16_bf16 v[16:31], a[92:95], v[92:95], v[16:31]
    ds_read_b128 v[56:59], v9 offset:26624
    v_mfma_f32_32x32x16_bf16 v[32:47], a[204:207], v[60:63], v[32:47]
    s_waitcnt lgkmcnt(2)
    v_mfma_f32_32x32x16_bf16 v[16:31], a[96:99], v[48:51], v[16:31]
    ds_read_b128 v[60:63], v9 offset:27648
    v_mfma_f32_32x32x16_bf16 v[32:47], a[208:211], v[64:67], v[32:47]
    s_waitcnt lgkmcnt(2)
    v_mfma_f32_32x32x16_bf16 v[16:31], a[100:103], v[52:55], v[16:31]
    ds_read_b128 v[64:67], v9 offset:28672
    s_waitcnt vmcnt(1)
    v_cmp_eq_u32 vcc, 0, v2
    s_nop 0
    s_cmp_eq_u64 vcc, 0
    s_cselect_b32 s62, 1, 0
    s_cmp_lt_u32 s37, 64
    s_cselect_b32 s62, s62, 0
    s_cmp_lg_u32 s62, 0
    s_cselect_b32 s30, 268435456, 0
    v_mfma_f32_32x32x16_bf16 v[32:47], a[212:215], v[68:71], v[32:47]
    s_waitcnt lgkmcnt(2)
    v_mfma_f32_32x32x16_bf16 v[16:31], a[104:107], v[56:59], v[16:31]
    ds_read_b128 v[68:71], v9 offset:29696
    s_add_u32 m0, s59, 0
    s_add_u32 s47, s41, 0
    buffer_load_dwordx4 v0, s[28:31], s47 offen offset:0 lds
    v_mfma_f32_32x32x16_bf16 v[32:47], a[216:219], v[72:75], v[32:47]
    s_waitcnt lgkmcnt(2)
    v_mfma_f32_32x32x16_bf16 v[16:31], a[108:111], v[60:63], v[16:31]
    ds_read_b128 v[72:75], v9 offset:30720
    buffer_load_dwordx4 v0, s[28:31], s47 offen offset:1024 lds
    v_mfma_f32_32x32x16_bf16 v[32:47], a[220:223], v[76:79], v[32:47]
    s_waitcnt lgkmcnt(2)
    v_mfma_f32_32x32x16_bf16 v[16:31], a[112:115], v[64:67], v[16:31]
    ds_read_b128 v[76:79], v9 offset:31744
    buffer_load_dwordx4 v0, s[28:31], s47 offen offset:2048 lds
    v_mfma_f32_32x32x16_bf16 v[32:47], a[224:227], v[80:83], v[32:47]
    s_waitcnt lgkmcnt(2)
    v_mfma_f32_32x32x16_bf16 v[16:31], a[116:119], v[68:71], v[16:31]
    ds_read_b128 v[80:83], v9 offset:32768
    buffer_load_dwordx4 v0, s[28:31], s47 offen offset:3072 lds
    v_mfma_f32_32x32x16_bf16 v[32:47], a[228:231], v[84:87], v[32:47]
    s_waitcnt lgkmcnt(2)
    v_mfma_f32_32x32x16_bf16 v[16:31], a[120:123], v[72:75], v[16:31]
    ds_read_b128 v[84:87], v9 offset:33792
    s_add_u32 m0, s59, 4096
    s_add_u32 s47, s41, 4096
    buffer_load_dwordx4 v0, s[28:31], s47 offen offset:0 lds
    v_mfma_f32_32x32x16_bf16 v[32:47], a[232:235], v[88:91], v[32:47]
    s_waitcnt lgkmcnt(2)
    v_mfma_f32_32x32x16_bf16 v[16:31], a[124:127], v[76:79], v[16:31]
    ds_read_b128 v[88:91], v9 offset:34816
    buffer_load_dwordx4 v0, s[28:31], s47 offen offset:1024 lds
    v_mfma_f32_32x32x16_bf16 v[32:47], a[236:239], v[92:95], v[32:47]
    s_waitcnt lgkmcnt(2)
    v_mfma_f32_32x32x16_bf16 v[16:31], a[128:131], v[80:83], v[16:31]
    ds_read_b128 v[92:95], v9 offset:35840
    buffer_load_dwordx4 v0, s[28:31], s47 offen offset:2048 lds
    v_mfma_f32_32x32x16_bf16 v[32:47], a[240:243], v[48:51], v[32:47]
    s_waitcnt lgkmcnt(2)
    v_mfma_f32_32x32x16_bf16 v[16:31], a[132:135], v[84:87], v[16:31]
    buffer_load_dwordx4 v0, s[28:31], s47 offen offset:3072 lds
    v_mfma_f32_32x32x16_bf16 v[32:47], a[244:247], v[52:55], v[32:47]
    s_waitcnt lgkmcnt(1)
    v_mfma_f32_32x32x16_bf16 v[16:31], a[136:139], v[88:91], v[16:31]
    s_add_u32 m0, s59, 8192
    s_add_u32 s47, s41, 8192
    buffer_load_dwordx4 v0, s[28:31], s47 offen offset:0 lds
    v_mfma_f32_32x32x16_bf16 v[32:47], a[248:251], v[56:59], v[32:47]
    s_waitcnt lgkmcnt(0)
    v_mfma_f32_32x32x16_bf16 v[16:31], a[140:143], v[92:95], v[16:31]
    s_mul_i32 s48, s36, 786432
    s_mul_i32 s18, s37, 6144
    s_add_u32 s48, s48, s18
    s_add_u32 s48, s48, 16125952
    s_add_u32 m0, s66, 4096
    s_nop 0
    buffer_load_dwordx4 v0, s[28:31], s48 offen lds
    v_mfma_f32_32x32x16_bf16 v[32:47], a[252:255], v[60:63], v[32:47]
    v_mfma_f32_32x32x16_bf16 v[32:47], v[224:227], v[64:67], v[32:47]
    s_add_u32 m0, s66, s67
    s_sub_u32 s48, s48, 4096
    s_add_u32 s48, s48, s67
    buffer_load_dwordx4 v0, s[28:31], s48 offen lds
    v_mfma_f32_32x32x16_bf16 v[32:47], v[228:231], v[68:71], v[32:47]
    v_mul_f32 v180, v117, v148
    v_fma_f32 v16, v16, v116, -v180
    v_mul_f32 v184, v117, v152
    v_fma_f32 v20, v20, v116, -v184
    v_cvt_pk_bf16_f32 v196, v16, v20
    v_mfma_f32_32x32x16_bf16 v[32:47], v[232:235], v[72:75], v[32:47]
    v_mul_f32 v181, v117, v149
    v_fma_f32 v17, v17, v116, -v181
    v_mul_f32 v185, v117, v153
    v_fma_f32 v21, v21, v116, -v185
    v_cvt_pk_bf16_f32 v197, v17, v21
    v_mfma_f32_32x32x16_bf16 v[32:47], v[236:239], v[76:79], v[32:47]
    v_mul_f32 v182, v117, v150
    v_fma_f32 v18, v18, v116, -v182
    v_mul_f32 v186, v117, v154
    v_fma_f32 v22, v22, v116, -v186
    v_cvt_pk_bf16_f32 v198, v18, v22
    v_mfma_f32_32x32x16_bf16 v[32:47], v[240:243], v[80:83], v[32:47]
    v_mul_f32 v183, v117, v151
    v_fma_f32 v19, v19, v116, -v183
    v_mul_f32 v187, v117, v155
    v_fma_f32 v23, v23, v116, -v187
    v_cvt_pk_bf16_f32 v199, v19, v23
    v_mfma_f32_32x32x16_bf16 v[32:47], v[244:247], v[84:87], v[32:47]
    buffer_store_dwordx4 v[196:199], v13, s[8:11], s46 offen offset:0 sc1
    v_mul_f32 v188, v117, v156
    v_fma_f32 v24, v24, v116, -v188
    v_mul_f32 v192, v117, v160
    v_fma_f32 v28, v28, v116, -v192
    v_mfma_f32_32x32x16_bf16 v[32:47], v[248:251], v[88:91], v[32:47]
    v_cvt_pk_bf16_f32 v200, v24, v28
    v_mul_f32 v189, v117, v157
    v_fma_f32 v25, v25, v116, -v189
    v_mul_f32 v193, v117, v161
    v_fma_f32 v29, v29, v116, -v193
    v_mfma_f32_32x32x16_bf16 v[32:47], v[252:255], v[92:95], v[32:47]
    v_cvt_pk_bf16_f32 v201, v25, v29
    v_mul_f32 v190, v117, v158
    v_fma_f32 v26, v26, v116, -v190
    v_mul_f32 v194, v117, v162
    v_fma_f32 v30, v30, v116, -v194
    v_cvt_pk_bf16_f32 v202, v26, v30
    v_mul_f32 v191, v117, v159
    v_fma_f32 v27, v27, v116, -v191
    v_mul_f32 v195, v117, v163
    v_fma_f32 v31, v31, v116, -v195
    v_cvt_pk_bf16_f32 v203, v27, v31
    buffer_store_dwordx4 v[200:203], v13, s[8:11], s46 offen offset:512 sc1
    v_mul_f32 v180, v117, v164
    v_fma_f32 v32, v32, v116, -v180
    v_mul_f32 v184, v117, v168
    v_fma_f32 v36, v36, v116, -v184
    v_cvt_pk_bf16_f32 v196, v32, v36
    v_mul_f32 v181, v117, v165
    v_fma_f32 v33, v33, v116, -v181
    v_mul_f32 v185, v117, v169
    v_fma_f32 v37, v37, v116, -v185
    v_cvt_pk_bf16_f32 v197, v33, v37
    v_mul_f32 v182, v117, v166
    v_fma_f32 v34, v34, v116, -v182
    v_mul_f32 v186, v117, v170
    v_fma_f32 v38, v38, v116, -v186
    v_cvt_pk_bf16_f32 v198, v34, v38
    v_mul_f32 v183, v117, v167
    v_fma_f32 v35, v35, v116, -v183
    v_mul_f32 v187, v117, v171
    v_fma_f32 v39, v39, v116, -v187
    v_cvt_pk_bf16_f32 v199, v35, v39
    buffer_store_dwordx4 v[196:199], v13, s[8:11], s46 offen offset:2048 sc1
    v_mul_f32 v188, v117, v172
    v_fma_f32 v40, v40, v116, -v188
    v_mul_f32 v192, v117, v176
    v_fma_f32 v44, v44, v116, -v192
    v_cvt_pk_bf16_f32 v200, v40, v44
    v_mul_f32 v189, v117, v173
    v_fma_f32 v41, v41, v116, -v189
    v_mul_f32 v193, v117, v177
    v_fma_f32 v45, v45, v116, -v193
    v_cvt_pk_bf16_f32 v201, v41, v45
    v_mul_f32 v190, v117, v174
    v_fma_f32 v42, v42, v116, -v190
    v_mul_f32 v194, v117, v178
    v_fma_f32 v46, v46, v116, -v194
    v_cvt_pk_bf16_f32 v202, v42, v46
    v_mul_f32 v191, v117, v175
    v_fma_f32 v43, v43, v116, -v191
    v_mul_f32 v195, v117, v179
    v_fma_f32 v47, v47, v116, -v195
    v_cvt_pk_bf16_f32 v203, v43, v47
    buffer_store_dwordx4 v[200:203], v13, s[8:11], s46 offen offset:2560 sc1
    s_mul_i32 s43, s57, 22528
    s_add_u32 s43, s43, s49
    s_cmp_lg_u32 s62, 0
    s_cbranch_scc1 LpQ_item
    buffer_load_dword v2, v1, s[8:11], s42 offen sc1
    s_waitcnt vmcnt(0)
    s_cmp_ge_u32 s37, 64
    s_cbranch_scc1 LpQ_fin
    v_cmp_eq_u32 vcc, 0, v2
    s_nop 0
    s_cbranch_vccnz LpQ_pub
    s_add_u32 m0, s59, 0
    s_add_u32 s47, s41, 0
    buffer_load_dwordx4 v0, s[8:11], s47 offen offset:0 lds
    buffer_load_dwordx4 v0, s[8:11], s47 offen offset:1024 lds
    buffer_load_dwordx4 v0, s[8:11], s47 offen offset:2048 lds
    buffer_load_dwordx4 v0, s[8:11], s47 offen offset:3072 lds
    s_add_u32 m0, s59, 4096
    s_add_u32 s47, s41, 4096
    buffer_load_dwordx4 v0, s[8:11], s47 offen offset:0 lds
    buffer_load_dwordx4 v0, s[8:11], s47 offen offset:1024 lds
    buffer_load_dwordx4 v0, s[8:11], s47 offen offset:2048 lds
    buffer_load_dwordx4 v0, s[8:11], s47 offen offset:3072 lds
    s_add_u32 m0, s59, 8192
    s_add_u32 s47, s41, 8192
    buffer_load_dwordx4 v0, s[8:11], s47 offen offset:0 lds
    s_mul_i32 s48, s36, 786432
    s_mul_i32 s18, s37, 6144
    s_add_u32 s48, s48, s18
    s_add_u32 s48, s48, 16125952
    s_add_u32 m0, s66, 4096
    s_nop 0
    buffer_load_dwordx4 v0, s[8:11], s48 offen lds
    s_add_u32 m0, s66, s67
    s_sub_u32 s48, s48, 4096
    s_add_u32 s48, s48, s67
    buffer_load_dwordx4 v0, s[8:11], s48 offen lds
    s_cmp_lg_u32 s43, 0
    s_cselect_b64 exec, 1, 0
    buffer_store_dwordx2 v[212:213], v4, s[8:11], s43 offen sc1
    s_mov_b64 exec, -1
    s_mov_b32 s43, 0
    s_waitcnt vmcnt(1)
    s_branch LpQ_go
LpQ_fin:
    s_cmp_lg_u32 s43, 0
    s_cselect_b64 exec, 1, 0
    buffer_store_dwordx2 v[212:213], v4, s[8:11], s43 offen sc1
    s_mov_b64 exec, -1
    s_mov_b32 s43, 0
    s_branch L_role_p_exit
LpQ_pub:
    s_cmp_lg_u32 s43, 0
    s_cselect_b64 exec, 1, 0
    buffer_store_dwordx2 v[212:213], v4, s[8:11], s43 offen sc1
    s_mov_b64 exec, -1
    s_mov_b32 s43, 0
LpQ_poll:
    s_mov_b32 s16, 0
LpQ_pl:
    buffer_load_dword v2, v1, s[8:11], s42 offen sc1
    s_add_u32 s16, s16, 1
    s_cmp_gt_u32 s16, 100000
    s_cbranch_scc1 L_role_p_abort
    s_waitcnt vmcnt(0)
    v_cmp_eq_u32 vcc, 0, v2
    s_nop 0
    s_cbranch_vccz LpQ_pld
    s_sleep 4
    s_branch LpQ_pl
LpQ_pld:
    s_add_u32 m0, s59, 0
    s_add_u32 s47, s41, 0
    buffer_load_dwordx4 v0, s[8:11], s47 offen offset:0 lds
    buffer_load_dwordx4 v0, s[8:11], s47 offen offset:1024 lds
    buffer_load_dwordx4 v0, s[8:11], s47 offen offset:2048 lds
    buffer_load_dwordx4 v0, s[8:11], s47 offen offset:3072 lds
    s_add_u32 m0, s59, 4096
    s_add_u32 s47, s41, 4096
    buffer_load_dwordx4 v0, s[8:11], s47 offen offset:0 lds
    buffer_load_dwordx4 v0, s[8:11], s47 offen offset:1024 lds
    buffer_load_dwordx4 v0, s[8:11], s47 offen offset:2048 lds
    buffer_load_dwordx4 v0, s[8:11], s47 offen offset:3072 lds
    s_add_u32 m0, s59, 8192
    s_add_u32 s47, s41, 8192
    buffer_load_dwordx4 v0, s[8:11], s47 offen offset:0 lds
    s_mul_i32 s48, s36, 786432
    s_mul_i32 s18, s37, 6144
    s_add_u32 s48, s48, s18
    s_add_u32 s48, s48, 16125952
    s_add_u32 m0, s66, 4096
    s_nop 0
    buffer_load_dwordx4 v0, s[8:11], s48 offen lds
    s_add_u32 m0, s66, s67
    s_sub_u32 s48, s48, 4096
    s_add_u32 s48, s48, s67
    buffer_load_dwordx4 v0, s[8:11], s48 offen lds
    s_waitcnt vmcnt(0)
    s_branch LpQ_go
Lp_v:
    v_mfma_f32_32x32x16_bf16 v[16:31], v[48:51], a[0:3], 0
    v_mfma_f32_32x32x16_bf16 v[16:31], v[48:51], a[4:7], v[16:31]
    v_mfma_f32_32x32x16_bf16 v[16:31], v[48:51], a[8:11], v[16:31]
    v_mfma_f32_32x32x16_bf16 v[16:31], v[48:51], a[12:15], v[16:31]
    v_mfma_f32_32x32x16_bf16 v[16:31], v[48:51], a[16:19], v[16:31]
    v_mfma_f32_32x32x16_bf16 v[16:31], v[48:51], a[20:23], v[16:31]
    v_mfma_f32_32x32x16_bf16 v[16:31], v[48:51], a[24:27], v[16:31]
    v_mfma_f32_32x32x16_bf16 v[16:31], v[48:51], a[28:31], v[16:31]
    v_mfma_f32_32x32x16_bf16 v[16:31], v[48:51], a[32:35], v[16:31]
    v_mfma_f32_32x32x16_bf16 v[16:31], v[48:51], a[36:39], v[16:31]
    v_mfma_f32_32x32x16_bf16 v[16:31], v[48:51], a[40:43], v[16:31]
    v_mfma_f32_32x32x16_bf16 v[16:31], v[48:51], a[44:47], v[16:31]
    v_mfma_f32_32x32x16_bf16 v[16:31], v[48:51], a[48:51], v[16:31]
    v_mfma_f32_32x32x16_bf16 v[16:31], v[48:51], a[52:55], v[16:31]
    v_mfma_f32_32x32x16_bf16 v[16:31], v[48:51], a[56:59], v[16:31]
    v_mfma_f32_32x32x16_bf16 v[16:31], v[48:51], a[60:63], v[16:31]
    v_mfma_f32_32x32x16_bf16 v[16:31], v[48:51], a[64:67], v[16:31]
    v_mfma_f32_32x32x16_bf16 v[16:31], v[48:51], a[68:71], v[16:31]
    v_mfma_f32_32x32x16_bf16 v[16:31], v[48:51], a[72:75], v[16:31]
    v_mfma_f32_32x32x16_bf16 v[16:31], v[48:51], a[76:79], v[16:31]
    v_mfma_f32_32x32x16_bf16 v[16:31], v[48:51], a[80:83], v[16:31]
    v_mfma_f32_32x32x16_bf16 v[16:31], v[48:51], a[84:87], v[16:31]
    v_mfma_f32_32x32x16_bf16 v[16:31], v[48:51], a[88:91], v[16:31]
    v_mfma_f32_32x32x16_bf16 v[16:31], v[48:51], a[92:95], v[16:31]
    v_mfma_f32_32x32x16_bf16 v[16:31], v[48:51], a[96:99], v[16:31]
    v_mfma_f32_32x32x16_bf16 v[16:31], v[48:51], a[100:103], v[16:31]
    v_mfma_f32_32x32x16_bf16 v[16:31], v[48:51], a[104:107], v[16:31]
    v_mfma_f32_32x32x16_bf16 v[16:31], v[48:51], a[108:111], v[16:31]
    v_mfma_f32_32x32x16_bf16 v[16:31], v[48:51], a[112:115], v[16:31]
    v_mfma_f32_32x32x16_bf16 v[16:31], v[48:51], a[116:119], v[16:31]
    v_mfma_f32_32x32x16_bf16 v[16:31], v[48:51], a[120:123], v[16:31]
    v_mfma_f32_32x32x16_bf16 v[16:31], v[48:51], a[124:127], v[16:31]
    v_mfma_f32_32x32x16_bf16 v[16:31], v[48:51], a[128:131], v[16:31]
    v_mfma_f32_32x32x16_bf16 v[16:31], v[48:51], a[132:135], v[16:31]
    v_mfma_f32_32x32x16_bf16 v[16:31], v[48:51], a[136:139], v[16:31]
    v_mfma_f32_32x32x16_bf16 v[16:31], v[48:51], a[140:143], v[16:31]
    v_mfma_f32_32x32x16_bf16 v[32:47], v[48:51], a[144:147], 0
    v_mfma_f32_32x32x16_bf16 v[32:47], v[48:51], a[148:151], v[32:47]
    v_mfma_f32_32x32x16_bf16 v[32:47], v[48:51], a[152:155], v[32:47]
    v_mfma_f32_32x32x16_bf16 v[32:47], v[48:51], a[156:159], v[32:47]
    v_mfma_f32_32x32x16_bf16 v[32:47], v[48:51], a[160:163], v[32:47]
    v_mfma_f32_32x32x16_bf16 v[32:47], v[48:51], a[164:167], v[32:47]
    v_mfma_f32_32x32x16_bf16 v[32:47], v[48:51], a[168:171], v[32:47]
    v_mfma_f32_32x32x16_bf16 v[32:47], v[48:51], a[172:175], v[32:47]
    v_mfma_f32_32x32x16_bf16 v[32:47], v[48:51], a[176:179], v[32:47]
    v_mfma_f32_32x32x16_bf16 v[32:47], v[48:51], a[180:183], v[32:47]
    v_mfma_f32_32x32x16_bf16 v[32:47], v[48:51], a[184:187], v[32:47]
    v_mfma_f32_32x32x16_bf16 v[32:47], v[48:51], a[188:191], v[32:47]
    v_mfma_f32_32x32x16_bf16 v[32:47], v[48:51], a[192:195], v[32:47]
    v_mfma_f32_32x32x16_bf16 v[32:47], v[48:51], a[196:199], v[32:47]
    v_mfma_f32_32x32x16_bf16 v[32:47], v[48:51], a[200:203], v[32:47]
    v_mfma_f32_32x32x16_bf16 v[32:47], v[48:51], a[204:207], v[32:47]
    v_mfma_f32_32x32x16_bf16 v[32:47], v[48:51], a[208:211], v[32:47]
    v_mfma_f32_32x32x16_bf16 v[32:47], v[48:51], a[212:215], v[32:47]
    v_mfma_f32_32x32x16_bf16 v[32:47], v[48:51], a[216:219], v[32:47]
    v_mfma_f32_32x32x16_bf16 v[32:47], v[48:51], a[220:223], v[32:47]
    v_mfma_f32_32x32x16_bf16 v[32:47], v[48:51], a[224:227], v[32:47]
    v_mfma_f32_32x32x16_bf16 v[32:47], v[48:51], a[228:231], v[32:47]
    v_mfma_f32_32x32x16_bf16 v[32:47], v[48:51], a[232:235], v[32:47]
    v_mfma_f32_32x32x16_bf16 v[32:47], v[48:51], a[236:239], v[32:47]
    v_mfma_f32_32x32x16_bf16 v[32:47], v[48:51], a[240:243], v[32:47]
    v_mfma_f32_32x32x16_bf16 v[32:47], v[48:51], a[244:247], v[32:47]
    v_mfma_f32_32x32x16_bf16 v[32:47], v[48:51], a[248:251], v[32:47]
    v_mfma_f32_32x32x16_bf16 v[32:47], v[48:51], a[252:255], v[32:47]
    v_mfma_f32_32x32x16_bf16 v[32:47], v[48:51], v[224:227], v[32:47]
    v_mfma_f32_32x32x16_bf16 v[32:47], v[48:51], v[228:231], v[32:47]
    v_mfma_f32_32x32x16_bf16 v[32:47], v[48:51], v[232:235], v[32:47]
    v_mfma_f32_32x32x16_bf16 v[32:47], v[48:51], v[236:239], v[32:47]
    v_mfma_f32_32x32x16_bf16 v[32:47], v[48:51], v[240:243], v[32:47]
    v_mfma_f32_32x32x16_bf16 v[32:47], v[48:51], v[244:247], v[32:47]
    v_mfma_f32_32x32x16_bf16 v[32:47], v[48:51], v[248:251], v[32:47]
    v_mfma_f32_32x32x16_bf16 v[32:47], v[48:51], v[252:255], v[32:47]
    v_mov_b32 v11, v16
    s_nop 10
    v_mov_b32 v12, v32
    s_mov_b32 s66, 114688
    s_mov_b32 s71, 0x2000
    s_mov_b32 s36, s63
    s_mov_b32 s34, s63
    s_mov_b32 s37, 0
    s_lshl_b32 s56, s63, 6
    s_mul_i32 s58, s14, 9216
    s_mov_b32 s40, 36864
    s_mov_b32 s59, s58
    s_mov_b32 s43, 0
    s_mov_b32 s28, s8
    s_mov_b32 s29, s9
    s_mov_b32 s30, 0
    s_mov_b32 s31, 0x00020000
    s_mul_i32 s41, s63, 4718592
    s_add_u32 s41, s41, s58
    s_add_u32 s41, s41, 8650752
    s_mul_i32 s42, s56, 22528
    s_add_u32 s42, s42, 183808
    s_cmp_lg_u32 s14, 0
    s_cbranch_scc1 LpV_ini_d
    v_mov_b32 v5, 160
    s_mov_b32 s16, 0
LpV_ini:
    global_load_dword v6, v5, s[12:13] sc1
    s_add_u32 s16, s16, 1
    s_cmp_gt_u32 s16, 100000
    s_cbranch_scc1 L_role_p_abort
    s_waitcnt vmcnt(0)
    v_cmp_gt_u32 vcc, 123, v6
    s_nop 0
    s_cbranch_vccz LpV_ini_d
    s_sleep 8
    s_branch LpV_ini
LpV_ini_d:
    s_barrier
    s_branch LpV_poll
LpV_item:
    s_waitcnt vmcnt(4)
LpV_go:
    s_barrier
    s_xor_b32 s40, s40, 36864
    s_xor_b32 s59, s59, 36864
    s_xor_b32 s66, s66, 0x2000
    s_xor_b32 s71, s71, 0x2000
    s_mov_b32 s35, s37
    s_mov_b32 s57, s56
    s_add_u32 s37, s37, 1
    s_add_u32 s56, s56, 1
    s_add_u32 s41, s41, 36864
    s_add_u32 s42, s42, 22528
    s_mov_b32 s62, 0
    v_add_u32 v9, s40, v0
    v_add_u32 v5, s71, v10
    ds_read_b128 v[48:51], v9 offset:0
    ds_read_b128 v[52:55], v9 offset:1024
    ds_read_b128 v[56:59], v9 offset:2048
    s_waitcnt lgkmcnt(2)
    v_mfma_f32_32x32x16_bf16 v[16:31], v[48:51], a[0:3], 0
    ds_read_b128 v[60:63], v9 offset:3072
    ds_read_b128 v[96:99], v5 offset:0
    ds_read_b128 v[100:103], v5 offset:512
    s_waitcnt lgkmcnt(4)
    v_mfma_f32_32x32x16_bf16 v[16:31], v[52:55], a[4:7], v[16:31]
    ds_read_b128 v[64:67], v9 offset:4096
    ds_read_b128 v[104:107], v5 offset:1024
    ds_read_b128 v[108:111], v5 offset:1536
    s_waitcnt lgkmcnt(6)
    v_mfma_f32_32x32x16_bf16 v[16:31], v[56:59], a[8:11], v[16:31]
    ds_read_b128 v[68:71], v9 offset:5120
    ds_read_b128 v[112:115], v5 offset:2048
    s_waitcnt lgkmcnt(7)
    v_mfma_f32_32x32x16_bf16 v[16:31], v[60:63], a[12:15], v[16:31]
    ds_read_b128 v[72:75], v9 offset:6144
    s_waitcnt lgkmcnt(6)
    v_add_f32 v96, v96, v100
    s_waitcnt lgkmcnt(5)
    v_mfma_f32_32x32x16_bf16 v[16:31], v[64:67], a[16:19], v[16:31]
    ds_read_b128 v[76:79], v9 offset:7168
    v_add_f32 v97, v97, v101
    v_add_f32 v98, v98, v102
    s_waitcnt lgkmcnt(3)
    v_mfma_f32_32x32x16_bf16 v[16:31], v[68:71], a[20:23], v[16:31]
    ds_read_b128 v[80:83], v9 offset:8192
    v_add_f32 v99, v99, v103
    v_add_f32 v96, v96, v104
    s_waitcnt lgkmcnt(2)
    v_mfma_f32_32x32x16_bf16 v[16:31], v[72:75], a[24:27], v[16:31]
    ds_read_b128 v[84:87], v9 offset:9216
    v_add_f32 v97, v97, v105
    v_add_f32 v98, v98, v106
    s_waitcnt lgkmcnt(2)
    v_mfma_f32_32x32x16_bf16 v[16:31], v[76:79], a[28:31], v[16:31]
    ds_read_b128 v[88:91], v9 offset:10240
    v_add_f32 v99, v99, v107
    v_add_f32 v96, v96, v108
    s_waitcnt lgkmcnt(2)
    v_mfma_f32_32x32x16_bf16 v[16:31], v[80:83], a[32:35], v[16:31]
    ds_read_b128 v[92:95], v9 offset:11264
    v_add_f32 v97, v97, v109
    v_add_f32 v98, v98, v110
    v_mfma_f32_32x32x16_bf16 v[32:47], v[48:51], a[144:147], 0
    v_add_f32 v99, v99, v111
    v_add_f32 v96, v96, v112
    s_waitcnt lgkmcnt(2)
    v_mfma_f32_32x32x16_bf16 v[16:31], v[84:87], a[36:39], v[16:31]
    ds_read_b128 v[48:51], v9 offset:12288
    v_add_f32 v97, v97, v113
    v_add_f32 v98, v98, v114
    v_mfma_f32_32x32x16_bf16 v[32:47], v[52:55], a[148:151], v[32:47]
    v_add_f32 v99, v99, v115
    v_add_f32 v96, v96, v98
    s_waitcnt lgkmcnt(2)
    v_mfma_f32_32x32x16_bf16 v[16:31], v[88:91], a[40:43], v[16:31]
    ds_read_b128 v[52:55], v9 offset:13312
    v_add_f32 v97, v97, v99
    v_mov_b32 v98, v96
    v_mfma_f32_32x32x16_bf16 v[32:47], v[56:59], a[152:155], v[32:47]
    v_mov_b32 v99, v97
    v_permlane32_swap_b32 v96, v98
    s_waitcnt lgkmcnt(2)
    v_mfma_f32_32x32x16_bf16 v[16:31], v[92:95], a[44:47], v[16:31]
    ds_read_b128 v[56:59], v9 offset:14336
    v_permlane32_swap_b32 v97, v99
    v_add_f32 v96, v96, v98
    v_mfma_f32_32x32x16_bf16 v[32:47], v[60:63], a[156:159], v[32:47]
    v_add_f32 v97, v97, v99
    v_mul_f32 v96, 0x3ae38e39, v96
    s_waitcnt lgkmcnt(2)
    v_mfma_f32_32x32x16_bf16 v[16:31], v[48:51], a[48:51], v[16:31]
    ds_read_b128 v[60:63], v9 offset:15360
    v_mul_f32 v97, 0x3ae38e39, v97
    v_fma_f32 v97, -v96, v96, v97
    v_mfma_f32_32x32x16_bf16 v[32:47], v[64:67], a[160:163], v[32:47]
    v_max_f32 v97, 0, v97
    v_add_f32 v97, 0x3727c5ac, v97
    s_waitcnt lgkmcnt(2)
    v_mfma_f32_32x32x16_bf16 v[16:31], v[52:55], a[52:55], v[16:31]
    ds_read_b128 v[64:67], v9 offset:16384
    v_rsq_f32 v116, v97
    s_nop 0
    v_mul_f32 v117, v96, v116
    v_mfma_f32_32x32x16_bf16 v[32:47], v[68:71], a[164:167], v[32:47]
    ds_write2_b32 v14, v116, v117 offset0:0 offset1:32
    ds_read_b128 v[116:119], v214 offset:0
    s_waitcnt lgkmcnt(4)
    v_mfma_f32_32x32x16_bf16 v[16:31], v[56:59], a[56:59], v[16:31]
    ds_read_b128 v[68:71], v9 offset:17408
    s_waitcnt vmcnt(0)
    buffer_load_dword v2, v1, s[8:11], s42 offen sc1
    s_cmp_lg_u32 s43, 0
    s_cselect_b64 exec, 1, 0
    buffer_store_dwordx2 v[212:213], v4, s[8:11], s43 offen sc1
    s_mov_b64 exec, -1
    s_mov_b32 s43, 0
    v_mfma_f32_32x32x16_bf16 v[32:47], v[72:75], a[168:171], v[32:47]
    ds_read_b128 v[120:123], v214 offset:32
    ds_read_b128 v[124:127], v214 offset:64
    s_waitcnt lgkmcnt(6)
    v_mfma_f32_32x32x16_bf16 v[16:31], v[60:63], a[60:63], v[16:31]
    ds_read_b128 v[72:75], v9 offset:18432
    ds_read_b128 v[128:131], v214 offset:96
    ds_read_b128 v[132:135], v214 offset:128
    v_mfma_f32_32x32x16_bf16 v[32:47], v[76:79], a[172:175], v[32:47]
    ds_read_b128 v[136:139], v214 offset:160
    ds_read_b128 v[140:143], v214 offset:192
    s_waitcnt lgkmcnt(10)
    v_mfma_f32_32x32x16_bf16 v[16:31], v[64:67], a[64:67], v[16:31]
    ds_read_b128 v[76:79], v9 offset:19456
    ds_read_b128 v[144:147], v214 offset:224
    s_mul_i32 s46, s34, 50331648
    v_mfma_f32_32x32x16_bf16 v[32:47], v[80:83], a[176:179], v[32:47]
    s_lshl_b32 s19, s35, 18
    s_add_u32 s46, s46, s19
    s_waitcnt lgkmcnt(9)
    v_mfma_f32_32x32x16_bf16 v[16:31], v[68:71], a[68:71], v[16:31]
    ds_read_b128 v[80:83], v9 offset:20480
    s_add_u32 s46, s46, s52
    v_mfma_f32_32x32x16_bf16 v[32:47], v[84:87], a[180:183], v[32:47]
    s_waitcnt lgkmcnt(7)
    v_mfma_f32_32x32x16_bf16 v[16:31], v[72:75], a[72:75], v[16:31]
    ds_read_b128 v[84:87], v9 offset:21504
    v_mfma_f32_32x32x16_bf16 v[32:47], v[88:91], a[184:187], v[32:47]
    s_waitcnt lgkmcnt(3)
    v_mfma_f32_32x32x16_bf16 v[16:31], v[76:79], a[76:79], v[16:31]
    ds_read_b128 v[88:91], v9 offset:22528
    v_mfma_f32_32x32x16_bf16 v[32:47], v[92:95], a[188:191], v[32:47]
    s_waitcnt lgkmcnt(2)
    v_mfma_f32_32x32x16_bf16 v[16:31], v[80:83], a[80:83], v[16:31]
    ds_read_b128 v[92:95], v9 offset:23552
    v_mfma_f32_32x32x16_bf16 v[32:47], v[48:51], a[192:195], v[32:47]
    s_waitcnt lgkmcnt(2)
    v_mfma_f32_32x32x16_bf16 v[16:31], v[84:87], a[84:87], v[16:31]
    ds_read_b128 v[48:51], v9 offset:24576
    v_mfma_f32_32x32x16_bf16 v[32:47], v[52:55], a[196:199], v[32:47]
    s_waitcnt lgkmcnt(2)
    v_mfma_f32_32x32x16_bf16 v[16:31], v[88:91], a[88:91], v[16:31]
    ds_read_b128 v[52:55], v9 offset:25600
    v_mfma_f32_32x32x16_bf16 v[32:47], v[56:59], a[200:203], v[32:47]
    s_waitcnt lgkmcnt(2)
    v_mfma_f32_32x32x16_bf16 v[16:31], v[92:95], a[92:95], v[16:31]
    ds_read_b128 v[56:59], v9 offset:26624
    v_mfma_f32_32x32x16_bf16 v[32:47], v[60:63], a[204:207], v[32:47]
    s_waitcnt lgkmcnt(2)
    v_mfma_f32_32x32x16_bf16 v[16:31], v[48:51], a[96:99], v[16:31]
    ds_read_b128 v[60:63], v9 offset:27648
    v_mfma_f32_32x32x16_bf16 v[32:47], v[64:67], a[208:211], v[32:47]
    s_waitcnt lgkmcnt(2)
    v_mfma_f32_32x32x16_bf16 v[16:31], v[52:55], a[100:103], v[16:31]
    ds_read_b128 v[64:67], v9 offset:28672
    s_waitcnt vmcnt(1)
    v_cmp_eq_u32 vcc, 0, v2
    s_nop 0
    s_cmp_eq_u64 vcc, 0
    s_cselect_b32 s62, 1, 0
    s_cmp_lt_u32 s37, 64
    s_cselect_b32 s62, s62, 0
    s_cmp_lg_u32 s62, 0
    s_cselect_b32 s30, 268435456, 0
    v_mfma_f32_32x32x16_bf16 v[32:47], v[68:71], a[212:215], v[32:47]
    s_waitcnt lgkmcnt(2)
    v_mfma_f32_32x32x16_bf16 v[16:31], v[56:59], a[104:107], v[16:31]
    ds_read_b128 v[68:71], v9 offset:29696
    s_add_u32 m0, s59, 0
    s_add_u32 s47, s41, 0
    buffer_load_dwordx4 v0, s[28:31], s47 offen offset:0 lds
    v_mfma_f32_32x32x16_bf16 v[32:47], v[72:75], a[216:219], v[32:47]
    s_waitcnt lgkmcnt(2)
    v_mfma_f32_32x32x16_bf16 v[16:31], v[60:63], a[108:111], v[16:31]
    ds_read_b128 v[72:75], v9 offset:30720
    buffer_load_dwordx4 v0, s[28:31], s47 offen offset:1024 lds
    v_mfma_f32_32x32x16_bf16 v[32:47], v[76:79], a[220:223], v[32:47]
    s_waitcnt lgkmcnt(2)
    v_mfma_f32_32x32x16_bf16 v[16:31], v[64:67], a[112:115], v[16:31]
    ds_read_b128 v[76:79], v9 offset:31744
    buffer_load_dwordx4 v0, s[28:31], s47 offen offset:2048 lds
    v_mfma_f32_32x32x16_bf16 v[32:47], v[80:83], a[224:227], v[32:47]
    s_waitcnt lgkmcnt(2)
    v_mfma_f32_32x32x16_bf16 v[16:31], v[68:71], a[116:119], v[16:31]
    ds_read_b128 v[80:83], v9 offset:32768
    buffer_load_dwordx4 v0, s[28:31], s47 offen offset:3072 lds
    v_mfma_f32_32x32x16_bf16 v[32:47], v[84:87], a[228:231], v[32:47]
    s_waitcnt lgkmcnt(2)
    v_mfma_f32_32x32x16_bf16 v[16:31], v[72:75], a[120:123], v[16:31]
    ds_read_b128 v[84:87], v9 offset:33792
    s_add_u32 m0, s59, 4096
    s_add_u32 s47, s41, 4096
    buffer_load_dwordx4 v0, s[28:31], s47 offen offset:0 lds
    v_mfma_f32_32x32x16_bf16 v[32:47], v[88:91], a[232:235], v[32:47]
    s_waitcnt lgkmcnt(2)
    v_mfma_f32_32x32x16_bf16 v[16:31], v[76:79], a[124:127], v[16:31]
    ds_read_b128 v[88:91], v9 offset:34816
    buffer_load_dwordx4 v0, s[28:31], s47 offen offset:1024 lds
    v_mfma_f32_32x32x16_bf16 v[32:47], v[92:95], a[236:239], v[32:47]
    s_waitcnt lgkmcnt(2)
    v_mfma_f32_32x32x16_bf16 v[16:31], v[80:83], a[128:131], v[16:31]
    ds_read_b128 v[92:95], v9 offset:35840
    buffer_load_dwordx4 v0, s[28:31], s47 offen offset:2048 lds
    v_mfma_f32_32x32x16_bf16 v[32:47], v[48:51], a[240:243], v[32:47]
    s_waitcnt lgkmcnt(2)
    v_mfma_f32_32x32x16_bf16 v[16:31], v[84:87], a[132:135], v[16:31]
    buffer_load_dwordx4 v0, s[28:31], s47 offen offset:3072 lds
    v_mfma_f32_32x32x16_bf16 v[32:47], v[52:55], a[244:247], v[32:47]
    s_waitcnt lgkmcnt(1)
    v_mfma_f32_32x32x16_bf16 v[16:31], v[88:91], a[136:139], v[16:31]
    s_add_u32 m0, s59, 8192
    s_add_u32 s47, s41, 8192
    buffer_load_dwordx4 v0, s[28:31], s47 offen offset:0 lds
    v_mfma_f32_32x32x16_bf16 v[32:47], v[56:59], a[248:251], v[32:47]
    s_waitcnt lgkmcnt(0)
    v_mfma_f32_32x32x16_bf16 v[16:31], v[92:95], a[140:143], v[16:31]
    s_mul_i32 s48, s36, 786432
    s_mul_i32 s18, s37, 6144
    s_add_u32 s48, s48, s18
    s_add_u32 s48, s48, 16125952
    s_add_u32 m0, s66, 4096
    s_nop 0
    buffer_load_dwordx4 v0, s[28:31], s48 offen lds
    v_mfma_f32_32x32x16_bf16 v[32:47], v[60:63], a[252:255], v[32:47]
    v_mfma_f32_32x32x16_bf16 v[32:47], v[64:67], v[224:227], v[32:47]
    s_add_u32 m0, s66, s67
    s_sub_u32 s48, s48, 4096
    s_add_u32 s48, s48, s67
    buffer_load_dwordx4 v0, s[28:31], s48 offen lds
    v_mfma_f32_32x32x16_bf16 v[32:47], v[68:71], v[228:231], v[32:47]
    v_mul_f32 v180, v11, v132
    v_fma_f32 v16, v16, v116, -v180
    v_mul_f32 v181, v11, v133
    v_fma_f32 v17, v17, v117, -v181
    v_cvt_pk_bf16_f32 v196, v16, v17
    v_mfma_f32_32x32x16_bf16 v[32:47], v[72:75], v[232:235], v[32:47]
    v_mul_f32 v182, v11, v134
    v_fma_f32 v18, v18, v118, -v182
    v_mul_f32 v183, v11, v135
    v_fma_f32 v19, v19, v119, -v183
    v_cvt_pk_bf16_f32 v197, v18, v19
    v_mfma_f32_32x32x16_bf16 v[32:47], v[76:79], v[236:239], v[32:47]
    v_mul_f32 v188, v11, v140
    v_fma_f32 v24, v24, v124, -v188
    v_mul_f32 v189, v11, v141
    v_fma_f32 v25, v25, v125, -v189
    v_cvt_pk_bf16_f32 v198, v24, v25
    v_mfma_f32_32x32x16_bf16 v[32:47], v[80:83], v[240:243], v[32:47]
    v_mul_f32 v190, v11, v142
    v_fma_f32 v26, v26, v126, -v190
    v_mul_f32 v191, v11, v143
    v_fma_f32 v27, v27, v127, -v191
    v_cvt_pk_bf16_f32 v199, v26, v27
    v_mfma_f32_32x32x16_bf16 v[32:47], v[84:87], v[244:247], v[32:47]
    buffer_store_dwordx4 v[196:199], v13, s[8:11], s46 offen offset:0 sc1
    v_mul_f32 v184, v11, v136
    v_fma_f32 v20, v20, v120, -v184
    v_mul_f32 v185, v11, v137
    v_fma_f32 v21, v21, v121, -v185
    v_mfma_f32_32x32x16_bf16 v[32:47], v[88:91], v[248:251], v[32:47]
    v_cvt_pk_bf16_f32 v200, v20, v21
    v_mul_f32 v186, v11, v138
    v_fma_f32 v22, v22, v122, -v186
    v_mul_f32 v187, v11, v139
    v_fma_f32 v23, v23, v123, -v187
    v_mfma_f32_32x32x16_bf16 v[32:47], v[92:95], v[252:255], v[32:47]
    v_cvt_pk_bf16_f32 v201, v22, v23
    v_mul_f32 v192, v11, v144
    v_fma_f32 v28, v28, v128, -v192
    v_mul_f32 v193, v11, v145
    v_fma_f32 v29, v29, v129, -v193
    v_cvt_pk_bf16_f32 v202, v28, v29
    v_mul_f32 v194, v11, v146
    v_fma_f32 v30, v30, v130, -v194
    v_mul_f32 v195, v11, v147
    v_fma_f32 v31, v31, v131, -v195
    v_cvt_pk_bf16_f32 v203, v30, v31
    buffer_store_dwordx4 v[200:203], v13, s[8:11], s46 offen offset:512 sc1
    v_mul_f32 v180, v12, v132
    v_fma_f32 v32, v32, v116, -v180
    v_mul_f32 v181, v12, v133
    v_fma_f32 v33, v33, v117, -v181
    v_cvt_pk_bf16_f32 v196, v32, v33
    v_mul_f32 v182, v12, v134
    v_fma_f32 v34, v34, v118, -v182
    v_mul_f32 v183, v12, v135
    v_fma_f32 v35, v35, v119, -v183
    v_cvt_pk_bf16_f32 v197, v34, v35
    v_mul_f32 v188, v12, v140
    v_fma_f32 v40, v40, v124, -v188
    v_mul_f32 v189, v12, v141
    v_fma_f32 v41, v41, v125, -v189
    v_cvt_pk_bf16_f32 v198, v40, v41
    v_mul_f32 v190, v12, v142
    v_fma_f32 v42, v42, v126, -v190
    v_mul_f32 v191, v12, v143
    v_fma_f32 v43, v43, v127, -v191
    v_cvt_pk_bf16_f32 v199, v42, v43
    buffer_store_dwordx4 v[196:199], v13, s[8:11], s46 offen offset:2048 sc1
    v_mul_f32 v184, v12, v136
    v_fma_f32 v36, v36, v120, -v184
    v_mul_f32 v185, v12, v137
    v_fma_f32 v37, v37, v121, -v185
    v_cvt_pk_bf16_f32 v200, v36, v37
    v_mul_f32 v186, v12, v138
    v_fma_f32 v38, v38, v122, -v186
    v_mul_f32 v187, v12, v139
    v_fma_f32 v39, v39, v123, -v187
    v_cvt_pk_bf16_f32 v201, v38, v39
    v_mul_f32 v192, v12, v144
    v_fma_f32 v44, v44, v128, -v192
    v_mul_f32 v193, v12, v145
    v_fma_f32 v45, v45, v129, -v193
    v_cvt_pk_bf16_f32 v202, v44, v45
    v_mul_f32 v194, v12, v146
    v_fma_f32 v46, v46, v130, -v194
    v_mul_f32 v195, v12, v147
    v_fma_f32 v47, v47, v131, -v195
    v_cvt_pk_bf16_f32 v203, v46, v47
    buffer_store_dwordx4 v[200:203], v13, s[8:11], s46 offen offset:2560 sc1
    s_mul_i32 s43, s57, 22528
    s_add_u32 s43, s43, s49
    s_cmp_lg_u32 s62, 0
    s_cbranch_scc1 LpV_item
    buffer_load_dword v2, v1, s[8:11], s42 offen sc1
    s_waitcnt vmcnt(0)
    s_cmp_ge_u32 s37, 64
    s_cbranch_scc1 LpV_fin
    v_cmp_eq_u32 vcc, 0, v2
    s_nop 0
    s_cbranch_vccnz LpV_pub
    s_add_u32 m0, s59, 0
    s_add_u32 s47, s41, 0
    buffer_load_dwordx4 v0, s[8:11], s47 offen offset:0 lds
    buffer_load_dwordx4 v0, s[8:11], s47 offen offset:1024 lds
    buffer_load_dwordx4 v0, s[8:11], s47 offen offset:2048 lds
    buffer_load_dwordx4 v0, s[8:11], s47 offen offset:3072 lds
    s_add_u32 m0, s59, 4096
    s_add_u32 s47, s41, 4096
    buffer_load_dwordx4 v0, s[8:11], s47 offen offset:0 lds
    buffer_load_dwordx4 v0, s[8:11], s47 offen offset:1024 lds
    buffer_load_dwordx4 v0, s[8:11], s47 offen offset:2048 lds
    buffer_load_dwordx4 v0, s[8:11], s47 offen offset:3072 lds
    s_add_u32 m0, s59, 8192
    s_add_u32 s47, s41, 8192
    buffer_load_dwordx4 v0, s[8:11], s47 offen offset:0 lds
    s_mul_i32 s48, s36, 786432
    s_mul_i32 s18, s37, 6144
    s_add_u32 s48, s48, s18
    s_add_u32 s48, s48, 16125952
    s_add_u32 m0, s66, 4096
    s_nop 0
    buffer_load_dwordx4 v0, s[8:11], s48 offen lds
    s_add_u32 m0, s66, s67
    s_sub_u32 s48, s48, 4096
    s_add_u32 s48, s48, s67
    buffer_load_dwordx4 v0, s[8:11], s48 offen lds
    s_cmp_lg_u32 s43, 0
    s_cselect_b64 exec, 1, 0
    buffer_store_dwordx2 v[212:213], v4, s[8:11], s43 offen sc1
    s_mov_b64 exec, -1
    s_mov_b32 s43, 0
    s_waitcnt vmcnt(1)
    s_branch LpV_go
LpV_fin:
    s_cmp_lg_u32 s43, 0
    s_cselect_b64 exec, 1, 0
    buffer_store_dwordx2 v[212:213], v4, s[8:11], s43 offen sc1
    s_mov_b64 exec, -1
    s_mov_b32 s43, 0
    s_branch L_role_p_exit
LpV_pub:
    s_cmp_lg_u32 s43, 0
    s_cselect_b64 exec, 1, 0
    buffer_store_dwordx2 v[212:213], v4, s[8:11], s43 offen sc1
    s_mov_b64 exec, -1
    s_mov_b32 s43, 0
LpV_poll:
    s_mov_b32 s16, 0
LpV_pl:
    buffer_load_dword v2, v1, s[8:11], s42 offen sc1
    s_add_u32 s16, s16, 1
    s_cmp_gt_u32 s16, 100000
    s_cbranch_scc1 L_role_p_abort
    s_waitcnt vmcnt(0)
    v_cmp_eq_u32 vcc, 0, v2
    s_nop 0
    s_cbranch_vccz LpV_pld
    s_sleep 4
    s_branch LpV_pl
LpV_pld:
    s_add_u32 m0, s59, 0
    s_add_u32 s47, s41, 0
    buffer_load_dwordx4 v0, s[8:11], s47 offen offset:0 lds
    buffer_load_dwordx4 v0, s[8:11], s47 offen offset:1024 lds
    buffer_load_dwordx4 v0, s[8:11], s47 offen offset:2048 lds
    buffer_load_dwordx4 v0, s[8:11], s47 offen offset:3072 lds
    s_add_u32 m0, s59, 4096
    s_add_u32 s47, s41, 4096
    buffer_load_dwordx4 v0, s[8:11], s47 offen offset:0 lds
    buffer_load_dwordx4 v0, s[8:11], s47 offen offset:1024 lds
    buffer_load_dwordx4 v0, s[8:11], s47 offen offset:2048 lds
    buffer_load_dwordx4 v0, s[8:11], s47 offen offset:3072 lds
    s_add_u32 m0, s59, 8192
    s_add_u32 s47, s41, 8192
    buffer_load_dwordx4 v0, s[8:11], s47 offen offset:0 lds
    s_mul_i32 s48, s36, 786432
    s_mul_i32 s18, s37, 6144
    s_add_u32 s48, s48, s18
    s_add_u32 s48, s48, 16125952
    s_add_u32 m0, s66, 4096
    s_nop 0
    buffer_load_dwordx4 v0, s[8:11], s48 offen lds
    s_add_u32 m0, s66, s67
    s_sub_u32 s48, s48, 4096
    s_add_u32 s48, s48, s67
    buffer_load_dwordx4 v0, s[8:11], s48 offen lds
    s_waitcnt vmcnt(0)
    s_branch LpV_go
L_role_p_abort:
    s_waitcnt lgkmcnt(0)
    s_mov_b64 exec, -1
    v_mov_b32 v0, 60
    s_lshl_b32 s5, s3, 8
    s_or_b32 s5, s5, s4
    s_or_b32 s5, s5, 0x10000
    v_mov_b32 v1, s5
    global_store_dword v0, v1, s[12:13]
    s_endpgm
L_role_p_exit:
    s_endpgm
.p2align 6
L_role_awo:
    v_and_b32 v5, 63, v0
    v_lshlrev_b32 v0, 4, v5
    v_and_b32 v7, 15, v5
    v_lshrrev_b32 v8, 4, v5
    v_min_u32 v1, 63, v5
    v_lshrrev_b32 v6, 2, v1
    v_and_b32 v1, 3, v1
    v_lshlrev_b32 v1, 2, v1
    v_lshl_add_u32 v1, v6, 7, v1
    v_mov_b32 v3, 1
    v_mov_b32 v4, 0
    s_mov_b32 s44, 0x05040100
    s_mov_b32 s45, 0x07060302
    s_cmp_lt_u32 s15, 5
    s_cbranch_scc1 Lawo_noord
    s_cmp_lg_u32 s14, 0
    s_cbranch_scc1 Lawo_ord_d
    v_mov_b32 v5, 48
    s_mov_b32 s16, 0
Lawo_ord:
    global_load_dword v6, v5, s[12:13] sc1
    s_add_u32 s16, s16, 1
    s_cmp_gt_u32 s16, 100000
    s_cbranch_scc1 L_role_awo_abort
    s_waitcnt vmcnt(0)
    v_cmp_gt_u32 vcc, 1, v6
    s_nop 0
    s_cbranch_vccz Lawo_ord_d
    s_sleep 64
    s_branch Lawo_ord
Lawo_ord_d:
    s_barrier
Lawo_noord:
    s_load_dwordx2 s[20:21], s[0:1], 16
    s_mov_b32 s22, 663552
    s_mov_b32 s23, 0x00020000
    s_waitcnt lgkmcnt(0)
    s_and_b32 s21, s21, 0xffff
    s_cmp_ge_u32 s15, 5
    s_cselect_b32 s63, 1, 0
    s_cselect_b32 s17, 5, 0
    s_sub_u32 s15, s15, s17
    s_lshl_b32 s50, s15, 2
    s_add_u32 s50, s50, s14
    s_min_u32 s50, s50, 17
    s_lshl_b32 s49, s50, 6
    v_bfe_u32 v10, v0, 4, 5
    v_and_b32 v14, 19, v10
    v_bfe_u32 v5, v10, 2, 1
    v_lshl_add_u32 v14, v5, 3, v14
    v_bfe_u32 v5, v10, 3, 1
    v_lshl_add_u32 v14, v5, 2, v14
    v_and_b32 v5, 1, v14
    v_mov_b32 v11, s44
    v_mov_b32 v6, s45
    v_cmp_eq_u32 vcc, 1, v5
    s_nop 1
    v_cndmask_b32 v11, v11, v6, vcc
    v_and_b32 v14, 30, v14
    v_lshlrev_b32 v14, 1, v14
    v_lshrrev_b32 v9, 9, v0
    v_mul_u32_u24 v5, 9216, v9
    v_add_u32 v12, v5, v14
    v_add_u32 v13, 1152, v12
    s_add_u32 s17, s49, 0
    buffer_load_dword v16, v12, s[20:23], s17 offen
    buffer_load_dword v17, v13, s[20:23], s17 offen
    s_add_u32 s17, s49, 2304
    buffer_load_dword v18, v12, s[20:23], s17 offen
    buffer_load_dword v19, v13, s[20:23], s17 offen
    s_add_u32 s17, s49, 4608
    buffer_load_dword v20, v12, s[20:23], s17 offen
    buffer_load_dword v21, v13, s[20:23], s17 offen
    s_add_u32 s17, s49, 6912
    buffer_load_dword v22, v12, s[20:23], s17 offen
    buffer_load_dword v23, v13, s[20:23], s17 offen
    s_add_u32 s17, s49, 23040
    buffer_load_dword v24, v12, s[20:23], s17 offen
    buffer_load_dword v25, v13, s[20:23], s17 offen
    s_add_u32 s17, s49, 25344
    buffer_load_dword v26, v12, s[20:23], s17 offen
    buffer_load_dword v27, v13, s[20:23], s17 offen
    s_add_u32 s17, s49, 27648
    buffer_load_dword v28, v12, s[20:23], s17 offen
    buffer_load_dword v29, v13, s[20:23], s17 offen
    s_add_u32 s17, s49, 29952
    buffer_load_dword v30, v12, s[20:23], s17 offen
    buffer_load_dword v31, v13, s[20:23], s17 offen
    s_add_u32 s17, s49, 41472
    buffer_load_dword v32, v12, s[20:23], s17 offen
    buffer_load_dword v33, v13, s[20:23], s17 offen
    s_add_u32 s17, s49, 43776
    buffer_load_dword v34, v12, s[20:23], s17 offen
    buffer_load_dword v35, v13, s[20:23], s17 offen
    s_add_u32 s17, s49, 46080
    buffer_load_dword v36, v12, s[20:23], s17 offen
    buffer_load_dword v37, v13, s[20:23], s17 offen
    s_add_u32 s17, s49, 48384
    buffer_load_dword v38, v12, s[20:23], s17 offen
    buffer_load_dword v39, v13, s[20:23], s17 offen
    s_add_u32 s17, s49, 64512
    buffer_load_dword v40, v12, s[20:23], s17 offen
    buffer_load_dword v41, v13, s[20:23], s17 offen
    s_add_u32 s17, s49, 66816
    buffer_load_dword v42, v12, s[20:23], s17 offen
    buffer_load_dword v43, v13, s[20:23], s17 offen
    s_add_u32 s17, s49, 69120
    buffer_load_dword v44, v12, s[20:23], s17 offen
    buffer_load_dword v45, v13, s[20:23], s17 offen
    s_add_u32 s17, s49, 71424
    buffer_load_dword v46, v12, s[20:23], s17 offen
    buffer_load_dword v47, v13, s[20:23], s17 offen
    s_add_u32 s17, s49, 82944
    buffer_load_dword v48, v12, s[20:23], s17 offen
    buffer_load_dword v49, v13, s[20:23], s17 offen
    s_add_u32 s17, s49, 85248
    buffer_load_dword v50, v12, s[20:23], s17 offen
    buffer_load_dword v51, v13, s[20:23], s17 offen
    s_add_u32 s17, s49, 87552
    buffer_load_dword v52, v12, s[20:23], s17 offen
    buffer_load_dword v53, v13, s[20:23], s17 offen
    s_add_u32 s17, s49, 89856
    buffer_load_dword v54, v12, s[20:23], s17 offen
    buffer_load_dword v55, v13, s[20:23], s17 offen
    s_add_u32 s17, s49, 105984
    buffer_load_dword v56, v12, s[20:23], s17 offen
    buffer_load_dword v57, v13, s[20:23], s17 offen
    s_add_u32 s17, s49, 108288
    buffer_load_dword v58, v12, s[20:23], s17 offen
    buffer_load_dword v59, v13, s[20:23], s17 offen
    s_add_u32 s17, s49, 110592
    buffer_load_dword v60, v12, s[20:23], s17 offen
    buffer_load_dword v61, v13, s[20:23], s17 offen
    s_add_u32 s17, s49, 112896
    buffer_load_dword v62, v12, s[20:23], s17 offen
    buffer_load_dword v63, v13, s[20:23], s17 offen
    s_add_u32 s17, s49, 124416
    buffer_load_dword v64, v12, s[20:23], s17 offen
    buffer_load_dword v65, v13, s[20:23], s17 offen
    s_add_u32 s17, s49, 126720
    buffer_load_dword v66, v12, s[20:23], s17 offen
    buffer_load_dword v67, v13, s[20:23], s17 offen
    s_add_u32 s17, s49, 129024
    buffer_load_dword v68, v12, s[20:23], s17 offen
    buffer_load_dword v69, v13, s[20:23], s17 offen
    s_add_u32 s17, s49, 131328
    buffer_load_dword v70, v12, s[20:23], s17 offen
    buffer_load_dword v71, v13, s[20:23], s17 offen
    s_add_u32 s17, s49, 147456
    buffer_load_dword v72, v12, s[20:23], s17 offen
    buffer_load_dword v73, v13, s[20:23], s17 offen
    s_waitcnt vmcnt(56)
    v_perm_b32 v112, v17, v16, v11
    s_add_u32 s17, s49, 149760
    buffer_load_dword v74, v12, s[20:23], s17 offen
    buffer_load_dword v75, v13, s[20:23], s17 offen
    s_waitcnt vmcnt(56)
    v_perm_b32 v113, v19, v18, v11
    s_add_u32 s17, s49, 152064
    buffer_load_dword v76, v12, s[20:23], s17 offen
    buffer_load_dword v77, v13, s[20:23], s17 offen
    s_waitcnt vmcnt(56)
    v_perm_b32 v114, v21, v20, v11
    s_add_u32 s17, s49, 154368
    buffer_load_dword v78, v12, s[20:23], s17 offen
    buffer_load_dword v79, v13, s[20:23], s17 offen
    s_waitcnt vmcnt(56)
    v_perm_b32 v115, v23, v22, v11
    s_add_u32 s17, s49, 165888
    buffer_load_dword v80, v12, s[20:23], s17 offen
    buffer_load_dword v81, v13, s[20:23], s17 offen
    s_waitcnt vmcnt(56)
    v_perm_b32 v116, v25, v24, v11
    s_add_u32 s17, s49, 168192
    buffer_load_dword v82, v12, s[20:23], s17 offen
    buffer_load_dword v83, v13, s[20:23], s17 offen
    s_waitcnt vmcnt(56)
    v_perm_b32 v117, v27, v26, v11
    s_add_u32 s17, s49, 170496
    buffer_load_dword v84, v12, s[20:23], s17 offen
    buffer_load_dword v85, v13, s[20:23], s17 offen
    s_waitcnt vmcnt(56)
    v_perm_b32 v118, v29, v28, v11
    s_add_u32 s17, s49, 172800
    buffer_load_dword v86, v12, s[20:23], s17 offen
    buffer_load_dword v87, v13, s[20:23], s17 offen
    s_waitcnt vmcnt(56)
    v_perm_b32 v119, v31, v30, v11
    s_add_u32 s17, s49, 188928
    buffer_load_dword v88, v12, s[20:23], s17 offen
    buffer_load_dword v89, v13, s[20:23], s17 offen
    s_waitcnt vmcnt(56)
    v_perm_b32 v120, v33, v32, v11
    s_add_u32 s17, s49, 191232
    buffer_load_dword v90, v12, s[20:23], s17 offen
    buffer_load_dword v91, v13, s[20:23], s17 offen
    s_waitcnt vmcnt(56)
    v_perm_b32 v121, v35, v34, v11
    s_add_u32 s17, s49, 193536
    buffer_load_dword v92, v12, s[20:23], s17 offen
    buffer_load_dword v93, v13, s[20:23], s17 offen
    s_waitcnt vmcnt(56)
    v_perm_b32 v122, v37, v36, v11
    s_add_u32 s17, s49, 195840
    buffer_load_dword v94, v12, s[20:23], s17 offen
    buffer_load_dword v95, v13, s[20:23], s17 offen
    s_waitcnt vmcnt(56)
    v_perm_b32 v123, v39, v38, v11
    s_add_u32 s17, s49, 207360
    buffer_load_dword v96, v12, s[20:23], s17 offen
    buffer_load_dword v97, v13, s[20:23], s17 offen
    s_waitcnt vmcnt(56)
    v_perm_b32 v124, v41, v40, v11
    s_add_u32 s17, s49, 209664
    buffer_load_dword v98, v12, s[20:23], s17 offen
    buffer_load_dword v99, v13, s[20:23], s17 offen
    s_waitcnt vmcnt(56)
    v_perm_b32 v125, v43, v42, v11
    s_add_u32 s17, s49, 211968
    buffer_load_dword v100, v12, s[20:23], s17 offen
    buffer_load_dword v101, v13, s[20:23], s17 offen
    s_waitcnt vmcnt(56)
    v_perm_b32 v126, v45, v44, v11
    s_add_u32 s17, s49, 214272
    buffer_load_dword v102, v12, s[20:23], s17 offen
    buffer_load_dword v103, v13, s[20:23], s17 offen
    s_waitcnt vmcnt(56)
    v_perm_b32 v127, v47, v46, v11
    s_add_u32 s17, s49, 230400
    buffer_load_dword v104, v12, s[20:23], s17 offen
    buffer_load_dword v105, v13, s[20:23], s17 offen
    s_waitcnt vmcnt(56)
    v_perm_b32 v128, v49, v48, v11
    s_add_u32 s17, s49, 232704
    buffer_load_dword v106, v12, s[20:23], s17 offen
    buffer_load_dword v107, v13, s[20:23], s17 offen
    s_waitcnt vmcnt(56)
    v_perm_b32 v129, v51, v50, v11
    s_add_u32 s17, s49, 235008
    buffer_load_dword v108, v12, s[20:23], s17 offen
    buffer_load_dword v109, v13, s[20:23], s17 offen
    s_waitcnt vmcnt(56)
    v_perm_b32 v130, v53, v52, v11
    s_add_u32 s17, s49, 237312
    buffer_load_dword v110, v12, s[20:23], s17 offen
    buffer_load_dword v111, v13, s[20:23], s17 offen
    s_waitcnt vmcnt(56)
    v_perm_b32 v131, v55, v54, v11
    s_add_u32 s17, s49, 248832
    buffer_load_dword v16, v12, s[20:23], s17 offen
    buffer_load_dword v17, v13, s[20:23], s17 offen
    s_waitcnt vmcnt(56)
    v_perm_b32 v132, v57, v56, v11
    s_add_u32 s17, s49, 251136
    buffer_load_dword v18, v12, s[20:23], s17 offen
    buffer_load_dword v19, v13, s[20:23], s17 offen
    s_waitcnt vmcnt(56)
    v_perm_b32 v133, v59, v58, v11
    s_add_u32 s17, s49, 253440
    buffer_load_dword v20, v12, s[20:23], s17 offen
    buffer_load_dword v21, v13, s[20:23], s17 offen
    s_waitcnt vmcnt(56)
    v_perm_b32 v134, v61, v60, v11
    s_add_u32 s17, s49, 255744
    buffer_load_dword v22, v12, s[20:23], s17 offen
    buffer_load_dword v23, v13, s[20:23], s17 offen
    s_waitcnt vmcnt(56)
    v_perm_b32 v135, v63, v62, v11
    s_add_u32 s17, s49, 271872
    buffer_load_dword v24, v12, s[20:23], s17 offen
    buffer_load_dword v25, v13, s[20:23], s17 offen
    s_waitcnt vmcnt(56)
    v_perm_b32 v136, v65, v64, v11
    s_add_u32 s17, s49, 274176
    buffer_load_dword v26, v12, s[20:23], s17 offen
    buffer_load_dword v27, v13, s[20:23], s17 offen
    s_waitcnt vmcnt(56)
    v_perm_b32 v137, v67, v66, v11
    s_add_u32 s17, s49, 276480
    buffer_load_dword v28, v12, s[20:23], s17 offen
    buffer_load_dword v29, v13, s[20:23], s17 offen
    s_waitcnt vmcnt(56)
    v_perm_b32 v138, v69, v68, v11
    s_add_u32 s17, s49, 278784
    buffer_load_dword v30, v12, s[20:23], s17 offen
    buffer_load_dword v31, v13, s[20:23], s17 offen
    s_waitcnt vmcnt(56)
    v_perm_b32 v139, v71, v70, v11
    s_add_u32 s17, s49, 290304
    buffer_load_dword v32, v12, s[20:23], s17 offen
    buffer_load_dword v33, v13, s[20:23], s17 offen
    s_waitcnt vmcnt(56)
    v_perm_b32 v140, v73, v72, v11
    s_add_u32 s17, s49, 292608
    buffer_load_dword v34, v12, s[20:23], s17 offen
    buffer_load_dword v35, v13, s[20:23], s17 offen
    s_waitcnt vmcnt(56)
    v_perm_b32 v141, v75, v74, v11
    s_add_u32 s17, s49, 294912
    buffer_load_dword v36, v12, s[20:23], s17 offen
    buffer_load_dword v37, v13, s[20:23], s17 offen
    s_waitcnt vmcnt(56)
    v_perm_b32 v142, v77, v76, v11
    s_add_u32 s17, s49, 297216
    buffer_load_dword v38, v12, s[20:23], s17 offen
    buffer_load_dword v39, v13, s[20:23], s17 offen
    s_waitcnt vmcnt(56)
    v_perm_b32 v143, v79, v78, v11
    s_add_u32 s17, s49, 313344
    buffer_load_dword v40, v12, s[20:23], s17 offen
    buffer_load_dword v41, v13, s[20:23], s17 offen
    s_waitcnt vmcnt(56)
    v_perm_b32 v144, v81, v80, v11
    s_add_u32 s17, s49, 315648
    buffer_load_dword v42, v12, s[20:23], s17 offen
    buffer_load_dword v43, v13, s[20:23], s17 offen
    s_waitcnt vmcnt(56)
    v_perm_b32 v145, v83, v82, v11
    s_add_u32 s17, s49, 317952
    buffer_load_dword v44, v12, s[20:23], s17 offen
    buffer_load_dword v45, v13, s[20:23], s17 offen
    s_waitcnt vmcnt(56)
    v_perm_b32 v146, v85, v84, v11
    s_add_u32 s17, s49, 320256
    buffer_load_dword v46, v12, s[20:23], s17 offen
    buffer_load_dword v47, v13, s[20:23], s17 offen
    s_waitcnt vmcnt(56)
    v_perm_b32 v147, v87, v86, v11
    s_add_u32 s17, s49, 331776
    buffer_load_dword v48, v12, s[20:23], s17 offen
    buffer_load_dword v49, v13, s[20:23], s17 offen
    s_waitcnt vmcnt(56)
    v_perm_b32 v148, v89, v88, v11
    s_add_u32 s17, s49, 334080
    buffer_load_dword v50, v12, s[20:23], s17 offen
    buffer_load_dword v51, v13, s[20:23], s17 offen
    s_waitcnt vmcnt(56)
    v_perm_b32 v149, v91, v90, v11
    s_add_u32 s17, s49, 336384
    buffer_load_dword v52, v12, s[20:23], s17 offen
    buffer_load_dword v53, v13, s[20:23], s17 offen
    s_waitcnt vmcnt(56)
    v_perm_b32 v150, v93, v92, v11
    s_add_u32 s17, s49, 338688
    buffer_load_dword v54, v12, s[20:23], s17 offen
    buffer_load_dword v55, v13, s[20:23], s17 offen
    s_waitcnt vmcnt(56)
    v_perm_b32 v151, v95, v94, v11
    s_add_u32 s17, s49, 354816
    buffer_load_dword v56, v12, s[20:23], s17 offen
    buffer_load_dword v57, v13, s[20:23], s17 offen
    s_waitcnt vmcnt(56)
    v_perm_b32 v152, v97, v96, v11
    s_add_u32 s17, s49, 357120
    buffer_load_dword v58, v12, s[20:23], s17 offen
    buffer_load_dword v59, v13, s[20:23], s17 offen
    s_waitcnt vmcnt(56)
    v_perm_b32 v153, v99, v98, v11
    s_add_u32 s17, s49, 359424
    buffer_load_dword v60, v12, s[20:23], s17 offen
    buffer_load_dword v61, v13, s[20:23], s17 offen
    s_waitcnt vmcnt(56)
    v_perm_b32 v154, v101, v100, v11
    s_add_u32 s17, s49, 361728
    buffer_load_dword v62, v12, s[20:23], s17 offen
    buffer_load_dword v63, v13, s[20:23], s17 offen
    s_waitcnt vmcnt(56)
    v_perm_b32 v155, v103, v102, v11
    s_add_u32 s17, s49, 373248
    buffer_load_dword v64, v12, s[20:23], s17 offen
    buffer_load_dword v65, v13, s[20:23], s17 offen
    s_waitcnt vmcnt(56)
    v_perm_b32 v156, v105, v104, v11
    s_add_u32 s17, s49, 375552
    buffer_load_dword v66, v12, s[20:23], s17 offen
    buffer_load_dword v67, v13, s[20:23], s17 offen
    s_waitcnt vmcnt(56)
    v_perm_b32 v157, v107, v106, v11
    s_add_u32 s17, s49, 377856
    buffer_load_dword v68, v12, s[20:23], s17 offen
    buffer_load_dword v69, v13, s[20:23], s17 offen
    s_waitcnt vmcnt(56)
    v_perm_b32 v158, v109, v108, v11
    s_add_u32 s17, s49, 380160
    buffer_load_dword v70, v12, s[20:23], s17 offen
    buffer_load_dword v71, v13, s[20:23], s17 offen
    s_waitcnt vmcnt(56)
    v_perm_b32 v159, v111, v110, v11
    s_add_u32 s17, s49, 396288
    buffer_load_dword v72, v12, s[20:23], s17 offen
    buffer_load_dword v73, v13, s[20:23], s17 offen
    s_waitcnt vmcnt(56)
    v_perm_b32 v160, v17, v16, v11
    s_add_u32 s17, s49, 398592
    buffer_load_dword v74, v12, s[20:23], s17 offen
    buffer_load_dword v75, v13, s[20:23], s17 offen
    s_waitcnt vmcnt(56)
    v_perm_b32 v161, v19, v18, v11
    s_add_u32 s17, s49, 400896
    buffer_load_dword v76, v12, s[20:23], s17 offen
    buffer_load_dword v77, v13, s[20:23], s17 offen
    s_waitcnt vmcnt(56)
    v_perm_b32 v162, v21, v20, v11
    s_add_u32 s17, s49, 403200
    buffer_load_dword v78, v12, s[20:23], s17 offen
    buffer_load_dword v79, v13, s[20:23], s17 offen
    s_waitcnt vmcnt(56)
    v_perm_b32 v163, v23, v22, v11
    s_add_u32 s17, s49, 414720
    buffer_load_dword v80, v12, s[20:23], s17 offen
    buffer_load_dword v81, v13, s[20:23], s17 offen
    s_waitcnt vmcnt(56)
    v_perm_b32 v164, v25, v24, v11
    s_add_u32 s17, s49, 417024
    buffer_load_dword v82, v12, s[20:23], s17 offen
    buffer_load_dword v83, v13, s[20:23], s17 offen
    s_waitcnt vmcnt(56)
    v_perm_b32 v165, v27, v26, v11
    s_add_u32 s17, s49, 419328
    buffer_load_dword v84, v12, s[20:23], s17 offen
    buffer_load_dword v85, v13, s[20:23], s17 offen
    s_waitcnt vmcnt(56)
    v_perm_b32 v166, v29, v28, v11
    s_add_u32 s17, s49, 421632
    buffer_load_dword v86, v12, s[20:23], s17 offen
    buffer_load_dword v87, v13, s[20:23], s17 offen
    s_waitcnt vmcnt(56)
    v_perm_b32 v167, v31, v30, v11
    s_add_u32 s17, s49, 437760
    buffer_load_dword v88, v12, s[20:23], s17 offen
    buffer_load_dword v89, v13, s[20:23], s17 offen
    s_waitcnt vmcnt(56)
    v_perm_b32 v168, v33, v32, v11
    s_add_u32 s17, s49, 440064
    buffer_load_dword v90, v12, s[20:23], s17 offen
    buffer_load_dword v91, v13, s[20:23], s17 offen
    s_waitcnt vmcnt(56)
    v_perm_b32 v169, v35, v34, v11
    s_add_u32 s17, s49, 442368
    buffer_load_dword v92, v12, s[20:23], s17 offen
    buffer_load_dword v93, v13, s[20:23], s17 offen
    s_waitcnt vmcnt(56)
    v_perm_b32 v170, v37, v36, v11
    s_add_u32 s17, s49, 444672
    buffer_load_dword v94, v12, s[20:23], s17 offen
    buffer_load_dword v95, v13, s[20:23], s17 offen
    s_waitcnt vmcnt(56)
    v_perm_b32 v171, v39, v38, v11
    s_add_u32 s17, s49, 456192
    buffer_load_dword v96, v12, s[20:23], s17 offen
    buffer_load_dword v97, v13, s[20:23], s17 offen
    s_waitcnt vmcnt(56)
    v_perm_b32 v172, v41, v40, v11
    s_add_u32 s17, s49, 458496
    buffer_load_dword v98, v12, s[20:23], s17 offen
    buffer_load_dword v99, v13, s[20:23], s17 offen
    s_waitcnt vmcnt(56)
    v_perm_b32 v173, v43, v42, v11
    s_add_u32 s17, s49, 460800
    buffer_load_dword v100, v12, s[20:23], s17 offen
    buffer_load_dword v101, v13, s[20:23], s17 offen
    s_waitcnt vmcnt(56)
    v_perm_b32 v174, v45, v44, v11
    s_add_u32 s17, s49, 463104
    buffer_load_dword v102, v12, s[20:23], s17 offen
    buffer_load_dword v103, v13, s[20:23], s17 offen
    s_waitcnt vmcnt(56)
    v_perm_b32 v175, v47, v46, v11
    s_add_u32 s17, s49, 479232
    buffer_load_dword v104, v12, s[20:23], s17 offen
    buffer_load_dword v105, v13, s[20:23], s17 offen
    s_waitcnt vmcnt(56)
    v_perm_b32 v176, v49, v48, v11
    s_add_u32 s17, s49, 481536
    buffer_load_dword v106, v12, s[20:23], s17 offen
    buffer_load_dword v107, v13, s[20:23], s17 offen
    s_waitcnt vmcnt(56)
    v_perm_b32 v177, v51, v50, v11
    s_add_u32 s17, s49, 483840
    buffer_load_dword v108, v12, s[20:23], s17 offen
    buffer_load_dword v109, v13, s[20:23], s17 offen
    s_waitcnt vmcnt(56)
    v_perm_b32 v178, v53, v52, v11
    s_add_u32 s17, s49, 486144
    buffer_load_dword v110, v12, s[20:23], s17 offen
    buffer_load_dword v111, v13, s[20:23], s17 offen
    s_waitcnt vmcnt(56)
    v_perm_b32 v179, v55, v54, v11
    s_add_u32 s17, s49, 497664
    buffer_load_dword v16, v12, s[20:23], s17 offen
    buffer_load_dword v17, v13, s[20:23], s17 offen
    s_waitcnt vmcnt(56)
    v_perm_b32 v180, v57, v56, v11
    s_add_u32 s17, s49, 499968
    buffer_load_dword v18, v12, s[20:23], s17 offen
    buffer_load_dword v19, v13, s[20:23], s17 offen
    s_waitcnt vmcnt(56)
    v_perm_b32 v181, v59, v58, v11
    s_add_u32 s17, s49, 502272
    buffer_load_dword v20, v12, s[20:23], s17 offen
    buffer_load_dword v21, v13, s[20:23], s17 offen
    s_waitcnt vmcnt(56)
    v_perm_b32 v182, v61, v60, v11
    s_add_u32 s17, s49, 504576
    buffer_load_dword v22, v12, s[20:23], s17 offen
    buffer_load_dword v23, v13, s[20:23], s17 offen
    s_waitcnt vmcnt(56)
    v_perm_b32 v183, v63, v62, v11
    s_add_u32 s17, s49, 520704
    buffer_load_dword v24, v12, s[20:23], s17 offen
    buffer_load_dword v25, v13, s[20:23], s17 offen
    s_waitcnt vmcnt(56)
    v_perm_b32 v184, v65, v64, v11
    s_add_u32 s17, s49, 523008
    buffer_load_dword v26, v12, s[20:23], s17 offen
    buffer_load_dword v27, v13, s[20:23], s17 offen
    s_waitcnt vmcnt(56)
    v_perm_b32 v185, v67, v66, v11
    s_add_u32 s17, s49, 525312
    buffer_load_dword v28, v12, s[20:23], s17 offen
    buffer_load_dword v29, v13, s[20:23], s17 offen
    s_waitcnt vmcnt(56)
    v_perm_b32 v186, v69, v68, v11
    s_add_u32 s17, s49, 527616
    buffer_load_dword v30, v12, s[20:23], s17 offen
    buffer_load_dword v31, v13, s[20:23], s17 offen
    s_waitcnt vmcnt(56)
    v_perm_b32 v187, v71, v70, v11
    s_add_u32 s17, s49, 539136
    buffer_load_dword v32, v12, s[20:23], s17 offen
    buffer_load_dword v33, v13, s[20:23], s17 offen
    s_waitcnt vmcnt(56)
    v_perm_b32 v188, v73, v72, v11
    s_add_u32 s17, s49, 541440
    buffer_load_dword v34, v12, s[20:23], s17 offen
    buffer_load_dword v35, v13, s[20:23], s17 offen
    s_waitcnt vmcnt(56)
    v_perm_b32 v189, v75, v74, v11
    s_add_u32 s17, s49, 543744
    buffer_load_dword v36, v12, s[20:23], s17 offen
    buffer_load_dword v37, v13, s[20:23], s17 offen
    s_waitcnt vmcnt(56)
    v_perm_b32 v190, v77, v76, v11
    s_add_u32 s17, s49, 546048
    buffer_load_dword v38, v12, s[20:23], s17 offen
    buffer_load_dword v39, v13, s[20:23], s17 offen
    s_waitcnt vmcnt(56)
    v_perm_b32 v191, v79, v78, v11
    s_add_u32 s17, s49, 562176
    buffer_load_dword v40, v12, s[20:23], s17 offen
    buffer_load_dword v41, v13, s[20:23], s17 offen
    s_waitcnt vmcnt(56)
    v_perm_b32 v192, v81, v80, v11
    s_add_u32 s17, s49, 564480
    buffer_load_dword v42, v12, s[20:23], s17 offen
    buffer_load_dword v43, v13, s[20:23], s17 offen
    s_waitcnt vmcnt(56)
    v_perm_b32 v193, v83, v82, v11
    s_add_u32 s17, s49, 566784
    buffer_load_dword v44, v12, s[20:23], s17 offen
    buffer_load_dword v45, v13, s[20:23], s17 offen
    s_waitcnt vmcnt(56)
    v_perm_b32 v194, v85, v84, v11
    s_add_u32 s17, s49, 569088
    buffer_load_dword v46, v12, s[20:23], s17 offen
    buffer_load_dword v47, v13, s[20:23], s17 offen
    s_waitcnt vmcnt(56)
    v_perm_b32 v195, v87, v86, v11
    s_add_u32 s17, s49, 580608
    buffer_load_dword v48, v12, s[20:23], s17 offen
    buffer_load_dword v49, v13, s[20:23], s17 offen
    s_waitcnt vmcnt(56)
    v_perm_b32 v196, v89, v88, v11
    s_add_u32 s17, s49, 582912
    buffer_load_dword v50, v12, s[20:23], s17 offen
    buffer_load_dword v51, v13, s[20:23], s17 offen
    s_waitcnt vmcnt(56)
    v_perm_b32 v197, v91, v90, v11
    s_add_u32 s17, s49, 585216
    buffer_load_dword v52, v12, s[20:23], s17 offen
    buffer_load_dword v53, v13, s[20:23], s17 offen
    s_waitcnt vmcnt(56)
    v_perm_b32 v198, v93, v92, v11
    s_add_u32 s17, s49, 587520
    buffer_load_dword v54, v12, s[20:23], s17 offen
    buffer_load_dword v55, v13, s[20:23], s17 offen
    s_waitcnt vmcnt(56)
    v_perm_b32 v199, v95, v94, v11
    s_add_u32 s17, s49, 603648
    buffer_load_dword v56, v12, s[20:23], s17 offen
    buffer_load_dword v57, v13, s[20:23], s17 offen
    s_waitcnt vmcnt(56)
    v_perm_b32 v200, v97, v96, v11
    s_add_u32 s17, s49, 605952
    buffer_load_dword v58, v12, s[20:23], s17 offen
    buffer_load_dword v59, v13, s[20:23], s17 offen
    s_waitcnt vmcnt(56)
    v_perm_b32 v201, v99, v98, v11
    s_add_u32 s17, s49, 608256
    buffer_load_dword v60, v12, s[20:23], s17 offen
    buffer_load_dword v61, v13, s[20:23], s17 offen
    s_waitcnt vmcnt(56)
    v_perm_b32 v202, v101, v100, v11
    s_add_u32 s17, s49, 610560
    buffer_load_dword v62, v12, s[20:23], s17 offen
    buffer_load_dword v63, v13, s[20:23], s17 offen
    s_waitcnt vmcnt(56)
    v_perm_b32 v203, v103, v102, v11
    s_add_u32 s17, s49, 622080
    buffer_load_dword v64, v12, s[20:23], s17 offen
    buffer_load_dword v65, v13, s[20:23], s17 offen
    s_waitcnt vmcnt(56)
    v_perm_b32 v204, v105, v104, v11
    s_add_u32 s17, s49, 624384
    buffer_load_dword v66, v12, s[20:23], s17 offen
    buffer_load_dword v67, v13, s[20:23], s17 offen
    s_waitcnt vmcnt(56)
    v_perm_b32 v205, v107, v106, v11
    s_add_u32 s17, s49, 626688
    buffer_load_dword v68, v12, s[20:23], s17 offen
    buffer_load_dword v69, v13, s[20:23], s17 offen
    s_waitcnt vmcnt(56)
    v_perm_b32 v206, v109, v108, v11
    s_add_u32 s17, s49, 628992
    buffer_load_dword v70, v12, s[20:23], s17 offen
    buffer_load_dword v71, v13, s[20:23], s17 offen
    s_waitcnt vmcnt(56)
    v_perm_b32 v207, v111, v110, v11
    s_add_u32 s17, s49, 645120
    buffer_load_dword v72, v12, s[20:23], s17 offen
    buffer_load_dword v73, v13, s[20:23], s17 offen
    s_waitcnt vmcnt(56)
    v_perm_b32 v208, v17, v16, v11
    s_add_u32 s17, s49, 647424
    buffer_load_dword v74, v12, s[20:23], s17 offen
    buffer_load_dword v75, v13, s[20:23], s17 offen
    s_waitcnt vmcnt(56)
    v_perm_b32 v209, v19, v18, v11
    s_add_u32 s17, s49, 649728
    buffer_load_dword v76, v12, s[20:23], s17 offen
    buffer_load_dword v77, v13, s[20:23], s17 offen
    s_waitcnt vmcnt(56)
    v_perm_b32 v210, v21, v20, v11
    s_add_u32 s17, s49, 652032
    buffer_load_dword v78, v12, s[20:23], s17 offen
    buffer_load_dword v79, v13, s[20:23], s17 offen
    s_waitcnt vmcnt(56)
    v_perm_b32 v211, v23, v22, v11
    s_waitcnt vmcnt(54)
    v_perm_b32 v212, v25, v24, v11
    s_waitcnt vmcnt(52)
    v_perm_b32 v213, v27, v26, v11
    s_waitcnt vmcnt(50)
    v_perm_b32 v214, v29, v28, v11
    s_waitcnt vmcnt(48)
    v_perm_b32 v215, v31, v30, v11
    s_waitcnt vmcnt(46)
    v_perm_b32 v216, v33, v32, v11
    s_waitcnt vmcnt(44)
    v_perm_b32 v217, v35, v34, v11
    s_waitcnt vmcnt(42)
    v_perm_b32 v218, v37, v36, v11
    s_waitcnt vmcnt(40)
    v_perm_b32 v219, v39, v38, v11
    s_waitcnt vmcnt(38)
    v_perm_b32 v220, v41, v40, v11
    s_waitcnt vmcnt(36)
    v_perm_b32 v221, v43, v42, v11
    s_waitcnt vmcnt(34)
    v_perm_b32 v222, v45, v44, v11
    s_waitcnt vmcnt(32)
    v_perm_b32 v223, v47, v46, v11
    s_waitcnt vmcnt(30)
    v_perm_b32 v224, v49, v48, v11
    s_waitcnt vmcnt(28)
    v_perm_b32 v225, v51, v50, v11
    s_waitcnt vmcnt(26)
    v_perm_b32 v226, v53, v52, v11
    s_waitcnt vmcnt(24)
    v_perm_b32 v227, v55, v54, v11
    s_waitcnt vmcnt(22)
    v_perm_b32 v228, v57, v56, v11
    s_waitcnt vmcnt(20)
    v_perm_b32 v229, v59, v58, v11
    s_waitcnt vmcnt(18)
    v_perm_b32 v230, v61, v60, v11
    s_waitcnt vmcnt(16)
    v_perm_b32 v231, v63, v62, v11
    s_waitcnt vmcnt(14)
    v_perm_b32 v232, v65, v64, v11
    s_waitcnt vmcnt(12)
    v_perm_b32 v233, v67, v66, v11
    s_waitcnt vmcnt(10)
    v_perm_b32 v234, v69, v68, v11
    s_waitcnt vmcnt(8)
    v_perm_b32 v235, v71, v70, v11
    s_waitcnt vmcnt(6)
    v_perm_b32 v236, v73, v72, v11
    s_waitcnt vmcnt(4)
    v_perm_b32 v237, v75, v74, v11
    s_waitcnt vmcnt(2)
    v_perm_b32 v238, v77, v76, v11
    s_waitcnt vmcnt(0)
    v_perm_b32 v239, v79, v78, v11
    v_mul_u32_u24 v5, 82944, v9
    v_add_u32 v12, v5, v14
    v_add_u32 v13, 1152, v12
    s_add_u32 s17, s49, 18432
    buffer_load_dword v16, v12, s[20:23], s17 offen
    buffer_load_dword v17, v13, s[20:23], s17 offen
    s_add_u32 s17, s49, 20736
    buffer_load_dword v18, v12, s[20:23], s17 offen
    buffer_load_dword v19, v13, s[20:23], s17 offen
    s_add_u32 s17, s49, 59904
    buffer_load_dword v20, v12, s[20:23], s17 offen
    buffer_load_dword v21, v13, s[20:23], s17 offen
    s_add_u32 s17, s49, 62208
    buffer_load_dword v22, v12, s[20:23], s17 offen
    buffer_load_dword v23, v13, s[20:23], s17 offen
    s_add_u32 s17, s49, 184320
    buffer_load_dword v24, v12, s[20:23], s17 offen
    buffer_load_dword v25, v13, s[20:23], s17 offen
    s_add_u32 s17, s49, 186624
    buffer_load_dword v26, v12, s[20:23], s17 offen
    buffer_load_dword v27, v13, s[20:23], s17 offen
    s_add_u32 s17, s49, 225792
    buffer_load_dword v28, v12, s[20:23], s17 offen
    buffer_load_dword v29, v13, s[20:23], s17 offen
    s_add_u32 s17, s49, 228096
    buffer_load_dword v30, v12, s[20:23], s17 offen
    buffer_load_dword v31, v13, s[20:23], s17 offen
    s_add_u32 s17, s49, 350208
    buffer_load_dword v32, v12, s[20:23], s17 offen
    buffer_load_dword v33, v13, s[20:23], s17 offen
    s_add_u32 s17, s49, 352512
    buffer_load_dword v34, v12, s[20:23], s17 offen
    buffer_load_dword v35, v13, s[20:23], s17 offen
    s_add_u32 s17, s49, 391680
    buffer_load_dword v36, v12, s[20:23], s17 offen
    buffer_load_dword v37, v13, s[20:23], s17 offen
    s_add_u32 s17, s49, 393984
    buffer_load_dword v38, v12, s[20:23], s17 offen
    buffer_load_dword v39, v13, s[20:23], s17 offen
    s_add_u32 s17, s49, 516096
    buffer_load_dword v40, v12, s[20:23], s17 offen
    buffer_load_dword v41, v13, s[20:23], s17 offen
    s_add_u32 s17, s49, 518400
    buffer_load_dword v42, v12, s[20:23], s17 offen
    buffer_load_dword v43, v13, s[20:23], s17 offen
    s_add_u32 s17, s49, 557568
    buffer_load_dword v44, v12, s[20:23], s17 offen
    buffer_load_dword v45, v13, s[20:23], s17 offen
    s_add_u32 s17, s49, 559872
    buffer_load_dword v46, v12, s[20:23], s17 offen
    buffer_load_dword v47, v13, s[20:23], s17 offen
    s_waitcnt vmcnt(30)
    v_perm_b32 v240, v17, v16, v11
    s_waitcnt vmcnt(28)
    v_perm_b32 v241, v19, v18, v11
    s_waitcnt vmcnt(26)
    v_perm_b32 v242, v21, v20, v11
    s_waitcnt vmcnt(24)
    v_perm_b32 v243, v23, v22, v11
    s_waitcnt vmcnt(22)
    v_perm_b32 v244, v25, v24, v11
    s_waitcnt vmcnt(20)
    v_perm_b32 v245, v27, v26, v11
    s_waitcnt vmcnt(18)
    v_perm_b32 v246, v29, v28, v11
    s_waitcnt vmcnt(16)
    v_perm_b32 v247, v31, v30, v11
    s_waitcnt vmcnt(14)
    v_perm_b32 v248, v33, v32, v11
    s_waitcnt vmcnt(12)
    v_perm_b32 v249, v35, v34, v11
    s_waitcnt vmcnt(10)
    v_perm_b32 v250, v37, v36, v11
    s_waitcnt vmcnt(8)
    v_perm_b32 v251, v39, v38, v11
    s_waitcnt vmcnt(6)
    v_perm_b32 v252, v41, v40, v11
    s_waitcnt vmcnt(4)
    v_perm_b32 v253, v43, v42, v11
    s_waitcnt vmcnt(2)
    v_perm_b32 v254, v45, v44, v11
    s_waitcnt vmcnt(0)
    v_perm_b32 v255, v47, v46, v11
    v_lshlrev_b32 v10, 4, v10
    v_lshl_add_u32 v14, v9, 9, v10
    s_lshl_b32 s17, s50, 11
    v_add_u32 v14, s17, v14
    s_lshr_b32 s17, s50, 1
    s_lshl_b32 s17, s17, 9
    s_and_b32 s18, s50, 1
    s_lshl_b32 s18, s18, 3
    s_add_u32 s17, s17, s18
    v_add_u32 v10, s17, v10
    s_lshr_b32 s49, s50, 2
    s_lshl_b32 s49, s49, 7
    s_and_b32 s17, s50, 3
    s_lshl_b32 s17, s17, 2
    s_add_u32 s49, s49, s17
    s_add_u32 s49, s49, 183808
    s_mov_b32 s36, s63
    s_mov_b32 s34, s63
    s_mov_b32 s37, 0
    s_lshl_b32 s56, s63, 6
    s_mul_i32 s58, s14, 9216
    s_mov_b32 s40, 36864
    s_mov_b32 s59, s58
    s_mov_b32 s43, 0
    s_mov_b32 s28, s8
    s_mov_b32 s29, s9
    s_mov_b32 s30, 0
    s_mov_b32 s31, 0x00020000
    s_mul_i32 s41, s63, 2359296
    s_add_u32 s41, s41, s58
    s_add_u32 s41, s41, 17301504
    s_mul_i32 s42, s56, 22528
    s_add_u32 s42, s42, 181760
    s_cmp_lg_u32 s14, 0
    s_cbranch_scc1 Lawo_ini_d
    v_mov_b32 v5, 160
    s_mov_b32 s16, 0
Lawo_ini:
    global_load_dword v6, v5, s[12:13] sc1
    s_add_u32 s16, s16, 1
    s_cmp_gt_u32 s16, 100000
    s_cbranch_scc1 L_role_awo_abort
    s_waitcnt vmcnt(0)
    v_cmp_gt_u32 vcc, 123, v6
    s_nop 0
    s_cbranch_vccz Lawo_ini_d
    s_sleep 8
    s_branch Lawo_ini
Lawo_ini_d:
    s_barrier
    s_branch Lawo_poll
Lawo_item:
    s_waitcnt vmcnt(3)
Lawo_go:
    s_barrier
    s_xor_b32 s40, s40, 36864
    s_xor_b32 s59, s59, 36864
    s_xor_b32 s66, s66, 0x2000
    s_xor_b32 s71, s71, 0x2000
    s_mov_b32 s35, s37
    s_mov_b32 s57, s56
    s_add_u32 s37, s37, 1
    s_add_u32 s56, s56, 1
    s_add_u32 s41, s41, 36864
    s_add_u32 s42, s42, 22528
    s_mov_b32 s62, 0
    v_add_u32 v9, s40, v0
    ds_read_b128 v[32:35], v9 offset:0
    ds_read_b128 v[36:39], v9 offset:1024
    ds_read_b128 v[40:43], v9 offset:2048
    ds_read_b128 v[44:47], v9 offset:3072
    ds_read_b128 v[48:51], v9 offset:4096
    ds_read_b128 v[52:55], v9 offset:5120
    ds_read_b128 v[56:59], v9 offset:6144
    v_lshlrev_b32 v16, 16, v64
    v_and_b32 v17, 0xffff0000, v64
    v_lshlrev_b32 v18, 16, v65
    v_and_b32 v19, 0xffff0000, v65
    v_lshlrev_b32 v20, 16, v66
    v_and_b32 v21, 0xffff0000, v66
    v_lshlrev_b32 v22, 16, v67
    v_and_b32 v23, 0xffff0000, v67
    v_lshlrev_b32 v24, 16, v68
    v_and_b32 v25, 0xffff0000, v68
    v_lshlrev_b32 v26, 16, v69
    v_and_b32 v27, 0xffff0000, v69
    v_lshlrev_b32 v28, 16, v70
    v_and_b32 v29, 0xffff0000, v70
    v_lshlrev_b32 v30, 16, v71
    v_and_b32 v31, 0xffff0000, v71
    s_waitcnt lgkmcnt(6)
    s_nop 0
    v_mfma_f32_32x32x16_bf16 v[16:31], v[112:115], v[32:35], v[16:31]
    ds_read_b128 v[60:63], v9 offset:7168
    s_mul_i32 s46, s34, 4718592
    s_waitcnt lgkmcnt(6)
    v_mfma_f32_32x32x16_bf16 v[16:31], v[116:119], v[36:39], v[16:31]
    ds_read_b128 v[32:35], v9 offset:8192
    s_mul_i32 s51, s35, 36864
    s_waitcnt lgkmcnt(6)
    v_mfma_f32_32x32x16_bf16 v[16:31], v[120:123], v[40:43], v[16:31]
    ds_read_b128 v[36:39], v9 offset:9216
    s_add_u32 s46, s46, s51
    s_waitcnt lgkmcnt(6)
    v_mfma_f32_32x32x16_bf16 v[16:31], v[124:127], v[44:47], v[16:31]
    ds_read_b128 v[40:43], v9 offset:10240
    s_add_u32 s46, s46, 8650752
    s_waitcnt lgkmcnt(6)
    v_mfma_f32_32x32x16_bf16 v[16:31], v[128:131], v[48:51], v[16:31]
    ds_read_b128 v[44:47], v9 offset:11264
    s_mul_i32 s52, s34, 786432
    s_waitcnt lgkmcnt(6)
    v_mfma_f32_32x32x16_bf16 v[16:31], v[132:135], v[52:55], v[16:31]
    ds_read_b128 v[48:51], v9 offset:12288
    s_mul_i32 s51, s35, 6144
    s_waitcnt lgkmcnt(6)
    v_mfma_f32_32x32x16_bf16 v[16:31], v[136:139], v[56:59], v[16:31]
    ds_read_b128 v[52:55], v9 offset:13312
    s_add_u32 s52, s52, s51
    s_waitcnt lgkmcnt(6)
    v_mfma_f32_32x32x16_bf16 v[16:31], v[140:143], v[60:63], v[16:31]
    ds_read_b128 v[56:59], v9 offset:14336
    s_add_u32 s52, s52, 16121856
    s_waitcnt lgkmcnt(6)
    v_mfma_f32_32x32x16_bf16 v[16:31], v[144:147], v[32:35], v[16:31]
    ds_read_b128 v[60:63], v9 offset:15360
    s_waitcnt lgkmcnt(6)
    v_mfma_f32_32x32x16_bf16 v[16:31], v[148:151], v[36:39], v[16:31]
    ds_read_b128 v[32:35], v9 offset:16384
    s_waitcnt lgkmcnt(6)
    v_mfma_f32_32x32x16_bf16 v[16:31], v[152:155], v[40:43], v[16:31]
    ds_read_b128 v[36:39], v9 offset:17408
    s_waitcnt lgkmcnt(6)
    v_mfma_f32_32x32x16_bf16 v[16:31], v[156:159], v[44:47], v[16:31]
    ds_read_b128 v[40:43], v9 offset:18432
    s_waitcnt lgkmcnt(6)
    v_mfma_f32_32x32x16_bf16 v[16:31], v[160:163], v[48:51], v[16:31]
    ds_read_b128 v[44:47], v9 offset:19456
    s_waitcnt lgkmcnt(6)
    v_mfma_f32_32x32x16_bf16 v[16:31], v[164:167], v[52:55], v[16:31]
    ds_read_b128 v[48:51], v9 offset:20480
    s_waitcnt lgkmcnt(6)
    v_mfma_f32_32x32x16_bf16 v[16:31], v[168:171], v[56:59], v[16:31]
    ds_read_b128 v[52:55], v9 offset:21504
    s_waitcnt vmcnt(0)
    buffer_load_dword v2, v1, s[8:11], s42 offen sc1
    s_cmp_lg_u32 s43, 0
    s_cselect_b64 exec, 1, 0
    buffer_store_dword v3, v4, s[8:11], s43 offen sc1
    s_mov_b64 exec, -1
    s_mov_b32 s43, 0
    s_waitcnt lgkmcnt(6)
    v_mfma_f32_32x32x16_bf16 v[16:31], v[172:175], v[60:63], v[16:31]
    ds_read_b128 v[56:59], v9 offset:22528
    s_waitcnt lgkmcnt(6)
    v_mfma_f32_32x32x16_bf16 v[16:31], v[176:179], v[32:35], v[16:31]
    ds_read_b128 v[60:63], v9 offset:23552
    s_waitcnt lgkmcnt(6)
    v_mfma_f32_32x32x16_bf16 v[16:31], v[180:183], v[36:39], v[16:31]
    ds_read_b128 v[32:35], v9 offset:24576
    s_waitcnt lgkmcnt(6)
    v_mfma_f32_32x32x16_bf16 v[16:31], v[184:187], v[40:43], v[16:31]
    ds_read_b128 v[36:39], v9 offset:25600
    s_waitcnt lgkmcnt(6)
    v_mfma_f32_32x32x16_bf16 v[16:31], v[188:191], v[44:47], v[16:31]
    ds_read_b128 v[40:43], v9 offset:26624
    s_waitcnt lgkmcnt(6)
    v_mfma_f32_32x32x16_bf16 v[16:31], v[192:195], v[48:51], v[16:31]
    ds_read_b128 v[44:47], v9 offset:27648
    s_waitcnt lgkmcnt(6)
    v_mfma_f32_32x32x16_bf16 v[16:31], v[196:199], v[52:55], v[16:31]
    ds_read_b128 v[48:51], v9 offset:28672
    s_waitcnt lgkmcnt(6)
    v_mfma_f32_32x32x16_bf16 v[16:31], v[200:203], v[56:59], v[16:31]
    ds_read_b128 v[52:55], v9 offset:29696
    s_waitcnt lgkmcnt(6)
    v_mfma_f32_32x32x16_bf16 v[16:31], v[204:207], v[60:63], v[16:31]
    ds_read_b128 v[56:59], v9 offset:30720
    s_waitcnt lgkmcnt(6)
    v_mfma_f32_32x32x16_bf16 v[16:31], v[208:211], v[32:35], v[16:31]
    ds_read_b128 v[60:63], v9 offset:31744
    s_waitcnt lgkmcnt(6)
    v_mfma_f32_32x32x16_bf16 v[16:31], v[212:215], v[36:39], v[16:31]
    ds_read_b128 v[32:35], v9 offset:32768
    s_waitcnt lgkmcnt(6)
    v_mfma_f32_32x32x16_bf16 v[16:31], v[216:219], v[40:43], v[16:31]
    ds_read_b128 v[36:39], v9 offset:33792
    s_waitcnt lgkmcnt(6)
    v_mfma_f32_32x32x16_bf16 v[16:31], v[220:223], v[44:47], v[16:31]
    ds_read_b128 v[40:43], v9 offset:34816
    s_waitcnt lgkmcnt(6)
    v_mfma_f32_32x32x16_bf16 v[16:31], v[224:227], v[48:51], v[16:31]
    ds_read_b128 v[44:47], v9 offset:35840
    s_waitcnt lgkmcnt(6)
    v_mfma_f32_32x32x16_bf16 v[16:31], v[228:231], v[52:55], v[16:31]
    s_waitcnt lgkmcnt(5)
    v_mfma_f32_32x32x16_bf16 v[16:31], v[232:235], v[56:59], v[16:31]
    s_waitcnt lgkmcnt(4)
    v_mfma_f32_32x32x16_bf16 v[16:31], v[236:239], v[60:63], v[16:31]
    s_waitcnt lgkmcnt(3)
    v_mfma_f32_32x32x16_bf16 v[16:31], v[240:243], v[32:35], v[16:31]
    s_waitcnt vmcnt(1)
    v_cmp_eq_u32 vcc, 0, v2
    s_nop 0
    s_cmp_eq_u64 vcc, 0
    s_cselect_b32 s62, 1, 0
    s_cmp_lt_u32 s37, 64
    s_cselect_b32 s62, s62, 0
    s_cmp_lg_u32 s62, 0
    s_cselect_b32 s30, 268435456, 0
    s_waitcnt lgkmcnt(2)
    v_mfma_f32_32x32x16_bf16 v[16:31], v[244:247], v[36:39], v[16:31]
    s_add_u32 m0, s59, 0
    s_add_u32 s47, s41, 0
    buffer_load_dwordx4 v0, s[28:31], s47 offen offset:0 lds
    buffer_load_dwordx4 v0, s[28:31], s47 offen offset:1024 lds
    s_waitcnt lgkmcnt(1)
    v_mfma_f32_32x32x16_bf16 v[16:31], v[248:251], v[40:43], v[16:31]
    buffer_load_dwordx4 v0, s[28:31], s47 offen offset:2048 lds
    buffer_load_dwordx4 v0, s[28:31], s47 offen offset:3072 lds
    s_waitcnt lgkmcnt(0)
    v_mfma_f32_32x32x16_bf16 v[16:31], v[252:255], v[44:47], v[16:31]
    s_add_u32 m0, s59, 4096
    s_add_u32 s47, s41, 4096
    buffer_load_dwordx4 v0, s[28:31], s47 offen offset:0 lds
    buffer_load_dwordx4 v0, s[28:31], s47 offen offset:1024 lds
    buffer_load_dwordx4 v0, s[28:31], s47 offen offset:2048 lds
    buffer_load_dwordx4 v0, s[28:31], s47 offen offset:3072 lds
    s_add_u32 m0, s59, 8192
    s_add_u32 s47, s41, 8192
    buffer_load_dwordx4 v0, s[28:31], s47 offen offset:0 lds
    s_mul_i32 s48, s36, 4718592
    s_mul_i32 s18, s37, 36864
    s_add_u32 s48, s48, s18
    s_add_u32 s48, s48, 6291456
    buffer_load_dwordx4 v[64:67], v14, s[28:31], s48 offen offset:0
    buffer_load_dwordx4 v[68:71], v14, s[28:31], s48 offen offset:1024
    v_cvt_pk_bf16_f32 v32, v16, v17
    v_cvt_pk_bf16_f32 v33, v18, v19
    v_cvt_pk_bf16_f32 v34, v20, v21
    v_cvt_pk_bf16_f32 v35, v22, v23
    buffer_store_dwordx4 v[32:35], v14, s[8:11], s46 offen offset:0 sc1
    v_cvt_pk_bf16_f32 v36, v24, v25
    v_cvt_pk_bf16_f32 v37, v26, v27
    v_cvt_pk_bf16_f32 v38, v28, v29
    v_cvt_pk_bf16_f32 v39, v30, v31
    buffer_store_dwordx4 v[36:39], v14, s[8:11], s46 offen offset:1024 sc1
    v_add_f32 v72, v16, v17
    v_mul_f32 v73, v16, v16
    v_fmac_f32 v73, v17, v17
    v_add_f32 v72, v72, v18
    v_fmac_f32 v73, v18, v18
    v_add_f32 v72, v72, v19
    v_fmac_f32 v73, v19, v19
    v_add_f32 v72, v72, v20
    v_fmac_f32 v73, v20, v20
    v_add_f32 v72, v72, v21
    v_fmac_f32 v73, v21, v21
    v_add_f32 v72, v72, v22
    v_fmac_f32 v73, v22, v22
    v_add_f32 v72, v72, v23
    v_fmac_f32 v73, v23, v23
    v_add_f32 v72, v72, v24
    v_fmac_f32 v73, v24, v24
    v_add_f32 v72, v72, v25
    v_fmac_f32 v73, v25, v25
    v_add_f32 v72, v72, v26
    v_fmac_f32 v73, v26, v26
    v_add_f32 v72, v72, v27
    v_fmac_f32 v73, v27, v27
    v_add_f32 v72, v72, v28
    v_fmac_f32 v73, v28, v28
    v_add_f32 v72, v72, v29
    v_fmac_f32 v73, v29, v29
    v_add_f32 v72, v72, v30
    v_fmac_f32 v73, v30, v30
    v_add_f32 v72, v72, v31
    v_fmac_f32 v73, v31, v31
    v_mov_b32 v74, v72
    v_mov_b32 v75, v73
    s_nop 0
    v_permlane32_swap_b32 v72, v74
    v_permlane32_swap_b32 v73, v75
    v_add_f32 v72, v72, v74
    v_add_f32 v73, v73, v75
    buffer_store_dwordx2 v[72:73], v10, s[8:11], s52 offen sc1
    s_mul_i32 s43, s57, 22528
    s_add_u32 s43, s43, s49
    s_cmp_lg_u32 s62, 0
    s_cbranch_scc1 Lawo_item
    buffer_load_dword v2, v1, s[8:11], s42 offen sc1
    s_waitcnt vmcnt(0)
    s_cmp_ge_u32 s37, 64
    s_cbranch_scc1 Lawo_fin
    v_cmp_eq_u32 vcc, 0, v2
    s_nop 0
    s_cbranch_vccnz Lawo_pub
    s_add_u32 m0, s59, 0
    s_add_u32 s47, s41, 0
    buffer_load_dwordx4 v0, s[8:11], s47 offen offset:0 lds
    buffer_load_dwordx4 v0, s[8:11], s47 offen offset:1024 lds
    buffer_load_dwordx4 v0, s[8:11], s47 offen offset:2048 lds
    buffer_load_dwordx4 v0, s[8:11], s47 offen offset:3072 lds
    s_add_u32 m0, s59, 4096
    s_add_u32 s47, s41, 4096
    buffer_load_dwordx4 v0, s[8:11], s47 offen offset:0 lds
    buffer_load_dwordx4 v0, s[8:11], s47 offen offset:1024 lds
    buffer_load_dwordx4 v0, s[8:11], s47 offen offset:2048 lds
    buffer_load_dwordx4 v0, s[8:11], s47 offen offset:3072 lds
    s_add_u32 m0, s59, 8192
    s_add_u32 s47, s41, 8192
    buffer_load_dwordx4 v0, s[8:11], s47 offen offset:0 lds
    s_mul_i32 s48, s36, 4718592
    s_mul_i32 s18, s37, 36864
    s_add_u32 s48, s48, s18
    s_add_u32 s48, s48, 6291456
    buffer_load_dwordx4 v[64:67], v14, s[8:11], s48 offen offset:0
    buffer_load_dwordx4 v[68:71], v14, s[8:11], s48 offen offset:1024
    s_cmp_lg_u32 s43, 0
    s_cselect_b64 exec, 1, 0
    buffer_store_dword v3, v4, s[8:11], s43 offen sc1
    s_mov_b64 exec, -1
    s_mov_b32 s43, 0
    s_waitcnt vmcnt(1)
    s_branch Lawo_go
Lawo_fin:
    s_cmp_lg_u32 s43, 0
    s_cselect_b64 exec, 1, 0
    buffer_store_dword v3, v4, s[8:11], s43 offen sc1
    s_mov_b64 exec, -1
    s_mov_b32 s43, 0
    s_branch L_role_awo_exit
Lawo_pub:
    s_cmp_lg_u32 s43, 0
    s_cselect_b64 exec, 1, 0
    buffer_store_dword v3, v4, s[8:11], s43 offen sc1
    s_mov_b64 exec, -1
    s_mov_b32 s43, 0
Lawo_poll:
    s_mov_b32 s16, 0
Lawo_pl:
    buffer_load_dword v2, v1, s[8:11], s42 offen sc1
    s_add_u32 s16, s16, 1
    s_cmp_gt_u32 s16, 100000
    s_cbranch_scc1 L_role_awo_abort
    s_waitcnt vmcnt(0)
    v_cmp_eq_u32 vcc, 0, v2
    s_nop 0
    s_cbranch_vccz Lawo_pld
    s_sleep 2
    s_branch Lawo_pl
Lawo_pld:
    s_add_u32 m0, s59, 0
    s_add_u32 s47, s41, 0
    buffer_load_dwordx4 v0, s[8:11], s47 offen offset:0 lds
    buffer_load_dwordx4 v0, s[8:11], s47 offen offset:1024 lds
    buffer_load_dwordx4 v0, s[8:11], s47 offen offset:2048 lds
    buffer_load_dwordx4 v0, s[8:11], s47 offen offset:3072 lds
    s_add_u32 m0, s59, 4096
    s_add_u32 s47, s41, 4096
    buffer_load_dwordx4 v0, s[8:11], s47 offen offset:0 lds
    buffer_load_dwordx4 v0, s[8:11], s47 offen offset:1024 lds
    buffer_load_dwordx4 v0, s[8:11], s47 offen offset:2048 lds
    buffer_load_dwordx4 v0, s[8:11], s47 offen offset:3072 lds
    s_add_u32 m0, s59, 8192
    s_add_u32 s47, s41, 8192
    buffer_load_dwordx4 v0, s[8:11], s47 offen offset:0 lds
    s_mul_i32 s48, s36, 4718592
    s_mul_i32 s18, s37, 36864
    s_add_u32 s48, s48, s18
    s_add_u32 s48, s48, 6291456
    buffer_load_dwordx4 v[64:67], v14, s[8:11], s48 offen offset:0
    buffer_load_dwordx4 v[68:71], v14, s[8:11], s48 offen offset:1024
    s_waitcnt vmcnt(0)
    s_branch Lawo_go
L_role_awo_abort:
    s_waitcnt lgkmcnt(0)
    s_mov_b64 exec, -1
    v_mov_b32 v0, 60
    s_lshl_b32 s5, s3, 8
    s_or_b32 s5, s5, s4
    s_or_b32 s5, s5, 0x10000
    v_mov_b32 v1, s5
    global_store_dword v0, v1, s[12:13]
    s_endpgm
L_role_awo_exit:
    s_endpgm
.p2align 6
L_role_aq:
    v_and_b32 v5, 63, v0
    v_lshlrev_b32 v0, 4, v5
    v_and_b32 v7, 15, v5
    v_lshrrev_b32 v8, 4, v5
    v_min_u32 v1, 47, v5
    v_lshrrev_b32 v6, 2, v1
    v_and_b32 v1, 3, v1
    v_lshlrev_b32 v1, 2, v1
    v_lshl_add_u32 v1, v6, 7, v1
    v_mov_b32 v3, 1
    v_mov_b32 v4, 0
    s_mov_b32 s44, 0x05040100
    s_mov_b32 s45, 0x07060302
    s_lshr_b32 s63, s15, 4
    s_and_b32 s15, s15, 15
    s_lshl_b32 s50, s15, 1
    s_lshr_b32 s17, s14, 1
    s_add_u32 s50, s50, s17
    s_and_b32 s51, s14, 1
    s_mul_i32 s49, s50, 36
    s_cmp_eq_u32 s63, 0
    s_cbranch_scc1 Laq_noord
    s_cmp_lg_u32 s14, 0
    s_cbranch_scc1 Laq_ord_d
    v_mov_b32 v5, 48
    s_mov_b32 s16, 0
Laq_ord:
    global_load_dword v6, v5, s[12:13] sc1
    s_add_u32 s16, s16, 1
    s_cmp_gt_u32 s16, 100000
    s_cbranch_scc1 L_role_aq_abort
    s_waitcnt vmcnt(0)
    v_cmp_gt_u32 vcc, 1, v6
    s_nop 0
    s_cbranch_vccz Laq_ord_d
    s_sleep 64
    s_branch Laq_ord
Laq_ord_d:
    s_barrier
Laq_noord:
    s_load_dwordx2 s[20:21], s[0:1], 8
    s_mov_b32 s22, 1990656
    s_mov_b32 s23, 0x00020000
    s_waitcnt lgkmcnt(0)
    s_and_b32 s21, s21, 0xffff
    v_lshrrev_b32 v24, 4, v0
    v_add_u32 v24, 0, v24
    v_mul_u32_u24 v25, 4370, v24
    v_lshrrev_b32 v25, 16, v25
    v_mul_u32_u24 v26, 15, v25
    v_sub_u32 v24, v24, v26
    v_mul_u32_u24 v16, 3456, v25
    v_mul_u32_u24 v25, 13108, v24
    v_lshrrev_b32 v25, 16, v25
    v_mul_u32_u24 v26, 5, v25
    v_sub_u32 v24, v24, v26
    v_mul_u32_u24 v25, 1152, v25
    v_lshlrev_b32 v24, 4, v24
    v_add3_u32 v16, v16, v24, v25
    v_lshrrev_b32 v24, 4, v0
    v_add_u32 v24, 64, v24
    v_mul_u32_u24 v25, 4370, v24
    v_lshrrev_b32 v25, 16, v25
    v_mul_u32_u24 v26, 15, v25
    v_sub_u32 v24, v24, v26
    v_mul_u32_u24 v17, 3456, v25
    v_mul_u32_u24 v25, 13108, v24
    v_lshrrev_b32 v25, 16, v25
    v_mul_u32_u24 v26, 5, v25
    v_sub_u32 v24, v24, v26
    v_mul_u32_u24 v25, 1152, v25
    v_lshlrev_b32 v24, 4, v24
    v_add3_u32 v17, v17, v24, v25
    s_mul_i32 s49, s15, 72
    s_and_b32 s48, s49, 15
    s_and_b32 s49, s49, -16
    s_mul_i32 s17, s14, 27648
    s_add_u32 s49, s49, s17
    s_mul_i32 s46, s14, 1920
    s_mov_b32 s54, -1
    s_mov_b32 s55, 0x00ffffff
    s_add_u32 s17, s49, 0
    s_add_u32 m0, s46, 0
    s_nop 0
    buffer_load_dwordx4 v16, s[20:23], s17 offen lds
    s_add_u32 m0, s46, 1024
    s_mov_b64 exec, s[54:55]
    buffer_load_dwordx4 v17, s[20:23], s17 offen lds
    s_mov_b64 exec, -1
    s_add_u32 s17, s49, 110592
    s_add_u32 m0, s46, 7680
    s_nop 0
    buffer_load_dwordx4 v16, s[20:23], s17 offen lds
    s_add_u32 m0, s46, 8704
    s_mov_b64 exec, s[54:55]
    buffer_load_dwordx4 v17, s[20:23], s17 offen lds
    s_mov_b64 exec, -1
    s_add_u32 s17, s49, 221184
    s_add_u32 m0, s46, 15360
    s_nop 0
    buffer_load_dwordx4 v16, s[20:23], s17 offen lds
    s_add_u32 m0, s46, 16384
    s_mov_b64 exec, s[54:55]
    buffer_load_dwordx4 v17, s[20:23], s17 offen lds
    s_mov_b64 exec, -1
    s_add_u32 s17, s49, 331776
    s_add_u32 m0, s46, 23040
    s_nop 0
    buffer_load_dwordx4 v16, s[20:23], s17 offen lds
    s_add_u32 m0, s46, 24064
    s_mov_b64 exec, s[54:55]
    buffer_load_dwordx4 v17, s[20:23], s17 offen lds
    s_mov_b64 exec, -1
    s_add_u32 s17, s49, 442368
    s_add_u32 m0, s46, 30720
    s_nop 0
    buffer_load_dwordx4 v16, s[20:23], s17 offen lds
    s_add_u32 m0, s46, 31744
    s_mov_b64 exec, s[54:55]
    buffer_load_dwordx4 v17, s[20:23], s17 offen lds
    s_mov_b64 exec, -1
    s_add_u32 s17, s49, 552960
    s_add_u32 m0, s46, 38400
    s_nop 0
    buffer_load_dwordx4 v16, s[20:23], s17 offen lds
    s_add_u32 m0, s46, 39424
    s_mov_b64 exec, s[54:55]
    buffer_load_dwordx4 v17, s[20:23], s17 offen lds
    s_mov_b64 exec, -1
    s_add_u32 s17, s49, 663552
    s_add_u32 m0, s46, 46080
    s_nop 0
    buffer_load_dwordx4 v16, s[20:23], s17 offen lds
    s_add_u32 m0, s46, 47104
    s_mov_b64 exec, s[54:55]
    buffer_load_dwordx4 v17, s[20:23], s17 offen lds
    s_mov_b64 exec, -1
    s_add_u32 s17, s49, 774144
    s_add_u32 m0, s46, 53760
    s_nop 0
    buffer_load_dwordx4 v16, s[20:23], s17 offen lds
    s_add_u32 m0, s46, 54784
    s_mov_b64 exec, s[54:55]
    buffer_load_dwordx4 v17, s[20:23], s17 offen lds
    s_mov_b64 exec, -1
    s_add_u32 s17, s49, 884736
    s_add_u32 m0, s46, 61440
    s_nop 0
    buffer_load_dwordx4 v16, s[20:23], s17 offen lds
    s_add_u32 m0, s46, 62464
    s_mov_b64 exec, s[54:55]
    buffer_load_dwordx4 v17, s[20:23], s17 offen lds
    s_mov_b64 exec, -1
    s_add_u32 s17, s49, 995328
    s_add_u32 m0, s46, 69120
    s_nop 0
    buffer_load_dwordx4 v16, s[20:23], s17 offen lds
    s_add_u32 m0, s46, 70144
    s_mov_b64 exec, s[54:55]
    buffer_load_dwordx4 v17, s[20:23], s17 offen lds
    s_mov_b64 exec, -1
    s_add_u32 s17, s49, 1105920
    s_add_u32 m0, s46, 76800
    s_nop 0
    buffer_load_dwordx4 v16, s[20:23], s17 offen lds
    s_add_u32 m0, s46, 77824
    s_mov_b64 exec, s[54:55]
    buffer_load_dwordx4 v17, s[20:23], s17 offen lds
    s_mov_b64 exec, -1
    s_add_u32 s17, s49, 1216512
    s_add_u32 m0, s46, 84480
    s_nop 0
    buffer_load_dwordx4 v16, s[20:23], s17 offen lds
    s_add_u32 m0, s46, 85504
    s_mov_b64 exec, s[54:55]
    buffer_load_dwordx4 v17, s[20:23], s17 offen lds
    s_mov_b64 exec, -1
    s_lshr_b32 s47, s14, 1
    s_mul_i32 s17, s47, 40
    s_add_u32 s17, s17, s48
    s_mul_i32 s18, s47, 4
    s_add_u32 s18, s18, s48
    s_add_u32 s18, s18, 32
    s_lshl_b32 s19, s47, 4
    s_add_u32 s19, s19, 138240
    v_lshrrev_b32 v5, 2, v7
    v_lshl_add_u32 v5, v8, 3, v5
    v_and_b32 v6, 3, v7
    v_mul_u32_u24 v19, 240, v5
    v_add_u32 v19, s17, v19
    v_lshl_add_u32 v19, v6, 3, v19
    v_lshlrev_b32 v20, 5, v5
    v_add_u32 v20, s19, v20
    v_mov_b32 v22, 156672
    v_cmp_eq_u32 vcc, 0, v6
    s_nop 1
    v_cndmask_b32 v20, v22, v20, vcc
    v_cndmask_b32 v21, 0, -1, vcc
    v_bfe_u32 v5, v0, 4, 5
    v_mul_u32_u24 v23, 240, v5
    v_add_u32 v23, s18, v23
    v_lshlrev_b32 v28, 5, v5
    v_add_u32 v28, s19, v28
    v_mov_b32 v24, 0
    v_mov_b32 v25, 0
    v_mov_b32 v26, 0
    v_mov_b32 v27, 0
    v_lshlrev_b32 v22, 4, v7
    v_add_u32 v22, 156672, v22
    ds_write_b128 v22, v[24:27]
    v_mov_b32 v104, 0x3f803f80
    v_mov_b32 v105, 0x3f803f80
    v_mov_b32 v106, 0x3f803f80
    v_mov_b32 v107, 0x3f803f80
    s_waitcnt vmcnt(12) lgkmcnt(0)
    s_barrier
    v_add_u32 v60, 0, v23
    v_mov_b32 v59, 0
    ds_read_b32 v56, v60
    ds_read_b32 v57, v60 offset:80
    ds_read_b32 v58, v60 offset:160
    v_add_u32 v68, 7680, v23
    v_mov_b32 v67, 0
    ds_read_b32 v64, v68
    ds_read_b32 v65, v68 offset:80
    ds_read_b32 v66, v68 offset:160
    v_add_u32 v76, 15360, v23
    v_mov_b32 v75, 0
    ds_read_b32 v72, v76
    ds_read_b32 v73, v76 offset:80
    ds_read_b32 v74, v76 offset:160
    v_add_u32 v84, 23040, v23
    v_mov_b32 v83, 0
    ds_read_b32 v80, v84
    ds_read_b32 v81, v84 offset:80
    ds_read_b32 v82, v84 offset:160
    v_add_u32 v92, 30720, v23
    v_mov_b32 v91, 0
    ds_read_b32 v88, v92
    ds_read_b32 v89, v92 offset:80
    ds_read_b32 v90, v92 offset:160
    v_add_u32 v100, 38400, v23
    v_mov_b32 v99, 0
    ds_read_b32 v96, v100
    ds_read_b32 v97, v100 offset:80
    ds_read_b32 v98, v100 offset:160
    v_add_u32 v61, 0, v19
    ds_read_b64_tr_b16 v[152:153], v61 offset:0
    ds_read_b64_tr_b16 v[224:225], v61 offset:80
    ds_read_b64_tr_b16 a[112:113], v61 offset:160
    ds_read_b64_tr_b16 v[154:155], v61 offset:960
    ds_read_b64_tr_b16 v[226:227], v61 offset:1040
    ds_read_b64_tr_b16 a[114:115], v61 offset:1120
    v_add_u32 v69, 7680, v19
    ds_read_b64_tr_b16 v[156:157], v69 offset:0
    ds_read_b64_tr_b16 v[228:229], v69 offset:80
    ds_read_b64_tr_b16 a[116:117], v69 offset:160
    ds_read_b64_tr_b16 v[158:159], v69 offset:960
    ds_read_b64_tr_b16 v[230:231], v69 offset:1040
    ds_read_b64_tr_b16 a[118:119], v69 offset:1120
    v_add_u32 v77, 15360, v19
    ds_read_b64_tr_b16 v[160:161], v77 offset:0
    ds_read_b64_tr_b16 v[232:233], v77 offset:80
    ds_read_b64_tr_b16 a[120:121], v77 offset:160
    ds_read_b64_tr_b16 v[162:163], v77 offset:960
    ds_read_b64_tr_b16 v[234:235], v77 offset:1040
    ds_read_b64_tr_b16 a[122:123], v77 offset:1120
    v_add_u32 v85, 23040, v19
    ds_read_b64_tr_b16 v[164:165], v85 offset:0
    ds_read_b64_tr_b16 v[236:237], v85 offset:80
    ds_read_b64_tr_b16 a[124:125], v85 offset:160
    ds_read_b64_tr_b16 v[166:167], v85 offset:960
    ds_read_b64_tr_b16 v[238:239], v85 offset:1040
    ds_read_b64_tr_b16 a[126:127], v85 offset:1120
    v_add_u32 v93, 30720, v19
    ds_read_b64_tr_b16 v[168:169], v93 offset:0
    ds_read_b64_tr_b16 v[240:241], v93 offset:80
    ds_read_b64_tr_b16 a[128:129], v93 offset:160
    ds_read_b64_tr_b16 v[170:171], v93 offset:960
    ds_read_b64_tr_b16 v[242:243], v93 offset:1040
    ds_read_b64_tr_b16 a[130:131], v93 offset:1120
    v_add_u32 v101, 38400, v19
    ds_read_b64_tr_b16 v[172:173], v101 offset:0
    ds_read_b64_tr_b16 v[244:245], v101 offset:80
    ds_read_b64_tr_b16 a[132:133], v101 offset:160
    ds_read_b64_tr_b16 v[174:175], v101 offset:960
    ds_read_b64_tr_b16 v[246:247], v101 offset:1040
    ds_read_b64_tr_b16 a[134:135], v101 offset:1120
    s_waitcnt lgkmcnt(15)
    ds_write_b64 v28, v[56:57] offset:0
    ds_write_b64 v28, v[58:59] offset:8
    ds_write_b64 v28, v[64:65] offset:1024
    ds_write_b64 v28, v[66:67] offset:1032
    ds_write_b64 v28, v[72:73] offset:2048
    ds_write_b64 v28, v[74:75] offset:2056
    ds_write_b64 v28, v[80:81] offset:3072
    ds_write_b64 v28, v[82:83] offset:3080
    ds_write_b64 v28, v[88:89] offset:4096
    ds_write_b64 v28, v[90:91] offset:4104
    ds_write_b64 v28, v[96:97] offset:5120
    ds_write_b64 v28, v[98:99] offset:5128
    s_waitcnt lgkmcnt(0)
    v_and_b32 v56, 0, v21
    v_add_u32 v56, v56, v20
    ds_read_b64_tr_b16 a[40:41], v56 offset:0
    ds_read_b64_tr_b16 a[42:43], v56 offset:128
    v_and_b32 v57, 8, v21
    v_add_u32 v57, v57, v20
    ds_read_b64_tr_b16 a[184:185], v57 offset:0
    ds_read_b64_tr_b16 a[186:187], v57 offset:128
    v_and_b32 v64, 1024, v21
    v_add_u32 v64, v64, v20
    ds_read_b64_tr_b16 a[44:45], v64 offset:0
    ds_read_b64_tr_b16 a[46:47], v64 offset:128
    v_and_b32 v65, 1032, v21
    v_add_u32 v65, v65, v20
    ds_read_b64_tr_b16 a[188:189], v65 offset:0
    ds_read_b64_tr_b16 a[190:191], v65 offset:128
    v_and_b32 v72, 2048, v21
    v_add_u32 v72, v72, v20
    ds_read_b64_tr_b16 a[48:49], v72 offset:0
    ds_read_b64_tr_b16 a[50:51], v72 offset:128
    v_and_b32 v73, 2056, v21
    v_add_u32 v73, v73, v20
    ds_read_b64_tr_b16 a[192:193], v73 offset:0
    ds_read_b64_tr_b16 a[194:195], v73 offset:128
    v_and_b32 v80, 3072, v21
    v_add_u32 v80, v80, v20
    ds_read_b64_tr_b16 a[52:53], v80 offset:0
    ds_read_b64_tr_b16 a[54:55], v80 offset:128
    v_and_b32 v81, 3080, v21
    v_add_u32 v81, v81, v20
    ds_read_b64_tr_b16 a[196:197], v81 offset:0
    ds_read_b64_tr_b16 a[198:199], v81 offset:128
    v_and_b32 v88, 4096, v21
    v_add_u32 v88, v88, v20
    ds_read_b64_tr_b16 a[56:57], v88 offset:0
    ds_read_b64_tr_b16 a[58:59], v88 offset:128
    v_and_b32 v89, 4104, v21
    v_add_u32 v89, v89, v20
    ds_read_b64_tr_b16 a[200:201], v89 offset:0
    ds_read_b64_tr_b16 a[202:203], v89 offset:128
    v_and_b32 v96, 5120, v21
    v_add_u32 v96, v96, v20
    ds_read_b64_tr_b16 a[60:61], v96 offset:0
    ds_read_b64_tr_b16 a[62:63], v96 offset:128
    v_and_b32 v97, 5128, v21
    v_add_u32 v97, v97, v20
    ds_read_b64_tr_b16 a[204:205], v97 offset:0
    ds_read_b64_tr_b16 a[206:207], v97 offset:128
    s_waitcnt lgkmcnt(0)
    s_add_u32 s17, s49, 1327104
    s_add_u32 m0, s46, 92160
    s_nop 0
    buffer_load_dwordx4 v16, s[20:23], s17 offen lds
    s_add_u32 m0, s46, 93184
    s_mov_b64 exec, s[54:55]
    buffer_load_dwordx4 v17, s[20:23], s17 offen lds
    s_mov_b64 exec, -1
    s_add_u32 s17, s49, 1437696
    s_add_u32 m0, s46, 99840
    s_nop 0
    buffer_load_dwordx4 v16, s[20:23], s17 offen lds
    s_add_u32 m0, s46, 100864
    s_mov_b64 exec, s[54:55]
    buffer_load_dwordx4 v17, s[20:23], s17 offen lds
    s_mov_b64 exec, -1
    s_add_u32 s17, s49, 1548288
    s_add_u32 m0, s46, 107520
    s_nop 0
    buffer_load_dwordx4 v16, s[20:23], s17 offen lds
    s_add_u32 m0, s46, 108544
    s_mov_b64 exec, s[54:55]
    buffer_load_dwordx4 v17, s[20:23], s17 offen lds
    s_mov_b64 exec, -1
    s_add_u32 s17, s49, 1658880
    s_add_u32 m0, s46, 115200
    s_nop 0
    buffer_load_dwordx4 v16, s[20:23], s17 offen lds
    s_add_u32 m0, s46, 116224
    s_mov_b64 exec, s[54:55]
    buffer_load_dwordx4 v17, s[20:23], s17 offen lds
    s_mov_b64 exec, -1
    s_add_u32 s17, s49, 1769472
    s_add_u32 m0, s46, 122880
    s_nop 0
    buffer_load_dwordx4 v16, s[20:23], s17 offen lds
    s_add_u32 m0, s46, 123904
    s_mov_b64 exec, s[54:55]
    buffer_load_dwordx4 v17, s[20:23], s17 offen lds
    s_mov_b64 exec, -1
    s_add_u32 s17, s49, 1880064
    s_add_u32 m0, s46, 130560
    s_nop 0
    buffer_load_dwordx4 v16, s[20:23], s17 offen lds
    s_add_u32 m0, s46, 131584
    s_mov_b64 exec, s[54:55]
    buffer_load_dwordx4 v17, s[20:23], s17 offen lds
    s_mov_b64 exec, -1
    v_mfma_f32_16x16x32_bf16 v[36:39], v[152:155], v[104:107], 0
    v_mfma_f32_16x16x32_bf16 v[40:43], v[224:227], v[104:107], 0
    v_mfma_f32_16x16x32_bf16 v[44:47], a[40:43], v[104:107], 0
    v_mfma_f32_16x16x32_bf16 v[48:51], v[104:107], a[112:115], 0
    v_mfma_f32_16x16x32_bf16 v[52:55], v[104:107], a[184:187], 0
    v_mfma_f32_16x16x32_bf16 v[36:39], v[156:159], v[104:107], v[36:39]
    v_mfma_f32_16x16x32_bf16 v[40:43], v[228:231], v[104:107], v[40:43]
    v_mfma_f32_16x16x32_bf16 v[44:47], a[44:47], v[104:107], v[44:47]
    v_mfma_f32_16x16x32_bf16 v[48:51], v[104:107], a[116:119], v[48:51]
    v_mfma_f32_16x16x32_bf16 v[52:55], v[104:107], a[188:191], v[52:55]
    v_mfma_f32_16x16x32_bf16 v[36:39], v[160:163], v[104:107], v[36:39]
    v_mfma_f32_16x16x32_bf16 v[40:43], v[232:235], v[104:107], v[40:43]
    v_mfma_f32_16x16x32_bf16 v[44:47], a[48:51], v[104:107], v[44:47]
    v_mfma_f32_16x16x32_bf16 v[48:51], v[104:107], a[120:123], v[48:51]
    v_mfma_f32_16x16x32_bf16 v[52:55], v[104:107], a[192:195], v[52:55]
    v_mfma_f32_16x16x32_bf16 v[36:39], v[164:167], v[104:107], v[36:39]
    v_mfma_f32_16x16x32_bf16 v[40:43], v[236:239], v[104:107], v[40:43]
    v_mfma_f32_16x16x32_bf16 v[44:47], a[52:55], v[104:107], v[44:47]
    v_mfma_f32_16x16x32_bf16 v[48:51], v[104:107], a[124:127], v[48:51]
    v_mfma_f32_16x16x32_bf16 v[52:55], v[104:107], a[196:199], v[52:55]
    v_mfma_f32_16x16x32_bf16 v[36:39], v[168:171], v[104:107], v[36:39]
    v_mfma_f32_16x16x32_bf16 v[40:43], v[240:243], v[104:107], v[40:43]
    v_mfma_f32_16x16x32_bf16 v[44:47], a[56:59], v[104:107], v[44:47]
    v_mfma_f32_16x16x32_bf16 v[48:51], v[104:107], a[128:131], v[48:51]
    v_mfma_f32_16x16x32_bf16 v[52:55], v[104:107], a[200:203], v[52:55]
    v_mfma_f32_16x16x32_bf16 v[36:39], v[172:175], v[104:107], v[36:39]
    v_mfma_f32_16x16x32_bf16 v[40:43], v[244:247], v[104:107], v[40:43]
    v_mfma_f32_16x16x32_bf16 v[44:47], a[60:63], v[104:107], v[44:47]
    v_mfma_f32_16x16x32_bf16 v[48:51], v[104:107], a[132:135], v[48:51]
    v_mfma_f32_16x16x32_bf16 v[52:55], v[104:107], a[204:207], v[52:55]
    s_waitcnt vmcnt(12)
    s_barrier
    v_add_u32 v60, 46080, v23
    v_mov_b32 v59, 0
    ds_read_b32 v56, v60
    ds_read_b32 v57, v60 offset:80
    ds_read_b32 v58, v60 offset:160
    v_add_u32 v68, 53760, v23
    v_mov_b32 v67, 0
    ds_read_b32 v64, v68
    ds_read_b32 v65, v68 offset:80
    ds_read_b32 v66, v68 offset:160
    v_add_u32 v76, 61440, v23
    v_mov_b32 v75, 0
    ds_read_b32 v72, v76
    ds_read_b32 v73, v76 offset:80
    ds_read_b32 v74, v76 offset:160
    v_add_u32 v84, 69120, v23
    v_mov_b32 v83, 0
    ds_read_b32 v80, v84
    ds_read_b32 v81, v84 offset:80
    ds_read_b32 v82, v84 offset:160
    v_add_u32 v92, 76800, v23
    v_mov_b32 v91, 0
    ds_read_b32 v88, v92
    ds_read_b32 v89, v92 offset:80
    ds_read_b32 v90, v92 offset:160
    v_add_u32 v100, 84480, v23
    v_mov_b32 v99, 0
    ds_read_b32 v96, v100
    ds_read_b32 v97, v100 offset:80
    ds_read_b32 v98, v100 offset:160
    v_add_u32 v61, 46080, v19
    ds_read_b64_tr_b16 v[176:177], v61 offset:0
    ds_read_b64_tr_b16 v[248:249], v61 offset:80
    ds_read_b64_tr_b16 a[136:137], v61 offset:160
    ds_read_b64_tr_b16 v[178:179], v61 offset:960
    ds_read_b64_tr_b16 v[250:251], v61 offset:1040
    ds_read_b64_tr_b16 a[138:139], v61 offset:1120
    v_add_u32 v69, 53760, v19
    ds_read_b64_tr_b16 v[180:181], v69 offset:0
    ds_read_b64_tr_b16 v[252:253], v69 offset:80
    ds_read_b64_tr_b16 a[140:141], v69 offset:160
    ds_read_b64_tr_b16 v[182:183], v69 offset:960
    ds_read_b64_tr_b16 v[254:255], v69 offset:1040
    ds_read_b64_tr_b16 a[142:143], v69 offset:1120
    v_add_u32 v77, 61440, v19
    ds_read_b64_tr_b16 v[184:185], v77 offset:0
    ds_read_b64_tr_b16 a[0:1], v77 offset:80
    ds_read_b64_tr_b16 a[144:145], v77 offset:160
    ds_read_b64_tr_b16 v[186:187], v77 offset:960
    ds_read_b64_tr_b16 a[2:3], v77 offset:1040
    ds_read_b64_tr_b16 a[146:147], v77 offset:1120
    v_add_u32 v85, 69120, v19
    ds_read_b64_tr_b16 v[188:189], v85 offset:0
    ds_read_b64_tr_b16 a[4:5], v85 offset:80
    ds_read_b64_tr_b16 a[148:149], v85 offset:160
    ds_read_b64_tr_b16 v[190:191], v85 offset:960
    ds_read_b64_tr_b16 a[6:7], v85 offset:1040
    ds_read_b64_tr_b16 a[150:151], v85 offset:1120
    v_add_u32 v93, 76800, v19
    ds_read_b64_tr_b16 v[192:193], v93 offset:0
    ds_read_b64_tr_b16 a[8:9], v93 offset:80
    ds_read_b64_tr_b16 a[152:153], v93 offset:160
    ds_read_b64_tr_b16 v[194:195], v93 offset:960
    ds_read_b64_tr_b16 a[10:11], v93 offset:1040
    ds_read_b64_tr_b16 a[154:155], v93 offset:1120
    v_add_u32 v101, 84480, v19
    ds_read_b64_tr_b16 v[196:197], v101 offset:0
    ds_read_b64_tr_b16 a[12:13], v101 offset:80
    ds_read_b64_tr_b16 a[156:157], v101 offset:160
    ds_read_b64_tr_b16 v[198:199], v101 offset:960
    ds_read_b64_tr_b16 a[14:15], v101 offset:1040
    ds_read_b64_tr_b16 a[158:159], v101 offset:1120
    s_waitcnt lgkmcnt(15)
    ds_write_b64 v28, v[56:57] offset:6144
    ds_write_b64 v28, v[58:59] offset:6152
    ds_write_b64 v28, v[64:65] offset:7168
    ds_write_b64 v28, v[66:67] offset:7176
    ds_write_b64 v28, v[72:73] offset:8192
    ds_write_b64 v28, v[74:75] offset:8200
    ds_write_b64 v28, v[80:81] offset:9216
    ds_write_b64 v28, v[82:83] offset:9224
    ds_write_b64 v28, v[88:89] offset:10240
    ds_write_b64 v28, v[90:91] offset:10248
    ds_write_b64 v28, v[96:97] offset:11264
    ds_write_b64 v28, v[98:99] offset:11272
    s_waitcnt lgkmcnt(0)
    v_and_b32 v56, 6144, v21
    v_add_u32 v56, v56, v20
    ds_read_b64_tr_b16 a[64:65], v56 offset:0
    ds_read_b64_tr_b16 a[66:67], v56 offset:128
    v_and_b32 v57, 6152, v21
    v_add_u32 v57, v57, v20
    ds_read_b64_tr_b16 a[208:209], v57 offset:0
    ds_read_b64_tr_b16 a[210:211], v57 offset:128
    v_and_b32 v64, 7168, v21
    v_add_u32 v64, v64, v20
    ds_read_b64_tr_b16 a[68:69], v64 offset:0
    ds_read_b64_tr_b16 a[70:71], v64 offset:128
    v_and_b32 v65, 7176, v21
    v_add_u32 v65, v65, v20
    ds_read_b64_tr_b16 a[212:213], v65 offset:0
    ds_read_b64_tr_b16 a[214:215], v65 offset:128
    v_and_b32 v72, 8192, v21
    v_add_u32 v72, v72, v20
    ds_read_b64_tr_b16 a[72:73], v72 offset:0
    ds_read_b64_tr_b16 a[74:75], v72 offset:128
    v_and_b32 v73, 8200, v21
    v_add_u32 v73, v73, v20
    ds_read_b64_tr_b16 a[216:217], v73 offset:0
    ds_read_b64_tr_b16 a[218:219], v73 offset:128
    v_and_b32 v80, 9216, v21
    v_add_u32 v80, v80, v20
    ds_read_b64_tr_b16 a[76:77], v80 offset:0
    ds_read_b64_tr_b16 a[78:79], v80 offset:128
    v_and_b32 v81, 9224, v21
    v_add_u32 v81, v81, v20
    ds_read_b64_tr_b16 a[220:221], v81 offset:0
    ds_read_b64_tr_b16 a[222:223], v81 offset:128
    v_and_b32 v88, 10240, v21
    v_add_u32 v88, v88, v20
    ds_read_b64_tr_b16 a[80:81], v88 offset:0
    ds_read_b64_tr_b16 a[82:83], v88 offset:128
    v_and_b32 v89, 10248, v21
    v_add_u32 v89, v89, v20
    ds_read_b64_tr_b16 a[224:225], v89 offset:0
    ds_read_b64_tr_b16 a[226:227], v89 offset:128
    v_and_b32 v96, 11264, v21
    v_add_u32 v96, v96, v20
    ds_read_b64_tr_b16 a[84:85], v96 offset:0
    ds_read_b64_tr_b16 a[86:87], v96 offset:128
    v_and_b32 v97, 11272, v21
    v_add_u32 v97, v97, v20
    ds_read_b64_tr_b16 a[228:229], v97 offset:0
    ds_read_b64_tr_b16 a[230:231], v97 offset:128
    s_waitcnt lgkmcnt(0)
    v_mfma_f32_16x16x32_bf16 v[36:39], v[176:179], v[104:107], v[36:39]
    v_mfma_f32_16x16x32_bf16 v[40:43], v[248:251], v[104:107], v[40:43]
    v_mfma_f32_16x16x32_bf16 v[44:47], a[64:67], v[104:107], v[44:47]
    v_mfma_f32_16x16x32_bf16 v[48:51], v[104:107], a[136:139], v[48:51]
    v_mfma_f32_16x16x32_bf16 v[52:55], v[104:107], a[208:211], v[52:55]
    v_mfma_f32_16x16x32_bf16 v[36:39], v[180:183], v[104:107], v[36:39]
    v_mfma_f32_16x16x32_bf16 v[40:43], v[252:255], v[104:107], v[40:43]
    v_mfma_f32_16x16x32_bf16 v[44:47], a[68:71], v[104:107], v[44:47]
    v_mfma_f32_16x16x32_bf16 v[48:51], v[104:107], a[140:143], v[48:51]
    v_mfma_f32_16x16x32_bf16 v[52:55], v[104:107], a[212:215], v[52:55]
    v_mfma_f32_16x16x32_bf16 v[36:39], v[184:187], v[104:107], v[36:39]
    v_mfma_f32_16x16x32_bf16 v[40:43], a[0:3], v[104:107], v[40:43]
    v_mfma_f32_16x16x32_bf16 v[44:47], a[72:75], v[104:107], v[44:47]
    v_mfma_f32_16x16x32_bf16 v[48:51], v[104:107], a[144:147], v[48:51]
    v_mfma_f32_16x16x32_bf16 v[52:55], v[104:107], a[216:219], v[52:55]
    v_mfma_f32_16x16x32_bf16 v[36:39], v[188:191], v[104:107], v[36:39]
    v_mfma_f32_16x16x32_bf16 v[40:43], a[4:7], v[104:107], v[40:43]
    v_mfma_f32_16x16x32_bf16 v[44:47], a[76:79], v[104:107], v[44:47]
    v_mfma_f32_16x16x32_bf16 v[48:51], v[104:107], a[148:151], v[48:51]
    v_mfma_f32_16x16x32_bf16 v[52:55], v[104:107], a[220:223], v[52:55]
    v_mfma_f32_16x16x32_bf16 v[36:39], v[192:195], v[104:107], v[36:39]
    v_mfma_f32_16x16x32_bf16 v[40:43], a[8:11], v[104:107], v[40:43]
    v_mfma_f32_16x16x32_bf16 v[44:47], a[80:83], v[104:107], v[44:47]
    v_mfma_f32_16x16x32_bf16 v[48:51], v[104:107], a[152:155], v[48:51]
    v_mfma_f32_16x16x32_bf16 v[52:55], v[104:107], a[224:227], v[52:55]
    v_mfma_f32_16x16x32_bf16 v[36:39], v[196:199], v[104:107], v[36:39]
    v_mfma_f32_16x16x32_bf16 v[40:43], a[12:15], v[104:107], v[40:43]
    v_mfma_f32_16x16x32_bf16 v[44:47], a[84:87], v[104:107], v[44:47]
    v_mfma_f32_16x16x32_bf16 v[48:51], v[104:107], a[156:159], v[48:51]
    v_mfma_f32_16x16x32_bf16 v[52:55], v[104:107], a[228:231], v[52:55]
    s_waitcnt vmcnt(0)
    s_barrier
    v_add_u32 v60, 92160, v23
    v_mov_b32 v59, 0
    ds_read_b32 v56, v60
    ds_read_b32 v57, v60 offset:80
    ds_read_b32 v58, v60 offset:160
    v_add_u32 v68, 99840, v23
    v_mov_b32 v67, 0
    ds_read_b32 v64, v68
    ds_read_b32 v65, v68 offset:80
    ds_read_b32 v66, v68 offset:160
    v_add_u32 v76, 107520, v23
    v_mov_b32 v75, 0
    ds_read_b32 v72, v76
    ds_read_b32 v73, v76 offset:80
    ds_read_b32 v74, v76 offset:160
    v_add_u32 v84, 115200, v23
    v_mov_b32 v83, 0
    ds_read_b32 v80, v84
    ds_read_b32 v81, v84 offset:80
    ds_read_b32 v82, v84 offset:160
    v_add_u32 v92, 122880, v23
    v_mov_b32 v91, 0
    ds_read_b32 v88, v92
    ds_read_b32 v89, v92 offset:80
    ds_read_b32 v90, v92 offset:160
    v_add_u32 v100, 130560, v23
    v_mov_b32 v99, 0
    ds_read_b32 v96, v100
    ds_read_b32 v97, v100 offset:80
    ds_read_b32 v98, v100 offset:160
    v_add_u32 v61, 92160, v19
    ds_read_b64_tr_b16 v[200:201], v61 offset:0
    ds_read_b64_tr_b16 a[16:17], v61 offset:80
    ds_read_b64_tr_b16 a[160:161], v61 offset:160
    ds_read_b64_tr_b16 v[202:203], v61 offset:960
    ds_read_b64_tr_b16 a[18:19], v61 offset:1040
    ds_read_b64_tr_b16 a[162:163], v61 offset:1120
    v_add_u32 v69, 99840, v19
    ds_read_b64_tr_b16 v[204:205], v69 offset:0
    ds_read_b64_tr_b16 a[20:21], v69 offset:80
    ds_read_b64_tr_b16 a[164:165], v69 offset:160
    ds_read_b64_tr_b16 v[206:207], v69 offset:960
    ds_read_b64_tr_b16 a[22:23], v69 offset:1040
    ds_read_b64_tr_b16 a[166:167], v69 offset:1120
    v_add_u32 v77, 107520, v19
    ds_read_b64_tr_b16 v[208:209], v77 offset:0
    ds_read_b64_tr_b16 a[24:25], v77 offset:80
    ds_read_b64_tr_b16 a[168:169], v77 offset:160
    ds_read_b64_tr_b16 v[210:211], v77 offset:960
    ds_read_b64_tr_b16 a[26:27], v77 offset:1040
    ds_read_b64_tr_b16 a[170:171], v77 offset:1120
    v_add_u32 v85, 115200, v19
    ds_read_b64_tr_b16 v[212:213], v85 offset:0
    ds_read_b64_tr_b16 a[28:29], v85 offset:80
    ds_read_b64_tr_b16 a[172:173], v85 offset:160
    ds_read_b64_tr_b16 v[214:215], v85 offset:960
    ds_read_b64_tr_b16 a[30:31], v85 offset:1040
    ds_read_b64_tr_b16 a[174:175], v85 offset:1120
    v_add_u32 v93, 122880, v19
    ds_read_b64_tr_b16 v[216:217], v93 offset:0
    ds_read_b64_tr_b16 a[32:33], v93 offset:80
    ds_read_b64_tr_b16 a[176:177], v93 offset:160
    ds_read_b64_tr_b16 v[218:219], v93 offset:960
    ds_read_b64_tr_b16 a[34:35], v93 offset:1040
    ds_read_b64_tr_b16 a[178:179], v93 offset:1120
    v_add_u32 v101, 130560, v19
    ds_read_b64_tr_b16 v[220:221], v101 offset:0
    ds_read_b64_tr_b16 a[36:37], v101 offset:80
    ds_read_b64_tr_b16 a[180:181], v101 offset:160
    ds_read_b64_tr_b16 v[222:223], v101 offset:960
    ds_read_b64_tr_b16 a[38:39], v101 offset:1040
    ds_read_b64_tr_b16 a[182:183], v101 offset:1120
    s_waitcnt lgkmcnt(15)
    ds_write_b64 v28, v[56:57] offset:12288
    ds_write_b64 v28, v[58:59] offset:12296
    ds_write_b64 v28, v[64:65] offset:13312
    ds_write_b64 v28, v[66:67] offset:13320
    ds_write_b64 v28, v[72:73] offset:14336
    ds_write_b64 v28, v[74:75] offset:14344
    ds_write_b64 v28, v[80:81] offset:15360
    ds_write_b64 v28, v[82:83] offset:15368
    ds_write_b64 v28, v[88:89] offset:16384
    ds_write_b64 v28, v[90:91] offset:16392
    ds_write_b64 v28, v[96:97] offset:17408
    ds_write_b64 v28, v[98:99] offset:17416
    s_waitcnt lgkmcnt(0)
    v_and_b32 v56, 12288, v21
    v_add_u32 v56, v56, v20
    ds_read_b64_tr_b16 a[88:89], v56 offset:0
    ds_read_b64_tr_b16 a[90:91], v56 offset:128
    v_and_b32 v57, 12296, v21
    v_add_u32 v57, v57, v20
    ds_read_b64_tr_b16 a[232:233], v57 offset:0
    ds_read_b64_tr_b16 a[234:235], v57 offset:128
    v_and_b32 v64, 13312, v21
    v_add_u32 v64, v64, v20
    ds_read_b64_tr_b16 a[92:93], v64 offset:0
    ds_read_b64_tr_b16 a[94:95], v64 offset:128
    v_and_b32 v65, 13320, v21
    v_add_u32 v65, v65, v20
    ds_read_b64_tr_b16 a[236:237], v65 offset:0
    ds_read_b64_tr_b16 a[238:239], v65 offset:128
    v_and_b32 v72, 14336, v21
    v_add_u32 v72, v72, v20
    ds_read_b64_tr_b16 a[96:97], v72 offset:0
    ds_read_b64_tr_b16 a[98:99], v72 offset:128
    v_and_b32 v73, 14344, v21
    v_add_u32 v73, v73, v20
    ds_read_b64_tr_b16 a[240:241], v73 offset:0
    ds_read_b64_tr_b16 a[242:243], v73 offset:128
    v_and_b32 v80, 15360, v21
    v_add_u32 v80, v80, v20
    ds_read_b64_tr_b16 a[100:101], v80 offset:0
    ds_read_b64_tr_b16 a[102:103], v80 offset:128
    v_and_b32 v81, 15368, v21
    v_add_u32 v81, v81, v20
    ds_read_b64_tr_b16 a[244:245], v81 offset:0
    ds_read_b64_tr_b16 a[246:247], v81 offset:128
    v_and_b32 v88, 16384, v21
    v_add_u32 v88, v88, v20
    ds_read_b64_tr_b16 a[104:105], v88 offset:0
    ds_read_b64_tr_b16 a[106:107], v88 offset:128
    v_and_b32 v89, 16392, v21
    v_add_u32 v89, v89, v20
    ds_read_b64_tr_b16 a[248:249], v89 offset:0
    ds_read_b64_tr_b16 a[250:251], v89 offset:128
    v_and_b32 v96, 17408, v21
    v_add_u32 v96, v96, v20
    ds_read_b64_tr_b16 a[108:109], v96 offset:0
    ds_read_b64_tr_b16 a[110:111], v96 offset:128
    v_and_b32 v97, 17416, v21
    v_add_u32 v97, v97, v20
    ds_read_b64_tr_b16 a[252:253], v97 offset:0
    ds_read_b64_tr_b16 a[254:255], v97 offset:128
    s_waitcnt lgkmcnt(0)
    v_mfma_f32_16x16x32_bf16 v[36:39], v[200:203], v[104:107], v[36:39]
    v_mfma_f32_16x16x32_bf16 v[40:43], a[16:19], v[104:107], v[40:43]
    v_mfma_f32_16x16x32_bf16 v[44:47], a[88:91], v[104:107], v[44:47]
    v_mfma_f32_16x16x32_bf16 v[48:51], v[104:107], a[160:163], v[48:51]
    v_mfma_f32_16x16x32_bf16 v[52:55], v[104:107], a[232:235], v[52:55]
    v_mfma_f32_16x16x32_bf16 v[36:39], v[204:207], v[104:107], v[36:39]
    v_mfma_f32_16x16x32_bf16 v[40:43], a[20:23], v[104:107], v[40:43]
    v_mfma_f32_16x16x32_bf16 v[44:47], a[92:95], v[104:107], v[44:47]
    v_mfma_f32_16x16x32_bf16 v[48:51], v[104:107], a[164:167], v[48:51]
    v_mfma_f32_16x16x32_bf16 v[52:55], v[104:107], a[236:239], v[52:55]
    v_mfma_f32_16x16x32_bf16 v[36:39], v[208:211], v[104:107], v[36:39]
    v_mfma_f32_16x16x32_bf16 v[40:43], a[24:27], v[104:107], v[40:43]
    v_mfma_f32_16x16x32_bf16 v[44:47], a[96:99], v[104:107], v[44:47]
    v_mfma_f32_16x16x32_bf16 v[48:51], v[104:107], a[168:171], v[48:51]
    v_mfma_f32_16x16x32_bf16 v[52:55], v[104:107], a[240:243], v[52:55]
    v_mfma_f32_16x16x32_bf16 v[36:39], v[212:215], v[104:107], v[36:39]
    v_mfma_f32_16x16x32_bf16 v[40:43], a[28:31], v[104:107], v[40:43]
    v_mfma_f32_16x16x32_bf16 v[44:47], a[100:103], v[104:107], v[44:47]
    v_mfma_f32_16x16x32_bf16 v[48:51], v[104:107], a[172:175], v[48:51]
    v_mfma_f32_16x16x32_bf16 v[52:55], v[104:107], a[244:247], v[52:55]
    v_mfma_f32_16x16x32_bf16 v[36:39], v[216:219], v[104:107], v[36:39]
    v_mfma_f32_16x16x32_bf16 v[40:43], a[32:35], v[104:107], v[40:43]
    v_mfma_f32_16x16x32_bf16 v[44:47], a[104:107], v[104:107], v[44:47]
    v_mfma_f32_16x16x32_bf16 v[48:51], v[104:107], a[176:179], v[48:51]
    v_mfma_f32_16x16x32_bf16 v[52:55], v[104:107], a[248:251], v[52:55]
    v_mfma_f32_16x16x32_bf16 v[36:39], v[220:223], v[104:107], v[36:39]
    v_mfma_f32_16x16x32_bf16 v[40:43], a[36:39], v[104:107], v[40:43]
    v_mfma_f32_16x16x32_bf16 v[44:47], a[108:111], v[104:107], v[44:47]
    v_mfma_f32_16x16x32_bf16 v[48:51], v[104:107], a[180:183], v[48:51]
    v_mfma_f32_16x16x32_bf16 v[52:55], v[104:107], a[252:255], v[52:55]
    s_barrier
    v_lshlrev_b32 v10, 5, v7
    s_lshl_b32 s17, s51, 4
    v_add_u32 v10, s17, v10
    v_mul_u32_u24 v6, 1536, v8
    v_add_u32 v10, v10, v6
    s_lshl_b32 s17, s14, 7
    s_add_u32 s17, s17, 73728
    v_lshl_add_u32 v11, v7, 3, s17
    v_lshl_add_u32 v12, v8, 5, s17
    v_lshlrev_b32 v13, 5, v7
    s_lshl_b32 s17, s51, 4
    v_add_u32 v13, s17, v13
    s_lshr_b32 s17, s50, 2
    s_add_u32 s17, s17, 64
    s_lshl_b32 s17, s17, 9
    s_and_b32 s18, s50, 3
    s_lshl_b32 s18, s18, 2
    s_add_u32 s17, s17, s18
    v_add_u32 v14, s17, v13
    v_lshrrev_b32 v5, 1, v8
    v_lshl_add_u32 v13, v5, 9, v13
    v_and_b32 v5, 1, v8
    v_lshl_add_u32 v13, v5, 3, v13
    s_lshl_b32 s17, s50, 10
    v_add_u32 v13, s17, v13
    s_lshl_b32 s49, s15, 7
    s_lshl_b32 s17, s14, 2
    s_add_u32 s49, s49, s17
    s_add_u32 s49, s49, 181760
    s_mov_b32 s52, 0x3eae1a93
    v_mov_b32 v6, 0xf149f2ca
    v_lshl_add_u32 v5, v8, 2, 0
    v_sub_u32 v5, v5, v7
    v_cmp_le_i32 vcc, 9, v5
    s_nop 1
    v_cndmask_b32 v72, v6, v4, vcc
    v_add_u32 v5, 7, v5
    v_cmp_ge_u32 vcc, 7, v5
    s_nop 1
    v_cndmask_b32 v76, v6, v4, vcc
    v_lshl_add_u32 v5, v8, 2, 1
    v_sub_u32 v5, v5, v7
    v_cmp_le_i32 vcc, 9, v5
    s_nop 1
    v_cndmask_b32 v73, v6, v4, vcc
    v_add_u32 v5, 7, v5
    v_cmp_ge_u32 vcc, 7, v5
    s_nop 1
    v_cndmask_b32 v77, v6, v4, vcc
    v_lshl_add_u32 v5, v8, 2, 2
    v_sub_u32 v5, v5, v7
    v_cmp_le_i32 vcc, 9, v5
    s_nop 1
    v_cndmask_b32 v74, v6, v4, vcc
    v_add_u32 v5, 7, v5
    v_cmp_ge_u32 vcc, 7, v5
    s_nop 1
    v_cndmask_b32 v78, v6, v4, vcc
    v_lshl_add_u32 v5, v8, 2, 3
    v_sub_u32 v5, v5, v7
    v_cmp_le_i32 vcc, 9, v5
    s_nop 1
    v_cndmask_b32 v75, v6, v4, vcc
    v_add_u32 v5, 7, v5
    v_cmp_ge_u32 vcc, 7, v5
    s_nop 1
    v_cndmask_b32 v79, v6, v4, vcc
    v_and_b32 v111, 0x200, v0
    v_lshl_add_u32 v111, v7, 5, v111
    v_and_b32 v5, 1, v8
    v_lshl_add_u32 v111, v5, 4, v111
    v_mov_b32 v112, 0
    v_mov_b32 v113, 0
    v_mov_b32 v114, 0
    v_mov_b32 v115, 0
    v_mov_b32 v136, 0
    v_mov_b32 v137, 0
    v_mov_b32 v138, 0
    v_mov_b32 v139, 0
    v_mov_b32 v140, 0
    v_mov_b32 v141, 0
    v_mov_b32 v142, 0
    v_mov_b32 v143, 0
    v_mov_b32 v116, 0x3f803f80
    v_mov_b32 v117, 0x3f803f80
    v_mov_b32 v118, 0x3f803f80
    v_mov_b32 v119, 0x3f803f80
    v_mov_b32 v131, 0
    v_mov_b32 v135, 0
    v_mbcnt_lo_u32_b32 v24, -1, 0
    v_mbcnt_hi_u32_b32 v24, -1, v24
    v_and_b32 v25, 1, v24
    v_lshlrev_b32 v25, 7, v25
    v_lshlrev_b32 v24, 1, v24
    v_and_or_b32 v24, v24, 12, v25
    s_mov_b32 s16, 0
Laq_pure:
    global_load_dword v25, v24, s[12:13] sc1
    s_add_u32 s16, s16, 1
    s_cmp_gt_u32 s16, 100000
    s_cbranch_scc1 L_role_aq_abort
    s_mov_b32 s6, 0
    s_waitcnt vmcnt(0)
    v_readlane_b32 s7, v25, 0
    s_nop 0
    s_add_u32 s6, s6, s7
    v_readlane_b32 s7, v25, 1
    s_nop 0
    s_add_u32 s6, s6, s7
    v_readlane_b32 s7, v25, 2
    s_nop 0
    s_add_u32 s6, s6, s7
    v_readlane_b32 s7, v25, 3
    s_nop 0
    s_add_u32 s6, s6, s7
    v_readlane_b32 s7, v25, 4
    s_nop 0
    s_add_u32 s6, s6, s7
    v_readlane_b32 s7, v25, 5
    s_nop 0
    s_add_u32 s6, s6, s7
    v_readlane_b32 s7, v25, 6
    s_nop 0
    s_add_u32 s6, s6, s7
    v_readlane_b32 s7, v25, 7
    s_nop 0
    s_add_u32 s6, s6, s7
    v_readlane_b32 s7, v25, s3
    s_nop 0
    s_cmp_ge_u32 s7, 32
    s_cselect_b32 s61, 1, 0
    s_cselect_b32 s6, 256, s6
    s_cmp_lt_u32 s6, 256
    s_cbranch_scc1 Laq_pure
    s_cmp_eq_u32 s61, 0
    s_cbranch_scc1 Laq_slow
    s_mov_b32 s36, s63
    s_mov_b32 s34, s63
    s_mov_b32 s37, 0
    s_lshl_b32 s56, s63, 6
    s_mul_i32 s58, s14, 9216
    s_mov_b32 s40, 36864
    s_mov_b32 s59, s58
    s_mov_b32 s43, 0
    s_mov_b32 s28, s8
    s_mov_b32 s29, s9
    s_mov_b32 s30, 0
    s_mov_b32 s31, 0x00020000
    s_mul_i32 s41, s63, 4718592
    s_add_u32 s41, s41, s58
    s_add_u32 s41, s41, 6291456
    s_mul_i32 s42, s56, 22528
    s_add_u32 s42, s42, 180224
    s_cmp_lg_u32 s14, 0
    s_cbranch_scc1 Laqf_ini_d
    v_mov_b32 v5, 160
    s_mov_b32 s16, 0
Laqf_ini:
    global_load_dword v6, v5, s[12:13] sc1
    s_add_u32 s16, s16, 1
    s_cmp_gt_u32 s16, 100000
    s_cbranch_scc1 L_role_aq_abort
    s_waitcnt vmcnt(0)
    v_cmp_gt_u32 vcc, 123, v6
    s_nop 0
    s_cbranch_vccz Laqf_ini_d
    s_sleep 8
    s_branch Laqf_ini
Laqf_ini_d:
    s_barrier
    s_branch Laqf_poll
Laqf_item:
    s_waitcnt vmcnt(2)
Laqf_go:
    s_barrier
    s_xor_b32 s40, s40, 36864
    s_xor_b32 s59, s59, 36864
    s_xor_b32 s66, s66, 0x2000
    s_xor_b32 s71, s71, 0x2000
    s_mov_b32 s35, s37
    s_mov_b32 s57, s56
    s_add_u32 s37, s37, 1
    s_add_u32 s56, s56, 1
    s_add_u32 s41, s41, 36864
    s_add_u32 s42, s42, 22528
    s_mov_b32 s62, 0
    v_lshlrev_b32 v9, 9, v8
    v_lshl_add_u32 v9, v7, 4, v9
    s_lshl_b32 s17, s51, 8
    s_add_u32 s17, s17, s40
    v_add_u32 v9, s17, v9
    ds_read_b128 v[56:59], v9 offset:0
    ds_read_b128 v[60:63], v9 offset:2048
    ds_read_b128 v[64:67], v9 offset:4096
    ds_read_b128 v[104:107], v9 offset:6144
    s_waitcnt lgkmcnt(3)
    v_mfma_f32_16x16x32_bf16 v[16:19], v[152:155], v[56:59], 0
    v_add_f32 v80, v80, v84
    v_mfma_f32_16x16x32_bf16 v[20:23], v[224:227], v[56:59], 0
    v_add_f32 v81, v81, v85
    v_mfma_f32_16x16x32_bf16 v[24:27], a[40:43], v[56:59], 0
    v_add_f32 v82, v82, v86
    ds_read_b128 v[56:59], v9 offset:8192
    s_waitcnt lgkmcnt(3)
    v_mfma_f32_16x16x32_bf16 v[16:19], v[156:159], v[60:63], v[16:19]
    v_add_f32 v83, v83, v87
    v_mfma_f32_16x16x32_bf16 v[20:23], v[228:231], v[60:63], v[20:23]
    v_add_f32 v80, v80, v88
    v_mfma_f32_16x16x32_bf16 v[24:27], a[44:47], v[60:63], v[24:27]
    v_add_f32 v81, v81, v89
    ds_read_b128 v[60:63], v9 offset:10240
    s_waitcnt lgkmcnt(3)
    v_mfma_f32_16x16x32_bf16 v[16:19], v[160:163], v[64:67], v[16:19]
    v_add_f32 v82, v82, v90
    v_mfma_f32_16x16x32_bf16 v[20:23], v[232:235], v[64:67], v[20:23]
    v_add_f32 v83, v83, v91
    v_mfma_f32_16x16x32_bf16 v[24:27], a[48:51], v[64:67], v[24:27]
    v_add_f32 v80, v80, v82
    ds_read_b128 v[64:67], v9 offset:12288
    s_waitcnt lgkmcnt(3)
    v_mfma_f32_16x16x32_bf16 v[16:19], v[164:167], v[104:107], v[16:19]
    v_add_f32 v81, v81, v83
    v_mfma_f32_16x16x32_bf16 v[20:23], v[236:239], v[104:107], v[20:23]
    v_mov_b32 v82, v80
    v_mfma_f32_16x16x32_bf16 v[24:27], a[52:55], v[104:107], v[24:27]
    v_mov_b32 v83, v81
    ds_read_b128 v[104:107], v9 offset:14336
    s_waitcnt lgkmcnt(3)
    v_mfma_f32_16x16x32_bf16 v[16:19], v[168:171], v[56:59], v[16:19]
    v_permlane32_swap_b32 v80, v82
    v_mfma_f32_16x16x32_bf16 v[20:23], v[240:243], v[56:59], v[20:23]
    v_permlane32_swap_b32 v81, v83
    v_mfma_f32_16x16x32_bf16 v[24:27], a[56:59], v[56:59], v[24:27]
    v_add_f32 v80, v80, v82
    ds_read_b128 v[56:59], v9 offset:16384
    s_waitcnt lgkmcnt(3)
    v_mfma_f32_16x16x32_bf16 v[16:19], v[172:175], v[60:63], v[16:19]
    v_add_f32 v81, v81, v83
    v_mfma_f32_16x16x32_bf16 v[20:23], v[244:247], v[60:63], v[20:23]
    v_mov_b32 v82, v80
    v_mfma_f32_16x16x32_bf16 v[24:27], a[60:63], v[60:63], v[24:27]
    v_mov_b32 v83, v81
    ds_read_b128 v[60:63], v9 offset:18432
    s_waitcnt lgkmcnt(3)
    v_mfma_f32_16x16x32_bf16 v[16:19], v[176:179], v[64:67], v[16:19]
    v_permlane16_swap_b32 v80, v82
    v_mfma_f32_16x16x32_bf16 v[20:23], v[248:251], v[64:67], v[20:23]
    v_permlane16_swap_b32 v81, v83
    v_mfma_f32_16x16x32_bf16 v[24:27], a[64:67], v[64:67], v[24:27]
    v_add_f32 v80, v80, v82
    ds_read_b128 v[64:67], v9 offset:20480
    s_waitcnt lgkmcnt(3)
    v_mfma_f32_16x16x32_bf16 v[16:19], v[180:183], v[104:107], v[16:19]
    v_add_f32 v81, v81, v83
    v_mfma_f32_16x16x32_bf16 v[20:23], v[252:255], v[104:107], v[20:23]
    v_mul_f32 v80, 0x3ae38e39, v80
    v_mfma_f32_16x16x32_bf16 v[24:27], a[68:71], v[104:107], v[24:27]
    v_mul_f32 v81, 0x3ae38e39, v81
    ds_read_b128 v[104:107], v9 offset:22528
    s_waitcnt lgkmcnt(3)
    v_mfma_f32_16x16x32_bf16 v[16:19], v[184:187], v[56:59], v[16:19]
    v_fma_f32 v81, -v80, v80, v81
    v_mfma_f32_16x16x32_bf16 v[20:23], a[0:3], v[56:59], v[20:23]
    v_max_f32 v81, 0, v81
    v_mfma_f32_16x16x32_bf16 v[24:27], a[72:75], v[56:59], v[24:27]
    v_add_f32 v81, 0x3727c5ac, v81
    ds_read_b128 v[56:59], v9 offset:24576
    s_waitcnt lgkmcnt(3)
    v_mfma_f32_16x16x32_bf16 v[16:19], v[188:191], v[60:63], v[16:19]
    v_rsq_f32 v92, v81
    v_mfma_f32_16x16x32_bf16 v[20:23], a[4:7], v[60:63], v[20:23]
    v_mul_f32 v93, v80, v92
    v_mfma_f32_16x16x32_bf16 v[24:27], a[76:79], v[60:63], v[24:27]
    ds_write_b64 v11, v[92:93]
    ds_read_b128 v[60:63], v9 offset:26624
    s_waitcnt lgkmcnt(4)
    v_mfma_f32_16x16x32_bf16 v[16:19], v[192:195], v[64:67], v[16:19]
    ds_read_b128 v[96:99], v12
    v_mfma_f32_16x16x32_bf16 v[20:23], a[8:11], v[64:67], v[20:23]
    ds_read_b128 v[100:103], v12 offset:16
    v_mfma_f32_16x16x32_bf16 v[24:27], a[80:83], v[64:67], v[24:27]
    s_waitcnt vmcnt(0)
    buffer_load_dword v2, v1, s[8:11], s42 offen sc1
    s_cmp_lg_u32 s43, 0
    s_cselect_b64 exec, 1, 0
    buffer_store_dword v3, v4, s[8:11], s43 offen
    s_mov_b64 exec, -1
    s_mov_b32 s43, 0
    ds_read_b128 v[64:67], v9 offset:28672
    s_waitcnt lgkmcnt(6)
    v_mfma_f32_16x16x32_bf16 v[16:19], v[196:199], v[104:107], v[16:19]
    v_mfma_f32_16x16x32_bf16 v[20:23], a[12:15], v[104:107], v[20:23]
    v_mfma_f32_16x16x32_bf16 v[24:27], a[84:87], v[104:107], v[24:27]
    ds_read_b128 v[104:107], v9 offset:30720
    s_waitcnt lgkmcnt(6)
    v_mfma_f32_16x16x32_bf16 v[16:19], v[200:203], v[56:59], v[16:19]
    v_mfma_f32_16x16x32_bf16 v[20:23], a[16:19], v[56:59], v[20:23]
    v_mfma_f32_16x16x32_bf16 v[24:27], a[88:91], v[56:59], v[24:27]
    ds_read_b128 v[56:59], v9 offset:32768
    s_waitcnt lgkmcnt(5)
    v_mfma_f32_16x16x32_bf16 v[16:19], v[204:207], v[60:63], v[16:19]
    v_mfma_f32_16x16x32_bf16 v[20:23], a[20:23], v[60:63], v[20:23]
    v_mfma_f32_16x16x32_bf16 v[24:27], a[92:95], v[60:63], v[24:27]
    ds_read_b128 v[60:63], v9 offset:34816
    s_waitcnt lgkmcnt(3)
    v_mfma_f32_16x16x32_bf16 v[16:19], v[208:211], v[64:67], v[16:19]
    v_mfma_f32_16x16x32_bf16 v[20:23], a[24:27], v[64:67], v[20:23]
    v_mfma_f32_16x16x32_bf16 v[24:27], a[96:99], v[64:67], v[24:27]
    ds_read_b128 v[64:67], v9 offset:0
    s_waitcnt lgkmcnt(3)
    v_mfma_f32_16x16x32_bf16 v[16:19], v[212:215], v[104:107], v[16:19]
    v_mfma_f32_16x16x32_bf16 v[20:23], a[28:31], v[104:107], v[20:23]
    v_mfma_f32_16x16x32_bf16 v[24:27], a[100:103], v[104:107], v[24:27]
    ds_read_b128 v[104:107], v9 offset:2048
    s_waitcnt lgkmcnt(3)
    v_mfma_f32_16x16x32_bf16 v[16:19], v[216:219], v[56:59], v[16:19]
    v_mfma_f32_16x16x32_bf16 v[20:23], a[32:35], v[56:59], v[20:23]
    v_mfma_f32_16x16x32_bf16 v[24:27], a[104:107], v[56:59], v[24:27]
    ds_read_b128 v[56:59], v9 offset:4096
    s_waitcnt lgkmcnt(3)
    v_mfma_f32_16x16x32_bf16 v[16:19], v[220:223], v[60:63], v[16:19]
    v_mfma_f32_16x16x32_bf16 v[20:23], a[36:39], v[60:63], v[20:23]
    v_mfma_f32_16x16x32_bf16 v[24:27], a[108:111], v[60:63], v[24:27]
    ds_read_b128 v[60:63], v9 offset:6144
    s_waitcnt lgkmcnt(3)
    v_mfma_f32_16x16x32_bf16 v[28:31], v[64:67], a[112:115], 0
    v_mfma_f32_16x16x32_bf16 v[32:35], v[64:67], a[184:187], 0
    ds_read_b128 v[64:67], v9 offset:8192
    s_waitcnt lgkmcnt(3)
    v_mfma_f32_16x16x32_bf16 v[28:31], v[104:107], a[116:119], v[28:31]
    v_mul_f32 v94, v93, v36
    v_fma_f32 v16, v16, v92, -v94
    v_mfma_f32_16x16x32_bf16 v[32:35], v[104:107], a[188:191], v[32:35]
    v_mul_f32 v94, v93, v37
    v_fma_f32 v17, v17, v92, -v94
    ds_read_b128 v[104:107], v9 offset:10240
    s_waitcnt lgkmcnt(3)
    v_mfma_f32_16x16x32_bf16 v[28:31], v[56:59], a[120:123], v[28:31]
    v_mul_f32 v94, v93, v38
    v_fma_f32 v18, v18, v92, -v94
    v_mfma_f32_16x16x32_bf16 v[32:35], v[56:59], a[192:195], v[32:35]
    v_mul_f32 v94, v93, v39
    v_fma_f32 v19, v19, v92, -v94
    ds_read_b128 v[56:59], v9 offset:12288
    s_waitcnt lgkmcnt(3)
    v_mfma_f32_16x16x32_bf16 v[28:31], v[60:63], a[124:127], v[28:31]
    v_mul_f32 v94, v93, v44
    v_fma_f32 v24, v24, v92, -v94
    v_mfma_f32_16x16x32_bf16 v[32:35], v[60:63], a[196:199], v[32:35]
    v_mul_f32 v94, v93, v45
    v_fma_f32 v25, v25, v92, -v94
    ds_read_b128 v[60:63], v9 offset:14336
    s_waitcnt lgkmcnt(3)
    v_mfma_f32_16x16x32_bf16 v[28:31], v[64:67], a[128:131], v[28:31]
    v_mul_f32 v94, v93, v46
    v_fma_f32 v26, v26, v92, -v94
    v_mfma_f32_16x16x32_bf16 v[32:35], v[64:67], a[200:203], v[32:35]
    v_mul_f32 v94, v93, v47
    v_fma_f32 v27, v27, v92, -v94
    s_waitcnt vmcnt(1)
    v_cmp_eq_u32 vcc, 0, v2
    s_nop 0
    s_cmp_eq_u64 vcc, 0
    s_cselect_b32 s62, 1, 0
    s_cmp_lt_u32 s37, 64
    s_cselect_b32 s62, s62, 0
    s_cmp_lg_u32 s62, 0
    s_cselect_b32 s30, 268435456, 0
    ds_read_b128 v[64:67], v9 offset:16384
    s_waitcnt lgkmcnt(3)
    v_mfma_f32_16x16x32_bf16 v[28:31], v[104:107], a[132:135], v[28:31]
    v_mul_f32 v94, v93, v40
    v_fma_f32 v20, v20, v92, -v94
    v_mfma_f32_16x16x32_bf16 v[32:35], v[104:107], a[204:207], v[32:35]
    v_mul_f32 v94, v93, v41
    v_fma_f32 v21, v21, v92, -v94
    s_add_u32 m0, s59, 0
    s_add_u32 s47, s41, 0
    buffer_load_dwordx4 v111, s[28:31], s47 offen offset:0 lds
    ds_read_b128 v[104:107], v9 offset:18432
    s_waitcnt lgkmcnt(3)
    v_mfma_f32_16x16x32_bf16 v[28:31], v[56:59], a[136:139], v[28:31]
    v_mul_f32 v94, v93, v42
    v_fma_f32 v22, v22, v92, -v94
    v_mfma_f32_16x16x32_bf16 v[32:35], v[56:59], a[208:211], v[32:35]
    v_mul_f32 v94, v93, v43
    v_fma_f32 v23, v23, v92, -v94
    buffer_load_dwordx4 v111, s[28:31], s47 offen offset:1024 lds
    ds_read_b128 v[56:59], v9 offset:20480
    s_waitcnt lgkmcnt(3)
    v_mfma_f32_16x16x32_bf16 v[28:31], v[60:63], a[140:143], v[28:31]
    v_cvt_pk_bf16_f32 v128, v16, v17
    v_cvt_pk_bf16_f32 v129, v18, v19
    v_mfma_f32_16x16x32_bf16 v[32:35], v[60:63], a[212:215], v[32:35]
    v_cvt_pk_bf16_f32 v130, v24, v25
    v_cvt_pk_bf16_f32 v132, v20, v21
    buffer_load_dwordx4 v111, s[28:31], s47 offen offset:2048 lds
    ds_read_b128 v[60:63], v9 offset:22528
    s_waitcnt lgkmcnt(3)
    v_mfma_f32_16x16x32_bf16 v[28:31], v[64:67], a[144:147], v[28:31]
    v_cvt_pk_bf16_f32 v133, v22, v23
    v_cvt_pk_bf16_f32 v134, v26, v27
    v_mfma_f32_16x16x32_bf16 v[32:35], v[64:67], a[216:219], v[32:35]
    s_cmp_eq_u32 s35, 0
    s_cselect_b32 s46, 0xf149f2ca, 0
    buffer_load_dwordx4 v111, s[28:31], s47 offen offset:3072 lds
    ds_read_b128 v[64:67], v9 offset:24576
    s_waitcnt lgkmcnt(3)
    v_mfma_f32_16x16x32_bf16 v[28:31], v[104:107], a[148:151], v[28:31]
    v_mfma_f32_16x16x32_bf16 v[144:147], v[112:115], v[128:131], 0
    v_mfma_f32_16x16x32_bf16 v[32:35], v[104:107], a[220:223], v[32:35]
    v_mfma_f32_16x16x32_bf16 v[148:151], v[132:135], v[128:131], 0
    s_add_u32 m0, s59, 4096
    s_add_u32 s47, s41, 4096
    buffer_load_dwordx4 v111, s[28:31], s47 offen offset:0 lds
    ds_read_b128 v[104:107], v9 offset:26624
    s_waitcnt lgkmcnt(3)
    v_mfma_f32_16x16x32_bf16 v[28:31], v[56:59], a[152:155], v[28:31]
    v_mov_b32 v112, v132
    v_mfma_f32_16x16x32_bf16 v[32:35], v[56:59], a[224:227], v[32:35]
    v_mov_b32 v113, v133
    v_mov_b32 v114, v134
    buffer_load_dwordx4 v111, s[28:31], s47 offen offset:1024 lds
    ds_read_b128 v[56:59], v9 offset:28672
    s_waitcnt lgkmcnt(3)
    v_mfma_f32_16x16x32_bf16 v[28:31], v[60:63], a[156:159], v[28:31]
    v_mfma_f32_16x16x32_bf16 v[32:35], v[60:63], a[228:231], v[32:35]
    v_fma_f32 v144, v144, s52, v72
    buffer_load_dwordx4 v111, s[28:31], s47 offen offset:2048 lds
    ds_read_b128 v[60:63], v9 offset:30720
    s_waitcnt lgkmcnt(3)
    v_mfma_f32_16x16x32_bf16 v[28:31], v[64:67], a[160:163], v[28:31]
    v_fma_f32 v145, v145, s52, v73
    v_fma_f32 v146, v146, s52, v74
    v_fma_f32 v147, v147, s52, v75
    v_mfma_f32_16x16x32_bf16 v[32:35], v[64:67], a[232:235], v[32:35]
    v_fma_f32 v148, v148, s52, v76
    v_fma_f32 v149, v149, s52, v77
    v_fma_f32 v150, v150, s52, v78
    buffer_load_dwordx4 v111, s[28:31], s47 offen offset:3072 lds
    ds_read_b128 v[64:67], v9 offset:32768
    s_waitcnt lgkmcnt(3)
    v_mfma_f32_16x16x32_bf16 v[28:31], v[104:107], a[164:167], v[28:31]
    v_fma_f32 v151, v151, s52, v79
    v_add_f32 v144, s46, v144
    v_add_f32 v145, s46, v145
    v_mfma_f32_16x16x32_bf16 v[32:35], v[104:107], a[236:239], v[32:35]
    v_add_f32 v146, s46, v146
    v_add_f32 v147, s46, v147
    v_max3_f32 v5, v144, v145, v146
    s_add_u32 m0, s59, 8192
    s_add_u32 s47, s41, 8192
    buffer_load_dwordx4 v111, s[28:31], s47 offen offset:0 lds
    ds_read_b128 v[104:107], v9 offset:34816
    s_waitcnt lgkmcnt(3)
    v_mfma_f32_16x16x32_bf16 v[28:31], v[56:59], a[168:171], v[28:31]
    v_max3_f32 v5, v5, v147, v148
    v_max3_f32 v5, v5, v149, v150
    v_max_f32 v5, v5, v151
    v_mfma_f32_16x16x32_bf16 v[32:35], v[56:59], a[240:243], v[32:35]
    v_mov_b32 v6, v5
    s_nop 1
    v_permlane32_swap_b32 v5, v6
    s_mul_i32 s48, s36, 786432
    s_mul_i32 s18, s37, 6144
    s_add_u32 s48, s48, s18
    s_add_u32 s48, s48, 15728640
    buffer_load_dwordx4 v[80:83], v10, s[28:31], s48 offen offset:0
    s_waitcnt lgkmcnt(2)
    v_mfma_f32_16x16x32_bf16 v[28:31], v[60:63], a[172:175], v[28:31]
    v_max_f32 v5, v5, v6
    v_mov_b32 v6, v5
    v_mfma_f32_16x16x32_bf16 v[32:35], v[60:63], a[244:247], v[32:35]
    s_nop 0
    v_permlane16_swap_b32 v5, v6
    v_max_f32 v5, v5, v6
    v_sub_f32 v144, v144, v5
    buffer_load_dwordx4 v[84:87], v10, s[28:31], s48 offen offset:512
    s_waitcnt lgkmcnt(1)
    v_mfma_f32_16x16x32_bf16 v[28:31], v[64:67], a[176:179], v[28:31]
    v_sub_f32 v145, v145, v5
    v_sub_f32 v146, v146, v5
    v_sub_f32 v147, v147, v5
    v_mfma_f32_16x16x32_bf16 v[32:35], v[64:67], a[248:251], v[32:35]
    v_sub_f32 v148, v148, v5
    v_sub_f32 v149, v149, v5
    v_sub_f32 v150, v150, v5
    buffer_load_dwordx4 v[88:91], v10, s[28:31], s48 offen offset:1024
    s_waitcnt lgkmcnt(0)
    v_mfma_f32_16x16x32_bf16 v[28:31], v[104:107], a[180:183], v[28:31]
    v_sub_f32 v151, v151, v5
    v_exp_f32 v144, v144
    v_exp_f32 v145, v145
    v_mfma_f32_16x16x32_bf16 v[32:35], v[104:107], a[252:255], v[32:35]
    v_exp_f32 v146, v146
    v_exp_f32 v147, v147
    v_exp_f32 v148, v148
    v_exp_f32 v149, v149
    v_exp_f32 v150, v150
    v_exp_f32 v151, v151
    v_cvt_pk_bf16_f32 v68, v144, v145
    v_cvt_pk_bf16_f32 v69, v146, v147
    v_cvt_pk_bf16_f32 v70, v148, v149
    v_cvt_pk_bf16_f32 v71, v150, v151
    s_nop 1
    v_mfma_f32_16x16x32_bf16 v[16:19], v[116:119], v[68:71], 0
    s_mul_i32 s46, s57, 36864
    s_add_u32 s46, s46, 17301504
    s_nop 5
    v_rcp_f32 v6, v16
    v_mul_f32 v94, v97, v48
    v_fma_f32 v28, v28, v96, -v94
    v_mul_f32 v94, v99, v49
    v_fma_f32 v29, v29, v98, -v94
    v_mul_f32 v94, v101, v50
    v_fma_f32 v30, v30, v100, -v94
    v_mul_f32 v94, v103, v51
    v_fma_f32 v31, v31, v102, -v94
    v_cvt_pk_bf16_f32 v138, v28, v29
    v_cvt_pk_bf16_f32 v139, v30, v31
    v_mul_f32 v94, v97, v52
    v_fma_f32 v32, v32, v96, -v94
    v_mfma_f32_16x16x32_bf16 v[20:23], v[136:139], v[68:71], 0
    v_mul_f32 v94, v99, v53
    v_fma_f32 v33, v33, v98, -v94
    v_mul_f32 v94, v101, v54
    v_fma_f32 v34, v34, v100, -v94
    v_mul_f32 v94, v103, v55
    v_fma_f32 v35, v35, v102, -v94
    v_cvt_pk_bf16_f32 v142, v32, v33
    v_cvt_pk_bf16_f32 v143, v34, v35
    v_mov_b32 v136, v138
    v_mov_b32 v137, v139
    v_mfma_f32_16x16x32_bf16 v[24:27], v[140:143], v[68:71], 0
    v_mul_f32 v20, v6, v20
    v_mul_f32 v21, v6, v21
    v_mul_f32 v22, v6, v22
    v_mul_f32 v23, v6, v23
    v_cvt_pk_bf16_f32 v20, v20, v21
    v_cvt_pk_bf16_f32 v21, v22, v23
    buffer_store_dwordx2 v[20:21], v13, s[8:11], s46 offen
    v_mov_b32 v140, v142
    v_mov_b32 v141, v143
    v_mul_f32 v24, v6, v24
    v_mul_f32 v25, v6, v25
    v_cvt_pk_bf16_f32 v24, v24, v25
    s_mov_b64 exec, 0xffff
    buffer_store_dword v24, v14, s[8:11], s46 offen
    s_mov_b64 exec, -1
    s_mul_i32 s43, s57, 22528
    s_add_u32 s43, s43, s49
    s_cmp_lg_u32 s62, 0
    s_cbranch_scc1 Laqf_item
    buffer_load_dword v2, v1, s[8:11], s42 offen sc1
    s_waitcnt vmcnt(0)
    s_cmp_ge_u32 s37, 64
    s_cbranch_scc1 Laqf_fin
    v_cmp_eq_u32 vcc, 0, v2
    s_nop 0
    s_cbranch_vccnz Laqf_pub
    s_add_u32 m0, s59, 0
    s_add_u32 s47, s41, 0
    buffer_load_dwordx4 v111, s[8:11], s47 offen offset:0 lds
    buffer_load_dwordx4 v111, s[8:11], s47 offen offset:1024 lds
    buffer_load_dwordx4 v111, s[8:11], s47 offen offset:2048 lds
    buffer_load_dwordx4 v111, s[8:11], s47 offen offset:3072 lds
    s_add_u32 m0, s59, 4096
    s_add_u32 s47, s41, 4096
    buffer_load_dwordx4 v111, s[8:11], s47 offen offset:0 lds
    buffer_load_dwordx4 v111, s[8:11], s47 offen offset:1024 lds
    buffer_load_dwordx4 v111, s[8:11], s47 offen offset:2048 lds
    buffer_load_dwordx4 v111, s[8:11], s47 offen offset:3072 lds
    s_add_u32 m0, s59, 8192
    s_add_u32 s47, s41, 8192
    buffer_load_dwordx4 v111, s[8:11], s47 offen offset:0 lds
    s_mul_i32 s48, s36, 786432
    s_mul_i32 s18, s37, 6144
    s_add_u32 s48, s48, s18
    s_add_u32 s48, s48, 15728640
    buffer_load_dwordx4 v[80:83], v10, s[8:11], s48 offen offset:0
    buffer_load_dwordx4 v[84:87], v10, s[8:11], s48 offen offset:512
    buffer_load_dwordx4 v[88:91], v10, s[8:11], s48 offen offset:1024
    s_cmp_lg_u32 s43, 0
    s_cselect_b64 exec, 1, 0
    buffer_store_dword v3, v4, s[8:11], s43 offen
    s_mov_b64 exec, -1
    s_mov_b32 s43, 0
    s_waitcnt vmcnt(1)
    s_branch Laqf_go
Laqf_fin:
    s_cmp_lg_u32 s43, 0
    s_cselect_b64 exec, 1, 0
    buffer_store_dword v3, v4, s[8:11], s43 offen
    s_mov_b64 exec, -1
    s_mov_b32 s43, 0
    s_branch L_role_aq_exit
Laqf_pub:
    s_cmp_lg_u32 s43, 0
    s_cselect_b64 exec, 1, 0
    buffer_store_dword v3, v4, s[8:11], s43 offen
    s_mov_b64 exec, -1
    s_mov_b32 s43, 0
Laqf_poll:
    s_mov_b32 s16, 0
Laqf_pl:
    buffer_load_dword v2, v1, s[8:11], s42 offen sc1
    s_add_u32 s16, s16, 1
    s_cmp_gt_u32 s16, 100000
    s_cbranch_scc1 L_role_aq_abort
    s_waitcnt vmcnt(0)
    v_cmp_eq_u32 vcc, 0, v2
    s_nop 0
    s_cbranch_vccz Laqf_pld
    s_sleep 4
    s_branch Laqf_pl
Laqf_pld:
    s_add_u32 m0, s59, 0
    s_add_u32 s47, s41, 0
    buffer_load_dwordx4 v111, s[8:11], s47 offen offset:0 lds
    buffer_load_dwordx4 v111, s[8:11], s47 offen offset:1024 lds
    buffer_load_dwordx4 v111, s[8:11], s47 offen offset:2048 lds
    buffer_load_dwordx4 v111, s[8:11], s47 offen offset:3072 lds
    s_add_u32 m0, s59, 4096
    s_add_u32 s47, s41, 4096
    buffer_load_dwordx4 v111, s[8:11], s47 offen offset:0 lds
    buffer_load_dwordx4 v111, s[8:11], s47 offen offset:1024 lds
    buffer_load_dwordx4 v111, s[8:11], s47 offen offset:2048 lds
    buffer_load_dwordx4 v111, s[8:11], s47 offen offset:3072 lds
    s_add_u32 m0, s59, 8192
    s_add_u32 s47, s41, 8192
    buffer_load_dwordx4 v111, s[8:11], s47 offen offset:0 lds
    s_mul_i32 s48, s36, 786432
    s_mul_i32 s18, s37, 6144
    s_add_u32 s48, s48, s18
    s_add_u32 s48, s48, 15728640
    buffer_load_dwordx4 v[80:83], v10, s[8:11], s48 offen offset:0
    buffer_load_dwordx4 v[84:87], v10, s[8:11], s48 offen offset:512
    buffer_load_dwordx4 v[88:91], v10, s[8:11], s48 offen offset:1024
    s_waitcnt vmcnt(0)
    s_branch Laqf_go
Laq_slow:
    s_mov_b32 s36, s63
    s_mov_b32 s34, s63
    s_mov_b32 s37, 0
    s_lshl_b32 s56, s63, 6
    s_mul_i32 s58, s14, 9216
    s_mov_b32 s40, 36864
    s_mov_b32 s59, s58
    s_mov_b32 s43, 0
    s_mov_b32 s28, s8
    s_mov_b32 s29, s9
    s_mov_b32 s30, 0
    s_mov_b32 s31, 0x00020000
    s_mul_i32 s41, s63, 4718592
    s_add_u32 s41, s41, s58
    s_add_u32 s41, s41, 6291456
    s_mul_i32 s42, s56, 22528
    s_add_u32 s42, s42, 180224
    s_cmp_lg_u32 s14, 0
    s_cbranch_scc1 Laq_ini_d
    v_mov_b32 v5, 160
    s_mov_b32 s16, 0
Laq_ini:
    global_load_dword v6, v5, s[12:13] sc1
    s_add_u32 s16, s16, 1
    s_cmp_gt_u32 s16, 100000
    s_cbranch_scc1 L_role_aq_abort
    s_waitcnt vmcnt(0)
    v_cmp_gt_u32 vcc, 123, v6
    s_nop 0
    s_cbranch_vccz Laq_ini_d
    s_sleep 8
    s_branch Laq_ini
Laq_ini_d:
    s_barrier
    s_branch Laq_poll
Laq_item:
    s_waitcnt vmcnt(2)
Laq_go:
    s_barrier
    s_xor_b32 s40, s40, 36864
    s_xor_b32 s59, s59, 36864
    s_xor_b32 s66, s66, 0x2000
    s_xor_b32 s71, s71, 0x2000
    s_mov_b32 s35, s37
    s_mov_b32 s57, s56
    s_add_u32 s37, s37, 1
    s_add_u32 s56, s56, 1
    s_add_u32 s41, s41, 36864
    s_add_u32 s42, s42, 22528
    s_mov_b32 s62, 0
    v_lshlrev_b32 v9, 9, v8
    v_lshl_add_u32 v9, v7, 4, v9
    s_lshl_b32 s17, s51, 8
    s_add_u32 s17, s17, s40
    v_add_u32 v9, s17, v9
    ds_read_b128 v[56:59], v9 offset:0
    ds_read_b128 v[60:63], v9 offset:2048
    ds_read_b128 v[64:67], v9 offset:4096
    ds_read_b128 v[104:107], v9 offset:6144
    s_waitcnt lgkmcnt(3)
    v_mfma_f32_16x16x32_bf16 v[16:19], v[152:155], v[56:59], 0
    v_add_f32 v80, v80, v84
    v_mfma_f32_16x16x32_bf16 v[20:23], v[224:227], v[56:59], 0
    v_add_f32 v81, v81, v85
    v_mfma_f32_16x16x32_bf16 v[24:27], a[40:43], v[56:59], 0
    v_add_f32 v82, v82, v86
    ds_read_b128 v[56:59], v9 offset:8192
    s_waitcnt lgkmcnt(3)
    v_mfma_f32_16x16x32_bf16 v[16:19], v[156:159], v[60:63], v[16:19]
    v_add_f32 v83, v83, v87
    v_mfma_f32_16x16x32_bf16 v[20:23], v[228:231], v[60:63], v[20:23]
    v_add_f32 v80, v80, v88
    v_mfma_f32_16x16x32_bf16 v[24:27], a[44:47], v[60:63], v[24:27]
    v_add_f32 v81, v81, v89
    ds_read_b128 v[60:63], v9 offset:10240
    s_waitcnt lgkmcnt(3)
    v_mfma_f32_16x16x32_bf16 v[16:19], v[160:163], v[64:67], v[16:19]
    v_add_f32 v82, v82, v90
    v_mfma_f32_16x16x32_bf16 v[20:23], v[232:235], v[64:67], v[20:23]
    v_add_f32 v83, v83, v91
    v_mfma_f32_16x16x32_bf16 v[24:27], a[48:51], v[64:67], v[24:27]
    v_add_f32 v80, v80, v82
    ds_read_b128 v[64:67], v9 offset:12288
    s_waitcnt lgkmcnt(3)
    v_mfma_f32_16x16x32_bf16 v[16:19], v[164:167], v[104:107], v[16:19]
    v_add_f32 v81, v81, v83
    v_mfma_f32_16x16x32_bf16 v[20:23], v[236:239], v[104:107], v[20:23]
    v_mov_b32 v82, v80
    v_mfma_f32_16x16x32_bf16 v[24:27], a[52:55], v[104:107], v[24:27]
    v_mov_b32 v83, v81
    ds_read_b128 v[104:107], v9 offset:14336
    s_waitcnt lgkmcnt(3)
    v_mfma_f32_16x16x32_bf16 v[16:19], v[168:171], v[56:59], v[16:19]
    v_permlane32_swap_b32 v80, v82
    v_mfma_f32_16x16x32_bf16 v[20:23], v[240:243], v[56:59], v[20:23]
    v_permlane32_swap_b32 v81, v83
    v_mfma_f32_16x16x32_bf16 v[24:27], a[56:59], v[56:59], v[24:27]
    v_add_f32 v80, v80, v82
    ds_read_b128 v[56:59], v9 offset:16384
    s_waitcnt lgkmcnt(3)
    v_mfma_f32_16x16x32_bf16 v[16:19], v[172:175], v[60:63], v[16:19]
    v_add_f32 v81, v81, v83
    v_mfma_f32_16x16x32_bf16 v[20:23], v[244:247], v[60:63], v[20:23]
    v_mov_b32 v82, v80
    v_mfma_f32_16x16x32_bf16 v[24:27], a[60:63], v[60:63], v[24:27]
    v_mov_b32 v83, v81
    ds_read_b128 v[60:63], v9 offset:18432
    s_waitcnt lgkmcnt(3)
    v_mfma_f32_16x16x32_bf16 v[16:19], v[176:179], v[64:67], v[16:19]
    v_permlane16_swap_b32 v80, v82
    v_mfma_f32_16x16x32_bf16 v[20:23], v[248:251], v[64:67], v[20:23]
    v_permlane16_swap_b32 v81, v83
    v_mfma_f32_16x16x32_bf16 v[24:27], a[64:67], v[64:67], v[24:27]
    v_add_f32 v80, v80, v82
    ds_read_b128 v[64:67], v9 offset:20480
    s_waitcnt lgkmcnt(3)
    v_mfma_f32_16x16x32_bf16 v[16:19], v[180:183], v[104:107], v[16:19]
    v_add_f32 v81, v81, v83
    v_mfma_f32_16x16x32_bf16 v[20:23], v[252:255], v[104:107], v[20:23]
    v_mul_f32 v80, 0x3ae38e39, v80
    v_mfma_f32_16x16x32_bf16 v[24:27], a[68:71], v[104:107], v[24:27]
    v_mul_f32 v81, 0x3ae38e39, v81
    ds_read_b128 v[104:107], v9 offset:22528
    s_waitcnt lgkmcnt(3)
    v_mfma_f32_16x16x32_bf16 v[16:19], v[184:187], v[56:59], v[16:19]
    v_fma_f32 v81, -v80, v80, v81
    v_mfma_f32_16x16x32_bf16 v[20:23], a[0:3], v[56:59], v[20:23]
    v_max_f32 v81, 0, v81
    v_mfma_f32_16x16x32_bf16 v[24:27], a[72:75], v[56:59], v[24:27]
    v_add_f32 v81, 0x3727c5ac, v81
    ds_read_b128 v[56:59], v9 offset:24576
    s_waitcnt lgkmcnt(3)
    v_mfma_f32_16x16x32_bf16 v[16:19], v[188:191], v[60:63], v[16:19]
    v_rsq_f32 v92, v81
    v_mfma_f32_16x16x32_bf16 v[20:23], a[4:7], v[60:63], v[20:23]
    v_mul_f32 v93, v80, v92
    v_mfma_f32_16x16x32_bf16 v[24:27], a[76:79], v[60:63], v[24:27]
    ds_write_b64 v11, v[92:93]
    ds_read_b128 v[60:63], v9 offset:26624
    s_waitcnt lgkmcnt(4)
    v_mfma_f32_16x16x32_bf16 v[16:19], v[192:195], v[64:67], v[16:19]
    ds_read_b128 v[96:99], v12
    v_mfma_f32_16x16x32_bf16 v[20:23], a[8:11], v[64:67], v[20:23]
    ds_read_b128 v[100:103], v12 offset:16
    v_mfma_f32_16x16x32_bf16 v[24:27], a[80:83], v[64:67], v[24:27]
    s_waitcnt vmcnt(0)
    buffer_load_dword v2, v1, s[8:11], s42 offen sc1
    s_cmp_lg_u32 s43, 0
    s_cselect_b64 exec, 1, 0
    buffer_store_dword v3, v4, s[8:11], s43 offen sc1
    s_mov_b64 exec, -1
    s_mov_b32 s43, 0
    ds_read_b128 v[64:67], v9 offset:28672
    s_waitcnt lgkmcnt(6)
    v_mfma_f32_16x16x32_bf16 v[16:19], v[196:199], v[104:107], v[16:19]
    v_mfma_f32_16x16x32_bf16 v[20:23], a[12:15], v[104:107], v[20:23]
    v_mfma_f32_16x16x32_bf16 v[24:27], a[84:87], v[104:107], v[24:27]
    ds_read_b128 v[104:107], v9 offset:30720
    s_waitcnt lgkmcnt(6)
    v_mfma_f32_16x16x32_bf16 v[16:19], v[200:203], v[56:59], v[16:19]
    v_mfma_f32_16x16x32_bf16 v[20:23], a[16:19], v[56:59], v[20:23]
    v_mfma_f32_16x16x32_bf16 v[24:27], a[88:91], v[56:59], v[24:27]
    ds_read_b128 v[56:59], v9 offset:32768
    s_waitcnt lgkmcnt(5)
    v_mfma_f32_16x16x32_bf16 v[16:19], v[204:207], v[60:63], v[16:19]
    v_mfma_f32_16x16x32_bf16 v[20:23], a[20:23], v[60:63], v[20:23]
    v_mfma_f32_16x16x32_bf16 v[24:27], a[92:95], v[60:63], v[24:27]
    ds_read_b128 v[60:63], v9 offset:34816
    s_waitcnt lgkmcnt(3)
    v_mfma_f32_16x16x32_bf16 v[16:19], v[208:211], v[64:67], v[16:19]
    v_mfma_f32_16x16x32_bf16 v[20:23], a[24:27], v[64:67], v[20:23]
    v_mfma_f32_16x16x32_bf16 v[24:27], a[96:99], v[64:67], v[24:27]
    ds_read_b128 v[64:67], v9 offset:0
    s_waitcnt lgkmcnt(3)
    v_mfma_f32_16x16x32_bf16 v[16:19], v[212:215], v[104:107], v[16:19]
    v_mfma_f32_16x16x32_bf16 v[20:23], a[28:31], v[104:107], v[20:23]
    v_mfma_f32_16x16x32_bf16 v[24:27], a[100:103], v[104:107], v[24:27]
    ds_read_b128 v[104:107], v9 offset:2048
    s_waitcnt lgkmcnt(3)
    v_mfma_f32_16x16x32_bf16 v[16:19], v[216:219], v[56:59], v[16:19]
    v_mfma_f32_16x16x32_bf16 v[20:23], a[32:35], v[56:59], v[20:23]
    v_mfma_f32_16x16x32_bf16 v[24:27], a[104:107], v[56:59], v[24:27]
    ds_read_b128 v[56:59], v9 offset:4096
    s_waitcnt lgkmcnt(3)
    v_mfma_f32_16x16x32_bf16 v[16:19], v[220:223], v[60:63], v[16:19]
    v_mfma_f32_16x16x32_bf16 v[20:23], a[36:39], v[60:63], v[20:23]
    v_mfma_f32_16x16x32_bf16 v[24:27], a[108:111], v[60:63], v[24:27]
    ds_read_b128 v[60:63], v9 offset:6144
    s_waitcnt lgkmcnt(3)
    v_mfma_f32_16x16x32_bf16 v[28:31], v[64:67], a[112:115], 0
    v_mfma_f32_16x16x32_bf16 v[32:35], v[64:67], a[184:187], 0
    ds_read_b128 v[64:67], v9 offset:8192
    s_waitcnt lgkmcnt(3)
    v_mfma_f32_16x16x32_bf16 v[28:31], v[104:107], a[116:119], v[28:31]
    v_mul_f32 v94, v93, v36
    v_fma_f32 v16, v16, v92, -v94
    v_mfma_f32_16x16x32_bf16 v[32:35], v[104:107], a[188:191], v[32:35]
    v_mul_f32 v94, v93, v37
    v_fma_f32 v17, v17, v92, -v94
    ds_read_b128 v[104:107], v9 offset:10240
    s_waitcnt lgkmcnt(3)
    v_mfma_f32_16x16x32_bf16 v[28:31], v[56:59], a[120:123], v[28:31]
    v_mul_f32 v94, v93, v38
    v_fma_f32 v18, v18, v92, -v94
    v_mfma_f32_16x16x32_bf16 v[32:35], v[56:59], a[192:195], v[32:35]
    v_mul_f32 v94, v93, v39
    v_fma_f32 v19, v19, v92, -v94
    ds_read_b128 v[56:59], v9 offset:12288
    s_waitcnt lgkmcnt(3)
    v_mfma_f32_16x16x32_bf16 v[28:31], v[60:63], a[124:127], v[28:31]
    v_mul_f32 v94, v93, v44
    v_fma_f32 v24, v24, v92, -v94
    v_mfma_f32_16x16x32_bf16 v[32:35], v[60:63], a[196:199], v[32:35]
    v_mul_f32 v94, v93, v45
    v_fma_f32 v25, v25, v92, -v94
    ds_read_b128 v[60:63], v9 offset:14336
    s_waitcnt lgkmcnt(3)
    v_mfma_f32_16x16x32_bf16 v[28:31], v[64:67], a[128:131], v[28:31]
    v_mul_f32 v94, v93, v46
    v_fma_f32 v26, v26, v92, -v94
    v_mfma_f32_16x16x32_bf16 v[32:35], v[64:67], a[200:203], v[32:35]
    v_mul_f32 v94, v93, v47
    v_fma_f32 v27, v27, v92, -v94
    s_waitcnt vmcnt(1)
    v_cmp_eq_u32 vcc, 0, v2
    s_nop 0
    s_cmp_eq_u64 vcc, 0
    s_cselect_b32 s62, 1, 0
    s_cmp_lt_u32 s37, 64
    s_cselect_b32 s62, s62, 0
    s_cmp_lg_u32 s62, 0
    s_cselect_b32 s30, 268435456, 0
    ds_read_b128 v[64:67], v9 offset:16384
    s_waitcnt lgkmcnt(3)
    v_mfma_f32_16x16x32_bf16 v[28:31], v[104:107], a[132:135], v[28:31]
    v_mul_f32 v94, v93, v40
    v_fma_f32 v20, v20, v92, -v94
    v_mfma_f32_16x16x32_bf16 v[32:35], v[104:107], a[204:207], v[32:35]
    v_mul_f32 v94, v93, v41
    v_fma_f32 v21, v21, v92, -v94
    s_add_u32 m0, s59, 0
    s_add_u32 s47, s41, 0
    buffer_load_dwordx4 v111, s[28:31], s47 offen offset:0 lds
    ds_read_b128 v[104:107], v9 offset:18432
    s_waitcnt lgkmcnt(3)
    v_mfma_f32_16x16x32_bf16 v[28:31], v[56:59], a[136:139], v[28:31]
    v_mul_f32 v94, v93, v42
    v_fma_f32 v22, v22, v92, -v94
    v_mfma_f32_16x16x32_bf16 v[32:35], v[56:59], a[208:211], v[32:35]
    v_mul_f32 v94, v93, v43
    v_fma_f32 v23, v23, v92, -v94
    buffer_load_dwordx4 v111, s[28:31], s47 offen offset:1024 lds
    ds_read_b128 v[56:59], v9 offset:20480
    s_waitcnt lgkmcnt(3)
    v_mfma_f32_16x16x32_bf16 v[28:31], v[60:63], a[140:143], v[28:31]
    v_cvt_pk_bf16_f32 v128, v16, v17
    v_cvt_pk_bf16_f32 v129, v18, v19
    v_mfma_f32_16x16x32_bf16 v[32:35], v[60:63], a[212:215], v[32:35]
    v_cvt_pk_bf16_f32 v130, v24, v25
    v_cvt_pk_bf16_f32 v132, v20, v21
    buffer_load_dwordx4 v111, s[28:31], s47 offen offset:2048 lds
    ds_read_b128 v[60:63], v9 offset:22528
    s_waitcnt lgkmcnt(3)
    v_mfma_f32_16x16x32_bf16 v[28:31], v[64:67], a[144:147], v[28:31]
    v_cvt_pk_bf16_f32 v133, v22, v23
    v_cvt_pk_bf16_f32 v134, v26, v27
    v_mfma_f32_16x16x32_bf16 v[32:35], v[64:67], a[216:219], v[32:35]
    s_cmp_eq_u32 s35, 0
    s_cselect_b32 s46, 0xf149f2ca, 0
    buffer_load_dwordx4 v111, s[28:31], s47 offen offset:3072 lds
    ds_read_b128 v[64:67], v9 offset:24576
    s_waitcnt lgkmcnt(3)
    v_mfma_f32_16x16x32_bf16 v[28:31], v[104:107], a[148:151], v[28:31]
    v_mfma_f32_16x16x32_bf16 v[144:147], v[112:115], v[128:131], 0
    v_mfma_f32_16x16x32_bf16 v[32:35], v[104:107], a[220:223], v[32:35]
    v_mfma_f32_16x16x32_bf16 v[148:151], v[132:135], v[128:131], 0
    s_add_u32 m0, s59, 4096
    s_add_u32 s47, s41, 4096
    buffer_load_dwordx4 v111, s[28:31], s47 offen offset:0 lds
    ds_read_b128 v[104:107], v9 offset:26624
    s_waitcnt lgkmcnt(3)
    v_mfma_f32_16x16x32_bf16 v[28:31], v[56:59], a[152:155], v[28:31]
    v_mov_b32 v112, v132
    v_mfma_f32_16x16x32_bf16 v[32:35], v[56:59], a[224:227], v[32:35]
    v_mov_b32 v113, v133
    v_mov_b32 v114, v134
    buffer_load_dwordx4 v111, s[28:31], s47 offen offset:1024 lds
    ds_read_b128 v[56:59], v9 offset:28672
    s_waitcnt lgkmcnt(3)
    v_mfma_f32_16x16x32_bf16 v[28:31], v[60:63], a[156:159], v[28:31]
    v_mfma_f32_16x16x32_bf16 v[32:35], v[60:63], a[228:231], v[32:35]
    v_fma_f32 v144, v144, s52, v72
    buffer_load_dwordx4 v111, s[28:31], s47 offen offset:2048 lds
    ds_read_b128 v[60:63], v9 offset:30720
    s_waitcnt lgkmcnt(3)
    v_mfma_f32_16x16x32_bf16 v[28:31], v[64:67], a[160:163], v[28:31]
    v_fma_f32 v145, v145, s52, v73
    v_fma_f32 v146, v146, s52, v74
    v_fma_f32 v147, v147, s52, v75
    v_mfma_f32_16x16x32_bf16 v[32:35], v[64:67], a[232:235], v[32:35]
    v_fma_f32 v148, v148, s52, v76
    v_fma_f32 v149, v149, s52, v77
    v_fma_f32 v150, v150, s52, v78
    buffer_load_dwordx4 v111, s[28:31], s47 offen offset:3072 lds
    ds_read_b128 v[64:67], v9 offset:32768
    s_waitcnt lgkmcnt(3)
    v_mfma_f32_16x16x32_bf16 v[28:31], v[104:107], a[164:167], v[28:31]
    v_fma_f32 v151, v151, s52, v79
    v_add_f32 v144, s46, v144
    v_add_f32 v145, s46, v145
    v_mfma_f32_16x16x32_bf16 v[32:35], v[104:107], a[236:239], v[32:35]
    v_add_f32 v146, s46, v146
    v_add_f32 v147, s46, v147
    v_max3_f32 v5, v144, v145, v146
    s_add_u32 m0, s59, 8192
    s_add_u32 s47, s41, 8192
    buffer_load_dwordx4 v111, s[28:31], s47 offen offset:0 lds
    ds_read_b128 v[104:107], v9 offset:34816
    s_waitcnt lgkmcnt(3)
    v_mfma_f32_16x16x32_bf16 v[28:31], v[56:59], a[168:171], v[28:31]
    v_max3_f32 v5, v5, v147, v148
    v_max3_f32 v5, v5, v149, v150
    v_max_f32 v5, v5, v151
    v_mfma_f32_16x16x32_bf16 v[32:35], v[56:59], a[240:243], v[32:35]
    v_mov_b32 v6, v5
    s_nop 1
    v_permlane32_swap_b32 v5, v6
    s_mul_i32 s48, s36, 786432
    s_mul_i32 s18, s37, 6144
    s_add_u32 s48, s48, s18
    s_add_u32 s48, s48, 15728640
    buffer_load_dwordx4 v[80:83], v10, s[28:31], s48 offen offset:0
    s_waitcnt lgkmcnt(2)
    v_mfma_f32_16x16x32_bf16 v[28:31], v[60:63], a[172:175], v[28:31]
    v_max_f32 v5, v5, v6
    v_mov_b32 v6, v5
    v_mfma_f32_16x16x32_bf16 v[32:35], v[60:63], a[244:247], v[32:35]
    s_nop 0
    v_permlane16_swap_b32 v5, v6
    v_max_f32 v5, v5, v6
    v_sub_f32 v144, v144, v5
    buffer_load_dwordx4 v[84:87], v10, s[28:31], s48 offen offset:512
    s_waitcnt lgkmcnt(1)
    v_mfma_f32_16x16x32_bf16 v[28:31], v[64:67], a[176:179], v[28:31]
    v_sub_f32 v145, v145, v5
    v_sub_f32 v146, v146, v5
    v_sub_f32 v147, v147, v5
    v_mfma_f32_16x16x32_bf16 v[32:35], v[64:67], a[248:251], v[32:35]
    v_sub_f32 v148, v148, v5
    v_sub_f32 v149, v149, v5
    v_sub_f32 v150, v150, v5
    buffer_load_dwordx4 v[88:91], v10, s[28:31], s48 offen offset:1024
    s_waitcnt lgkmcnt(0)
    v_mfma_f32_16x16x32_bf16 v[28:31], v[104:107], a[180:183], v[28:31]
    v_sub_f32 v151, v151, v5
    v_exp_f32 v144, v144
    v_exp_f32 v145, v145
    v_mfma_f32_16x16x32_bf16 v[32:35], v[104:107], a[252:255], v[32:35]
    v_exp_f32 v146, v146
    v_exp_f32 v147, v147
    v_exp_f32 v148, v148
    v_exp_f32 v149, v149
    v_exp_f32 v150, v150
    v_exp_f32 v151, v151
    v_cvt_pk_bf16_f32 v68, v144, v145
    v_cvt_pk_bf16_f32 v69, v146, v147
    v_cvt_pk_bf16_f32 v70, v148, v149
    v_cvt_pk_bf16_f32 v71, v150, v151
    s_nop 1
    v_mfma_f32_16x16x32_bf16 v[16:19], v[116:119], v[68:71], 0
    s_mul_i32 s46, s57, 36864
    s_add_u32 s46, s46, 17301504
    s_nop 5
    v_rcp_f32 v6, v16
    v_mul_f32 v94, v97, v48
    v_fma_f32 v28, v28, v96, -v94
    v_mul_f32 v94, v99, v49
    v_fma_f32 v29, v29, v98, -v94
    v_mul_f32 v94, v101, v50
    v_fma_f32 v30, v30, v100, -v94
    v_mul_f32 v94, v103, v51
    v_fma_f32 v31, v31, v102, -v94
    v_cvt_pk_bf16_f32 v138, v28, v29
    v_cvt_pk_bf16_f32 v139, v30, v31
    v_mul_f32 v94, v97, v52
    v_fma_f32 v32, v32, v96, -v94
    v_mfma_f32_16x16x32_bf16 v[20:23], v[136:139], v[68:71], 0
    v_mul_f32 v94, v99, v53
    v_fma_f32 v33, v33, v98, -v94
    v_mul_f32 v94, v101, v54
    v_fma_f32 v34, v34, v100, -v94
    v_mul_f32 v94, v103, v55
    v_fma_f32 v35, v35, v102, -v94
    v_cvt_pk_bf16_f32 v142, v32, v33
    v_cvt_pk_bf16_f32 v143, v34, v35
    v_mov_b32 v136, v138
    v_mov_b32 v137, v139
    v_mfma_f32_16x16x32_bf16 v[24:27], v[140:143], v[68:71], 0
    v_mul_f32 v20, v6, v20
    v_mul_f32 v21, v6, v21
    v_mul_f32 v22, v6, v22
    v_mul_f32 v23, v6, v23
    v_cvt_pk_bf16_f32 v20, v20, v21
    v_cvt_pk_bf16_f32 v21, v22, v23
    buffer_store_dwordx2 v[20:21], v13, s[8:11], s46 offen sc1
    v_mov_b32 v140, v142
    v_mov_b32 v141, v143
    v_mul_f32 v24, v6, v24
    v_mul_f32 v25, v6, v25
    v_cvt_pk_bf16_f32 v24, v24, v25
    s_mov_b64 exec, 0xffff
    buffer_store_dword v24, v14, s[8:11], s46 offen sc1
    s_mov_b64 exec, -1
    s_mul_i32 s43, s57, 22528
    s_add_u32 s43, s43, s49
    s_cmp_lg_u32 s62, 0
    s_cbranch_scc1 Laq_item
    buffer_load_dword v2, v1, s[8:11], s42 offen sc1
    s_waitcnt vmcnt(0)
    s_cmp_ge_u32 s37, 64
    s_cbranch_scc1 Laq_fin
    v_cmp_eq_u32 vcc, 0, v2
    s_nop 0
    s_cbranch_vccnz Laq_pub
    s_add_u32 m0, s59, 0
    s_add_u32 s47, s41, 0
    buffer_load_dwordx4 v111, s[8:11], s47 offen offset:0 lds
    buffer_load_dwordx4 v111, s[8:11], s47 offen offset:1024 lds
    buffer_load_dwordx4 v111, s[8:11], s47 offen offset:2048 lds
    buffer_load_dwordx4 v111, s[8:11], s47 offen offset:3072 lds
    s_add_u32 m0, s59, 4096
    s_add_u32 s47, s41, 4096
    buffer_load_dwordx4 v111, s[8:11], s47 offen offset:0 lds
    buffer_load_dwordx4 v111, s[8:11], s47 offen offset:1024 lds
    buffer_load_dwordx4 v111, s[8:11], s47 offen offset:2048 lds
    buffer_load_dwordx4 v111, s[8:11], s47 offen offset:3072 lds
    s_add_u32 m0, s59, 8192
    s_add_u32 s47, s41, 8192
    buffer_load_dwordx4 v111, s[8:11], s47 offen offset:0 lds
    s_mul_i32 s48, s36, 786432
    s_mul_i32 s18, s37, 6144
    s_add_u32 s48, s48, s18
    s_add_u32 s48, s48, 15728640
    buffer_load_dwordx4 v[80:83], v10, s[8:11], s48 offen offset:0
    buffer_load_dwordx4 v[84:87], v10, s[8:11], s48 offen offset:512
    buffer_load_dwordx4 v[88:91], v10, s[8:11], s48 offen offset:1024
    s_cmp_lg_u32 s43, 0
    s_cselect_b64 exec, 1, 0
    buffer_store_dword v3, v4, s[8:11], s43 offen sc1
    s_mov_b64 exec, -1
    s_mov_b32 s43, 0
    s_waitcnt vmcnt(1)
    s_branch Laq_go
Laq_fin:
    s_cmp_lg_u32 s43, 0
    s_cselect_b64 exec, 1, 0
    buffer_store_dword v3, v4, s[8:11], s43 offen sc1
    s_mov_b64 exec, -1
    s_mov_b32 s43, 0
    s_branch L_role_aq_exit
Laq_pub:
    s_cmp_lg_u32 s43, 0
    s_cselect_b64 exec, 1, 0
    buffer_store_dword v3, v4, s[8:11], s43 offen sc1
    s_mov_b64 exec, -1
    s_mov_b32 s43, 0
Laq_poll:
    s_mov_b32 s16, 0
Laq_pl:
    buffer_load_dword v2, v1, s[8:11], s42 offen sc1
    s_add_u32 s16, s16, 1
    s_cmp_gt_u32 s16, 100000
    s_cbranch_scc1 L_role_aq_abort
    s_waitcnt vmcnt(0)
    v_cmp_eq_u32 vcc, 0, v2
    s_nop 0
    s_cbranch_vccz Laq_pld
    s_sleep 4
    s_branch Laq_pl
Laq_pld:
    s_add_u32 m0, s59, 0
    s_add_u32 s47, s41, 0
    buffer_load_dwordx4 v111, s[8:11], s47 offen offset:0 lds
    buffer_load_dwordx4 v111, s[8:11], s47 offen offset:1024 lds
    buffer_load_dwordx4 v111, s[8:11], s47 offen offset:2048 lds
    buffer_load_dwordx4 v111, s[8:11], s47 offen offset:3072 lds
    s_add_u32 m0, s59, 4096
    s_add_u32 s47, s41, 4096
    buffer_load_dwordx4 v111, s[8:11], s47 offen offset:0 lds
    buffer_load_dwordx4 v111, s[8:11], s47 offen offset:1024 lds
    buffer_load_dwordx4 v111, s[8:11], s47 offen offset:2048 lds
    buffer_load_dwordx4 v111, s[8:11], s47 offen offset:3072 lds
    s_add_u32 m0, s59, 8192
    s_add_u32 s47, s41, 8192
    buffer_load_dwordx4 v111, s[8:11], s47 offen offset:0 lds
    s_mul_i32 s48, s36, 786432
    s_mul_i32 s18, s37, 6144
    s_add_u32 s48, s48, s18
    s_add_u32 s48, s48, 15728640
    buffer_load_dwordx4 v[80:83], v10, s[8:11], s48 offen offset:0
    buffer_load_dwordx4 v[84:87], v10, s[8:11], s48 offen offset:512
    buffer_load_dwordx4 v[88:91], v10, s[8:11], s48 offen offset:1024
    s_waitcnt vmcnt(0)
    s_branch Laq_go
L_role_aq_abort:
    s_waitcnt lgkmcnt(0)
    s_mov_b64 exec, -1
    v_mov_b32 v0, 60
    s_lshl_b32 s5, s3, 8
    s_or_b32 s5, s5, s4
    s_or_b32 s5, s5, 0x10000
    v_mov_b32 v1, s5
    global_store_dword v0, v1, s[12:13]
    s_endpgm
L_role_aq_exit:
    s_endpgm
.p2align 6
L_role_ta:
    v_and_b32 v5, 63, v0
    v_lshlrev_b32 v0, 4, v5
    v_and_b32 v7, 15, v5
    v_lshrrev_b32 v8, 4, v5
    v_min_u32 v1, 11, v5
    v_lshrrev_b32 v6, 2, v1
    v_and_b32 v1, 3, v1
    v_lshlrev_b32 v1, 2, v1
    v_lshl_add_u32 v1, v6, 7, v1
    v_mov_b32 v3, 1
    v_mov_b32 v4, 0
    s_mov_b32 s44, 0x05040100
    s_mov_b32 s45, 0x07060302
    s_lshl_b32 s17, s15, 2
    s_add_u32 s17, s17, s14
    s_lshr_b32 s36, s17, 5
    s_and_b32 s50, s17, 31
    s_mov_b32 s37, 0
    s_mov_b32 s52, 0x3e0293ee
    v_lshrrev_b32 v5, 2, v7
    v_and_b32 v6, 1, v7
    v_lshl_add_u32 v5, v5, 1, v6
    v_lshlrev_b32 v9, 8, v5
    v_lshl_add_u32 v9, v8, 4, v9
    v_lshrrev_b32 v10, 1, v0
    v_mov_b32 v6, 0xf149f2ca
    v_mov_b32 v21, 0
    v_mov_b32 v22, 0
    s_mul_i32 s42, s36, 1441792
    s_lshl_b32 s17, s50, 9
    s_add_u32 s42, s42, s17
    s_add_u32 s42, s42, 185600
    s_mul_i32 s51, s36, 50331648
    s_lshl_b32 s17, s50, 13
    s_add_u32 s51, s51, s17
    s_add_u32 s51, s51, 44040192
    s_lshl_b32 s47, s36, 11
    s_add_u32 s47, s47, s50
    s_lshl_b32 s48, s47, 13
    s_add_u32 s48, s48, 144703488
    s_mul_i32 s35, s36, 256
    s_add_u32 s35, s35, s50
    s_lshl_b32 s35, s35, 12
    s_add_u32 s35, s35, 27262976
    s_mul_i32 s43, s36, 1441792
    s_lshr_b32 s17, s50, 2
    s_lshl_b32 s17, s17, 7
    s_add_u32 s43, s43, s17
    s_lshl_b32 s17, s14, 2
    s_add_u32 s43, s43, s17
    s_add_u32 s43, s43, 184448
    s_mov_b32 s28, s8
    s_mov_b32 s29, s9
    s_mov_b32 s30, 0
    s_mov_b32 s31, 0x00020000
    s_mov_b32 s39, 0
    s_mov_b32 s49, 0
    s_lshl_b32 s47, s36, 2
    s_add_u32 s47, s47, 192
    v_mov_b32 v16, 0x3f803f80
    v_lshl_add_u32 v5, v8, 2, 0
    v_cmp_le_u32 vcc, v5, v7
    s_nop 1
    v_cndmask_b32 v236, v6, v4, vcc
    v_mov_b32 v17, 0x3f803f80
    v_lshl_add_u32 v5, v8, 2, 1
    v_cmp_le_u32 vcc, v5, v7
    s_nop 1
    v_cndmask_b32 v237, v6, v4, vcc
    v_mov_b32 v18, 0x3f803f80
    v_lshl_add_u32 v5, v8, 2, 2
    v_cmp_le_u32 vcc, v5, v7
    s_nop 1
    v_cndmask_b32 v238, v6, v4, vcc
    v_mov_b32 v19, 0x3f803f80
    v_lshl_add_u32 v5, v8, 2, 3
    v_cmp_le_u32 vcc, v5, v7
    s_nop 1
    v_cndmask_b32 v239, v6, v4, vcc
    s_cmp_lg_u32 s14, 0
    s_cbranch_scc1 Lta_ini_d
    v_mov_b32 v5, 160
    s_mov_b32 s16, 0
Lta_ini:
    global_load_dword v6, v5, s[12:13] sc1
    s_add_u32 s16, s16, 1
    s_cmp_gt_u32 s16, 100000
    s_cbranch_scc1 L_role_ta_abort
    s_waitcnt vmcnt(0)
    v_cmp_gt_u32 vcc, 123, v6
    s_nop 0
    s_cbranch_vccz Lta_ini_d
    s_sleep 64
    s_branch Lta_ini
Lta_ini_d:
    s_barrier
    s_cmp_lg_u32 s14, 0
    s_cbranch_scc1 Lta_team_d
    v_mov_b32 v5, s47
    s_mov_b32 s16, 0
Lta_team:
    global_load_dword v6, v5, s[12:13] sc1
    s_add_u32 s16, s16, 1
    s_cmp_gt_u32 s16, 100000
    s_cbranch_scc1 L_role_ta_abort
    s_waitcnt vmcnt(0)
    v_cmp_gt_u32 vcc, 32, v6
    s_nop 0
    s_cbranch_vccz Lta_team_d
    s_sleep 64
    s_branch Lta_team
Lta_team_d:
    s_barrier
    v_mbcnt_lo_u32_b32 v5, -1, 0
    v_mbcnt_hi_u32_b32 v5, -1, v5
    v_and_b32 v6, 1, v5
    v_lshlrev_b32 v6, 7, v6
    v_lshlrev_b32 v5, 1, v5
    v_and_or_b32 v5, v5, 12, v6
    s_mov_b32 s16, 0
Lta_pure:
    global_load_dword v6, v5, s[12:13] sc1
    s_add_u32 s16, s16, 1
    s_cmp_gt_u32 s16, 100000
    s_cbranch_scc1 L_role_ta_abort
    s_mov_b32 s6, 0
    s_waitcnt vmcnt(0)
    v_readlane_b32 s7, v6, 0
    s_nop 0
    s_add_u32 s6, s6, s7
    v_readlane_b32 s7, v6, 1
    s_nop 0
    s_add_u32 s6, s6, s7
    v_readlane_b32 s7, v6, 2
    s_nop 0
    s_add_u32 s6, s6, s7
    v_readlane_b32 s7, v6, 3
    s_nop 0
    s_add_u32 s6, s6, s7
    v_readlane_b32 s7, v6, 4
    s_nop 0
    s_add_u32 s6, s6, s7
    v_readlane_b32 s7, v6, 5
    s_nop 0
    s_add_u32 s6, s6, s7
    v_readlane_b32 s7, v6, 6
    s_nop 0
    s_add_u32 s6, s6, s7
    v_readlane_b32 s7, v6, 7
    s_nop 0
    s_add_u32 s6, s6, s7
    v_readlane_b32 s7, v6, s3
    s_nop 0
    s_cmp_ge_u32 s7, 32
    s_cselect_b32 s61, 1, 0
    s_cselect_b32 s6, 256, s6
    s_cmp_lt_u32 s6, 256
    s_cbranch_scc1 Lta_pure
    s_cmp_lg_u32 s36, 0
    s_cselect_b32 s61, 0, s61
    s_cmp_eq_u32 s61, 0
    s_cbranch_scc1 LtaS0
LtaF0:
    s_and_b32 s17, s37, 7
    s_mul_i32 s17, s17, 131072
    s_add_u32 s47, s35, s17
    s_bfe_u32 s34, s37, 65539
    s_cmp_eq_u32 s39, 1
    s_cbranch_scc1 LtaF0_have
    s_waitcnt vmcnt(0)
    s_cmp_lg_u32 s49, 0
    s_cselect_b64 exec, 1, 0
    buffer_store_dword v3, v4, s[8:11], s43 offen
    s_mov_b64 exec, -1
    s_add_u32 s43, s43, s49
    s_mov_b32 s49, 0
    s_mov_b32 s16, 0
LtaF0_f_1:
    buffer_load_dword v2, v1, s[8:11], s42 offen sc1
    s_add_u32 s16, s16, 1
    s_cmp_gt_u32 s16, 100000
    s_cbranch_scc1 L_role_ta_abort
    s_waitcnt vmcnt(0)
    v_cmp_eq_u32 vcc, 0, v2
    s_nop 0
    s_cbranch_vccz LtaF0_fd_2
    s_sleep 4
    s_branch LtaF0_f_1
LtaF0_fd_2:
    s_add_u32 s46, s51, 0
    buffer_load_dwordx4 v[140:143], v0, s[8:11], s46 offen offset:0
    buffer_load_dwordx4 v[144:147], v0, s[8:11], s46 offen offset:1024
    buffer_load_dwordx4 v[148:151], v0, s[8:11], s46 offen offset:2048
    buffer_load_dwordx4 v[152:155], v0, s[8:11], s46 offen offset:3072
    s_add_u32 s46, s51, 4096
    buffer_load_dwordx4 v[156:159], v0, s[8:11], s46 offen offset:0
    buffer_load_dwordx4 v[160:163], v0, s[8:11], s46 offen offset:1024
    buffer_load_dwordx4 v[164:167], v0, s[8:11], s46 offen offset:2048
    buffer_load_dwordx4 v[168:171], v0, s[8:11], s46 offen offset:3072
    s_add_u32 s46, s51, 16777216
    buffer_load_dwordx4 v[172:175], v0, s[8:11], s46 offen offset:0
    buffer_load_dwordx4 v[176:179], v0, s[8:11], s46 offen offset:1024
    buffer_load_dwordx4 v[180:183], v0, s[8:11], s46 offen offset:2048
    buffer_load_dwordx4 v[184:187], v0, s[8:11], s46 offen offset:3072
    s_add_u32 s46, s51, 16781312
    buffer_load_dwordx4 v[188:191], v0, s[8:11], s46 offen offset:0
    buffer_load_dwordx4 v[192:195], v0, s[8:11], s46 offen offset:1024
    buffer_load_dwordx4 v[196:199], v0, s[8:11], s46 offen offset:2048
    buffer_load_dwordx4 v[200:203], v0, s[8:11], s46 offen offset:3072
    s_add_u32 s46, s51, 33554432
    buffer_load_dwordx4 v[204:207], v0, s[8:11], s46 offen offset:0
    buffer_load_dwordx4 v[208:211], v0, s[8:11], s46 offen offset:1024
    buffer_load_dwordx4 v[212:215], v0, s[8:11], s46 offen offset:2048
    buffer_load_dwordx4 v[216:219], v0, s[8:11], s46 offen offset:3072
    s_add_u32 s46, s51, 33558528
    buffer_load_dwordx4 v[220:223], v0, s[8:11], s46 offen offset:0
    buffer_load_dwordx4 v[224:227], v0, s[8:11], s46 offen offset:1024
    buffer_load_dwordx4 v[228:231], v0, s[8:11], s46 offen offset:2048
    buffer_load_dwordx4 v[232:235], v0, s[8:11], s46 offen offset:3072
LtaF0_have:
    s_add_u32 s17, s42, 22528
    buffer_load_dword v15, v1, s[8:11], s17 offen sc1
    buffer_load_dwordx4 v[52:55], v9, s[8:11], s47 offen offset:0 sc1
    buffer_load_dwordx4 v[56:59], v9, s[8:11], s47 offen offset:64 sc1
    buffer_load_dwordx4 v[60:63], v9, s[8:11], s47 offen offset:128 sc1
    buffer_load_dwordx4 v[64:67], v9, s[8:11], s47 offen offset:192 sc1
    buffer_load_dwordx2 v[68:69], v10, s[8:11], s47 offen offset:2048 sc1
    buffer_load_dwordx2 v[70:71], v10, s[8:11], s47 offen offset:2560 sc1
    buffer_load_dwordx2 v[72:73], v10, s[8:11], s47 offen offset:3072 sc1
    buffer_load_dwordx2 v[74:75], v10, s[8:11], s47 offen offset:3584 sc1
    s_waitcnt vmcnt(9)
    s_cmp_lg_u32 s49, 0
    s_cselect_b64 exec, 1, 0
    buffer_store_dword v3, v4, s[8:11], s43 offen
    s_mov_b64 exec, -1
    s_add_u32 s43, s43, s49
    s_mov_b32 s49, 0
    v_mfma_f32_16x16x32_bf16 v[32:35], v[172:175], v[140:143], 0
    v_mfma_f32_16x16x32_bf16 v[36:39], v[172:175], v[144:147], 0
    v_mfma_f32_16x16x32_bf16 v[40:43], v[176:179], v[144:147], 0
    v_mfma_f32_16x16x32_bf16 v[32:35], v[180:183], v[148:151], v[32:35]
    v_mfma_f32_16x16x32_bf16 v[36:39], v[180:183], v[152:155], v[36:39]
    v_mfma_f32_16x16x32_bf16 v[40:43], v[184:187], v[152:155], v[40:43]
    v_mfma_f32_16x16x32_bf16 v[32:35], v[188:191], v[156:159], v[32:35]
    v_mfma_f32_16x16x32_bf16 v[36:39], v[188:191], v[160:163], v[36:39]
    v_mfma_f32_16x16x32_bf16 v[40:43], v[192:195], v[160:163], v[40:43]
    v_mfma_f32_16x16x32_bf16 v[32:35], v[196:199], v[164:167], v[32:35]
    v_mfma_f32_16x16x32_bf16 v[36:39], v[196:199], v[168:171], v[36:39]
    v_mfma_f32_16x16x32_bf16 v[40:43], v[200:203], v[168:171], v[40:43]
    s_waitcnt vmcnt(1)
    v_cmp_eq_u32 vcc, 0, v15
    s_add_u32 s51, s51, 262144
    s_add_u32 s42, s42, 22528
    s_add_u32 s37, s37, 1
    s_cmp_eq_u64 vcc, 0
    s_cselect_b32 s39, 1, 0
    s_cmp_lt_u32 s37, 64
    s_cselect_b32 s39, s39, 0
    s_cmp_eq_u32 s39, 1
    s_cselect_b32 s30, 268435456, 0
    v_fma_f32 v32, v32, s52, v236
    v_fma_f32 v33, v33, s52, v237
    v_fma_f32 v34, v34, s52, v238
    v_fma_f32 v35, v35, s52, v239
    v_mul_f32 v36, s52, v36
    v_mul_f32 v37, s52, v37
    v_mul_f32 v38, s52, v38
    v_mul_f32 v39, s52, v39
    v_fma_f32 v40, v40, s52, v236
    v_fma_f32 v41, v41, s52, v237
    v_fma_f32 v42, v42, s52, v238
    v_fma_f32 v43, v43, s52, v239
    v_xor_b32 v5, s34, v52
    v_xor_b32 v6, s34, v56
    v_or_b32 v5, v5, v6
    v_xor_b32 v6, s34, v60
    v_or_b32 v5, v5, v6
    v_xor_b32 v6, s34, v64
    v_or_b32 v5, v5, v6
    v_xor_b32 v6, s34, v68
    v_or_b32 v5, v5, v6
    v_xor_b32 v6, s34, v70
    v_or_b32 v5, v5, v6
    v_xor_b32 v6, s34, v72
    v_or_b32 v5, v5, v6
    v_xor_b32 v6, s34, v74
    v_or_b32 v5, v5, v6
    v_and_b32 v5, 1, v5
    v_cmp_ne_u32 vcc, 0, v5
    s_nop 0
    s_cbranch_vccz LtaF0_r
    s_mov_b32 s16, 0
LtaF0_rp:
    buffer_load_dwordx4 v[52:55], v9, s[8:11], s47 offen offset:0 sc1
    buffer_load_dwordx4 v[56:59], v9, s[8:11], s47 offen offset:64 sc1
    buffer_load_dwordx4 v[60:63], v9, s[8:11], s47 offen offset:128 sc1
    buffer_load_dwordx4 v[64:67], v9, s[8:11], s47 offen offset:192 sc1
    buffer_load_dwordx2 v[68:69], v10, s[8:11], s47 offen offset:2048 sc1
    buffer_load_dwordx2 v[70:71], v10, s[8:11], s47 offen offset:2560 sc1
    buffer_load_dwordx2 v[72:73], v10, s[8:11], s47 offen offset:3072 sc1
    buffer_load_dwordx2 v[74:75], v10, s[8:11], s47 offen offset:3584 sc1
    s_add_u32 s16, s16, 1
    s_cmp_gt_u32 s16, 100000
    s_cbranch_scc1 L_role_ta_abort
    s_waitcnt vmcnt(0)
    v_xor_b32 v5, s34, v52
    v_xor_b32 v6, s34, v56
    v_or_b32 v5, v5, v6
    v_xor_b32 v6, s34, v60
    v_or_b32 v5, v5, v6
    v_xor_b32 v6, s34, v64
    v_or_b32 v5, v5, v6
    v_xor_b32 v6, s34, v68
    v_or_b32 v5, v5, v6
    v_xor_b32 v6, s34, v70
    v_or_b32 v5, v5, v6
    v_xor_b32 v6, s34, v72
    v_or_b32 v5, v5, v6
    v_xor_b32 v6, s34, v74
    v_or_b32 v5, v5, v6
    v_and_b32 v5, 1, v5
    v_cmp_ne_u32 vcc, 0, v5
    s_nop 0
    s_cbranch_vccz LtaF0_r
    s_sleep 2
    s_branch LtaF0_rp
LtaF0_r:
    s_add_u32 s46, s51, 0
    buffer_load_dwordx4 a[0:3], v0, s[28:31], s46 offen offset:0
    buffer_load_dwordx4 a[4:7], v0, s[28:31], s46 offen offset:1024
    v_mfma_f32_16x16x32_bf16 v[44:47], v[52:55], v[140:143], 0
    v_mfma_f32_16x16x32_bf16 v[48:51], v[52:55], v[144:147], 0
    v_mfma_f32_16x16x32_bf16 v[44:47], v[56:59], v[148:151], v[44:47]
    v_mfma_f32_16x16x32_bf16 v[48:51], v[56:59], v[152:155], v[48:51]
    v_mfma_f32_16x16x32_bf16 v[44:47], v[60:63], v[156:159], v[44:47]
    v_mfma_f32_16x16x32_bf16 v[48:51], v[60:63], v[160:163], v[48:51]
    v_mfma_f32_16x16x32_bf16 v[44:47], v[64:67], v[164:167], v[44:47]
    v_mfma_f32_16x16x32_bf16 v[48:51], v[64:67], v[168:171], v[48:51]
    v_max3_f32 v5, v32, v33, v34
    v_max_f32 v5, v5, v35
    s_nop 4
    v_mul_f32 v44, s52, v44
    v_mul_f32 v45, s52, v45
    v_max3_f32 v5, v5, v44, v45
    v_mov_b32 v6, v5
    buffer_load_dwordx4 a[8:11], v0, s[28:31], s46 offen offset:2048
    s_nop 0
    v_permlane32_swap_b32 v5, v6
    v_max_f32 v5, v5, v6
    v_mov_b32 v6, v5
    buffer_load_dwordx4 a[12:15], v0, s[28:31], s46 offen offset:3072
    s_nop 0
    v_permlane16_swap_b32 v5, v6
    v_max_f32 v5, v5, v6
    v_sub_f32 v32, v32, v5
    v_sub_f32 v33, v33, v5
    v_sub_f32 v34, v34, v5
    v_sub_f32 v35, v35, v5
    v_sub_f32 v44, v44, v5
    v_sub_f32 v45, v45, v5
    v_exp_f32 v32, v32
    v_exp_f32 v33, v33
    v_exp_f32 v34, v34
    v_exp_f32 v35, v35
    v_exp_f32 v44, v44
    v_exp_f32 v45, v45
    v_cvt_pk_bf16_f32 v24, v32, v33
    v_cvt_pk_bf16_f32 v25, v34, v35
    v_mov_b32 v26, 0
    v_mov_b32 v27, 0
    v_cvt_pk_bf16_f32 v20, v44, v45
    v_cvt_pk_bf16_f32 v23, v44, v45
    v_mfma_f32_16x16x32_bf16 v[28:31], v[16:19], v[24:27], 0
    v_mfma_f32_16x16x32_bf16 v[76:79], v[204:207], v[24:27], 0
    v_mfma_f32_16x16x32_bf16 v[80:83], v[208:211], v[24:27], 0
    s_add_u32 s46, s51, 4096
    buffer_load_dwordx4 a[16:19], v0, s[28:31], s46 offen offset:0
    v_mfma_f32_16x16x32_bf16 v[84:87], v[212:215], v[24:27], 0
    v_mfma_f32_16x16x32_bf16 v[88:91], v[216:219], v[24:27], 0
    buffer_load_dwordx4 a[20:23], v0, s[28:31], s46 offen offset:1024
    v_mfma_f32_16x16x32_bf16 v[92:95], v[220:223], v[24:27], 0
    v_mfma_f32_16x16x32_bf16 v[96:99], v[224:227], v[24:27], 0
    buffer_load_dwordx4 a[24:27], v0, s[28:31], s46 offen offset:2048
    v_mfma_f32_16x16x16_bf16 v[28:31], v[16:17], v[20:21], v[28:31]
    v_mfma_f32_16x16x32_bf16 v[100:103], v[228:231], v[24:27], 0
    v_mfma_f32_16x16x32_bf16 v[104:107], v[232:235], v[24:27], 0
    buffer_load_dwordx4 a[28:31], v0, s[28:31], s46 offen offset:3072
    v_mfma_f32_16x16x16_bf16 v[76:79], v[68:69], v[20:21], v[76:79]
    v_mfma_f32_16x16x16_bf16 v[80:83], v[68:69], v[22:23], v[80:83]
    s_nop 2
    v_rcp_f32 v6, v28
    v_mfma_f32_16x16x16_bf16 v[84:87], v[70:71], v[20:21], v[84:87]
    v_mfma_f32_16x16x16_bf16 v[88:91], v[70:71], v[22:23], v[88:91]
    s_nop 0
    v_mul_f32 v76, v6, v76
    v_mul_f32 v80, v6, v80
    v_cvt_pk_bf16_f32 v108, v76, v80
    v_mul_f32 v77, v6, v77
    v_mul_f32 v81, v6, v81
    v_cvt_pk_bf16_f32 v109, v77, v81
    v_mul_f32 v78, v6, v78
    v_mul_f32 v82, v6, v82
    v_cvt_pk_bf16_f32 v110, v78, v82
    v_mul_f32 v79, v6, v79
    v_mul_f32 v83, v6, v83
    v_cvt_pk_bf16_f32 v111, v79, v83
    s_add_u32 s17, s48, 0
    buffer_store_dwordx4 v[108:111], v0, s[8:11], s17 offen offset:0
    s_add_u32 s46, s51, 16777216
    buffer_load_dwordx4 a[32:35], v0, s[28:31], s46 offen offset:0
    v_mfma_f32_16x16x16_bf16 v[92:95], v[72:73], v[20:21], v[92:95]
    v_mfma_f32_16x16x16_bf16 v[96:99], v[72:73], v[22:23], v[96:99]
    v_mul_f32 v84, v6, v84
    v_mul_f32 v88, v6, v88
    v_cvt_pk_bf16_f32 v112, v84, v88
    v_mul_f32 v85, v6, v85
    v_mul_f32 v89, v6, v89
    v_cvt_pk_bf16_f32 v113, v85, v89
    v_mul_f32 v86, v6, v86
    v_mul_f32 v90, v6, v90
    v_cvt_pk_bf16_f32 v114, v86, v90
    v_mul_f32 v87, v6, v87
    v_mul_f32 v91, v6, v91
    v_cvt_pk_bf16_f32 v115, v87, v91
    buffer_store_dwordx4 v[112:115], v0, s[8:11], s17 offen offset:2048
    buffer_load_dwordx4 a[36:39], v0, s[28:31], s46 offen offset:1024
    v_mfma_f32_16x16x16_bf16 v[100:103], v[74:75], v[20:21], v[100:103]
    v_mfma_f32_16x16x16_bf16 v[104:107], v[74:75], v[22:23], v[104:107]
    v_mul_f32 v92, v6, v92
    v_mul_f32 v96, v6, v96
    v_cvt_pk_bf16_f32 v116, v92, v96
    v_mul_f32 v93, v6, v93
    v_mul_f32 v97, v6, v97
    v_cvt_pk_bf16_f32 v117, v93, v97
    v_mul_f32 v94, v6, v94
    v_mul_f32 v98, v6, v98
    v_cvt_pk_bf16_f32 v118, v94, v98
    v_mul_f32 v95, v6, v95
    v_mul_f32 v99, v6, v99
    v_cvt_pk_bf16_f32 v119, v95, v99
    s_add_u32 s17, s48, 4096
    buffer_store_dwordx4 v[116:119], v0, s[8:11], s17 offen offset:0
    buffer_load_dwordx4 a[40:43], v0, s[28:31], s46 offen offset:2048
    v_mul_f32 v100, v6, v100
    v_mul_f32 v104, v6, v104
    v_cvt_pk_bf16_f32 v120, v100, v104
    v_mul_f32 v101, v6, v101
    v_mul_f32 v105, v6, v105
    v_cvt_pk_bf16_f32 v121, v101, v105
    v_mul_f32 v102, v6, v102
    v_mul_f32 v106, v6, v106
    v_cvt_pk_bf16_f32 v122, v102, v106
    v_mul_f32 v103, v6, v103
    v_mul_f32 v107, v6, v107
    v_cvt_pk_bf16_f32 v123, v103, v107
    buffer_store_dwordx4 v[120:123], v0, s[8:11], s17 offen offset:2048
    buffer_load_dwordx4 a[44:47], v0, s[28:31], s46 offen offset:3072
    v_max3_f32 v5, v36, v37, v38
    v_max_f32 v5, v5, v39
    v_max3_f32 v5, v5, v40, v41
    v_max3_f32 v5, v5, v42, v43
    v_mul_f32 v48, s52, v48
    v_mul_f32 v49, s52, v49
    v_max3_f32 v5, v5, v48, v49
    v_mov_b32 v6, v5
    s_add_u32 s46, s51, 16781312
    buffer_load_dwordx4 a[48:51], v0, s[28:31], s46 offen offset:0
    v_permlane32_swap_b32 v5, v6
    v_max_f32 v5, v5, v6
    v_mov_b32 v6, v5
    buffer_load_dwordx4 a[52:55], v0, s[28:31], s46 offen offset:1024
    s_nop 0
    v_permlane16_swap_b32 v5, v6
    v_max_f32 v5, v5, v6
    v_sub_f32 v36, v36, v5
    v_sub_f32 v37, v37, v5
    v_sub_f32 v38, v38, v5
    v_sub_f32 v39, v39, v5
    v_sub_f32 v40, v40, v5
    v_sub_f32 v41, v41, v5
    v_sub_f32 v42, v42, v5
    v_sub_f32 v43, v43, v5
    v_sub_f32 v48, v48, v5
    v_sub_f32 v49, v49, v5
    v_exp_f32 v36, v36
    v_exp_f32 v37, v37
    v_exp_f32 v38, v38
    v_exp_f32 v39, v39
    v_exp_f32 v40, v40
    v_exp_f32 v41, v41
    v_exp_f32 v42, v42
    v_exp_f32 v43, v43
    v_exp_f32 v48, v48
    v_exp_f32 v49, v49
    v_cvt_pk_bf16_f32 v24, v36, v37
    v_cvt_pk_bf16_f32 v25, v38, v39
    v_cvt_pk_bf16_f32 v26, v40, v41
    v_cvt_pk_bf16_f32 v27, v42, v43
    v_cvt_pk_bf16_f32 v20, v48, v49
    v_cvt_pk_bf16_f32 v23, v48, v49
    v_mfma_f32_16x16x32_bf16 v[28:31], v[16:19], v[24:27], 0
    v_mfma_f32_16x16x32_bf16 v[76:79], v[204:207], v[24:27], 0
    v_mfma_f32_16x16x32_bf16 v[80:83], v[208:211], v[24:27], 0
    buffer_load_dwordx4 a[56:59], v0, s[28:31], s46 offen offset:2048
    v_mfma_f32_16x16x32_bf16 v[84:87], v[212:215], v[24:27], 0
    v_mfma_f32_16x16x32_bf16 v[88:91], v[216:219], v[24:27], 0
    buffer_load_dwordx4 a[60:63], v0, s[28:31], s46 offen offset:3072
    v_mfma_f32_16x16x32_bf16 v[92:95], v[220:223], v[24:27], 0
    v_mfma_f32_16x16x32_bf16 v[96:99], v[224:227], v[24:27], 0
    s_add_u32 s46, s51, 33554432
    buffer_load_dwordx4 a[64:67], v0, s[28:31], s46 offen offset:0
    v_mfma_f32_16x16x16_bf16 v[28:31], v[16:17], v[20:21], v[28:31]
    v_mfma_f32_16x16x32_bf16 v[100:103], v[228:231], v[24:27], 0
    v_mfma_f32_16x16x32_bf16 v[104:107], v[232:235], v[24:27], 0
    buffer_load_dwordx4 a[68:71], v0, s[28:31], s46 offen offset:1024
    v_mfma_f32_16x16x16_bf16 v[76:79], v[68:69], v[20:21], v[76:79]
    v_mfma_f32_16x16x16_bf16 v[80:83], v[68:69], v[22:23], v[80:83]
    s_nop 2
    v_rcp_f32 v6, v28
    v_mfma_f32_16x16x16_bf16 v[84:87], v[70:71], v[20:21], v[84:87]
    v_mfma_f32_16x16x16_bf16 v[88:91], v[70:71], v[22:23], v[88:91]
    s_nop 0
    v_mul_f32 v76, v6, v76
    v_mul_f32 v80, v6, v80
    v_cvt_pk_bf16_f32 v124, v76, v80
    v_mul_f32 v77, v6, v77
    v_mul_f32 v81, v6, v81
    v_cvt_pk_bf16_f32 v125, v77, v81
    v_mul_f32 v78, v6, v78
    v_mul_f32 v82, v6, v82
    v_cvt_pk_bf16_f32 v126, v78, v82
    v_mul_f32 v79, v6, v79
    v_mul_f32 v83, v6, v83
    v_cvt_pk_bf16_f32 v127, v79, v83
    s_add_u32 s17, s48, 0
    buffer_store_dwordx4 v[124:127], v0, s[8:11], s17 offen offset:1024
    buffer_load_dwordx4 a[72:75], v0, s[28:31], s46 offen offset:2048
    v_mfma_f32_16x16x16_bf16 v[92:95], v[72:73], v[20:21], v[92:95]
    v_mfma_f32_16x16x16_bf16 v[96:99], v[72:73], v[22:23], v[96:99]
    v_mul_f32 v84, v6, v84
    v_mul_f32 v88, v6, v88
    v_cvt_pk_bf16_f32 v128, v84, v88
    v_mul_f32 v85, v6, v85
    v_mul_f32 v89, v6, v89
    v_cvt_pk_bf16_f32 v129, v85, v89
    v_mul_f32 v86, v6, v86
    v_mul_f32 v90, v6, v90
    v_cvt_pk_bf16_f32 v130, v86, v90
    v_mul_f32 v87, v6, v87
    v_mul_f32 v91, v6, v91
    v_cvt_pk_bf16_f32 v131, v87, v91
    buffer_store_dwordx4 v[128:131], v0, s[8:11], s17 offen offset:3072
    buffer_load_dwordx4 a[76:79], v0, s[28:31], s46 offen offset:3072
    v_mfma_f32_16x16x16_bf16 v[100:103], v[74:75], v[20:21], v[100:103]
    v_mfma_f32_16x16x16_bf16 v[104:107], v[74:75], v[22:23], v[104:107]
    v_mul_f32 v92, v6, v92
    v_mul_f32 v96, v6, v96
    v_cvt_pk_bf16_f32 v132, v92, v96
    v_mul_f32 v93, v6, v93
    v_mul_f32 v97, v6, v97
    v_cvt_pk_bf16_f32 v133, v93, v97
    v_mul_f32 v94, v6, v94
    v_mul_f32 v98, v6, v98
    v_cvt_pk_bf16_f32 v134, v94, v98
    v_mul_f32 v95, v6, v95
    v_mul_f32 v99, v6, v99
    v_cvt_pk_bf16_f32 v135, v95, v99
    s_add_u32 s17, s48, 4096
    buffer_store_dwordx4 v[132:135], v0, s[8:11], s17 offen offset:1024
    s_add_u32 s46, s51, 33558528
    buffer_load_dwordx4 a[80:83], v0, s[28:31], s46 offen offset:0
    v_mul_f32 v100, v6, v100
    v_mul_f32 v104, v6, v104
    v_cvt_pk_bf16_f32 v136, v100, v104
    v_mul_f32 v101, v6, v101
    v_mul_f32 v105, v6, v105
    v_cvt_pk_bf16_f32 v137, v101, v105
    v_mul_f32 v102, v6, v102
    v_mul_f32 v106, v6, v106
    v_cvt_pk_bf16_f32 v138, v102, v106
    v_mul_f32 v103, v6, v103
    v_mul_f32 v107, v6, v107
    v_cvt_pk_bf16_f32 v139, v103, v107
    buffer_store_dwordx4 v[136:139], v0, s[8:11], s17 offen offset:3072
    buffer_load_dwordx4 a[84:87], v0, s[28:31], s46 offen offset:1024
    buffer_load_dwordx4 a[88:91], v0, s[28:31], s46 offen offset:2048
    buffer_load_dwordx4 a[92:95], v0, s[28:31], s46 offen offset:3072
    s_add_u32 s48, s48, 262144
    s_mov_b32 s49, 22528
    s_cmp_ge_u32 s37, 64
    s_cbranch_scc1 LtaF_end
LtaF1:
    s_and_b32 s17, s37, 7
    s_mul_i32 s17, s17, 131072
    s_add_u32 s47, s35, s17
    s_bfe_u32 s34, s37, 65539
    s_cmp_eq_u32 s39, 1
    s_cbranch_scc1 LtaF1_have
    s_waitcnt vmcnt(0)
    s_cmp_lg_u32 s49, 0
    s_cselect_b64 exec, 1, 0
    buffer_store_dword v3, v4, s[8:11], s43 offen
    s_mov_b64 exec, -1
    s_add_u32 s43, s43, s49
    s_mov_b32 s49, 0
    s_mov_b32 s16, 0
LtaF1_f_3:
    buffer_load_dword v2, v1, s[8:11], s42 offen sc1
    s_add_u32 s16, s16, 1
    s_cmp_gt_u32 s16, 100000
    s_cbranch_scc1 L_role_ta_abort
    s_waitcnt vmcnt(0)
    v_cmp_eq_u32 vcc, 0, v2
    s_nop 0
    s_cbranch_vccz LtaF1_fd_4
    s_sleep 4
    s_branch LtaF1_f_3
LtaF1_fd_4:
    s_add_u32 s46, s51, 0
    buffer_load_dwordx4 a[0:3], v0, s[8:11], s46 offen offset:0
    buffer_load_dwordx4 a[4:7], v0, s[8:11], s46 offen offset:1024
    buffer_load_dwordx4 a[8:11], v0, s[8:11], s46 offen offset:2048
    buffer_load_dwordx4 a[12:15], v0, s[8:11], s46 offen offset:3072
    s_add_u32 s46, s51, 4096
    buffer_load_dwordx4 a[16:19], v0, s[8:11], s46 offen offset:0
    buffer_load_dwordx4 a[20:23], v0, s[8:11], s46 offen offset:1024
    buffer_load_dwordx4 a[24:27], v0, s[8:11], s46 offen offset:2048
    buffer_load_dwordx4 a[28:31], v0, s[8:11], s46 offen offset:3072
    s_add_u32 s46, s51, 16777216
    buffer_load_dwordx4 a[32:35], v0, s[8:11], s46 offen offset:0
    buffer_load_dwordx4 a[36:39], v0, s[8:11], s46 offen offset:1024
    buffer_load_dwordx4 a[40:43], v0, s[8:11], s46 offen offset:2048
    buffer_load_dwordx4 a[44:47], v0, s[8:11], s46 offen offset:3072
    s_add_u32 s46, s51, 16781312
    buffer_load_dwordx4 a[48:51], v0, s[8:11], s46 offen offset:0
    buffer_load_dwordx4 a[52:55], v0, s[8:11], s46 offen offset:1024
    buffer_load_dwordx4 a[56:59], v0, s[8:11], s46 offen offset:2048
    buffer_load_dwordx4 a[60:63], v0, s[8:11], s46 offen offset:3072
    s_add_u32 s46, s51, 33554432
    buffer_load_dwordx4 a[64:67], v0, s[8:11], s46 offen offset:0
    buffer_load_dwordx4 a[68:71], v0, s[8:11], s46 offen offset:1024
    buffer_load_dwordx4 a[72:75], v0, s[8:11], s46 offen offset:2048
    buffer_load_dwordx4 a[76:79], v0, s[8:11], s46 offen offset:3072
    s_add_u32 s46, s51, 33558528
    buffer_load_dwordx4 a[80:83], v0, s[8:11], s46 offen offset:0
    buffer_load_dwordx4 a[84:87], v0, s[8:11], s46 offen offset:1024
    buffer_load_dwordx4 a[88:91], v0, s[8:11], s46 offen offset:2048
    buffer_load_dwordx4 a[92:95], v0, s[8:11], s46 offen offset:3072
LtaF1_have:
    s_add_u32 s17, s42, 22528
    buffer_load_dword v15, v1, s[8:11], s17 offen sc1
    buffer_load_dwordx4 v[52:55], v9, s[8:11], s47 offen offset:0 sc1
    buffer_load_dwordx4 v[56:59], v9, s[8:11], s47 offen offset:64 sc1
    buffer_load_dwordx4 v[60:63], v9, s[8:11], s47 offen offset:128 sc1
    buffer_load_dwordx4 v[64:67], v9, s[8:11], s47 offen offset:192 sc1
    buffer_load_dwordx2 v[68:69], v10, s[8:11], s47 offen offset:2048 sc1
    buffer_load_dwordx2 v[70:71], v10, s[8:11], s47 offen offset:2560 sc1
    buffer_load_dwordx2 v[72:73], v10, s[8:11], s47 offen offset:3072 sc1
    buffer_load_dwordx2 v[74:75], v10, s[8:11], s47 offen offset:3584 sc1
    s_waitcnt vmcnt(9)
    s_cmp_lg_u32 s49, 0
    s_cselect_b64 exec, 1, 0
    buffer_store_dword v3, v4, s[8:11], s43 offen
    s_mov_b64 exec, -1
    s_add_u32 s43, s43, s49
    s_mov_b32 s49, 0
    v_mfma_f32_16x16x32_bf16 v[32:35], a[32:35], a[0:3], 0
    v_mfma_f32_16x16x32_bf16 v[36:39], a[32:35], a[4:7], 0
    v_mfma_f32_16x16x32_bf16 v[40:43], a[36:39], a[4:7], 0
    v_mfma_f32_16x16x32_bf16 v[32:35], a[40:43], a[8:11], v[32:35]
    v_mfma_f32_16x16x32_bf16 v[36:39], a[40:43], a[12:15], v[36:39]
    v_mfma_f32_16x16x32_bf16 v[40:43], a[44:47], a[12:15], v[40:43]
    v_mfma_f32_16x16x32_bf16 v[32:35], a[48:51], a[16:19], v[32:35]
    v_mfma_f32_16x16x32_bf16 v[36:39], a[48:51], a[20:23], v[36:39]
    v_mfma_f32_16x16x32_bf16 v[40:43], a[52:55], a[20:23], v[40:43]
    v_mfma_f32_16x16x32_bf16 v[32:35], a[56:59], a[24:27], v[32:35]
    v_mfma_f32_16x16x32_bf16 v[36:39], a[56:59], a[28:31], v[36:39]
    v_mfma_f32_16x16x32_bf16 v[40:43], a[60:63], a[28:31], v[40:43]
    s_waitcnt vmcnt(1)
    v_cmp_eq_u32 vcc, 0, v15
    s_add_u32 s51, s51, 262144
    s_add_u32 s42, s42, 22528
    s_add_u32 s37, s37, 1
    s_cmp_eq_u64 vcc, 0
    s_cselect_b32 s39, 1, 0
    s_cmp_lt_u32 s37, 64
    s_cselect_b32 s39, s39, 0
    s_cmp_eq_u32 s39, 1
    s_cselect_b32 s30, 268435456, 0
    v_fma_f32 v32, v32, s52, v236
    v_fma_f32 v33, v33, s52, v237
    v_fma_f32 v34, v34, s52, v238
    v_fma_f32 v35, v35, s52, v239
    v_mul_f32 v36, s52, v36
    v_mul_f32 v37, s52, v37
    v_mul_f32 v38, s52, v38
    v_mul_f32 v39, s52, v39
    v_fma_f32 v40, v40, s52, v236
    v_fma_f32 v41, v41, s52, v237
    v_fma_f32 v42, v42, s52, v238
    v_fma_f32 v43, v43, s52, v239
    v_xor_b32 v5, s34, v52
    v_xor_b32 v6, s34, v56
    v_or_b32 v5, v5, v6
    v_xor_b32 v6, s34, v60
    v_or_b32 v5, v5, v6
    v_xor_b32 v6, s34, v64
    v_or_b32 v5, v5, v6
    v_xor_b32 v6, s34, v68
    v_or_b32 v5, v5, v6
    v_xor_b32 v6, s34, v70
    v_or_b32 v5, v5, v6
    v_xor_b32 v6, s34, v72
    v_or_b32 v5, v5, v6
    v_xor_b32 v6, s34, v74
    v_or_b32 v5, v5, v6
    v_and_b32 v5, 1, v5
    v_cmp_ne_u32 vcc, 0, v5
    s_nop 0
    s_cbranch_vccz LtaF1_r
    s_mov_b32 s16, 0
LtaF1_rp:
    buffer_load_dwordx4 v[52:55], v9, s[8:11], s47 offen offset:0 sc1
    buffer_load_dwordx4 v[56:59], v9, s[8:11], s47 offen offset:64 sc1
    buffer_load_dwordx4 v[60:63], v9, s[8:11], s47 offen offset:128 sc1
    buffer_load_dwordx4 v[64:67], v9, s[8:11], s47 offen offset:192 sc1
    buffer_load_dwordx2 v[68:69], v10, s[8:11], s47 offen offset:2048 sc1
    buffer_load_dwordx2 v[70:71], v10, s[8:11], s47 offen offset:2560 sc1
    buffer_load_dwordx2 v[72:73], v10, s[8:11], s47 offen offset:3072 sc1
    buffer_load_dwordx2 v[74:75], v10, s[8:11], s47 offen offset:3584 sc1
    s_add_u32 s16, s16, 1
    s_cmp_gt_u32 s16, 100000
    s_cbranch_scc1 L_role_ta_abort
    s_waitcnt vmcnt(0)
    v_xor_b32 v5, s34, v52
    v_xor_b32 v6, s34, v56
    v_or_b32 v5, v5, v6
    v_xor_b32 v6, s34, v60
    v_or_b32 v5, v5, v6
    v_xor_b32 v6, s34, v64
    v_or_b32 v5, v5, v6
    v_xor_b32 v6, s34, v68
    v_or_b32 v5, v5, v6
    v_xor_b32 v6, s34, v70
    v_or_b32 v5, v5, v6
    v_xor_b32 v6, s34, v72
    v_or_b32 v5, v5, v6
    v_xor_b32 v6, s34, v74
    v_or_b32 v5, v5, v6
    v_and_b32 v5, 1, v5
    v_cmp_ne_u32 vcc, 0, v5
    s_nop 0
    s_cbranch_vccz LtaF1_r
    s_sleep 2
    s_branch LtaF1_rp
LtaF1_r:
    s_add_u32 s46, s51, 0
    buffer_load_dwordx4 v[140:143], v0, s[28:31], s46 offen offset:0
    buffer_load_dwordx4 v[144:147], v0, s[28:31], s46 offen offset:1024
    v_mfma_f32_16x16x32_bf16 v[44:47], v[52:55], a[0:3], 0
    v_mfma_f32_16x16x32_bf16 v[48:51], v[52:55], a[4:7], 0
    v_mfma_f32_16x16x32_bf16 v[44:47], v[56:59], a[8:11], v[44:47]
    v_mfma_f32_16x16x32_bf16 v[48:51], v[56:59], a[12:15], v[48:51]
    v_mfma_f32_16x16x32_bf16 v[44:47], v[60:63], a[16:19], v[44:47]
    v_mfma_f32_16x16x32_bf16 v[48:51], v[60:63], a[20:23], v[48:51]
    v_mfma_f32_16x16x32_bf16 v[44:47], v[64:67], a[24:27], v[44:47]
    v_mfma_f32_16x16x32_bf16 v[48:51], v[64:67], a[28:31], v[48:51]
    v_max3_f32 v5, v32, v33, v34
    v_max_f32 v5, v5, v35
    s_nop 4
    v_mul_f32 v44, s52, v44
    v_mul_f32 v45, s52, v45
    v_max3_f32 v5, v5, v44, v45
    v_mov_b32 v6, v5
    buffer_load_dwordx4 v[148:151], v0, s[28:31], s46 offen offset:2048
    s_nop 0
    v_permlane32_swap_b32 v5, v6
    v_max_f32 v5, v5, v6
    v_mov_b32 v6, v5
    buffer_load_dwordx4 v[152:155], v0, s[28:31], s46 offen offset:3072
    s_nop 0
    v_permlane16_swap_b32 v5, v6
    v_max_f32 v5, v5, v6
    v_sub_f32 v32, v32, v5
    v_sub_f32 v33, v33, v5
    v_sub_f32 v34, v34, v5
    v_sub_f32 v35, v35, v5
    v_sub_f32 v44, v44, v5
    v_sub_f32 v45, v45, v5
    v_exp_f32 v32, v32
    v_exp_f32 v33, v33
    v_exp_f32 v34, v34
    v_exp_f32 v35, v35
    v_exp_f32 v44, v44
    v_exp_f32 v45, v45
    v_cvt_pk_bf16_f32 v24, v32, v33
    v_cvt_pk_bf16_f32 v25, v34, v35
    v_mov_b32 v26, 0
    v_mov_b32 v27, 0
    v_cvt_pk_bf16_f32 v20, v44, v45
    v_cvt_pk_bf16_f32 v23, v44, v45
    v_mfma_f32_16x16x32_bf16 v[28:31], v[16:19], v[24:27], 0
    v_mfma_f32_16x16x32_bf16 v[76:79], a[64:67], v[24:27], 0
    v_mfma_f32_16x16x32_bf16 v[80:83], a[68:71], v[24:27], 0
    s_add_u32 s46, s51, 4096
    buffer_load_dwordx4 v[156:159], v0, s[28:31], s46 offen offset:0
    v_mfma_f32_16x16x32_bf16 v[84:87], a[72:75], v[24:27], 0
    v_mfma_f32_16x16x32_bf16 v[88:91], a[76:79], v[24:27], 0
    buffer_load_dwordx4 v[160:163], v0, s[28:31], s46 offen offset:1024
    v_mfma_f32_16x16x32_bf16 v[92:95], a[80:83], v[24:27], 0
    v_mfma_f32_16x16x32_bf16 v[96:99], a[84:87], v[24:27], 0
    buffer_load_dwordx4 v[164:167], v0, s[28:31], s46 offen offset:2048
    v_mfma_f32_16x16x16_bf16 v[28:31], v[16:17], v[20:21], v[28:31]
    v_mfma_f32_16x16x32_bf16 v[100:103], a[88:91], v[24:27], 0
    v_mfma_f32_16x16x32_bf16 v[104:107], a[92:95], v[24:27], 0
    buffer_load_dwordx4 v[168:171], v0, s[28:31], s46 offen offset:3072
    v_mfma_f32_16x16x16_bf16 v[76:79], v[68:69], v[20:21], v[76:79]
    v_mfma_f32_16x16x16_bf16 v[80:83], v[68:69], v[22:23], v[80:83]
    s_nop 2
    v_rcp_f32 v6, v28
    v_mfma_f32_16x16x16_bf16 v[84:87], v[70:71], v[20:21], v[84:87]
    v_mfma_f32_16x16x16_bf16 v[88:91], v[70:71], v[22:23], v[88:91]
    s_nop 0
    v_mul_f32 v76, v6, v76
    v_mul_f32 v80, v6, v80
    v_cvt_pk_bf16_f32 v108, v76, v80
    v_mul_f32 v77, v6, v77
    v_mul_f32 v81, v6, v81
    v_cvt_pk_bf16_f32 v109, v77, v81
    v_mul_f32 v78, v6, v78
    v_mul_f32 v82, v6, v82
    v_cvt_pk_bf16_f32 v110, v78, v82
    v_mul_f32 v79, v6, v79
    v_mul_f32 v83, v6, v83
    v_cvt_pk_bf16_f32 v111, v79, v83
    s_add_u32 s17, s48, 0
    buffer_store_dwordx4 v[108:111], v0, s[8:11], s17 offen offset:0
    s_add_u32 s46, s51, 16777216
    buffer_load_dwordx4 v[172:175], v0, s[28:31], s46 offen offset:0
    v_mfma_f32_16x16x16_bf16 v[92:95], v[72:73], v[20:21], v[92:95]
    v_mfma_f32_16x16x16_bf16 v[96:99], v[72:73], v[22:23], v[96:99]
    v_mul_f32 v84, v6, v84
    v_mul_f32 v88, v6, v88
    v_cvt_pk_bf16_f32 v112, v84, v88
    v_mul_f32 v85, v6, v85
    v_mul_f32 v89, v6, v89
    v_cvt_pk_bf16_f32 v113, v85, v89
    v_mul_f32 v86, v6, v86
    v_mul_f32 v90, v6, v90
    v_cvt_pk_bf16_f32 v114, v86, v90
    v_mul_f32 v87, v6, v87
    v_mul_f32 v91, v6, v91
    v_cvt_pk_bf16_f32 v115, v87, v91
    buffer_store_dwordx4 v[112:115], v0, s[8:11], s17 offen offset:2048
    buffer_load_dwordx4 v[176:179], v0, s[28:31], s46 offen offset:1024
    v_mfma_f32_16x16x16_bf16 v[100:103], v[74:75], v[20:21], v[100:103]
    v_mfma_f32_16x16x16_bf16 v[104:107], v[74:75], v[22:23], v[104:107]
    v_mul_f32 v92, v6, v92
    v_mul_f32 v96, v6, v96
    v_cvt_pk_bf16_f32 v116, v92, v96
    v_mul_f32 v93, v6, v93
    v_mul_f32 v97, v6, v97
    v_cvt_pk_bf16_f32 v117, v93, v97
    v_mul_f32 v94, v6, v94
    v_mul_f32 v98, v6, v98
    v_cvt_pk_bf16_f32 v118, v94, v98
    v_mul_f32 v95, v6, v95
    v_mul_f32 v99, v6, v99
    v_cvt_pk_bf16_f32 v119, v95, v99
    s_add_u32 s17, s48, 4096
    buffer_store_dwordx4 v[116:119], v0, s[8:11], s17 offen offset:0
    buffer_load_dwordx4 v[180:183], v0, s[28:31], s46 offen offset:2048
    v_mul_f32 v100, v6, v100
    v_mul_f32 v104, v6, v104
    v_cvt_pk_bf16_f32 v120, v100, v104
    v_mul_f32 v101, v6, v101
    v_mul_f32 v105, v6, v105
    v_cvt_pk_bf16_f32 v121, v101, v105
    v_mul_f32 v102, v6, v102
    v_mul_f32 v106, v6, v106
    v_cvt_pk_bf16_f32 v122, v102, v106
    v_mul_f32 v103, v6, v103
    v_mul_f32 v107, v6, v107
    v_cvt_pk_bf16_f32 v123, v103, v107
    buffer_store_dwordx4 v[120:123], v0, s[8:11], s17 offen offset:2048
    buffer_load_dwordx4 v[184:187], v0, s[28:31], s46 offen offset:3072
    v_max3_f32 v5, v36, v37, v38
    v_max_f32 v5, v5, v39
    v_max3_f32 v5, v5, v40, v41
    v_max3_f32 v5, v5, v42, v43
    v_mul_f32 v48, s52, v48
    v_mul_f32 v49, s52, v49
    v_max3_f32 v5, v5, v48, v49
    v_mov_b32 v6, v5
    s_add_u32 s46, s51, 16781312
    buffer_load_dwordx4 v[188:191], v0, s[28:31], s46 offen offset:0
    v_permlane32_swap_b32 v5, v6
    v_max_f32 v5, v5, v6
    v_mov_b32 v6, v5
    buffer_load_dwordx4 v[192:195], v0, s[28:31], s46 offen offset:1024
    s_nop 0
    v_permlane16_swap_b32 v5, v6
    v_max_f32 v5, v5, v6
    v_sub_f32 v36, v36, v5
    v_sub_f32 v37, v37, v5
    v_sub_f32 v38, v38, v5
    v_sub_f32 v39, v39, v5
    v_sub_f32 v40, v40, v5
    v_sub_f32 v41, v41, v5
    v_sub_f32 v42, v42, v5
    v_sub_f32 v43, v43, v5
    v_sub_f32 v48, v48, v5
    v_sub_f32 v49, v49, v5
    v_exp_f32 v36, v36
    v_exp_f32 v37, v37
    v_exp_f32 v38, v38
    v_exp_f32 v39, v39
    v_exp_f32 v40, v40
    v_exp_f32 v41, v41
    v_exp_f32 v42, v42
    v_exp_f32 v43, v43
    v_exp_f32 v48, v48
    v_exp_f32 v49, v49
    v_cvt_pk_bf16_f32 v24, v36, v37
    v_cvt_pk_bf16_f32 v25, v38, v39
    v_cvt_pk_bf16_f32 v26, v40, v41
    v_cvt_pk_bf16_f32 v27, v42, v43
    v_cvt_pk_bf16_f32 v20, v48, v49
    v_cvt_pk_bf16_f32 v23, v48, v49
    v_mfma_f32_16x16x32_bf16 v[28:31], v[16:19], v[24:27], 0
    v_mfma_f32_16x16x32_bf16 v[76:79], a[64:67], v[24:27], 0
    v_mfma_f32_16x16x32_bf16 v[80:83], a[68:71], v[24:27], 0
    buffer_load_dwordx4 v[196:199], v0, s[28:31], s46 offen offset:2048
    v_mfma_f32_16x16x32_bf16 v[84:87], a[72:75], v[24:27], 0
    v_mfma_f32_16x16x32_bf16 v[88:91], a[76:79], v[24:27], 0
    buffer_load_dwordx4 v[200:203], v0, s[28:31], s46 offen offset:3072
    v_mfma_f32_16x16x32_bf16 v[92:95], a[80:83], v[24:27], 0
    v_mfma_f32_16x16x32_bf16 v[96:99], a[84:87], v[24:27], 0
    s_add_u32 s46, s51, 33554432
    buffer_load_dwordx4 v[204:207], v0, s[28:31], s46 offen offset:0
    v_mfma_f32_16x16x16_bf16 v[28:31], v[16:17], v[20:21], v[28:31]
    v_mfma_f32_16x16x32_bf16 v[100:103], a[88:91], v[24:27], 0
    v_mfma_f32_16x16x32_bf16 v[104:107], a[92:95], v[24:27], 0
    buffer_load_dwordx4 v[208:211], v0, s[28:31], s46 offen offset:1024
    v_mfma_f32_16x16x16_bf16 v[76:79], v[68:69], v[20:21], v[76:79]
    v_mfma_f32_16x16x16_bf16 v[80:83], v[68:69], v[22:23], v[80:83]
    s_nop 2
    v_rcp_f32 v6, v28
    v_mfma_f32_16x16x16_bf16 v[84:87], v[70:71], v[20:21], v[84:87]
    v_mfma_f32_16x16x16_bf16 v[88:91], v[70:71], v[22:23], v[88:91]
    s_nop 0
    v_mul_f32 v76, v6, v76
    v_mul_f32 v80, v6, v80
    v_cvt_pk_bf16_f32 v124, v76, v80
    v_mul_f32 v77, v6, v77
    v_mul_f32 v81, v6, v81
    v_cvt_pk_bf16_f32 v125, v77, v81
    v_mul_f32 v78, v6, v78
    v_mul_f32 v82, v6, v82
    v_cvt_pk_bf16_f32 v126, v78, v82
    v_mul_f32 v79, v6, v79
    v_mul_f32 v83, v6, v83
    v_cvt_pk_bf16_f32 v127, v79, v83
    s_add_u32 s17, s48, 0
    buffer_store_dwordx4 v[124:127], v0, s[8:11], s17 offen offset:1024
    buffer_load_dwordx4 v[212:215], v0, s[28:31], s46 offen offset:2048
    v_mfma_f32_16x16x16_bf16 v[92:95], v[72:73], v[20:21], v[92:95]
    v_mfma_f32_16x16x16_bf16 v[96:99], v[72:73], v[22:23], v[96:99]
    v_mul_f32 v84, v6, v84
    v_mul_f32 v88, v6, v88
    v_cvt_pk_bf16_f32 v128, v84, v88
    v_mul_f32 v85, v6, v85
    v_mul_f32 v89, v6, v89
    v_cvt_pk_bf16_f32 v129, v85, v89
    v_mul_f32 v86, v6, v86
    v_mul_f32 v90, v6, v90
    v_cvt_pk_bf16_f32 v130, v86, v90
    v_mul_f32 v87, v6, v87
    v_mul_f32 v91, v6, v91
    v_cvt_pk_bf16_f32 v131, v87, v91
    buffer_store_dwordx4 v[128:131], v0, s[8:11], s17 offen offset:3072
    buffer_load_dwordx4 v[216:219], v0, s[28:31], s46 offen offset:3072
    v_mfma_f32_16x16x16_bf16 v[100:103], v[74:75], v[20:21], v[100:103]
    v_mfma_f32_16x16x16_bf16 v[104:107], v[74:75], v[22:23], v[104:107]
    v_mul_f32 v92, v6, v92
    v_mul_f32 v96, v6, v96
    v_cvt_pk_bf16_f32 v132, v92, v96
    v_mul_f32 v93, v6, v93
    v_mul_f32 v97, v6, v97
    v_cvt_pk_bf16_f32 v133, v93, v97
    v_mul_f32 v94, v6, v94
    v_mul_f32 v98, v6, v98
    v_cvt_pk_bf16_f32 v134, v94, v98
    v_mul_f32 v95, v6, v95
    v_mul_f32 v99, v6, v99
    v_cvt_pk_bf16_f32 v135, v95, v99
    s_add_u32 s17, s48, 4096
    buffer_store_dwordx4 v[132:135], v0, s[8:11], s17 offen offset:1024
    s_add_u32 s46, s51, 33558528
    buffer_load_dwordx4 v[220:223], v0, s[28:31], s46 offen offset:0
    v_mul_f32 v100, v6, v100
    v_mul_f32 v104, v6, v104
    v_cvt_pk_bf16_f32 v136, v100, v104
    v_mul_f32 v101, v6, v101
    v_mul_f32 v105, v6, v105
    v_cvt_pk_bf16_f32 v137, v101, v105
    v_mul_f32 v102, v6, v102
    v_mul_f32 v106, v6, v106
    v_cvt_pk_bf16_f32 v138, v102, v106
    v_mul_f32 v103, v6, v103
    v_mul_f32 v107, v6, v107
    v_cvt_pk_bf16_f32 v139, v103, v107
    buffer_store_dwordx4 v[136:139], v0, s[8:11], s17 offen offset:3072
    buffer_load_dwordx4 v[224:227], v0, s[28:31], s46 offen offset:1024
    buffer_load_dwordx4 v[228:231], v0, s[28:31], s46 offen offset:2048
    buffer_load_dwordx4 v[232:235], v0, s[28:31], s46 offen offset:3072
    s_add_u32 s48, s48, 262144
    s_mov_b32 s49, 22528
    s_cmp_ge_u32 s37, 64
    s_cbranch_scc1 LtaF_end
    s_branch LtaF0
LtaF_end:
    s_waitcnt vmcnt(0)
    s_cmp_lg_u32 s49, 0
    s_cselect_b64 exec, 1, 0
    buffer_store_dword v3, v4, s[8:11], s43 offen
    s_mov_b64 exec, -1
    s_add_u32 s43, s43, s49
    s_mov_b32 s49, 0
    s_branch L_role_ta_exit
LtaS0:
    s_and_b32 s17, s37, 7
    s_mul_i32 s17, s17, 131072
    s_add_u32 s47, s35, s17
    s_bfe_u32 s34, s37, 65539
    s_cmp_eq_u32 s39, 1
    s_cbranch_scc1 LtaS0_have
    s_waitcnt vmcnt(0)
    s_cmp_lg_u32 s49, 0
    s_cselect_b64 exec, 1, 0
    buffer_store_dword v3, v4, s[8:11], s43 offen sc1
    s_mov_b64 exec, -1
    s_add_u32 s43, s43, s49
    s_mov_b32 s49, 0
    s_mov_b32 s16, 0
LtaS0_f_5:
    buffer_load_dword v2, v1, s[8:11], s42 offen sc1
    s_add_u32 s16, s16, 1
    s_cmp_gt_u32 s16, 100000
    s_cbranch_scc1 L_role_ta_abort
    s_waitcnt vmcnt(0)
    v_cmp_eq_u32 vcc, 0, v2
    s_nop 0
    s_cbranch_vccz LtaS0_fd_6
    s_sleep 4
    s_branch LtaS0_f_5
LtaS0_fd_6:
    s_add_u32 s46, s51, 0
    buffer_load_dwordx4 v[140:143], v0, s[8:11], s46 offen offset:0
    buffer_load_dwordx4 v[144:147], v0, s[8:11], s46 offen offset:1024
    buffer_load_dwordx4 v[148:151], v0, s[8:11], s46 offen offset:2048
    buffer_load_dwordx4 v[152:155], v0, s[8:11], s46 offen offset:3072
    s_add_u32 s46, s51, 4096
    buffer_load_dwordx4 v[156:159], v0, s[8:11], s46 offen offset:0
    buffer_load_dwordx4 v[160:163], v0, s[8:11], s46 offen offset:1024
    buffer_load_dwordx4 v[164:167], v0, s[8:11], s46 offen offset:2048
    buffer_load_dwordx4 v[168:171], v0, s[8:11], s46 offen offset:3072
    s_add_u32 s46, s51, 16777216
    buffer_load_dwordx4 v[172:175], v0, s[8:11], s46 offen offset:0
    buffer_load_dwordx4 v[176:179], v0, s[8:11], s46 offen offset:1024
    buffer_load_dwordx4 v[180:183], v0, s[8:11], s46 offen offset:2048
    buffer_load_dwordx4 v[184:187], v0, s[8:11], s46 offen offset:3072
    s_add_u32 s46, s51, 16781312
    buffer_load_dwordx4 v[188:191], v0, s[8:11], s46 offen offset:0
    buffer_load_dwordx4 v[192:195], v0, s[8:11], s46 offen offset:1024
    buffer_load_dwordx4 v[196:199], v0, s[8:11], s46 offen offset:2048
    buffer_load_dwordx4 v[200:203], v0, s[8:11], s46 offen offset:3072
    s_add_u32 s46, s51, 33554432
    buffer_load_dwordx4 v[204:207], v0, s[8:11], s46 offen offset:0
    buffer_load_dwordx4 v[208:211], v0, s[8:11], s46 offen offset:1024
    buffer_load_dwordx4 v[212:215], v0, s[8:11], s46 offen offset:2048
    buffer_load_dwordx4 v[216:219], v0, s[8:11], s46 offen offset:3072
    s_add_u32 s46, s51, 33558528
    buffer_load_dwordx4 v[220:223], v0, s[8:11], s46 offen offset:0
    buffer_load_dwordx4 v[224:227], v0, s[8:11], s46 offen offset:1024
    buffer_load_dwordx4 v[228:231], v0, s[8:11], s46 offen offset:2048
    buffer_load_dwordx4 v[232:235], v0, s[8:11], s46 offen offset:3072
LtaS0_have:
    s_add_u32 s17, s42, 22528
    buffer_load_dword v15, v1, s[8:11], s17 offen sc1
    buffer_load_dwordx4 v[52:55], v9, s[8:11], s47 offen offset:0 sc1
    buffer_load_dwordx4 v[56:59], v9, s[8:11], s47 offen offset:64 sc1
    buffer_load_dwordx4 v[60:63], v9, s[8:11], s47 offen offset:128 sc1
    buffer_load_dwordx4 v[64:67], v9, s[8:11], s47 offen offset:192 sc1
    buffer_load_dwordx2 v[68:69], v10, s[8:11], s47 offen offset:2048 sc1
    buffer_load_dwordx2 v[70:71], v10, s[8:11], s47 offen offset:2560 sc1
    buffer_load_dwordx2 v[72:73], v10, s[8:11], s47 offen offset:3072 sc1
    buffer_load_dwordx2 v[74:75], v10, s[8:11], s47 offen offset:3584 sc1
    s_waitcnt vmcnt(9)
    s_cmp_lg_u32 s49, 0
    s_cselect_b64 exec, 1, 0
    buffer_store_dword v3, v4, s[8:11], s43 offen sc1
    s_mov_b64 exec, -1
    s_add_u32 s43, s43, s49
    s_mov_b32 s49, 0
    v_mfma_f32_16x16x32_bf16 v[32:35], v[172:175], v[140:143], 0
    v_mfma_f32_16x16x32_bf16 v[36:39], v[172:175], v[144:147], 0
    v_mfma_f32_16x16x32_bf16 v[40:43], v[176:179], v[144:147], 0
    v_mfma_f32_16x16x32_bf16 v[32:35], v[180:183], v[148:151], v[32:35]
    v_mfma_f32_16x16x32_bf16 v[36:39], v[180:183], v[152:155], v[36:39]
    v_mfma_f32_16x16x32_bf16 v[40:43], v[184:187], v[152:155], v[40:43]
    v_mfma_f32_16x16x32_bf16 v[32:35], v[188:191], v[156:159], v[32:35]
    v_mfma_f32_16x16x32_bf16 v[36:39], v[188:191], v[160:163], v[36:39]
    v_mfma_f32_16x16x32_bf16 v[40:43], v[192:195], v[160:163], v[40:43]
    v_mfma_f32_16x16x32_bf16 v[32:35], v[196:199], v[164:167], v[32:35]
    v_mfma_f32_16x16x32_bf16 v[36:39], v[196:199], v[168:171], v[36:39]
    v_mfma_f32_16x16x32_bf16 v[40:43], v[200:203], v[168:171], v[40:43]
    s_waitcnt vmcnt(1)
    v_cmp_eq_u32 vcc, 0, v15
    s_add_u32 s51, s51, 262144
    s_add_u32 s42, s42, 22528
    s_add_u32 s37, s37, 1
    s_cmp_eq_u64 vcc, 0
    s_cselect_b32 s39, 1, 0
    s_cmp_lt_u32 s37, 64
    s_cselect_b32 s39, s39, 0
    s_cmp_eq_u32 s39, 1
    s_cselect_b32 s30, 268435456, 0
    v_fma_f32 v32, v32, s52, v236
    v_fma_f32 v33, v33, s52, v237
    v_fma_f32 v34, v34, s52, v238
    v_fma_f32 v35, v35, s52, v239
    v_mul_f32 v36, s52, v36
    v_mul_f32 v37, s52, v37
    v_mul_f32 v38, s52, v38
    v_mul_f32 v39, s52, v39
    v_fma_f32 v40, v40, s52, v236
    v_fma_f32 v41, v41, s52, v237
    v_fma_f32 v42, v42, s52, v238
    v_fma_f32 v43, v43, s52, v239
    v_xor_b32 v5, s34, v52
    v_xor_b32 v6, s34, v56
    v_or_b32 v5, v5, v6
    v_xor_b32 v6, s34, v60
    v_or_b32 v5, v5, v6
    v_xor_b32 v6, s34, v64
    v_or_b32 v5, v5, v6
    v_xor_b32 v6, s34, v68
    v_or_b32 v5, v5, v6
    v_xor_b32 v6, s34, v70
    v_or_b32 v5, v5, v6
    v_xor_b32 v6, s34, v72
    v_or_b32 v5, v5, v6
    v_xor_b32 v6, s34, v74
    v_or_b32 v5, v5, v6
    v_and_b32 v5, 1, v5
    v_cmp_ne_u32 vcc, 0, v5
    s_nop 0
    s_cbranch_vccz LtaS0_r
    s_mov_b32 s16, 0
LtaS0_rp:
    buffer_load_dwordx4 v[52:55], v9, s[8:11], s47 offen offset:0 sc1
    buffer_load_dwordx4 v[56:59], v9, s[8:11], s47 offen offset:64 sc1
    buffer_load_dwordx4 v[60:63], v9, s[8:11], s47 offen offset:128 sc1
    buffer_load_dwordx4 v[64:67], v9, s[8:11], s47 offen offset:192 sc1
    buffer_load_dwordx2 v[68:69], v10, s[8:11], s47 offen offset:2048 sc1
    buffer_load_dwordx2 v[70:71], v10, s[8:11], s47 offen offset:2560 sc1
    buffer_load_dwordx2 v[72:73], v10, s[8:11], s47 offen offset:3072 sc1
    buffer_load_dwordx2 v[74:75], v10, s[8:11], s47 offen offset:3584 sc1
    s_add_u32 s16, s16, 1
    s_cmp_gt_u32 s16, 100000
    s_cbranch_scc1 L_role_ta_abort
    s_waitcnt vmcnt(0)
    v_xor_b32 v5, s34, v52
    v_xor_b32 v6, s34, v56
    v_or_b32 v5, v5, v6
    v_xor_b32 v6, s34, v60
    v_or_b32 v5, v5, v6
    v_xor_b32 v6, s34, v64
    v_or_b32 v5, v5, v6
    v_xor_b32 v6, s34, v68
    v_or_b32 v5, v5, v6
    v_xor_b32 v6, s34, v70
    v_or_b32 v5, v5, v6
    v_xor_b32 v6, s34, v72
    v_or_b32 v5, v5, v6
    v_xor_b32 v6, s34, v74
    v_or_b32 v5, v5, v6
    v_and_b32 v5, 1, v5
    v_cmp_ne_u32 vcc, 0, v5
    s_nop 0
    s_cbranch_vccz LtaS0_r
    s_sleep 2
    s_branch LtaS0_rp
LtaS0_r:
    s_add_u32 s46, s51, 0
    buffer_load_dwordx4 a[0:3], v0, s[28:31], s46 offen offset:0
    buffer_load_dwordx4 a[4:7], v0, s[28:31], s46 offen offset:1024
    v_mfma_f32_16x16x32_bf16 v[44:47], v[52:55], v[140:143], 0
    v_mfma_f32_16x16x32_bf16 v[48:51], v[52:55], v[144:147], 0
    v_mfma_f32_16x16x32_bf16 v[44:47], v[56:59], v[148:151], v[44:47]
    v_mfma_f32_16x16x32_bf16 v[48:51], v[56:59], v[152:155], v[48:51]
    v_mfma_f32_16x16x32_bf16 v[44:47], v[60:63], v[156:159], v[44:47]
    v_mfma_f32_16x16x32_bf16 v[48:51], v[60:63], v[160:163], v[48:51]
    v_mfma_f32_16x16x32_bf16 v[44:47], v[64:67], v[164:167], v[44:47]
    v_mfma_f32_16x16x32_bf16 v[48:51], v[64:67], v[168:171], v[48:51]
    v_max3_f32 v5, v32, v33, v34
    v_max_f32 v5, v5, v35
    s_nop 4
    v_mul_f32 v44, s52, v44
    v_mul_f32 v45, s52, v45
    v_max3_f32 v5, v5, v44, v45
    v_mov_b32 v6, v5
    buffer_load_dwordx4 a[8:11], v0, s[28:31], s46 offen offset:2048
    s_nop 0
    v_permlane32_swap_b32 v5, v6
    v_max_f32 v5, v5, v6
    v_mov_b32 v6, v5
    buffer_load_dwordx4 a[12:15], v0, s[28:31], s46 offen offset:3072
    s_nop 0
    v_permlane16_swap_b32 v5, v6
    v_max_f32 v5, v5, v6
    v_sub_f32 v32, v32, v5
    v_sub_f32 v33, v33, v5
    v_sub_f32 v34, v34, v5
    v_sub_f32 v35, v35, v5
    v_sub_f32 v44, v44, v5
    v_sub_f32 v45, v45, v5
    v_exp_f32 v32, v32
    v_exp_f32 v33, v33
    v_exp_f32 v34, v34
    v_exp_f32 v35, v35
    v_exp_f32 v44, v44
    v_exp_f32 v45, v45
    v_cvt_pk_bf16_f32 v24, v32, v33
    v_cvt_pk_bf16_f32 v25, v34, v35
    v_mov_b32 v26, 0
    v_mov_b32 v27, 0
    v_cvt_pk_bf16_f32 v20, v44, v45
    v_cvt_pk_bf16_f32 v23, v44, v45
    v_mfma_f32_16x16x32_bf16 v[28:31], v[16:19], v[24:27], 0
    v_mfma_f32_16x16x32_bf16 v[76:79], v[204:207], v[24:27], 0
    v_mfma_f32_16x16x32_bf16 v[80:83], v[208:211], v[24:27], 0
    s_add_u32 s46, s51, 4096
    buffer_load_dwordx4 a[16:19], v0, s[28:31], s46 offen offset:0
    v_mfma_f32_16x16x32_bf16 v[84:87], v[212:215], v[24:27], 0
    v_mfma_f32_16x16x32_bf16 v[88:91], v[216:219], v[24:27], 0
    buffer_load_dwordx4 a[20:23], v0, s[28:31], s46 offen offset:1024
    v_mfma_f32_16x16x32_bf16 v[92:95], v[220:223], v[24:27], 0
    v_mfma_f32_16x16x32_bf16 v[96:99], v[224:227], v[24:27], 0
    buffer_load_dwordx4 a[24:27], v0, s[28:31], s46 offen offset:2048
    v_mfma_f32_16x16x16_bf16 v[28:31], v[16:17], v[20:21], v[28:31]
    v_mfma_f32_16x16x32_bf16 v[100:103], v[228:231], v[24:27], 0
    v_mfma_f32_16x16x32_bf16 v[104:107], v[232:235], v[24:27], 0
    buffer_load_dwordx4 a[28:31], v0, s[28:31], s46 offen offset:3072
    v_mfma_f32_16x16x16_bf16 v[76:79], v[68:69], v[20:21], v[76:79]
    v_mfma_f32_16x16x16_bf16 v[80:83], v[68:69], v[22:23], v[80:83]
    s_nop 2
    v_rcp_f32 v6, v28
    v_mfma_f32_16x16x16_bf16 v[84:87], v[70:71], v[20:21], v[84:87]
    v_mfma_f32_16x16x16_bf16 v[88:91], v[70:71], v[22:23], v[88:91]
    s_nop 0
    v_mul_f32 v76, v6, v76
    v_mul_f32 v80, v6, v80
    v_cvt_pk_bf16_f32 v108, v76, v80
    v_mul_f32 v77, v6, v77
    v_mul_f32 v81, v6, v81
    v_cvt_pk_bf16_f32 v109, v77, v81
    v_mul_f32 v78, v6, v78
    v_mul_f32 v82, v6, v82
    v_cvt_pk_bf16_f32 v110, v78, v82
    v_mul_f32 v79, v6, v79
    v_mul_f32 v83, v6, v83
    v_cvt_pk_bf16_f32 v111, v79, v83
    s_add_u32 s17, s48, 0
    buffer_store_dwordx4 v[108:111], v0, s[8:11], s17 offen offset:0 sc1
    s_add_u32 s46, s51, 16777216
    buffer_load_dwordx4 a[32:35], v0, s[28:31], s46 offen offset:0
    v_mfma_f32_16x16x16_bf16 v[92:95], v[72:73], v[20:21], v[92:95]
    v_mfma_f32_16x16x16_bf16 v[96:99], v[72:73], v[22:23], v[96:99]
    v_mul_f32 v84, v6, v84
    v_mul_f32 v88, v6, v88
    v_cvt_pk_bf16_f32 v112, v84, v88
    v_mul_f32 v85, v6, v85
    v_mul_f32 v89, v6, v89
    v_cvt_pk_bf16_f32 v113, v85, v89
    v_mul_f32 v86, v6, v86
    v_mul_f32 v90, v6, v90
    v_cvt_pk_bf16_f32 v114, v86, v90
    v_mul_f32 v87, v6, v87
    v_mul_f32 v91, v6, v91
    v_cvt_pk_bf16_f32 v115, v87, v91
    buffer_store_dwordx4 v[112:115], v0, s[8:11], s17 offen offset:2048 sc1
    buffer_load_dwordx4 a[36:39], v0, s[28:31], s46 offen offset:1024
    v_mfma_f32_16x16x16_bf16 v[100:103], v[74:75], v[20:21], v[100:103]
    v_mfma_f32_16x16x16_bf16 v[104:107], v[74:75], v[22:23], v[104:107]
    v_mul_f32 v92, v6, v92
    v_mul_f32 v96, v6, v96
    v_cvt_pk_bf16_f32 v116, v92, v96
    v_mul_f32 v93, v6, v93
    v_mul_f32 v97, v6, v97
    v_cvt_pk_bf16_f32 v117, v93, v97
    v_mul_f32 v94, v6, v94
    v_mul_f32 v98, v6, v98
    v_cvt_pk_bf16_f32 v118, v94, v98
    v_mul_f32 v95, v6, v95
    v_mul_f32 v99, v6, v99
    v_cvt_pk_bf16_f32 v119, v95, v99
    s_add_u32 s17, s48, 4096
    buffer_store_dwordx4 v[116:119], v0, s[8:11], s17 offen offset:0 sc1
    buffer_load_dwordx4 a[40:43], v0, s[28:31], s46 offen offset:2048
    v_mul_f32 v100, v6, v100
    v_mul_f32 v104, v6, v104
    v_cvt_pk_bf16_f32 v120, v100, v104
    v_mul_f32 v101, v6, v101
    v_mul_f32 v105, v6, v105
    v_cvt_pk_bf16_f32 v121, v101, v105
    v_mul_f32 v102, v6, v102
    v_mul_f32 v106, v6, v106
    v_cvt_pk_bf16_f32 v122, v102, v106
    v_mul_f32 v103, v6, v103
    v_mul_f32 v107, v6, v107
    v_cvt_pk_bf16_f32 v123, v103, v107
    buffer_store_dwordx4 v[120:123], v0, s[8:11], s17 offen offset:2048 sc1
    buffer_load_dwordx4 a[44:47], v0, s[28:31], s46 offen offset:3072
    v_max3_f32 v5, v36, v37, v38
    v_max_f32 v5, v5, v39
    v_max3_f32 v5, v5, v40, v41
    v_max3_f32 v5, v5, v42, v43
    v_mul_f32 v48, s52, v48
    v_mul_f32 v49, s52, v49
    v_max3_f32 v5, v5, v48, v49
    v_mov_b32 v6, v5
    s_add_u32 s46, s51, 16781312
    buffer_load_dwordx4 a[48:51], v0, s[28:31], s46 offen offset:0
    v_permlane32_swap_b32 v5, v6
    v_max_f32 v5, v5, v6
    v_mov_b32 v6, v5
    buffer_load_dwordx4 a[52:55], v0, s[28:31], s46 offen offset:1024
    s_nop 0
    v_permlane16_swap_b32 v5, v6
    v_max_f32 v5, v5, v6
    v_sub_f32 v36, v36, v5
    v_sub_f32 v37, v37, v5
    v_sub_f32 v38, v38, v5
    v_sub_f32 v39, v39, v5
    v_sub_f32 v40, v40, v5
    v_sub_f32 v41, v41, v5
    v_sub_f32 v42, v42, v5
    v_sub_f32 v43, v43, v5
    v_sub_f32 v48, v48, v5
    v_sub_f32 v49, v49, v5
    v_exp_f32 v36, v36
    v_exp_f32 v37, v37
    v_exp_f32 v38, v38
    v_exp_f32 v39, v39
    v_exp_f32 v40, v40
    v_exp_f32 v41, v41
    v_exp_f32 v42, v42
    v_exp_f32 v43, v43
    v_exp_f32 v48, v48
    v_exp_f32 v49, v49
    v_cvt_pk_bf16_f32 v24, v36, v37
    v_cvt_pk_bf16_f32 v25, v38, v39
    v_cvt_pk_bf16_f32 v26, v40, v41
    v_cvt_pk_bf16_f32 v27, v42, v43
    v_cvt_pk_bf16_f32 v20, v48, v49
    v_cvt_pk_bf16_f32 v23, v48, v49
    v_mfma_f32_16x16x32_bf16 v[28:31], v[16:19], v[24:27], 0
    v_mfma_f32_16x16x32_bf16 v[76:79], v[204:207], v[24:27], 0
    v_mfma_f32_16x16x32_bf16 v[80:83], v[208:211], v[24:27], 0
    buffer_load_dwordx4 a[56:59], v0, s[28:31], s46 offen offset:2048
    v_mfma_f32_16x16x32_bf16 v[84:87], v[212:215], v[24:27], 0
    v_mfma_f32_16x16x32_bf16 v[88:91], v[216:219], v[24:27], 0
    buffer_load_dwordx4 a[60:63], v0, s[28:31], s46 offen offset:3072
    v_mfma_f32_16x16x32_bf16 v[92:95], v[220:223], v[24:27], 0
    v_mfma_f32_16x16x32_bf16 v[96:99], v[224:227], v[24:27], 0
    s_add_u32 s46, s51, 33554432
    buffer_load_dwordx4 a[64:67], v0, s[28:31], s46 offen offset:0
    v_mfma_f32_16x16x16_bf16 v[28:31], v[16:17], v[20:21], v[28:31]
    v_mfma_f32_16x16x32_bf16 v[100:103], v[228:231], v[24:27], 0
    v_mfma_f32_16x16x32_bf16 v[104:107], v[232:235], v[24:27], 0
    buffer_load_dwordx4 a[68:71], v0, s[28:31], s46 offen offset:1024
    v_mfma_f32_16x16x16_bf16 v[76:79], v[68:69], v[20:21], v[76:79]
    v_mfma_f32_16x16x16_bf16 v[80:83], v[68:69], v[22:23], v[80:83]
    s_nop 2
    v_rcp_f32 v6, v28
    v_mfma_f32_16x16x16_bf16 v[84:87], v[70:71], v[20:21], v[84:87]
    v_mfma_f32_16x16x16_bf16 v[88:91], v[70:71], v[22:23], v[88:91]
    s_nop 0
    v_mul_f32 v76, v6, v76
    v_mul_f32 v80, v6, v80
    v_cvt_pk_bf16_f32 v124, v76, v80
    v_mul_f32 v77, v6, v77
    v_mul_f32 v81, v6, v81
    v_cvt_pk_bf16_f32 v125, v77, v81
    v_mul_f32 v78, v6, v78
    v_mul_f32 v82, v6, v82
    v_cvt_pk_bf16_f32 v126, v78, v82
    v_mul_f32 v79, v6, v79
    v_mul_f32 v83, v6, v83
    v_cvt_pk_bf16_f32 v127, v79, v83
    s_add_u32 s17, s48, 0
    buffer_store_dwordx4 v[124:127], v0, s[8:11], s17 offen offset:1024 sc1
    buffer_load_dwordx4 a[72:75], v0, s[28:31], s46 offen offset:2048
    v_mfma_f32_16x16x16_bf16 v[92:95], v[72:73], v[20:21], v[92:95]
    v_mfma_f32_16x16x16_bf16 v[96:99], v[72:73], v[22:23], v[96:99]
    v_mul_f32 v84, v6, v84
    v_mul_f32 v88, v6, v88
    v_cvt_pk_bf16_f32 v128, v84, v88
    v_mul_f32 v85, v6, v85
    v_mul_f32 v89, v6, v89
    v_cvt_pk_bf16_f32 v129, v85, v89
    v_mul_f32 v86, v6, v86
    v_mul_f32 v90, v6, v90
    v_cvt_pk_bf16_f32 v130, v86, v90
    v_mul_f32 v87, v6, v87
    v_mul_f32 v91, v6, v91
    v_cvt_pk_bf16_f32 v131, v87, v91
    buffer_store_dwordx4 v[128:131], v0, s[8:11], s17 offen offset:3072 sc1
    buffer_load_dwordx4 a[76:79], v0, s[28:31], s46 offen offset:3072
    v_mfma_f32_16x16x16_bf16 v[100:103], v[74:75], v[20:21], v[100:103]
    v_mfma_f32_16x16x16_bf16 v[104:107], v[74:75], v[22:23], v[104:107]
    v_mul_f32 v92, v6, v92
    v_mul_f32 v96, v6, v96
    v_cvt_pk_bf16_f32 v132, v92, v96
    v_mul_f32 v93, v6, v93
    v_mul_f32 v97, v6, v97
    v_cvt_pk_bf16_f32 v133, v93, v97
    v_mul_f32 v94, v6, v94
    v_mul_f32 v98, v6, v98
    v_cvt_pk_bf16_f32 v134, v94, v98
    v_mul_f32 v95, v6, v95
    v_mul_f32 v99, v6, v99
    v_cvt_pk_bf16_f32 v135, v95, v99
    s_add_u32 s17, s48, 4096
    buffer_store_dwordx4 v[132:135], v0, s[8:11], s17 offen offset:1024 sc1
    s_add_u32 s46, s51, 33558528
    buffer_load_dwordx4 a[80:83], v0, s[28:31], s46 offen offset:0
    v_mul_f32 v100, v6, v100
    v_mul_f32 v104, v6, v104
    v_cvt_pk_bf16_f32 v136, v100, v104
    v_mul_f32 v101, v6, v101
    v_mul_f32 v105, v6, v105
    v_cvt_pk_bf16_f32 v137, v101, v105
    v_mul_f32 v102, v6, v102
    v_mul_f32 v106, v6, v106
    v_cvt_pk_bf16_f32 v138, v102, v106
    v_mul_f32 v103, v6, v103
    v_mul_f32 v107, v6, v107
    v_cvt_pk_bf16_f32 v139, v103, v107
    buffer_store_dwordx4 v[136:139], v0, s[8:11], s17 offen offset:3072 sc1
    buffer_load_dwordx4 a[84:87], v0, s[28:31], s46 offen offset:1024
    buffer_load_dwordx4 a[88:91], v0, s[28:31], s46 offen offset:2048
    buffer_load_dwordx4 a[92:95], v0, s[28:31], s46 offen offset:3072
    s_add_u32 s48, s48, 262144
    s_mov_b32 s49, 22528
    s_cmp_ge_u32 s37, 64
    s_cbranch_scc1 LtaS_end
LtaS1:
    s_and_b32 s17, s37, 7
    s_mul_i32 s17, s17, 131072
    s_add_u32 s47, s35, s17
    s_bfe_u32 s34, s37, 65539
    s_cmp_eq_u32 s39, 1
    s_cbranch_scc1 LtaS1_have
    s_waitcnt vmcnt(0)
    s_cmp_lg_u32 s49, 0
    s_cselect_b64 exec, 1, 0
    buffer_store_dword v3, v4, s[8:11], s43 offen sc1
    s_mov_b64 exec, -1
    s_add_u32 s43, s43, s49
    s_mov_b32 s49, 0
    s_mov_b32 s16, 0
LtaS1_f_7:
    buffer_load_dword v2, v1, s[8:11], s42 offen sc1
    s_add_u32 s16, s16, 1
    s_cmp_gt_u32 s16, 100000
    s_cbranch_scc1 L_role_ta_abort
    s_waitcnt vmcnt(0)
    v_cmp_eq_u32 vcc, 0, v2
    s_nop 0
    s_cbranch_vccz LtaS1_fd_8
    s_sleep 4
    s_branch LtaS1_f_7
LtaS1_fd_8:
    s_add_u32 s46, s51, 0
    buffer_load_dwordx4 a[0:3], v0, s[8:11], s46 offen offset:0
    buffer_load_dwordx4 a[4:7], v0, s[8:11], s46 offen offset:1024
    buffer_load_dwordx4 a[8:11], v0, s[8:11], s46 offen offset:2048
    buffer_load_dwordx4 a[12:15], v0, s[8:11], s46 offen offset:3072
    s_add_u32 s46, s51, 4096
    buffer_load_dwordx4 a[16:19], v0, s[8:11], s46 offen offset:0
    buffer_load_dwordx4 a[20:23], v0, s[8:11], s46 offen offset:1024
    buffer_load_dwordx4 a[24:27], v0, s[8:11], s46 offen offset:2048
    buffer_load_dwordx4 a[28:31], v0, s[8:11], s46 offen offset:3072
    s_add_u32 s46, s51, 16777216
    buffer_load_dwordx4 a[32:35], v0, s[8:11], s46 offen offset:0
    buffer_load_dwordx4 a[36:39], v0, s[8:11], s46 offen offset:1024
    buffer_load_dwordx4 a[40:43], v0, s[8:11], s46 offen offset:2048
    buffer_load_dwordx4 a[44:47], v0, s[8:11], s46 offen offset:3072
    s_add_u32 s46, s51, 16781312
    buffer_load_dwordx4 a[48:51], v0, s[8:11], s46 offen offset:0
    buffer_load_dwordx4 a[52:55], v0, s[8:11], s46 offen offset:1024
    buffer_load_dwordx4 a[56:59], v0, s[8:11], s46 offen offset:2048
    buffer_load_dwordx4 a[60:63], v0, s[8:11], s46 offen offset:3072
    s_add_u32 s46, s51, 33554432
    buffer_load_dwordx4 a[64:67], v0, s[8:11], s46 offen offset:0
    buffer_load_dwordx4 a[68:71], v0, s[8:11], s46 offen offset:1024
    buffer_load_dwordx4 a[72:75], v0, s[8:11], s46 offen offset:2048
    buffer_load_dwordx4 a[76:79], v0, s[8:11], s46 offen offset:3072
    s_add_u32 s46, s51, 33558528
    buffer_load_dwordx4 a[80:83], v0, s[8:11], s46 offen offset:0
    buffer_load_dwordx4 a[84:87], v0, s[8:11], s46 offen offset:1024
    buffer_load_dwordx4 a[88:91], v0, s[8:11], s46 offen offset:2048
    buffer_load_dwordx4 a[92:95], v0, s[8:11], s46 offen offset:3072
LtaS1_have:
    s_add_u32 s17, s42, 22528
    buffer_load_dword v15, v1, s[8:11], s17 offen sc1
    buffer_load_dwordx4 v[52:55], v9, s[8:11], s47 offen offset:0 sc1
    buffer_load_dwordx4 v[56:59], v9, s[8:11], s47 offen offset:64 sc1
    buffer_load_dwordx4 v[60:63], v9, s[8:11], s47 offen offset:128 sc1
    buffer_load_dwordx4 v[64:67], v9, s[8:11], s47 offen offset:192 sc1
    buffer_load_dwordx2 v[68:69], v10, s[8:11], s47 offen offset:2048 sc1
    buffer_load_dwordx2 v[70:71], v10, s[8:11], s47 offen offset:2560 sc1
    buffer_load_dwordx2 v[72:73], v10, s[8:11], s47 offen offset:3072 sc1
    buffer_load_dwordx2 v[74:75], v10, s[8:11], s47 offen offset:3584 sc1
    s_waitcnt vmcnt(9)
    s_cmp_lg_u32 s49, 0
    s_cselect_b64 exec, 1, 0
    buffer_store_dword v3, v4, s[8:11], s43 offen sc1
    s_mov_b64 exec, -1
    s_add_u32 s43, s43, s49
    s_mov_b32 s49, 0
    v_mfma_f32_16x16x32_bf16 v[32:35], a[32:35], a[0:3], 0
    v_mfma_f32_16x16x32_bf16 v[36:39], a[32:35], a[4:7], 0
    v_mfma_f32_16x16x32_bf16 v[40:43], a[36:39], a[4:7], 0
    v_mfma_f32_16x16x32_bf16 v[32:35], a[40:43], a[8:11], v[32:35]
    v_mfma_f32_16x16x32_bf16 v[36:39], a[40:43], a[12:15], v[36:39]
    v_mfma_f32_16x16x32_bf16 v[40:43], a[44:47], a[12:15], v[40:43]
    v_mfma_f32_16x16x32_bf16 v[32:35], a[48:51], a[16:19], v[32:35]
    v_mfma_f32_16x16x32_bf16 v[36:39], a[48:51], a[20:23], v[36:39]
    v_mfma_f32_16x16x32_bf16 v[40:43], a[52:55], a[20:23], v[40:43]
    v_mfma_f32_16x16x32_bf16 v[32:35], a[56:59], a[24:27], v[32:35]
    v_mfma_f32_16x16x32_bf16 v[36:39], a[56:59], a[28:31], v[36:39]
    v_mfma_f32_16x16x32_bf16 v[40:43], a[60:63], a[28:31], v[40:43]
    s_waitcnt vmcnt(1)
    v_cmp_eq_u32 vcc, 0, v15
    s_add_u32 s51, s51, 262144
    s_add_u32 s42, s42, 22528
    s_add_u32 s37, s37, 1
    s_cmp_eq_u64 vcc, 0
    s_cselect_b32 s39, 1, 0
    s_cmp_lt_u32 s37, 64
    s_cselect_b32 s39, s39, 0
    s_cmp_eq_u32 s39, 1
    s_cselect_b32 s30, 268435456, 0
    v_fma_f32 v32, v32, s52, v236
    v_fma_f32 v33, v33, s52, v237
    v_fma_f32 v34, v34, s52, v238
    v_fma_f32 v35, v35, s52, v239
    v_mul_f32 v36, s52, v36
    v_mul_f32 v37, s52, v37
    v_mul_f32 v38, s52, v38
    v_mul_f32 v39, s52, v39
    v_fma_f32 v40, v40, s52, v236
    v_fma_f32 v41, v41, s52, v237
    v_fma_f32 v42, v42, s52, v238
    v_fma_f32 v43, v43, s52, v239
    v_xor_b32 v5, s34, v52
    v_xor_b32 v6, s34, v56
    v_or_b32 v5, v5, v6
    v_xor_b32 v6, s34, v60
    v_or_b32 v5, v5, v6
    v_xor_b32 v6, s34, v64
    v_or_b32 v5, v5, v6
    v_xor_b32 v6, s34, v68
    v_or_b32 v5, v5, v6
    v_xor_b32 v6, s34, v70
    v_or_b32 v5, v5, v6
    v_xor_b32 v6, s34, v72
    v_or_b32 v5, v5, v6
    v_xor_b32 v6, s34, v74
    v_or_b32 v5, v5, v6
    v_and_b32 v5, 1, v5
    v_cmp_ne_u32 vcc, 0, v5
    s_nop 0
    s_cbranch_vccz LtaS1_r
    s_mov_b32 s16, 0
LtaS1_rp:
    buffer_load_dwordx4 v[52:55], v9, s[8:11], s47 offen offset:0 sc1
    buffer_load_dwordx4 v[56:59], v9, s[8:11], s47 offen offset:64 sc1
    buffer_load_dwordx4 v[60:63], v9, s[8:11], s47 offen offset:128 sc1
    buffer_load_dwordx4 v[64:67], v9, s[8:11], s47 offen offset:192 sc1
    buffer_load_dwordx2 v[68:69], v10, s[8:11], s47 offen offset:2048 sc1
    buffer_load_dwordx2 v[70:71], v10, s[8:11], s47 offen offset:2560 sc1
    buffer_load_dwordx2 v[72:73], v10, s[8:11], s47 offen offset:3072 sc1
    buffer_load_dwordx2 v[74:75], v10, s[8:11], s47 offen offset:3584 sc1
    s_add_u32 s16, s16, 1
    s_cmp_gt_u32 s16, 100000
    s_cbranch_scc1 L_role_ta_abort
    s_waitcnt vmcnt(0)
    v_xor_b32 v5, s34, v52
    v_xor_b32 v6, s34, v56
    v_or_b32 v5, v5, v6
    v_xor_b32 v6, s34, v60
    v_or_b32 v5, v5, v6
    v_xor_b32 v6, s34, v64
    v_or_b32 v5, v5, v6
    v_xor_b32 v6, s34, v68
    v_or_b32 v5, v5, v6
    v_xor_b32 v6, s34, v70
    v_or_b32 v5, v5, v6
    v_xor_b32 v6, s34, v72
    v_or_b32 v5, v5, v6
    v_xor_b32 v6, s34, v74
    v_or_b32 v5, v5, v6
    v_and_b32 v5, 1, v5
    v_cmp_ne_u32 vcc, 0, v5
    s_nop 0
    s_cbranch_vccz LtaS1_r
    s_sleep 2
    s_branch LtaS1_rp
LtaS1_r:
    s_add_u32 s46, s51, 0
    buffer_load_dwordx4 v[140:143], v0, s[28:31], s46 offen offset:0
    buffer_load_dwordx4 v[144:147], v0, s[28:31], s46 offen offset:1024
    v_mfma_f32_16x16x32_bf16 v[44:47], v[52:55], a[0:3], 0
    v_mfma_f32_16x16x32_bf16 v[48:51], v[52:55], a[4:7], 0
    v_mfma_f32_16x16x32_bf16 v[44:47], v[56:59], a[8:11], v[44:47]
    v_mfma_f32_16x16x32_bf16 v[48:51], v[56:59], a[12:15], v[48:51]
    v_mfma_f32_16x16x32_bf16 v[44:47], v[60:63], a[16:19], v[44:47]
    v_mfma_f32_16x16x32_bf16 v[48:51], v[60:63], a[20:23], v[48:51]
    v_mfma_f32_16x16x32_bf16 v[44:47], v[64:67], a[24:27], v[44:47]
    v_mfma_f32_16x16x32_bf16 v[48:51], v[64:67], a[28:31], v[48:51]
    v_max3_f32 v5, v32, v33, v34
    v_max_f32 v5, v5, v35
    s_nop 4
    v_mul_f32 v44, s52, v44
    v_mul_f32 v45, s52, v45
    v_max3_f32 v5, v5, v44, v45
    v_mov_b32 v6, v5
    buffer_load_dwordx4 v[148:151], v0, s[28:31], s46 offen offset:2048
    s_nop 0
    v_permlane32_swap_b32 v5, v6
    v_max_f32 v5, v5, v6
    v_mov_b32 v6, v5
    buffer_load_dwordx4 v[152:155], v0, s[28:31], s46 offen offset:3072
    s_nop 0
    v_permlane16_swap_b32 v5, v6
    v_max_f32 v5, v5, v6
    v_sub_f32 v32, v32, v5
    v_sub_f32 v33, v33, v5
    v_sub_f32 v34, v34, v5
    v_sub_f32 v35, v35, v5
    v_sub_f32 v44, v44, v5
    v_sub_f32 v45, v45, v5
    v_exp_f32 v32, v32
    v_exp_f32 v33, v33
    v_exp_f32 v34, v34
    v_exp_f32 v35, v35
    v_exp_f32 v44, v44
    v_exp_f32 v45, v45
    v_cvt_pk_bf16_f32 v24, v32, v33
    v_cvt_pk_bf16_f32 v25, v34, v35
    v_mov_b32 v26, 0
    v_mov_b32 v27, 0
    v_cvt_pk_bf16_f32 v20, v44, v45
    v_cvt_pk_bf16_f32 v23, v44, v45
    v_mfma_f32_16x16x32_bf16 v[28:31], v[16:19], v[24:27], 0
    v_mfma_f32_16x16x32_bf16 v[76:79], a[64:67], v[24:27], 0
    v_mfma_f32_16x16x32_bf16 v[80:83], a[68:71], v[24:27], 0
    s_add_u32 s46, s51, 4096
    buffer_load_dwordx4 v[156:159], v0, s[28:31], s46 offen offset:0
    v_mfma_f32_16x16x32_bf16 v[84:87], a[72:75], v[24:27], 0
    v_mfma_f32_16x16x32_bf16 v[88:91], a[76:79], v[24:27], 0
    buffer_load_dwordx4 v[160:163], v0, s[28:31], s46 offen offset:1024
    v_mfma_f32_16x16x32_bf16 v[92:95], a[80:83], v[24:27], 0
    v_mfma_f32_16x16x32_bf16 v[96:99], a[84:87], v[24:27], 0
    buffer_load_dwordx4 v[164:167], v0, s[28:31], s46 offen offset:2048
    v_mfma_f32_16x16x16_bf16 v[28:31], v[16:17], v[20:21], v[28:31]
    v_mfma_f32_16x16x32_bf16 v[100:103], a[88:91], v[24:27], 0
    v_mfma_f32_16x16x32_bf16 v[104:107], a[92:95], v[24:27], 0
    buffer_load_dwordx4 v[168:171], v0, s[28:31], s46 offen offset:3072
    v_mfma_f32_16x16x16_bf16 v[76:79], v[68:69], v[20:21], v[76:79]
    v_mfma_f32_16x16x16_bf16 v[80:83], v[68:69], v[22:23], v[80:83]
    s_nop 2
    v_rcp_f32 v6, v28
    v_mfma_f32_16x16x16_bf16 v[84:87], v[70:71], v[20:21], v[84:87]
    v_mfma_f32_16x16x16_bf16 v[88:91], v[70:71], v[22:23], v[88:91]
    s_nop 0
    v_mul_f32 v76, v6, v76
    v_mul_f32 v80, v6, v80
    v_cvt_pk_bf16_f32 v108, v76, v80
    v_mul_f32 v77, v6, v77
    v_mul_f32 v81, v6, v81
    v_cvt_pk_bf16_f32 v109, v77, v81
    v_mul_f32 v78, v6, v78
    v_mul_f32 v82, v6, v82
    v_cvt_pk_bf16_f32 v110, v78, v82
    v_mul_f32 v79, v6, v79
    v_mul_f32 v83, v6, v83
    v_cvt_pk_bf16_f32 v111, v79, v83
    s_add_u32 s17, s48, 0
    buffer_store_dwordx4 v[108:111], v0, s[8:11], s17 offen offset:0 sc1
    s_add_u32 s46, s51, 16777216
    buffer_load_dwordx4 v[172:175], v0, s[28:31], s46 offen offset:0
    v_mfma_f32_16x16x16_bf16 v[92:95], v[72:73], v[20:21], v[92:95]
    v_mfma_f32_16x16x16_bf16 v[96:99], v[72:73], v[22:23], v[96:99]
    v_mul_f32 v84, v6, v84
    v_mul_f32 v88, v6, v88
    v_cvt_pk_bf16_f32 v112, v84, v88
    v_mul_f32 v85, v6, v85
    v_mul_f32 v89, v6, v89
    v_cvt_pk_bf16_f32 v113, v85, v89
    v_mul_f32 v86, v6, v86
    v_mul_f32 v90, v6, v90
    v_cvt_pk_bf16_f32 v114, v86, v90
    v_mul_f32 v87, v6, v87
    v_mul_f32 v91, v6, v91
    v_cvt_pk_bf16_f32 v115, v87, v91
    buffer_store_dwordx4 v[112:115], v0, s[8:11], s17 offen offset:2048 sc1
    buffer_load_dwordx4 v[176:179], v0, s[28:31], s46 offen offset:1024
    v_mfma_f32_16x16x16_bf16 v[100:103], v[74:75], v[20:21], v[100:103]
    v_mfma_f32_16x16x16_bf16 v[104:107], v[74:75], v[22:23], v[104:107]
    v_mul_f32 v92, v6, v92
    v_mul_f32 v96, v6, v96
    v_cvt_pk_bf16_f32 v116, v92, v96
    v_mul_f32 v93, v6, v93
    v_mul_f32 v97, v6, v97
    v_cvt_pk_bf16_f32 v117, v93, v97
    v_mul_f32 v94, v6, v94
    v_mul_f32 v98, v6, v98
    v_cvt_pk_bf16_f32 v118, v94, v98
    v_mul_f32 v95, v6, v95
    v_mul_f32 v99, v6, v99
    v_cvt_pk_bf16_f32 v119, v95, v99
    s_add_u32 s17, s48, 4096
    buffer_store_dwordx4 v[116:119], v0, s[8:11], s17 offen offset:0 sc1
    buffer_load_dwordx4 v[180:183], v0, s[28:31], s46 offen offset:2048
    v_mul_f32 v100, v6, v100
    v_mul_f32 v104, v6, v104
    v_cvt_pk_bf16_f32 v120, v100, v104
    v_mul_f32 v101, v6, v101
    v_mul_f32 v105, v6, v105
    v_cvt_pk_bf16_f32 v121, v101, v105
    v_mul_f32 v102, v6, v102
    v_mul_f32 v106, v6, v106
    v_cvt_pk_bf16_f32 v122, v102, v106
    v_mul_f32 v103, v6, v103
    v_mul_f32 v107, v6, v107
    v_cvt_pk_bf16_f32 v123, v103, v107
    buffer_store_dwordx4 v[120:123], v0, s[8:11], s17 offen offset:2048 sc1
    buffer_load_dwordx4 v[184:187], v0, s[28:31], s46 offen offset:3072
    v_max3_f32 v5, v36, v37, v38
    v_max_f32 v5, v5, v39
    v_max3_f32 v5, v5, v40, v41
    v_max3_f32 v5, v5, v42, v43
    v_mul_f32 v48, s52, v48
    v_mul_f32 v49, s52, v49
    v_max3_f32 v5, v5, v48, v49
    v_mov_b32 v6, v5
    s_add_u32 s46, s51, 16781312
    buffer_load_dwordx4 v[188:191], v0, s[28:31], s46 offen offset:0
    v_permlane32_swap_b32 v5, v6
    v_max_f32 v5, v5, v6
    v_mov_b32 v6, v5
    buffer_load_dwordx4 v[192:195], v0, s[28:31], s46 offen offset:1024
    s_nop 0
    v_permlane16_swap_b32 v5, v6
    v_max_f32 v5, v5, v6
    v_sub_f32 v36, v36, v5
    v_sub_f32 v37, v37, v5
    v_sub_f32 v38, v38, v5
    v_sub_f32 v39, v39, v5
    v_sub_f32 v40, v40, v5
    v_sub_f32 v41, v41, v5
    v_sub_f32 v42, v42, v5
    v_sub_f32 v43, v43, v5
    v_sub_f32 v48, v48, v5
    v_sub_f32 v49, v49, v5
    v_exp_f32 v36, v36
    v_exp_f32 v37, v37
    v_exp_f32 v38, v38
    v_exp_f32 v39, v39
    v_exp_f32 v40, v40
    v_exp_f32 v41, v41
    v_exp_f32 v42, v42
    v_exp_f32 v43, v43
    v_exp_f32 v48, v48
    v_exp_f32 v49, v49
    v_cvt_pk_bf16_f32 v24, v36, v37
    v_cvt_pk_bf16_f32 v25, v38, v39
    v_cvt_pk_bf16_f32 v26, v40, v41
    v_cvt_pk_bf16_f32 v27, v42, v43
    v_cvt_pk_bf16_f32 v20, v48, v49
    v_cvt_pk_bf16_f32 v23, v48, v49
    v_mfma_f32_16x16x32_bf16 v[28:31], v[16:19], v[24:27], 0
    v_mfma_f32_16x16x32_bf16 v[76:79], a[64:67], v[24:27], 0
    v_mfma_f32_16x16x32_bf16 v[80:83], a[68:71], v[24:27], 0
    buffer_load_dwordx4 v[196:199], v0, s[28:31], s46 offen offset:2048
    v_mfma_f32_16x16x32_bf16 v[84:87], a[72:75], v[24:27], 0
    v_mfma_f32_16x16x32_bf16 v[88:91], a[76:79], v[24:27], 0
    buffer_load_dwordx4 v[200:203], v0, s[28:31], s46 offen offset:3072
    v_mfma_f32_16x16x32_bf16 v[92:95], a[80:83], v[24:27], 0
    v_mfma_f32_16x16x32_bf16 v[96:99], a[84:87], v[24:27], 0
    s_add_u32 s46, s51, 33554432
    buffer_load_dwordx4 v[204:207], v0, s[28:31], s46 offen offset:0
    v_mfma_f32_16x16x16_bf16 v[28:31], v[16:17], v[20:21], v[28:31]
    v_mfma_f32_16x16x32_bf16 v[100:103], a[88:91], v[24:27], 0
    v_mfma_f32_16x16x32_bf16 v[104:107], a[92:95], v[24:27], 0
    buffer_load_dwordx4 v[208:211], v0, s[28:31], s46 offen offset:1024
    v_mfma_f32_16x16x16_bf16 v[76:79], v[68:69], v[20:21], v[76:79]
    v_mfma_f32_16x16x16_bf16 v[80:83], v[68:69], v[22:23], v[80:83]
    s_nop 2
    v_rcp_f32 v6, v28
    v_mfma_f32_16x16x16_bf16 v[84:87], v[70:71], v[20:21], v[84:87]
    v_mfma_f32_16x16x16_bf16 v[88:91], v[70:71], v[22:23], v[88:91]
    s_nop 0
    v_mul_f32 v76, v6, v76
    v_mul_f32 v80, v6, v80
    v_cvt_pk_bf16_f32 v124, v76, v80
    v_mul_f32 v77, v6, v77
    v_mul_f32 v81, v6, v81
    v_cvt_pk_bf16_f32 v125, v77, v81
    v_mul_f32 v78, v6, v78
    v_mul_f32 v82, v6, v82
    v_cvt_pk_bf16_f32 v126, v78, v82
    v_mul_f32 v79, v6, v79
    v_mul_f32 v83, v6, v83
    v_cvt_pk_bf16_f32 v127, v79, v83
    s_add_u32 s17, s48, 0
    buffer_store_dwordx4 v[124:127], v0, s[8:11], s17 offen offset:1024 sc1
    buffer_load_dwordx4 v[212:215], v0, s[28:31], s46 offen offset:2048
    v_mfma_f32_16x16x16_bf16 v[92:95], v[72:73], v[20:21], v[92:95]
    v_mfma_f32_16x16x16_bf16 v[96:99], v[72:73], v[22:23], v[96:99]
    v_mul_f32 v84, v6, v84
    v_mul_f32 v88, v6, v88
    v_cvt_pk_bf16_f32 v128, v84, v88
    v_mul_f32 v85, v6, v85
    v_mul_f32 v89, v6, v89
    v_cvt_pk_bf16_f32 v129, v85, v89
    v_mul_f32 v86, v6, v86
    v_mul_f32 v90, v6, v90
    v_cvt_pk_bf16_f32 v130, v86, v90
    v_mul_f32 v87, v6, v87
    v_mul_f32 v91, v6, v91
    v_cvt_pk_bf16_f32 v131, v87, v91
    buffer_store_dwordx4 v[128:131], v0, s[8:11], s17 offen offset:3072 sc1
    buffer_load_dwordx4 v[216:219], v0, s[28:31], s46 offen offset:3072
    v_mfma_f32_16x16x16_bf16 v[100:103], v[74:75], v[20:21], v[100:103]
    v_mfma_f32_16x16x16_bf16 v[104:107], v[74:75], v[22:23], v[104:107]
    v_mul_f32 v92, v6, v92
    v_mul_f32 v96, v6, v96
    v_cvt_pk_bf16_f32 v132, v92, v96
    v_mul_f32 v93, v6, v93
    v_mul_f32 v97, v6, v97
    v_cvt_pk_bf16_f32 v133, v93, v97
    v_mul_f32 v94, v6, v94
    v_mul_f32 v98, v6, v98
    v_cvt_pk_bf16_f32 v134, v94, v98
    v_mul_f32 v95, v6, v95
    v_mul_f32 v99, v6, v99
    v_cvt_pk_bf16_f32 v135, v95, v99
    s_add_u32 s17, s48, 4096
    buffer_store_dwordx4 v[132:135], v0, s[8:11], s17 offen offset:1024 sc1
    s_add_u32 s46, s51, 33558528
    buffer_load_dwordx4 v[220:223], v0, s[28:31], s46 offen offset:0
    v_mul_f32 v100, v6, v100
    v_mul_f32 v104, v6, v104
    v_cvt_pk_bf16_f32 v136, v100, v104
    v_mul_f32 v101, v6, v101
    v_mul_f32 v105, v6, v105
    v_cvt_pk_bf16_f32 v137, v101, v105
    v_mul_f32 v102, v6, v102
    v_mul_f32 v106, v6, v106
    v_cvt_pk_bf16_f32 v138, v102, v106
    v_mul_f32 v103, v6, v103
    v_mul_f32 v107, v6, v107
    v_cvt_pk_bf16_f32 v139, v103, v107
    buffer_store_dwordx4 v[136:139], v0, s[8:11], s17 offen offset:3072 sc1
    buffer_load_dwordx4 v[224:227], v0, s[28:31], s46 offen offset:1024
    buffer_load_dwordx4 v[228:231], v0, s[28:31], s46 offen offset:2048
    buffer_load_dwordx4 v[232:235], v0, s[28:31], s46 offen offset:3072
    s_add_u32 s48, s48, 262144
    s_mov_b32 s49, 22528
    s_cmp_ge_u32 s37, 64
    s_cbranch_scc1 LtaS_end
    s_branch LtaS0
LtaS_end:
    s_waitcnt vmcnt(0)
    s_cmp_lg_u32 s49, 0
    s_cselect_b64 exec, 1, 0
    buffer_store_dword v3, v4, s[8:11], s43 offen sc1
    s_mov_b64 exec, -1
    s_add_u32 s43, s43, s49
    s_mov_b32 s49, 0
    s_branch L_role_ta_exit
L_role_ta_abort:
    s_waitcnt lgkmcnt(0)
    s_mov_b64 exec, -1
    v_mov_b32 v0, 60
    s_lshl_b32 s5, s3, 8
    s_or_b32 s5, s5, s4
    s_or_b32 s5, s5, 0x10000
    v_mov_b32 v1, s5
    global_store_dword v0, v1, s[12:13]
    s_endpgm
L_role_ta_exit:
    s_endpgm
.p2align 6
L_role_tw:
    v_and_b32 v5, 63, v0
    v_lshlrev_b32 v0, 4, v5
    v_and_b32 v7, 15, v5
    v_lshrrev_b32 v8, 4, v5
    v_min_u32 v1, 31, v5
    v_lshrrev_b32 v6, 2, v1
    v_and_b32 v1, 3, v1
    v_lshlrev_b32 v1, 2, v1
    v_lshl_add_u32 v1, v6, 7, v1
    v_mov_b32 v3, 1
    v_mov_b32 v4, 0
    s_mov_b32 s44, 0x05040100
    s_mov_b32 s45, 0x07060302
    s_cmp_lt_u32 s15, 24
    s_cbranch_scc1 Ltw_noord
    s_cmp_lg_u32 s14, 0
    s_cbranch_scc1 Ltw_ord_d
    v_mov_b32 v5, 48
    s_mov_b32 s16, 0
Ltw_ord:
    global_load_dword v6, v5, s[12:13] sc1
    s_add_u32 s16, s16, 1
    s_cmp_gt_u32 s16, 100000
    s_cbranch_scc1 L_role_tw_abort
    s_waitcnt vmcnt(0)
    v_cmp_gt_u32 vcc, 1, v6
    s_nop 0
    s_cbranch_vccz Ltw_ord_d
    s_sleep 64
    s_branch Ltw_ord
Ltw_ord_d:
    s_barrier
Ltw_noord:
    s_load_dwordx2 s[20:21], s[0:1], 64
    s_mov_b32 s22, 4718592
    s_mov_b32 s23, 0x00020000
    s_waitcnt lgkmcnt(0)
    s_and_b32 s21, s21, 0xffff
    s_load_dwordx2 s[24:25], s[0:1], 80
    s_mov_b32 s26, 2359296
    s_mov_b32 s27, 0x00020000
    s_waitcnt lgkmcnt(0)
    s_and_b32 s25, s25, 0xffff
    s_mul_i32 s17, s15, 43
    s_lshr_b32 s32, s17, 9
    s_mul_i32 s17, s32, 12
    s_sub_u32 s50, s15, s17
    s_add_u32 s33, s32, 34
    s_cmp_eq_u32 s32, 2
    s_cselect_b32 s33, 0, s33
    s_cselect_b32 s32, 64, s32
    s_mul_i32 s49, s50, 96
    s_mul_i32 s17, s14, 1179648
    s_add_u32 s49, s49, s17
    v_mul_u32_u24 v5, 4608, v8
    v_lshl_add_u32 v9, v7, 2, v5
    v_add_u32 v10, 18432, v9
    v_and_b32 v6, 14, v7
    v_lshl_add_u32 v12, v6, 1, v5
    v_add_u32 v12, 64, v12
    v_add_u32 v13, 18432, v12
    v_and_b32 v5, 1, v7
    v_mov_b32 v11, s44
    v_mov_b32 v6, s45
    v_cmp_eq_u32 vcc, 1, v5
    s_nop 1
    v_cndmask_b32 v11, v11, v6, vcc
    s_add_u32 s17, s49, 0
    buffer_load_dword v16, v9, s[20:23], s17 offen
    buffer_load_dword v17, v10, s[20:23], s17 offen
    buffer_load_dword v18, v12, s[20:23], s17 offen
    buffer_load_dword v19, v13, s[20:23], s17 offen
    s_add_u32 s17, s49, 1152
    buffer_load_dword v20, v9, s[20:23], s17 offen
    buffer_load_dword v21, v10, s[20:23], s17 offen
    buffer_load_dword v22, v12, s[20:23], s17 offen
    buffer_load_dword v23, v13, s[20:23], s17 offen
    s_add_u32 s17, s49, 2304
    buffer_load_dword v24, v9, s[20:23], s17 offen
    buffer_load_dword v25, v10, s[20:23], s17 offen
    buffer_load_dword v26, v12, s[20:23], s17 offen
    buffer_load_dword v27, v13, s[20:23], s17 offen
    s_add_u32 s17, s49, 3456
    buffer_load_dword v28, v9, s[20:23], s17 offen
    buffer_load_dword v29, v10, s[20:23], s17 offen
    buffer_load_dword v30, v12, s[20:23], s17 offen
    buffer_load_dword v31, v13, s[20:23], s17 offen
    s_add_u32 s17, s49, 36864
    buffer_load_dword v32, v9, s[20:23], s17 offen
    buffer_load_dword v33, v10, s[20:23], s17 offen
    buffer_load_dword v34, v12, s[20:23], s17 offen
    buffer_load_dword v35, v13, s[20:23], s17 offen
    s_add_u32 s17, s49, 38016
    buffer_load_dword v36, v9, s[20:23], s17 offen
    buffer_load_dword v37, v10, s[20:23], s17 offen
    buffer_load_dword v38, v12, s[20:23], s17 offen
    buffer_load_dword v39, v13, s[20:23], s17 offen
    s_add_u32 s17, s49, 39168
    buffer_load_dword v40, v9, s[20:23], s17 offen
    buffer_load_dword v41, v10, s[20:23], s17 offen
    buffer_load_dword v42, v12, s[20:23], s17 offen
    buffer_load_dword v43, v13, s[20:23], s17 offen
    s_add_u32 s17, s49, 40320
    buffer_load_dword v44, v9, s[20:23], s17 offen
    buffer_load_dword v45, v10, s[20:23], s17 offen
    buffer_load_dword v46, v12, s[20:23], s17 offen
    buffer_load_dword v47, v13, s[20:23], s17 offen
    s_add_u32 s17, s49, 73728
    buffer_load_dword v48, v9, s[20:23], s17 offen
    buffer_load_dword v49, v10, s[20:23], s17 offen
    buffer_load_dword v50, v12, s[20:23], s17 offen
    buffer_load_dword v51, v13, s[20:23], s17 offen
    s_add_u32 s17, s49, 74880
    buffer_load_dword v52, v9, s[20:23], s17 offen
    buffer_load_dword v53, v10, s[20:23], s17 offen
    buffer_load_dword v54, v12, s[20:23], s17 offen
    buffer_load_dword v55, v13, s[20:23], s17 offen
    s_add_u32 s17, s49, 76032
    buffer_load_dword v56, v9, s[20:23], s17 offen
    buffer_load_dword v57, v10, s[20:23], s17 offen
    buffer_load_dword v58, v12, s[20:23], s17 offen
    buffer_load_dword v59, v13, s[20:23], s17 offen
    s_add_u32 s17, s49, 77184
    buffer_load_dword v60, v9, s[20:23], s17 offen
    buffer_load_dword v61, v10, s[20:23], s17 offen
    buffer_load_dword v62, v12, s[20:23], s17 offen
    buffer_load_dword v63, v13, s[20:23], s17 offen
    s_add_u32 s17, s49, 110592
    buffer_load_dword v64, v9, s[20:23], s17 offen
    buffer_load_dword v65, v10, s[20:23], s17 offen
    buffer_load_dword v66, v12, s[20:23], s17 offen
    buffer_load_dword v67, v13, s[20:23], s17 offen
    s_add_u32 s17, s49, 111744
    buffer_load_dword v68, v9, s[20:23], s17 offen
    buffer_load_dword v69, v10, s[20:23], s17 offen
    buffer_load_dword v70, v12, s[20:23], s17 offen
    buffer_load_dword v71, v13, s[20:23], s17 offen
    s_add_u32 s17, s49, 112896
    buffer_load_dword v72, v9, s[20:23], s17 offen
    buffer_load_dword v73, v10, s[20:23], s17 offen
    buffer_load_dword v74, v12, s[20:23], s17 offen
    buffer_load_dword v75, v13, s[20:23], s17 offen
    s_waitcnt vmcnt(58)
    v_perm_b32 v5, v17, v16, s44
    v_perm_b32 v6, v17, v16, s45
    s_waitcnt vmcnt(56)
    v_perm_b32 v128, v19, v18, v11
    v_accvgpr_write_b32 a0, v5
    v_accvgpr_write_b32 a4, v6
    s_add_u32 s17, s49, 114048
    buffer_load_dword v76, v9, s[20:23], s17 offen
    buffer_load_dword v77, v10, s[20:23], s17 offen
    buffer_load_dword v78, v12, s[20:23], s17 offen
    buffer_load_dword v79, v13, s[20:23], s17 offen
    s_waitcnt vmcnt(58)
    v_perm_b32 v5, v21, v20, s44
    v_perm_b32 v6, v21, v20, s45
    s_waitcnt vmcnt(56)
    v_perm_b32 v129, v23, v22, v11
    v_accvgpr_write_b32 a1, v5
    v_accvgpr_write_b32 a5, v6
    s_add_u32 s17, s49, 147456
    buffer_load_dword v80, v9, s[20:23], s17 offen
    buffer_load_dword v81, v10, s[20:23], s17 offen
    buffer_load_dword v82, v12, s[20:23], s17 offen
    buffer_load_dword v83, v13, s[20:23], s17 offen
    s_waitcnt vmcnt(58)
    v_perm_b32 v5, v25, v24, s44
    v_perm_b32 v6, v25, v24, s45
    s_waitcnt vmcnt(56)
    v_perm_b32 v130, v27, v26, v11
    v_accvgpr_write_b32 a2, v5
    v_accvgpr_write_b32 a6, v6
    s_add_u32 s17, s49, 148608
    buffer_load_dword v84, v9, s[20:23], s17 offen
    buffer_load_dword v85, v10, s[20:23], s17 offen
    buffer_load_dword v86, v12, s[20:23], s17 offen
    buffer_load_dword v87, v13, s[20:23], s17 offen
    s_waitcnt vmcnt(58)
    v_perm_b32 v5, v29, v28, s44
    v_perm_b32 v6, v29, v28, s45
    s_waitcnt vmcnt(56)
    v_perm_b32 v131, v31, v30, v11
    v_accvgpr_write_b32 a3, v5
    v_accvgpr_write_b32 a7, v6
    s_add_u32 s17, s49, 149760
    buffer_load_dword v88, v9, s[20:23], s17 offen
    buffer_load_dword v89, v10, s[20:23], s17 offen
    buffer_load_dword v90, v12, s[20:23], s17 offen
    buffer_load_dword v91, v13, s[20:23], s17 offen
    s_waitcnt vmcnt(58)
    v_perm_b32 v5, v33, v32, s44
    v_perm_b32 v6, v33, v32, s45
    s_waitcnt vmcnt(56)
    v_perm_b32 v132, v35, v34, v11
    v_accvgpr_write_b32 a8, v5
    v_accvgpr_write_b32 a12, v6
    s_add_u32 s17, s49, 150912
    buffer_load_dword v92, v9, s[20:23], s17 offen
    buffer_load_dword v93, v10, s[20:23], s17 offen
    buffer_load_dword v94, v12, s[20:23], s17 offen
    buffer_load_dword v95, v13, s[20:23], s17 offen
    s_waitcnt vmcnt(58)
    v_perm_b32 v5, v37, v36, s44
    v_perm_b32 v6, v37, v36, s45
    s_waitcnt vmcnt(56)
    v_perm_b32 v133, v39, v38, v11
    v_accvgpr_write_b32 a9, v5
    v_accvgpr_write_b32 a13, v6
    s_add_u32 s17, s49, 184320
    buffer_load_dword v96, v9, s[20:23], s17 offen
    buffer_load_dword v97, v10, s[20:23], s17 offen
    buffer_load_dword v98, v12, s[20:23], s17 offen
    buffer_load_dword v99, v13, s[20:23], s17 offen
    s_waitcnt vmcnt(58)
    v_perm_b32 v5, v41, v40, s44
    v_perm_b32 v6, v41, v40, s45
    s_waitcnt vmcnt(56)
    v_perm_b32 v134, v43, v42, v11
    v_accvgpr_write_b32 a10, v5
    v_accvgpr_write_b32 a14, v6
    s_add_u32 s17, s49, 185472
    buffer_load_dword v100, v9, s[20:23], s17 offen
    buffer_load_dword v101, v10, s[20:23], s17 offen
    buffer_load_dword v102, v12, s[20:23], s17 offen
    buffer_load_dword v103, v13, s[20:23], s17 offen
    s_waitcnt vmcnt(58)
    v_perm_b32 v5, v45, v44, s44
    v_perm_b32 v6, v45, v44, s45
    s_waitcnt vmcnt(56)
    v_perm_b32 v135, v47, v46, v11
    v_accvgpr_write_b32 a11, v5
    v_accvgpr_write_b32 a15, v6
    s_add_u32 s17, s49, 186624
    buffer_load_dword v104, v9, s[20:23], s17 offen
    buffer_load_dword v105, v10, s[20:23], s17 offen
    buffer_load_dword v106, v12, s[20:23], s17 offen
    buffer_load_dword v107, v13, s[20:23], s17 offen
    s_waitcnt vmcnt(58)
    v_perm_b32 v5, v49, v48, s44
    v_perm_b32 v6, v49, v48, s45
    s_waitcnt vmcnt(56)
    v_perm_b32 v136, v51, v50, v11
    v_accvgpr_write_b32 a16, v5
    v_accvgpr_write_b32 a20, v6
    s_add_u32 s17, s49, 187776
    buffer_load_dword v108, v9, s[20:23], s17 offen
    buffer_load_dword v109, v10, s[20:23], s17 offen
    buffer_load_dword v110, v12, s[20:23], s17 offen
    buffer_load_dword v111, v13, s[20:23], s17 offen
    s_waitcnt vmcnt(58)
    v_perm_b32 v5, v53, v52, s44
    v_perm_b32 v6, v53, v52, s45
    s_waitcnt vmcnt(56)
    v_perm_b32 v137, v55, v54, v11
    v_accvgpr_write_b32 a17, v5
    v_accvgpr_write_b32 a21, v6
    s_add_u32 s17, s49, 221184
    buffer_load_dword v112, v9, s[20:23], s17 offen
    buffer_load_dword v113, v10, s[20:23], s17 offen
    buffer_load_dword v114, v12, s[20:23], s17 offen
    buffer_load_dword v115, v13, s[20:23], s17 offen
    s_waitcnt vmcnt(58)
    v_perm_b32 v5, v57, v56, s44
    v_perm_b32 v6, v57, v56, s45
    s_waitcnt vmcnt(56)
    v_perm_b32 v138, v59, v58, v11
    v_accvgpr_write_b32 a18, v5
    v_accvgpr_write_b32 a22, v6
    s_add_u32 s17, s49, 222336
    buffer_load_dword v116, v9, s[20:23], s17 offen
    buffer_load_dword v117, v10, s[20:23], s17 offen
    buffer_load_dword v118, v12, s[20:23], s17 offen
    buffer_load_dword v119, v13, s[20:23], s17 offen
    s_waitcnt vmcnt(58)
    v_perm_b32 v5, v61, v60, s44
    v_perm_b32 v6, v61, v60, s45
    s_waitcnt vmcnt(56)
    v_perm_b32 v139, v63, v62, v11
    v_accvgpr_write_b32 a19, v5
    v_accvgpr_write_b32 a23, v6
    s_add_u32 s17, s49, 223488
    buffer_load_dword v120, v9, s[20:23], s17 offen
    buffer_load_dword v121, v10, s[20:23], s17 offen
    buffer_load_dword v122, v12, s[20:23], s17 offen
    buffer_load_dword v123, v13, s[20:23], s17 offen
    s_waitcnt vmcnt(58)
    v_perm_b32 v5, v65, v64, s44
    v_perm_b32 v6, v65, v64, s45
    s_waitcnt vmcnt(56)
    v_perm_b32 v140, v67, v66, v11
    v_accvgpr_write_b32 a24, v5
    v_accvgpr_write_b32 a28, v6
    s_add_u32 s17, s49, 224640
    buffer_load_dword v124, v9, s[20:23], s17 offen
    buffer_load_dword v125, v10, s[20:23], s17 offen
    buffer_load_dword v126, v12, s[20:23], s17 offen
    buffer_load_dword v127, v13, s[20:23], s17 offen
    s_waitcnt vmcnt(58)
    v_perm_b32 v5, v69, v68, s44
    v_perm_b32 v6, v69, v68, s45
    s_waitcnt vmcnt(56)
    v_perm_b32 v141, v71, v70, v11
    v_accvgpr_write_b32 a25, v5
    v_accvgpr_write_b32 a29, v6
    s_add_u32 s17, s49, 258048
    buffer_load_dword v16, v9, s[20:23], s17 offen
    buffer_load_dword v17, v10, s[20:23], s17 offen
    buffer_load_dword v18, v12, s[20:23], s17 offen
    buffer_load_dword v19, v13, s[20:23], s17 offen
    s_waitcnt vmcnt(58)
    v_perm_b32 v5, v73, v72, s44
    v_perm_b32 v6, v73, v72, s45
    s_waitcnt vmcnt(56)
    v_perm_b32 v142, v75, v74, v11
    v_accvgpr_write_b32 a26, v5
    v_accvgpr_write_b32 a30, v6
    s_add_u32 s17, s49, 259200
    buffer_load_dword v20, v9, s[20:23], s17 offen
    buffer_load_dword v21, v10, s[20:23], s17 offen
    buffer_load_dword v22, v12, s[20:23], s17 offen
    buffer_load_dword v23, v13, s[20:23], s17 offen
    s_waitcnt vmcnt(58)
    v_perm_b32 v5, v77, v76, s44
    v_perm_b32 v6, v77, v76, s45
    s_waitcnt vmcnt(56)
    v_perm_b32 v143, v79, v78, v11
    v_accvgpr_write_b32 a27, v5
    v_accvgpr_write_b32 a31, v6
    s_add_u32 s17, s49, 260352
    buffer_load_dword v24, v9, s[20:23], s17 offen
    buffer_load_dword v25, v10, s[20:23], s17 offen
    buffer_load_dword v26, v12, s[20:23], s17 offen
    buffer_load_dword v27, v13, s[20:23], s17 offen
    s_waitcnt vmcnt(58)
    v_perm_b32 v5, v81, v80, s44
    v_perm_b32 v6, v81, v80, s45
    s_waitcnt vmcnt(56)
    v_perm_b32 v144, v83, v82, v11
    v_accvgpr_write_b32 a32, v5
    v_accvgpr_write_b32 a36, v6
    s_add_u32 s17, s49, 261504
    buffer_load_dword v28, v9, s[20:23], s17 offen
    buffer_load_dword v29, v10, s[20:23], s17 offen
    buffer_load_dword v30, v12, s[20:23], s17 offen
    buffer_load_dword v31, v13, s[20:23], s17 offen
    s_waitcnt vmcnt(58)
    v_perm_b32 v5, v85, v84, s44
    v_perm_b32 v6, v85, v84, s45
    s_waitcnt vmcnt(56)
    v_perm_b32 v145, v87, v86, v11
    v_accvgpr_write_b32 a33, v5
    v_accvgpr_write_b32 a37, v6
    s_add_u32 s17, s49, 294912
    buffer_load_dword v32, v9, s[20:23], s17 offen
    buffer_load_dword v33, v10, s[20:23], s17 offen
    buffer_load_dword v34, v12, s[20:23], s17 offen
    buffer_load_dword v35, v13, s[20:23], s17 offen
    s_waitcnt vmcnt(58)
    v_perm_b32 v5, v89, v88, s44
    v_perm_b32 v6, v89, v88, s45
    s_waitcnt vmcnt(56)
    v_perm_b32 v146, v91, v90, v11
    v_accvgpr_write_b32 a34, v5
    v_accvgpr_write_b32 a38, v6
    s_add_u32 s17, s49, 296064
    buffer_load_dword v36, v9, s[20:23], s17 offen
    buffer_load_dword v37, v10, s[20:23], s17 offen
    buffer_load_dword v38, v12, s[20:23], s17 offen
    buffer_load_dword v39, v13, s[20:23], s17 offen
    s_waitcnt vmcnt(58)
    v_perm_b32 v5, v93, v92, s44
    v_perm_b32 v6, v93, v92, s45
    s_waitcnt vmcnt(56)
    v_perm_b32 v147, v95, v94, v11
    v_accvgpr_write_b32 a35, v5
    v_accvgpr_write_b32 a39, v6
    s_add_u32 s17, s49, 297216
    buffer_load_dword v40, v9, s[20:23], s17 offen
    buffer_load_dword v41, v10, s[20:23], s17 offen
    buffer_load_dword v42, v12, s[20:23], s17 offen
    buffer_load_dword v43, v13, s[20:23], s17 offen
    s_waitcnt vmcnt(58)
    v_perm_b32 v5, v97, v96, s44
    v_perm_b32 v6, v97, v96, s45
    s_waitcnt vmcnt(56)
    v_perm_b32 v148, v99, v98, v11
    v_accvgpr_write_b32 a40, v5
    v_accvgpr_write_b32 a44, v6
    s_add_u32 s17, s49, 298368
    buffer_load_dword v44, v9, s[20:23], s17 offen
    buffer_load_dword v45, v10, s[20:23], s17 offen
    buffer_load_dword v46, v12, s[20:23], s17 offen
    buffer_load_dword v47, v13, s[20:23], s17 offen
    s_waitcnt vmcnt(58)
    v_perm_b32 v5, v101, v100, s44
    v_perm_b32 v6, v101, v100, s45
    s_waitcnt vmcnt(56)
    v_perm_b32 v149, v103, v102, v11
    v_accvgpr_write_b32 a41, v5
    v_accvgpr_write_b32 a45, v6
    s_add_u32 s17, s49, 331776
    buffer_load_dword v48, v9, s[20:23], s17 offen
    buffer_load_dword v49, v10, s[20:23], s17 offen
    buffer_load_dword v50, v12, s[20:23], s17 offen
    buffer_load_dword v51, v13, s[20:23], s17 offen
    s_waitcnt vmcnt(58)
    v_perm_b32 v5, v105, v104, s44
    v_perm_b32 v6, v105, v104, s45
    s_waitcnt vmcnt(56)
    v_perm_b32 v150, v107, v106, v11
    v_accvgpr_write_b32 a42, v5
    v_accvgpr_write_b32 a46, v6
    s_add_u32 s17, s49, 332928
    buffer_load_dword v52, v9, s[20:23], s17 offen
    buffer_load_dword v53, v10, s[20:23], s17 offen
    buffer_load_dword v54, v12, s[20:23], s17 offen
    buffer_load_dword v55, v13, s[20:23], s17 offen
    s_waitcnt vmcnt(58)
    v_perm_b32 v5, v109, v108, s44
    v_perm_b32 v6, v109, v108, s45
    s_waitcnt vmcnt(56)
    v_perm_b32 v151, v111, v110, v11
    v_accvgpr_write_b32 a43, v5
    v_accvgpr_write_b32 a47, v6
    s_add_u32 s17, s49, 334080
    buffer_load_dword v56, v9, s[20:23], s17 offen
    buffer_load_dword v57, v10, s[20:23], s17 offen
    buffer_load_dword v58, v12, s[20:23], s17 offen
    buffer_load_dword v59, v13, s[20:23], s17 offen
    s_waitcnt vmcnt(58)
    v_perm_b32 v5, v113, v112, s44
    v_perm_b32 v6, v113, v112, s45
    s_waitcnt vmcnt(56)
    v_perm_b32 v152, v115, v114, v11
    v_accvgpr_write_b32 a48, v5
    v_accvgpr_write_b32 a52, v6
    s_add_u32 s17, s49, 335232
    buffer_load_dword v60, v9, s[20:23], s17 offen
    buffer_load_dword v61, v10, s[20:23], s17 offen
    buffer_load_dword v62, v12, s[20:23], s17 offen
    buffer_load_dword v63, v13, s[20:23], s17 offen
    s_waitcnt vmcnt(58)
    v_perm_b32 v5, v117, v116, s44
    v_perm_b32 v6, v117, v116, s45
    s_waitcnt vmcnt(56)
    v_perm_b32 v153, v119, v118, v11
    v_accvgpr_write_b32 a49, v5
    v_accvgpr_write_b32 a53, v6
    s_add_u32 s17, s49, 368640
    buffer_load_dword v64, v9, s[20:23], s17 offen
    buffer_load_dword v65, v10, s[20:23], s17 offen
    buffer_load_dword v66, v12, s[20:23], s17 offen
    buffer_load_dword v67, v13, s[20:23], s17 offen
    s_waitcnt vmcnt(58)
    v_perm_b32 v5, v121, v120, s44
    v_perm_b32 v6, v121, v120, s45
    s_waitcnt vmcnt(56)
    v_perm_b32 v154, v123, v122, v11
    v_accvgpr_write_b32 a50, v5
    v_accvgpr_write_b32 a54, v6
    s_add_u32 s17, s49, 369792
    buffer_load_dword v68, v9, s[20:23], s17 offen
    buffer_load_dword v69, v10, s[20:23], s17 offen
    buffer_load_dword v70, v12, s[20:23], s17 offen
    buffer_load_dword v71, v13, s[20:23], s17 offen
    s_waitcnt vmcnt(58)
    v_perm_b32 v5, v125, v124, s44
    v_perm_b32 v6, v125, v124, s45
    s_waitcnt vmcnt(56)
    v_perm_b32 v155, v127, v126, v11
    v_accvgpr_write_b32 a51, v5
    v_accvgpr_write_b32 a55, v6
    s_add_u32 s17, s49, 370944
    buffer_load_dword v72, v9, s[20:23], s17 offen
    buffer_load_dword v73, v10, s[20:23], s17 offen
    buffer_load_dword v74, v12, s[20:23], s17 offen
    buffer_load_dword v75, v13, s[20:23], s17 offen
    s_waitcnt vmcnt(58)
    v_perm_b32 v5, v17, v16, s44
    v_perm_b32 v6, v17, v16, s45
    s_waitcnt vmcnt(56)
    v_perm_b32 v156, v19, v18, v11
    v_accvgpr_write_b32 a56, v5
    v_accvgpr_write_b32 a60, v6
    s_add_u32 s17, s49, 372096
    buffer_load_dword v76, v9, s[20:23], s17 offen
    buffer_load_dword v77, v10, s[20:23], s17 offen
    buffer_load_dword v78, v12, s[20:23], s17 offen
    buffer_load_dword v79, v13, s[20:23], s17 offen
    s_waitcnt vmcnt(58)
    v_perm_b32 v5, v21, v20, s44
    v_perm_b32 v6, v21, v20, s45
    s_waitcnt vmcnt(56)
    v_perm_b32 v157, v23, v22, v11
    v_accvgpr_write_b32 a57, v5
    v_accvgpr_write_b32 a61, v6
    s_add_u32 s17, s49, 405504
    buffer_load_dword v80, v9, s[20:23], s17 offen
    buffer_load_dword v81, v10, s[20:23], s17 offen
    buffer_load_dword v82, v12, s[20:23], s17 offen
    buffer_load_dword v83, v13, s[20:23], s17 offen
    s_waitcnt vmcnt(58)
    v_perm_b32 v5, v25, v24, s44
    v_perm_b32 v6, v25, v24, s45
    s_waitcnt vmcnt(56)
    v_perm_b32 v158, v27, v26, v11
    v_accvgpr_write_b32 a58, v5
    v_accvgpr_write_b32 a62, v6
    s_add_u32 s17, s49, 406656
    buffer_load_dword v84, v9, s[20:23], s17 offen
    buffer_load_dword v85, v10, s[20:23], s17 offen
    buffer_load_dword v86, v12, s[20:23], s17 offen
    buffer_load_dword v87, v13, s[20:23], s17 offen
    s_waitcnt vmcnt(58)
    v_perm_b32 v5, v29, v28, s44
    v_perm_b32 v6, v29, v28, s45
    s_waitcnt vmcnt(56)
    v_perm_b32 v159, v31, v30, v11
    v_accvgpr_write_b32 a59, v5
    v_accvgpr_write_b32 a63, v6
    s_add_u32 s17, s49, 407808
    buffer_load_dword v88, v9, s[20:23], s17 offen
    buffer_load_dword v89, v10, s[20:23], s17 offen
    buffer_load_dword v90, v12, s[20:23], s17 offen
    buffer_load_dword v91, v13, s[20:23], s17 offen
    s_waitcnt vmcnt(58)
    v_perm_b32 v5, v33, v32, s44
    v_perm_b32 v6, v33, v32, s45
    s_waitcnt vmcnt(56)
    v_perm_b32 v160, v35, v34, v11
    v_accvgpr_write_b32 a64, v5
    v_accvgpr_write_b32 a68, v6
    s_add_u32 s17, s49, 408960
    buffer_load_dword v92, v9, s[20:23], s17 offen
    buffer_load_dword v93, v10, s[20:23], s17 offen
    buffer_load_dword v94, v12, s[20:23], s17 offen
    buffer_load_dword v95, v13, s[20:23], s17 offen
    s_waitcnt vmcnt(58)
    v_perm_b32 v5, v37, v36, s44
    v_perm_b32 v6, v37, v36, s45
    s_waitcnt vmcnt(56)
    v_perm_b32 v161, v39, v38, v11
    v_accvgpr_write_b32 a65, v5
    v_accvgpr_write_b32 a69, v6
    s_add_u32 s17, s49, 442368
    buffer_load_dword v96, v9, s[20:23], s17 offen
    buffer_load_dword v97, v10, s[20:23], s17 offen
    buffer_load_dword v98, v12, s[20:23], s17 offen
    buffer_load_dword v99, v13, s[20:23], s17 offen
    s_waitcnt vmcnt(58)
    v_perm_b32 v5, v41, v40, s44
    v_perm_b32 v6, v41, v40, s45
    s_waitcnt vmcnt(56)
    v_perm_b32 v162, v43, v42, v11
    v_accvgpr_write_b32 a66, v5
    v_accvgpr_write_b32 a70, v6
    s_add_u32 s17, s49, 443520
    buffer_load_dword v100, v9, s[20:23], s17 offen
    buffer_load_dword v101, v10, s[20:23], s17 offen
    buffer_load_dword v102, v12, s[20:23], s17 offen
    buffer_load_dword v103, v13, s[20:23], s17 offen
    s_waitcnt vmcnt(58)
    v_perm_b32 v5, v45, v44, s44
    v_perm_b32 v6, v45, v44, s45
    s_waitcnt vmcnt(56)
    v_perm_b32 v163, v47, v46, v11
    v_accvgpr_write_b32 a67, v5
    v_accvgpr_write_b32 a71, v6
    s_add_u32 s17, s49, 444672
    buffer_load_dword v104, v9, s[20:23], s17 offen
    buffer_load_dword v105, v10, s[20:23], s17 offen
    buffer_load_dword v106, v12, s[20:23], s17 offen
    buffer_load_dword v107, v13, s[20:23], s17 offen
    s_waitcnt vmcnt(58)
    v_perm_b32 v5, v49, v48, s44
    v_perm_b32 v6, v49, v48, s45
    s_waitcnt vmcnt(56)
    v_perm_b32 v164, v51, v50, v11
    v_accvgpr_write_b32 a72, v5
    v_accvgpr_write_b32 a76, v6
    s_add_u32 s17, s49, 445824
    buffer_load_dword v108, v9, s[20:23], s17 offen
    buffer_load_dword v109, v10, s[20:23], s17 offen
    buffer_load_dword v110, v12, s[20:23], s17 offen
    buffer_load_dword v111, v13, s[20:23], s17 offen
    s_waitcnt vmcnt(58)
    v_perm_b32 v5, v53, v52, s44
    v_perm_b32 v6, v53, v52, s45
    s_waitcnt vmcnt(56)
    v_perm_b32 v165, v55, v54, v11
    v_accvgpr_write_b32 a73, v5
    v_accvgpr_write_b32 a77, v6
    s_add_u32 s17, s49, 479232
    buffer_load_dword v112, v9, s[20:23], s17 offen
    buffer_load_dword v113, v10, s[20:23], s17 offen
    buffer_load_dword v114, v12, s[20:23], s17 offen
    buffer_load_dword v115, v13, s[20:23], s17 offen
    s_waitcnt vmcnt(58)
    v_perm_b32 v5, v57, v56, s44
    v_perm_b32 v6, v57, v56, s45
    s_waitcnt vmcnt(56)
    v_perm_b32 v166, v59, v58, v11
    v_accvgpr_write_b32 a74, v5
    v_accvgpr_write_b32 a78, v6
    s_add_u32 s17, s49, 480384
    buffer_load_dword v116, v9, s[20:23], s17 offen
    buffer_load_dword v117, v10, s[20:23], s17 offen
    buffer_load_dword v118, v12, s[20:23], s17 offen
    buffer_load_dword v119, v13, s[20:23], s17 offen
    s_waitcnt vmcnt(58)
    v_perm_b32 v5, v61, v60, s44
    v_perm_b32 v6, v61, v60, s45
    s_waitcnt vmcnt(56)
    v_perm_b32 v167, v63, v62, v11
    v_accvgpr_write_b32 a75, v5
    v_accvgpr_write_b32 a79, v6
    s_add_u32 s17, s49, 481536
    buffer_load_dword v120, v9, s[20:23], s17 offen
    buffer_load_dword v121, v10, s[20:23], s17 offen
    buffer_load_dword v122, v12, s[20:23], s17 offen
    buffer_load_dword v123, v13, s[20:23], s17 offen
    s_waitcnt vmcnt(58)
    v_perm_b32 v5, v65, v64, s44
    v_perm_b32 v6, v65, v64, s45
    s_waitcnt vmcnt(56)
    v_perm_b32 v168, v67, v66, v11
    v_accvgpr_write_b32 a80, v5
    v_accvgpr_write_b32 a84, v6
    s_add_u32 s17, s49, 482688
    buffer_load_dword v124, v9, s[20:23], s17 offen
    buffer_load_dword v125, v10, s[20:23], s17 offen
    buffer_load_dword v126, v12, s[20:23], s17 offen
    buffer_load_dword v127, v13, s[20:23], s17 offen
    s_waitcnt vmcnt(58)
    v_perm_b32 v5, v69, v68, s44
    v_perm_b32 v6, v69, v68, s45
    s_waitcnt vmcnt(56)
    v_perm_b32 v169, v71, v70, v11
    v_accvgpr_write_b32 a81, v5
    v_accvgpr_write_b32 a85, v6
    s_add_u32 s17, s49, 516096
    buffer_load_dword v16, v9, s[20:23], s17 offen
    buffer_load_dword v17, v10, s[20:23], s17 offen
    buffer_load_dword v18, v12, s[20:23], s17 offen
    buffer_load_dword v19, v13, s[20:23], s17 offen
    s_waitcnt vmcnt(58)
    v_perm_b32 v5, v73, v72, s44
    v_perm_b32 v6, v73, v72, s45
    s_waitcnt vmcnt(56)
    v_perm_b32 v170, v75, v74, v11
    v_accvgpr_write_b32 a82, v5
    v_accvgpr_write_b32 a86, v6
    s_add_u32 s17, s49, 517248
    buffer_load_dword v20, v9, s[20:23], s17 offen
    buffer_load_dword v21, v10, s[20:23], s17 offen
    buffer_load_dword v22, v12, s[20:23], s17 offen
    buffer_load_dword v23, v13, s[20:23], s17 offen
    s_waitcnt vmcnt(58)
    v_perm_b32 v5, v77, v76, s44
    v_perm_b32 v6, v77, v76, s45
    s_waitcnt vmcnt(56)
    v_perm_b32 v171, v79, v78, v11
    v_accvgpr_write_b32 a83, v5
    v_accvgpr_write_b32 a87, v6
    s_add_u32 s17, s49, 518400
    buffer_load_dword v24, v9, s[20:23], s17 offen
    buffer_load_dword v25, v10, s[20:23], s17 offen
    buffer_load_dword v26, v12, s[20:23], s17 offen
    buffer_load_dword v27, v13, s[20:23], s17 offen
    s_waitcnt vmcnt(58)
    v_perm_b32 v5, v81, v80, s44
    v_perm_b32 v6, v81, v80, s45
    s_waitcnt vmcnt(56)
    v_perm_b32 v172, v83, v82, v11
    v_accvgpr_write_b32 a88, v5
    v_accvgpr_write_b32 a92, v6
    s_add_u32 s17, s49, 519552
    buffer_load_dword v28, v9, s[20:23], s17 offen
    buffer_load_dword v29, v10, s[20:23], s17 offen
    buffer_load_dword v30, v12, s[20:23], s17 offen
    buffer_load_dword v31, v13, s[20:23], s17 offen
    s_waitcnt vmcnt(58)
    v_perm_b32 v5, v85, v84, s44
    v_perm_b32 v6, v85, v84, s45
    s_waitcnt vmcnt(56)
    v_perm_b32 v173, v87, v86, v11
    v_accvgpr_write_b32 a89, v5
    v_accvgpr_write_b32 a93, v6
    s_add_u32 s17, s49, 552960
    buffer_load_dword v32, v9, s[20:23], s17 offen
    buffer_load_dword v33, v10, s[20:23], s17 offen
    buffer_load_dword v34, v12, s[20:23], s17 offen
    buffer_load_dword v35, v13, s[20:23], s17 offen
    s_waitcnt vmcnt(58)
    v_perm_b32 v5, v89, v88, s44
    v_perm_b32 v6, v89, v88, s45
    s_waitcnt vmcnt(56)
    v_perm_b32 v174, v91, v90, v11
    v_accvgpr_write_b32 a90, v5
    v_accvgpr_write_b32 a94, v6
    s_add_u32 s17, s49, 554112
    buffer_load_dword v36, v9, s[20:23], s17 offen
    buffer_load_dword v37, v10, s[20:23], s17 offen
    buffer_load_dword v38, v12, s[20:23], s17 offen
    buffer_load_dword v39, v13, s[20:23], s17 offen
    s_waitcnt vmcnt(58)
    v_perm_b32 v5, v93, v92, s44
    v_perm_b32 v6, v93, v92, s45
    s_waitcnt vmcnt(56)
    v_perm_b32 v175, v95, v94, v11
    v_accvgpr_write_b32 a91, v5
    v_accvgpr_write_b32 a95, v6
    s_add_u32 s17, s49, 555264
    buffer_load_dword v40, v9, s[20:23], s17 offen
    buffer_load_dword v41, v10, s[20:23], s17 offen
    buffer_load_dword v42, v12, s[20:23], s17 offen
    buffer_load_dword v43, v13, s[20:23], s17 offen
    s_waitcnt vmcnt(58)
    v_perm_b32 v5, v97, v96, s44
    v_perm_b32 v6, v97, v96, s45
    s_waitcnt vmcnt(56)
    v_perm_b32 v176, v99, v98, v11
    v_accvgpr_write_b32 a96, v5
    v_accvgpr_write_b32 a100, v6
    s_add_u32 s17, s49, 556416
    buffer_load_dword v44, v9, s[20:23], s17 offen
    buffer_load_dword v45, v10, s[20:23], s17 offen
    buffer_load_dword v46, v12, s[20:23], s17 offen
    buffer_load_dword v47, v13, s[20:23], s17 offen
    s_waitcnt vmcnt(58)
    v_perm_b32 v5, v101, v100, s44
    v_perm_b32 v6, v101, v100, s45
    s_waitcnt vmcnt(56)
    v_perm_b32 v177, v103, v102, v11
    v_accvgpr_write_b32 a97, v5
    v_accvgpr_write_b32 a101, v6
    s_add_u32 s17, s49, 589824
    buffer_load_dword v48, v9, s[20:23], s17 offen
    buffer_load_dword v49, v10, s[20:23], s17 offen
    buffer_load_dword v50, v12, s[20:23], s17 offen
    buffer_load_dword v51, v13, s[20:23], s17 offen
    s_waitcnt vmcnt(58)
    v_perm_b32 v5, v105, v104, s44
    v_perm_b32 v6, v105, v104, s45
    s_waitcnt vmcnt(56)
    v_perm_b32 v178, v107, v106, v11
    v_accvgpr_write_b32 a98, v5
    v_accvgpr_write_b32 a102, v6
    s_add_u32 s17, s49, 590976
    buffer_load_dword v52, v9, s[20:23], s17 offen
    buffer_load_dword v53, v10, s[20:23], s17 offen
    buffer_load_dword v54, v12, s[20:23], s17 offen
    buffer_load_dword v55, v13, s[20:23], s17 offen
    s_waitcnt vmcnt(58)
    v_perm_b32 v5, v109, v108, s44
    v_perm_b32 v6, v109, v108, s45
    s_waitcnt vmcnt(56)
    v_perm_b32 v179, v111, v110, v11
    v_accvgpr_write_b32 a99, v5
    v_accvgpr_write_b32 a103, v6
    s_add_u32 s17, s49, 592128
    buffer_load_dword v56, v9, s[20:23], s17 offen
    buffer_load_dword v57, v10, s[20:23], s17 offen
    buffer_load_dword v58, v12, s[20:23], s17 offen
    buffer_load_dword v59, v13, s[20:23], s17 offen
    s_waitcnt vmcnt(58)
    v_perm_b32 v5, v113, v112, s44
    v_perm_b32 v6, v113, v112, s45
    s_waitcnt vmcnt(56)
    v_perm_b32 v180, v115, v114, v11
    v_accvgpr_write_b32 a104, v5
    v_accvgpr_write_b32 a108, v6
    s_add_u32 s17, s49, 593280
    buffer_load_dword v60, v9, s[20:23], s17 offen
    buffer_load_dword v61, v10, s[20:23], s17 offen
    buffer_load_dword v62, v12, s[20:23], s17 offen
    buffer_load_dword v63, v13, s[20:23], s17 offen
    s_waitcnt vmcnt(58)
    v_perm_b32 v5, v117, v116, s44
    v_perm_b32 v6, v117, v116, s45
    s_waitcnt vmcnt(56)
    v_perm_b32 v181, v119, v118, v11
    v_accvgpr_write_b32 a105, v5
    v_accvgpr_write_b32 a109, v6
    s_add_u32 s17, s49, 626688
    buffer_load_dword v64, v9, s[20:23], s17 offen
    buffer_load_dword v65, v10, s[20:23], s17 offen
    buffer_load_dword v66, v12, s[20:23], s17 offen
    buffer_load_dword v67, v13, s[20:23], s17 offen
    s_waitcnt vmcnt(58)
    v_perm_b32 v5, v121, v120, s44
    v_perm_b32 v6, v121, v120, s45
    s_waitcnt vmcnt(56)
    v_perm_b32 v182, v123, v122, v11
    v_accvgpr_write_b32 a106, v5
    v_accvgpr_write_b32 a110, v6
    s_add_u32 s17, s49, 627840
    buffer_load_dword v68, v9, s[20:23], s17 offen
    buffer_load_dword v69, v10, s[20:23], s17 offen
    buffer_load_dword v70, v12, s[20:23], s17 offen
    buffer_load_dword v71, v13, s[20:23], s17 offen
    s_waitcnt vmcnt(58)
    v_perm_b32 v5, v125, v124, s44
    v_perm_b32 v6, v125, v124, s45
    s_waitcnt vmcnt(56)
    v_perm_b32 v183, v127, v126, v11
    v_accvgpr_write_b32 a107, v5
    v_accvgpr_write_b32 a111, v6
    s_add_u32 s17, s49, 628992
    buffer_load_dword v72, v9, s[20:23], s17 offen
    buffer_load_dword v73, v10, s[20:23], s17 offen
    buffer_load_dword v74, v12, s[20:23], s17 offen
    buffer_load_dword v75, v13, s[20:23], s17 offen
    s_waitcnt vmcnt(58)
    v_perm_b32 v5, v17, v16, s44
    v_perm_b32 v6, v17, v16, s45
    s_waitcnt vmcnt(56)
    v_perm_b32 v184, v19, v18, v11
    v_accvgpr_write_b32 a112, v5
    v_accvgpr_write_b32 a116, v6
    s_add_u32 s17, s49, 630144
    buffer_load_dword v76, v9, s[20:23], s17 offen
    buffer_load_dword v77, v10, s[20:23], s17 offen
    buffer_load_dword v78, v12, s[20:23], s17 offen
    buffer_load_dword v79, v13, s[20:23], s17 offen
    s_waitcnt vmcnt(58)
    v_perm_b32 v5, v21, v20, s44
    v_perm_b32 v6, v21, v20, s45
    s_waitcnt vmcnt(56)
    v_perm_b32 v185, v23, v22, v11
    v_accvgpr_write_b32 a113, v5
    v_accvgpr_write_b32 a117, v6
    s_add_u32 s17, s49, 663552
    buffer_load_dword v80, v9, s[20:23], s17 offen
    buffer_load_dword v81, v10, s[20:23], s17 offen
    buffer_load_dword v82, v12, s[20:23], s17 offen
    buffer_load_dword v83, v13, s[20:23], s17 offen
    s_waitcnt vmcnt(58)
    v_perm_b32 v5, v25, v24, s44
    v_perm_b32 v6, v25, v24, s45
    s_waitcnt vmcnt(56)
    v_perm_b32 v186, v27, v26, v11
    v_accvgpr_write_b32 a114, v5
    v_accvgpr_write_b32 a118, v6
    s_add_u32 s17, s49, 664704
    buffer_load_dword v84, v9, s[20:23], s17 offen
    buffer_load_dword v85, v10, s[20:23], s17 offen
    buffer_load_dword v86, v12, s[20:23], s17 offen
    buffer_load_dword v87, v13, s[20:23], s17 offen
    s_waitcnt vmcnt(58)
    v_perm_b32 v5, v29, v28, s44
    v_perm_b32 v6, v29, v28, s45
    s_waitcnt vmcnt(56)
    v_perm_b32 v187, v31, v30, v11
    v_accvgpr_write_b32 a115, v5
    v_accvgpr_write_b32 a119, v6
    s_add_u32 s17, s49, 665856
    buffer_load_dword v88, v9, s[20:23], s17 offen
    buffer_load_dword v89, v10, s[20:23], s17 offen
    buffer_load_dword v90, v12, s[20:23], s17 offen
    buffer_load_dword v91, v13, s[20:23], s17 offen
    s_waitcnt vmcnt(58)
    v_perm_b32 v5, v33, v32, s44
    v_perm_b32 v6, v33, v32, s45
    s_waitcnt vmcnt(56)
    v_perm_b32 v188, v35, v34, v11
    v_accvgpr_write_b32 a120, v5
    v_accvgpr_write_b32 a124, v6
    s_add_u32 s17, s49, 667008
    buffer_load_dword v92, v9, s[20:23], s17 offen
    buffer_load_dword v93, v10, s[20:23], s17 offen
    buffer_load_dword v94, v12, s[20:23], s17 offen
    buffer_load_dword v95, v13, s[20:23], s17 offen
    s_waitcnt vmcnt(58)
    v_perm_b32 v5, v37, v36, s44
    v_perm_b32 v6, v37, v36, s45
    s_waitcnt vmcnt(56)
    v_perm_b32 v189, v39, v38, v11
    v_accvgpr_write_b32 a121, v5
    v_accvgpr_write_b32 a125, v6
    s_add_u32 s17, s49, 700416
    buffer_load_dword v96, v9, s[20:23], s17 offen
    buffer_load_dword v97, v10, s[20:23], s17 offen
    buffer_load_dword v98, v12, s[20:23], s17 offen
    buffer_load_dword v99, v13, s[20:23], s17 offen
    s_waitcnt vmcnt(58)
    v_perm_b32 v5, v41, v40, s44
    v_perm_b32 v6, v41, v40, s45
    s_waitcnt vmcnt(56)
    v_perm_b32 v190, v43, v42, v11
    v_accvgpr_write_b32 a122, v5
    v_accvgpr_write_b32 a126, v6
    s_add_u32 s17, s49, 701568
    buffer_load_dword v100, v9, s[20:23], s17 offen
    buffer_load_dword v101, v10, s[20:23], s17 offen
    buffer_load_dword v102, v12, s[20:23], s17 offen
    buffer_load_dword v103, v13, s[20:23], s17 offen
    s_waitcnt vmcnt(58)
    v_perm_b32 v5, v45, v44, s44
    v_perm_b32 v6, v45, v44, s45
    s_waitcnt vmcnt(56)
    v_perm_b32 v191, v47, v46, v11
    v_accvgpr_write_b32 a123, v5
    v_accvgpr_write_b32 a127, v6
    s_add_u32 s17, s49, 702720
    buffer_load_dword v104, v9, s[20:23], s17 offen
    buffer_load_dword v105, v10, s[20:23], s17 offen
    buffer_load_dword v106, v12, s[20:23], s17 offen
    buffer_load_dword v107, v13, s[20:23], s17 offen
    s_waitcnt vmcnt(58)
    v_perm_b32 v5, v49, v48, s44
    v_perm_b32 v6, v49, v48, s45
    s_waitcnt vmcnt(56)
    v_perm_b32 v192, v51, v50, v11
    v_accvgpr_write_b32 a128, v5
    v_accvgpr_write_b32 a132, v6
    s_add_u32 s17, s49, 703872
    buffer_load_dword v108, v9, s[20:23], s17 offen
    buffer_load_dword v109, v10, s[20:23], s17 offen
    buffer_load_dword v110, v12, s[20:23], s17 offen
    buffer_load_dword v111, v13, s[20:23], s17 offen
    s_waitcnt vmcnt(58)
    v_perm_b32 v5, v53, v52, s44
    v_perm_b32 v6, v53, v52, s45
    s_waitcnt vmcnt(56)
    v_perm_b32 v193, v55, v54, v11
    v_accvgpr_write_b32 a129, v5
    v_accvgpr_write_b32 a133, v6
    s_add_u32 s17, s49, 737280
    buffer_load_dword v112, v9, s[20:23], s17 offen
    buffer_load_dword v113, v10, s[20:23], s17 offen
    buffer_load_dword v114, v12, s[20:23], s17 offen
    buffer_load_dword v115, v13, s[20:23], s17 offen
    s_waitcnt vmcnt(58)
    v_perm_b32 v5, v57, v56, s44
    v_perm_b32 v6, v57, v56, s45
    s_waitcnt vmcnt(56)
    v_perm_b32 v194, v59, v58, v11
    v_accvgpr_write_b32 a130, v5
    v_accvgpr_write_b32 a134, v6
    s_add_u32 s17, s49, 738432
    buffer_load_dword v116, v9, s[20:23], s17 offen
    buffer_load_dword v117, v10, s[20:23], s17 offen
    buffer_load_dword v118, v12, s[20:23], s17 offen
    buffer_load_dword v119, v13, s[20:23], s17 offen
    s_waitcnt vmcnt(58)
    v_perm_b32 v5, v61, v60, s44
    v_perm_b32 v6, v61, v60, s45
    s_waitcnt vmcnt(56)
    v_perm_b32 v195, v63, v62, v11
    v_accvgpr_write_b32 a131, v5
    v_accvgpr_write_b32 a135, v6
    s_add_u32 s17, s49, 739584
    buffer_load_dword v120, v9, s[20:23], s17 offen
    buffer_load_dword v121, v10, s[20:23], s17 offen
    buffer_load_dword v122, v12, s[20:23], s17 offen
    buffer_load_dword v123, v13, s[20:23], s17 offen
    s_waitcnt vmcnt(58)
    v_perm_b32 v5, v65, v64, s44
    v_perm_b32 v6, v65, v64, s45
    s_waitcnt vmcnt(56)
    v_perm_b32 v196, v67, v66, v11
    v_accvgpr_write_b32 a136, v5
    v_accvgpr_write_b32 a140, v6
    s_add_u32 s17, s49, 740736
    buffer_load_dword v124, v9, s[20:23], s17 offen
    buffer_load_dword v125, v10, s[20:23], s17 offen
    buffer_load_dword v126, v12, s[20:23], s17 offen
    buffer_load_dword v127, v13, s[20:23], s17 offen
    s_waitcnt vmcnt(58)
    v_perm_b32 v5, v69, v68, s44
    v_perm_b32 v6, v69, v68, s45
    s_waitcnt vmcnt(56)
    v_perm_b32 v197, v71, v70, v11
    v_accvgpr_write_b32 a137, v5
    v_accvgpr_write_b32 a141, v6
    s_add_u32 s17, s49, 774144
    buffer_load_dword v16, v9, s[20:23], s17 offen
    buffer_load_dword v17, v10, s[20:23], s17 offen
    buffer_load_dword v18, v12, s[20:23], s17 offen
    buffer_load_dword v19, v13, s[20:23], s17 offen
    s_waitcnt vmcnt(58)
    v_perm_b32 v5, v73, v72, s44
    v_perm_b32 v6, v73, v72, s45
    s_waitcnt vmcnt(56)
    v_perm_b32 v198, v75, v74, v11
    v_accvgpr_write_b32 a138, v5
    v_accvgpr_write_b32 a142, v6
    s_add_u32 s17, s49, 775296
    buffer_load_dword v20, v9, s[20:23], s17 offen
    buffer_load_dword v21, v10, s[20:23], s17 offen
    buffer_load_dword v22, v12, s[20:23], s17 offen
    buffer_load_dword v23, v13, s[20:23], s17 offen
    s_waitcnt vmcnt(58)
    v_perm_b32 v5, v77, v76, s44
    v_perm_b32 v6, v77, v76, s45
    s_waitcnt vmcnt(56)
    v_perm_b32 v199, v79, v78, v11
    v_accvgpr_write_b32 a139, v5
    v_accvgpr_write_b32 a143, v6
    s_add_u32 s17, s49, 776448
    buffer_load_dword v24, v9, s[20:23], s17 offen
    buffer_load_dword v25, v10, s[20:23], s17 offen
    buffer_load_dword v26, v12, s[20:23], s17 offen
    buffer_load_dword v27, v13, s[20:23], s17 offen
    s_waitcnt vmcnt(58)
    v_perm_b32 v5, v81, v80, s44
    v_perm_b32 v6, v81, v80, s45
    s_waitcnt vmcnt(56)
    v_perm_b32 v200, v83, v82, v11
    v_accvgpr_write_b32 a144, v5
    v_accvgpr_write_b32 a148, v6
    s_add_u32 s17, s49, 777600
    buffer_load_dword v28, v9, s[20:23], s17 offen
    buffer_load_dword v29, v10, s[20:23], s17 offen
    buffer_load_dword v30, v12, s[20:23], s17 offen
    buffer_load_dword v31, v13, s[20:23], s17 offen
    s_waitcnt vmcnt(58)
    v_perm_b32 v5, v85, v84, s44
    v_perm_b32 v6, v85, v84, s45
    s_waitcnt vmcnt(56)
    v_perm_b32 v201, v87, v86, v11
    v_accvgpr_write_b32 a145, v5
    v_accvgpr_write_b32 a149, v6
    s_add_u32 s17, s49, 811008
    buffer_load_dword v32, v9, s[20:23], s17 offen
    buffer_load_dword v33, v10, s[20:23], s17 offen
    buffer_load_dword v34, v12, s[20:23], s17 offen
    buffer_load_dword v35, v13, s[20:23], s17 offen
    s_waitcnt vmcnt(58)
    v_perm_b32 v5, v89, v88, s44
    v_perm_b32 v6, v89, v88, s45
    s_waitcnt vmcnt(56)
    v_perm_b32 v202, v91, v90, v11
    v_accvgpr_write_b32 a146, v5
    v_accvgpr_write_b32 a150, v6
    s_add_u32 s17, s49, 812160
    buffer_load_dword v36, v9, s[20:23], s17 offen
    buffer_load_dword v37, v10, s[20:23], s17 offen
    buffer_load_dword v38, v12, s[20:23], s17 offen
    buffer_load_dword v39, v13, s[20:23], s17 offen
    s_waitcnt vmcnt(58)
    v_perm_b32 v5, v93, v92, s44
    v_perm_b32 v6, v93, v92, s45
    s_waitcnt vmcnt(56)
    v_perm_b32 v203, v95, v94, v11
    v_accvgpr_write_b32 a147, v5
    v_accvgpr_write_b32 a151, v6
    s_add_u32 s17, s49, 813312
    buffer_load_dword v40, v9, s[20:23], s17 offen
    buffer_load_dword v41, v10, s[20:23], s17 offen
    buffer_load_dword v42, v12, s[20:23], s17 offen
    buffer_load_dword v43, v13, s[20:23], s17 offen
    s_waitcnt vmcnt(58)
    v_perm_b32 v5, v97, v96, s44
    v_perm_b32 v6, v97, v96, s45
    s_waitcnt vmcnt(56)
    v_perm_b32 v204, v99, v98, v11
    v_accvgpr_write_b32 a152, v5
    v_accvgpr_write_b32 a156, v6
    s_add_u32 s17, s49, 814464
    buffer_load_dword v44, v9, s[20:23], s17 offen
    buffer_load_dword v45, v10, s[20:23], s17 offen
    buffer_load_dword v46, v12, s[20:23], s17 offen
    buffer_load_dword v47, v13, s[20:23], s17 offen
    s_waitcnt vmcnt(58)
    v_perm_b32 v5, v101, v100, s44
    v_perm_b32 v6, v101, v100, s45
    s_waitcnt vmcnt(56)
    v_perm_b32 v205, v103, v102, v11
    v_accvgpr_write_b32 a153, v5
    v_accvgpr_write_b32 a157, v6
    s_add_u32 s17, s49, 847872
    buffer_load_dword v48, v9, s[20:23], s17 offen
    buffer_load_dword v49, v10, s[20:23], s17 offen
    buffer_load_dword v50, v12, s[20:23], s17 offen
    buffer_load_dword v51, v13, s[20:23], s17 offen
    s_waitcnt vmcnt(58)
    v_perm_b32 v5, v105, v104, s44
    v_perm_b32 v6, v105, v104, s45
    s_waitcnt vmcnt(56)
    v_perm_b32 v206, v107, v106, v11
    v_accvgpr_write_b32 a154, v5
    v_accvgpr_write_b32 a158, v6
    s_add_u32 s17, s49, 849024
    buffer_load_dword v52, v9, s[20:23], s17 offen
    buffer_load_dword v53, v10, s[20:23], s17 offen
    buffer_load_dword v54, v12, s[20:23], s17 offen
    buffer_load_dword v55, v13, s[20:23], s17 offen
    s_waitcnt vmcnt(58)
    v_perm_b32 v5, v109, v108, s44
    v_perm_b32 v6, v109, v108, s45
    s_waitcnt vmcnt(56)
    v_perm_b32 v207, v111, v110, v11
    v_accvgpr_write_b32 a155, v5
    v_accvgpr_write_b32 a159, v6
    s_add_u32 s17, s49, 850176
    buffer_load_dword v56, v9, s[20:23], s17 offen
    buffer_load_dword v57, v10, s[20:23], s17 offen
    buffer_load_dword v58, v12, s[20:23], s17 offen
    buffer_load_dword v59, v13, s[20:23], s17 offen
    s_waitcnt vmcnt(58)
    v_perm_b32 v5, v113, v112, s44
    v_perm_b32 v6, v113, v112, s45
    s_waitcnt vmcnt(56)
    v_perm_b32 v208, v115, v114, v11
    v_accvgpr_write_b32 a160, v5
    v_accvgpr_write_b32 a164, v6
    s_add_u32 s17, s49, 851328
    buffer_load_dword v60, v9, s[20:23], s17 offen
    buffer_load_dword v61, v10, s[20:23], s17 offen
    buffer_load_dword v62, v12, s[20:23], s17 offen
    buffer_load_dword v63, v13, s[20:23], s17 offen
    s_waitcnt vmcnt(58)
    v_perm_b32 v5, v117, v116, s44
    v_perm_b32 v6, v117, v116, s45
    s_waitcnt vmcnt(56)
    v_perm_b32 v209, v119, v118, v11
    v_accvgpr_write_b32 a161, v5
    v_accvgpr_write_b32 a165, v6
    s_add_u32 s17, s49, 884736
    buffer_load_dword v64, v9, s[20:23], s17 offen
    buffer_load_dword v65, v10, s[20:23], s17 offen
    buffer_load_dword v66, v12, s[20:23], s17 offen
    buffer_load_dword v67, v13, s[20:23], s17 offen
    s_waitcnt vmcnt(58)
    v_perm_b32 v5, v121, v120, s44
    v_perm_b32 v6, v121, v120, s45
    s_waitcnt vmcnt(56)
    v_perm_b32 v210, v123, v122, v11
    v_accvgpr_write_b32 a162, v5
    v_accvgpr_write_b32 a166, v6
    s_add_u32 s17, s49, 885888
    buffer_load_dword v68, v9, s[20:23], s17 offen
    buffer_load_dword v69, v10, s[20:23], s17 offen
    buffer_load_dword v70, v12, s[20:23], s17 offen
    buffer_load_dword v71, v13, s[20:23], s17 offen
    s_waitcnt vmcnt(58)
    v_perm_b32 v5, v125, v124, s44
    v_perm_b32 v6, v125, v124, s45
    s_waitcnt vmcnt(56)
    v_perm_b32 v211, v127, v126, v11
    v_accvgpr_write_b32 a163, v5
    v_accvgpr_write_b32 a167, v6
    s_add_u32 s17, s49, 887040
    buffer_load_dword v72, v9, s[20:23], s17 offen
    buffer_load_dword v73, v10, s[20:23], s17 offen
    buffer_load_dword v74, v12, s[20:23], s17 offen
    buffer_load_dword v75, v13, s[20:23], s17 offen
    s_waitcnt vmcnt(58)
    v_perm_b32 v5, v17, v16, s44
    v_perm_b32 v6, v17, v16, s45
    s_waitcnt vmcnt(56)
    v_perm_b32 v212, v19, v18, v11
    v_accvgpr_write_b32 a168, v5
    v_accvgpr_write_b32 a172, v6
    s_add_u32 s17, s49, 888192
    buffer_load_dword v76, v9, s[20:23], s17 offen
    buffer_load_dword v77, v10, s[20:23], s17 offen
    buffer_load_dword v78, v12, s[20:23], s17 offen
    buffer_load_dword v79, v13, s[20:23], s17 offen
    s_waitcnt vmcnt(58)
    v_perm_b32 v5, v21, v20, s44
    v_perm_b32 v6, v21, v20, s45
    s_waitcnt vmcnt(56)
    v_perm_b32 v213, v23, v22, v11
    v_accvgpr_write_b32 a169, v5
    v_accvgpr_write_b32 a173, v6
    s_add_u32 s17, s49, 921600
    buffer_load_dword v80, v9, s[20:23], s17 offen
    buffer_load_dword v81, v10, s[20:23], s17 offen
    buffer_load_dword v82, v12, s[20:23], s17 offen
    buffer_load_dword v83, v13, s[20:23], s17 offen
    s_waitcnt vmcnt(58)
    v_perm_b32 v5, v25, v24, s44
    v_perm_b32 v6, v25, v24, s45
    s_waitcnt vmcnt(56)
    v_perm_b32 v214, v27, v26, v11
    v_accvgpr_write_b32 a170, v5
    v_accvgpr_write_b32 a174, v6
    s_add_u32 s17, s49, 922752
    buffer_load_dword v84, v9, s[20:23], s17 offen
    buffer_load_dword v85, v10, s[20:23], s17 offen
    buffer_load_dword v86, v12, s[20:23], s17 offen
    buffer_load_dword v87, v13, s[20:23], s17 offen
    s_waitcnt vmcnt(58)
    v_perm_b32 v5, v29, v28, s44
    v_perm_b32 v6, v29, v28, s45
    s_waitcnt vmcnt(56)
    v_perm_b32 v215, v31, v30, v11
    v_accvgpr_write_b32 a171, v5
    v_accvgpr_write_b32 a175, v6
    s_add_u32 s17, s49, 923904
    buffer_load_dword v88, v9, s[20:23], s17 offen
    buffer_load_dword v89, v10, s[20:23], s17 offen
    buffer_load_dword v90, v12, s[20:23], s17 offen
    buffer_load_dword v91, v13, s[20:23], s17 offen
    s_waitcnt vmcnt(58)
    v_perm_b32 v5, v33, v32, s44
    v_perm_b32 v6, v33, v32, s45
    s_waitcnt vmcnt(56)
    v_perm_b32 v216, v35, v34, v11
    v_accvgpr_write_b32 a176, v5
    v_accvgpr_write_b32 a180, v6
    s_add_u32 s17, s49, 925056
    buffer_load_dword v92, v9, s[20:23], s17 offen
    buffer_load_dword v93, v10, s[20:23], s17 offen
    buffer_load_dword v94, v12, s[20:23], s17 offen
    buffer_load_dword v95, v13, s[20:23], s17 offen
    s_waitcnt vmcnt(58)
    v_perm_b32 v5, v37, v36, s44
    v_perm_b32 v6, v37, v36, s45
    s_waitcnt vmcnt(56)
    v_perm_b32 v217, v39, v38, v11
    v_accvgpr_write_b32 a177, v5
    v_accvgpr_write_b32 a181, v6
    s_add_u32 s17, s49, 958464
    buffer_load_dword v96, v9, s[20:23], s17 offen
    buffer_load_dword v97, v10, s[20:23], s17 offen
    buffer_load_dword v98, v12, s[20:23], s17 offen
    buffer_load_dword v99, v13, s[20:23], s17 offen
    s_waitcnt vmcnt(58)
    v_perm_b32 v5, v41, v40, s44
    v_perm_b32 v6, v41, v40, s45
    s_waitcnt vmcnt(56)
    v_perm_b32 v218, v43, v42, v11
    v_accvgpr_write_b32 a178, v5
    v_accvgpr_write_b32 a182, v6
    s_add_u32 s17, s49, 959616
    buffer_load_dword v100, v9, s[20:23], s17 offen
    buffer_load_dword v101, v10, s[20:23], s17 offen
    buffer_load_dword v102, v12, s[20:23], s17 offen
    buffer_load_dword v103, v13, s[20:23], s17 offen
    s_waitcnt vmcnt(58)
    v_perm_b32 v5, v45, v44, s44
    v_perm_b32 v6, v45, v44, s45
    s_waitcnt vmcnt(56)
    v_perm_b32 v219, v47, v46, v11
    v_accvgpr_write_b32 a179, v5
    v_accvgpr_write_b32 a183, v6
    s_add_u32 s17, s49, 960768
    buffer_load_dword v104, v9, s[20:23], s17 offen
    buffer_load_dword v105, v10, s[20:23], s17 offen
    buffer_load_dword v106, v12, s[20:23], s17 offen
    buffer_load_dword v107, v13, s[20:23], s17 offen
    s_waitcnt vmcnt(58)
    v_perm_b32 v5, v49, v48, s44
    v_perm_b32 v6, v49, v48, s45
    s_waitcnt vmcnt(56)
    v_perm_b32 v220, v51, v50, v11
    v_accvgpr_write_b32 a184, v5
    v_accvgpr_write_b32 a188, v6
    s_add_u32 s17, s49, 961920
    buffer_load_dword v108, v9, s[20:23], s17 offen
    buffer_load_dword v109, v10, s[20:23], s17 offen
    buffer_load_dword v110, v12, s[20:23], s17 offen
    buffer_load_dword v111, v13, s[20:23], s17 offen
    s_waitcnt vmcnt(58)
    v_perm_b32 v5, v53, v52, s44
    v_perm_b32 v6, v53, v52, s45
    s_waitcnt vmcnt(56)
    v_perm_b32 v221, v55, v54, v11
    v_accvgpr_write_b32 a185, v5
    v_accvgpr_write_b32 a189, v6
    s_add_u32 s17, s49, 995328
    buffer_load_dword v112, v9, s[20:23], s17 offen
    buffer_load_dword v113, v10, s[20:23], s17 offen
    buffer_load_dword v114, v12, s[20:23], s17 offen
    buffer_load_dword v115, v13, s[20:23], s17 offen
    s_waitcnt vmcnt(58)
    v_perm_b32 v5, v57, v56, s44
    v_perm_b32 v6, v57, v56, s45
    s_waitcnt vmcnt(56)
    v_perm_b32 v222, v59, v58, v11
    v_accvgpr_write_b32 a186, v5
    v_accvgpr_write_b32 a190, v6
    s_add_u32 s17, s49, 996480
    buffer_load_dword v116, v9, s[20:23], s17 offen
    buffer_load_dword v117, v10, s[20:23], s17 offen
    buffer_load_dword v118, v12, s[20:23], s17 offen
    buffer_load_dword v119, v13, s[20:23], s17 offen
    s_waitcnt vmcnt(58)
    v_perm_b32 v5, v61, v60, s44
    v_perm_b32 v6, v61, v60, s45
    s_waitcnt vmcnt(56)
    v_perm_b32 v223, v63, v62, v11
    v_accvgpr_write_b32 a187, v5
    v_accvgpr_write_b32 a191, v6
    s_add_u32 s17, s49, 997632
    buffer_load_dword v120, v9, s[20:23], s17 offen
    buffer_load_dword v121, v10, s[20:23], s17 offen
    buffer_load_dword v122, v12, s[20:23], s17 offen
    buffer_load_dword v123, v13, s[20:23], s17 offen
    s_waitcnt vmcnt(58)
    v_perm_b32 v5, v65, v64, s44
    v_perm_b32 v6, v65, v64, s45
    s_waitcnt vmcnt(56)
    v_perm_b32 v224, v67, v66, v11
    v_accvgpr_write_b32 a192, v5
    v_accvgpr_write_b32 a196, v6
    s_add_u32 s17, s49, 998784
    buffer_load_dword v124, v9, s[20:23], s17 offen
    buffer_load_dword v125, v10, s[20:23], s17 offen
    buffer_load_dword v126, v12, s[20:23], s17 offen
    buffer_load_dword v127, v13, s[20:23], s17 offen
    s_waitcnt vmcnt(58)
    v_perm_b32 v5, v69, v68, s44
    v_perm_b32 v6, v69, v68, s45
    s_waitcnt vmcnt(56)
    v_perm_b32 v225, v71, v70, v11
    v_accvgpr_write_b32 a193, v5
    v_accvgpr_write_b32 a197, v6
    s_add_u32 s17, s49, 1032192
    buffer_load_dword v16, v9, s[20:23], s17 offen
    buffer_load_dword v17, v10, s[20:23], s17 offen
    buffer_load_dword v18, v12, s[20:23], s17 offen
    buffer_load_dword v19, v13, s[20:23], s17 offen
    s_waitcnt vmcnt(58)
    v_perm_b32 v5, v73, v72, s44
    v_perm_b32 v6, v73, v72, s45
    s_waitcnt vmcnt(56)
    v_perm_b32 v226, v75, v74, v11
    v_accvgpr_write_b32 a194, v5
    v_accvgpr_write_b32 a198, v6
    s_add_u32 s17, s49, 1033344
    buffer_load_dword v20, v9, s[20:23], s17 offen
    buffer_load_dword v21, v10, s[20:23], s17 offen
    buffer_load_dword v22, v12, s[20:23], s17 offen
    buffer_load_dword v23, v13, s[20:23], s17 offen
    s_waitcnt vmcnt(58)
    v_perm_b32 v5, v77, v76, s44
    v_perm_b32 v6, v77, v76, s45
    s_waitcnt vmcnt(56)
    v_perm_b32 v227, v79, v78, v11
    v_accvgpr_write_b32 a195, v5
    v_accvgpr_write_b32 a199, v6
    s_add_u32 s17, s49, 1034496
    buffer_load_dword v24, v9, s[20:23], s17 offen
    buffer_load_dword v25, v10, s[20:23], s17 offen
    buffer_load_dword v26, v12, s[20:23], s17 offen
    buffer_load_dword v27, v13, s[20:23], s17 offen
    s_waitcnt vmcnt(58)
    v_perm_b32 v5, v81, v80, s44
    v_perm_b32 v6, v81, v80, s45
    s_waitcnt vmcnt(56)
    v_perm_b32 v228, v83, v82, v11
    v_accvgpr_write_b32 a200, v5
    v_accvgpr_write_b32 a204, v6
    s_add_u32 s17, s49, 1035648
    buffer_load_dword v28, v9, s[20:23], s17 offen
    buffer_load_dword v29, v10, s[20:23], s17 offen
    buffer_load_dword v30, v12, s[20:23], s17 offen
    buffer_load_dword v31, v13, s[20:23], s17 offen
    s_waitcnt vmcnt(58)
    v_perm_b32 v5, v85, v84, s44
    v_perm_b32 v6, v85, v84, s45
    s_waitcnt vmcnt(56)
    v_perm_b32 v229, v87, v86, v11
    v_accvgpr_write_b32 a201, v5
    v_accvgpr_write_b32 a205, v6
    s_add_u32 s17, s49, 1069056
    buffer_load_dword v32, v9, s[20:23], s17 offen
    buffer_load_dword v33, v10, s[20:23], s17 offen
    buffer_load_dword v34, v12, s[20:23], s17 offen
    buffer_load_dword v35, v13, s[20:23], s17 offen
    s_waitcnt vmcnt(58)
    v_perm_b32 v5, v89, v88, s44
    v_perm_b32 v6, v89, v88, s45
    s_waitcnt vmcnt(56)
    v_perm_b32 v230, v91, v90, v11
    v_accvgpr_write_b32 a202, v5
    v_accvgpr_write_b32 a206, v6
    s_add_u32 s17, s49, 1070208
    buffer_load_dword v36, v9, s[20:23], s17 offen
    buffer_load_dword v37, v10, s[20:23], s17 offen
    buffer_load_dword v38, v12, s[20:23], s17 offen
    buffer_load_dword v39, v13, s[20:23], s17 offen
    s_waitcnt vmcnt(58)
    v_perm_b32 v5, v93, v92, s44
    v_perm_b32 v6, v93, v92, s45
    s_waitcnt vmcnt(56)
    v_perm_b32 v231, v95, v94, v11
    v_accvgpr_write_b32 a203, v5
    v_accvgpr_write_b32 a207, v6
    s_add_u32 s17, s49, 1071360
    buffer_load_dword v40, v9, s[20:23], s17 offen
    buffer_load_dword v41, v10, s[20:23], s17 offen
    buffer_load_dword v42, v12, s[20:23], s17 offen
    buffer_load_dword v43, v13, s[20:23], s17 offen
    s_waitcnt vmcnt(58)
    v_perm_b32 v5, v97, v96, s44
    v_perm_b32 v6, v97, v96, s45
    s_waitcnt vmcnt(56)
    v_perm_b32 v232, v99, v98, v11
    v_accvgpr_write_b32 a208, v5
    v_accvgpr_write_b32 a212, v6
    s_add_u32 s17, s49, 1072512
    buffer_load_dword v44, v9, s[20:23], s17 offen
    buffer_load_dword v45, v10, s[20:23], s17 offen
    buffer_load_dword v46, v12, s[20:23], s17 offen
    buffer_load_dword v47, v13, s[20:23], s17 offen
    s_waitcnt vmcnt(58)
    v_perm_b32 v5, v101, v100, s44
    v_perm_b32 v6, v101, v100, s45
    s_waitcnt vmcnt(56)
    v_perm_b32 v233, v103, v102, v11
    v_accvgpr_write_b32 a209, v5
    v_accvgpr_write_b32 a213, v6
    s_add_u32 s17, s49, 1105920
    buffer_load_dword v48, v9, s[20:23], s17 offen
    buffer_load_dword v49, v10, s[20:23], s17 offen
    buffer_load_dword v50, v12, s[20:23], s17 offen
    buffer_load_dword v51, v13, s[20:23], s17 offen
    s_waitcnt vmcnt(58)
    v_perm_b32 v5, v105, v104, s44
    v_perm_b32 v6, v105, v104, s45
    s_waitcnt vmcnt(56)
    v_perm_b32 v234, v107, v106, v11
    v_accvgpr_write_b32 a210, v5
    v_accvgpr_write_b32 a214, v6
    s_add_u32 s17, s49, 1107072
    buffer_load_dword v52, v9, s[20:23], s17 offen
    buffer_load_dword v53, v10, s[20:23], s17 offen
    buffer_load_dword v54, v12, s[20:23], s17 offen
    buffer_load_dword v55, v13, s[20:23], s17 offen
    s_waitcnt vmcnt(58)
    v_perm_b32 v5, v109, v108, s44
    v_perm_b32 v6, v109, v108, s45
    s_waitcnt vmcnt(56)
    v_perm_b32 v235, v111, v110, v11
    v_accvgpr_write_b32 a211, v5
    v_accvgpr_write_b32 a215, v6
    s_add_u32 s17, s49, 1108224
    buffer_load_dword v56, v9, s[20:23], s17 offen
    buffer_load_dword v57, v10, s[20:23], s17 offen
    buffer_load_dword v58, v12, s[20:23], s17 offen
    buffer_load_dword v59, v13, s[20:23], s17 offen
    s_waitcnt vmcnt(58)
    v_perm_b32 v5, v113, v112, s44
    v_perm_b32 v6, v113, v112, s45
    s_waitcnt vmcnt(56)
    v_perm_b32 v236, v115, v114, v11
    v_accvgpr_write_b32 a216, v5
    v_accvgpr_write_b32 a220, v6
    s_add_u32 s17, s49, 1109376
    buffer_load_dword v60, v9, s[20:23], s17 offen
    buffer_load_dword v61, v10, s[20:23], s17 offen
    buffer_load_dword v62, v12, s[20:23], s17 offen
    buffer_load_dword v63, v13, s[20:23], s17 offen
    s_waitcnt vmcnt(58)
    v_perm_b32 v5, v117, v116, s44
    v_perm_b32 v6, v117, v116, s45
    s_waitcnt vmcnt(56)
    v_perm_b32 v237, v119, v118, v11
    v_accvgpr_write_b32 a217, v5
    v_accvgpr_write_b32 a221, v6
    s_add_u32 s17, s49, 1142784
    buffer_load_dword v64, v9, s[20:23], s17 offen
    buffer_load_dword v65, v10, s[20:23], s17 offen
    buffer_load_dword v66, v12, s[20:23], s17 offen
    buffer_load_dword v67, v13, s[20:23], s17 offen
    s_waitcnt vmcnt(58)
    v_perm_b32 v5, v121, v120, s44
    v_perm_b32 v6, v121, v120, s45
    s_waitcnt vmcnt(56)
    v_perm_b32 v238, v123, v122, v11
    v_accvgpr_write_b32 a218, v5
    v_accvgpr_write_b32 a222, v6
    s_add_u32 s17, s49, 1143936
    buffer_load_dword v68, v9, s[20:23], s17 offen
    buffer_load_dword v69, v10, s[20:23], s17 offen
    buffer_load_dword v70, v12, s[20:23], s17 offen
    buffer_load_dword v71, v13, s[20:23], s17 offen
    s_waitcnt vmcnt(58)
    v_perm_b32 v5, v125, v124, s44
    v_perm_b32 v6, v125, v124, s45
    s_waitcnt vmcnt(56)
    v_perm_b32 v239, v127, v126, v11
    v_accvgpr_write_b32 a219, v5
    v_accvgpr_write_b32 a223, v6
    s_add_u32 s17, s49, 1145088
    buffer_load_dword v72, v9, s[20:23], s17 offen
    buffer_load_dword v73, v10, s[20:23], s17 offen
    buffer_load_dword v74, v12, s[20:23], s17 offen
    buffer_load_dword v75, v13, s[20:23], s17 offen
    s_waitcnt vmcnt(58)
    v_perm_b32 v5, v17, v16, s44
    v_perm_b32 v6, v17, v16, s45
    s_waitcnt vmcnt(56)
    v_perm_b32 v240, v19, v18, v11
    v_accvgpr_write_b32 a224, v5
    v_accvgpr_write_b32 a228, v6
    s_add_u32 s17, s49, 1146240
    buffer_load_dword v76, v9, s[20:23], s17 offen
    buffer_load_dword v77, v10, s[20:23], s17 offen
    buffer_load_dword v78, v12, s[20:23], s17 offen
    buffer_load_dword v79, v13, s[20:23], s17 offen
    s_waitcnt vmcnt(58)
    v_perm_b32 v5, v21, v20, s44
    v_perm_b32 v6, v21, v20, s45
    s_waitcnt vmcnt(56)
    v_perm_b32 v241, v23, v22, v11
    v_accvgpr_write_b32 a225, v5
    v_accvgpr_write_b32 a229, v6
    s_waitcnt vmcnt(54)
    v_perm_b32 v5, v25, v24, s44
    v_perm_b32 v6, v25, v24, s45
    s_waitcnt vmcnt(52)
    v_perm_b32 v242, v27, v26, v11
    v_accvgpr_write_b32 a226, v5
    v_accvgpr_write_b32 a230, v6
    s_waitcnt vmcnt(50)
    v_perm_b32 v5, v29, v28, s44
    v_perm_b32 v6, v29, v28, s45
    s_waitcnt vmcnt(48)
    v_perm_b32 v243, v31, v30, v11
    v_accvgpr_write_b32 a227, v5
    v_accvgpr_write_b32 a231, v6
    s_waitcnt vmcnt(46)
    v_perm_b32 v5, v33, v32, s44
    v_perm_b32 v6, v33, v32, s45
    s_waitcnt vmcnt(44)
    v_perm_b32 v244, v35, v34, v11
    v_accvgpr_write_b32 a232, v5
    v_accvgpr_write_b32 a236, v6
    s_waitcnt vmcnt(42)
    v_perm_b32 v5, v37, v36, s44
    v_perm_b32 v6, v37, v36, s45
    s_waitcnt vmcnt(40)
    v_perm_b32 v245, v39, v38, v11
    v_accvgpr_write_b32 a233, v5
    v_accvgpr_write_b32 a237, v6
    s_waitcnt vmcnt(38)
    v_perm_b32 v5, v41, v40, s44
    v_perm_b32 v6, v41, v40, s45
    s_waitcnt vmcnt(36)
    v_perm_b32 v246, v43, v42, v11
    v_accvgpr_write_b32 a234, v5
    v_accvgpr_write_b32 a238, v6
    s_waitcnt vmcnt(34)
    v_perm_b32 v5, v45, v44, s44
    v_perm_b32 v6, v45, v44, s45
    s_waitcnt vmcnt(32)
    v_perm_b32 v247, v47, v46, v11
    v_accvgpr_write_b32 a235, v5
    v_accvgpr_write_b32 a239, v6
    s_waitcnt vmcnt(30)
    v_perm_b32 v5, v49, v48, s44
    v_perm_b32 v6, v49, v48, s45
    s_waitcnt vmcnt(28)
    v_perm_b32 v248, v51, v50, v11
    v_accvgpr_write_b32 a240, v5
    v_accvgpr_write_b32 a244, v6
    s_waitcnt vmcnt(26)
    v_perm_b32 v5, v53, v52, s44
    v_perm_b32 v6, v53, v52, s45
    s_waitcnt vmcnt(24)
    v_perm_b32 v249, v55, v54, v11
    v_accvgpr_write_b32 a241, v5
    v_accvgpr_write_b32 a245, v6
    s_waitcnt vmcnt(22)
    v_perm_b32 v5, v57, v56, s44
    v_perm_b32 v6, v57, v56, s45
    s_waitcnt vmcnt(20)
    v_perm_b32 v250, v59, v58, v11
    v_accvgpr_write_b32 a242, v5
    v_accvgpr_write_b32 a246, v6
    s_waitcnt vmcnt(18)
    v_perm_b32 v5, v61, v60, s44
    v_perm_b32 v6, v61, v60, s45
    s_waitcnt vmcnt(16)
    v_perm_b32 v251, v63, v62, v11
    v_accvgpr_write_b32 a243, v5
    v_accvgpr_write_b32 a247, v6
    s_waitcnt vmcnt(14)
    v_perm_b32 v5, v65, v64, s44
    v_perm_b32 v6, v65, v64, s45
    s_waitcnt vmcnt(12)
    v_perm_b32 v252, v67, v66, v11
    v_accvgpr_write_b32 a248, v5
    v_accvgpr_write_b32 a252, v6
    s_waitcnt vmcnt(10)
    v_perm_b32 v5, v69, v68, s44
    v_perm_b32 v6, v69, v68, s45
    s_waitcnt vmcnt(8)
    v_perm_b32 v253, v71, v70, v11
    v_accvgpr_write_b32 a249, v5
    v_accvgpr_write_b32 a253, v6
    s_waitcnt vmcnt(6)
    v_perm_b32 v5, v73, v72, s44
    v_perm_b32 v6, v73, v72, s45
    s_waitcnt vmcnt(4)
    v_perm_b32 v254, v75, v74, v11
    v_accvgpr_write_b32 a250, v5
    v_accvgpr_write_b32 a254, v6
    s_waitcnt vmcnt(2)
    v_perm_b32 v5, v77, v76, s44
    v_perm_b32 v6, v77, v76, s45
    s_waitcnt vmcnt(0)
    v_perm_b32 v255, v79, v78, v11
    v_accvgpr_write_b32 a251, v5
    v_accvgpr_write_b32 a255, v6
    s_and_b32 s51, s14, 1
    s_lshl_b32 s17, s51, 4
    v_add_u32 v5, s17, v7
    v_lshlrev_b32 v14, 4, v5
    v_mul_u32_u24 v13, 1152, v5
    s_mul_i32 s17, s50, 96
    v_add_u32 v13, s17, v13
    s_mul_i32 s17, s50, 3072
    v_add_u32 v12, s17, v14
    s_lshl_b32 s17, s50, 9
    v_add_u32 v14, s17, v14
    s_lshl_b32 s49, s50, 7
    s_lshl_b32 s17, s14, 2
    s_add_u32 s49, s49, s17
    s_add_u32 s49, s49, 1622016
    s_mul_i32 s17, s14, 6144
    v_add_u32 v48, s17, v0
    v_mov_b32 v49, 0x10000
    v_lshrrev_b32 v51, 4, v0
    v_min_u32 v51, 42, v51
    s_mul_i32 s17, s50, 43
    v_add_u32 v51, s17, v51
    v_lshlrev_b32 v51, 7, v51
    s_cmp_gt_u32 s14, 1
    s_cbranch_scc1 Ltw_z
    v_lshl_add_u32 v12, v8, 9, v12
    v_lshl_add_u32 v13, v8, 4, v13
    s_lshl_b32 s58, s14, 16
    s_add_u32 s58, s58, 144703488
    s_mov_b32 s43, 0
    s_mov_b32 s28, s8
    s_mov_b32 s29, s9
    s_mov_b32 s30, 0
    s_mov_b32 s31, 0x00020000
    s_mul_i32 s17, s51, 3072
    v_add_u32 v50, s17, v0
    ds_write2_b32 v49, v4, v4 offset0:0 offset1:1
    s_waitcnt lgkmcnt(0)
    s_cmp_lg_u32 s14, 0
    s_cbranch_scc1 LtwX_ini_d
    v_mov_b32 v5, 160
    s_mov_b32 s16, 0
LtwX_ini:
    global_load_dword v6, v5, s[12:13] sc1
    s_add_u32 s16, s16, 1
    s_cmp_gt_u32 s16, 100000
    s_cbranch_scc1 L_role_tw_abort
    s_waitcnt vmcnt(0)
    v_cmp_gt_u32 vcc, 123, v6
    s_nop 0
    s_cbranch_vccz LtwX_ini_d
    s_sleep 8
    s_branch LtwX_ini
LtwX_ini_d:
    s_barrier
LtwX_idle:
    s_cmp_lg_u32 s14, 0
    s_cbranch_scc1 LtwX_nw0
    s_mul_i32 s60, s32, 22528
    s_add_u32 s60, s60, 184448
    s_cmp_lt_u32 s32, 64
    s_cselect_b32 s60, s60, 3080192
    s_mul_i32 s61, s33, 22528
    s_add_u32 s61, s61, 1626240
    s_cmp_lt_u32 s33, 64
    s_cselect_b32 s61, s61, 3080192
    s_mov_b32 s16, 0
LtwX_p_9:
    buffer_load_dword v2, v1, s[8:11], s60 offen sc1
    buffer_load_dword v15, v1, s[8:11], s61 offen sc1
    s_add_u32 s16, s16, 1
    s_cmp_gt_u32 s16, 100000
    s_cbranch_scc1 L_role_tw_abort
    s_waitcnt vmcnt(1)
    v_cmp_eq_u32 vcc, 0, v2
    s_waitcnt vmcnt(0)
    v_cmp_eq_u32 s[54:55], 0, v15
    s_nop 0
    s_cmp_eq_u64 s[54:55], 0
    s_cselect_b32 s62, 2, 0
    s_cmp_eq_u64 vcc, 0
    s_cselect_b32 s62, 1, s62
    s_cmp_lg_u32 s62, 0
    s_cbranch_scc1 LtwX_p_9d
    s_sleep 4
    s_branch LtwX_p_9
LtwX_p_9d:
    v_mov_b32 v5, s62
    ds_write_b32 v49, v5
    s_waitcnt lgkmcnt(0)
LtwX_nw0:
    s_barrier
    ds_read_b32 v6, v49
    v_xor_b32 v49, 4, v49
    s_waitcnt lgkmcnt(0)
    v_readfirstlane_b32 s62, v6
    s_nop 0
    s_cmp_eq_u32 s62, 0
    s_cbranch_scc1 L_role_tw_abort
    s_cmp_lt_u32 s33, 33
    s_cselect_b32 s38, 1, 3
    s_cmp_eq_u32 s62, 2
    s_cselect_b32 s36, 1, 0
    s_cselect_b32 s37, s33, s32
    s_cselect_b32 s17, s38, 0
    s_add_u32 s33, s33, s17
    s_cmp_eq_u32 s62, 1
    s_cselect_b32 s17, 2, 0
    s_add_u32 s32, s32, s17
    s_lshl_b32 s56, s36, 6
    s_add_u32 s56, s56, s37
    s_lshl_b32 s46, s56, 18
    s_add_u32 s46, s46, s58
    s_mul_i32 s41, s36, 4718592
    s_mul_i32 s17, s37, 36864
    s_add_u32 s41, s41, s17
    s_add_u32 s41, s41, 8650752
    s_cmp_ge_u32 s37, 64
    s_cbranch_scc1 L_role_tw_abort
    buffer_load_dword v10, v51, s[8:11], s46 offen
    s_add_u32 s48, s46, 0
    buffer_load_dwordx4 v[64:67], v0, s[8:11], s48 offen offset:0
    buffer_load_dwordx4 v[68:71], v0, s[8:11], s48 offen offset:1024
    buffer_load_dwordx4 v[72:75], v0, s[8:11], s48 offen offset:2048
    buffer_load_dwordx4 v[76:79], v0, s[8:11], s48 offen offset:3072
    s_add_u32 s48, s46, 4096
    buffer_load_dwordx4 v[80:83], v0, s[8:11], s48 offen offset:0
    buffer_load_dwordx4 v[84:87], v0, s[8:11], s48 offen offset:1024
    buffer_load_dwordx4 v[88:91], v0, s[8:11], s48 offen offset:2048
    buffer_load_dwordx4 v[92:95], v0, s[8:11], s48 offen offset:3072
    s_add_u32 s48, s46, 8192
    buffer_load_dwordx4 v[96:99], v0, s[8:11], s48 offen offset:0
    buffer_load_dwordx4 v[100:103], v0, s[8:11], s48 offen offset:1024
    buffer_load_dwordx4 v[104:107], v0, s[8:11], s48 offen offset:2048
    buffer_load_dwordx4 v[108:111], v0, s[8:11], s48 offen offset:3072
    s_add_u32 s48, s46, 12288
    buffer_load_dwordx4 v[112:115], v0, s[8:11], s48 offen offset:0
    buffer_load_dwordx4 v[116:119], v0, s[8:11], s48 offen offset:1024
    buffer_load_dwordx4 v[120:123], v0, s[8:11], s48 offen offset:2048
    buffer_load_dwordx4 v[40:43], v12, s[8:11], s41 offen
LtwX_item:
    s_mov_b32 s34, s36
    s_mov_b32 s35, s37
    s_mov_b32 s47, s41
    buffer_load_dwordx4 v[124:127], v0, s[8:11], s48 offen offset:3072
    s_waitcnt vmcnt(16)
    v_mfma_f32_16x16x32_bf16 v[16:19], a[0:3], v[64:67], 0
    v_mfma_f32_16x16x32_bf16 v[20:23], a[4:7], v[64:67], 0
    v_mfma_f32_16x16x32_bf16 v[24:27], v[128:131], v[64:67], 0
    s_add_u32 s48, s46, 16384
    buffer_load_dwordx4 v[64:67], v0, s[8:11], s48 offen offset:0
    s_waitcnt vmcnt(16)
    v_mfma_f32_16x16x32_bf16 v[28:31], a[0:3], v[68:71], 0
    v_mfma_f32_16x16x32_bf16 v[32:35], a[4:7], v[68:71], 0
    v_mfma_f32_16x16x32_bf16 v[36:39], v[128:131], v[68:71], 0
    buffer_load_dwordx4 v[68:71], v0, s[8:11], s48 offen offset:1024
    s_waitcnt vmcnt(16)
    v_mfma_f32_16x16x32_bf16 v[16:19], a[8:11], v[72:75], v[16:19]
    v_mfma_f32_16x16x32_bf16 v[20:23], a[12:15], v[72:75], v[20:23]
    v_mfma_f32_16x16x32_bf16 v[24:27], v[132:135], v[72:75], v[24:27]
    buffer_load_dwordx4 v[72:75], v0, s[8:11], s48 offen offset:2048
    s_waitcnt vmcnt(16)
    v_mfma_f32_16x16x32_bf16 v[28:31], a[8:11], v[76:79], v[28:31]
    v_mfma_f32_16x16x32_bf16 v[32:35], a[12:15], v[76:79], v[32:35]
    v_mfma_f32_16x16x32_bf16 v[36:39], v[132:135], v[76:79], v[36:39]
    buffer_load_dwordx4 v[76:79], v0, s[8:11], s48 offen offset:3072
    s_waitcnt vmcnt(16)
    v_mfma_f32_16x16x32_bf16 v[16:19], a[16:19], v[80:83], v[16:19]
    v_mfma_f32_16x16x32_bf16 v[20:23], a[20:23], v[80:83], v[20:23]
    v_mfma_f32_16x16x32_bf16 v[24:27], v[136:139], v[80:83], v[24:27]
    s_add_u32 s48, s46, 20480
    buffer_load_dwordx4 v[80:83], v0, s[8:11], s48 offen offset:0
    s_waitcnt vmcnt(16)
    v_mfma_f32_16x16x32_bf16 v[28:31], a[16:19], v[84:87], v[28:31]
    v_mfma_f32_16x16x32_bf16 v[32:35], a[20:23], v[84:87], v[32:35]
    v_mfma_f32_16x16x32_bf16 v[36:39], v[136:139], v[84:87], v[36:39]
    buffer_load_dwordx4 v[84:87], v0, s[8:11], s48 offen offset:1024
    s_waitcnt vmcnt(16)
    v_mfma_f32_16x16x32_bf16 v[16:19], a[24:27], v[88:91], v[16:19]
    v_mfma_f32_16x16x32_bf16 v[20:23], a[28:31], v[88:91], v[20:23]
    v_mfma_f32_16x16x32_bf16 v[24:27], v[140:143], v[88:91], v[24:27]
    buffer_load_dwordx4 v[88:91], v0, s[8:11], s48 offen offset:2048
    s_waitcnt vmcnt(16)
    v_mfma_f32_16x16x32_bf16 v[28:31], a[24:27], v[92:95], v[28:31]
    v_mfma_f32_16x16x32_bf16 v[32:35], a[28:31], v[92:95], v[32:35]
    v_mfma_f32_16x16x32_bf16 v[36:39], v[140:143], v[92:95], v[36:39]
    buffer_load_dwordx4 v[92:95], v0, s[8:11], s48 offen offset:3072
    s_waitcnt vmcnt(16)
    v_mfma_f32_16x16x32_bf16 v[16:19], a[32:35], v[96:99], v[16:19]
    v_mfma_f32_16x16x32_bf16 v[20:23], a[36:39], v[96:99], v[20:23]
    v_mfma_f32_16x16x32_bf16 v[24:27], v[144:147], v[96:99], v[24:27]
    s_add_u32 s48, s46, 24576
    buffer_load_dwordx4 v[96:99], v0, s[8:11], s48 offen offset:0
    s_waitcnt vmcnt(16)
    v_mfma_f32_16x16x32_bf16 v[28:31], a[32:35], v[100:103], v[28:31]
    v_mfma_f32_16x16x32_bf16 v[32:35], a[36:39], v[100:103], v[32:35]
    v_mfma_f32_16x16x32_bf16 v[36:39], v[144:147], v[100:103], v[36:39]
    buffer_load_dwordx4 v[100:103], v0, s[8:11], s48 offen offset:1024
    s_waitcnt vmcnt(16)
    v_mfma_f32_16x16x32_bf16 v[16:19], a[40:43], v[104:107], v[16:19]
    v_mfma_f32_16x16x32_bf16 v[20:23], a[44:47], v[104:107], v[20:23]
    v_mfma_f32_16x16x32_bf16 v[24:27], v[148:151], v[104:107], v[24:27]
    buffer_load_dwordx4 v[104:107], v0, s[8:11], s48 offen offset:2048
    s_waitcnt vmcnt(16)
    v_mfma_f32_16x16x32_bf16 v[28:31], a[40:43], v[108:111], v[28:31]
    v_mfma_f32_16x16x32_bf16 v[32:35], a[44:47], v[108:111], v[32:35]
    v_mfma_f32_16x16x32_bf16 v[36:39], v[148:151], v[108:111], v[36:39]
    buffer_load_dwordx4 v[108:111], v0, s[8:11], s48 offen offset:3072
    s_waitcnt vmcnt(16)
    v_mfma_f32_16x16x32_bf16 v[16:19], a[48:51], v[112:115], v[16:19]
    v_mfma_f32_16x16x32_bf16 v[20:23], a[52:55], v[112:115], v[20:23]
    v_mfma_f32_16x16x32_bf16 v[24:27], v[152:155], v[112:115], v[24:27]
    s_add_u32 s48, s46, 28672
    buffer_load_dwordx4 v[112:115], v0, s[8:11], s48 offen offset:0
    s_waitcnt vmcnt(16)
    v_mfma_f32_16x16x32_bf16 v[28:31], a[48:51], v[116:119], v[28:31]
    v_mfma_f32_16x16x32_bf16 v[32:35], a[52:55], v[116:119], v[32:35]
    v_mfma_f32_16x16x32_bf16 v[36:39], v[152:155], v[116:119], v[36:39]
    buffer_load_dwordx4 v[116:119], v0, s[8:11], s48 offen offset:1024
    s_waitcnt vmcnt(16)
    v_mfma_f32_16x16x32_bf16 v[16:19], a[56:59], v[120:123], v[16:19]
    v_mfma_f32_16x16x32_bf16 v[20:23], a[60:63], v[120:123], v[20:23]
    v_mfma_f32_16x16x32_bf16 v[24:27], v[156:159], v[120:123], v[24:27]
    buffer_load_dwordx4 v[120:123], v0, s[8:11], s48 offen offset:2048
    s_waitcnt vmcnt(15)
    v_mfma_f32_16x16x32_bf16 v[28:31], a[56:59], v[124:127], v[28:31]
    v_mfma_f32_16x16x32_bf16 v[32:35], a[60:63], v[124:127], v[32:35]
    v_mfma_f32_16x16x32_bf16 v[36:39], v[156:159], v[124:127], v[36:39]
    buffer_load_dwordx4 v[124:127], v0, s[8:11], s48 offen offset:3072
    s_waitcnt vmcnt(15)
    v_mfma_f32_16x16x32_bf16 v[16:19], a[64:67], v[64:67], v[16:19]
    v_mfma_f32_16x16x32_bf16 v[20:23], a[68:71], v[64:67], v[20:23]
    v_mfma_f32_16x16x32_bf16 v[24:27], v[160:163], v[64:67], v[24:27]
    s_add_u32 s48, s46, 32768
    buffer_load_dwordx4 v[64:67], v0, s[8:11], s48 offen offset:0
    s_waitcnt vmcnt(15)
    v_mfma_f32_16x16x32_bf16 v[28:31], a[64:67], v[68:71], v[28:31]
    v_mfma_f32_16x16x32_bf16 v[32:35], a[68:71], v[68:71], v[32:35]
    v_mfma_f32_16x16x32_bf16 v[36:39], v[160:163], v[68:71], v[36:39]
    s_cmp_lg_u32 s43, 0
    s_cselect_b64 exec, 1, 0
    buffer_store_dword v3, v4, s[8:11], s43 offen sc1
    s_mov_b64 exec, -1
    s_mov_b32 s43, 0
    buffer_load_dwordx4 v[68:71], v0, s[8:11], s48 offen offset:1024
    s_waitcnt vmcnt(16)
    v_mfma_f32_16x16x32_bf16 v[16:19], a[72:75], v[72:75], v[16:19]
    v_mfma_f32_16x16x32_bf16 v[20:23], a[76:79], v[72:75], v[20:23]
    v_mfma_f32_16x16x32_bf16 v[24:27], v[164:167], v[72:75], v[24:27]
    buffer_load_dwordx4 v[72:75], v0, s[8:11], s48 offen offset:2048
    s_waitcnt vmcnt(16)
    v_mfma_f32_16x16x32_bf16 v[28:31], a[72:75], v[76:79], v[28:31]
    v_mfma_f32_16x16x32_bf16 v[32:35], a[76:79], v[76:79], v[32:35]
    v_mfma_f32_16x16x32_bf16 v[36:39], v[164:167], v[76:79], v[36:39]
    buffer_load_dwordx4 v[76:79], v0, s[8:11], s48 offen offset:3072
    s_waitcnt vmcnt(16)
    v_mfma_f32_16x16x32_bf16 v[16:19], a[80:83], v[80:83], v[16:19]
    v_mfma_f32_16x16x32_bf16 v[20:23], a[84:87], v[80:83], v[20:23]
    v_mfma_f32_16x16x32_bf16 v[24:27], v[168:171], v[80:83], v[24:27]
    s_add_u32 s48, s46, 36864
    buffer_load_dwordx4 v[80:83], v0, s[8:11], s48 offen offset:0
    s_waitcnt vmcnt(16)
    v_mfma_f32_16x16x32_bf16 v[28:31], a[80:83], v[84:87], v[28:31]
    v_mfma_f32_16x16x32_bf16 v[32:35], a[84:87], v[84:87], v[32:35]
    v_mfma_f32_16x16x32_bf16 v[36:39], v[168:171], v[84:87], v[36:39]
    buffer_load_dwordx4 v[84:87], v0, s[8:11], s48 offen offset:1024
    s_waitcnt vmcnt(16)
    v_mfma_f32_16x16x32_bf16 v[16:19], a[88:91], v[88:91], v[16:19]
    v_mfma_f32_16x16x32_bf16 v[20:23], a[92:95], v[88:91], v[20:23]
    v_mfma_f32_16x16x32_bf16 v[24:27], v[172:175], v[88:91], v[24:27]
    buffer_load_dwordx4 v[88:91], v0, s[8:11], s48 offen offset:2048
    s_waitcnt vmcnt(16)
    v_mfma_f32_16x16x32_bf16 v[28:31], a[88:91], v[92:95], v[28:31]
    v_mfma_f32_16x16x32_bf16 v[32:35], a[92:95], v[92:95], v[32:35]
    v_mfma_f32_16x16x32_bf16 v[36:39], v[172:175], v[92:95], v[36:39]
    buffer_load_dwordx4 v[92:95], v0, s[8:11], s48 offen offset:3072
    s_waitcnt vmcnt(16)
    v_mfma_f32_16x16x32_bf16 v[16:19], a[96:99], v[96:99], v[16:19]
    v_mfma_f32_16x16x32_bf16 v[20:23], a[100:103], v[96:99], v[20:23]
    v_mfma_f32_16x16x32_bf16 v[24:27], v[176:179], v[96:99], v[24:27]
    s_add_u32 s48, s46, 40960
    buffer_load_dwordx4 v[96:99], v0, s[8:11], s48 offen offset:0
    s_waitcnt vmcnt(16)
    v_mfma_f32_16x16x32_bf16 v[28:31], a[96:99], v[100:103], v[28:31]
    v_mfma_f32_16x16x32_bf16 v[32:35], a[100:103], v[100:103], v[32:35]
    v_mfma_f32_16x16x32_bf16 v[36:39], v[176:179], v[100:103], v[36:39]
    buffer_load_dwordx4 v[100:103], v0, s[8:11], s48 offen offset:1024
    s_waitcnt vmcnt(16)
    v_mfma_f32_16x16x32_bf16 v[16:19], a[104:107], v[104:107], v[16:19]
    v_mfma_f32_16x16x32_bf16 v[20:23], a[108:111], v[104:107], v[20:23]
    v_mfma_f32_16x16x32_bf16 v[24:27], v[180:183], v[104:107], v[24:27]
    s_cmp_lg_u32 s14, 0
    s_cbranch_scc1 LtwX_nw1
    s_mul_i32 s60, s32, 22528
    s_add_u32 s60, s60, 184448
    s_cmp_lt_u32 s32, 64
    s_cselect_b32 s60, s60, 3080192
    s_mul_i32 s61, s33, 22528
    s_add_u32 s61, s61, 1626240
    s_cmp_lt_u32 s33, 64
    s_cselect_b32 s61, s61, 3080192
    buffer_load_dword v2, v1, s[8:11], s60 offen sc1
    buffer_load_dword v15, v1, s[8:11], s61 offen sc1
LtwX_nw1:
    buffer_load_dwordx4 v[104:107], v0, s[8:11], s48 offen offset:2048
    s_waitcnt vmcnt(16)
    v_mfma_f32_16x16x32_bf16 v[28:31], a[104:107], v[108:111], v[28:31]
    v_mfma_f32_16x16x32_bf16 v[32:35], a[108:111], v[108:111], v[32:35]
    v_mfma_f32_16x16x32_bf16 v[36:39], v[180:183], v[108:111], v[36:39]
    buffer_load_dwordx4 v[108:111], v0, s[8:11], s48 offen offset:3072
    s_waitcnt vmcnt(16)
    v_mfma_f32_16x16x32_bf16 v[16:19], a[112:115], v[112:115], v[16:19]
    v_mfma_f32_16x16x32_bf16 v[20:23], a[116:119], v[112:115], v[20:23]
    v_mfma_f32_16x16x32_bf16 v[24:27], v[184:187], v[112:115], v[24:27]
    s_add_u32 s48, s46, 45056
    buffer_load_dwordx4 v[112:115], v0, s[8:11], s48 offen offset:0
    s_waitcnt vmcnt(16)
    v_mfma_f32_16x16x32_bf16 v[28:31], a[112:115], v[116:119], v[28:31]
    v_mfma_f32_16x16x32_bf16 v[32:35], a[116:119], v[116:119], v[32:35]
    v_mfma_f32_16x16x32_bf16 v[36:39], v[184:187], v[116:119], v[36:39]
    buffer_load_dwordx4 v[116:119], v0, s[8:11], s48 offen offset:1024
    s_waitcnt vmcnt(16)
    v_mfma_f32_16x16x32_bf16 v[16:19], a[120:123], v[120:123], v[16:19]
    v_mfma_f32_16x16x32_bf16 v[20:23], a[124:127], v[120:123], v[20:23]
    v_mfma_f32_16x16x32_bf16 v[24:27], v[188:191], v[120:123], v[24:27]
    buffer_load_dwordx4 v[120:123], v0, s[8:11], s48 offen offset:2048
    s_waitcnt vmcnt(16)
    v_mfma_f32_16x16x32_bf16 v[28:31], a[120:123], v[124:127], v[28:31]
    v_mfma_f32_16x16x32_bf16 v[32:35], a[124:127], v[124:127], v[32:35]
    v_mfma_f32_16x16x32_bf16 v[36:39], v[188:191], v[124:127], v[36:39]
    buffer_load_dwordx4 v[124:127], v0, s[8:11], s48 offen offset:3072
    s_waitcnt vmcnt(16)
    v_mfma_f32_16x16x32_bf16 v[16:19], a[128:131], v[64:67], v[16:19]
    v_mfma_f32_16x16x32_bf16 v[20:23], a[132:135], v[64:67], v[20:23]
    v_mfma_f32_16x16x32_bf16 v[24:27], v[192:195], v[64:67], v[24:27]
    s_add_u32 s48, s46, 49152
    buffer_load_dwordx4 v[64:67], v0, s[8:11], s48 offen offset:0
    s_waitcnt vmcnt(15)
    v_mfma_f32_16x16x32_bf16 v[28:31], a[128:131], v[68:71], v[28:31]
    v_mfma_f32_16x16x32_bf16 v[32:35], a[132:135], v[68:71], v[32:35]
    v_mfma_f32_16x16x32_bf16 v[36:39], v[192:195], v[68:71], v[36:39]
    buffer_load_dwordx4 v[68:71], v0, s[8:11], s48 offen offset:1024
    s_waitcnt vmcnt(15)
    v_mfma_f32_16x16x32_bf16 v[16:19], a[136:139], v[72:75], v[16:19]
    v_mfma_f32_16x16x32_bf16 v[20:23], a[140:143], v[72:75], v[20:23]
    v_mfma_f32_16x16x32_bf16 v[24:27], v[196:199], v[72:75], v[24:27]
    buffer_load_dwordx4 v[72:75], v0, s[8:11], s48 offen offset:2048
    s_waitcnt vmcnt(15)
    v_mfma_f32_16x16x32_bf16 v[28:31], a[136:139], v[76:79], v[28:31]
    v_mfma_f32_16x16x32_bf16 v[32:35], a[140:143], v[76:79], v[32:35]
    v_mfma_f32_16x16x32_bf16 v[36:39], v[196:199], v[76:79], v[36:39]
    buffer_load_dwordx4 v[76:79], v0, s[8:11], s48 offen offset:3072
    s_waitcnt vmcnt(15)
    v_mfma_f32_16x16x32_bf16 v[16:19], a[144:147], v[80:83], v[16:19]
    v_mfma_f32_16x16x32_bf16 v[20:23], a[148:151], v[80:83], v[20:23]
    v_mfma_f32_16x16x32_bf16 v[24:27], v[200:203], v[80:83], v[24:27]
    s_add_u32 s48, s46, 53248
    buffer_load_dwordx4 v[80:83], v0, s[8:11], s48 offen offset:0
    s_waitcnt vmcnt(15)
    v_mfma_f32_16x16x32_bf16 v[28:31], a[144:147], v[84:87], v[28:31]
    v_mfma_f32_16x16x32_bf16 v[32:35], a[148:151], v[84:87], v[32:35]
    v_mfma_f32_16x16x32_bf16 v[36:39], v[200:203], v[84:87], v[36:39]
    buffer_load_dwordx4 v[84:87], v0, s[8:11], s48 offen offset:1024
    s_waitcnt vmcnt(15)
    v_mfma_f32_16x16x32_bf16 v[16:19], a[152:155], v[88:91], v[16:19]
    v_mfma_f32_16x16x32_bf16 v[20:23], a[156:159], v[88:91], v[20:23]
    v_mfma_f32_16x16x32_bf16 v[24:27], v[204:207], v[88:91], v[24:27]
    buffer_load_dwordx4 v[88:91], v0, s[8:11], s48 offen offset:2048
    s_waitcnt vmcnt(15)
    v_mfma_f32_16x16x32_bf16 v[28:31], a[152:155], v[92:95], v[28:31]
    v_mfma_f32_16x16x32_bf16 v[32:35], a[156:159], v[92:95], v[32:35]
    v_mfma_f32_16x16x32_bf16 v[36:39], v[204:207], v[92:95], v[36:39]
    buffer_load_dwordx4 v[92:95], v0, s[8:11], s48 offen offset:3072
    s_waitcnt vmcnt(15)
    v_mfma_f32_16x16x32_bf16 v[16:19], a[160:163], v[96:99], v[16:19]
    v_mfma_f32_16x16x32_bf16 v[20:23], a[164:167], v[96:99], v[20:23]
    v_mfma_f32_16x16x32_bf16 v[24:27], v[208:211], v[96:99], v[24:27]
    s_add_u32 s48, s46, 57344
    buffer_load_dwordx4 v[96:99], v0, s[8:11], s48 offen offset:0
    s_waitcnt vmcnt(15)
    v_mfma_f32_16x16x32_bf16 v[28:31], a[160:163], v[100:103], v[28:31]
    v_mfma_f32_16x16x32_bf16 v[32:35], a[164:167], v[100:103], v[32:35]
    v_mfma_f32_16x16x32_bf16 v[36:39], v[208:211], v[100:103], v[36:39]
    buffer_load_dwordx4 v[100:103], v0, s[8:11], s48 offen offset:1024
    s_waitcnt vmcnt(15)
    v_mfma_f32_16x16x32_bf16 v[16:19], a[168:171], v[104:107], v[16:19]
    v_mfma_f32_16x16x32_bf16 v[20:23], a[172:175], v[104:107], v[20:23]
    v_mfma_f32_16x16x32_bf16 v[24:27], v[212:215], v[104:107], v[24:27]
    buffer_load_dwordx4 v[104:107], v0, s[8:11], s48 offen offset:2048
    s_waitcnt vmcnt(15)
    v_mfma_f32_16x16x32_bf16 v[28:31], a[168:171], v[108:111], v[28:31]
    v_mfma_f32_16x16x32_bf16 v[32:35], a[172:175], v[108:111], v[32:35]
    v_mfma_f32_16x16x32_bf16 v[36:39], v[212:215], v[108:111], v[36:39]
    buffer_load_dwordx4 v[108:111], v0, s[8:11], s48 offen offset:3072
    s_waitcnt vmcnt(15)
    v_mfma_f32_16x16x32_bf16 v[16:19], a[176:179], v[112:115], v[16:19]
    v_mfma_f32_16x16x32_bf16 v[20:23], a[180:183], v[112:115], v[20:23]
    v_mfma_f32_16x16x32_bf16 v[24:27], v[216:219], v[112:115], v[24:27]
    s_cmp_lg_u32 s14, 0
    s_cbranch_scc1 LtwX_nw2
    v_cmp_eq_u32 vcc, 0, v2
    v_cmp_eq_u32 s[54:55], 0, v15
    s_nop 0
    s_cmp_eq_u64 s[54:55], 0
    s_cselect_b32 s62, 2, 0
    s_cmp_eq_u64 vcc, 0
    s_cselect_b32 s62, 1, s62
    v_mov_b32 v5, s62
    ds_write_b32 v49, v5
    s_waitcnt lgkmcnt(0)
LtwX_nw2:
    s_barrier
    ds_read_b32 v6, v49
    v_xor_b32 v49, 4, v49
    s_add_u32 s48, s46, 61440
    buffer_load_dwordx4 v[112:115], v0, s[8:11], s48 offen offset:0
    s_waitcnt vmcnt(15)
    v_mfma_f32_16x16x32_bf16 v[28:31], a[176:179], v[116:119], v[28:31]
    v_mfma_f32_16x16x32_bf16 v[32:35], a[180:183], v[116:119], v[32:35]
    v_mfma_f32_16x16x32_bf16 v[36:39], v[216:219], v[116:119], v[36:39]
    buffer_load_dwordx4 v[116:119], v0, s[8:11], s48 offen offset:1024
    s_waitcnt vmcnt(15)
    v_mfma_f32_16x16x32_bf16 v[16:19], a[184:187], v[120:123], v[16:19]
    v_mfma_f32_16x16x32_bf16 v[20:23], a[188:191], v[120:123], v[20:23]
    v_mfma_f32_16x16x32_bf16 v[24:27], v[220:223], v[120:123], v[24:27]
    buffer_load_dwordx4 v[120:123], v0, s[8:11], s48 offen offset:2048
    s_waitcnt vmcnt(15)
    v_mfma_f32_16x16x32_bf16 v[28:31], a[184:187], v[124:127], v[28:31]
    v_mfma_f32_16x16x32_bf16 v[32:35], a[188:191], v[124:127], v[32:35]
    v_mfma_f32_16x16x32_bf16 v[36:39], v[220:223], v[124:127], v[36:39]
    s_waitcnt lgkmcnt(0)
    v_readfirstlane_b32 s62, v6
    s_cmp_lt_u32 s33, 33
    s_cselect_b32 s38, 1, 3
    s_cmp_eq_u32 s62, 2
    s_cselect_b32 s36, 1, 0
    s_cselect_b32 s37, s33, s32
    s_cselect_b32 s17, s38, 0
    s_add_u32 s33, s33, s17
    s_cmp_eq_u32 s62, 1
    s_cselect_b32 s17, 2, 0
    s_add_u32 s32, s32, s17
    s_lshl_b32 s56, s36, 6
    s_add_u32 s56, s56, s37
    buffer_load_dwordx4 v[124:127], v0, s[8:11], s48 offen offset:3072
    s_waitcnt vmcnt(15)
    v_mfma_f32_16x16x32_bf16 v[16:19], a[192:195], v[64:67], v[16:19]
    v_mfma_f32_16x16x32_bf16 v[20:23], a[196:199], v[64:67], v[20:23]
    v_mfma_f32_16x16x32_bf16 v[24:27], v[224:227], v[64:67], v[24:27]
    s_cmp_lt_u32 s37, 64
    s_cselect_b32 s62, s62, 0
    s_lshl_b32 s46, s56, 18
    s_add_u32 s46, s46, s58
    s_mul_i32 s41, s36, 4718592
    s_mul_i32 s17, s37, 36864
    s_add_u32 s41, s41, s17
    s_add_u32 s41, s41, 8650752
    s_cmp_lg_u32 s62, 0
    s_cselect_b32 s30, 268435456, 0
    buffer_load_dword v10, v51, s[28:31], s46 offen
    s_add_u32 s48, s46, 0
    buffer_load_dwordx4 v[64:67], v0, s[28:31], s48 offen offset:0
    s_waitcnt vmcnt(15)
    v_mfma_f32_16x16x32_bf16 v[28:31], a[192:195], v[68:71], v[28:31]
    v_mfma_f32_16x16x32_bf16 v[32:35], a[196:199], v[68:71], v[32:35]
    v_mfma_f32_16x16x32_bf16 v[36:39], v[224:227], v[68:71], v[36:39]
    buffer_load_dwordx4 v[68:71], v0, s[28:31], s48 offen offset:1024
    s_waitcnt vmcnt(15)
    v_mfma_f32_16x16x32_bf16 v[16:19], a[200:203], v[72:75], v[16:19]
    v_mfma_f32_16x16x32_bf16 v[20:23], a[204:207], v[72:75], v[20:23]
    v_mfma_f32_16x16x32_bf16 v[24:27], v[228:231], v[72:75], v[24:27]
    buffer_load_dwordx4 v[72:75], v0, s[28:31], s48 offen offset:2048
    s_waitcnt vmcnt(15)
    v_mfma_f32_16x16x32_bf16 v[28:31], a[200:203], v[76:79], v[28:31]
    v_mfma_f32_16x16x32_bf16 v[32:35], a[204:207], v[76:79], v[32:35]
    v_mfma_f32_16x16x32_bf16 v[36:39], v[228:231], v[76:79], v[36:39]
    buffer_load_dwordx4 v[76:79], v0, s[28:31], s48 offen offset:3072
    s_waitcnt vmcnt(15)
    v_mfma_f32_16x16x32_bf16 v[16:19], a[208:211], v[80:83], v[16:19]
    v_mfma_f32_16x16x32_bf16 v[20:23], a[212:215], v[80:83], v[20:23]
    v_mfma_f32_16x16x32_bf16 v[24:27], v[232:235], v[80:83], v[24:27]
    s_add_u32 s48, s46, 4096
    buffer_load_dwordx4 v[80:83], v0, s[28:31], s48 offen offset:0
    s_waitcnt vmcnt(15)
    v_mfma_f32_16x16x32_bf16 v[28:31], a[208:211], v[84:87], v[28:31]
    v_mfma_f32_16x16x32_bf16 v[32:35], a[212:215], v[84:87], v[32:35]
    v_mfma_f32_16x16x32_bf16 v[36:39], v[232:235], v[84:87], v[36:39]
    buffer_load_dwordx4 v[84:87], v0, s[28:31], s48 offen offset:1024
    s_waitcnt vmcnt(15)
    v_mfma_f32_16x16x32_bf16 v[16:19], a[216:219], v[88:91], v[16:19]
    v_mfma_f32_16x16x32_bf16 v[20:23], a[220:223], v[88:91], v[20:23]
    v_mfma_f32_16x16x32_bf16 v[24:27], v[236:239], v[88:91], v[24:27]
    buffer_load_dwordx4 v[88:91], v0, s[28:31], s48 offen offset:2048
    s_waitcnt vmcnt(15)
    v_mfma_f32_16x16x32_bf16 v[28:31], a[216:219], v[92:95], v[28:31]
    v_mfma_f32_16x16x32_bf16 v[32:35], a[220:223], v[92:95], v[32:35]
    v_mfma_f32_16x16x32_bf16 v[36:39], v[236:239], v[92:95], v[36:39]
    buffer_load_dwordx4 v[92:95], v0, s[28:31], s48 offen offset:3072
    s_waitcnt vmcnt(15)
    v_mfma_f32_16x16x32_bf16 v[16:19], a[224:227], v[96:99], v[16:19]
    v_mfma_f32_16x16x32_bf16 v[20:23], a[228:231], v[96:99], v[20:23]
    v_mfma_f32_16x16x32_bf16 v[24:27], v[240:243], v[96:99], v[24:27]
    s_add_u32 s48, s46, 8192
    buffer_load_dwordx4 v[96:99], v0, s[28:31], s48 offen offset:0
    s_waitcnt vmcnt(15)
    v_mfma_f32_16x16x32_bf16 v[28:31], a[224:227], v[100:103], v[28:31]
    v_mfma_f32_16x16x32_bf16 v[32:35], a[228:231], v[100:103], v[32:35]
    v_mfma_f32_16x16x32_bf16 v[36:39], v[240:243], v[100:103], v[36:39]
    buffer_load_dwordx4 v[100:103], v0, s[28:31], s48 offen offset:1024
    s_waitcnt vmcnt(15)
    v_mfma_f32_16x16x32_bf16 v[16:19], a[232:235], v[104:107], v[16:19]
    v_mfma_f32_16x16x32_bf16 v[20:23], a[236:239], v[104:107], v[20:23]
    v_mfma_f32_16x16x32_bf16 v[24:27], v[244:247], v[104:107], v[24:27]
    buffer_load_dwordx4 v[104:107], v0, s[28:31], s48 offen offset:2048
    s_waitcnt vmcnt(15)
    v_mfma_f32_16x16x32_bf16 v[28:31], a[232:235], v[108:111], v[28:31]
    v_mfma_f32_16x16x32_bf16 v[32:35], a[236:239], v[108:111], v[32:35]
    v_mfma_f32_16x16x32_bf16 v[36:39], v[244:247], v[108:111], v[36:39]
    buffer_load_dwordx4 v[108:111], v0, s[28:31], s48 offen offset:3072
    s_waitcnt vmcnt(15)
    v_mfma_f32_16x16x32_bf16 v[16:19], a[240:243], v[112:115], v[16:19]
    v_mfma_f32_16x16x32_bf16 v[20:23], a[244:247], v[112:115], v[20:23]
    v_mfma_f32_16x16x32_bf16 v[24:27], v[248:251], v[112:115], v[24:27]
    s_add_u32 s48, s46, 12288
    buffer_load_dwordx4 v[112:115], v0, s[28:31], s48 offen offset:0
    s_waitcnt vmcnt(15)
    v_mfma_f32_16x16x32_bf16 v[28:31], a[240:243], v[116:119], v[28:31]
    v_mfma_f32_16x16x32_bf16 v[32:35], a[244:247], v[116:119], v[32:35]
    v_mfma_f32_16x16x32_bf16 v[36:39], v[248:251], v[116:119], v[36:39]
    buffer_load_dwordx4 v[116:119], v0, s[28:31], s48 offen offset:1024
    s_waitcnt vmcnt(15)
    v_mfma_f32_16x16x32_bf16 v[16:19], a[248:251], v[120:123], v[16:19]
    v_mfma_f32_16x16x32_bf16 v[20:23], a[252:255], v[120:123], v[20:23]
    v_mfma_f32_16x16x32_bf16 v[24:27], v[252:255], v[120:123], v[24:27]
    buffer_load_dwordx4 v[120:123], v0, s[28:31], s48 offen offset:2048
    s_waitcnt vmcnt(15)
    v_mfma_f32_16x16x32_bf16 v[28:31], a[248:251], v[124:127], v[28:31]
    v_mfma_f32_16x16x32_bf16 v[32:35], a[252:255], v[124:127], v[32:35]
    v_mfma_f32_16x16x32_bf16 v[36:39], v[252:255], v[124:127], v[36:39]
    s_nop 5
    ds_write_b128 v48, v[16:19] offset:0
    ds_write_b128 v48, v[20:23] offset:1024
    ds_write_b128 v48, v[24:27] offset:2048
    ds_write_b128 v48, v[28:31] offset:3072
    ds_write_b128 v48, v[32:35] offset:4096
    ds_write_b128 v48, v[36:39] offset:5120
    s_waitcnt lgkmcnt(0)
    s_barrier
    ds_read_b128 v[24:27], v50 offset:0
    ds_read_b128 v[28:31], v50 offset:1024
    ds_read_b128 v[32:35], v50 offset:6144
    ds_read_b128 v[36:39], v50 offset:7168
    ds_read_b128 v[56:59], v50 offset:12288
    ds_read_b128 v[60:63], v50 offset:13312
    ds_read_b128 v[124:127], v50 offset:18432
    ds_read_b128 v[52:55], v50 offset:19456
    v_xor_b32 v48, 0x8000, v48
    v_xor_b32 v50, 0x8000, v50
    v_lshlrev_b32 v16, 16, v40
    v_and_b32 v20, 0xffff0000, v40
    v_lshlrev_b32 v17, 16, v41
    v_and_b32 v21, 0xffff0000, v41
    v_lshlrev_b32 v18, 16, v42
    v_and_b32 v22, 0xffff0000, v42
    v_lshlrev_b32 v19, 16, v43
    v_and_b32 v23, 0xffff0000, v43
    buffer_load_dwordx4 v[40:43], v12, s[28:31], s41 offen
    s_waitcnt lgkmcnt(7)
    v_add_f32 v16, v16, v24
    v_add_f32 v17, v17, v25
    v_add_f32 v18, v18, v26
    v_add_f32 v19, v19, v27
    s_waitcnt lgkmcnt(6)
    v_add_f32 v20, v20, v28
    v_add_f32 v21, v21, v29
    v_add_f32 v22, v22, v30
    v_add_f32 v23, v23, v31
    s_waitcnt lgkmcnt(5)
    v_add_f32 v16, v16, v32
    v_add_f32 v17, v17, v33
    v_add_f32 v18, v18, v34
    v_add_f32 v19, v19, v35
    s_waitcnt lgkmcnt(4)
    v_add_f32 v20, v20, v36
    v_add_f32 v21, v21, v37
    v_add_f32 v22, v22, v38
    v_add_f32 v23, v23, v39
    s_waitcnt lgkmcnt(3)
    v_add_f32 v16, v16, v56
    v_add_f32 v17, v17, v57
    v_add_f32 v18, v18, v58
    v_add_f32 v19, v19, v59
    s_waitcnt lgkmcnt(2)
    v_add_f32 v20, v20, v60
    v_add_f32 v21, v21, v61
    v_add_f32 v22, v22, v62
    v_add_f32 v23, v23, v63
    s_waitcnt lgkmcnt(1)
    v_add_f32 v16, v16, v124
    v_add_f32 v17, v17, v125
    v_add_f32 v18, v18, v126
    v_add_f32 v19, v19, v127
    s_waitcnt lgkmcnt(0)
    v_add_f32 v20, v20, v52
    v_add_f32 v21, v21, v53
    v_add_f32 v22, v22, v54
    v_add_f32 v23, v23, v55
    v_cvt_pk_bf16_f32 v52, v16, v20
    v_cvt_pk_bf16_f32 v53, v17, v21
    v_cvt_pk_bf16_f32 v54, v18, v22
    v_cvt_pk_bf16_f32 v55, v19, v23
    s_cmp_eq_u32 s34, 0
    s_cbranch_scc1 LtwX_l0
    s_mul_i32 s17, s35, 36864
    buffer_store_dwordx4 v[52:55], v13, s[24:27], s17 offen
    s_cmp_lg_u32 s62, 0
    s_cbranch_scc1 LtwX_item
LtwX_chk:
    s_min_u32 s17, s32, s33
    s_cmp_lt_u32 s17, 64
    s_cbranch_scc1 LtwX_idle
    s_branch L_role_tw_exit
LtwX_l0:
    s_add_u32 s47, s47, 2359296
    buffer_store_dwordx4 v[52:55], v12, s[8:11], s47 offen sc1
    v_add_f32 v44, v16, v17
    v_mul_f32 v45, v16, v16
    v_fmac_f32 v45, v17, v17
    v_add_f32 v44, v44, v18
    v_fmac_f32 v45, v18, v18
    v_add_f32 v44, v44, v19
    v_fmac_f32 v45, v19, v19
    v_add_f32 v44, v44, v20
    v_fmac_f32 v45, v20, v20
    v_add_f32 v44, v44, v21
    v_fmac_f32 v45, v21, v21
    v_add_f32 v44, v44, v22
    v_fmac_f32 v45, v22, v22
    v_add_f32 v44, v44, v23
    v_fmac_f32 v45, v23, v23
    v_mov_b32 v46, v44
    v_mov_b32 v47, v45
    s_nop 0
    v_permlane32_swap_b32 v44, v46
    v_permlane32_swap_b32 v45, v47
    v_add_f32 v44, v44, v46
    v_add_f32 v45, v45, v47
    v_mov_b32 v46, v44
    v_mov_b32 v47, v45
    s_nop 0
    v_permlane16_swap_b32 v44, v46
    v_permlane16_swap_b32 v45, v47
    v_add_f32 v44, v44, v46
    v_add_f32 v45, v45, v47
    s_mul_i32 s17, s35, 6144
    s_add_u32 s17, s17, 16515072
    s_mov_b64 exec, 0xffff
    buffer_store_dwordx2 v[44:45], v14, s[8:11], s17 offen sc1
    s_mov_b64 exec, -1
    s_mul_i32 s43, s35, 22528
    s_add_u32 s43, s43, s49
    s_cmp_lg_u32 s62, 0
    s_cbranch_scc1 LtwX_item
    s_waitcnt vmcnt(0)
    s_mov_b64 exec, 1
    buffer_store_dword v3, v4, s[8:11], s43 offen sc1
    s_mov_b64 exec, -1
    s_mov_b32 s43, 0
    s_branch LtwX_chk
Ltw_z:
    v_lshrrev_b32 v5, 1, v8
    v_lshl_add_u32 v12, v5, 9, v12
    v_and_b32 v5, 1, v8
    v_lshl_add_u32 v12, v5, 3, v12
    v_add_u32 v12, 2048, v12
    v_lshl_add_u32 v13, v8, 3, v13
    v_add_u32 v13, 64, v13
    v_add_u32 v14, 8, v14
    s_lshl_b32 s58, s14, 16
    s_add_u32 s58, s58, 144703488
    s_mov_b32 s43, 0
    s_mov_b32 s28, s8
    s_mov_b32 s29, s9
    s_mov_b32 s30, 0
    s_mov_b32 s31, 0x00020000
    s_mul_i32 s17, s51, 3072
    v_add_u32 v50, s17, v0
    ds_write2_b32 v49, v4, v4 offset0:0 offset1:1
    s_waitcnt lgkmcnt(0)
    s_cmp_lg_u32 s14, 0
    s_cbranch_scc1 LtwZ_ini_d
    v_mov_b32 v5, 160
    s_mov_b32 s16, 0
LtwZ_ini:
    global_load_dword v6, v5, s[12:13] sc1
    s_add_u32 s16, s16, 1
    s_cmp_gt_u32 s16, 100000
    s_cbranch_scc1 L_role_tw_abort
    s_waitcnt vmcnt(0)
    v_cmp_gt_u32 vcc, 123, v6
    s_nop 0
    s_cbranch_vccz LtwZ_ini_d
    s_sleep 8
    s_branch LtwZ_ini
LtwZ_ini_d:
    s_barrier
LtwZ_idle:
    s_barrier
    ds_read_b32 v6, v49
    v_xor_b32 v49, 4, v49
    s_waitcnt lgkmcnt(0)
    v_readfirstlane_b32 s62, v6
    s_nop 0
    s_cmp_eq_u32 s62, 0
    s_cbranch_scc1 L_role_tw_abort
    s_cmp_lt_u32 s33, 33
    s_cselect_b32 s38, 1, 3
    s_cmp_eq_u32 s62, 2
    s_cselect_b32 s36, 1, 0
    s_cselect_b32 s37, s33, s32
    s_cselect_b32 s17, s38, 0
    s_add_u32 s33, s33, s17
    s_cmp_eq_u32 s62, 1
    s_cselect_b32 s17, 2, 0
    s_add_u32 s32, s32, s17
    s_lshl_b32 s56, s36, 6
    s_add_u32 s56, s56, s37
    s_lshl_b32 s46, s56, 18
    s_add_u32 s46, s46, s58
    s_mul_i32 s41, s36, 4718592
    s_mul_i32 s17, s37, 36864
    s_add_u32 s41, s41, s17
    s_add_u32 s41, s41, 8650752
    s_cmp_ge_u32 s37, 64
    s_cbranch_scc1 L_role_tw_abort
    buffer_load_dword v10, v51, s[8:11], s46 offen
    s_add_u32 s48, s46, 0
    buffer_load_dwordx4 v[64:67], v0, s[8:11], s48 offen offset:0
    buffer_load_dwordx4 v[68:71], v0, s[8:11], s48 offen offset:1024
    buffer_load_dwordx4 v[72:75], v0, s[8:11], s48 offen offset:2048
    buffer_load_dwordx4 v[76:79], v0, s[8:11], s48 offen offset:3072
    s_add_u32 s48, s46, 4096
    buffer_load_dwordx4 v[80:83], v0, s[8:11], s48 offen offset:0
    buffer_load_dwordx4 v[84:87], v0, s[8:11], s48 offen offset:1024
    buffer_load_dwordx4 v[88:91], v0, s[8:11], s48 offen offset:2048
    buffer_load_dwordx4 v[92:95], v0, s[8:11], s48 offen offset:3072
    s_add_u32 s48, s46, 8192
    buffer_load_dwordx4 v[96:99], v0, s[8:11], s48 offen offset:0
    buffer_load_dwordx4 v[100:103], v0, s[8:11], s48 offen offset:1024
    buffer_load_dwordx4 v[104:107], v0, s[8:11], s48 offen offset:2048
    buffer_load_dwordx4 v[108:111], v0, s[8:11], s48 offen offset:3072
    s_add_u32 s48, s46, 12288
    buffer_load_dwordx4 v[112:115], v0, s[8:11], s48 offen offset:0
    buffer_load_dwordx4 v[116:119], v0, s[8:11], s48 offen offset:1024
    buffer_load_dwordx4 v[120:123], v0, s[8:11], s48 offen offset:2048
    buffer_load_dwordx2 v[40:41], v12, s[8:11], s41 offen
LtwZ_item:
    s_mov_b32 s34, s36
    s_mov_b32 s35, s37
    s_mov_b32 s47, s41
    buffer_load_dwordx4 v[124:127], v0, s[8:11], s48 offen offset:3072
    s_waitcnt vmcnt(16)
    v_mfma_f32_16x16x32_bf16 v[16:19], a[0:3], v[64:67], 0
    v_mfma_f32_16x16x32_bf16 v[20:23], a[4:7], v[64:67], 0
    v_mfma_f32_16x16x32_bf16 v[24:27], v[128:131], v[64:67], 0
    s_add_u32 s48, s46, 16384
    buffer_load_dwordx4 v[64:67], v0, s[8:11], s48 offen offset:0
    s_waitcnt vmcnt(16)
    v_mfma_f32_16x16x32_bf16 v[28:31], a[0:3], v[68:71], 0
    v_mfma_f32_16x16x32_bf16 v[32:35], a[4:7], v[68:71], 0
    v_mfma_f32_16x16x32_bf16 v[36:39], v[128:131], v[68:71], 0
    buffer_load_dwordx4 v[68:71], v0, s[8:11], s48 offen offset:1024
    s_waitcnt vmcnt(16)
    v_mfma_f32_16x16x32_bf16 v[16:19], a[8:11], v[72:75], v[16:19]
    v_mfma_f32_16x16x32_bf16 v[20:23], a[12:15], v[72:75], v[20:23]
    v_mfma_f32_16x16x32_bf16 v[24:27], v[132:135], v[72:75], v[24:27]
    buffer_load_dwordx4 v[72:75], v0, s[8:11], s48 offen offset:2048
    s_waitcnt vmcnt(16)
    v_mfma_f32_16x16x32_bf16 v[28:31], a[8:11], v[76:79], v[28:31]
    v_mfma_f32_16x16x32_bf16 v[32:35], a[12:15], v[76:79], v[32:35]
    v_mfma_f32_16x16x32_bf16 v[36:39], v[132:135], v[76:79], v[36:39]
    buffer_load_dwordx4 v[76:79], v0, s[8:11], s48 offen offset:3072
    s_waitcnt vmcnt(16)
    v_mfma_f32_16x16x32_bf16 v[16:19], a[16:19], v[80:83], v[16:19]
    v_mfma_f32_16x16x32_bf16 v[20:23], a[20:23], v[80:83], v[20:23]
    v_mfma_f32_16x16x32_bf16 v[24:27], v[136:139], v[80:83], v[24:27]
    s_add_u32 s48, s46, 20480
    buffer_load_dwordx4 v[80:83], v0, s[8:11], s48 offen offset:0
    s_waitcnt vmcnt(16)
    v_mfma_f32_16x16x32_bf16 v[28:31], a[16:19], v[84:87], v[28:31]
    v_mfma_f32_16x16x32_bf16 v[32:35], a[20:23], v[84:87], v[32:35]
    v_mfma_f32_16x16x32_bf16 v[36:39], v[136:139], v[84:87], v[36:39]
    buffer_load_dwordx4 v[84:87], v0, s[8:11], s48 offen offset:1024
    s_waitcnt vmcnt(16)
    v_mfma_f32_16x16x32_bf16 v[16:19], a[24:27], v[88:91], v[16:19]
    v_mfma_f32_16x16x32_bf16 v[20:23], a[28:31], v[88:91], v[20:23]
    v_mfma_f32_16x16x32_bf16 v[24:27], v[140:143], v[88:91], v[24:27]
    buffer_load_dwordx4 v[88:91], v0, s[8:11], s48 offen offset:2048
    s_waitcnt vmcnt(16)
    v_mfma_f32_16x16x32_bf16 v[28:31], a[24:27], v[92:95], v[28:31]
    v_mfma_f32_16x16x32_bf16 v[32:35], a[28:31], v[92:95], v[32:35]
    v_mfma_f32_16x16x32_bf16 v[36:39], v[140:143], v[92:95], v[36:39]
    buffer_load_dwordx4 v[92:95], v0, s[8:11], s48 offen offset:3072
    s_waitcnt vmcnt(16)
    v_mfma_f32_16x16x32_bf16 v[16:19], a[32:35], v[96:99], v[16:19]
    v_mfma_f32_16x16x32_bf16 v[20:23], a[36:39], v[96:99], v[20:23]
    v_mfma_f32_16x16x32_bf16 v[24:27], v[144:147], v[96:99], v[24:27]
    s_add_u32 s48, s46, 24576
    buffer_load_dwordx4 v[96:99], v0, s[8:11], s48 offen offset:0
    s_waitcnt vmcnt(16)
    v_mfma_f32_16x16x32_bf16 v[28:31], a[32:35], v[100:103], v[28:31]
    v_mfma_f32_16x16x32_bf16 v[32:35], a[36:39], v[100:103], v[32:35]
    v_mfma_f32_16x16x32_bf16 v[36:39], v[144:147], v[100:103], v[36:39]
    buffer_load_dwordx4 v[100:103], v0, s[8:11], s48 offen offset:1024
    s_waitcnt vmcnt(16)
    v_mfma_f32_16x16x32_bf16 v[16:19], a[40:43], v[104:107], v[16:19]
    v_mfma_f32_16x16x32_bf16 v[20:23], a[44:47], v[104:107], v[20:23]
    v_mfma_f32_16x16x32_bf16 v[24:27], v[148:151], v[104:107], v[24:27]
    buffer_load_dwordx4 v[104:107], v0, s[8:11], s48 offen offset:2048
    s_waitcnt vmcnt(16)
    v_mfma_f32_16x16x32_bf16 v[28:31], a[40:43], v[108:111], v[28:31]
    v_mfma_f32_16x16x32_bf16 v[32:35], a[44:47], v[108:111], v[32:35]
    v_mfma_f32_16x16x32_bf16 v[36:39], v[148:151], v[108:111], v[36:39]
    buffer_load_dwordx4 v[108:111], v0, s[8:11], s48 offen offset:3072
    s_waitcnt vmcnt(16)
    v_mfma_f32_16x16x32_bf16 v[16:19], a[48:51], v[112:115], v[16:19]
    v_mfma_f32_16x16x32_bf16 v[20:23], a[52:55], v[112:115], v[20:23]
    v_mfma_f32_16x16x32_bf16 v[24:27], v[152:155], v[112:115], v[24:27]
    s_add_u32 s48, s46, 28672
    buffer_load_dwordx4 v[112:115], v0, s[8:11], s48 offen offset:0
    s_waitcnt vmcnt(16)
    v_mfma_f32_16x16x32_bf16 v[28:31], a[48:51], v[116:119], v[28:31]
    v_mfma_f32_16x16x32_bf16 v[32:35], a[52:55], v[116:119], v[32:35]
    v_mfma_f32_16x16x32_bf16 v[36:39], v[152:155], v[116:119], v[36:39]
    buffer_load_dwordx4 v[116:119], v0, s[8:11], s48 offen offset:1024
    s_waitcnt vmcnt(16)
    v_mfma_f32_16x16x32_bf16 v[16:19], a[56:59], v[120:123], v[16:19]
    v_mfma_f32_16x16x32_bf16 v[20:23], a[60:63], v[120:123], v[20:23]
    v_mfma_f32_16x16x32_bf16 v[24:27], v[156:159], v[120:123], v[24:27]
    buffer_load_dwordx4 v[120:123], v0, s[8:11], s48 offen offset:2048
    s_waitcnt vmcnt(15)
    v_mfma_f32_16x16x32_bf16 v[28:31], a[56:59], v[124:127], v[28:31]
    v_mfma_f32_16x16x32_bf16 v[32:35], a[60:63], v[124:127], v[32:35]
    v_mfma_f32_16x16x32_bf16 v[36:39], v[156:159], v[124:127], v[36:39]
    buffer_load_dwordx4 v[124:127], v0, s[8:11], s48 offen offset:3072
    s_waitcnt vmcnt(15)
    v_mfma_f32_16x16x32_bf16 v[16:19], a[64:67], v[64:67], v[16:19]
    v_mfma_f32_16x16x32_bf16 v[20:23], a[68:71], v[64:67], v[20:23]
    v_mfma_f32_16x16x32_bf16 v[24:27], v[160:163], v[64:67], v[24:27]
    s_add_u32 s48, s46, 32768
    buffer_load_dwordx4 v[64:67], v0, s[8:11], s48 offen offset:0
    s_waitcnt vmcnt(15)
    v_mfma_f32_16x16x32_bf16 v[28:31], a[64:67], v[68:71], v[28:31]
    v_mfma_f32_16x16x32_bf16 v[32:35], a[68:71], v[68:71], v[32:35]
    v_mfma_f32_16x16x32_bf16 v[36:39], v[160:163], v[68:71], v[36:39]
    s_cmp_lg_u32 s43, 0
    s_cselect_b64 exec, 1, 0
    buffer_store_dword v3, v4, s[8:11], s43 offen sc1
    s_mov_b64 exec, -1
    s_mov_b32 s43, 0
    buffer_load_dwordx4 v[68:71], v0, s[8:11], s48 offen offset:1024
    s_waitcnt vmcnt(16)
    v_mfma_f32_16x16x32_bf16 v[16:19], a[72:75], v[72:75], v[16:19]
    v_mfma_f32_16x16x32_bf16 v[20:23], a[76:79], v[72:75], v[20:23]
    v_mfma_f32_16x16x32_bf16 v[24:27], v[164:167], v[72:75], v[24:27]
    buffer_load_dwordx4 v[72:75], v0, s[8:11], s48 offen offset:2048
    s_waitcnt vmcnt(16)
    v_mfma_f32_16x16x32_bf16 v[28:31], a[72:75], v[76:79], v[28:31]
    v_mfma_f32_16x16x32_bf16 v[32:35], a[76:79], v[76:79], v[32:35]
    v_mfma_f32_16x16x32_bf16 v[36:39], v[164:167], v[76:79], v[36:39]
    buffer_load_dwordx4 v[76:79], v0, s[8:11], s48 offen offset:3072
    s_waitcnt vmcnt(16)
    v_mfma_f32_16x16x32_bf16 v[16:19], a[80:83], v[80:83], v[16:19]
    v_mfma_f32_16x16x32_bf16 v[20:23], a[84:87], v[80:83], v[20:23]
    v_mfma_f32_16x16x32_bf16 v[24:27], v[168:171], v[80:83], v[24:27]
    s_add_u32 s48, s46, 36864
    buffer_load_dwordx4 v[80:83], v0, s[8:11], s48 offen offset:0
    s_waitcnt vmcnt(16)
    v_mfma_f32_16x16x32_bf16 v[28:31], a[80:83], v[84:87], v[28:31]
    v_mfma_f32_16x16x32_bf16 v[32:35], a[84:87], v[84:87], v[32:35]
    v_mfma_f32_16x16x32_bf16 v[36:39], v[168:171], v[84:87], v[36:39]
    buffer_load_dwordx4 v[84:87], v0, s[8:11], s48 offen offset:1024
    s_waitcnt vmcnt(16)
    v_mfma_f32_16x16x32_bf16 v[16:19], a[88:91], v[88:91], v[16:19]
    v_mfma_f32_16x16x32_bf16 v[20:23], a[92:95], v[88:91], v[20:23]
    v_mfma_f32_16x16x32_bf16 v[24:27], v[172:175], v[88:91], v[24:27]
    buffer_load_dwordx4 v[88:91], v0, s[8:11], s48 offen offset:2048
    s_waitcnt vmcnt(16)
    v_mfma_f32_16x16x32_bf16 v[28:31], a[88:91], v[92:95], v[28:31]
    v_mfma_f32_16x16x32_bf16 v[32:35], a[92:95], v[92:95], v[32:35]
    v_mfma_f32_16x16x32_bf16 v[36:39], v[172:175], v[92:95], v[36:39]
    buffer_load_dwordx4 v[92:95], v0, s[8:11], s48 offen offset:3072
    s_waitcnt vmcnt(16)
    v_mfma_f32_16x16x32_bf16 v[16:19], a[96:99], v[96:99], v[16:19]
    v_mfma_f32_16x16x32_bf16 v[20:23], a[100:103], v[96:99], v[20:23]
    v_mfma_f32_16x16x32_bf16 v[24:27], v[176:179], v[96:99], v[24:27]
    s_add_u32 s48, s46, 40960
    buffer_load_dwordx4 v[96:99], v0, s[8:11], s48 offen offset:0
    s_waitcnt vmcnt(16)
    v_mfma_f32_16x16x32_bf16 v[28:31], a[96:99], v[100:103], v[28:31]
    v_mfma_f32_16x16x32_bf16 v[32:35], a[100:103], v[100:103], v[32:35]
    v_mfma_f32_16x16x32_bf16 v[36:39], v[176:179], v[100:103], v[36:39]
    buffer_load_dwordx4 v[100:103], v0, s[8:11], s48 offen offset:1024
    s_waitcnt vmcnt(16)
    v_mfma_f32_16x16x32_bf16 v[16:19], a[104:107], v[104:107], v[16:19]
    v_mfma_f32_16x16x32_bf16 v[20:23], a[108:111], v[104:107], v[20:23]
    v_mfma_f32_16x16x32_bf16 v[24:27], v[180:183], v[104:107], v[24:27]
    buffer_load_dwordx4 v[104:107], v0, s[8:11], s48 offen offset:2048
    s_waitcnt vmcnt(16)
    v_mfma_f32_16x16x32_bf16 v[28:31], a[104:107], v[108:111], v[28:31]
    v_mfma_f32_16x16x32_bf16 v[32:35], a[108:111], v[108:111], v[32:35]
    v_mfma_f32_16x16x32_bf16 v[36:39], v[180:183], v[108:111], v[36:39]
    buffer_load_dwordx4 v[108:111], v0, s[8:11], s48 offen offset:3072
    s_waitcnt vmcnt(16)
    v_mfma_f32_16x16x32_bf16 v[16:19], a[112:115], v[112:115], v[16:19]
    v_mfma_f32_16x16x32_bf16 v[20:23], a[116:119], v[112:115], v[20:23]
    v_mfma_f32_16x16x32_bf16 v[24:27], v[184:187], v[112:115], v[24:27]
    s_add_u32 s48, s46, 45056
    buffer_load_dwordx4 v[112:115], v0, s[8:11], s48 offen offset:0
    s_waitcnt vmcnt(16)
    v_mfma_f32_16x16x32_bf16 v[28:31], a[112:115], v[116:119], v[28:31]
    v_mfma_f32_16x16x32_bf16 v[32:35], a[116:119], v[116:119], v[32:35]
    v_mfma_f32_16x16x32_bf16 v[36:39], v[184:187], v[116:119], v[36:39]
    buffer_load_dwordx4 v[116:119], v0, s[8:11], s48 offen offset:1024
    s_waitcnt vmcnt(16)
    v_mfma_f32_16x16x32_bf16 v[16:19], a[120:123], v[120:123], v[16:19]
    v_mfma_f32_16x16x32_bf16 v[20:23], a[124:127], v[120:123], v[20:23]
    v_mfma_f32_16x16x32_bf16 v[24:27], v[188:191], v[120:123], v[24:27]
    buffer_load_dwordx4 v[120:123], v0, s[8:11], s48 offen offset:2048
    s_waitcnt vmcnt(16)
    v_mfma_f32_16x16x32_bf16 v[28:31], a[120:123], v[124:127], v[28:31]
    v_mfma_f32_16x16x32_bf16 v[32:35], a[124:127], v[124:127], v[32:35]
    v_mfma_f32_16x16x32_bf16 v[36:39], v[188:191], v[124:127], v[36:39]
    buffer_load_dwordx4 v[124:127], v0, s[8:11], s48 offen offset:3072
    s_waitcnt vmcnt(16)
    v_mfma_f32_16x16x32_bf16 v[16:19], a[128:131], v[64:67], v[16:19]
    v_mfma_f32_16x16x32_bf16 v[20:23], a[132:135], v[64:67], v[20:23]
    v_mfma_f32_16x16x32_bf16 v[24:27], v[192:195], v[64:67], v[24:27]
    s_add_u32 s48, s46, 49152
    buffer_load_dwordx4 v[64:67], v0, s[8:11], s48 offen offset:0
    s_waitcnt vmcnt(15)
    v_mfma_f32_16x16x32_bf16 v[28:31], a[128:131], v[68:71], v[28:31]
    v_mfma_f32_16x16x32_bf16 v[32:35], a[132:135], v[68:71], v[32:35]
    v_mfma_f32_16x16x32_bf16 v[36:39], v[192:195], v[68:71], v[36:39]
    buffer_load_dwordx4 v[68:71], v0, s[8:11], s48 offen offset:1024
    s_waitcnt vmcnt(15)
    v_mfma_f32_16x16x32_bf16 v[16:19], a[136:139], v[72:75], v[16:19]
    v_mfma_f32_16x16x32_bf16 v[20:23], a[140:143], v[72:75], v[20:23]
    v_mfma_f32_16x16x32_bf16 v[24:27], v[196:199], v[72:75], v[24:27]
    buffer_load_dwordx4 v[72:75], v0, s[8:11], s48 offen offset:2048
    s_waitcnt vmcnt(15)
    v_mfma_f32_16x16x32_bf16 v[28:31], a[136:139], v[76:79], v[28:31]
    v_mfma_f32_16x16x32_bf16 v[32:35], a[140:143], v[76:79], v[32:35]
    v_mfma_f32_16x16x32_bf16 v[36:39], v[196:199], v[76:79], v[36:39]
    buffer_load_dwordx4 v[76:79], v0, s[8:11], s48 offen offset:3072
    s_waitcnt vmcnt(15)
    v_mfma_f32_16x16x32_bf16 v[16:19], a[144:147], v[80:83], v[16:19]
    v_mfma_f32_16x16x32_bf16 v[20:23], a[148:151], v[80:83], v[20:23]
    v_mfma_f32_16x16x32_bf16 v[24:27], v[200:203], v[80:83], v[24:27]
    s_add_u32 s48, s46, 53248
    buffer_load_dwordx4 v[80:83], v0, s[8:11], s48 offen offset:0
    s_waitcnt vmcnt(15)
    v_mfma_f32_16x16x32_bf16 v[28:31], a[144:147], v[84:87], v[28:31]
    v_mfma_f32_16x16x32_bf16 v[32:35], a[148:151], v[84:87], v[32:35]
    v_mfma_f32_16x16x32_bf16 v[36:39], v[200:203], v[84:87], v[36:39]
    buffer_load_dwordx4 v[84:87], v0, s[8:11], s48 offen offset:1024
    s_waitcnt vmcnt(15)
    v_mfma_f32_16x16x32_bf16 v[16:19], a[152:155], v[88:91], v[16:19]
    v_mfma_f32_16x16x32_bf16 v[20:23], a[156:159], v[88:91], v[20:23]
    v_mfma_f32_16x16x32_bf16 v[24:27], v[204:207], v[88:91], v[24:27]
    buffer_load_dwordx4 v[88:91], v0, s[8:11], s48 offen offset:2048
    s_waitcnt vmcnt(15)
    v_mfma_f32_16x16x32_bf16 v[28:31], a[152:155], v[92:95], v[28:31]
    v_mfma_f32_16x16x32_bf16 v[32:35], a[156:159], v[92:95], v[32:35]
    v_mfma_f32_16x16x32_bf16 v[36:39], v[204:207], v[92:95], v[36:39]
    buffer_load_dwordx4 v[92:95], v0, s[8:11], s48 offen offset:3072
    s_waitcnt vmcnt(15)
    v_mfma_f32_16x16x32_bf16 v[16:19], a[160:163], v[96:99], v[16:19]
    v_mfma_f32_16x16x32_bf16 v[20:23], a[164:167], v[96:99], v[20:23]
    v_mfma_f32_16x16x32_bf16 v[24:27], v[208:211], v[96:99], v[24:27]
    s_add_u32 s48, s46, 57344
    buffer_load_dwordx4 v[96:99], v0, s[8:11], s48 offen offset:0
    s_waitcnt vmcnt(15)
    v_mfma_f32_16x16x32_bf16 v[28:31], a[160:163], v[100:103], v[28:31]
    v_mfma_f32_16x16x32_bf16 v[32:35], a[164:167], v[100:103], v[32:35]
    v_mfma_f32_16x16x32_bf16 v[36:39], v[208:211], v[100:103], v[36:39]
    buffer_load_dwordx4 v[100:103], v0, s[8:11], s48 offen offset:1024
    s_waitcnt vmcnt(15)
    v_mfma_f32_16x16x32_bf16 v[16:19], a[168:171], v[104:107], v[16:19]
    v_mfma_f32_16x16x32_bf16 v[20:23], a[172:175], v[104:107], v[20:23]
    v_mfma_f32_16x16x32_bf16 v[24:27], v[212:215], v[104:107], v[24:27]
    buffer_load_dwordx4 v[104:107], v0, s[8:11], s48 offen offset:2048
    s_waitcnt vmcnt(15)
    v_mfma_f32_16x16x32_bf16 v[28:31], a[168:171], v[108:111], v[28:31]
    v_mfma_f32_16x16x32_bf16 v[32:35], a[172:175], v[108:111], v[32:35]
    v_mfma_f32_16x16x32_bf16 v[36:39], v[212:215], v[108:111], v[36:39]
    buffer_load_dwordx4 v[108:111], v0, s[8:11], s48 offen offset:3072
    s_waitcnt vmcnt(15)
    v_mfma_f32_16x16x32_bf16 v[16:19], a[176:179], v[112:115], v[16:19]
    v_mfma_f32_16x16x32_bf16 v[20:23], a[180:183], v[112:115], v[20:23]
    v_mfma_f32_16x16x32_bf16 v[24:27], v[216:219], v[112:115], v[24:27]
    s_barrier
    ds_read_b32 v6, v49
    v_xor_b32 v49, 4, v49
    s_add_u32 s48, s46, 61440
    buffer_load_dwordx4 v[112:115], v0, s[8:11], s48 offen offset:0
    s_waitcnt vmcnt(15)
    v_mfma_f32_16x16x32_bf16 v[28:31], a[176:179], v[116:119], v[28:31]
    v_mfma_f32_16x16x32_bf16 v[32:35], a[180:183], v[116:119], v[32:35]
    v_mfma_f32_16x16x32_bf16 v[36:39], v[216:219], v[116:119], v[36:39]
    buffer_load_dwordx4 v[116:119], v0, s[8:11], s48 offen offset:1024
    s_waitcnt vmcnt(15)
    v_mfma_f32_16x16x32_bf16 v[16:19], a[184:187], v[120:123], v[16:19]
    v_mfma_f32_16x16x32_bf16 v[20:23], a[188:191], v[120:123], v[20:23]
    v_mfma_f32_16x16x32_bf16 v[24:27], v[220:223], v[120:123], v[24:27]
    buffer_load_dwordx4 v[120:123], v0, s[8:11], s48 offen offset:2048
    s_waitcnt vmcnt(15)
    v_mfma_f32_16x16x32_bf16 v[28:31], a[184:187], v[124:127], v[28:31]
    v_mfma_f32_16x16x32_bf16 v[32:35], a[188:191], v[124:127], v[32:35]
    v_mfma_f32_16x16x32_bf16 v[36:39], v[220:223], v[124:127], v[36:39]
    s_waitcnt lgkmcnt(0)
    v_readfirstlane_b32 s62, v6
    s_cmp_lt_u32 s33, 33
    s_cselect_b32 s38, 1, 3
    s_cmp_eq_u32 s62, 2
    s_cselect_b32 s36, 1, 0
    s_cselect_b32 s37, s33, s32
    s_cselect_b32 s17, s38, 0
    s_add_u32 s33, s33, s17
    s_cmp_eq_u32 s62, 1
    s_cselect_b32 s17, 2, 0
    s_add_u32 s32, s32, s17
    s_lshl_b32 s56, s36, 6
    s_add_u32 s56, s56, s37
    buffer_load_dwordx4 v[124:127], v0, s[8:11], s48 offen offset:3072
    s_waitcnt vmcnt(15)
    v_mfma_f32_16x16x32_bf16 v[16:19], a[192:195], v[64:67], v[16:19]
    v_mfma_f32_16x16x32_bf16 v[20:23], a[196:199], v[64:67], v[20:23]
    v_mfma_f32_16x16x32_bf16 v[24:27], v[224:227], v[64:67], v[24:27]
    s_cmp_lt_u32 s37, 64
    s_cselect_b32 s62, s62, 0
    s_lshl_b32 s46, s56, 18
    s_add_u32 s46, s46, s58
    s_mul_i32 s41, s36, 4718592
    s_mul_i32 s17, s37, 36864
    s_add_u32 s41, s41, s17
    s_add_u32 s41, s41, 8650752
    s_cmp_lg_u32 s62, 0
    s_cselect_b32 s30, 268435456, 0
    buffer_load_dword v10, v51, s[28:31], s46 offen
    s_add_u32 s48, s46, 0
    buffer_load_dwordx4 v[64:67], v0, s[28:31], s48 offen offset:0
    s_waitcnt vmcnt(15)
    v_mfma_f32_16x16x32_bf16 v[28:31], a[192:195], v[68:71], v[28:31]
    v_mfma_f32_16x16x32_bf16 v[32:35], a[196:199], v[68:71], v[32:35]
    v_mfma_f32_16x16x32_bf16 v[36:39], v[224:227], v[68:71], v[36:39]
    buffer_load_dwordx4 v[68:71], v0, s[28:31], s48 offen offset:1024
    s_waitcnt vmcnt(15)
    v_mfma_f32_16x16x32_bf16 v[16:19], a[200:203], v[72:75], v[16:19]
    v_mfma_f32_16x16x32_bf16 v[20:23], a[204:207], v[72:75], v[20:23]
    v_mfma_f32_16x16x32_bf16 v[24:27], v[228:231], v[72:75], v[24:27]
    buffer_load_dwordx4 v[72:75], v0, s[28:31], s48 offen offset:2048
    s_waitcnt vmcnt(15)
    v_mfma_f32_16x16x32_bf16 v[28:31], a[200:203], v[76:79], v[28:31]
    v_mfma_f32_16x16x32_bf16 v[32:35], a[204:207], v[76:79], v[32:35]
    v_mfma_f32_16x16x32_bf16 v[36:39], v[228:231], v[76:79], v[36:39]
    buffer_load_dwordx4 v[76:79], v0, s[28:31], s48 offen offset:3072
    s_waitcnt vmcnt(15)
    v_mfma_f32_16x16x32_bf16 v[16:19], a[208:211], v[80:83], v[16:19]
    v_mfma_f32_16x16x32_bf16 v[20:23], a[212:215], v[80:83], v[20:23]
    v_mfma_f32_16x16x32_bf16 v[24:27], v[232:235], v[80:83], v[24:27]
    s_add_u32 s48, s46, 4096
    buffer_load_dwordx4 v[80:83], v0, s[28:31], s48 offen offset:0
    s_waitcnt vmcnt(15)
    v_mfma_f32_16x16x32_bf16 v[28:31], a[208:211], v[84:87], v[28:31]
    v_mfma_f32_16x16x32_bf16 v[32:35], a[212:215], v[84:87], v[32:35]
    v_mfma_f32_16x16x32_bf16 v[36:39], v[232:235], v[84:87], v[36:39]
    buffer_load_dwordx4 v[84:87], v0, s[28:31], s48 offen offset:1024
    s_waitcnt vmcnt(15)
    v_mfma_f32_16x16x32_bf16 v[16:19], a[216:219], v[88:91], v[16:19]
    v_mfma_f32_16x16x32_bf16 v[20:23], a[220:223], v[88:91], v[20:23]
    v_mfma_f32_16x16x32_bf16 v[24:27], v[236:239], v[88:91], v[24:27]
    buffer_load_dwordx4 v[88:91], v0, s[28:31], s48 offen offset:2048
    s_waitcnt vmcnt(15)
    v_mfma_f32_16x16x32_bf16 v[28:31], a[216:219], v[92:95], v[28:31]
    v_mfma_f32_16x16x32_bf16 v[32:35], a[220:223], v[92:95], v[32:35]
    v_mfma_f32_16x16x32_bf16 v[36:39], v[236:239], v[92:95], v[36:39]
    buffer_load_dwordx4 v[92:95], v0, s[28:31], s48 offen offset:3072
    s_waitcnt vmcnt(15)
    v_mfma_f32_16x16x32_bf16 v[16:19], a[224:227], v[96:99], v[16:19]
    v_mfma_f32_16x16x32_bf16 v[20:23], a[228:231], v[96:99], v[20:23]
    v_mfma_f32_16x16x32_bf16 v[24:27], v[240:243], v[96:99], v[24:27]
    s_add_u32 s48, s46, 8192
    buffer_load_dwordx4 v[96:99], v0, s[28:31], s48 offen offset:0
    s_waitcnt vmcnt(15)
    v_mfma_f32_16x16x32_bf16 v[28:31], a[224:227], v[100:103], v[28:31]
    v_mfma_f32_16x16x32_bf16 v[32:35], a[228:231], v[100:103], v[32:35]
    v_mfma_f32_16x16x32_bf16 v[36:39], v[240:243], v[100:103], v[36:39]
    buffer_load_dwordx4 v[100:103], v0, s[28:31], s48 offen offset:1024
    s_waitcnt vmcnt(15)
    v_mfma_f32_16x16x32_bf16 v[16:19], a[232:235], v[104:107], v[16:19]
    v_mfma_f32_16x16x32_bf16 v[20:23], a[236:239], v[104:107], v[20:23]
    v_mfma_f32_16x16x32_bf16 v[24:27], v[244:247], v[104:107], v[24:27]
    buffer_load_dwordx4 v[104:107], v0, s[28:31], s48 offen offset:2048
    s_waitcnt vmcnt(15)
    v_mfma_f32_16x16x32_bf16 v[28:31], a[232:235], v[108:111], v[28:31]
    v_mfma_f32_16x16x32_bf16 v[32:35], a[236:239], v[108:111], v[32:35]
    v_mfma_f32_16x16x32_bf16 v[36:39], v[244:247], v[108:111], v[36:39]
    buffer_load_dwordx4 v[108:111], v0, s[28:31], s48 offen offset:3072
    s_waitcnt vmcnt(15)
    v_mfma_f32_16x16x32_bf16 v[16:19], a[240:243], v[112:115], v[16:19]
    v_mfma_f32_16x16x32_bf16 v[20:23], a[244:247], v[112:115], v[20:23]
    v_mfma_f32_16x16x32_bf16 v[24:27], v[248:251], v[112:115], v[24:27]
    s_add_u32 s48, s46, 12288
    buffer_load_dwordx4 v[112:115], v0, s[28:31], s48 offen offset:0
    s_waitcnt vmcnt(15)
    v_mfma_f32_16x16x32_bf16 v[28:31], a[240:243], v[116:119], v[28:31]
    v_mfma_f32_16x16x32_bf16 v[32:35], a[244:247], v[116:119], v[32:35]
    v_mfma_f32_16x16x32_bf16 v[36:39], v[248:251], v[116:119], v[36:39]
    buffer_load_dwordx4 v[116:119], v0, s[28:31], s48 offen offset:1024
    s_waitcnt vmcnt(15)
    v_mfma_f32_16x16x32_bf16 v[16:19], a[248:251], v[120:123], v[16:19]
    v_mfma_f32_16x16x32_bf16 v[20:23], a[252:255], v[120:123], v[20:23]
    v_mfma_f32_16x16x32_bf16 v[24:27], v[252:255], v[120:123], v[24:27]
    buffer_load_dwordx4 v[120:123], v0, s[28:31], s48 offen offset:2048
    s_waitcnt vmcnt(15)
    v_mfma_f32_16x16x32_bf16 v[28:31], a[248:251], v[124:127], v[28:31]
    v_mfma_f32_16x16x32_bf16 v[32:35], a[252:255], v[124:127], v[32:35]
    v_mfma_f32_16x16x32_bf16 v[36:39], v[252:255], v[124:127], v[36:39]
    s_nop 5
    ds_write_b128 v48, v[16:19] offset:0
    ds_write_b128 v48, v[20:23] offset:1024
    ds_write_b128 v48, v[24:27] offset:2048
    ds_write_b128 v48, v[28:31] offset:3072
    ds_write_b128 v48, v[32:35] offset:4096
    ds_write_b128 v48, v[36:39] offset:5120
    s_waitcnt lgkmcnt(0)
    s_barrier
    ds_read_b128 v[24:27], v50 offset:2048
    ds_read_b128 v[28:31], v50 offset:8192
    ds_read_b128 v[32:35], v50 offset:14336
    ds_read_b128 v[36:39], v50 offset:20480
    v_xor_b32 v48, 0x8000, v48
    v_xor_b32 v50, 0x8000, v50
    v_lshlrev_b32 v16, 16, v40
    v_and_b32 v17, 0xffff0000, v40
    v_lshlrev_b32 v18, 16, v41
    v_and_b32 v19, 0xffff0000, v41
    buffer_load_dwordx2 v[40:41], v12, s[28:31], s41 offen
    s_waitcnt lgkmcnt(3)
    v_add_f32 v16, v16, v24
    v_add_f32 v17, v17, v25
    v_add_f32 v18, v18, v26
    v_add_f32 v19, v19, v27
    s_waitcnt lgkmcnt(2)
    v_add_f32 v16, v16, v28
    v_add_f32 v17, v17, v29
    v_add_f32 v18, v18, v30
    v_add_f32 v19, v19, v31
    s_waitcnt lgkmcnt(1)
    v_add_f32 v16, v16, v32
    v_add_f32 v17, v17, v33
    v_add_f32 v18, v18, v34
    v_add_f32 v19, v19, v35
    s_waitcnt lgkmcnt(0)
    v_add_f32 v16, v16, v36
    v_add_f32 v17, v17, v37
    v_add_f32 v18, v18, v38
    v_add_f32 v19, v19, v39
    v_cvt_pk_bf16_f32 v52, v16, v17
    v_cvt_pk_bf16_f32 v53, v18, v19
    s_cmp_eq_u32 s34, 0
    s_cbranch_scc1 LtwZ_l0
    s_mul_i32 s17, s35, 36864
    buffer_store_dwordx2 v[52:53], v13, s[24:27], s17 offen
    s_cmp_lg_u32 s62, 0
    s_cbranch_scc1 LtwZ_item
LtwZ_chk:
    s_min_u32 s17, s32, s33
    s_cmp_lt_u32 s17, 64
    s_cbranch_scc1 LtwZ_idle
    s_branch L_role_tw_exit
LtwZ_l0:
    s_add_u32 s47, s47, 2359296
    buffer_store_dwordx2 v[52:53], v12, s[8:11], s47 offen sc1
    v_add_f32 v44, v16, v17
    v_mul_f32 v45, v16, v16
    v_fmac_f32 v45, v17, v17
    v_add_f32 v44, v44, v18
    v_fmac_f32 v45, v18, v18
    v_add_f32 v44, v44, v19
    v_fmac_f32 v45, v19, v19
    v_mov_b32 v46, v44
    v_mov_b32 v47, v45
    s_nop 0
    v_permlane32_swap_b32 v44, v46
    v_permlane32_swap_b32 v45, v47
    v_add_f32 v44, v44, v46
    v_add_f32 v45, v45, v47
    v_mov_b32 v46, v44
    v_mov_b32 v47, v45
    s_nop 0
    v_permlane16_swap_b32 v44, v46
    v_permlane16_swap_b32 v45, v47
    v_add_f32 v44, v44, v46
    v_add_f32 v45, v45, v47
    s_mul_i32 s17, s35, 6144
    s_add_u32 s17, s17, 16515072
    s_mov_b64 exec, 0xffff
    buffer_store_dwordx2 v[44:45], v14, s[8:11], s17 offen sc1
    s_mov_b64 exec, -1
    s_mul_i32 s43, s35, 22528
    s_add_u32 s43, s43, s49
    s_cmp_lg_u32 s62, 0
    s_cbranch_scc1 LtwZ_item
    s_waitcnt vmcnt(0)
    s_mov_b64 exec, 1
    buffer_store_dword v3, v4, s[8:11], s43 offen sc1
    s_mov_b64 exec, -1
    s_mov_b32 s43, 0
    s_branch LtwZ_chk
L_role_tw_abort:
    s_waitcnt lgkmcnt(0)
    s_mov_b64 exec, -1
    v_mov_b32 v0, 60
    s_lshl_b32 s5, s3, 8
    s_or_b32 s5, s5, s4
    s_or_b32 s5, s5, 0x10000
    v_mov_b32 v1, s5
    global_store_dword v0, v1, s[12:13]
    s_endpgm
L_role_tw_exit:
    s_endpgm
.p2align 6
L_role_r:
    s_mov_b32 s32, s3
    s_mov_b32 s15, s4
    v_and_b32 v10, 63, v0
    v_and_b32 v60, 15, v10
    v_lshrrev_b32 v61, 4, v10
    v_lshlrev_b32 v0, 4, v10
    v_lshlrev_b32 v8, 2, v10
    s_mul_i32 s17, s14, 26624
    s_add_u32 s17, s17, 57344
    v_add_u32 v9, s17, v0
    s_mov_b32 s54, 0xfffffffe
    s_mov_b32 s46, 0x3e0293ee
    s_mov_b32 s47, 0x3e0293ee
    s_mov_b32 s50, 0x00ff00ff
    s_mov_b32 s51, 0x00ff00ff
    s_mov_b32 s52, -1
    s_mov_b32 s53, 0
    s_mov_b32 s68, 0x3f803f80
    s_mov_b32 s69, 0x3f803f80
    s_mov_b32 s39, 0
    v_lshrrev_b32 v63, 2, v60
    v_and_b32 v64, 1, v60
    v_lshl_add_u32 v62, v63, 1, v64
    v_bfe_u32 v65, v60, 1, 1
    v_mov_b32 v1, 0x4444
    v_mov_b32 v63, 0xeeee
    v_cmp_eq_u32 vcc, 0, v65
    s_nop 1
    v_cndmask_b32 v1, v63, v1, vcc
    v_mul_u32_u24 v63, 576, v61
    v_lshl_add_u32 v2, v60, 2, v63
    s_lshl_b32 s17, s14, 6
    v_add_u32 v2, s17, v2
    v_mul_u32_u24 v63, 288, v62
    v_lshl_add_u32 v3, v61, 4, v63
    v_lshl_add_u32 v4, v61, 5, v63
    v_lshl_add_u32 v4, v65, 4, v4
    s_cmp_eq_u32 s32, 0
    s_cbranch_scc1 Lr_noord
    s_cmp_lg_u32 s14, 0
    s_cbranch_scc1 Lr_ord_d
    v_mov_b32 v63, 48
    s_mov_b32 s16, 0
Lr_ord:
    global_load_dword v64, v63, s[12:13] sc1
    s_add_u32 s16, s16, 1
    s_cmp_gt_u32 s16, 100000
    s_cbranch_scc1 Lr_abort
    s_waitcnt vmcnt(0)
    v_cmp_gt_u32 vcc, 16, v64
    s_nop 0
    s_cbranch_vccz Lr_ord_d
    s_sleep 32
    s_branch Lr_ord
Lr_ord_d:
    s_barrier
Lr_noord:
    s_load_dwordx2 s[20:21], s[0:1], 40
    s_mov_b32 s22, 4718592
    s_mov_b32 s23, 0x00020000
    s_waitcnt lgkmcnt(0)
    s_and_b32 s21, s21, 0xffff
    s_load_dwordx2 s[24:25], s[0:1], 48
    s_mov_b32 s26, 4718592
    s_mov_b32 s27, 0x00020000
    s_waitcnt lgkmcnt(0)
    s_and_b32 s25, s25, 0xffff
    s_load_dwordx2 s[28:29], s[0:1], 56
    s_mov_b32 s30, 4718592
    s_mov_b32 s31, 0x00020000
    s_waitcnt lgkmcnt(0)
    s_and_b32 s29, s29, 0xffff
    s_load_dwordx2 s[80:81], s[0:1], 64
    s_mov_b32 s82, 4718592
    s_mov_b32 s83, 0x00020000
    s_waitcnt lgkmcnt(0)
    s_and_b32 s81, s81, 0xffff
    v_lshlrev_b32 v71, 1, v61
    v_xor_b32 v71, v71, v60
    v_lshlrev_b32 v71, 4, v71
    v_lshl_add_u32 v62, v61, 13, v71
    v_xor_b32 v63, 128, v62
    v_lshrrev_b32 v64, 1, v61
    v_lshlrev_b32 v64, 3, v64
    v_and_b32 v65, 1, v61
    v_lshl_add_u32 v64, v65, 2, v64
    v_lshl_add_u32 v64, v64, 13, v71
    v_xor_b32 v65, 128, v64
    s_mul_i32 s57, s14, 1179648
    s_lshl_b32 s17, s15, 8
    s_add_u32 s57, s57, s17
    s_lshl_b32 s58, s14, 12
    v_lshrrev_b32 v71, 2, v60
    v_lshl_add_u32 v66, v61, 3, v71
    v_lshlrev_b32 v66, 8, v66
    v_bfe_u32 v67, v60, 1, 1
    s_lshl_b32 s17, s14, 2
    v_add_u32 v67, s17, v67
    v_lshlrev_b32 v71, 1, v71
    v_xor_b32 v67, v67, v71
    v_and_b32 v71, 1, v61
    v_lshlrev_b32 v71, 3, v71
    v_xor_b32 v67, v67, v71
    v_and_b32 v71, 1, v60
    v_lshl_add_u32 v66, v71, 3, v66
    v_xor_b32 v71, 2, v67
    v_lshl_add_u32 v67, v71, 4, v66
    v_xor_b32 v71, 2, v71
    v_lshl_add_u32 v66, v71, 4, v66
    v_lshrrev_b32 v71, 2, v60
    v_lshl_add_u32 v70, v61, 2, v71
    v_mul_u32_u24 v70, 1152, v70
    v_and_b32 v71, 3, v60
    v_lshl_add_u32 v70, v71, 3, v70
    s_mul_i32 s17, s14, 288
    v_add_u32 v70, s17, v70
    v_add_u32 v71, 0, v10
    v_mul_u32_u24 v59, 911, v71
    v_lshrrev_b32 v59, 16, v59
    v_mul_u32_u24 v60, 72, v59
    v_sub_u32 v71, v71, v60
    v_and_b32 v60, 1, v59
    v_lshlrev_b32 v60, 4, v60
    v_lshrrev_b32 v59, 1, v59
    v_lshl_add_u32 v60, v59, 2, v60
    v_mul_u32_u24 v60, 1152, v60
    v_lshl_add_u32 v50, v71, 4, v60
    v_add_u32 v71, 64, v10
    v_mul_u32_u24 v59, 911, v71
    v_lshrrev_b32 v59, 16, v59
    v_mul_u32_u24 v60, 72, v59
    v_sub_u32 v71, v71, v60
    v_and_b32 v60, 1, v59
    v_lshlrev_b32 v60, 4, v60
    v_lshrrev_b32 v59, 1, v59
    v_lshl_add_u32 v60, v59, 2, v60
    v_mul_u32_u24 v60, 1152, v60
    v_lshl_add_u32 v51, v71, 4, v60
    v_add_u32 v71, 128, v10
    v_mul_u32_u24 v59, 911, v71
    v_lshrrev_b32 v59, 16, v59
    v_mul_u32_u24 v60, 72, v59
    v_sub_u32 v71, v71, v60
    v_and_b32 v60, 1, v59
    v_lshlrev_b32 v60, 4, v60
    v_lshrrev_b32 v59, 1, v59
    v_lshl_add_u32 v60, v59, 2, v60
    v_mul_u32_u24 v60, 1152, v60
    v_lshl_add_u32 v52, v71, 4, v60
    v_add_u32 v71, 192, v10
    v_mul_u32_u24 v59, 911, v71
    v_lshrrev_b32 v59, 16, v59
    v_mul_u32_u24 v60, 72, v59
    v_sub_u32 v71, v71, v60
    v_and_b32 v60, 1, v59
    v_lshlrev_b32 v60, 4, v60
    v_lshrrev_b32 v59, 1, v59
    v_lshl_add_u32 v60, v59, 2, v60
    v_mul_u32_u24 v60, 1152, v60
    v_lshl_add_u32 v53, v71, 4, v60
    v_add_u32 v71, 256, v10
    v_mul_u32_u24 v59, 911, v71
    v_lshrrev_b32 v59, 16, v59
    v_mul_u32_u24 v60, 72, v59
    v_sub_u32 v71, v71, v60
    v_and_b32 v60, 1, v59
    v_lshlrev_b32 v60, 4, v60
    v_lshrrev_b32 v59, 1, v59
    v_lshl_add_u32 v60, v59, 2, v60
    v_mul_u32_u24 v60, 1152, v60
    v_lshl_add_u32 v54, v71, 4, v60
    s_lshr_b32 s17, s14, 1
    s_lshl_b32 s17, s17, 3
    s_and_b32 s18, s14, 1
    s_lshl_b32 s18, s18, 1
    s_add_u32 s17, s17, s18
    s_lshl_b32 s18, s15, 7
    s_add_u32 s17, s17, s18
    s_mul_i32 s59, s17, 1152
    s_mul_i32 s60, s14, 4608
    s_add_u32 m0, s58, 49152
    s_add_u32 s17, s57, 0
    buffer_load_dwordx4 v62, s[20:23], s17 offen lds
    s_add_u32 m0, s58, 50176
    s_add_u32 s17, s57, 32768
    buffer_load_dwordx4 v62, s[20:23], s17 offen lds
    s_add_u32 m0, s58, 51200
    s_add_u32 s17, s57, 65536
    buffer_load_dwordx4 v63, s[20:23], s17 offen lds
    s_add_u32 m0, s58, 52224
    s_add_u32 s17, s57, 98304
    buffer_load_dwordx4 v63, s[20:23], s17 offen lds
    s_add_u32 m0, s58, 65536
    s_add_u32 s17, s57, 0
    buffer_load_dwordx4 v62, s[24:27], s17 offen lds
    s_add_u32 m0, s58, 66560
    s_add_u32 s17, s57, 32768
    buffer_load_dwordx4 v62, s[24:27], s17 offen lds
    s_add_u32 m0, s58, 67584
    s_add_u32 s17, s57, 65536
    buffer_load_dwordx4 v63, s[24:27], s17 offen lds
    s_add_u32 m0, s58, 68608
    s_add_u32 s17, s57, 98304
    buffer_load_dwordx4 v63, s[24:27], s17 offen lds
    s_add_u32 m0, s58, 81920
    s_add_u32 s17, s57, 0
    buffer_load_dwordx4 v62, s[28:31], s17 offen lds
    s_add_u32 m0, s58, 82944
    s_add_u32 s17, s57, 32768
    buffer_load_dwordx4 v62, s[28:31], s17 offen lds
    s_add_u32 m0, s58, 83968
    s_add_u32 s17, s57, 65536
    buffer_load_dwordx4 v63, s[28:31], s17 offen lds
    s_add_u32 m0, s58, 84992
    s_add_u32 s17, s57, 98304
    buffer_load_dwordx4 v63, s[28:31], s17 offen lds
    s_add_u32 m0, s58, 98304
    s_add_u32 s17, s57, 131072
    buffer_load_dwordx4 v62, s[20:23], s17 offen lds
    s_add_u32 m0, s58, 99328
    s_add_u32 s17, s57, 163840
    buffer_load_dwordx4 v62, s[20:23], s17 offen lds
    s_add_u32 m0, s58, 100352
    s_add_u32 s17, s57, 196608
    buffer_load_dwordx4 v63, s[20:23], s17 offen lds
    s_add_u32 m0, s58, 101376
    s_add_u32 s17, s57, 229376
    buffer_load_dwordx4 v63, s[20:23], s17 offen lds
    s_add_u32 m0, s58, 114688
    s_add_u32 s17, s57, 131072
    buffer_load_dwordx4 v62, s[24:27], s17 offen lds
    s_add_u32 m0, s58, 115712
    s_add_u32 s17, s57, 163840
    buffer_load_dwordx4 v62, s[24:27], s17 offen lds
    s_add_u32 m0, s58, 116736
    s_add_u32 s17, s57, 196608
    buffer_load_dwordx4 v63, s[24:27], s17 offen lds
    s_add_u32 m0, s58, 117760
    s_add_u32 s17, s57, 229376
    buffer_load_dwordx4 v63, s[24:27], s17 offen lds
    s_add_u32 m0, s58, 131072
    s_add_u32 s17, s57, 131072
    buffer_load_dwordx4 v62, s[28:31], s17 offen lds
    s_add_u32 m0, s58, 132096
    s_add_u32 s17, s57, 163840
    buffer_load_dwordx4 v62, s[28:31], s17 offen lds
    s_add_u32 m0, s58, 133120
    s_add_u32 s17, s57, 196608
    buffer_load_dwordx4 v63, s[28:31], s17 offen lds
    s_add_u32 m0, s58, 134144
    s_add_u32 s17, s57, 229376
    buffer_load_dwordx4 v63, s[28:31], s17 offen lds
    s_add_u32 m0, s58, 147456
    s_add_u32 s17, s57, 262144
    buffer_load_dwordx4 v62, s[20:23], s17 offen lds
    s_add_u32 m0, s58, 148480
    s_add_u32 s17, s57, 294912
    buffer_load_dwordx4 v62, s[20:23], s17 offen lds
    s_add_u32 m0, s58, 149504
    s_add_u32 s17, s57, 327680
    buffer_load_dwordx4 v63, s[20:23], s17 offen lds
    s_add_u32 m0, s58, 150528
    s_add_u32 s17, s57, 360448
    buffer_load_dwordx4 v63, s[20:23], s17 offen lds
    s_add_u32 m0, s58, 0
    s_add_u32 s17, s57, 262144
    buffer_load_dwordx4 v62, s[24:27], s17 offen lds
    s_add_u32 m0, s58, 1024
    s_add_u32 s17, s57, 294912
    buffer_load_dwordx4 v62, s[24:27], s17 offen lds
    s_add_u32 m0, s58, 2048
    s_add_u32 s17, s57, 327680
    buffer_load_dwordx4 v63, s[24:27], s17 offen lds
    s_add_u32 m0, s58, 3072
    s_add_u32 s17, s57, 360448
    buffer_load_dwordx4 v63, s[24:27], s17 offen lds
    s_add_u32 m0, s58, 16384
    s_add_u32 s17, s57, 262144
    buffer_load_dwordx4 v62, s[28:31], s17 offen lds
    s_add_u32 m0, s58, 17408
    s_add_u32 s17, s57, 294912
    buffer_load_dwordx4 v62, s[28:31], s17 offen lds
    s_add_u32 m0, s58, 18432
    s_add_u32 s17, s57, 327680
    buffer_load_dwordx4 v63, s[28:31], s17 offen lds
    s_add_u32 m0, s58, 19456
    s_add_u32 s17, s57, 360448
    buffer_load_dwordx4 v63, s[28:31], s17 offen lds
    v_and_b32 v12, 15, v10
    v_lshrrev_b32 v13, 4, v10
    s_lshr_b32 s84, s15, 3
    s_bfe_u32 s85, s15, 0x20001
    s_and_b32 s86, s15, 1
    s_cmp_lt_u32 s14, 2
    s_cbranch_scc1 Lr_jab
    s_lshr_b32 s84, s15, 1
    s_and_b32 s84, s84, 3
Lr_jab:
    s_cmp_lt_u32 s15, 8
    s_cselect_b32 s62, 1, 0
    v_bfe_u32 v20, v12, 2, 1
    v_lshl_add_u32 v17, v20, 2, v13
    v_mul_u32_u24 v17, 12288, v17
    v_lshrrev_b32 v21, 3, v12
    v_lshlrev_b32 v21, 2, v21
    v_and_b32 v20, 3, v12
    v_add_u32 v21, v21, v20
    v_lshl_add_u32 v6, v21, 4, v17
    s_mul_i32 s17, s84, 2304
    s_lshl_b32 s18, s14, 10
    s_add_u32 s17, s17, s18
    s_lshl_b32 s18, s86, 7
    s_add_u32 s17, s17, s18
    s_lshl_b32 s18, s85, 8
    s_cmp_lt_u32 s14, 2
    s_cselect_b32 s18, s18, 0
    s_add_u32 s17, s17, s18
    v_add_u32 v6, s17, v6
    v_bfe_u32 v24, v12, 1, 2
    v_and_b32 v25, 1, v12
    v_lshrrev_b32 v26, 1, v13
    v_and_b32 v27, 1, v13
    s_cmp_lt_u32 s14, 2
    s_cbranch_scc0 Lr_jc
    s_lshl_b32 s17, s14, 2
    v_add_u32 v18, s17, v24
    v_lshlrev_b32 v7, 10, v18
    v_lshl_add_u32 v19, v27, 1, v25
    s_lshl_b32 s17, s84, 4
    s_lshl_b32 s18, s85, 2
    s_add_u32 s17, s17, s18
    v_add_u32 v19, s17, v19
    v_lshl_add_u32 v7, v19, 4, v7
    s_lshl_b32 s17, s86, 1
    v_add_u32 v19, s17, v26
    v_lshl_add_u32 v7, v19, 2, v7
    s_lshl_b32 s17, s85, 1
    v_add_u32 v19, s17, v25
    v_mul_u32_u24 v19, 576, v19
    v_lshl_add_u32 v19, v18, 4, v19
    v_lshl_add_u32 v19, v13, 1, v19
    s_mul_i32 s17, s84, 144
    s_lshl_b32 s18, s86, 3
    s_add_u32 s17, s17, s18
    v_add_u32 v19, s17, v19
    v_lshlrev_b32 v14, 1, v19
    v_add_u32 v15, 2, v14
    s_branch Lr_jd
Lr_jc:
    s_lshl_b32 s17, s86, 1
    v_add_u32 v18, s17, v26
    v_lshlrev_b32 v19, 2, v18
    v_lshl_add_u32 v19, v27, 1, v19
    v_add_u32 v19, v19, v25
    s_lshl_b32 s17, s84, 4
    v_add_u32 v19, s17, v19
    v_lshlrev_b32 v7, 4, v19
    v_lshl_add_u32 v7, v24, 2, v7
    v_add_u32 v7, 8192, v7
    v_lshl_add_u32 v19, v18, 1, v25
    v_mul_u32_u24 v19, 576, v19
    v_lshl_add_u32 v19, v27, 3, v19
    v_add_u32 v19, v19, v24
    s_mul_i32 s17, s84, 144
    s_add_u32 s17, s17, 128
    v_add_u32 v19, s17, v19
    v_lshlrev_b32 v14, 1, v19
    v_add_u32 v15, 8, v14
Lr_jd:
    s_mul_i32 s48, s32, 1048576
    s_add_u32 s48, s48, 4194304
    s_lshl_b32 s18, s14, 11
    s_lshl_b32 s19, s14, 8
    s_add_u32 s19, s19, 8192
    s_mul_i32 s17, s15, 12288
    s_add_u32 s17, s17, s48
    s_mul_i32 s38, s14, 2304
    s_add_u32 s38, s38, s17
    s_add_u32 s37, s48, 983040
    s_xor_b32 s36, s37, 16384
    s_add_u32 s34, s37, s18
    s_add_u32 s35, s37, s19
    s_mul_i32 s17, s32, 50331648
    s_lshl_b32 s19, s15, 13
    s_add_u32 s17, s17, s19
    s_add_u32 s40, s17, 61079552
    s_add_u32 s17, s17, s18
    s_add_u32 s41, s17, 60817408
    s_add_u32 s42, s17, 77594624
    s_mul_i32 s17, s32, 1048576
    s_lshl_b32 s19, s15, 12
    s_add_u32 s17, s17, s19
    s_lshl_b32 s19, s14, 9
    s_add_u32 s17, s17, s19
    s_add_u32 s45, s17, 27262976
    s_mov_b32 s43, s45
    s_mov_b32 s66, 0
    s_mul_i32 s17, s32, 1441792
    s_lshr_b32 s19, s15, 2
    s_lshl_b32 s19, s19, 7
    s_add_u32 s17, s17, s19
    s_and_b32 s19, s15, 3
    s_lshl_b32 s19, s19, 2
    s_add_u32 s17, s17, s19
    s_add_u32 s67, s17, 26752
    s_cmp_eq_u32 s32, 0
    s_cselect_b32 s67, 1464320, s67
    s_mov_b32 s78, 0xff
    s_mov_b32 s79, 0
    s_mul_i32 s17, s32, 1441792
    s_lshl_b32 s19, s15, 9
    s_add_u32 s17, s17, s19
    s_add_u32 s44, s17, 185600
    s_mov_b32 s33, 0
    s_load_dwordx2 s[88:89], s[0:1], 32
    s_mov_b32 s90, 9216
    s_mov_b32 s91, 0x00020000
    s_waitcnt lgkmcnt(0)
    s_and_b32 s89, s89, 0xffff
    s_cmp_eq_u32 s14, 3
    s_cbranch_scc1 Lr_mem0_done
    s_cmp_lt_u32 s14, 2
    s_cselect_b32 s17, 1, s62
    s_cmp_eq_u32 s17, 0
    s_cbranch_scc1 Lr_mem0_done
    s_mov_b64 exec, s[50:51]
    buffer_load_ushort v20, v14, s[88:91], 0 offen
    buffer_load_ushort v21, v15, s[88:91], 0 offen
    s_waitcnt vmcnt(0)
    v_lshl_or_b32 v20, v21, 16, v20
    v_min_u32 v20, s54, v20
    buffer_store_dword v20, v7, s[8:11], s37 offen sc1
    v_mov_b32 v20, -1
    buffer_store_dword v20, v7, s[8:11], s36 offen sc1
    s_mov_b64 exec, -1
Lr_mem0_done:
    v_mov_b32 v20, 1
    v_mov_b32 v21, 1
    v_mov_b32 v22, 1
    v_mov_b32 v23, 1
    s_xor_b32 s17, s38, 524288
    buffer_store_dwordx4 v[20:23], v0, s[8:11], s38 offen offset:0 sc1
    buffer_store_dwordx4 v[20:23], v0, s[8:11], s38 offen offset:1024 sc1
    buffer_store_dword v20, v8, s[8:11], s38 offen offset:2048 sc1
    buffer_store_dwordx4 v[20:23], v0, s[8:11], s17 offen offset:0 sc1
    buffer_store_dwordx4 v[20:23], v0, s[8:11], s17 offen offset:1024 sc1
    buffer_store_dword v20, v8, s[8:11], s17 offen offset:2048 sc1
    v_lshrrev_b32 v17, 1, v0
    s_mov_b32 s17, s45
    buffer_store_dwordx2 v[20:21], v17, s[8:11], s17 offen offset:2048 sc1
    s_mov_b64 exec, s[52:53]
    buffer_store_dwordx4 v[20:23], v0, s[8:11], s17 offen sc1
    s_mov_b64 exec, -1
    s_add_u32 s17, s17, 131072
    buffer_store_dwordx2 v[20:21], v17, s[8:11], s17 offen offset:2048 sc1
    s_mov_b64 exec, s[52:53]
    buffer_store_dwordx4 v[20:23], v0, s[8:11], s17 offen sc1
    s_mov_b64 exec, -1
    s_add_u32 s17, s17, 131072
    buffer_store_dwordx2 v[20:21], v17, s[8:11], s17 offen offset:2048 sc1
    s_mov_b64 exec, s[52:53]
    buffer_store_dwordx4 v[20:23], v0, s[8:11], s17 offen sc1
    s_mov_b64 exec, -1
    s_add_u32 s17, s17, 131072
    buffer_store_dwordx2 v[20:21], v17, s[8:11], s17 offen offset:2048 sc1
    s_mov_b64 exec, s[52:53]
    buffer_store_dwordx4 v[20:23], v0, s[8:11], s17 offen sc1
    s_mov_b64 exec, -1
    s_add_u32 s17, s17, 131072
    buffer_store_dwordx2 v[20:21], v17, s[8:11], s17 offen offset:2048 sc1
    s_mov_b64 exec, s[52:53]
    buffer_store_dwordx4 v[20:23], v0, s[8:11], s17 offen sc1
    s_mov_b64 exec, -1
    s_add_u32 s17, s17, 131072
    buffer_store_dwordx2 v[20:21], v17, s[8:11], s17 offen offset:2048 sc1
    s_mov_b64 exec, s[52:53]
    buffer_store_dwordx4 v[20:23], v0, s[8:11], s17 offen sc1
    s_mov_b64 exec, -1
    s_add_u32 s17, s17, 131072
    buffer_store_dwordx2 v[20:21], v17, s[8:11], s17 offen offset:2048 sc1
    s_mov_b64 exec, s[52:53]
    buffer_store_dwordx4 v[20:23], v0, s[8:11], s17 offen sc1
    s_mov_b64 exec, -1
    s_add_u32 s17, s17, 131072
    buffer_store_dwordx2 v[20:21], v17, s[8:11], s17 offen offset:2048 sc1
    s_mov_b64 exec, s[52:53]
    buffer_store_dwordx4 v[20:23], v0, s[8:11], s17 offen sc1
    s_mov_b64 exec, -1
    s_add_u32 s17, s17, 131072
    s_cmp_lg_u32 s14, 3
    s_cbranch_scc1 Lr_not_w3
    v_and_b32 v7, 12, v8
    v_and_b32 v17, 4, v10
    v_lshl_add_u32 v7, v17, 5, v7
    s_add_u32 s17, s44, 22656
    s_min_u32 s18, s17, s67
    s_sub_u32 s17, s17, s18
    v_add_u32 v7, s17, v7
    s_sub_u32 s17, s67, s18
    v_mov_b32 v17, s17
    v_cmp_gt_u32 vcc, 8, v10
    s_nop 1
    v_cndmask_b32 v7, v17, v7, vcc
    s_mov_b32 s67, s18
Lr_not_w3:
    v_lshlrev_b32 v5, 3, v0
    s_add_u32 s56, s40, 16777216
    s_waitcnt vmcnt(32)
    s_barrier
    s_cmp_lg_u32 s14, 0
    s_cbranch_scc1 Lr_noadd
    s_lshl_b32 s17, s32, 2
    s_add_u32 s17, s17, 192
    v_mov_b32 v48, s17
    v_mov_b32 v49, 1
    s_mov_b64 exec, 1
    global_atomic_add v48, v49, s[12:13]
    s_mov_b64 exec, -1
Lr_noadd:
    s_add_u32 m0, s58, 32768
    s_add_u32 s17, s57, 393216
    buffer_load_dwordx4 v62, s[20:23], s17 offen lds
    s_add_u32 m0, s58, 33792
    s_add_u32 s17, s57, 425984
    buffer_load_dwordx4 v62, s[20:23], s17 offen lds
    s_add_u32 m0, s58, 34816
    s_add_u32 s17, s57, 458752
    buffer_load_dwordx4 v63, s[20:23], s17 offen lds
    s_add_u32 m0, s58, 35840
    s_add_u32 s17, s57, 491520
    buffer_load_dwordx4 v63, s[20:23], s17 offen lds
    v_add_u32 v68, 49152, v66
    v_add_u32 v69, 49152, v67
    ds_read_b64_tr_b16 v[72:73], v68 offset:0
    ds_read_b64_tr_b16 v[74:75], v68 offset:1024
    ds_read_b64_tr_b16 v[76:77], v68 offset:8192
    ds_read_b64_tr_b16 v[78:79], v68 offset:9216
    ds_read_b64_tr_b16 v[80:81], v69 offset:0
    ds_read_b64_tr_b16 v[82:83], v69 offset:1024
    ds_read_b64_tr_b16 v[84:85], v69 offset:8192
    ds_read_b64_tr_b16 v[86:87], v69 offset:9216
    s_waitcnt lgkmcnt(0)
    s_waitcnt vmcnt(32)
    s_barrier
    s_add_u32 m0, s58, 49152
    s_add_u32 s17, s57, 393216
    buffer_load_dwordx4 v62, s[24:27], s17 offen lds
    s_add_u32 m0, s58, 50176
    s_add_u32 s17, s57, 425984
    buffer_load_dwordx4 v62, s[24:27], s17 offen lds
    s_add_u32 m0, s58, 51200
    s_add_u32 s17, s57, 458752
    buffer_load_dwordx4 v63, s[24:27], s17 offen lds
    s_add_u32 m0, s58, 52224
    s_add_u32 s17, s57, 491520
    buffer_load_dwordx4 v63, s[24:27], s17 offen lds
    v_add_u32 v68, 65536, v66
    v_add_u32 v69, 65536, v67
    ds_read_b64_tr_b16 v[88:89], v68 offset:0
    ds_read_b64_tr_b16 v[90:91], v68 offset:1024
    ds_read_b64_tr_b16 v[92:93], v68 offset:8192
    ds_read_b64_tr_b16 v[94:95], v68 offset:9216
    ds_read_b64_tr_b16 a[176:177], v69 offset:0
    ds_read_b64_tr_b16 a[178:179], v69 offset:1024
    ds_read_b64_tr_b16 a[180:181], v69 offset:8192
    ds_read_b64_tr_b16 a[182:183], v69 offset:9216
    s_waitcnt lgkmcnt(0)
    s_waitcnt vmcnt(32)
    s_barrier
    s_add_u32 m0, s58, 65536
    s_add_u32 s17, s57, 393216
    buffer_load_dwordx4 v62, s[28:31], s17 offen lds
    s_add_u32 m0, s58, 66560
    s_add_u32 s17, s57, 425984
    buffer_load_dwordx4 v62, s[28:31], s17 offen lds
    s_add_u32 m0, s58, 67584
    s_add_u32 s17, s57, 458752
    buffer_load_dwordx4 v63, s[28:31], s17 offen lds
    s_add_u32 m0, s58, 68608
    s_add_u32 s17, s57, 491520
    buffer_load_dwordx4 v63, s[28:31], s17 offen lds
    v_add_u32 v68, 81920, v66
    v_add_u32 v69, 81920, v67
    ds_read_b64_tr_b16 v[96:97], v68 offset:0
    ds_read_b64_tr_b16 v[98:99], v68 offset:1024
    ds_read_b64_tr_b16 v[100:101], v68 offset:8192
    ds_read_b64_tr_b16 v[102:103], v68 offset:9216
    ds_read_b64_tr_b16 v[104:105], v69 offset:0
    ds_read_b64_tr_b16 v[106:107], v69 offset:1024
    ds_read_b64_tr_b16 v[108:109], v69 offset:8192
    ds_read_b64_tr_b16 v[110:111], v69 offset:9216
    s_waitcnt lgkmcnt(0)
    s_waitcnt vmcnt(32)
    s_barrier
    s_add_u32 m0, s58, 81920
    s_add_u32 s17, s57, 524288
    buffer_load_dwordx4 v62, s[20:23], s17 offen lds
    s_add_u32 m0, s58, 82944
    s_add_u32 s17, s57, 557056
    buffer_load_dwordx4 v62, s[20:23], s17 offen lds
    s_add_u32 m0, s58, 83968
    s_add_u32 s17, s57, 589824
    buffer_load_dwordx4 v63, s[20:23], s17 offen lds
    s_add_u32 m0, s58, 84992
    s_add_u32 s17, s57, 622592
    buffer_load_dwordx4 v63, s[20:23], s17 offen lds
    v_add_u32 v68, 98304, v66
    v_add_u32 v69, 98304, v67
    ds_read_b64_tr_b16 v[112:113], v68 offset:0
    ds_read_b64_tr_b16 v[114:115], v68 offset:1024
    ds_read_b64_tr_b16 v[116:117], v68 offset:8192
    ds_read_b64_tr_b16 v[118:119], v68 offset:9216
    ds_read_b64_tr_b16 v[120:121], v69 offset:0
    ds_read_b64_tr_b16 v[122:123], v69 offset:1024
    ds_read_b64_tr_b16 v[124:125], v69 offset:8192
    ds_read_b64_tr_b16 v[126:127], v69 offset:9216
    s_waitcnt lgkmcnt(0)
    s_waitcnt vmcnt(32)
    s_barrier
    s_add_u32 m0, s58, 98304
    s_add_u32 s17, s57, 524288
    buffer_load_dwordx4 v62, s[24:27], s17 offen lds
    s_add_u32 m0, s58, 99328
    s_add_u32 s17, s57, 557056
    buffer_load_dwordx4 v62, s[24:27], s17 offen lds
    s_add_u32 m0, s58, 100352
    s_add_u32 s17, s57, 589824
    buffer_load_dwordx4 v63, s[24:27], s17 offen lds
    s_add_u32 m0, s58, 101376
    s_add_u32 s17, s57, 622592
    buffer_load_dwordx4 v63, s[24:27], s17 offen lds
    v_add_u32 v68, 114688, v66
    v_add_u32 v69, 114688, v67
    ds_read_b64_tr_b16 v[128:129], v68 offset:0
    ds_read_b64_tr_b16 v[130:131], v68 offset:1024
    ds_read_b64_tr_b16 v[132:133], v68 offset:8192
    ds_read_b64_tr_b16 v[134:135], v68 offset:9216
    ds_read_b64_tr_b16 a[184:185], v69 offset:0
    ds_read_b64_tr_b16 a[186:187], v69 offset:1024
    ds_read_b64_tr_b16 a[188:189], v69 offset:8192
    ds_read_b64_tr_b16 a[190:191], v69 offset:9216
    s_waitcnt lgkmcnt(0)
    s_waitcnt vmcnt(32)
    s_barrier
    s_add_u32 m0, s58, 114688
    s_add_u32 s17, s57, 524288
    buffer_load_dwordx4 v62, s[28:31], s17 offen lds
    s_add_u32 m0, s58, 115712
    s_add_u32 s17, s57, 557056
    buffer_load_dwordx4 v62, s[28:31], s17 offen lds
    s_add_u32 m0, s58, 116736
    s_add_u32 s17, s57, 589824
    buffer_load_dwordx4 v63, s[28:31], s17 offen lds
    s_add_u32 m0, s58, 117760
    s_add_u32 s17, s57, 622592
    buffer_load_dwordx4 v63, s[28:31], s17 offen lds
    v_add_u32 v68, 131072, v66
    v_add_u32 v69, 131072, v67
    ds_read_b64_tr_b16 v[136:137], v68 offset:0
    ds_read_b64_tr_b16 v[138:139], v68 offset:1024
    ds_read_b64_tr_b16 v[140:141], v68 offset:8192
    ds_read_b64_tr_b16 v[142:143], v68 offset:9216
    ds_read_b64_tr_b16 v[144:145], v69 offset:0
    ds_read_b64_tr_b16 v[146:147], v69 offset:1024
    ds_read_b64_tr_b16 v[148:149], v69 offset:8192
    ds_read_b64_tr_b16 v[150:151], v69 offset:9216
    s_waitcnt lgkmcnt(0)
    s_waitcnt vmcnt(32)
    s_barrier
    s_add_u32 m0, s58, 131072
    s_add_u32 s17, s57, 655360
    buffer_load_dwordx4 v62, s[20:23], s17 offen lds
    s_add_u32 m0, s58, 132096
    s_add_u32 s17, s57, 688128
    buffer_load_dwordx4 v62, s[20:23], s17 offen lds
    s_add_u32 m0, s58, 133120
    s_add_u32 s17, s57, 720896
    buffer_load_dwordx4 v63, s[20:23], s17 offen lds
    s_add_u32 m0, s58, 134144
    s_add_u32 s17, s57, 753664
    buffer_load_dwordx4 v63, s[20:23], s17 offen lds
    v_add_u32 v68, 147456, v66
    v_add_u32 v69, 147456, v67
    ds_read_b64_tr_b16 v[152:153], v68 offset:0
    ds_read_b64_tr_b16 v[154:155], v68 offset:1024
    ds_read_b64_tr_b16 v[156:157], v68 offset:8192
    ds_read_b64_tr_b16 v[158:159], v68 offset:9216
    ds_read_b64_tr_b16 v[160:161], v69 offset:0
    ds_read_b64_tr_b16 v[162:163], v69 offset:1024
    ds_read_b64_tr_b16 v[164:165], v69 offset:8192
    ds_read_b64_tr_b16 v[166:167], v69 offset:9216
    s_waitcnt lgkmcnt(0)
    s_waitcnt vmcnt(32)
    s_barrier
    s_add_u32 m0, s58, 147456
    s_add_u32 s17, s57, 655360
    buffer_load_dwordx4 v62, s[24:27], s17 offen lds
    s_add_u32 m0, s58, 148480
    s_add_u32 s17, s57, 688128
    buffer_load_dwordx4 v62, s[24:27], s17 offen lds
    s_add_u32 m0, s58, 149504
    s_add_u32 s17, s57, 720896
    buffer_load_dwordx4 v63, s[24:27], s17 offen lds
    s_add_u32 m0, s58, 150528
    s_add_u32 s17, s57, 753664
    buffer_load_dwordx4 v63, s[24:27], s17 offen lds
    v_add_u32 v68, 0, v66
    v_add_u32 v69, 0, v67
    ds_read_b64_tr_b16 v[168:169], v68 offset:0
    ds_read_b64_tr_b16 v[170:171], v68 offset:1024
    ds_read_b64_tr_b16 v[172:173], v68 offset:8192
    ds_read_b64_tr_b16 v[174:175], v68 offset:9216
    ds_read_b64_tr_b16 a[192:193], v69 offset:0
    ds_read_b64_tr_b16 a[194:195], v69 offset:1024
    ds_read_b64_tr_b16 a[196:197], v69 offset:8192
    ds_read_b64_tr_b16 a[198:199], v69 offset:9216
    s_waitcnt lgkmcnt(0)
    s_waitcnt vmcnt(32)
    s_barrier
    s_add_u32 m0, s58, 0
    s_add_u32 s17, s57, 655360
    buffer_load_dwordx4 v62, s[28:31], s17 offen lds
    s_add_u32 m0, s58, 1024
    s_add_u32 s17, s57, 688128
    buffer_load_dwordx4 v62, s[28:31], s17 offen lds
    s_add_u32 m0, s58, 2048
    s_add_u32 s17, s57, 720896
    buffer_load_dwordx4 v63, s[28:31], s17 offen lds
    s_add_u32 m0, s58, 3072
    s_add_u32 s17, s57, 753664
    buffer_load_dwordx4 v63, s[28:31], s17 offen lds
    v_add_u32 v68, 16384, v66
    v_add_u32 v69, 16384, v67
    ds_read_b64_tr_b16 v[176:177], v68 offset:0
    ds_read_b64_tr_b16 v[178:179], v68 offset:1024
    ds_read_b64_tr_b16 v[180:181], v68 offset:8192
    ds_read_b64_tr_b16 v[182:183], v68 offset:9216
    ds_read_b64_tr_b16 v[184:185], v69 offset:0
    ds_read_b64_tr_b16 v[186:187], v69 offset:1024
    ds_read_b64_tr_b16 v[188:189], v69 offset:8192
    ds_read_b64_tr_b16 v[190:191], v69 offset:9216
    s_waitcnt lgkmcnt(0)
    s_waitcnt vmcnt(32)
    s_barrier
    s_add_u32 m0, s58, 16384
    s_add_u32 s17, s57, 786432
    buffer_load_dwordx4 v62, s[20:23], s17 offen lds
    s_add_u32 m0, s58, 17408
    s_add_u32 s17, s57, 819200
    buffer_load_dwordx4 v62, s[20:23], s17 offen lds
    s_add_u32 m0, s58, 18432
    s_add_u32 s17, s57, 851968
    buffer_load_dwordx4 v63, s[20:23], s17 offen lds
    s_add_u32 m0, s58, 19456
    s_add_u32 s17, s57, 884736
    buffer_load_dwordx4 v63, s[20:23], s17 offen lds
    v_add_u32 v68, 32768, v66
    v_add_u32 v69, 32768, v67
    ds_read_b64_tr_b16 v[192:193], v68 offset:0
    ds_read_b64_tr_b16 v[194:195], v68 offset:1024
    ds_read_b64_tr_b16 v[196:197], v68 offset:8192
    ds_read_b64_tr_b16 v[198:199], v68 offset:9216
    ds_read_b64_tr_b16 v[200:201], v69 offset:0
    ds_read_b64_tr_b16 v[202:203], v69 offset:1024
    ds_read_b64_tr_b16 v[204:205], v69 offset:8192
    ds_read_b64_tr_b16 v[206:207], v69 offset:9216
    s_waitcnt lgkmcnt(0)
    s_waitcnt vmcnt(32)
    s_barrier
    s_add_u32 m0, s58, 32768
    s_add_u32 s17, s57, 786432
    buffer_load_dwordx4 v62, s[24:27], s17 offen lds
    s_add_u32 m0, s58, 33792
    s_add_u32 s17, s57, 819200
    buffer_load_dwordx4 v62, s[24:27], s17 offen lds
    s_add_u32 m0, s58, 34816
    s_add_u32 s17, s57, 851968
    buffer_load_dwordx4 v63, s[24:27], s17 offen lds
    s_add_u32 m0, s58, 35840
    s_add_u32 s17, s57, 884736
    buffer_load_dwordx4 v63, s[24:27], s17 offen lds
    v_add_u32 v68, 49152, v66
    v_add_u32 v69, 49152, v67
    ds_read_b64_tr_b16 v[208:209], v68 offset:0
    ds_read_b64_tr_b16 v[210:211], v68 offset:1024
    ds_read_b64_tr_b16 v[212:213], v68 offset:8192
    ds_read_b64_tr_b16 v[214:215], v68 offset:9216
    ds_read_b64_tr_b16 a[200:201], v69 offset:0
    ds_read_b64_tr_b16 a[202:203], v69 offset:1024
    ds_read_b64_tr_b16 a[204:205], v69 offset:8192
    ds_read_b64_tr_b16 a[206:207], v69 offset:9216
    s_waitcnt lgkmcnt(0)
    s_waitcnt vmcnt(32)
    s_barrier
    s_add_u32 m0, s58, 49152
    s_add_u32 s17, s57, 786432
    buffer_load_dwordx4 v62, s[28:31], s17 offen lds
    s_add_u32 m0, s58, 50176
    s_add_u32 s17, s57, 819200
    buffer_load_dwordx4 v62, s[28:31], s17 offen lds
    s_add_u32 m0, s58, 51200
    s_add_u32 s17, s57, 851968
    buffer_load_dwordx4 v63, s[28:31], s17 offen lds
    s_add_u32 m0, s58, 52224
    s_add_u32 s17, s57, 884736
    buffer_load_dwordx4 v63, s[28:31], s17 offen lds
    v_add_u32 v68, 65536, v66
    v_add_u32 v69, 65536, v67
    ds_read_b64_tr_b16 v[216:217], v68 offset:0
    ds_read_b64_tr_b16 v[218:219], v68 offset:1024
    ds_read_b64_tr_b16 v[220:221], v68 offset:8192
    ds_read_b64_tr_b16 v[222:223], v68 offset:9216
    ds_read_b64_tr_b16 v[224:225], v69 offset:0
    ds_read_b64_tr_b16 v[226:227], v69 offset:1024
    ds_read_b64_tr_b16 v[228:229], v69 offset:8192
    ds_read_b64_tr_b16 v[230:231], v69 offset:9216
    s_waitcnt lgkmcnt(0)
    s_waitcnt vmcnt(32)
    s_barrier
    s_add_u32 m0, s58, 65536
    s_add_u32 s17, s57, 917504
    buffer_load_dwordx4 v62, s[20:23], s17 offen lds
    s_add_u32 m0, s58, 66560
    s_add_u32 s17, s57, 950272
    buffer_load_dwordx4 v62, s[20:23], s17 offen lds
    s_add_u32 m0, s58, 67584
    s_add_u32 s17, s57, 983040
    buffer_load_dwordx4 v63, s[20:23], s17 offen lds
    s_add_u32 m0, s58, 68608
    s_add_u32 s17, s57, 1015808
    buffer_load_dwordx4 v63, s[20:23], s17 offen lds
    v_add_u32 v68, 81920, v66
    v_add_u32 v69, 81920, v67
    ds_read_b64_tr_b16 v[232:233], v68 offset:0
    ds_read_b64_tr_b16 v[234:235], v68 offset:1024
    ds_read_b64_tr_b16 v[236:237], v68 offset:8192
    ds_read_b64_tr_b16 v[238:239], v68 offset:9216
    ds_read_b64_tr_b16 v[240:241], v69 offset:0
    ds_read_b64_tr_b16 v[242:243], v69 offset:1024
    ds_read_b64_tr_b16 v[244:245], v69 offset:8192
    ds_read_b64_tr_b16 v[246:247], v69 offset:9216
    s_waitcnt lgkmcnt(0)
    s_waitcnt vmcnt(32)
    s_barrier
    s_add_u32 m0, s58, 81920
    s_add_u32 s17, s57, 917504
    buffer_load_dwordx4 v62, s[24:27], s17 offen lds
    s_add_u32 m0, s58, 82944
    s_add_u32 s17, s57, 950272
    buffer_load_dwordx4 v62, s[24:27], s17 offen lds
    s_add_u32 m0, s58, 83968
    s_add_u32 s17, s57, 983040
    buffer_load_dwordx4 v63, s[24:27], s17 offen lds
    s_add_u32 m0, s58, 84992
    s_add_u32 s17, s57, 1015808
    buffer_load_dwordx4 v63, s[24:27], s17 offen lds
    v_add_u32 v68, 98304, v66
    v_add_u32 v69, 98304, v67
    ds_read_b64_tr_b16 v[248:249], v68 offset:0
    ds_read_b64_tr_b16 v[250:251], v68 offset:1024
    ds_read_b64_tr_b16 v[252:253], v68 offset:8192
    ds_read_b64_tr_b16 v[254:255], v68 offset:9216
    ds_read_b64_tr_b16 a[208:209], v69 offset:0
    ds_read_b64_tr_b16 a[210:211], v69 offset:1024
    ds_read_b64_tr_b16 a[212:213], v69 offset:8192
    ds_read_b64_tr_b16 a[214:215], v69 offset:9216
    s_waitcnt lgkmcnt(0)
    s_waitcnt vmcnt(32)
    s_barrier
    s_add_u32 m0, s58, 98304
    s_add_u32 s17, s57, 917504
    buffer_load_dwordx4 v62, s[28:31], s17 offen lds
    s_add_u32 m0, s58, 99328
    s_add_u32 s17, s57, 950272
    buffer_load_dwordx4 v62, s[28:31], s17 offen lds
    s_add_u32 m0, s58, 100352
    s_add_u32 s17, s57, 983040
    buffer_load_dwordx4 v63, s[28:31], s17 offen lds
    s_add_u32 m0, s58, 101376
    s_add_u32 s17, s57, 1015808
    buffer_load_dwordx4 v63, s[28:31], s17 offen lds
    v_add_u32 v68, 114688, v66
    v_add_u32 v69, 114688, v67
    ds_read_b64_tr_b16 a[0:1], v68 offset:0
    ds_read_b64_tr_b16 a[2:3], v68 offset:1024
    ds_read_b64_tr_b16 a[4:5], v68 offset:8192
    ds_read_b64_tr_b16 a[6:7], v68 offset:9216
    ds_read_b64_tr_b16 a[8:9], v69 offset:0
    ds_read_b64_tr_b16 a[10:11], v69 offset:1024
    ds_read_b64_tr_b16 a[12:13], v69 offset:8192
    ds_read_b64_tr_b16 a[14:15], v69 offset:9216
    s_waitcnt lgkmcnt(0)
    s_waitcnt vmcnt(32)
    s_barrier
    s_add_u32 m0, s58, 114688
    s_add_u32 s17, s57, 1048576
    buffer_load_dwordx4 v64, s[20:23], s17 offen lds
    s_add_u32 m0, s58, 115712
    s_add_u32 s17, s57, 1056768
    buffer_load_dwordx4 v64, s[20:23], s17 offen lds
    s_add_u32 m0, s58, 116736
    s_add_u32 s17, s57, 1064960
    buffer_load_dwordx4 v65, s[20:23], s17 offen lds
    s_add_u32 m0, s58, 117760
    s_add_u32 s17, s57, 1073152
    buffer_load_dwordx4 v65, s[20:23], s17 offen lds
    v_add_u32 v68, 131072, v66
    v_add_u32 v69, 131072, v67
    ds_read_b64_tr_b16 a[16:17], v68 offset:0
    ds_read_b64_tr_b16 a[18:19], v68 offset:1024
    ds_read_b64_tr_b16 a[20:21], v68 offset:8192
    ds_read_b64_tr_b16 a[22:23], v68 offset:9216
    ds_read_b64_tr_b16 a[24:25], v69 offset:0
    ds_read_b64_tr_b16 a[26:27], v69 offset:1024
    ds_read_b64_tr_b16 a[28:29], v69 offset:8192
    ds_read_b64_tr_b16 a[30:31], v69 offset:9216
    s_waitcnt lgkmcnt(0)
    s_waitcnt vmcnt(32)
    s_barrier
    s_add_u32 m0, s58, 131072
    s_add_u32 s17, s57, 1048576
    buffer_load_dwordx4 v64, s[24:27], s17 offen lds
    s_add_u32 m0, s58, 132096
    s_add_u32 s17, s57, 1056768
    buffer_load_dwordx4 v64, s[24:27], s17 offen lds
    s_add_u32 m0, s58, 133120
    s_add_u32 s17, s57, 1064960
    buffer_load_dwordx4 v65, s[24:27], s17 offen lds
    s_add_u32 m0, s58, 134144
    s_add_u32 s17, s57, 1073152
    buffer_load_dwordx4 v65, s[24:27], s17 offen lds
    v_add_u32 v68, 147456, v66
    v_add_u32 v69, 147456, v67
    ds_read_b64_tr_b16 a[32:33], v68 offset:0
    ds_read_b64_tr_b16 a[34:35], v68 offset:1024
    ds_read_b64_tr_b16 a[36:37], v68 offset:8192
    ds_read_b64_tr_b16 a[38:39], v68 offset:9216
    ds_read_b64_tr_b16 a[216:217], v69 offset:0
    ds_read_b64_tr_b16 a[218:219], v69 offset:1024
    ds_read_b64_tr_b16 a[220:221], v69 offset:8192
    ds_read_b64_tr_b16 a[222:223], v69 offset:9216
    s_waitcnt lgkmcnt(0)
    s_waitcnt vmcnt(32)
    s_barrier
    s_add_u32 m0, s58, 147456
    s_add_u32 s17, s57, 1048576
    buffer_load_dwordx4 v64, s[28:31], s17 offen lds
    s_add_u32 m0, s58, 148480
    s_add_u32 s17, s57, 1056768
    buffer_load_dwordx4 v64, s[28:31], s17 offen lds
    s_add_u32 m0, s58, 149504
    s_add_u32 s17, s57, 1064960
    buffer_load_dwordx4 v65, s[28:31], s17 offen lds
    s_add_u32 m0, s58, 150528
    s_add_u32 s17, s57, 1073152
    buffer_load_dwordx4 v65, s[28:31], s17 offen lds
    v_add_u32 v68, 0, v66
    v_add_u32 v69, 0, v67
    ds_read_b64_tr_b16 a[40:41], v68 offset:0
    ds_read_b64_tr_b16 a[42:43], v68 offset:1024
    ds_read_b64_tr_b16 a[44:45], v68 offset:8192
    ds_read_b64_tr_b16 a[46:47], v68 offset:9216
    ds_read_b64_tr_b16 a[48:49], v69 offset:0
    ds_read_b64_tr_b16 a[50:51], v69 offset:1024
    ds_read_b64_tr_b16 a[52:53], v69 offset:8192
    ds_read_b64_tr_b16 a[54:55], v69 offset:9216
    s_waitcnt lgkmcnt(0)
    s_waitcnt vmcnt(32)
    s_barrier
    v_add_u32 v68, 16384, v66
    v_add_u32 v69, 16384, v67
    ds_read_b64_tr_b16 a[56:57], v68 offset:0
    ds_read_b64_tr_b16 a[58:59], v68 offset:1024
    ds_read_b64_tr_b16 a[60:61], v68 offset:8192
    ds_read_b64_tr_b16 a[62:63], v68 offset:9216
    ds_read_b64_tr_b16 a[64:65], v69 offset:0
    ds_read_b64_tr_b16 a[66:67], v69 offset:1024
    ds_read_b64_tr_b16 a[68:69], v69 offset:8192
    ds_read_b64_tr_b16 a[70:71], v69 offset:9216
    s_waitcnt lgkmcnt(0)
    s_waitcnt vmcnt(28)
    s_barrier
    v_add_u32 v68, 32768, v66
    v_add_u32 v69, 32768, v67
    ds_read_b64_tr_b16 a[72:73], v68 offset:0
    ds_read_b64_tr_b16 a[74:75], v68 offset:1024
    ds_read_b64_tr_b16 a[76:77], v68 offset:8192
    ds_read_b64_tr_b16 a[78:79], v68 offset:9216
    ds_read_b64_tr_b16 a[224:225], v69 offset:0
    ds_read_b64_tr_b16 a[226:227], v69 offset:1024
    ds_read_b64_tr_b16 a[228:229], v69 offset:8192
    ds_read_b64_tr_b16 a[230:231], v69 offset:9216
    s_waitcnt lgkmcnt(0)
    s_waitcnt vmcnt(24)
    s_barrier
    v_add_u32 v68, 49152, v66
    v_add_u32 v69, 49152, v67
    ds_read_b64_tr_b16 a[80:81], v68 offset:0
    ds_read_b64_tr_b16 a[82:83], v68 offset:1024
    ds_read_b64_tr_b16 a[84:85], v68 offset:8192
    ds_read_b64_tr_b16 a[86:87], v68 offset:9216
    ds_read_b64_tr_b16 a[88:89], v69 offset:0
    ds_read_b64_tr_b16 a[90:91], v69 offset:1024
    ds_read_b64_tr_b16 a[92:93], v69 offset:8192
    ds_read_b64_tr_b16 a[94:95], v69 offset:9216
    s_waitcnt lgkmcnt(0)
    s_waitcnt vmcnt(20)
    s_barrier
    s_add_u32 s17, s59, 0
    s_add_u32 m0, s60, 0
    s_nop 0
    buffer_load_dwordx4 v50, s[80:83], s17 offen lds
    s_add_u32 m0, s60, 1024
    s_nop 0
    buffer_load_dwordx4 v51, s[80:83], s17 offen lds
    s_add_u32 m0, s60, 2048
    s_nop 0
    buffer_load_dwordx4 v52, s[80:83], s17 offen lds
    s_add_u32 m0, s60, 3072
    s_nop 0
    buffer_load_dwordx4 v53, s[80:83], s17 offen lds
    s_add_u32 m0, s60, 4096
    s_mov_b64 exec, s[52:53]
    buffer_load_dwordx4 v54, s[80:83], s17 offen lds
    s_mov_b64 exec, -1
    v_add_u32 v68, 65536, v66
    v_add_u32 v69, 65536, v67
    ds_read_b64_tr_b16 a[96:97], v68 offset:0
    ds_read_b64_tr_b16 a[98:99], v68 offset:1024
    ds_read_b64_tr_b16 a[100:101], v68 offset:8192
    ds_read_b64_tr_b16 a[102:103], v68 offset:9216
    ds_read_b64_tr_b16 a[104:105], v69 offset:0
    ds_read_b64_tr_b16 a[106:107], v69 offset:1024
    ds_read_b64_tr_b16 a[108:109], v69 offset:8192
    ds_read_b64_tr_b16 a[110:111], v69 offset:9216
    s_waitcnt lgkmcnt(0)
    s_waitcnt vmcnt(21)
    s_barrier
    s_add_u32 s17, s59, 1152
    s_add_u32 m0, s60, 18432
    s_nop 0
    buffer_load_dwordx4 v50, s[80:83], s17 offen lds
    s_add_u32 m0, s60, 19456
    s_nop 0
    buffer_load_dwordx4 v51, s[80:83], s17 offen lds
    s_add_u32 m0, s60, 20480
    s_nop 0
    buffer_load_dwordx4 v52, s[80:83], s17 offen lds
    s_add_u32 m0, s60, 21504
    s_nop 0
    buffer_load_dwordx4 v53, s[80:83], s17 offen lds
    s_add_u32 m0, s60, 22528
    s_mov_b64 exec, s[52:53]
    buffer_load_dwordx4 v54, s[80:83], s17 offen lds
    s_mov_b64 exec, -1
    v_add_u32 v68, 81920, v66
    v_add_u32 v69, 81920, v67
    ds_read_b64_tr_b16 a[112:113], v68 offset:0
    ds_read_b64_tr_b16 a[114:115], v68 offset:1024
    ds_read_b64_tr_b16 a[116:117], v68 offset:8192
    ds_read_b64_tr_b16 a[118:119], v68 offset:9216
    ds_read_b64_tr_b16 a[232:233], v69 offset:0
    ds_read_b64_tr_b16 a[234:235], v69 offset:1024
    ds_read_b64_tr_b16 a[236:237], v69 offset:8192
    ds_read_b64_tr_b16 a[238:239], v69 offset:9216
    s_waitcnt lgkmcnt(0)
    s_waitcnt vmcnt(22)
    s_barrier
    s_add_u32 s17, s59, 36864
    s_add_u32 m0, s60, 36864
    s_nop 0
    buffer_load_dwordx4 v50, s[80:83], s17 offen lds
    s_add_u32 m0, s60, 37888
    s_nop 0
    buffer_load_dwordx4 v51, s[80:83], s17 offen lds
    s_add_u32 m0, s60, 38912
    s_nop 0
    buffer_load_dwordx4 v52, s[80:83], s17 offen lds
    s_add_u32 m0, s60, 39936
    s_nop 0
    buffer_load_dwordx4 v53, s[80:83], s17 offen lds
    s_add_u32 m0, s60, 40960
    s_mov_b64 exec, s[52:53]
    buffer_load_dwordx4 v54, s[80:83], s17 offen lds
    s_mov_b64 exec, -1
    v_add_u32 v68, 98304, v66
    v_add_u32 v69, 98304, v67
    ds_read_b64_tr_b16 a[120:121], v68 offset:0
    ds_read_b64_tr_b16 a[122:123], v68 offset:1024
    ds_read_b64_tr_b16 a[124:125], v68 offset:8192
    ds_read_b64_tr_b16 a[126:127], v68 offset:9216
    ds_read_b64_tr_b16 a[128:129], v69 offset:0
    ds_read_b64_tr_b16 a[130:131], v69 offset:1024
    ds_read_b64_tr_b16 a[132:133], v69 offset:8192
    ds_read_b64_tr_b16 a[134:135], v69 offset:9216
    s_waitcnt lgkmcnt(0)
    s_waitcnt vmcnt(23)
    s_barrier
    v_add_u32 v68, 114688, v66
    v_add_u32 v69, 114688, v67
    ds_read_b64_tr_b16 a[136:137], v68 offset:0
    ds_read_b64_tr_b16 a[138:139], v68 offset:1024
    ds_read_b64_tr_b16 a[140:141], v68 offset:8192
    ds_read_b64_tr_b16 a[142:143], v68 offset:9216
    ds_read_b64_tr_b16 a[144:145], v69 offset:0
    ds_read_b64_tr_b16 a[146:147], v69 offset:1024
    ds_read_b64_tr_b16 a[148:149], v69 offset:8192
    ds_read_b64_tr_b16 a[150:151], v69 offset:9216
    s_waitcnt lgkmcnt(0)
    s_waitcnt vmcnt(19)
    s_barrier
    v_add_u32 v68, 131072, v66
    v_add_u32 v69, 131072, v67
    ds_read_b64_tr_b16 a[152:153], v68 offset:0
    ds_read_b64_tr_b16 a[154:155], v68 offset:1024
    ds_read_b64_tr_b16 a[156:157], v68 offset:8192
    ds_read_b64_tr_b16 a[158:159], v68 offset:9216
    ds_read_b64_tr_b16 a[240:241], v69 offset:0
    ds_read_b64_tr_b16 a[242:243], v69 offset:1024
    ds_read_b64_tr_b16 a[244:245], v69 offset:8192
    ds_read_b64_tr_b16 a[246:247], v69 offset:9216
    s_waitcnt lgkmcnt(0)
    s_waitcnt vmcnt(15)
    s_barrier
    v_add_u32 v68, 147456, v66
    v_add_u32 v69, 147456, v67
    ds_read_b64_tr_b16 a[160:161], v68 offset:0
    ds_read_b64_tr_b16 a[162:163], v68 offset:1024
    ds_read_b64_tr_b16 a[164:165], v68 offset:8192
    ds_read_b64_tr_b16 a[166:167], v68 offset:9216
    ds_read_b64_tr_b16 a[168:169], v69 offset:0
    ds_read_b64_tr_b16 a[170:171], v69 offset:1024
    ds_read_b64_tr_b16 a[172:173], v69 offset:8192
    ds_read_b64_tr_b16 a[174:175], v69 offset:9216
    s_waitcnt lgkmcnt(0)
    s_barrier
    ds_write_b128 v9, a[176:179] offset:0
    ds_write_b128 v9, a[180:183] offset:1024
    ds_write_b128 v9, a[184:187] offset:2048
    ds_write_b128 v9, a[188:191] offset:3072
    ds_write_b128 v9, a[192:195] offset:4096
    ds_write_b128 v9, a[196:199] offset:5120
    ds_write_b128 v9, a[200:203] offset:6144
    ds_write_b128 v9, a[204:207] offset:7168
    ds_write_b128 v9, a[208:211] offset:8192
    ds_write_b128 v9, a[212:215] offset:9216
    ds_write_b128 v9, a[216:219] offset:10240
    ds_write_b128 v9, a[220:223] offset:11264
    ds_write_b128 v9, a[224:227] offset:12288
    ds_write_b128 v9, a[228:231] offset:13312
    ds_write_b128 v9, a[232:235] offset:14336
    ds_write_b128 v9, a[236:239] offset:15360
    ds_write_b128 v9, a[240:243] offset:16384
    ds_write_b128 v9, a[244:247] offset:17408
    s_waitcnt lgkmcnt(0)
    s_waitcnt vmcnt(10)
    s_barrier
    ds_read_b64_tr_b16 a[176:177], v70 offset:0
    ds_read_b64_tr_b16 a[192:193], v70 offset:32
    ds_read_b64_tr_b16 v[12:13], v70 offset:64
    ds_read_b64_tr_b16 a[208:209], v70 offset:96
    ds_read_b64_tr_b16 v[20:21], v70 offset:128
    ds_read_b64_tr_b16 a[224:225], v70 offset:160
    ds_read_b64_tr_b16 a[240:241], v70 offset:192
    ds_read_b64_tr_b16 v[28:29], v70 offset:224
    ds_read_b64_tr_b16 v[36:37], v70 offset:256
    s_waitcnt lgkmcnt(0)
    s_waitcnt vmcnt(5)
    s_barrier
    s_add_u32 s17, s59, 38016
    s_add_u32 m0, s60, 0
    s_nop 0
    buffer_load_dwordx4 v50, s[80:83], s17 offen lds
    s_add_u32 m0, s60, 1024
    s_nop 0
    buffer_load_dwordx4 v51, s[80:83], s17 offen lds
    s_add_u32 m0, s60, 2048
    s_nop 0
    buffer_load_dwordx4 v52, s[80:83], s17 offen lds
    s_add_u32 m0, s60, 3072
    s_nop 0
    buffer_load_dwordx4 v53, s[80:83], s17 offen lds
    s_add_u32 m0, s60, 4096
    s_mov_b64 exec, s[52:53]
    buffer_load_dwordx4 v54, s[80:83], s17 offen lds
    s_mov_b64 exec, -1
    ds_read_b64_tr_b16 a[178:179], v70 offset:18432
    ds_read_b64_tr_b16 a[194:195], v70 offset:18464
    ds_read_b64_tr_b16 v[14:15], v70 offset:18496
    ds_read_b64_tr_b16 a[210:211], v70 offset:18528
    ds_read_b64_tr_b16 v[22:23], v70 offset:18560
    ds_read_b64_tr_b16 a[226:227], v70 offset:18592
    ds_read_b64_tr_b16 a[242:243], v70 offset:18624
    ds_read_b64_tr_b16 v[30:31], v70 offset:18656
    ds_read_b64_tr_b16 v[38:39], v70 offset:18688
    s_waitcnt lgkmcnt(0)
    s_waitcnt vmcnt(5)
    s_barrier
    s_add_u32 s17, s59, 73728
    s_add_u32 m0, s60, 18432
    s_nop 0
    buffer_load_dwordx4 v50, s[80:83], s17 offen lds
    s_add_u32 m0, s60, 19456
    s_nop 0
    buffer_load_dwordx4 v51, s[80:83], s17 offen lds
    s_add_u32 m0, s60, 20480
    s_nop 0
    buffer_load_dwordx4 v52, s[80:83], s17 offen lds
    s_add_u32 m0, s60, 21504
    s_nop 0
    buffer_load_dwordx4 v53, s[80:83], s17 offen lds
    s_add_u32 m0, s60, 22528
    s_mov_b64 exec, s[52:53]
    buffer_load_dwordx4 v54, s[80:83], s17 offen lds
    s_mov_b64 exec, -1
    ds_read_b64_tr_b16 a[180:181], v70 offset:36864
    ds_read_b64_tr_b16 a[196:197], v70 offset:36896
    ds_read_b64_tr_b16 v[16:17], v70 offset:36928
    ds_read_b64_tr_b16 a[212:213], v70 offset:36960
    ds_read_b64_tr_b16 v[24:25], v70 offset:36992
    ds_read_b64_tr_b16 a[228:229], v70 offset:37024
    ds_read_b64_tr_b16 a[244:245], v70 offset:37056
    ds_read_b64_tr_b16 v[32:33], v70 offset:37088
    ds_read_b64_tr_b16 v[40:41], v70 offset:37120
    s_waitcnt lgkmcnt(0)
    s_waitcnt vmcnt(5)
    s_barrier
    s_add_u32 s17, s59, 74880
    s_add_u32 m0, s60, 36864
    s_nop 0
    buffer_load_dwordx4 v50, s[80:83], s17 offen lds
    s_add_u32 m0, s60, 37888
    s_nop 0
    buffer_load_dwordx4 v51, s[80:83], s17 offen lds
    s_add_u32 m0, s60, 38912
    s_nop 0
    buffer_load_dwordx4 v52, s[80:83], s17 offen lds
    s_add_u32 m0, s60, 39936
    s_nop 0
    buffer_load_dwordx4 v53, s[80:83], s17 offen lds
    s_add_u32 m0, s60, 40960
    s_mov_b64 exec, s[52:53]
    buffer_load_dwordx4 v54, s[80:83], s17 offen lds
    s_mov_b64 exec, -1
    ds_read_b64_tr_b16 a[182:183], v70 offset:0
    ds_read_b64_tr_b16 a[198:199], v70 offset:32
    ds_read_b64_tr_b16 v[18:19], v70 offset:64
    ds_read_b64_tr_b16 a[214:215], v70 offset:96
    ds_read_b64_tr_b16 v[26:27], v70 offset:128
    ds_read_b64_tr_b16 a[230:231], v70 offset:160
    ds_read_b64_tr_b16 a[246:247], v70 offset:192
    ds_read_b64_tr_b16 v[34:35], v70 offset:224
    ds_read_b64_tr_b16 v[42:43], v70 offset:256
    s_waitcnt lgkmcnt(0)
    ds_write_b128 v9, v[12:15] offset:18432
    ds_write_b128 v9, v[16:19] offset:19456
    ds_write_b128 v9, v[20:23] offset:20480
    ds_write_b128 v9, v[24:27] offset:21504
    ds_write_b128 v9, v[28:31] offset:22528
    ds_write_b128 v9, v[32:35] offset:23552
    ds_write_b128 v9, v[36:39] offset:24576
    ds_write_b128 v9, v[40:43] offset:25600
    s_waitcnt lgkmcnt(0)
    s_waitcnt vmcnt(5)
    s_barrier
    s_add_u32 s17, s59, 110592
    s_add_u32 m0, s60, 0
    s_nop 0
    buffer_load_dwordx4 v50, s[80:83], s17 offen lds
    s_add_u32 m0, s60, 1024
    s_nop 0
    buffer_load_dwordx4 v51, s[80:83], s17 offen lds
    s_add_u32 m0, s60, 2048
    s_nop 0
    buffer_load_dwordx4 v52, s[80:83], s17 offen lds
    s_add_u32 m0, s60, 3072
    s_nop 0
    buffer_load_dwordx4 v53, s[80:83], s17 offen lds
    s_add_u32 m0, s60, 4096
    s_mov_b64 exec, s[52:53]
    buffer_load_dwordx4 v54, s[80:83], s17 offen lds
    s_mov_b64 exec, -1
    ds_read_b64_tr_b16 a[184:185], v70 offset:18432
    ds_read_b64_tr_b16 v[12:13], v70 offset:18464
    ds_read_b64_tr_b16 a[200:201], v70 offset:18496
    ds_read_b64_tr_b16 a[216:217], v70 offset:18528
    ds_read_b64_tr_b16 v[20:21], v70 offset:18560
    ds_read_b64_tr_b16 a[232:233], v70 offset:18592
    ds_read_b64_tr_b16 v[28:29], v70 offset:18624
    ds_read_b64_tr_b16 a[248:249], v70 offset:18656
    ds_read_b64_tr_b16 v[36:37], v70 offset:18688
    s_waitcnt lgkmcnt(0)
    s_waitcnt vmcnt(5)
    s_barrier
    s_add_u32 s17, s59, 111744
    s_add_u32 m0, s60, 18432
    s_nop 0
    buffer_load_dwordx4 v50, s[80:83], s17 offen lds
    s_add_u32 m0, s60, 19456
    s_nop 0
    buffer_load_dwordx4 v51, s[80:83], s17 offen lds
    s_add_u32 m0, s60, 20480
    s_nop 0
    buffer_load_dwordx4 v52, s[80:83], s17 offen lds
    s_add_u32 m0, s60, 21504
    s_nop 0
    buffer_load_dwordx4 v53, s[80:83], s17 offen lds
    s_add_u32 m0, s60, 22528
    s_mov_b64 exec, s[52:53]
    buffer_load_dwordx4 v54, s[80:83], s17 offen lds
    s_mov_b64 exec, -1
    ds_read_b64_tr_b16 a[186:187], v70 offset:36864
    ds_read_b64_tr_b16 v[14:15], v70 offset:36896
    ds_read_b64_tr_b16 a[202:203], v70 offset:36928
    ds_read_b64_tr_b16 a[218:219], v70 offset:36960
    ds_read_b64_tr_b16 v[22:23], v70 offset:36992
    ds_read_b64_tr_b16 a[234:235], v70 offset:37024
    ds_read_b64_tr_b16 v[30:31], v70 offset:37056
    ds_read_b64_tr_b16 a[250:251], v70 offset:37088
    ds_read_b64_tr_b16 v[38:39], v70 offset:37120
    s_waitcnt lgkmcnt(0)
    s_waitcnt vmcnt(5)
    s_barrier
    ds_read_b64_tr_b16 a[188:189], v70 offset:0
    ds_read_b64_tr_b16 v[16:17], v70 offset:32
    ds_read_b64_tr_b16 a[204:205], v70 offset:64
    ds_read_b64_tr_b16 a[220:221], v70 offset:96
    ds_read_b64_tr_b16 v[24:25], v70 offset:128
    ds_read_b64_tr_b16 a[236:237], v70 offset:160
    ds_read_b64_tr_b16 v[32:33], v70 offset:192
    ds_read_b64_tr_b16 a[252:253], v70 offset:224
    ds_read_b64_tr_b16 v[40:41], v70 offset:256
    s_waitcnt lgkmcnt(0)
    s_waitcnt vmcnt(0)
    s_barrier
    ds_read_b64_tr_b16 a[190:191], v70 offset:18432
    ds_read_b64_tr_b16 v[18:19], v70 offset:18464
    ds_read_b64_tr_b16 a[206:207], v70 offset:18496
    ds_read_b64_tr_b16 a[222:223], v70 offset:18528
    ds_read_b64_tr_b16 v[26:27], v70 offset:18560
    ds_read_b64_tr_b16 a[238:239], v70 offset:18592
    ds_read_b64_tr_b16 v[34:35], v70 offset:18624
    ds_read_b64_tr_b16 a[254:255], v70 offset:18656
    ds_read_b64_tr_b16 v[42:43], v70 offset:18688
    s_waitcnt lgkmcnt(0)
    s_barrier
    s_lshl_b32 s17, s14, 13
    v_add_u32 v71, s17, v0
    ds_write_b128 v71, v[12:15] offset:24576
    ds_write_b128 v71, v[16:19] offset:25600
    ds_write_b128 v71, v[20:23] offset:26624
    ds_write_b128 v71, v[24:27] offset:27648
    ds_write_b128 v71, v[28:31] offset:28672
    ds_write_b128 v71, v[32:35] offset:29696
    ds_write_b128 v71, v[36:39] offset:30720
    ds_write_b128 v71, v[40:43] offset:31744
    s_waitcnt vmcnt(0) lgkmcnt(0)
    s_barrier
    s_add_u32 s17, s32, s14
    s_cmp_lg_u32 s17, 0
    s_cbranch_scc1 Lr_nold
    v_mov_b32 v63, 48
    v_mov_b32 v64, 1
    s_mov_b64 exec, 1
    global_atomic_add v63, v64, s[12:13]
    s_mov_b64 exec, -1
Lr_nold:
    s_add_u32 s57, s48, 0
    s_add_u32 s58, s48, 98304
    s_add_u32 s59, s48, 196608
    s_add_u32 s60, s48, 294912
    s_mov_b64 exec, 0xff
    v_lshlrev_b32 v12, 5, v8
    v_and_b32 v12, 128, v12
    v_lshrrev_b32 v13, 1, v8
    v_and_or_b32 v12, v13, 12, v12
    s_mov_b32 s16, 0
L_pure:
    global_load_dword v13, v12, s[12:13] sc1
    s_add_u32 s16, s16, 1
    s_cmp_gt_u32 s16, 100000
    s_cbranch_scc1 Lr_abort
    s_mov_b32 s6, 0
    s_waitcnt vmcnt(0)
    v_readlane_b32 s7, v13, 0
    s_nop 0
    s_add_u32 s6, s6, s7
    v_readlane_b32 s7, v13, 1
    s_nop 0
    s_add_u32 s6, s6, s7
    v_readlane_b32 s7, v13, 2
    s_nop 0
    s_add_u32 s6, s6, s7
    v_readlane_b32 s7, v13, 3
    s_nop 0
    s_add_u32 s6, s6, s7
    v_readlane_b32 s7, v13, 4
    s_nop 0
    s_add_u32 s6, s6, s7
    v_readlane_b32 s7, v13, 5
    s_nop 0
    s_add_u32 s6, s6, s7
    v_readlane_b32 s7, v13, 6
    s_nop 0
    s_add_u32 s6, s6, s7
    v_readlane_b32 s7, v13, 7
    s_nop 0
    s_add_u32 s6, s6, s7
    v_readlane_b32 s7, v13, s32
    s_nop 0
    s_cmp_ge_u32 s7, 32
    s_cselect_b32 s55, 1, 0
    s_cselect_b32 s6, 256, s6
    s_cmp_lt_u32 s6, 256
    s_cbranch_scc1 L_pure
    s_mov_b64 exec, -1
    s_lshl_b32 s6, s32, 2
    s_add_u32 s6, s6, 192
    s_cmp_lg_u32 s14, 0
    s_cbranch_scc1 L_team_d
    v_mov_b32 v12, s6
    s_mov_b32 s16, 0
L_team:
    global_load_dword v13, v12, s[12:13] sc1
    s_add_u32 s16, s16, 1
    s_cmp_gt_u32 s16, 100000
    s_cbranch_scc1 Lr_abort
    s_waitcnt vmcnt(0)
    v_cmp_gt_u32 vcc, 32, v13
    s_nop 0
    s_cbranch_vccz L_team_d
    s_sleep 8
    s_branch L_team
L_team_d:
    s_barrier
    s_cmp_lg_u32 s14, 0
    s_cbranch_scc1 L_rpool_d
    v_mov_b32 v12, 160
    s_mov_b32 s16, 0
L_rpool:
    global_load_dword v13, v12, s[12:13] sc1
    s_add_u32 s16, s16, 1
    s_cmp_gt_u32 s16, 100000
    s_cbranch_scc1 Lr_abort
    s_waitcnt vmcnt(0)
    v_cmp_gt_u32 vcc, 123, v13
    s_nop 0
    s_cbranch_vccz L_rpool_d
    s_sleep 8
    s_branch L_rpool
L_rpool_d:
    s_barrier
    s_barrier
    s_cmp_eq_u32 s55, 0
    s_cbranch_scc1 L_slow
    s_cmp_lg_u32 s14, 0
    s_cbranch_scc1 L_w1_1
    s_barrier
    s_mov_b32 m0, 9216
    s_nop 0
    buffer_load_dwordx4 v0, s[8:11], s41 offen offset:0 lds
    buffer_load_dwordx4 v0, s[8:11], s41 offen offset:1024 lds
    s_add_u32 s41, s41, 262144
    s_waitcnt vmcnt(0)
    buffer_load_dwordx4 v[44:47], v0, s[8:11], s34 offen sc1
    buffer_load_dwordx4 v[48:51], v0, s[8:11], s34 offen offset:1024 sc1
    buffer_load_dword v10, v8, s[8:11], s35 offen sc1
    ds_read_b128 v[56:59], v9 offset:0
    ds_read_b128 v[60:63], v9 offset:1024
    ds_read_b128 v[64:67], v9 offset:2048
    ds_read_b128 v[68:71], v9 offset:3072
    v_mov_b64 v[12:13], 0
    v_mov_b64 v[14:15], 0
    v_mov_b64 v[16:17], 0
    v_mov_b64 v[18:19], 0
    v_mov_b64 v[20:21], 0
    v_mov_b64 v[22:23], 0
    v_mov_b64 v[24:25], 0
    v_mov_b64 v[26:27], 0
    v_mov_b64 v[28:29], 0
    v_mov_b64 v[30:31], 0
    v_mov_b64 v[32:33], 0
    v_mov_b64 v[34:35], 0
    s_waitcnt lgkmcnt(0)
Lr0f_step:
    s_mov_b32 s16, 0
    s_mov_b64 s[70:71], 0
    s_mov_b64 s[72:73], 0
    s_mov_b64 s[74:75], 0
Lr0f_p2:
    s_mov_b64 exec, s[70:71]
    buffer_load_dwordx4 v[44:47], v0, s[8:11], s34 offen sc1
    s_mov_b64 exec, s[72:73]
    buffer_load_dwordx4 v[48:51], v0, s[8:11], s34 offen offset:1024 sc1
    s_mov_b64 exec, s[74:75]
    buffer_load_dword v10, v8, s[8:11], s35 offen sc1
    s_mov_b64 exec, -1
    s_add_u32 s16, s16, 1
    s_cmp_gt_u32 s16, 100000
    s_cbranch_scc1 Lr_abort
    s_waitcnt vmcnt(5)
    v_max3_u32 v11, v44, v45, v46
    v_max_u32 v11, v11, v47
    v_cmp_eq_u32 s[70:71], -1, v11
    s_waitcnt vmcnt(4)
    v_max3_u32 v11, v48, v49, v50
    v_max_u32 v11, v11, v51
    v_cmp_eq_u32 s[72:73], -1, v11
    s_waitcnt vmcnt(3)
    v_cmp_eq_u32 s[74:75], -1, v10
    s_or_b64 vcc, s[70:71], s[72:73]
    s_or_b64 vcc, vcc, s[74:75]
    s_cbranch_scc1 Lr0f_p2
    v_smfmac_f32_16x16x64_bf16 v[12:15], v[44:47], v[72:79], v1
    ds_write_b128 v0, v[44:47] offset:0
    v_smfmac_f32_16x16x64_bf16 v[16:19], v[44:47], v[80:87], v1
    ds_write_b128 v0, v[48:51] offset:1024
    v_smfmac_f32_16x16x64_bf16 v[20:23], v[44:47], v[88:95], v1
    ds_write_b32 v8, v10 offset:8192
    v_smfmac_f32_16x16x64_bf16 v[24:27], v[44:47], v[56:63], v1
    s_waitcnt lgkmcnt(0)
    s_barrier
    ds_read_b128 v[52:55], v0 offset:2048
    v_smfmac_f32_16x16x64_bf16 v[12:15], v[48:51], v[112:119], v1
    ds_read_b128 v[36:39], v0 offset:3072
    v_smfmac_f32_16x16x64_bf16 v[16:19], v[48:51], v[120:127], v1
    ds_read_b128 v[56:59], v9 offset:4096
    v_smfmac_f32_16x16x64_bf16 v[20:23], v[48:51], v[128:135], v1
    ds_read_b128 v[60:63], v9 offset:5120
    v_smfmac_f32_16x16x64_bf16 v[24:27], v[48:51], v[64:71], v1
    ds_read_b128 v[40:43], v0 offset:4096
    s_waitcnt lgkmcnt(4)
    v_smfmac_f32_16x16x64_bf16 v[12:15], v[52:55], v[152:159], v1
    v_smfmac_f32_16x16x64_bf16 v[16:19], v[52:55], v[160:167], v1
    ds_read_b128 v[64:67], v9 offset:6144
    v_smfmac_f32_16x16x64_bf16 v[20:23], v[52:55], v[168:175], v1
    ds_read_b128 v[68:71], v9 offset:7168
    s_waitcnt lgkmcnt(3)
    v_smfmac_f32_16x16x64_bf16 v[24:27], v[52:55], v[56:63], v1
    v_smfmac_f32_16x16x64_bf16 v[12:15], v[36:39], v[192:199], v1
    ds_read_b128 v[52:55], v0 offset:5120
    v_smfmac_f32_16x16x64_bf16 v[16:19], v[36:39], v[200:207], v1
    ds_read_b128 v[56:59], v9 offset:8192
    v_smfmac_f32_16x16x64_bf16 v[20:23], v[36:39], v[208:215], v1
    ds_read_b128 v[60:63], v9 offset:9216
    s_waitcnt lgkmcnt(3)
    v_smfmac_f32_16x16x64_bf16 v[24:27], v[36:39], v[64:71], v1
    v_smfmac_f32_16x16x64_bf16 v[12:15], v[40:43], v[232:239], v1
    buffer_load_dwordx4 v[36:39], v0, s[8:11], s42 offen
    v_smfmac_f32_16x16x64_bf16 v[16:19], v[40:43], v[240:247], v1
    ds_read_b128 v[64:67], v9 offset:10240
    v_smfmac_f32_16x16x64_bf16 v[20:23], v[40:43], v[248:255], v1
    ds_read_b128 v[68:71], v9 offset:11264
    s_waitcnt lgkmcnt(2)
    v_smfmac_f32_16x16x64_bf16 v[24:27], v[40:43], v[56:63], v1
    s_waitcnt vmcnt(1)
    ds_read_b128 v[44:47], v0 offset:6144
    v_smfmac_f32_16x16x64_bf16 v[12:15], v[52:55], a[16:23], v1
    buffer_load_dwordx4 v[40:43], v0, s[8:11], s42 offen offset:1024
    v_smfmac_f32_16x16x64_bf16 v[16:19], v[52:55], a[24:31], v1
    ds_read_b128 v[56:59], v9 offset:12288
    v_smfmac_f32_16x16x64_bf16 v[20:23], v[52:55], a[32:39], v1
    ds_read_b128 v[60:63], v9 offset:13312
    s_waitcnt lgkmcnt(3)
    v_smfmac_f32_16x16x64_bf16 v[24:27], v[52:55], v[64:71], v1
    ds_read_b128 v[48:51], v0 offset:7168
    s_waitcnt lgkmcnt(3)
    v_smfmac_f32_16x16x64_bf16 v[12:15], v[44:47], a[56:63], v1
    ds_read_b128 v[52:55], v0 offset:8192
    v_smfmac_f32_16x16x64_bf16 v[16:19], v[44:47], a[64:71], v1
    ds_read_b128 v[64:67], v9 offset:14336
    v_smfmac_f32_16x16x64_bf16 v[20:23], v[44:47], a[72:79], v1
    ds_read_b128 v[68:71], v9 offset:15360
    s_waitcnt lgkmcnt(4)
    v_smfmac_f32_16x16x64_bf16 v[24:27], v[44:47], v[56:63], v1
    s_waitcnt lgkmcnt(3)
    v_smfmac_f32_16x16x64_bf16 v[12:15], v[48:51], a[96:103], v1
    v_smfmac_f32_16x16x64_bf16 v[16:19], v[48:51], a[104:111], v1
    ds_read_b128 v[56:59], v9 offset:16384
    s_waitcnt lgkmcnt(3)
    v_smfmac_f32_16x16x64_bf16 v[12:15], v[52:55], a[136:143], v1
    ds_read_b128 v[60:63], v9 offset:17408
    v_smfmac_f32_16x16x64_bf16 v[16:19], v[52:55], a[144:151], v1
    v_smfmac_f32_16x16x64_bf16 v[20:23], v[48:51], a[112:119], v1
    s_waitcnt lgkmcnt(2)
    v_smfmac_f32_16x16x64_bf16 v[24:27], v[48:51], v[64:71], v1
    ds_read_b128 v[64:67], v0 offset:9216
    s_nop 1
    v_add_f32 v12, v12, v14
    v_smfmac_f32_16x16x64_bf16 v[20:23], v[52:55], a[152:159], v1
    ds_read_b128 v[68:71], v0 offset:10240
    v_add_f32 v16, v16, v18
    s_waitcnt lgkmcnt(2)
    v_smfmac_f32_16x16x64_bf16 v[24:27], v[52:55], v[56:63], v1
    ds_read_b128 v[56:59], v0 offset:11264
    v_add_f32 v13, v13, v15
    v_add_f32 v17, v17, v19
    v_cvt_pk_bf16_f32 v14, v12, v16
    v_cvt_pk_bf16_f32 v15, v13, v17
    ds_write_b32 v2, v14 offset:17408
    ds_write_b32 v2, v15 offset:17696
    v_smfmac_f32_16x16x64_bf16 v[28:31], v[52:55], a[160:167], v1
    ds_read_b128 v[60:63], v0 offset:12288
    v_add_f32 v20, v20, v22
    v_add_f32 v24, v24, v26
    v_add_f32 v21, v21, v23
    v_add_f32 v25, v25, v27
    v_smfmac_f32_16x16x64_bf16 v[32:35], v[52:55], a[168:175], v1
    ds_read_b128 v[12:15], v0 offset:0
    v_cvt_pk_bf16_f32 v22, v20, v24
    v_cvt_pk_bf16_f32 v23, v21, v25
    ds_write_b32 v2, v22 offset:19712
    ds_write_b32 v2, v23 offset:20000
    v_smfmac_f32_16x16x64_bf16 v[28:31], v[48:51], a[120:127], v1
    ds_read_b128 v[16:19], v0 offset:1024
    v_smfmac_f32_16x16x64_bf16 v[32:35], v[48:51], a[128:135], v1
    ds_read_b128 v[20:23], v0 offset:2048
    v_smfmac_f32_16x16x64_bf16 v[28:31], v[44:47], a[80:87], v1
    ds_read_b128 v[24:27], v0 offset:3072
    v_smfmac_f32_16x16x64_bf16 v[32:35], v[44:47], a[88:95], v1
    s_waitcnt lgkmcnt(3)
    s_barrier
    ds_read_b128 v[44:47], v3 offset:17408
    v_smfmac_f32_16x16x64_bf16 v[28:31], v[12:15], v[96:103], v1
    ds_read_b128 v[52:55], v0 offset:4096
    v_smfmac_f32_16x16x64_bf16 v[32:35], v[12:15], v[104:111], v1
    ds_read_b128 v[12:15], v3 offset:19712
    s_waitcnt lgkmcnt(5)
    v_smfmac_f32_16x16x64_bf16 v[28:31], v[16:19], v[136:143], v1
    ds_read_b128 v[48:51], v0 offset:5120
    v_smfmac_f32_16x16x64_bf16 v[32:35], v[16:19], v[144:151], v1
    s_waitcnt lgkmcnt(5)
    v_smfmac_f32_16x16x64_bf16 v[28:31], v[20:23], v[176:183], v1
    v_smfmac_f32_16x16x64_bf16 v[32:35], v[20:23], v[184:191], v1
    ds_read_b128 v[20:23], v3 offset:17472
    s_waitcnt lgkmcnt(5)
    v_smfmac_f32_16x16x64_bf16 v[28:31], v[24:27], v[216:223], v1
    v_smfmac_f32_16x16x64_bf16 v[32:35], v[24:27], v[224:231], v1
    s_waitcnt lgkmcnt(3)
    v_smfmac_f32_16x16x64_bf16 v[28:31], v[52:55], a[0:7], v1
    v_smfmac_f32_16x16x64_bf16 v[32:35], v[52:55], a[8:15], v1
    ds_read_b128 v[52:55], v3 offset:19776
    s_waitcnt lgkmcnt(2)
    v_smfmac_f32_16x16x64_bf16 v[28:31], v[48:51], a[40:47], v1
    v_smfmac_f32_16x16x64_bf16 v[32:35], v[48:51], a[48:55], v1
    ds_read_b128 v[48:51], v3 offset:17536
    v_mfma_f32_16x16x32_bf16 v[24:27], v[12:15], v[44:47], 0
    v_mfma_f32_16x16x32_bf16 v[12:15], v[64:67], v[44:47], 0
    ds_read_b128 v[64:67], v0 offset:13312
    v_mfma_f32_16x16x32_bf16 v[16:19], v[68:71], v[44:47], 0
    ds_read_b128 v[68:71], v0 offset:14336
    s_waitcnt lgkmcnt(3)
    v_mfma_f32_16x16x32_bf16 v[24:27], v[52:55], v[20:23], v[24:27]
    ds_read_b128 v[44:47], v3 offset:19840
    v_add_f32 v28, v28, v30
    v_add_f32 v29, v29, v31
    v_mfma_f32_16x16x32_bf16 v[12:15], v[56:59], v[20:23], v[12:15]
    ds_read_b128 v[52:55], v3 offset:17600
    v_add_f32 v32, v32, v34
    v_add_f32 v33, v33, v35
    v_mfma_f32_16x16x32_bf16 v[16:19], v[60:63], v[20:23], v[16:19]
    ds_read_b128 v[56:59], v0 offset:15360
    v_cvt_pk_bf16_f32 v30, v28, v29
    v_cvt_pk_bf16_f32 v31, v32, v33
    s_waitcnt lgkmcnt(2)
    v_mfma_f32_16x16x32_bf16 v[24:27], v[44:47], v[48:51], v[24:27]
    ds_read_b128 v[20:23], v3 offset:19904
    v_lshrrev_b32 v10, 8, v0
    v_mul_u32_u24 v10, 288, v10
    v_mfma_f32_16x16x32_bf16 v[12:15], v[64:67], v[48:51], v[12:15]
    ds_read_b128 v[60:63], v0 offset:16384
    v_and_b32 v11, 0xf0, v0
    v_add_u32 v10, v10, v11
    v_mfma_f32_16x16x32_bf16 v[16:19], v[68:71], v[48:51], v[16:19]
    ds_read_b128 v[32:35], v10 offset:19712
    v_lshrrev_b32 v11, 1, v0
    v_bfi_b32 v30, 1, s66, v30
    s_waitcnt lgkmcnt(2)
    v_mfma_f32_16x16x32_bf16 v[24:27], v[20:23], v[52:55], v[24:27]
    buffer_store_dwordx2 v[30:31], v11, s[8:11], s43 offen offset:2048 sc1
    v_mov_b32 v49, 0
    v_mov_b32 v50, 0
    v_mfma_f32_16x16x32_bf16 v[12:15], v[56:59], v[52:55], v[12:15]
    v_mov_b64 v[64:65], s[68:69]
    v_mov_b64 v[66:67], s[68:69]
    s_waitcnt lgkmcnt(1)
    v_mfma_f32_16x16x32_bf16 v[16:19], v[60:63], v[52:55], v[16:19]
    s_waitcnt lgkmcnt(0)
    v_bfi_b32 v32, 1, s66, v32
    s_mov_b64 exec, s[52:53]
    buffer_store_dwordx4 v[32:35], v0, s[8:11], s43 offen sc1
    s_mov_b64 exec, -1
    v_max3_f32 v10, v24, v25, v12
    v_max3_f32 v10, v10, v13, v14
    s_nop 0
    v_max3_f32 v10, v10, v15, v16
    v_max3_f32 v10, v10, v17, v18
    v_max_f32 v10, v10, v19
    v_mov_b32 v11, v10
    s_nop 1
    v_permlane32_swap_b32 v10, v11
    v_max_f32 v10, v10, v11
    v_mov_b32 v11, v10
    s_nop 1
    v_permlane16_swap_b32 v10, v11
    v_max_f32 v10, v10, v11
    v_mul_f32 v20, s46, v10
    v_pk_fma_f32 v[24:25], v[24:25], s[46:47], v[20:21] op_sel_hi:[1,1,0] neg_lo:[0,0,1] neg_hi:[0,0,1]
    v_pk_fma_f32 v[12:13], v[12:13], s[46:47], v[20:21] op_sel_hi:[1,1,0] neg_lo:[0,0,1] neg_hi:[0,0,1]
    v_exp_f32 v24, v24
    v_exp_f32 v25, v25
    v_pk_fma_f32 v[14:15], v[14:15], s[46:47], v[20:21] op_sel_hi:[1,1,0] neg_lo:[0,0,1] neg_hi:[0,0,1]
    v_exp_f32 v12, v12
    v_exp_f32 v13, v13
    v_pk_fma_f32 v[16:17], v[16:17], s[46:47], v[20:21] op_sel_hi:[1,1,0] neg_lo:[0,0,1] neg_hi:[0,0,1]
    v_cvt_pk_bf16_f32 v48, v24, v25
    v_exp_f32 v14, v14
    v_pk_fma_f32 v[18:19], v[18:19], s[46:47], v[20:21] op_sel_hi:[1,1,0] neg_lo:[0,0,1] neg_hi:[0,0,1]
    v_cvt_pk_bf16_f32 v51, v24, v25
    v_exp_f32 v15, v15
    v_cvt_pk_bf16_f32 v44, v12, v13
    v_exp_f32 v16, v16
    v_exp_f32 v17, v17
    v_cvt_pk_bf16_f32 v45, v14, v15
    v_exp_f32 v18, v18
    v_exp_f32 v19, v19
    v_cvt_pk_bf16_f32 v46, v16, v17
    v_cvt_pk_bf16_f32 v47, v18, v19
    v_mfma_f32_16x16x16_bf16 v[68:71], v[64:65], v[48:49], 0
    v_mfma_f32_16x16x16_bf16 v[52:55], v[30:31], v[48:49], 0
    v_mfma_f32_16x16x16_bf16 v[56:59], v[30:31], v[50:51], 0
    v_mfma_f32_16x16x32_bf16 v[68:71], v[64:67], v[44:47], v[68:71]
    s_waitcnt vmcnt(3)
    v_mfma_f32_16x16x32_bf16 v[52:55], v[36:39], v[44:47], v[52:55]
    s_waitcnt vmcnt(2)
    v_mfma_f32_16x16x32_bf16 v[56:59], v[40:43], v[44:47], v[56:59]
    ds_read_b128 v[36:39], v0 offset:30720
    ds_read_b128 v[40:43], v0 offset:31744
    ds_read_b128 v[60:63], v9 offset:24576
    s_nop 0
    v_rcp_f32 v10, v68
    s_nop 0
    v_pk_mul_f32 v[52:53], v[52:53], v[10:11] op_sel_hi:[1,0]
    s_nop 0
    v_pk_mul_f32 v[56:57], v[56:57], v[10:11] op_sel_hi:[1,0]
    v_cvt_pk_bf16_f32 v16, v52, v56
    v_cvt_pk_bf16_f32 v17, v53, v57
    v_pk_mul_f32 v[54:55], v[54:55], v[10:11] op_sel_hi:[1,0]
    v_pk_mul_f32 v[58:59], v[58:59], v[10:11] op_sel_hi:[1,0]
    v_cvt_pk_bf16_f32 v18, v54, v58
    v_cvt_pk_bf16_f32 v19, v55, v59
    ds_write_b128 v3, v[16:19] offset:22016
    ds_read_b128 v[64:67], v9 offset:25600
    v_mov_b64 v[12:13], 0
    v_mov_b64 v[14:15], 0
    v_mov_b64 v[20:21], 0
    v_mov_b64 v[22:23], 0
    v_mov_b64 v[24:25], 0
    v_mov_b64 v[26:27], 0
    v_mov_b64 v[32:33], 0
    v_mov_b64 v[34:35], 0
    v_mov_b64 v[44:45], 0
    v_mov_b64 v[46:47], 0
    v_mov_b64 v[48:49], 0
    v_mov_b64 v[50:51], 0
    s_waitcnt lgkmcnt(1)
    s_barrier
    ds_read_b128 v[52:55], v4 offset:22016
    ds_read_b128 v[56:59], v4 offset:22144
    v_mov_b64 v[68:69], 0
    v_mov_b64 v[70:71], 0
    v_mov_b64 v[28:29], 0
    v_mov_b64 v[30:31], 0
    v_mov_b64 v[16:17], 0
    v_mov_b64 v[18:19], 0
    s_cmp_eq_u32 s33, 63
    s_cbranch_scc1 Lr0f_last
    s_waitcnt lgkmcnt(1)
    v_smfmac_f32_16x16x64_bf16 v[28:31], v[52:55], v[60:67], v1
    ds_read_b128 v[60:63], v0 offset:24576
    s_waitcnt lgkmcnt(1)
    v_smfmac_f32_16x16x64_bf16 v[28:31], v[56:59], v[36:43], v1
    ds_read_b128 v[64:67], v0 offset:25600
    ds_read_b128 v[36:39], v9 offset:18432
    v_smfmac_f32_16x16x64_bf16 v[12:15], v[52:55], a[176:183], v1
    ds_read_b128 v[40:43], v9 offset:19456
    v_smfmac_f32_16x16x64_bf16 v[12:15], v[56:59], a[184:191], v1
    buffer_load_dwordx4 v0, s[8:11], s41 offen offset:0 lds
    v_smfmac_f32_16x16x64_bf16 v[20:23], v[52:55], a[192:199], v1
    s_nop 0
    v_add_f32 v28, v28, v30
    v_add_f32 v29, v29, v31
    s_waitcnt lgkmcnt(2)
    v_smfmac_f32_16x16x64_bf16 v[20:23], v[56:59], v[60:67], v1
    ds_read_b128 v[60:63], v9 offset:20480
    v_cvt_pk_bf16_f32 v28, v28, v29
    v_bfi_b32 v28, 1, s39, v28
    buffer_store_dword v28, v8, s[8:11], s38 offen offset:2048
    s_waitcnt lgkmcnt(1)
    v_smfmac_f32_16x16x64_bf16 v[24:27], v[52:55], v[36:43], v1
    ds_read_b128 v[64:67], v9 offset:21504
    ds_read_b128 v[36:39], v0 offset:26624
    v_add_f32 v12, v12, v14
    v_add_f32 v13, v13, v15
    v_smfmac_f32_16x16x64_bf16 v[24:27], v[56:59], a[200:207], v1
    ds_read_b128 v[40:43], v0 offset:27648
    v_cvt_pk_bf16_f32 v12, v12, v13
    v_bfi_b32 v12, 1, s39, v12
    v_smfmac_f32_16x16x64_bf16 v[32:35], v[52:55], a[208:215], v1
    buffer_load_dwordx4 v0, s[8:11], s41 offen offset:1024 lds
    v_add_f32 v20, v20, v22
    v_add_f32 v21, v21, v23
    v_smfmac_f32_16x16x64_bf16 v[32:35], v[56:59], a[216:223], v1
    v_cvt_pk_bf16_f32 v13, v20, v21
    s_waitcnt lgkmcnt(2)
    v_smfmac_f32_16x16x64_bf16 v[44:47], v[52:55], v[60:67], v1
    ds_read_b128 v[60:63], v0 offset:28672
    v_add_f32 v24, v24, v26
    v_add_f32 v25, v25, v27
    s_waitcnt lgkmcnt(1)
    v_smfmac_f32_16x16x64_bf16 v[44:47], v[56:59], v[36:43], v1
    ds_read_b128 v[64:67], v0 offset:29696
    ds_read_b128 v[36:39], v9 offset:22528
    v_cvt_pk_bf16_f32 v14, v24, v25
    v_smfmac_f32_16x16x64_bf16 v[48:51], v[52:55], a[224:231], v1
    ds_read_b128 v[40:43], v9 offset:23552
    v_add_f32 v32, v32, v34
    v_add_f32 v33, v33, v35
    v_smfmac_f32_16x16x64_bf16 v[48:51], v[56:59], a[232:239], v1
    v_cvt_pk_bf16_f32 v15, v32, v33
    buffer_store_dwordx4 v[12:15], v0, s[8:11], s38 offen offset:0
    v_smfmac_f32_16x16x64_bf16 v[68:71], v[52:55], a[240:247], v1
    v_add_f32 v44, v44, v46
    v_add_f32 v45, v45, v47
    s_waitcnt lgkmcnt(2)
    v_smfmac_f32_16x16x64_bf16 v[68:71], v[56:59], v[60:67], v1
    v_cvt_pk_bf16_f32 v44, v44, v45
    v_bfi_b32 v44, 1, s39, v44
    s_waitcnt lgkmcnt(0)
    v_smfmac_f32_16x16x64_bf16 v[16:19], v[52:55], v[36:43], v1
    v_add_f32 v48, v48, v50
    v_add_f32 v49, v49, v51
    v_smfmac_f32_16x16x64_bf16 v[16:19], v[56:59], a[248:255], v1
    v_cvt_pk_bf16_f32 v45, v48, v49
    v_add_f32 v68, v68, v70
    v_add_f32 v69, v69, v71
    v_cvt_pk_bf16_f32 v46, v68, v69
    s_nop 3
    v_add_f32 v16, v16, v18
    v_add_f32 v17, v17, v19
    v_cvt_pk_bf16_f32 v47, v16, v17
    buffer_store_dwordx4 v[44:47], v0, s[8:11], s38 offen offset:1024
    v_bfe_u32 v10, v0, 4, 4
    v_mov_b32 v11, 0x3f80
    v_mov_b32 v40, 0x3f800000
    v_cmp_eq_u32 vcc, 0, v10
    v_cmp_eq_u32 s[48:49], 1, v10
    s_nop 0
    v_cndmask_b32 v36, 0, v11, vcc
    v_cndmask_b32 v36, v36, v40, s[48:49]
    v_cmp_eq_u32 vcc, 2, v10
    v_cmp_eq_u32 s[48:49], 3, v10
    s_nop 0
    v_cndmask_b32 v37, 0, v11, vcc
    v_cndmask_b32 v37, v37, v40, s[48:49]
    v_cmp_eq_u32 vcc, 4, v10
    v_cmp_eq_u32 s[48:49], 5, v10
    s_nop 0
    v_cndmask_b32 v38, 0, v11, vcc
    v_cndmask_b32 v38, v38, v40, s[48:49]
    v_cmp_eq_u32 vcc, 6, v10
    v_cmp_eq_u32 s[48:49], 7, v10
    s_nop 0
    v_cndmask_b32 v39, 0, v11, vcc
    v_cndmask_b32 v39, v39, v40, s[48:49]
    s_sleep 5
    buffer_load_dwordx4 v[52:55], v6, s[8:11], s57 offen sc1
    buffer_load_dwordx4 v[56:59], v6, s[8:11], s58 offen sc1
    buffer_load_dwordx4 v[60:63], v6, s[8:11], s59 offen sc1
    buffer_load_dwordx4 v[64:67], v6, s[8:11], s60 offen sc1
    s_mov_b32 s16, 0
    s_mov_b64 s[70:71], 0
    s_mov_b64 s[72:73], 0
    s_mov_b64 s[74:75], 0
    s_mov_b64 s[76:77], 0
Lr0f_p1:
    s_mov_b64 exec, s[70:71]
    buffer_load_dwordx4 v[52:55], v6, s[8:11], s57 offen sc1
    s_mov_b64 exec, s[72:73]
    buffer_load_dwordx4 v[56:59], v6, s[8:11], s58 offen sc1
    s_mov_b64 exec, s[74:75]
    buffer_load_dwordx4 v[60:63], v6, s[8:11], s59 offen sc1
    s_mov_b64 exec, s[76:77]
    buffer_load_dwordx4 v[64:67], v6, s[8:11], s60 offen sc1
    s_mov_b64 exec, -1
    s_add_u32 s16, s16, 1
    s_cmp_gt_u32 s16, 100000
    s_cbranch_scc1 Lr_abort
    s_waitcnt vmcnt(7)
    v_and_b32 v11, 1, v52
    v_cmp_ne_u32 s[70:71], s39, v11
    v_mfma_f32_16x16x32_bf16 v[40:43], v[52:55], v[36:39], 0
    s_waitcnt vmcnt(6)
    v_and_b32 v11, 1, v56
    v_cmp_ne_u32 s[72:73], s39, v11
    v_mfma_f32_16x16x32_bf16 v[40:43], v[56:59], v[36:39], v[40:43]
    s_waitcnt vmcnt(5)
    v_and_b32 v11, 1, v60
    v_cmp_ne_u32 s[74:75], s39, v11
    v_mfma_f32_16x16x32_bf16 v[40:43], v[60:63], v[36:39], v[40:43]
    s_or_b64 vcc, s[70:71], s[72:73]
    s_waitcnt vmcnt(4)
    v_and_b32 v11, 1, v64
    v_cmp_ne_u32 s[76:77], s39, v11
    v_mfma_f32_16x16x32_bf16 v[40:43], v[64:67], v[36:39], v[40:43]
    s_or_b64 vcc, vcc, s[74:75]
    s_or_b64 vcc, vcc, s[76:77]
    s_cbranch_scc1 Lr0f_p1
    s_nop 4
    v_permlane16_swap_b32 v40, v42
    v_permlane16_swap_b32 v41, v43
    s_mov_b64 exec, s[50:51]
    v_add_f32 v40, v40, v42
    v_add_f32 v41, v41, v43
    v_cvt_pk_bf16_f32 v40, v40, v41
    v_min_u32 v40, s54, v40
    buffer_store_dword v40, v7, s[8:11], s36 offen
    v_mov_b32 v41, -1
    buffer_store_dword v41, v7, s[8:11], s37 offen
    s_mov_b64 exec, -1
    s_xor_b32 s34, s34, 16384
    s_xor_b32 s35, s35, 16384
    s_barrier
    s_sleep 2
    buffer_load_dwordx4 v[44:47], v0, s[8:11], s34 offen sc1
    buffer_load_dwordx4 v[48:51], v0, s[8:11], s34 offen offset:1024 sc1
    buffer_load_dword v10, v8, s[8:11], s35 offen sc1
    s_add_u32 s33, s33, 1
    s_bfe_u32 s39, s33, 0x10001
    s_xor_b32 s38, s38, 524288
    s_xor_b32 s57, s57, 524288
    s_xor_b32 s58, s58, 524288
    s_xor_b32 s59, s59, 524288
    s_xor_b32 s60, s60, 524288
    s_xor_b32 s36, s36, 16384
    s_xor_b32 s37, s37, 16384
    s_and_b32 s17, s33, 7
    s_mul_i32 s17, s17, 131072
    s_add_u32 s43, s45, s17
    s_bfe_u32 s66, s33, 65539
    s_add_u32 s67, s67, 22528
    s_add_u32 s42, s42, 262144
    s_add_u32 s41, s41, 262144
    s_add_u32 s40, s40, 262144
    s_add_u32 s44, s44, 22528
    s_waitcnt vmcnt(5)
    ds_read_b128 v[56:59], v9 offset:0
    ds_read_b128 v[60:63], v9 offset:1024
    ds_read_b128 v[64:67], v9 offset:2048
    ds_read_b128 v[68:71], v9 offset:3072
    v_mov_b64 v[12:13], 0
    v_mov_b64 v[14:15], 0
    v_mov_b64 v[16:17], 0
    v_mov_b64 v[18:19], 0
    v_mov_b64 v[20:21], 0
    v_mov_b64 v[22:23], 0
    v_mov_b64 v[24:25], 0
    v_mov_b64 v[26:27], 0
    v_mov_b64 v[28:29], 0
    v_mov_b64 v[30:31], 0
    v_mov_b64 v[32:33], 0
    v_mov_b64 v[34:35], 0
    s_waitcnt lgkmcnt(0)
    s_branch Lr0f_step
Lr0f_last:
    s_waitcnt vmcnt(0) lgkmcnt(0)
    s_branch Lr_exit
L_w1_1:
    s_cmp_lg_u32 s14, 1
    s_cbranch_scc1 L_w2_1
    s_barrier
    s_mov_b32 m0, 11264
    s_nop 0
    buffer_load_dwordx4 v0, s[8:11], s41 offen offset:0 lds
    buffer_load_dwordx4 v0, s[8:11], s41 offen offset:1024 lds
    s_add_u32 s41, s41, 262144
    s_waitcnt vmcnt(0)
    buffer_load_dwordx4 v[44:47], v0, s[8:11], s34 offen sc1
    buffer_load_dwordx4 v[48:51], v0, s[8:11], s34 offen offset:1024 sc1
    buffer_load_dword v10, v8, s[8:11], s35 offen sc1
    ds_read_b128 v[56:59], v9 offset:4096
    ds_read_b128 v[60:63], v9 offset:5120
    ds_read_b128 v[64:67], v9 offset:6144
    ds_read_b128 v[68:71], v9 offset:7168
    v_mov_b64 v[12:13], 0
    v_mov_b64 v[14:15], 0
    v_mov_b64 v[16:17], 0
    v_mov_b64 v[18:19], 0
    v_mov_b64 v[20:21], 0
    v_mov_b64 v[22:23], 0
    v_mov_b64 v[24:25], 0
    v_mov_b64 v[26:27], 0
    v_mov_b64 v[28:29], 0
    v_mov_b64 v[30:31], 0
    v_mov_b64 v[32:33], 0
    v_mov_b64 v[34:35], 0
    s_waitcnt lgkmcnt(0)
Lr1f_step:
    s_mov_b32 s16, 0
    s_mov_b64 s[70:71], 0
    s_mov_b64 s[72:73], 0
    s_mov_b64 s[74:75], 0
Lr1f_p2:
    s_mov_b64 exec, s[70:71]
    buffer_load_dwordx4 v[44:47], v0, s[8:11], s34 offen sc1
    s_mov_b64 exec, s[72:73]
    buffer_load_dwordx4 v[48:51], v0, s[8:11], s34 offen offset:1024 sc1
    s_mov_b64 exec, s[74:75]
    buffer_load_dword v10, v8, s[8:11], s35 offen sc1
    s_mov_b64 exec, -1
    s_add_u32 s16, s16, 1
    s_cmp_gt_u32 s16, 100000
    s_cbranch_scc1 Lr_abort
    s_waitcnt vmcnt(5)
    v_max3_u32 v11, v44, v45, v46
    v_max_u32 v11, v11, v47
    v_cmp_eq_u32 s[70:71], -1, v11
    s_waitcnt vmcnt(4)
    v_max3_u32 v11, v48, v49, v50
    v_max_u32 v11, v11, v51
    v_cmp_eq_u32 s[72:73], -1, v11
    s_waitcnt vmcnt(3)
    v_cmp_eq_u32 s[74:75], -1, v10
    s_or_b64 vcc, s[70:71], s[72:73]
    s_or_b64 vcc, vcc, s[74:75]
    s_cbranch_scc1 Lr1f_p2
    v_smfmac_f32_16x16x64_bf16 v[12:15], v[44:47], v[152:159], v1
    ds_write_b128 v0, v[44:47] offset:2048
    v_smfmac_f32_16x16x64_bf16 v[16:19], v[44:47], v[160:167], v1
    ds_write_b128 v0, v[48:51] offset:3072
    v_smfmac_f32_16x16x64_bf16 v[20:23], v[44:47], v[168:175], v1
    ds_write_b32 v8, v10 offset:8448
    v_smfmac_f32_16x16x64_bf16 v[24:27], v[44:47], v[56:63], v1
    s_waitcnt lgkmcnt(0)
    s_barrier
    ds_read_b128 v[52:55], v0 offset:0
    v_smfmac_f32_16x16x64_bf16 v[12:15], v[48:51], v[192:199], v1
    ds_read_b128 v[36:39], v0 offset:1024
    v_smfmac_f32_16x16x64_bf16 v[16:19], v[48:51], v[200:207], v1
    ds_read_b128 v[56:59], v9 offset:0
    v_smfmac_f32_16x16x64_bf16 v[20:23], v[48:51], v[208:215], v1
    ds_read_b128 v[60:63], v9 offset:1024
    v_smfmac_f32_16x16x64_bf16 v[24:27], v[48:51], v[64:71], v1
    ds_read_b128 v[40:43], v0 offset:4096
    s_waitcnt lgkmcnt(4)
    v_smfmac_f32_16x16x64_bf16 v[12:15], v[52:55], v[72:79], v1
    v_smfmac_f32_16x16x64_bf16 v[16:19], v[52:55], v[80:87], v1
    ds_read_b128 v[64:67], v9 offset:2048
    v_smfmac_f32_16x16x64_bf16 v[20:23], v[52:55], v[88:95], v1
    ds_read_b128 v[68:71], v9 offset:3072
    s_waitcnt lgkmcnt(3)
    v_smfmac_f32_16x16x64_bf16 v[24:27], v[52:55], v[56:63], v1
    v_smfmac_f32_16x16x64_bf16 v[12:15], v[36:39], v[112:119], v1
    ds_read_b128 v[52:55], v0 offset:5120
    v_smfmac_f32_16x16x64_bf16 v[16:19], v[36:39], v[120:127], v1
    ds_read_b128 v[56:59], v9 offset:8192
    v_smfmac_f32_16x16x64_bf16 v[20:23], v[36:39], v[128:135], v1
    ds_read_b128 v[60:63], v9 offset:9216
    s_waitcnt lgkmcnt(3)
    v_smfmac_f32_16x16x64_bf16 v[24:27], v[36:39], v[64:71], v1
    v_smfmac_f32_16x16x64_bf16 v[12:15], v[40:43], v[232:239], v1
    buffer_load_dwordx4 v[36:39], v0, s[8:11], s42 offen
    v_smfmac_f32_16x16x64_bf16 v[16:19], v[40:43], v[240:247], v1
    ds_read_b128 v[64:67], v9 offset:10240
    v_smfmac_f32_16x16x64_bf16 v[20:23], v[40:43], v[248:255], v1
    ds_read_b128 v[68:71], v9 offset:11264
    s_waitcnt lgkmcnt(2)
    v_smfmac_f32_16x16x64_bf16 v[24:27], v[40:43], v[56:63], v1
    s_waitcnt vmcnt(1)
    ds_read_b128 v[44:47], v0 offset:6144
    v_smfmac_f32_16x16x64_bf16 v[12:15], v[52:55], a[16:23], v1
    buffer_load_dwordx4 v[40:43], v0, s[8:11], s42 offen offset:1024
    v_smfmac_f32_16x16x64_bf16 v[16:19], v[52:55], a[24:31], v1
    ds_read_b128 v[56:59], v9 offset:12288
    v_smfmac_f32_16x16x64_bf16 v[20:23], v[52:55], a[32:39], v1
    ds_read_b128 v[60:63], v9 offset:13312
    s_waitcnt lgkmcnt(3)
    v_smfmac_f32_16x16x64_bf16 v[24:27], v[52:55], v[64:71], v1
    ds_read_b128 v[48:51], v0 offset:7168
    s_waitcnt lgkmcnt(3)
    v_smfmac_f32_16x16x64_bf16 v[12:15], v[44:47], a[56:63], v1
    ds_read_b128 v[52:55], v0 offset:8192
    v_smfmac_f32_16x16x64_bf16 v[16:19], v[44:47], a[64:71], v1
    ds_read_b128 v[64:67], v9 offset:14336
    v_smfmac_f32_16x16x64_bf16 v[20:23], v[44:47], a[72:79], v1
    ds_read_b128 v[68:71], v9 offset:15360
    s_waitcnt lgkmcnt(4)
    v_smfmac_f32_16x16x64_bf16 v[24:27], v[44:47], v[56:63], v1
    s_waitcnt lgkmcnt(3)
    v_smfmac_f32_16x16x64_bf16 v[12:15], v[48:51], a[96:103], v1
    v_smfmac_f32_16x16x64_bf16 v[16:19], v[48:51], a[104:111], v1
    ds_read_b128 v[56:59], v9 offset:16384
    s_waitcnt lgkmcnt(3)
    v_smfmac_f32_16x16x64_bf16 v[12:15], v[52:55], a[136:143], v1
    ds_read_b128 v[60:63], v9 offset:17408
    v_smfmac_f32_16x16x64_bf16 v[16:19], v[52:55], a[144:151], v1
    v_smfmac_f32_16x16x64_bf16 v[20:23], v[48:51], a[112:119], v1
    s_waitcnt lgkmcnt(2)
    v_smfmac_f32_16x16x64_bf16 v[24:27], v[48:51], v[64:71], v1
    ds_read_b128 v[64:67], v0 offset:9216
    s_nop 1
    v_add_f32 v12, v12, v14
    v_smfmac_f32_16x16x64_bf16 v[20:23], v[52:55], a[152:159], v1
    ds_read_b128 v[68:71], v0 offset:10240
    v_add_f32 v16, v16, v18
    s_waitcnt lgkmcnt(2)
    v_smfmac_f32_16x16x64_bf16 v[24:27], v[52:55], v[56:63], v1
    ds_read_b128 v[56:59], v0 offset:11264
    v_add_f32 v13, v13, v15
    v_add_f32 v17, v17, v19
    v_cvt_pk_bf16_f32 v14, v12, v16
    v_cvt_pk_bf16_f32 v15, v13, v17
    ds_write_b32 v2, v14 offset:17408
    ds_write_b32 v2, v15 offset:17696
    v_smfmac_f32_16x16x64_bf16 v[28:31], v[52:55], a[160:167], v1
    ds_read_b128 v[60:63], v0 offset:12288
    v_add_f32 v20, v20, v22
    v_add_f32 v24, v24, v26
    v_add_f32 v21, v21, v23
    v_add_f32 v25, v25, v27
    v_smfmac_f32_16x16x64_bf16 v[32:35], v[52:55], a[168:175], v1
    ds_read_b128 v[12:15], v0 offset:2048
    v_cvt_pk_bf16_f32 v22, v20, v24
    v_cvt_pk_bf16_f32 v23, v21, v25
    ds_write_b32 v2, v22 offset:19712
    ds_write_b32 v2, v23 offset:20000
    v_smfmac_f32_16x16x64_bf16 v[28:31], v[48:51], a[120:127], v1
    ds_read_b128 v[16:19], v0 offset:3072
    v_smfmac_f32_16x16x64_bf16 v[32:35], v[48:51], a[128:135], v1
    ds_read_b128 v[20:23], v0 offset:0
    v_smfmac_f32_16x16x64_bf16 v[28:31], v[44:47], a[80:87], v1
    ds_read_b128 v[24:27], v0 offset:1024
    v_smfmac_f32_16x16x64_bf16 v[32:35], v[44:47], a[88:95], v1
    s_waitcnt lgkmcnt(3)
    s_barrier
    ds_read_b128 v[44:47], v3 offset:17408
    v_smfmac_f32_16x16x64_bf16 v[28:31], v[12:15], v[176:183], v1
    ds_read_b128 v[52:55], v0 offset:4096
    v_smfmac_f32_16x16x64_bf16 v[32:35], v[12:15], v[184:191], v1
    ds_read_b128 v[12:15], v3 offset:19712
    s_waitcnt lgkmcnt(5)
    v_smfmac_f32_16x16x64_bf16 v[28:31], v[16:19], v[216:223], v1
    ds_read_b128 v[48:51], v0 offset:5120
    v_smfmac_f32_16x16x64_bf16 v[32:35], v[16:19], v[224:231], v1
    s_waitcnt lgkmcnt(5)
    v_smfmac_f32_16x16x64_bf16 v[28:31], v[20:23], v[96:103], v1
    v_smfmac_f32_16x16x64_bf16 v[32:35], v[20:23], v[104:111], v1
    ds_read_b128 v[20:23], v3 offset:17472
    s_waitcnt lgkmcnt(5)
    v_smfmac_f32_16x16x64_bf16 v[28:31], v[24:27], v[136:143], v1
    v_smfmac_f32_16x16x64_bf16 v[32:35], v[24:27], v[144:151], v1
    s_waitcnt lgkmcnt(3)
    v_smfmac_f32_16x16x64_bf16 v[28:31], v[52:55], a[0:7], v1
    v_smfmac_f32_16x16x64_bf16 v[32:35], v[52:55], a[8:15], v1
    ds_read_b128 v[52:55], v3 offset:19776
    s_waitcnt lgkmcnt(2)
    v_smfmac_f32_16x16x64_bf16 v[28:31], v[48:51], a[40:47], v1
    v_smfmac_f32_16x16x64_bf16 v[32:35], v[48:51], a[48:55], v1
    ds_read_b128 v[48:51], v3 offset:17536
    v_mfma_f32_16x16x32_bf16 v[24:27], v[12:15], v[44:47], 0
    v_mfma_f32_16x16x32_bf16 v[12:15], v[64:67], v[44:47], 0
    ds_read_b128 v[64:67], v0 offset:13312
    v_mfma_f32_16x16x32_bf16 v[16:19], v[68:71], v[44:47], 0
    ds_read_b128 v[68:71], v0 offset:14336
    s_waitcnt lgkmcnt(3)
    v_mfma_f32_16x16x32_bf16 v[24:27], v[52:55], v[20:23], v[24:27]
    ds_read_b128 v[44:47], v3 offset:19840
    v_add_f32 v28, v28, v30
    v_add_f32 v29, v29, v31
    v_mfma_f32_16x16x32_bf16 v[12:15], v[56:59], v[20:23], v[12:15]
    ds_read_b128 v[52:55], v3 offset:17600
    v_add_f32 v32, v32, v34
    v_add_f32 v33, v33, v35
    v_mfma_f32_16x16x32_bf16 v[16:19], v[60:63], v[20:23], v[16:19]
    ds_read_b128 v[56:59], v0 offset:15360
    v_cvt_pk_bf16_f32 v30, v28, v29
    v_cvt_pk_bf16_f32 v31, v32, v33
    s_waitcnt lgkmcnt(2)
    v_mfma_f32_16x16x32_bf16 v[24:27], v[44:47], v[48:51], v[24:27]
    ds_read_b128 v[20:23], v3 offset:19904
    v_lshrrev_b32 v10, 8, v0
    v_mul_u32_u24 v10, 288, v10
    v_mfma_f32_16x16x32_bf16 v[12:15], v[64:67], v[48:51], v[12:15]
    ds_read_b128 v[60:63], v0 offset:16384
    v_and_b32 v11, 0xf0, v0
    v_add_u32 v10, v10, v11
    v_mfma_f32_16x16x32_bf16 v[16:19], v[68:71], v[48:51], v[16:19]
    ds_read_b128 v[32:35], v10 offset:20288
    v_lshrrev_b32 v11, 1, v0
    v_bfi_b32 v30, 1, s66, v30
    s_waitcnt lgkmcnt(2)
    v_mfma_f32_16x16x32_bf16 v[24:27], v[20:23], v[52:55], v[24:27]
    buffer_store_dwordx2 v[30:31], v11, s[8:11], s43 offen offset:2048 sc1
    v_mov_b32 v49, 0
    v_mov_b32 v50, 0
    v_mfma_f32_16x16x32_bf16 v[12:15], v[56:59], v[52:55], v[12:15]
    v_mov_b64 v[64:65], s[68:69]
    v_mov_b64 v[66:67], s[68:69]
    s_waitcnt lgkmcnt(1)
    v_mfma_f32_16x16x32_bf16 v[16:19], v[60:63], v[52:55], v[16:19]
    s_waitcnt lgkmcnt(0)
    v_bfi_b32 v32, 1, s66, v32
    s_mov_b64 exec, s[52:53]
    buffer_store_dwordx4 v[32:35], v0, s[8:11], s43 offen sc1
    s_mov_b64 exec, -1
    v_max3_f32 v10, v24, v25, v12
    v_max3_f32 v10, v10, v13, v14
    s_nop 0
    v_max3_f32 v10, v10, v15, v16
    v_max3_f32 v10, v10, v17, v18
    v_max_f32 v10, v10, v19
    v_mov_b32 v11, v10
    s_nop 1
    v_permlane32_swap_b32 v10, v11
    v_max_f32 v10, v10, v11
    v_mov_b32 v11, v10
    s_nop 1
    v_permlane16_swap_b32 v10, v11
    v_max_f32 v10, v10, v11
    v_mul_f32 v20, s46, v10
    v_pk_fma_f32 v[24:25], v[24:25], s[46:47], v[20:21] op_sel_hi:[1,1,0] neg_lo:[0,0,1] neg_hi:[0,0,1]
    v_pk_fma_f32 v[12:13], v[12:13], s[46:47], v[20:21] op_sel_hi:[1,1,0] neg_lo:[0,0,1] neg_hi:[0,0,1]
    v_exp_f32 v24, v24
    v_exp_f32 v25, v25
    v_pk_fma_f32 v[14:15], v[14:15], s[46:47], v[20:21] op_sel_hi:[1,1,0] neg_lo:[0,0,1] neg_hi:[0,0,1]
    v_exp_f32 v12, v12
    v_exp_f32 v13, v13
    v_pk_fma_f32 v[16:17], v[16:17], s[46:47], v[20:21] op_sel_hi:[1,1,0] neg_lo:[0,0,1] neg_hi:[0,0,1]
    v_cvt_pk_bf16_f32 v48, v24, v25
    v_exp_f32 v14, v14
    v_pk_fma_f32 v[18:19], v[18:19], s[46:47], v[20:21] op_sel_hi:[1,1,0] neg_lo:[0,0,1] neg_hi:[0,0,1]
    v_cvt_pk_bf16_f32 v51, v24, v25
    v_exp_f32 v15, v15
    v_cvt_pk_bf16_f32 v44, v12, v13
    v_exp_f32 v16, v16
    v_exp_f32 v17, v17
    v_cvt_pk_bf16_f32 v45, v14, v15
    v_exp_f32 v18, v18
    v_exp_f32 v19, v19
    v_cvt_pk_bf16_f32 v46, v16, v17
    v_cvt_pk_bf16_f32 v47, v18, v19
    v_mfma_f32_16x16x16_bf16 v[68:71], v[64:65], v[48:49], 0
    v_mfma_f32_16x16x16_bf16 v[52:55], v[30:31], v[48:49], 0
    v_mfma_f32_16x16x16_bf16 v[56:59], v[30:31], v[50:51], 0
    v_mfma_f32_16x16x32_bf16 v[68:71], v[64:67], v[44:47], v[68:71]
    s_waitcnt vmcnt(3)
    v_mfma_f32_16x16x32_bf16 v[52:55], v[36:39], v[44:47], v[52:55]
    s_waitcnt vmcnt(2)
    v_mfma_f32_16x16x32_bf16 v[56:59], v[40:43], v[44:47], v[56:59]
    ds_read_b128 v[36:39], v0 offset:38912
    ds_read_b128 v[40:43], v0 offset:39936
    ds_read_b128 v[60:63], v9 offset:24576
    s_nop 0
    v_rcp_f32 v10, v68
    s_nop 0
    v_pk_mul_f32 v[52:53], v[52:53], v[10:11] op_sel_hi:[1,0]
    s_nop 0
    v_pk_mul_f32 v[56:57], v[56:57], v[10:11] op_sel_hi:[1,0]
    v_cvt_pk_bf16_f32 v16, v52, v56
    v_cvt_pk_bf16_f32 v17, v53, v57
    v_pk_mul_f32 v[54:55], v[54:55], v[10:11] op_sel_hi:[1,0]
    v_pk_mul_f32 v[58:59], v[58:59], v[10:11] op_sel_hi:[1,0]
    v_cvt_pk_bf16_f32 v18, v54, v58
    v_cvt_pk_bf16_f32 v19, v55, v59
    ds_write_b128 v3, v[16:19] offset:22080
    ds_read_b128 v[64:67], v9 offset:25600
    v_mov_b64 v[12:13], 0
    v_mov_b64 v[14:15], 0
    v_mov_b64 v[20:21], 0
    v_mov_b64 v[22:23], 0
    v_mov_b64 v[24:25], 0
    v_mov_b64 v[26:27], 0
    v_mov_b64 v[32:33], 0
    v_mov_b64 v[34:35], 0
    v_mov_b64 v[44:45], 0
    v_mov_b64 v[46:47], 0
    v_mov_b64 v[48:49], 0
    v_mov_b64 v[50:51], 0
    s_waitcnt lgkmcnt(1)
    s_barrier
    ds_read_b128 v[52:55], v4 offset:22016
    ds_read_b128 v[56:59], v4 offset:22144
    v_mov_b64 v[68:69], 0
    v_mov_b64 v[70:71], 0
    v_mov_b64 v[28:29], 0
    v_mov_b64 v[30:31], 0
    v_mov_b64 v[16:17], 0
    v_mov_b64 v[18:19], 0
    s_cmp_eq_u32 s33, 63
    s_cbranch_scc1 Lr1f_last
    s_waitcnt lgkmcnt(1)
    v_smfmac_f32_16x16x64_bf16 v[28:31], v[52:55], v[60:67], v1
    ds_read_b128 v[60:63], v0 offset:32768
    s_waitcnt lgkmcnt(1)
    v_smfmac_f32_16x16x64_bf16 v[28:31], v[56:59], v[36:43], v1
    ds_read_b128 v[64:67], v0 offset:33792
    ds_read_b128 v[36:39], v9 offset:18432
    v_smfmac_f32_16x16x64_bf16 v[12:15], v[52:55], a[176:183], v1
    ds_read_b128 v[40:43], v9 offset:19456
    v_smfmac_f32_16x16x64_bf16 v[12:15], v[56:59], a[184:191], v1
    buffer_load_dwordx4 v0, s[8:11], s41 offen offset:0 lds
    v_smfmac_f32_16x16x64_bf16 v[20:23], v[52:55], a[192:199], v1
    s_nop 0
    v_add_f32 v28, v28, v30
    v_add_f32 v29, v29, v31
    s_waitcnt lgkmcnt(2)
    v_smfmac_f32_16x16x64_bf16 v[20:23], v[56:59], v[60:67], v1
    ds_read_b128 v[60:63], v9 offset:20480
    v_cvt_pk_bf16_f32 v28, v28, v29
    v_bfi_b32 v28, 1, s39, v28
    buffer_store_dword v28, v8, s[8:11], s38 offen offset:2048
    s_waitcnt lgkmcnt(1)
    v_smfmac_f32_16x16x64_bf16 v[24:27], v[52:55], v[36:43], v1
    ds_read_b128 v[64:67], v9 offset:21504
    ds_read_b128 v[36:39], v0 offset:34816
    v_add_f32 v12, v12, v14
    v_add_f32 v13, v13, v15
    v_smfmac_f32_16x16x64_bf16 v[24:27], v[56:59], a[200:207], v1
    ds_read_b128 v[40:43], v0 offset:35840
    v_cvt_pk_bf16_f32 v12, v12, v13
    v_bfi_b32 v12, 1, s39, v12
    v_smfmac_f32_16x16x64_bf16 v[32:35], v[52:55], a[208:215], v1
    buffer_load_dwordx4 v0, s[8:11], s41 offen offset:1024 lds
    v_add_f32 v20, v20, v22
    v_add_f32 v21, v21, v23
    v_smfmac_f32_16x16x64_bf16 v[32:35], v[56:59], a[216:223], v1
    v_cvt_pk_bf16_f32 v13, v20, v21
    s_waitcnt lgkmcnt(2)
    v_smfmac_f32_16x16x64_bf16 v[44:47], v[52:55], v[60:67], v1
    ds_read_b128 v[60:63], v0 offset:36864
    v_add_f32 v24, v24, v26
    v_add_f32 v25, v25, v27
    s_waitcnt lgkmcnt(1)
    v_smfmac_f32_16x16x64_bf16 v[44:47], v[56:59], v[36:43], v1
    ds_read_b128 v[64:67], v0 offset:37888
    ds_read_b128 v[36:39], v9 offset:22528
    v_cvt_pk_bf16_f32 v14, v24, v25
    v_smfmac_f32_16x16x64_bf16 v[48:51], v[52:55], a[224:231], v1
    ds_read_b128 v[40:43], v9 offset:23552
    v_add_f32 v32, v32, v34
    v_add_f32 v33, v33, v35
    v_smfmac_f32_16x16x64_bf16 v[48:51], v[56:59], a[232:239], v1
    v_cvt_pk_bf16_f32 v15, v32, v33
    buffer_store_dwordx4 v[12:15], v0, s[8:11], s38 offen offset:0
    v_smfmac_f32_16x16x64_bf16 v[68:71], v[52:55], a[240:247], v1
    v_add_f32 v44, v44, v46
    v_add_f32 v45, v45, v47
    s_waitcnt lgkmcnt(2)
    v_smfmac_f32_16x16x64_bf16 v[68:71], v[56:59], v[60:67], v1
    v_cvt_pk_bf16_f32 v44, v44, v45
    v_bfi_b32 v44, 1, s39, v44
    s_waitcnt lgkmcnt(0)
    v_smfmac_f32_16x16x64_bf16 v[16:19], v[52:55], v[36:43], v1
    v_add_f32 v48, v48, v50
    v_add_f32 v49, v49, v51
    v_smfmac_f32_16x16x64_bf16 v[16:19], v[56:59], a[248:255], v1
    v_cvt_pk_bf16_f32 v45, v48, v49
    v_add_f32 v68, v68, v70
    v_add_f32 v69, v69, v71
    v_cvt_pk_bf16_f32 v46, v68, v69
    s_nop 3
    v_add_f32 v16, v16, v18
    v_add_f32 v17, v17, v19
    v_cvt_pk_bf16_f32 v47, v16, v17
    buffer_store_dwordx4 v[44:47], v0, s[8:11], s38 offen offset:1024
    v_bfe_u32 v10, v0, 4, 4
    v_mov_b32 v11, 0x3f80
    v_mov_b32 v40, 0x3f800000
    v_cmp_eq_u32 vcc, 0, v10
    v_cmp_eq_u32 s[48:49], 1, v10
    s_nop 0
    v_cndmask_b32 v36, 0, v11, vcc
    v_cndmask_b32 v36, v36, v40, s[48:49]
    v_cmp_eq_u32 vcc, 2, v10
    v_cmp_eq_u32 s[48:49], 3, v10
    s_nop 0
    v_cndmask_b32 v37, 0, v11, vcc
    v_cndmask_b32 v37, v37, v40, s[48:49]
    v_cmp_eq_u32 vcc, 4, v10
    v_cmp_eq_u32 s[48:49], 5, v10
    s_nop 0
    v_cndmask_b32 v38, 0, v11, vcc
    v_cndmask_b32 v38, v38, v40, s[48:49]
    v_cmp_eq_u32 vcc, 6, v10
    v_cmp_eq_u32 s[48:49], 7, v10
    s_nop 0
    v_cndmask_b32 v39, 0, v11, vcc
    v_cndmask_b32 v39, v39, v40, s[48:49]
    s_sleep 5
    buffer_load_dwordx4 v[52:55], v6, s[8:11], s57 offen sc1
    buffer_load_dwordx4 v[56:59], v6, s[8:11], s58 offen sc1
    buffer_load_dwordx4 v[60:63], v6, s[8:11], s59 offen sc1
    buffer_load_dwordx4 v[64:67], v6, s[8:11], s60 offen sc1
    s_mov_b32 s16, 0
    s_mov_b64 s[70:71], 0
    s_mov_b64 s[72:73], 0
    s_mov_b64 s[74:75], 0
    s_mov_b64 s[76:77], 0
Lr1f_p1:
    s_mov_b64 exec, s[70:71]
    buffer_load_dwordx4 v[52:55], v6, s[8:11], s57 offen sc1
    s_mov_b64 exec, s[72:73]
    buffer_load_dwordx4 v[56:59], v6, s[8:11], s58 offen sc1
    s_mov_b64 exec, s[74:75]
    buffer_load_dwordx4 v[60:63], v6, s[8:11], s59 offen sc1
    s_mov_b64 exec, s[76:77]
    buffer_load_dwordx4 v[64:67], v6, s[8:11], s60 offen sc1
    s_mov_b64 exec, -1
    s_add_u32 s16, s16, 1
    s_cmp_gt_u32 s16, 100000
    s_cbranch_scc1 Lr_abort
    s_waitcnt vmcnt(7)
    v_and_b32 v11, 1, v52
    v_cmp_ne_u32 s[70:71], s39, v11
    v_mfma_f32_16x16x32_bf16 v[40:43], v[52:55], v[36:39], 0
    s_waitcnt vmcnt(6)
    v_and_b32 v11, 1, v56
    v_cmp_ne_u32 s[72:73], s39, v11
    v_mfma_f32_16x16x32_bf16 v[40:43], v[56:59], v[36:39], v[40:43]
    s_waitcnt vmcnt(5)
    v_and_b32 v11, 1, v60
    v_cmp_ne_u32 s[74:75], s39, v11
    v_mfma_f32_16x16x32_bf16 v[40:43], v[60:63], v[36:39], v[40:43]
    s_or_b64 vcc, s[70:71], s[72:73]
    s_waitcnt vmcnt(4)
    v_and_b32 v11, 1, v64
    v_cmp_ne_u32 s[76:77], s39, v11
    v_mfma_f32_16x16x32_bf16 v[40:43], v[64:67], v[36:39], v[40:43]
    s_or_b64 vcc, vcc, s[74:75]
    s_or_b64 vcc, vcc, s[76:77]
    s_cbranch_scc1 Lr1f_p1
    s_nop 4
    v_permlane16_swap_b32 v40, v42
    v_permlane16_swap_b32 v41, v43
    s_mov_b64 exec, s[50:51]
    v_add_f32 v40, v40, v42
    v_add_f32 v41, v41, v43
    v_cvt_pk_bf16_f32 v40, v40, v41
    v_min_u32 v40, s54, v40
    buffer_store_dword v40, v7, s[8:11], s36 offen
    v_mov_b32 v41, -1
    buffer_store_dword v41, v7, s[8:11], s37 offen
    s_mov_b64 exec, -1
    s_xor_b32 s34, s34, 16384
    s_xor_b32 s35, s35, 16384
    s_barrier
    s_sleep 2
    buffer_load_dwordx4 v[44:47], v0, s[8:11], s34 offen sc1
    buffer_load_dwordx4 v[48:51], v0, s[8:11], s34 offen offset:1024 sc1
    buffer_load_dword v10, v8, s[8:11], s35 offen sc1
    s_add_u32 s33, s33, 1
    s_bfe_u32 s39, s33, 0x10001
    s_xor_b32 s38, s38, 524288
    s_xor_b32 s57, s57, 524288
    s_xor_b32 s58, s58, 524288
    s_xor_b32 s59, s59, 524288
    s_xor_b32 s60, s60, 524288
    s_xor_b32 s36, s36, 16384
    s_xor_b32 s37, s37, 16384
    s_and_b32 s17, s33, 7
    s_mul_i32 s17, s17, 131072
    s_add_u32 s43, s45, s17
    s_bfe_u32 s66, s33, 65539
    s_add_u32 s67, s67, 22528
    s_add_u32 s42, s42, 262144
    s_add_u32 s41, s41, 262144
    s_add_u32 s40, s40, 262144
    s_add_u32 s44, s44, 22528
    s_waitcnt vmcnt(5)
    ds_read_b128 v[56:59], v9 offset:4096
    ds_read_b128 v[60:63], v9 offset:5120
    ds_read_b128 v[64:67], v9 offset:6144
    ds_read_b128 v[68:71], v9 offset:7168
    v_mov_b64 v[12:13], 0
    v_mov_b64 v[14:15], 0
    v_mov_b64 v[16:17], 0
    v_mov_b64 v[18:19], 0
    v_mov_b64 v[20:21], 0
    v_mov_b64 v[22:23], 0
    v_mov_b64 v[24:25], 0
    v_mov_b64 v[26:27], 0
    v_mov_b64 v[28:29], 0
    v_mov_b64 v[30:31], 0
    v_mov_b64 v[32:33], 0
    v_mov_b64 v[34:35], 0
    s_waitcnt lgkmcnt(0)
    s_branch Lr1f_step
Lr1f_last:
    s_waitcnt vmcnt(0) lgkmcnt(0)
    s_branch Lr_exit
L_w2_1:
    s_cmp_lg_u32 s14, 2
    s_cbranch_scc1 L_w3_1
    s_barrier
    s_mov_b32 m0, 13312
    s_nop 0
    buffer_load_dwordx4 v0, s[8:11], s41 offen offset:0 lds
    buffer_load_dwordx4 v0, s[8:11], s41 offen offset:1024 lds
    s_add_u32 s41, s41, 262144
    s_waitcnt vmcnt(0)
    buffer_load_dwordx4 v[44:47], v0, s[8:11], s34 offen sc1
    buffer_load_dwordx4 v[48:51], v0, s[8:11], s34 offen offset:1024 sc1
    buffer_load_dword v10, v8, s[8:11], s35 offen sc1
    ds_read_b128 v[56:59], v9 offset:8192
    ds_read_b128 v[60:63], v9 offset:9216
    ds_read_b128 v[64:67], v9 offset:10240
    ds_read_b128 v[68:71], v9 offset:11264
    v_mov_b64 v[12:13], 0
    v_mov_b64 v[14:15], 0
    v_mov_b64 v[16:17], 0
    v_mov_b64 v[18:19], 0
    v_mov_b64 v[20:21], 0
    v_mov_b64 v[22:23], 0
    v_mov_b64 v[24:25], 0
    v_mov_b64 v[26:27], 0
    v_mov_b64 v[28:29], 0
    v_mov_b64 v[30:31], 0
    v_mov_b64 v[32:33], 0
    v_mov_b64 v[34:35], 0
    s_waitcnt lgkmcnt(0)
Lr2f_step:
    s_mov_b32 s16, 0
    s_mov_b64 s[70:71], 0
    s_mov_b64 s[72:73], 0
    s_mov_b64 s[74:75], 0
Lr2f_p2:
    s_mov_b64 exec, s[70:71]
    buffer_load_dwordx4 v[44:47], v0, s[8:11], s34 offen sc1
    s_mov_b64 exec, s[72:73]
    buffer_load_dwordx4 v[48:51], v0, s[8:11], s34 offen offset:1024 sc1
    s_mov_b64 exec, s[74:75]
    buffer_load_dword v10, v8, s[8:11], s35 offen sc1
    s_mov_b64 exec, -1
    s_add_u32 s16, s16, 1
    s_cmp_gt_u32 s16, 100000
    s_cbranch_scc1 Lr_abort
    s_waitcnt vmcnt(5)
    v_max3_u32 v11, v44, v45, v46
    v_max_u32 v11, v11, v47
    v_cmp_eq_u32 s[70:71], -1, v11
    s_waitcnt vmcnt(4)
    v_max3_u32 v11, v48, v49, v50
    v_max_u32 v11, v11, v51
    v_cmp_eq_u32 s[72:73], -1, v11
    s_waitcnt vmcnt(3)
    v_cmp_eq_u32 s[74:75], -1, v10
    s_or_b64 vcc, s[70:71], s[72:73]
    s_or_b64 vcc, vcc, s[74:75]
    s_cbranch_scc1 Lr2f_p2
    v_smfmac_f32_16x16x64_bf16 v[12:15], v[44:47], v[232:239], v1
    ds_write_b128 v0, v[44:47] offset:4096
    v_smfmac_f32_16x16x64_bf16 v[16:19], v[44:47], v[240:247], v1
    ds_write_b128 v0, v[48:51] offset:5120
    v_smfmac_f32_16x16x64_bf16 v[20:23], v[44:47], v[248:255], v1
    ds_write_b32 v8, v10 offset:8704
    v_smfmac_f32_16x16x64_bf16 v[24:27], v[44:47], v[56:63], v1
    s_waitcnt lgkmcnt(0)
    s_barrier
    ds_read_b128 v[52:55], v0 offset:0
    v_smfmac_f32_16x16x64_bf16 v[12:15], v[48:51], a[16:23], v1
    ds_read_b128 v[36:39], v0 offset:1024
    v_smfmac_f32_16x16x64_bf16 v[16:19], v[48:51], a[24:31], v1
    ds_read_b128 v[56:59], v9 offset:0
    v_smfmac_f32_16x16x64_bf16 v[20:23], v[48:51], a[32:39], v1
    ds_read_b128 v[60:63], v9 offset:1024
    v_smfmac_f32_16x16x64_bf16 v[24:27], v[48:51], v[64:71], v1
    ds_read_b128 v[40:43], v0 offset:2048
    s_waitcnt lgkmcnt(4)
    v_smfmac_f32_16x16x64_bf16 v[12:15], v[52:55], v[72:79], v1
    v_smfmac_f32_16x16x64_bf16 v[16:19], v[52:55], v[80:87], v1
    ds_read_b128 v[64:67], v9 offset:2048
    v_smfmac_f32_16x16x64_bf16 v[20:23], v[52:55], v[88:95], v1
    ds_read_b128 v[68:71], v9 offset:3072
    s_waitcnt lgkmcnt(3)
    v_smfmac_f32_16x16x64_bf16 v[24:27], v[52:55], v[56:63], v1
    v_smfmac_f32_16x16x64_bf16 v[12:15], v[36:39], v[112:119], v1
    ds_read_b128 v[52:55], v0 offset:3072
    v_smfmac_f32_16x16x64_bf16 v[16:19], v[36:39], v[120:127], v1
    ds_read_b128 v[56:59], v9 offset:4096
    v_smfmac_f32_16x16x64_bf16 v[20:23], v[36:39], v[128:135], v1
    ds_read_b128 v[60:63], v9 offset:5120
    s_waitcnt lgkmcnt(3)
    v_smfmac_f32_16x16x64_bf16 v[24:27], v[36:39], v[64:71], v1
    v_smfmac_f32_16x16x64_bf16 v[12:15], v[40:43], v[152:159], v1
    buffer_load_dwordx4 v[36:39], v0, s[8:11], s42 offen
    v_smfmac_f32_16x16x64_bf16 v[16:19], v[40:43], v[160:167], v1
    ds_read_b128 v[64:67], v9 offset:6144
    v_smfmac_f32_16x16x64_bf16 v[20:23], v[40:43], v[168:175], v1
    ds_read_b128 v[68:71], v9 offset:7168
    s_waitcnt lgkmcnt(2)
    v_smfmac_f32_16x16x64_bf16 v[24:27], v[40:43], v[56:63], v1
    s_waitcnt vmcnt(1)
    ds_read_b128 v[44:47], v0 offset:6144
    v_smfmac_f32_16x16x64_bf16 v[12:15], v[52:55], v[192:199], v1
    buffer_load_dwordx4 v[40:43], v0, s[8:11], s42 offen offset:1024
    v_smfmac_f32_16x16x64_bf16 v[16:19], v[52:55], v[200:207], v1
    ds_read_b128 v[56:59], v9 offset:12288
    v_smfmac_f32_16x16x64_bf16 v[20:23], v[52:55], v[208:215], v1
    ds_read_b128 v[60:63], v9 offset:13312
    s_waitcnt lgkmcnt(3)
    v_smfmac_f32_16x16x64_bf16 v[24:27], v[52:55], v[64:71], v1
    ds_read_b128 v[48:51], v0 offset:7168
    s_waitcnt lgkmcnt(3)
    v_smfmac_f32_16x16x64_bf16 v[12:15], v[44:47], a[56:63], v1
    ds_read_b128 v[52:55], v0 offset:8192
    v_smfmac_f32_16x16x64_bf16 v[16:19], v[44:47], a[64:71], v1
    ds_read_b128 v[64:67], v9 offset:14336
    v_smfmac_f32_16x16x64_bf16 v[20:23], v[44:47], a[72:79], v1
    ds_read_b128 v[68:71], v9 offset:15360
    s_waitcnt lgkmcnt(4)
    v_smfmac_f32_16x16x64_bf16 v[24:27], v[44:47], v[56:63], v1
    s_waitcnt lgkmcnt(3)
    v_smfmac_f32_16x16x64_bf16 v[12:15], v[48:51], a[96:103], v1
    v_smfmac_f32_16x16x64_bf16 v[16:19], v[48:51], a[104:111], v1
    ds_read_b128 v[56:59], v9 offset:16384
    s_waitcnt lgkmcnt(3)
    v_smfmac_f32_16x16x64_bf16 v[12:15], v[52:55], a[136:143], v1
    ds_read_b128 v[60:63], v9 offset:17408
    v_smfmac_f32_16x16x64_bf16 v[16:19], v[52:55], a[144:151], v1
    v_smfmac_f32_16x16x64_bf16 v[20:23], v[48:51], a[112:119], v1
    s_waitcnt lgkmcnt(2)
    v_smfmac_f32_16x16x64_bf16 v[24:27], v[48:51], v[64:71], v1
    ds_read_b128 v[64:67], v0 offset:9216
    s_nop 1
    v_add_f32 v12, v12, v14
    v_smfmac_f32_16x16x64_bf16 v[20:23], v[52:55], a[152:159], v1
    ds_read_b128 v[68:71], v0 offset:10240
    v_add_f32 v16, v16, v18
    s_waitcnt lgkmcnt(2)
    v_smfmac_f32_16x16x64_bf16 v[24:27], v[52:55], v[56:63], v1
    ds_read_b128 v[56:59], v0 offset:11264
    v_add_f32 v13, v13, v15
    v_add_f32 v17, v17, v19
    v_cvt_pk_bf16_f32 v14, v12, v16
    v_cvt_pk_bf16_f32 v15, v13, v17
    ds_write_b32 v2, v14 offset:17408
    ds_write_b32 v2, v15 offset:17696
    v_smfmac_f32_16x16x64_bf16 v[28:31], v[52:55], a[160:167], v1
    ds_read_b128 v[60:63], v0 offset:12288
    v_add_f32 v20, v20, v22
    v_add_f32 v24, v24, v26
    v_add_f32 v21, v21, v23
    v_add_f32 v25, v25, v27
    v_smfmac_f32_16x16x64_bf16 v[32:35], v[52:55], a[168:175], v1
    ds_read_b128 v[12:15], v0 offset:4096
    v_cvt_pk_bf16_f32 v22, v20, v24
    v_cvt_pk_bf16_f32 v23, v21, v25
    ds_write_b32 v2, v22 offset:19712
    ds_write_b32 v2, v23 offset:20000
    v_smfmac_f32_16x16x64_bf16 v[28:31], v[48:51], a[120:127], v1
    ds_read_b128 v[16:19], v0 offset:5120
    v_smfmac_f32_16x16x64_bf16 v[32:35], v[48:51], a[128:135], v1
    ds_read_b128 v[20:23], v0 offset:0
    v_smfmac_f32_16x16x64_bf16 v[28:31], v[44:47], a[80:87], v1
    ds_read_b128 v[24:27], v0 offset:1024
    v_smfmac_f32_16x16x64_bf16 v[32:35], v[44:47], a[88:95], v1
    s_waitcnt lgkmcnt(3)
    s_barrier
    ds_read_b128 v[44:47], v3 offset:17408
    v_smfmac_f32_16x16x64_bf16 v[28:31], v[12:15], a[0:7], v1
    ds_read_b128 v[52:55], v0 offset:2048
    v_smfmac_f32_16x16x64_bf16 v[32:35], v[12:15], a[8:15], v1
    ds_read_b128 v[12:15], v3 offset:19712
    s_waitcnt lgkmcnt(5)
    v_smfmac_f32_16x16x64_bf16 v[28:31], v[16:19], a[40:47], v1
    ds_read_b128 v[48:51], v0 offset:3072
    v_smfmac_f32_16x16x64_bf16 v[32:35], v[16:19], a[48:55], v1
    s_waitcnt lgkmcnt(5)
    v_smfmac_f32_16x16x64_bf16 v[28:31], v[20:23], v[96:103], v1
    v_smfmac_f32_16x16x64_bf16 v[32:35], v[20:23], v[104:111], v1
    ds_read_b128 v[20:23], v3 offset:17472
    s_waitcnt lgkmcnt(5)
    v_smfmac_f32_16x16x64_bf16 v[28:31], v[24:27], v[136:143], v1
    v_smfmac_f32_16x16x64_bf16 v[32:35], v[24:27], v[144:151], v1
    s_waitcnt lgkmcnt(3)
    v_smfmac_f32_16x16x64_bf16 v[28:31], v[52:55], v[176:183], v1
    v_smfmac_f32_16x16x64_bf16 v[32:35], v[52:55], v[184:191], v1
    ds_read_b128 v[52:55], v3 offset:19776
    s_waitcnt lgkmcnt(2)
    v_smfmac_f32_16x16x64_bf16 v[28:31], v[48:51], v[216:223], v1
    v_smfmac_f32_16x16x64_bf16 v[32:35], v[48:51], v[224:231], v1
    ds_read_b128 v[48:51], v3 offset:17536
    v_mfma_f32_16x16x32_bf16 v[24:27], v[12:15], v[44:47], 0
    v_mfma_f32_16x16x32_bf16 v[12:15], v[64:67], v[44:47], 0
    ds_read_b128 v[64:67], v0 offset:13312
    v_mfma_f32_16x16x32_bf16 v[16:19], v[68:71], v[44:47], 0
    ds_read_b128 v[68:71], v0 offset:14336
    s_waitcnt lgkmcnt(3)
    v_mfma_f32_16x16x32_bf16 v[24:27], v[52:55], v[20:23], v[24:27]
    ds_read_b128 v[44:47], v3 offset:19840
    v_add_f32 v28, v28, v30
    v_add_f32 v29, v29, v31
    v_mfma_f32_16x16x32_bf16 v[12:15], v[56:59], v[20:23], v[12:15]
    ds_read_b128 v[52:55], v3 offset:17600
    v_add_f32 v32, v32, v34
    v_add_f32 v33, v33, v35
    v_mfma_f32_16x16x32_bf16 v[16:19], v[60:63], v[20:23], v[16:19]
    ds_read_b128 v[56:59], v0 offset:15360
    v_cvt_pk_bf16_f32 v30, v28, v29
    v_cvt_pk_bf16_f32 v31, v32, v33
    s_waitcnt lgkmcnt(2)
    v_mfma_f32_16x16x32_bf16 v[24:27], v[44:47], v[48:51], v[24:27]
    ds_read_b128 v[20:23], v3 offset:19904
    v_lshrrev_b32 v10, 8, v0
    v_mul_u32_u24 v10, 288, v10
    v_mfma_f32_16x16x32_bf16 v[12:15], v[64:67], v[48:51], v[12:15]
    ds_read_b128 v[60:63], v0 offset:16384
    v_and_b32 v11, 0xf0, v0
    v_add_u32 v10, v10, v11
    v_mfma_f32_16x16x32_bf16 v[16:19], v[68:71], v[48:51], v[16:19]
    ds_read_b128 v[32:35], v10 offset:20864
    v_lshrrev_b32 v11, 1, v0
    v_bfi_b32 v30, 1, s66, v30
    s_waitcnt lgkmcnt(2)
    v_mfma_f32_16x16x32_bf16 v[24:27], v[20:23], v[52:55], v[24:27]
    buffer_store_dwordx2 v[30:31], v11, s[8:11], s43 offen offset:2048 sc1
    v_mov_b32 v49, 0
    v_mov_b32 v50, 0
    v_mfma_f32_16x16x32_bf16 v[12:15], v[56:59], v[52:55], v[12:15]
    v_mov_b64 v[64:65], s[68:69]
    v_mov_b64 v[66:67], s[68:69]
    s_waitcnt lgkmcnt(1)
    v_mfma_f32_16x16x32_bf16 v[16:19], v[60:63], v[52:55], v[16:19]
    s_waitcnt lgkmcnt(0)
    v_bfi_b32 v32, 1, s66, v32
    s_mov_b64 exec, s[52:53]
    buffer_store_dwordx4 v[32:35], v0, s[8:11], s43 offen sc1
    s_mov_b64 exec, -1
    v_max3_f32 v10, v24, v25, v12
    v_max3_f32 v10, v10, v13, v14
    s_nop 0
    v_max3_f32 v10, v10, v15, v16
    v_max3_f32 v10, v10, v17, v18
    v_max_f32 v10, v10, v19
    v_mov_b32 v11, v10
    s_nop 1
    v_permlane32_swap_b32 v10, v11
    v_max_f32 v10, v10, v11
    v_mov_b32 v11, v10
    s_nop 1
    v_permlane16_swap_b32 v10, v11
    v_max_f32 v10, v10, v11
    v_mul_f32 v20, s46, v10
    v_pk_fma_f32 v[24:25], v[24:25], s[46:47], v[20:21] op_sel_hi:[1,1,0] neg_lo:[0,0,1] neg_hi:[0,0,1]
    v_pk_fma_f32 v[12:13], v[12:13], s[46:47], v[20:21] op_sel_hi:[1,1,0] neg_lo:[0,0,1] neg_hi:[0,0,1]
    v_exp_f32 v24, v24
    v_exp_f32 v25, v25
    v_pk_fma_f32 v[14:15], v[14:15], s[46:47], v[20:21] op_sel_hi:[1,1,0] neg_lo:[0,0,1] neg_hi:[0,0,1]
    v_exp_f32 v12, v12
    v_exp_f32 v13, v13
    v_pk_fma_f32 v[16:17], v[16:17], s[46:47], v[20:21] op_sel_hi:[1,1,0] neg_lo:[0,0,1] neg_hi:[0,0,1]
    v_cvt_pk_bf16_f32 v48, v24, v25
    v_exp_f32 v14, v14
    v_pk_fma_f32 v[18:19], v[18:19], s[46:47], v[20:21] op_sel_hi:[1,1,0] neg_lo:[0,0,1] neg_hi:[0,0,1]
    v_cvt_pk_bf16_f32 v51, v24, v25
    v_exp_f32 v15, v15
    v_cvt_pk_bf16_f32 v44, v12, v13
    v_exp_f32 v16, v16
    v_exp_f32 v17, v17
    v_cvt_pk_bf16_f32 v45, v14, v15
    v_exp_f32 v18, v18
    v_exp_f32 v19, v19
    v_cvt_pk_bf16_f32 v46, v16, v17
    v_cvt_pk_bf16_f32 v47, v18, v19
    v_mfma_f32_16x16x16_bf16 v[68:71], v[64:65], v[48:49], 0
    v_mfma_f32_16x16x16_bf16 v[52:55], v[30:31], v[48:49], 0
    v_mfma_f32_16x16x16_bf16 v[56:59], v[30:31], v[50:51], 0
    v_mfma_f32_16x16x32_bf16 v[68:71], v[64:67], v[44:47], v[68:71]
    s_waitcnt vmcnt(3)
    v_mfma_f32_16x16x32_bf16 v[52:55], v[36:39], v[44:47], v[52:55]
    s_waitcnt vmcnt(2)
    v_mfma_f32_16x16x32_bf16 v[56:59], v[40:43], v[44:47], v[56:59]
    ds_read_b128 v[36:39], v0 offset:47104
    ds_read_b128 v[40:43], v0 offset:48128
    ds_read_b128 v[60:63], v9 offset:24576
    s_nop 0
    v_rcp_f32 v10, v68
    s_nop 0
    v_pk_mul_f32 v[52:53], v[52:53], v[10:11] op_sel_hi:[1,0]
    s_nop 0
    v_pk_mul_f32 v[56:57], v[56:57], v[10:11] op_sel_hi:[1,0]
    v_cvt_pk_bf16_f32 v16, v52, v56
    v_cvt_pk_bf16_f32 v17, v53, v57
    v_pk_mul_f32 v[54:55], v[54:55], v[10:11] op_sel_hi:[1,0]
    v_pk_mul_f32 v[58:59], v[58:59], v[10:11] op_sel_hi:[1,0]
    v_cvt_pk_bf16_f32 v18, v54, v58
    v_cvt_pk_bf16_f32 v19, v55, v59
    ds_write_b128 v3, v[16:19] offset:22144
    ds_read_b128 v[64:67], v9 offset:25600
    v_mov_b64 v[12:13], 0
    v_mov_b64 v[14:15], 0
    v_mov_b64 v[20:21], 0
    v_mov_b64 v[22:23], 0
    v_mov_b64 v[24:25], 0
    v_mov_b64 v[26:27], 0
    v_mov_b64 v[32:33], 0
    v_mov_b64 v[34:35], 0
    v_mov_b64 v[44:45], 0
    v_mov_b64 v[46:47], 0
    v_mov_b64 v[48:49], 0
    v_mov_b64 v[50:51], 0
    s_waitcnt lgkmcnt(1)
    s_barrier
    ds_read_b128 v[52:55], v4 offset:22016
    ds_read_b128 v[56:59], v4 offset:22144
    v_mov_b64 v[68:69], 0
    v_mov_b64 v[70:71], 0
    v_mov_b64 v[28:29], 0
    v_mov_b64 v[30:31], 0
    v_mov_b64 v[16:17], 0
    v_mov_b64 v[18:19], 0
    s_cmp_eq_u32 s33, 63
    s_cbranch_scc1 Lr2f_last
    s_waitcnt lgkmcnt(1)
    v_smfmac_f32_16x16x64_bf16 v[28:31], v[52:55], v[60:67], v1
    ds_read_b128 v[60:63], v0 offset:40960
    s_waitcnt lgkmcnt(1)
    v_smfmac_f32_16x16x64_bf16 v[28:31], v[56:59], v[36:43], v1
    ds_read_b128 v[64:67], v0 offset:41984
    ds_read_b128 v[36:39], v9 offset:18432
    v_smfmac_f32_16x16x64_bf16 v[12:15], v[52:55], a[176:183], v1
    ds_read_b128 v[40:43], v9 offset:19456
    v_smfmac_f32_16x16x64_bf16 v[12:15], v[56:59], a[184:191], v1
    buffer_load_dwordx4 v0, s[8:11], s41 offen offset:0 lds
    v_smfmac_f32_16x16x64_bf16 v[20:23], v[52:55], a[192:199], v1
    s_nop 0
    v_add_f32 v28, v28, v30
    v_add_f32 v29, v29, v31
    s_waitcnt lgkmcnt(2)
    v_smfmac_f32_16x16x64_bf16 v[20:23], v[56:59], v[60:67], v1
    ds_read_b128 v[60:63], v9 offset:20480
    v_cvt_pk_bf16_f32 v28, v28, v29
    v_bfi_b32 v28, 1, s39, v28
    buffer_store_dword v28, v8, s[8:11], s38 offen offset:2048
    s_waitcnt lgkmcnt(1)
    v_smfmac_f32_16x16x64_bf16 v[24:27], v[52:55], v[36:43], v1
    ds_read_b128 v[64:67], v9 offset:21504
    ds_read_b128 v[36:39], v0 offset:43008
    v_add_f32 v12, v12, v14
    v_add_f32 v13, v13, v15
    v_smfmac_f32_16x16x64_bf16 v[24:27], v[56:59], a[200:207], v1
    ds_read_b128 v[40:43], v0 offset:44032
    v_cvt_pk_bf16_f32 v12, v12, v13
    v_bfi_b32 v12, 1, s39, v12
    v_smfmac_f32_16x16x64_bf16 v[32:35], v[52:55], a[208:215], v1
    buffer_load_dwordx4 v0, s[8:11], s41 offen offset:1024 lds
    v_add_f32 v20, v20, v22
    v_add_f32 v21, v21, v23
    v_smfmac_f32_16x16x64_bf16 v[32:35], v[56:59], a[216:223], v1
    v_cvt_pk_bf16_f32 v13, v20, v21
    s_waitcnt lgkmcnt(2)
    v_smfmac_f32_16x16x64_bf16 v[44:47], v[52:55], v[60:67], v1
    ds_read_b128 v[60:63], v0 offset:45056
    v_add_f32 v24, v24, v26
    v_add_f32 v25, v25, v27
    s_waitcnt lgkmcnt(1)
    v_smfmac_f32_16x16x64_bf16 v[44:47], v[56:59], v[36:43], v1
    ds_read_b128 v[64:67], v0 offset:46080
    ds_read_b128 v[36:39], v9 offset:22528
    v_cvt_pk_bf16_f32 v14, v24, v25
    v_smfmac_f32_16x16x64_bf16 v[48:51], v[52:55], a[224:231], v1
    ds_read_b128 v[40:43], v9 offset:23552
    v_add_f32 v32, v32, v34
    v_add_f32 v33, v33, v35
    v_smfmac_f32_16x16x64_bf16 v[48:51], v[56:59], a[232:239], v1
    v_cvt_pk_bf16_f32 v15, v32, v33
    buffer_store_dwordx4 v[12:15], v0, s[8:11], s38 offen offset:0
    v_smfmac_f32_16x16x64_bf16 v[68:71], v[52:55], a[240:247], v1
    v_add_f32 v44, v44, v46
    v_add_f32 v45, v45, v47
    s_waitcnt lgkmcnt(2)
    v_smfmac_f32_16x16x64_bf16 v[68:71], v[56:59], v[60:67], v1
    v_cvt_pk_bf16_f32 v44, v44, v45
    v_bfi_b32 v44, 1, s39, v44
    s_waitcnt lgkmcnt(0)
    v_smfmac_f32_16x16x64_bf16 v[16:19], v[52:55], v[36:43], v1
    v_add_f32 v48, v48, v50
    v_add_f32 v49, v49, v51
    v_smfmac_f32_16x16x64_bf16 v[16:19], v[56:59], a[248:255], v1
    v_cvt_pk_bf16_f32 v45, v48, v49
    v_add_f32 v68, v68, v70
    v_add_f32 v69, v69, v71
    v_cvt_pk_bf16_f32 v46, v68, v69
    s_nop 3
    v_add_f32 v16, v16, v18
    v_add_f32 v17, v17, v19
    v_cvt_pk_bf16_f32 v47, v16, v17
    buffer_store_dwordx4 v[44:47], v0, s[8:11], s38 offen offset:1024
    s_cmp_eq_u32 s62, 0
    s_cbranch_scc1 Lr2f_nojob
    v_bfe_u32 v10, v0, 4, 4
    v_mov_b32 v11, 0x3f80
    v_mov_b32 v40, 0x3f800000
    v_cmp_eq_u32 vcc, 0, v10
    v_cmp_eq_u32 s[48:49], 1, v10
    s_nop 0
    v_cndmask_b32 v36, 0, v11, vcc
    v_cndmask_b32 v36, v36, v40, s[48:49]
    v_cmp_eq_u32 vcc, 2, v10
    v_cmp_eq_u32 s[48:49], 3, v10
    s_nop 0
    v_cndmask_b32 v37, 0, v11, vcc
    v_cndmask_b32 v37, v37, v40, s[48:49]
    v_cmp_eq_u32 vcc, 4, v10
    v_cmp_eq_u32 s[48:49], 5, v10
    s_nop 0
    v_cndmask_b32 v38, 0, v11, vcc
    v_cndmask_b32 v38, v38, v40, s[48:49]
    v_cmp_eq_u32 vcc, 6, v10
    v_cmp_eq_u32 s[48:49], 7, v10
    s_nop 0
    v_cndmask_b32 v39, 0, v11, vcc
    v_cndmask_b32 v39, v39, v40, s[48:49]
    s_sleep 5
    buffer_load_dwordx4 v[52:55], v6, s[8:11], s57 offen sc1
    buffer_load_dwordx4 v[56:59], v6, s[8:11], s58 offen sc1
    buffer_load_dwordx4 v[60:63], v6, s[8:11], s59 offen sc1
    buffer_load_dwordx4 v[64:67], v6, s[8:11], s60 offen sc1
    s_mov_b32 s16, 0
    s_mov_b64 s[70:71], 0
    s_mov_b64 s[72:73], 0
    s_mov_b64 s[74:75], 0
    s_mov_b64 s[76:77], 0
Lr2f_p1:
    s_mov_b64 exec, s[70:71]
    buffer_load_dwordx4 v[52:55], v6, s[8:11], s57 offen sc1
    s_mov_b64 exec, s[72:73]
    buffer_load_dwordx4 v[56:59], v6, s[8:11], s58 offen sc1
    s_mov_b64 exec, s[74:75]
    buffer_load_dwordx4 v[60:63], v6, s[8:11], s59 offen sc1
    s_mov_b64 exec, s[76:77]
    buffer_load_dwordx4 v[64:67], v6, s[8:11], s60 offen sc1
    s_mov_b64 exec, -1
    s_add_u32 s16, s16, 1
    s_cmp_gt_u32 s16, 100000
    s_cbranch_scc1 Lr_abort
    s_waitcnt vmcnt(7)
    v_xor_b32 v10, v52, v53
    v_xor_b32 v11, v54, v55
    v_or_b32 v10, v10, v11
    v_xor_b32 v11, v52, v54
    v_or_b32 v10, v10, v11
    v_xor_b32 v11, s39, v52
    v_or_b32 v10, v10, v11
    v_and_b32 v10, 1, v10
    v_cmp_ne_u32 s[70:71], 0, v10
    v_mfma_f32_16x16x32_bf16 v[40:43], v[52:55], v[36:39], 0
    s_waitcnt vmcnt(6)
    v_xor_b32 v10, v56, v57
    v_xor_b32 v11, v58, v59
    v_or_b32 v10, v10, v11
    v_xor_b32 v11, v56, v58
    v_or_b32 v10, v10, v11
    v_xor_b32 v11, s39, v56
    v_or_b32 v10, v10, v11
    v_and_b32 v10, 1, v10
    v_cmp_ne_u32 s[72:73], 0, v10
    v_mfma_f32_16x16x32_bf16 v[40:43], v[56:59], v[36:39], v[40:43]
    s_waitcnt vmcnt(5)
    v_xor_b32 v10, v60, v61
    v_xor_b32 v11, v62, v63
    v_or_b32 v10, v10, v11
    v_xor_b32 v11, v60, v62
    v_or_b32 v10, v10, v11
    v_xor_b32 v11, s39, v60
    v_or_b32 v10, v10, v11
    v_and_b32 v10, 1, v10
    v_cmp_ne_u32 s[74:75], 0, v10
    v_mfma_f32_16x16x32_bf16 v[40:43], v[60:63], v[36:39], v[40:43]
    s_or_b64 vcc, s[70:71], s[72:73]
    s_waitcnt vmcnt(4)
    v_xor_b32 v10, v64, v65
    v_xor_b32 v11, v66, v67
    v_or_b32 v10, v10, v11
    v_xor_b32 v11, v64, v66
    v_or_b32 v10, v10, v11
    v_xor_b32 v11, s39, v64
    v_or_b32 v10, v10, v11
    v_and_b32 v10, 1, v10
    v_cmp_ne_u32 s[76:77], 0, v10
    v_mfma_f32_16x16x32_bf16 v[40:43], v[64:67], v[36:39], v[40:43]
    s_or_b64 vcc, vcc, s[74:75]
    s_or_b64 vcc, vcc, s[76:77]
    s_cbranch_scc1 Lr2f_p1
    s_nop 4
    v_permlane16_swap_b32 v40, v42
    v_permlane16_swap_b32 v41, v43
    s_mov_b64 exec, s[50:51]
    v_add_f32 v40, v40, v42
    v_add_f32 v41, v41, v43
    v_cvt_pk_bf16_f32 v40, v40, v41
    v_min_u32 v40, s54, v40
    buffer_store_dword v40, v7, s[8:11], s36 offen
    v_mov_b32 v41, -1
    buffer_store_dword v41, v7, s[8:11], s37 offen
    s_mov_b64 exec, -1
    s_branch Lr2f_jobdone
Lr2f_nojob:
Lr2f_jobdone:
    s_xor_b32 s34, s34, 16384
    s_xor_b32 s35, s35, 16384
    s_barrier
    s_sleep 2
    buffer_load_dwordx4 v[44:47], v0, s[8:11], s34 offen sc1
    buffer_load_dwordx4 v[48:51], v0, s[8:11], s34 offen offset:1024 sc1
    buffer_load_dword v10, v8, s[8:11], s35 offen sc1
    s_add_u32 s33, s33, 1
    s_bfe_u32 s39, s33, 0x10001
    s_xor_b32 s38, s38, 524288
    s_xor_b32 s57, s57, 524288
    s_xor_b32 s58, s58, 524288
    s_xor_b32 s59, s59, 524288
    s_xor_b32 s60, s60, 524288
    s_xor_b32 s36, s36, 16384
    s_xor_b32 s37, s37, 16384
    s_and_b32 s17, s33, 7
    s_mul_i32 s17, s17, 131072
    s_add_u32 s43, s45, s17
    s_bfe_u32 s66, s33, 65539
    s_add_u32 s67, s67, 22528
    s_add_u32 s42, s42, 262144
    s_add_u32 s41, s41, 262144
    s_add_u32 s40, s40, 262144
    s_add_u32 s44, s44, 22528
    s_waitcnt vmcnt(6)
    ds_read_b128 v[56:59], v9 offset:8192
    ds_read_b128 v[60:63], v9 offset:9216
    ds_read_b128 v[64:67], v9 offset:10240
    ds_read_b128 v[68:71], v9 offset:11264
    v_mov_b64 v[12:13], 0
    v_mov_b64 v[14:15], 0
    v_mov_b64 v[16:17], 0
    v_mov_b64 v[18:19], 0
    v_mov_b64 v[20:21], 0
    v_mov_b64 v[22:23], 0
    v_mov_b64 v[24:25], 0
    v_mov_b64 v[26:27], 0
    v_mov_b64 v[28:29], 0
    v_mov_b64 v[30:31], 0
    v_mov_b64 v[32:33], 0
    v_mov_b64 v[34:35], 0
    s_waitcnt lgkmcnt(0)
    s_branch Lr2f_step
Lr2f_last:
    s_waitcnt vmcnt(0) lgkmcnt(0)
    s_branch Lr_exit
L_w3_1:
    s_mov_b32 s16, 0
    s_add_u32 s17, s44, 128
    v_and_b32 v11, 16, v8
    v_lshlrev_b32 v11, 3, v11
    v_and_or_b32 v11, v8, 12, v11
Lr3f_fw_10:
    buffer_load_dword v10, v11, s[8:11], s17 offen sc1
    s_add_u32 s16, s16, 1
    s_cmp_gt_u32 s16, 100000
    s_cbranch_scc1 Lr_abort
    s_waitcnt vmcnt(0)
    v_cmp_eq_u32 vcc, 0, v10
    s_nop 0
    s_cbranch_vccz Lr3f_fw_10d
    s_sleep 4
    s_branch Lr3f_fw_10
Lr3f_fw_10d:
    s_barrier
    s_mov_b32 m0, 15360
    s_nop 0
    buffer_load_dwordx4 v0, s[8:11], s41 offen offset:0 lds
    buffer_load_dwordx4 v0, s[8:11], s41 offen offset:1024 lds
    s_add_u32 s41, s41, 262144
    s_waitcnt vmcnt(0)
    buffer_load_dwordx4 v[44:47], v0, s[8:11], s34 offen sc1
    buffer_load_dwordx4 v[48:51], v0, s[8:11], s34 offen offset:1024 sc1
    buffer_load_dword v10, v8, s[8:11], s35 offen sc1
    ds_read_b128 v[56:59], v9 offset:12288
    ds_read_b128 v[60:63], v9 offset:13312
    ds_read_b128 v[64:67], v9 offset:14336
    ds_read_b128 v[68:71], v9 offset:15360
    v_mov_b64 v[12:13], 0
    v_mov_b64 v[14:15], 0
    v_mov_b64 v[16:17], 0
    v_mov_b64 v[18:19], 0
    v_mov_b64 v[20:21], 0
    v_mov_b64 v[22:23], 0
    v_mov_b64 v[24:25], 0
    v_mov_b64 v[26:27], 0
    v_mov_b64 v[28:29], 0
    v_mov_b64 v[30:31], 0
    v_mov_b64 v[32:33], 0
    v_mov_b64 v[34:35], 0
    s_waitcnt lgkmcnt(0)
Lr3f_step:
    s_mov_b32 s16, 0
    s_mov_b64 s[70:71], 0
    s_mov_b64 s[72:73], 0
    s_mov_b64 s[74:75], 0
Lr3f_p2:
    s_mov_b64 exec, s[70:71]
    buffer_load_dwordx4 v[44:47], v0, s[8:11], s34 offen sc1
    s_mov_b64 exec, s[72:73]
    buffer_load_dwordx4 v[48:51], v0, s[8:11], s34 offen offset:1024 sc1
    s_mov_b64 exec, s[74:75]
    buffer_load_dword v10, v8, s[8:11], s35 offen sc1
    s_mov_b64 exec, -1
    s_add_u32 s16, s16, 1
    s_cmp_gt_u32 s16, 100000
    s_cbranch_scc1 Lr_abort
    s_waitcnt vmcnt(5)
    v_max3_u32 v11, v44, v45, v46
    v_max_u32 v11, v11, v47
    v_cmp_eq_u32 s[70:71], -1, v11
    s_waitcnt vmcnt(4)
    v_max3_u32 v11, v48, v49, v50
    v_max_u32 v11, v11, v51
    v_cmp_eq_u32 s[72:73], -1, v11
    s_waitcnt vmcnt(3)
    v_cmp_eq_u32 s[74:75], -1, v10
    s_or_b64 vcc, s[70:71], s[72:73]
    s_or_b64 vcc, vcc, s[74:75]
    s_cbranch_scc1 Lr3f_p2
    v_smfmac_f32_16x16x64_bf16 v[12:15], v[44:47], a[56:63], v1
    ds_write_b128 v0, v[44:47] offset:6144
    v_smfmac_f32_16x16x64_bf16 v[16:19], v[44:47], a[64:71], v1
    ds_write_b128 v0, v[48:51] offset:7168
    v_smfmac_f32_16x16x64_bf16 v[20:23], v[44:47], a[72:79], v1
    ds_write_b32 v8, v10 offset:8960
    v_smfmac_f32_16x16x64_bf16 v[24:27], v[44:47], v[56:63], v1
    s_waitcnt lgkmcnt(0)
    s_barrier
    ds_read_b128 v[52:55], v0 offset:0
    v_smfmac_f32_16x16x64_bf16 v[12:15], v[48:51], a[96:103], v1
    ds_read_b128 v[36:39], v0 offset:1024
    v_smfmac_f32_16x16x64_bf16 v[16:19], v[48:51], a[104:111], v1
    ds_read_b128 v[56:59], v9 offset:0
    v_smfmac_f32_16x16x64_bf16 v[20:23], v[48:51], a[112:119], v1
    ds_read_b128 v[60:63], v9 offset:1024
    v_smfmac_f32_16x16x64_bf16 v[24:27], v[48:51], v[64:71], v1
    ds_read_b128 v[40:43], v0 offset:2048
    s_waitcnt lgkmcnt(4)
    v_smfmac_f32_16x16x64_bf16 v[12:15], v[52:55], v[72:79], v1
    buffer_load_dword v6, v7, s[8:11], s67 offen sc1
    v_smfmac_f32_16x16x64_bf16 v[16:19], v[52:55], v[80:87], v1
    ds_read_b128 v[64:67], v9 offset:2048
    v_smfmac_f32_16x16x64_bf16 v[20:23], v[52:55], v[88:95], v1
    ds_read_b128 v[68:71], v9 offset:3072
    s_waitcnt lgkmcnt(3)
    v_smfmac_f32_16x16x64_bf16 v[24:27], v[52:55], v[56:63], v1
    v_smfmac_f32_16x16x64_bf16 v[12:15], v[36:39], v[112:119], v1
    ds_read_b128 v[52:55], v0 offset:3072
    v_smfmac_f32_16x16x64_bf16 v[16:19], v[36:39], v[120:127], v1
    ds_read_b128 v[56:59], v9 offset:4096
    v_smfmac_f32_16x16x64_bf16 v[20:23], v[36:39], v[128:135], v1
    ds_read_b128 v[60:63], v9 offset:5120
    s_waitcnt lgkmcnt(3)
    v_smfmac_f32_16x16x64_bf16 v[24:27], v[36:39], v[64:71], v1
    v_smfmac_f32_16x16x64_bf16 v[12:15], v[40:43], v[152:159], v1
    buffer_load_dwordx4 v[36:39], v0, s[8:11], s42 offen
    v_smfmac_f32_16x16x64_bf16 v[16:19], v[40:43], v[160:167], v1
    ds_read_b128 v[64:67], v9 offset:6144
    v_smfmac_f32_16x16x64_bf16 v[20:23], v[40:43], v[168:175], v1
    ds_read_b128 v[68:71], v9 offset:7168
    s_waitcnt lgkmcnt(2)
    v_smfmac_f32_16x16x64_bf16 v[24:27], v[40:43], v[56:63], v1
    s_waitcnt vmcnt(2)
    ds_read_b128 v[44:47], v0 offset:4096
    v_smfmac_f32_16x16x64_bf16 v[12:15], v[52:55], v[192:199], v1
    buffer_load_dwordx4 v[40:43], v0, s[8:11], s42 offen offset:1024
    v_smfmac_f32_16x16x64_bf16 v[16:19], v[52:55], v[200:207], v1
    ds_read_b128 v[56:59], v9 offset:8192
    v_smfmac_f32_16x16x64_bf16 v[20:23], v[52:55], v[208:215], v1
    ds_read_b128 v[60:63], v9 offset:9216
    s_waitcnt lgkmcnt(3)
    v_smfmac_f32_16x16x64_bf16 v[24:27], v[52:55], v[64:71], v1
    ds_read_b128 v[48:51], v0 offset:5120
    s_waitcnt lgkmcnt(3)
    v_smfmac_f32_16x16x64_bf16 v[12:15], v[44:47], v[232:239], v1
    ds_read_b128 v[52:55], v0 offset:8192
    v_smfmac_f32_16x16x64_bf16 v[16:19], v[44:47], v[240:247], v1
    ds_read_b128 v[64:67], v9 offset:10240
    v_smfmac_f32_16x16x64_bf16 v[20:23], v[44:47], v[248:255], v1
    ds_read_b128 v[68:71], v9 offset:11264
    s_waitcnt lgkmcnt(4)
    v_smfmac_f32_16x16x64_bf16 v[24:27], v[44:47], v[56:63], v1
    s_waitcnt lgkmcnt(3)
    v_smfmac_f32_16x16x64_bf16 v[12:15], v[48:51], a[16:23], v1
    v_smfmac_f32_16x16x64_bf16 v[16:19], v[48:51], a[24:31], v1
    ds_read_b128 v[56:59], v9 offset:16384
    s_waitcnt lgkmcnt(3)
    v_smfmac_f32_16x16x64_bf16 v[12:15], v[52:55], a[136:143], v1
    ds_read_b128 v[60:63], v9 offset:17408
    v_smfmac_f32_16x16x64_bf16 v[16:19], v[52:55], a[144:151], v1
    v_smfmac_f32_16x16x64_bf16 v[20:23], v[48:51], a[32:39], v1
    s_waitcnt lgkmcnt(2)
    v_smfmac_f32_16x16x64_bf16 v[24:27], v[48:51], v[64:71], v1
    ds_read_b128 v[64:67], v0 offset:9216
    s_nop 1
    v_add_f32 v12, v12, v14
    v_smfmac_f32_16x16x64_bf16 v[20:23], v[52:55], a[152:159], v1
    ds_read_b128 v[68:71], v0 offset:10240
    v_add_f32 v16, v16, v18
    s_waitcnt lgkmcnt(2)
    v_smfmac_f32_16x16x64_bf16 v[24:27], v[52:55], v[56:63], v1
    ds_read_b128 v[56:59], v0 offset:11264
    v_add_f32 v13, v13, v15
    v_add_f32 v17, v17, v19
    v_cvt_pk_bf16_f32 v14, v12, v16
    v_cvt_pk_bf16_f32 v15, v13, v17
    ds_write_b32 v2, v14 offset:17408
    ds_write_b32 v2, v15 offset:17696
    v_smfmac_f32_16x16x64_bf16 v[28:31], v[52:55], a[160:167], v1
    ds_read_b128 v[60:63], v0 offset:12288
    v_add_f32 v20, v20, v22
    v_add_f32 v24, v24, v26
    v_add_f32 v21, v21, v23
    v_add_f32 v25, v25, v27
    v_smfmac_f32_16x16x64_bf16 v[32:35], v[52:55], a[168:175], v1
    ds_read_b128 v[12:15], v0 offset:6144
    v_cvt_pk_bf16_f32 v22, v20, v24
    v_cvt_pk_bf16_f32 v23, v21, v25
    ds_write_b32 v2, v22 offset:19712
    ds_write_b32 v2, v23 offset:20000
    v_smfmac_f32_16x16x64_bf16 v[28:31], v[48:51], a[40:47], v1
    ds_read_b128 v[16:19], v0 offset:7168
    v_smfmac_f32_16x16x64_bf16 v[32:35], v[48:51], a[48:55], v1
    ds_read_b128 v[20:23], v0 offset:0
    v_smfmac_f32_16x16x64_bf16 v[28:31], v[44:47], a[0:7], v1
    ds_read_b128 v[24:27], v0 offset:1024
    v_smfmac_f32_16x16x64_bf16 v[32:35], v[44:47], a[8:15], v1
    s_waitcnt lgkmcnt(3)
    s_barrier
    ds_read_b128 v[44:47], v3 offset:17408
    v_smfmac_f32_16x16x64_bf16 v[28:31], v[12:15], a[80:87], v1
    ds_read_b128 v[52:55], v0 offset:2048
    v_smfmac_f32_16x16x64_bf16 v[32:35], v[12:15], a[88:95], v1
    ds_read_b128 v[12:15], v3 offset:19712
    s_waitcnt lgkmcnt(5)
    v_smfmac_f32_16x16x64_bf16 v[28:31], v[16:19], a[120:127], v1
    ds_read_b128 v[48:51], v0 offset:3072
    v_smfmac_f32_16x16x64_bf16 v[32:35], v[16:19], a[128:135], v1
    s_waitcnt lgkmcnt(5)
    v_smfmac_f32_16x16x64_bf16 v[28:31], v[20:23], v[96:103], v1
    v_smfmac_f32_16x16x64_bf16 v[32:35], v[20:23], v[104:111], v1
    ds_read_b128 v[20:23], v3 offset:17472
    s_waitcnt lgkmcnt(5)
    v_smfmac_f32_16x16x64_bf16 v[28:31], v[24:27], v[136:143], v1
    v_smfmac_f32_16x16x64_bf16 v[32:35], v[24:27], v[144:151], v1
    s_waitcnt lgkmcnt(3)
    v_smfmac_f32_16x16x64_bf16 v[28:31], v[52:55], v[176:183], v1
    v_smfmac_f32_16x16x64_bf16 v[32:35], v[52:55], v[184:191], v1
    ds_read_b128 v[52:55], v3 offset:19776
    s_waitcnt lgkmcnt(2)
    v_smfmac_f32_16x16x64_bf16 v[28:31], v[48:51], v[216:223], v1
    v_smfmac_f32_16x16x64_bf16 v[32:35], v[48:51], v[224:231], v1
    ds_read_b128 v[48:51], v3 offset:17536
    v_mfma_f32_16x16x32_bf16 v[24:27], v[12:15], v[44:47], 0
    s_waitcnt vmcnt(2)
    v_cmp_eq_u32 vcc, 0, v6
    s_nop 0
    s_and_b64 vcc, vcc, s[78:79]
    s_cbranch_scc1 Lr3f_flbad
Lr3f_flok:
    buffer_load_dword v6, v5, s[8:11], s40 offen
    buffer_load_dword v6, v5, s[8:11], s56 offen
    v_mfma_f32_16x16x32_bf16 v[12:15], v[64:67], v[44:47], 0
    ds_read_b128 v[64:67], v0 offset:13312
    v_mfma_f32_16x16x32_bf16 v[16:19], v[68:71], v[44:47], 0
    ds_read_b128 v[68:71], v0 offset:14336
    s_waitcnt lgkmcnt(3)
    v_mfma_f32_16x16x32_bf16 v[24:27], v[52:55], v[20:23], v[24:27]
    ds_read_b128 v[44:47], v3 offset:19840
    v_add_f32 v28, v28, v30
    v_add_f32 v29, v29, v31
    v_mfma_f32_16x16x32_bf16 v[12:15], v[56:59], v[20:23], v[12:15]
    ds_read_b128 v[52:55], v3 offset:17600
    v_add_f32 v32, v32, v34
    v_add_f32 v33, v33, v35
    v_mfma_f32_16x16x32_bf16 v[16:19], v[60:63], v[20:23], v[16:19]
    ds_read_b128 v[56:59], v0 offset:15360
    v_cvt_pk_bf16_f32 v30, v28, v29
    v_cvt_pk_bf16_f32 v31, v32, v33
    s_waitcnt lgkmcnt(2)
    v_mfma_f32_16x16x32_bf16 v[24:27], v[44:47], v[48:51], v[24:27]
    ds_read_b128 v[20:23], v3 offset:19904
    v_lshrrev_b32 v10, 8, v0
    v_mul_u32_u24 v10, 288, v10
    v_mfma_f32_16x16x32_bf16 v[12:15], v[64:67], v[48:51], v[12:15]
    ds_read_b128 v[60:63], v0 offset:16384
    v_and_b32 v11, 0xf0, v0
    v_add_u32 v10, v10, v11
    v_mfma_f32_16x16x32_bf16 v[16:19], v[68:71], v[48:51], v[16:19]
    ds_read_b128 v[32:35], v10 offset:21440
    v_lshrrev_b32 v11, 1, v0
    v_bfi_b32 v30, 1, s66, v30
    s_waitcnt lgkmcnt(2)
    v_mfma_f32_16x16x32_bf16 v[24:27], v[20:23], v[52:55], v[24:27]
    buffer_store_dwordx2 v[30:31], v11, s[8:11], s43 offen offset:2048 sc1
    v_mov_b32 v49, 0
    v_mov_b32 v50, 0
    v_mfma_f32_16x16x32_bf16 v[12:15], v[56:59], v[52:55], v[12:15]
    v_mov_b64 v[64:65], s[68:69]
    v_mov_b64 v[66:67], s[68:69]
    s_waitcnt lgkmcnt(1)
    v_mfma_f32_16x16x32_bf16 v[16:19], v[60:63], v[52:55], v[16:19]
    s_waitcnt lgkmcnt(0)
    v_bfi_b32 v32, 1, s66, v32
    s_mov_b64 exec, s[52:53]
    buffer_store_dwordx4 v[32:35], v0, s[8:11], s43 offen sc1
    s_mov_b64 exec, -1
    v_max3_f32 v10, v24, v25, v12
    v_max3_f32 v10, v10, v13, v14
    s_nop 0
    v_max3_f32 v10, v10, v15, v16
    v_max3_f32 v10, v10, v17, v18
    v_max_f32 v10, v10, v19
    v_mov_b32 v11, v10
    s_nop 1
    v_permlane32_swap_b32 v10, v11
    v_max_f32 v10, v10, v11
    v_mov_b32 v11, v10
    s_nop 1
    v_permlane16_swap_b32 v10, v11
    v_max_f32 v10, v10, v11
    v_mul_f32 v20, s46, v10
    v_pk_fma_f32 v[24:25], v[24:25], s[46:47], v[20:21] op_sel_hi:[1,1,0] neg_lo:[0,0,1] neg_hi:[0,0,1]
    v_pk_fma_f32 v[12:13], v[12:13], s[46:47], v[20:21] op_sel_hi:[1,1,0] neg_lo:[0,0,1] neg_hi:[0,0,1]
    v_exp_f32 v24, v24
    v_exp_f32 v25, v25
    v_pk_fma_f32 v[14:15], v[14:15], s[46:47], v[20:21] op_sel_hi:[1,1,0] neg_lo:[0,0,1] neg_hi:[0,0,1]
    v_exp_f32 v12, v12
    v_exp_f32 v13, v13
    v_pk_fma_f32 v[16:17], v[16:17], s[46:47], v[20:21] op_sel_hi:[1,1,0] neg_lo:[0,0,1] neg_hi:[0,0,1]
    v_cvt_pk_bf16_f32 v48, v24, v25
    v_exp_f32 v14, v14
    v_pk_fma_f32 v[18:19], v[18:19], s[46:47], v[20:21] op_sel_hi:[1,1,0] neg_lo:[0,0,1] neg_hi:[0,0,1]
    v_cvt_pk_bf16_f32 v51, v24, v25
    v_exp_f32 v15, v15
    v_cvt_pk_bf16_f32 v44, v12, v13
    v_exp_f32 v16, v16
    v_exp_f32 v17, v17
    v_cvt_pk_bf16_f32 v45, v14, v15
    v_exp_f32 v18, v18
    v_exp_f32 v19, v19
    v_cvt_pk_bf16_f32 v46, v16, v17
    v_cvt_pk_bf16_f32 v47, v18, v19
    v_mfma_f32_16x16x16_bf16 v[68:71], v[64:65], v[48:49], 0
    v_mfma_f32_16x16x16_bf16 v[52:55], v[30:31], v[48:49], 0
    v_mfma_f32_16x16x16_bf16 v[56:59], v[30:31], v[50:51], 0
    v_mfma_f32_16x16x32_bf16 v[68:71], v[64:67], v[44:47], v[68:71]
    s_waitcnt vmcnt(5)
    v_mfma_f32_16x16x32_bf16 v[52:55], v[36:39], v[44:47], v[52:55]
    s_waitcnt vmcnt(4)
    v_mfma_f32_16x16x32_bf16 v[56:59], v[40:43], v[44:47], v[56:59]
    ds_read_b128 v[36:39], v0 offset:55296
    ds_read_b128 v[40:43], v0 offset:56320
    ds_read_b128 v[60:63], v9 offset:24576
    s_nop 0
    v_rcp_f32 v10, v68
    s_nop 0
    v_pk_mul_f32 v[52:53], v[52:53], v[10:11] op_sel_hi:[1,0]
    s_nop 0
    v_pk_mul_f32 v[56:57], v[56:57], v[10:11] op_sel_hi:[1,0]
    v_cvt_pk_bf16_f32 v16, v52, v56
    v_cvt_pk_bf16_f32 v17, v53, v57
    v_pk_mul_f32 v[54:55], v[54:55], v[10:11] op_sel_hi:[1,0]
    v_pk_mul_f32 v[58:59], v[58:59], v[10:11] op_sel_hi:[1,0]
    v_cvt_pk_bf16_f32 v18, v54, v58
    v_cvt_pk_bf16_f32 v19, v55, v59
    ds_write_b128 v3, v[16:19] offset:22208
    ds_read_b128 v[64:67], v9 offset:25600
    v_mov_b64 v[12:13], 0
    v_mov_b64 v[14:15], 0
    v_mov_b64 v[20:21], 0
    v_mov_b64 v[22:23], 0
    v_mov_b64 v[24:25], 0
    v_mov_b64 v[26:27], 0
    v_mov_b64 v[32:33], 0
    v_mov_b64 v[34:35], 0
    v_mov_b64 v[44:45], 0
    v_mov_b64 v[46:47], 0
    v_mov_b64 v[48:49], 0
    v_mov_b64 v[50:51], 0
    s_waitcnt lgkmcnt(1)
    s_barrier
    ds_read_b128 v[52:55], v4 offset:22016
    ds_read_b128 v[56:59], v4 offset:22144
    v_mov_b64 v[68:69], 0
    v_mov_b64 v[70:71], 0
    v_mov_b64 v[28:29], 0
    v_mov_b64 v[30:31], 0
    v_mov_b64 v[16:17], 0
    v_mov_b64 v[18:19], 0
    s_cmp_eq_u32 s33, 63
    s_cbranch_scc1 Lr3f_last
    s_waitcnt lgkmcnt(1)
    v_smfmac_f32_16x16x64_bf16 v[28:31], v[52:55], v[60:67], v1
    ds_read_b128 v[60:63], v0 offset:49152
    s_waitcnt lgkmcnt(1)
    v_smfmac_f32_16x16x64_bf16 v[28:31], v[56:59], v[36:43], v1
    ds_read_b128 v[64:67], v0 offset:50176
    ds_read_b128 v[36:39], v9 offset:18432
    v_smfmac_f32_16x16x64_bf16 v[12:15], v[52:55], a[176:183], v1
    ds_read_b128 v[40:43], v9 offset:19456
    v_smfmac_f32_16x16x64_bf16 v[12:15], v[56:59], a[184:191], v1
    buffer_load_dwordx4 v0, s[8:11], s41 offen offset:0 lds
    v_smfmac_f32_16x16x64_bf16 v[20:23], v[52:55], a[192:199], v1
    s_nop 0
    v_add_f32 v28, v28, v30
    v_add_f32 v29, v29, v31
    s_waitcnt lgkmcnt(2)
    v_smfmac_f32_16x16x64_bf16 v[20:23], v[56:59], v[60:67], v1
    ds_read_b128 v[60:63], v9 offset:20480
    v_cvt_pk_bf16_f32 v28, v28, v29
    v_bfi_b32 v28, 1, s39, v28
    buffer_store_dword v28, v8, s[8:11], s38 offen offset:2048
    s_waitcnt lgkmcnt(1)
    v_smfmac_f32_16x16x64_bf16 v[24:27], v[52:55], v[36:43], v1
    ds_read_b128 v[64:67], v9 offset:21504
    ds_read_b128 v[36:39], v0 offset:51200
    v_add_f32 v12, v12, v14
    v_add_f32 v13, v13, v15
    v_smfmac_f32_16x16x64_bf16 v[24:27], v[56:59], a[200:207], v1
    ds_read_b128 v[40:43], v0 offset:52224
    v_cvt_pk_bf16_f32 v12, v12, v13
    v_bfi_b32 v12, 1, s39, v12
    v_smfmac_f32_16x16x64_bf16 v[32:35], v[52:55], a[208:215], v1
    buffer_load_dwordx4 v0, s[8:11], s41 offen offset:1024 lds
    v_add_f32 v20, v20, v22
    v_add_f32 v21, v21, v23
    v_smfmac_f32_16x16x64_bf16 v[32:35], v[56:59], a[216:223], v1
    v_cvt_pk_bf16_f32 v13, v20, v21
    s_waitcnt lgkmcnt(2)
    v_smfmac_f32_16x16x64_bf16 v[44:47], v[52:55], v[60:67], v1
    ds_read_b128 v[60:63], v0 offset:53248
    v_add_f32 v24, v24, v26
    v_add_f32 v25, v25, v27
    s_waitcnt lgkmcnt(1)
    v_smfmac_f32_16x16x64_bf16 v[44:47], v[56:59], v[36:43], v1
    ds_read_b128 v[64:67], v0 offset:54272
    ds_read_b128 v[36:39], v9 offset:22528
    v_cvt_pk_bf16_f32 v14, v24, v25
    v_smfmac_f32_16x16x64_bf16 v[48:51], v[52:55], a[224:231], v1
    ds_read_b128 v[40:43], v9 offset:23552
    v_add_f32 v32, v32, v34
    v_add_f32 v33, v33, v35
    v_smfmac_f32_16x16x64_bf16 v[48:51], v[56:59], a[232:239], v1
    v_cvt_pk_bf16_f32 v15, v32, v33
    buffer_store_dwordx4 v[12:15], v0, s[8:11], s38 offen offset:0
    v_smfmac_f32_16x16x64_bf16 v[68:71], v[52:55], a[240:247], v1
    v_add_f32 v44, v44, v46
    v_add_f32 v45, v45, v47
    s_waitcnt lgkmcnt(2)
    v_smfmac_f32_16x16x64_bf16 v[68:71], v[56:59], v[60:67], v1
    v_cvt_pk_bf16_f32 v44, v44, v45
    v_bfi_b32 v44, 1, s39, v44
    s_waitcnt lgkmcnt(0)
    v_smfmac_f32_16x16x64_bf16 v[16:19], v[52:55], v[36:43], v1
    v_add_f32 v48, v48, v50
    v_add_f32 v49, v49, v51
    v_smfmac_f32_16x16x64_bf16 v[16:19], v[56:59], a[248:255], v1
    v_cvt_pk_bf16_f32 v45, v48, v49
    v_add_f32 v68, v68, v70
    v_add_f32 v69, v69, v71
    v_cvt_pk_bf16_f32 v46, v68, v69
    s_nop 3
    v_add_f32 v16, v16, v18
    v_add_f32 v17, v17, v19
    v_cvt_pk_bf16_f32 v47, v16, v17
    buffer_store_dwordx4 v[44:47], v0, s[8:11], s38 offen offset:1024
    s_xor_b32 s34, s34, 16384
    s_xor_b32 s35, s35, 16384
    s_barrier
    s_sleep 2
    buffer_load_dwordx4 v[44:47], v0, s[8:11], s34 offen sc1
    buffer_load_dwordx4 v[48:51], v0, s[8:11], s34 offen offset:1024 sc1
    buffer_load_dword v10, v8, s[8:11], s35 offen sc1
    s_add_u32 s33, s33, 1
    s_bfe_u32 s39, s33, 0x10001
    s_xor_b32 s38, s38, 524288
    s_and_b32 s17, s33, 7
    s_mul_i32 s17, s17, 131072
    s_add_u32 s43, s45, s17
    s_bfe_u32 s66, s33, 65539
    s_add_u32 s67, s67, 22528
    s_cmp_ge_u32 s33, 7
    s_cselect_b64 s[78:79], -1, s[78:79]
    s_add_u32 s56, s56, 262144
    s_add_u32 s42, s42, 262144
    s_add_u32 s41, s41, 262144
    s_add_u32 s40, s40, 262144
    s_add_u32 s44, s44, 22528
    ds_read_b128 v[56:59], v9 offset:12288
    ds_read_b128 v[60:63], v9 offset:13312
    ds_read_b128 v[64:67], v9 offset:14336
    ds_read_b128 v[68:71], v9 offset:15360
    v_mov_b64 v[12:13], 0
    v_mov_b64 v[14:15], 0
    v_mov_b64 v[16:17], 0
    v_mov_b64 v[18:19], 0
    v_mov_b64 v[20:21], 0
    v_mov_b64 v[22:23], 0
    v_mov_b64 v[24:25], 0
    v_mov_b64 v[26:27], 0
    v_mov_b64 v[28:29], 0
    v_mov_b64 v[30:31], 0
    v_mov_b64 v[32:33], 0
    v_mov_b64 v[34:35], 0
    s_waitcnt lgkmcnt(0)
    s_branch Lr3f_step
Lr3f_flbad:
    s_cmp_eq_u32 s33, 63
    s_cbranch_scc1 Lr3f_flok
    s_mov_b32 s16, 0
Lr3f_flp:
    buffer_load_dword v6, v7, s[8:11], s67 offen sc1
    s_add_u32 s16, s16, 1
    s_cmp_gt_u32 s16, 100000
    s_cbranch_scc1 Lr_abort
    s_waitcnt vmcnt(0)
    v_cmp_eq_u32 vcc, 0, v6
    s_nop 0
    s_and_b64 vcc, vcc, s[78:79]
    s_cbranch_scc1 Lr3f_flp
    s_branch Lr3f_flok
Lr3f_last:
    s_waitcnt vmcnt(0) lgkmcnt(0)
    s_branch Lr_exit
L_slow:
    s_cmp_lg_u32 s14, 0
    s_cbranch_scc1 L_w1_0
    s_barrier
    s_mov_b32 m0, 9216
    s_nop 0
    buffer_load_dwordx4 v0, s[8:11], s41 offen offset:0 lds
    buffer_load_dwordx4 v0, s[8:11], s41 offen offset:1024 lds
    s_add_u32 s41, s41, 262144
    s_waitcnt vmcnt(0)
    buffer_load_dwordx4 v[44:47], v0, s[8:11], s34 offen sc1
    buffer_load_dwordx4 v[48:51], v0, s[8:11], s34 offen offset:1024 sc1
    buffer_load_dword v10, v8, s[8:11], s35 offen sc1
    ds_read_b128 v[56:59], v9 offset:0
    ds_read_b128 v[60:63], v9 offset:1024
    ds_read_b128 v[64:67], v9 offset:2048
    ds_read_b128 v[68:71], v9 offset:3072
    v_mov_b64 v[12:13], 0
    v_mov_b64 v[14:15], 0
    v_mov_b64 v[16:17], 0
    v_mov_b64 v[18:19], 0
    v_mov_b64 v[20:21], 0
    v_mov_b64 v[22:23], 0
    v_mov_b64 v[24:25], 0
    v_mov_b64 v[26:27], 0
    v_mov_b64 v[28:29], 0
    v_mov_b64 v[30:31], 0
    v_mov_b64 v[32:33], 0
    v_mov_b64 v[34:35], 0
    s_waitcnt lgkmcnt(0)
Lr0s_step:
    s_mov_b32 s16, 0
    s_mov_b64 s[70:71], 0
    s_mov_b64 s[72:73], 0
    s_mov_b64 s[74:75], 0
Lr0s_p2:
    s_mov_b64 exec, s[70:71]
    buffer_load_dwordx4 v[44:47], v0, s[8:11], s34 offen sc1
    s_mov_b64 exec, s[72:73]
    buffer_load_dwordx4 v[48:51], v0, s[8:11], s34 offen offset:1024 sc1
    s_mov_b64 exec, s[74:75]
    buffer_load_dword v10, v8, s[8:11], s35 offen sc1
    s_mov_b64 exec, -1
    s_add_u32 s16, s16, 1
    s_cmp_gt_u32 s16, 100000
    s_cbranch_scc1 Lr_abort
    s_waitcnt vmcnt(5)
    v_max3_u32 v11, v44, v45, v46
    v_max_u32 v11, v11, v47
    v_cmp_eq_u32 s[70:71], -1, v11
    s_waitcnt vmcnt(4)
    v_max3_u32 v11, v48, v49, v50
    v_max_u32 v11, v11, v51
    v_cmp_eq_u32 s[72:73], -1, v11
    s_waitcnt vmcnt(3)
    v_cmp_eq_u32 s[74:75], -1, v10
    s_or_b64 vcc, s[70:71], s[72:73]
    s_or_b64 vcc, vcc, s[74:75]
    s_cbranch_scc1 Lr0s_p2
    v_smfmac_f32_16x16x64_bf16 v[12:15], v[44:47], v[72:79], v1
    ds_write_b128 v0, v[44:47] offset:0
    v_smfmac_f32_16x16x64_bf16 v[16:19], v[44:47], v[80:87], v1
    ds_write_b128 v0, v[48:51] offset:1024
    v_smfmac_f32_16x16x64_bf16 v[20:23], v[44:47], v[88:95], v1
    ds_write_b32 v8, v10 offset:8192
    v_smfmac_f32_16x16x64_bf16 v[24:27], v[44:47], v[56:63], v1
    s_waitcnt lgkmcnt(0)
    s_barrier
    ds_read_b128 v[52:55], v0 offset:2048
    v_smfmac_f32_16x16x64_bf16 v[12:15], v[48:51], v[112:119], v1
    ds_read_b128 v[36:39], v0 offset:3072
    v_smfmac_f32_16x16x64_bf16 v[16:19], v[48:51], v[120:127], v1
    ds_read_b128 v[56:59], v9 offset:4096
    v_smfmac_f32_16x16x64_bf16 v[20:23], v[48:51], v[128:135], v1
    ds_read_b128 v[60:63], v9 offset:5120
    v_smfmac_f32_16x16x64_bf16 v[24:27], v[48:51], v[64:71], v1
    ds_read_b128 v[40:43], v0 offset:4096
    s_waitcnt lgkmcnt(4)
    v_smfmac_f32_16x16x64_bf16 v[12:15], v[52:55], v[152:159], v1
    v_smfmac_f32_16x16x64_bf16 v[16:19], v[52:55], v[160:167], v1
    ds_read_b128 v[64:67], v9 offset:6144
    v_smfmac_f32_16x16x64_bf16 v[20:23], v[52:55], v[168:175], v1
    ds_read_b128 v[68:71], v9 offset:7168
    s_waitcnt lgkmcnt(3)
    v_smfmac_f32_16x16x64_bf16 v[24:27], v[52:55], v[56:63], v1
    v_smfmac_f32_16x16x64_bf16 v[12:15], v[36:39], v[192:199], v1
    ds_read_b128 v[52:55], v0 offset:5120
    v_smfmac_f32_16x16x64_bf16 v[16:19], v[36:39], v[200:207], v1
    ds_read_b128 v[56:59], v9 offset:8192
    v_smfmac_f32_16x16x64_bf16 v[20:23], v[36:39], v[208:215], v1
    ds_read_b128 v[60:63], v9 offset:9216
    s_waitcnt lgkmcnt(3)
    v_smfmac_f32_16x16x64_bf16 v[24:27], v[36:39], v[64:71], v1
    v_smfmac_f32_16x16x64_bf16 v[12:15], v[40:43], v[232:239], v1
    buffer_load_dwordx4 v[36:39], v0, s[8:11], s42 offen
    v_smfmac_f32_16x16x64_bf16 v[16:19], v[40:43], v[240:247], v1
    ds_read_b128 v[64:67], v9 offset:10240
    v_smfmac_f32_16x16x64_bf16 v[20:23], v[40:43], v[248:255], v1
    ds_read_b128 v[68:71], v9 offset:11264
    s_waitcnt lgkmcnt(2)
    v_smfmac_f32_16x16x64_bf16 v[24:27], v[40:43], v[56:63], v1
    s_waitcnt vmcnt(1)
    ds_read_b128 v[44:47], v0 offset:6144
    v_smfmac_f32_16x16x64_bf16 v[12:15], v[52:55], a[16:23], v1
    buffer_load_dwordx4 v[40:43], v0, s[8:11], s42 offen offset:1024
    v_smfmac_f32_16x16x64_bf16 v[16:19], v[52:55], a[24:31], v1
    ds_read_b128 v[56:59], v9 offset:12288
    v_smfmac_f32_16x16x64_bf16 v[20:23], v[52:55], a[32:39], v1
    ds_read_b128 v[60:63], v9 offset:13312
    s_waitcnt lgkmcnt(3)
    v_smfmac_f32_16x16x64_bf16 v[24:27], v[52:55], v[64:71], v1
    ds_read_b128 v[48:51], v0 offset:7168
    s_waitcnt lgkmcnt(3)
    v_smfmac_f32_16x16x64_bf16 v[12:15], v[44:47], a[56:63], v1
    ds_read_b128 v[52:55], v0 offset:8192
    v_smfmac_f32_16x16x64_bf16 v[16:19], v[44:47], a[64:71], v1
    ds_read_b128 v[64:67], v9 offset:14336
    v_smfmac_f32_16x16x64_bf16 v[20:23], v[44:47], a[72:79], v1
    ds_read_b128 v[68:71], v9 offset:15360
    s_waitcnt lgkmcnt(4)
    v_smfmac_f32_16x16x64_bf16 v[24:27], v[44:47], v[56:63], v1
    s_waitcnt lgkmcnt(3)
    v_smfmac_f32_16x16x64_bf16 v[12:15], v[48:51], a[96:103], v1
    v_smfmac_f32_16x16x64_bf16 v[16:19], v[48:51], a[104:111], v1
    ds_read_b128 v[56:59], v9 offset:16384
    s_waitcnt lgkmcnt(3)
    v_smfmac_f32_16x16x64_bf16 v[12:15], v[52:55], a[136:143], v1
    ds_read_b128 v[60:63], v9 offset:17408
    v_smfmac_f32_16x16x64_bf16 v[16:19], v[52:55], a[144:151], v1
    v_smfmac_f32_16x16x64_bf16 v[20:23], v[48:51], a[112:119], v1
    s_waitcnt lgkmcnt(2)
    v_smfmac_f32_16x16x64_bf16 v[24:27], v[48:51], v[64:71], v1
    ds_read_b128 v[64:67], v0 offset:9216
    s_nop 1
    v_add_f32 v12, v12, v14
    v_smfmac_f32_16x16x64_bf16 v[20:23], v[52:55], a[152:159], v1
    ds_read_b128 v[68:71], v0 offset:10240
    v_add_f32 v16, v16, v18
    s_waitcnt lgkmcnt(2)
    v_smfmac_f32_16x16x64_bf16 v[24:27], v[52:55], v[56:63], v1
    ds_read_b128 v[56:59], v0 offset:11264
    v_add_f32 v13, v13, v15
    v_add_f32 v17, v17, v19
    v_cvt_pk_bf16_f32 v14, v12, v16
    v_cvt_pk_bf16_f32 v15, v13, v17
    ds_write_b32 v2, v14 offset:17408
    ds_write_b32 v2, v15 offset:17696
    v_smfmac_f32_16x16x64_bf16 v[28:31], v[52:55], a[160:167], v1
    ds_read_b128 v[60:63], v0 offset:12288
    v_add_f32 v20, v20, v22
    v_add_f32 v24, v24, v26
    v_add_f32 v21, v21, v23
    v_add_f32 v25, v25, v27
    v_smfmac_f32_16x16x64_bf16 v[32:35], v[52:55], a[168:175], v1
    ds_read_b128 v[12:15], v0 offset:0
    v_cvt_pk_bf16_f32 v22, v20, v24
    v_cvt_pk_bf16_f32 v23, v21, v25
    ds_write_b32 v2, v22 offset:19712
    ds_write_b32 v2, v23 offset:20000
    v_smfmac_f32_16x16x64_bf16 v[28:31], v[48:51], a[120:127], v1
    ds_read_b128 v[16:19], v0 offset:1024
    v_smfmac_f32_16x16x64_bf16 v[32:35], v[48:51], a[128:135], v1
    ds_read_b128 v[20:23], v0 offset:2048
    v_smfmac_f32_16x16x64_bf16 v[28:31], v[44:47], a[80:87], v1
    ds_read_b128 v[24:27], v0 offset:3072
    v_smfmac_f32_16x16x64_bf16 v[32:35], v[44:47], a[88:95], v1
    s_waitcnt lgkmcnt(3)
    s_barrier
    ds_read_b128 v[44:47], v3 offset:17408
    v_smfmac_f32_16x16x64_bf16 v[28:31], v[12:15], v[96:103], v1
    ds_read_b128 v[52:55], v0 offset:4096
    v_smfmac_f32_16x16x64_bf16 v[32:35], v[12:15], v[104:111], v1
    ds_read_b128 v[12:15], v3 offset:19712
    s_waitcnt lgkmcnt(5)
    v_smfmac_f32_16x16x64_bf16 v[28:31], v[16:19], v[136:143], v1
    ds_read_b128 v[48:51], v0 offset:5120
    v_smfmac_f32_16x16x64_bf16 v[32:35], v[16:19], v[144:151], v1
    s_waitcnt lgkmcnt(5)
    v_smfmac_f32_16x16x64_bf16 v[28:31], v[20:23], v[176:183], v1
    v_smfmac_f32_16x16x64_bf16 v[32:35], v[20:23], v[184:191], v1
    ds_read_b128 v[20:23], v3 offset:17472
    s_waitcnt lgkmcnt(5)
    v_smfmac_f32_16x16x64_bf16 v[28:31], v[24:27], v[216:223], v1
    v_smfmac_f32_16x16x64_bf16 v[32:35], v[24:27], v[224:231], v1
    s_waitcnt lgkmcnt(3)
    v_smfmac_f32_16x16x64_bf16 v[28:31], v[52:55], a[0:7], v1
    v_smfmac_f32_16x16x64_bf16 v[32:35], v[52:55], a[8:15], v1
    ds_read_b128 v[52:55], v3 offset:19776
    s_waitcnt lgkmcnt(2)
    v_smfmac_f32_16x16x64_bf16 v[28:31], v[48:51], a[40:47], v1
    v_smfmac_f32_16x16x64_bf16 v[32:35], v[48:51], a[48:55], v1
    ds_read_b128 v[48:51], v3 offset:17536
    v_mfma_f32_16x16x32_bf16 v[24:27], v[12:15], v[44:47], 0
    v_mfma_f32_16x16x32_bf16 v[12:15], v[64:67], v[44:47], 0
    ds_read_b128 v[64:67], v0 offset:13312
    v_mfma_f32_16x16x32_bf16 v[16:19], v[68:71], v[44:47], 0
    ds_read_b128 v[68:71], v0 offset:14336
    s_waitcnt lgkmcnt(3)
    v_mfma_f32_16x16x32_bf16 v[24:27], v[52:55], v[20:23], v[24:27]
    ds_read_b128 v[44:47], v3 offset:19840
    v_add_f32 v28, v28, v30
    v_add_f32 v29, v29, v31
    v_mfma_f32_16x16x32_bf16 v[12:15], v[56:59], v[20:23], v[12:15]
    ds_read_b128 v[52:55], v3 offset:17600
    v_add_f32 v32, v32, v34
    v_add_f32 v33, v33, v35
    v_mfma_f32_16x16x32_bf16 v[16:19], v[60:63], v[20:23], v[16:19]
    ds_read_b128 v[56:59], v0 offset:15360
    v_cvt_pk_bf16_f32 v30, v28, v29
    v_cvt_pk_bf16_f32 v31, v32, v33
    s_waitcnt lgkmcnt(2)
    v_mfma_f32_16x16x32_bf16 v[24:27], v[44:47], v[48:51], v[24:27]
    ds_read_b128 v[20:23], v3 offset:19904
    v_lshrrev_b32 v10, 8, v0
    v_mul_u32_u24 v10, 288, v10
    v_mfma_f32_16x16x32_bf16 v[12:15], v[64:67], v[48:51], v[12:15]
    ds_read_b128 v[60:63], v0 offset:16384
    v_and_b32 v11, 0xf0, v0
    v_add_u32 v10, v10, v11
    v_mfma_f32_16x16x32_bf16 v[16:19], v[68:71], v[48:51], v[16:19]
    ds_read_b128 v[32:35], v10 offset:19712
    v_lshrrev_b32 v11, 1, v0
    v_bfi_b32 v30, 1, s66, v30
    s_waitcnt lgkmcnt(2)
    v_mfma_f32_16x16x32_bf16 v[24:27], v[20:23], v[52:55], v[24:27]
    buffer_store_dwordx2 v[30:31], v11, s[8:11], s43 offen offset:2048 sc1
    v_mov_b32 v49, 0
    v_mov_b32 v50, 0
    v_mfma_f32_16x16x32_bf16 v[12:15], v[56:59], v[52:55], v[12:15]
    v_mov_b64 v[64:65], s[68:69]
    v_mov_b64 v[66:67], s[68:69]
    s_waitcnt lgkmcnt(1)
    v_mfma_f32_16x16x32_bf16 v[16:19], v[60:63], v[52:55], v[16:19]
    s_waitcnt lgkmcnt(0)
    v_bfi_b32 v32, 1, s66, v32
    s_mov_b64 exec, s[52:53]
    buffer_store_dwordx4 v[32:35], v0, s[8:11], s43 offen sc1
    s_mov_b64 exec, -1
    v_max3_f32 v10, v24, v25, v12
    v_max3_f32 v10, v10, v13, v14
    s_nop 0
    v_max3_f32 v10, v10, v15, v16
    v_max3_f32 v10, v10, v17, v18
    v_max_f32 v10, v10, v19
    v_mov_b32 v11, v10
    s_nop 1
    v_permlane32_swap_b32 v10, v11
    v_max_f32 v10, v10, v11
    v_mov_b32 v11, v10
    s_nop 1
    v_permlane16_swap_b32 v10, v11
    v_max_f32 v10, v10, v11
    v_mul_f32 v20, s46, v10
    v_pk_fma_f32 v[24:25], v[24:25], s[46:47], v[20:21] op_sel_hi:[1,1,0] neg_lo:[0,0,1] neg_hi:[0,0,1]
    v_pk_fma_f32 v[12:13], v[12:13], s[46:47], v[20:21] op_sel_hi:[1,1,0] neg_lo:[0,0,1] neg_hi:[0,0,1]
    v_exp_f32 v24, v24
    v_exp_f32 v25, v25
    v_pk_fma_f32 v[14:15], v[14:15], s[46:47], v[20:21] op_sel_hi:[1,1,0] neg_lo:[0,0,1] neg_hi:[0,0,1]
    v_exp_f32 v12, v12
    v_exp_f32 v13, v13
    v_pk_fma_f32 v[16:17], v[16:17], s[46:47], v[20:21] op_sel_hi:[1,1,0] neg_lo:[0,0,1] neg_hi:[0,0,1]
    v_cvt_pk_bf16_f32 v48, v24, v25
    v_exp_f32 v14, v14
    v_pk_fma_f32 v[18:19], v[18:19], s[46:47], v[20:21] op_sel_hi:[1,1,0] neg_lo:[0,0,1] neg_hi:[0,0,1]
    v_cvt_pk_bf16_f32 v51, v24, v25
    v_exp_f32 v15, v15
    v_cvt_pk_bf16_f32 v44, v12, v13
    v_exp_f32 v16, v16
    v_exp_f32 v17, v17
    v_cvt_pk_bf16_f32 v45, v14, v15
    v_exp_f32 v18, v18
    v_exp_f32 v19, v19
    v_cvt_pk_bf16_f32 v46, v16, v17
    v_cvt_pk_bf16_f32 v47, v18, v19
    v_mfma_f32_16x16x16_bf16 v[68:71], v[64:65], v[48:49], 0
    v_mfma_f32_16x16x16_bf16 v[52:55], v[30:31], v[48:49], 0
    v_mfma_f32_16x16x16_bf16 v[56:59], v[30:31], v[50:51], 0
    v_mfma_f32_16x16x32_bf16 v[68:71], v[64:67], v[44:47], v[68:71]
    s_waitcnt vmcnt(3)
    v_mfma_f32_16x16x32_bf16 v[52:55], v[36:39], v[44:47], v[52:55]
    s_waitcnt vmcnt(2)
    v_mfma_f32_16x16x32_bf16 v[56:59], v[40:43], v[44:47], v[56:59]
    ds_read_b128 v[36:39], v0 offset:30720
    ds_read_b128 v[40:43], v0 offset:31744
    ds_read_b128 v[60:63], v9 offset:24576
    s_nop 0
    v_rcp_f32 v10, v68
    s_nop 0
    v_pk_mul_f32 v[52:53], v[52:53], v[10:11] op_sel_hi:[1,0]
    s_nop 0
    v_pk_mul_f32 v[56:57], v[56:57], v[10:11] op_sel_hi:[1,0]
    v_cvt_pk_bf16_f32 v16, v52, v56
    v_cvt_pk_bf16_f32 v17, v53, v57
    v_pk_mul_f32 v[54:55], v[54:55], v[10:11] op_sel_hi:[1,0]
    v_pk_mul_f32 v[58:59], v[58:59], v[10:11] op_sel_hi:[1,0]
    v_cvt_pk_bf16_f32 v18, v54, v58
    v_cvt_pk_bf16_f32 v19, v55, v59
    ds_write_b128 v3, v[16:19] offset:22016
    ds_read_b128 v[64:67], v9 offset:25600
    v_mov_b64 v[12:13], 0
    v_mov_b64 v[14:15], 0
    v_mov_b64 v[20:21], 0
    v_mov_b64 v[22:23], 0
    v_mov_b64 v[24:25], 0
    v_mov_b64 v[26:27], 0
    v_mov_b64 v[32:33], 0
    v_mov_b64 v[34:35], 0
    v_mov_b64 v[44:45], 0
    v_mov_b64 v[46:47], 0
    v_mov_b64 v[48:49], 0
    v_mov_b64 v[50:51], 0
    s_waitcnt lgkmcnt(1)
    s_barrier
    ds_read_b128 v[52:55], v4 offset:22016
    ds_read_b128 v[56:59], v4 offset:22144
    v_mov_b64 v[68:69], 0
    v_mov_b64 v[70:71], 0
    v_mov_b64 v[28:29], 0
    v_mov_b64 v[30:31], 0
    v_mov_b64 v[16:17], 0
    v_mov_b64 v[18:19], 0
    s_cmp_eq_u32 s33, 63
    s_cbranch_scc1 Lr0s_last
    s_waitcnt lgkmcnt(1)
    v_smfmac_f32_16x16x64_bf16 v[28:31], v[52:55], v[60:67], v1
    ds_read_b128 v[60:63], v0 offset:24576
    s_waitcnt lgkmcnt(1)
    v_smfmac_f32_16x16x64_bf16 v[28:31], v[56:59], v[36:43], v1
    ds_read_b128 v[64:67], v0 offset:25600
    ds_read_b128 v[36:39], v9 offset:18432
    v_smfmac_f32_16x16x64_bf16 v[12:15], v[52:55], a[176:183], v1
    ds_read_b128 v[40:43], v9 offset:19456
    v_smfmac_f32_16x16x64_bf16 v[12:15], v[56:59], a[184:191], v1
    buffer_load_dwordx4 v0, s[8:11], s41 offen offset:0 lds
    v_smfmac_f32_16x16x64_bf16 v[20:23], v[52:55], a[192:199], v1
    s_nop 0
    v_add_f32 v28, v28, v30
    v_add_f32 v29, v29, v31
    s_waitcnt lgkmcnt(2)
    v_smfmac_f32_16x16x64_bf16 v[20:23], v[56:59], v[60:67], v1
    ds_read_b128 v[60:63], v9 offset:20480
    v_cvt_pk_bf16_f32 v28, v28, v29
    v_bfi_b32 v28, 1, s39, v28
    buffer_store_dword v28, v8, s[8:11], s38 offen offset:2048 sc1
    s_waitcnt lgkmcnt(1)
    v_smfmac_f32_16x16x64_bf16 v[24:27], v[52:55], v[36:43], v1
    ds_read_b128 v[64:67], v9 offset:21504
    ds_read_b128 v[36:39], v0 offset:26624
    v_add_f32 v12, v12, v14
    v_add_f32 v13, v13, v15
    v_smfmac_f32_16x16x64_bf16 v[24:27], v[56:59], a[200:207], v1
    ds_read_b128 v[40:43], v0 offset:27648
    v_cvt_pk_bf16_f32 v12, v12, v13
    v_bfi_b32 v12, 1, s39, v12
    v_smfmac_f32_16x16x64_bf16 v[32:35], v[52:55], a[208:215], v1
    buffer_load_dwordx4 v0, s[8:11], s41 offen offset:1024 lds
    v_add_f32 v20, v20, v22
    v_add_f32 v21, v21, v23
    v_smfmac_f32_16x16x64_bf16 v[32:35], v[56:59], a[216:223], v1
    v_cvt_pk_bf16_f32 v13, v20, v21
    s_waitcnt lgkmcnt(2)
    v_smfmac_f32_16x16x64_bf16 v[44:47], v[52:55], v[60:67], v1
    ds_read_b128 v[60:63], v0 offset:28672
    v_add_f32 v24, v24, v26
    v_add_f32 v25, v25, v27
    s_waitcnt lgkmcnt(1)
    v_smfmac_f32_16x16x64_bf16 v[44:47], v[56:59], v[36:43], v1
    ds_read_b128 v[64:67], v0 offset:29696
    ds_read_b128 v[36:39], v9 offset:22528
    v_cvt_pk_bf16_f32 v14, v24, v25
    v_smfmac_f32_16x16x64_bf16 v[48:51], v[52:55], a[224:231], v1
    ds_read_b128 v[40:43], v9 offset:23552
    v_add_f32 v32, v32, v34
    v_add_f32 v33, v33, v35
    v_smfmac_f32_16x16x64_bf16 v[48:51], v[56:59], a[232:239], v1
    v_cvt_pk_bf16_f32 v15, v32, v33
    buffer_store_dwordx4 v[12:15], v0, s[8:11], s38 offen offset:0 sc1
    v_smfmac_f32_16x16x64_bf16 v[68:71], v[52:55], a[240:247], v1
    v_add_f32 v44, v44, v46
    v_add_f32 v45, v45, v47
    s_waitcnt lgkmcnt(2)
    v_smfmac_f32_16x16x64_bf16 v[68:71], v[56:59], v[60:67], v1
    v_cvt_pk_bf16_f32 v44, v44, v45
    v_bfi_b32 v44, 1, s39, v44
    s_waitcnt lgkmcnt(0)
    v_smfmac_f32_16x16x64_bf16 v[16:19], v[52:55], v[36:43], v1
    v_add_f32 v48, v48, v50
    v_add_f32 v49, v49, v51
    v_smfmac_f32_16x16x64_bf16 v[16:19], v[56:59], a[248:255], v1
    v_cvt_pk_bf16_f32 v45, v48, v49
    v_add_f32 v68, v68, v70
    v_add_f32 v69, v69, v71
    v_cvt_pk_bf16_f32 v46, v68, v69
    s_nop 3
    v_add_f32 v16, v16, v18
    v_add_f32 v17, v17, v19
    v_cvt_pk_bf16_f32 v47, v16, v17
    buffer_store_dwordx4 v[44:47], v0, s[8:11], s38 offen offset:1024 sc1
    v_bfe_u32 v10, v0, 4, 4
    v_mov_b32 v11, 0x3f80
    v_mov_b32 v40, 0x3f800000
    v_cmp_eq_u32 vcc, 0, v10
    v_cmp_eq_u32 s[48:49], 1, v10
    s_nop 0
    v_cndmask_b32 v36, 0, v11, vcc
    v_cndmask_b32 v36, v36, v40, s[48:49]
    v_cmp_eq_u32 vcc, 2, v10
    v_cmp_eq_u32 s[48:49], 3, v10
    s_nop 0
    v_cndmask_b32 v37, 0, v11, vcc
    v_cndmask_b32 v37, v37, v40, s[48:49]
    v_cmp_eq_u32 vcc, 4, v10
    v_cmp_eq_u32 s[48:49], 5, v10
    s_nop 0
    v_cndmask_b32 v38, 0, v11, vcc
    v_cndmask_b32 v38, v38, v40, s[48:49]
    v_cmp_eq_u32 vcc, 6, v10
    v_cmp_eq_u32 s[48:49], 7, v10
    s_nop 0
    v_cndmask_b32 v39, 0, v11, vcc
    v_cndmask_b32 v39, v39, v40, s[48:49]
    s_sleep 5
    buffer_load_dwordx4 v[52:55], v6, s[8:11], s57 offen sc1
    buffer_load_dwordx4 v[56:59], v6, s[8:11], s58 offen sc1
    buffer_load_dwordx4 v[60:63], v6, s[8:11], s59 offen sc1
    buffer_load_dwordx4 v[64:67], v6, s[8:11], s60 offen sc1
    s_mov_b32 s16, 0
    s_mov_b64 s[70:71], 0
    s_mov_b64 s[72:73], 0
    s_mov_b64 s[74:75], 0
    s_mov_b64 s[76:77], 0
Lr0s_p1:
    s_mov_b64 exec, s[70:71]
    buffer_load_dwordx4 v[52:55], v6, s[8:11], s57 offen sc1
    s_mov_b64 exec, s[72:73]
    buffer_load_dwordx4 v[56:59], v6, s[8:11], s58 offen sc1
    s_mov_b64 exec, s[74:75]
    buffer_load_dwordx4 v[60:63], v6, s[8:11], s59 offen sc1
    s_mov_b64 exec, s[76:77]
    buffer_load_dwordx4 v[64:67], v6, s[8:11], s60 offen sc1
    s_mov_b64 exec, -1
    s_add_u32 s16, s16, 1
    s_cmp_gt_u32 s16, 100000
    s_cbranch_scc1 Lr_abort
    s_waitcnt vmcnt(7)
    v_and_b32 v11, 1, v52
    v_cmp_ne_u32 s[70:71], s39, v11
    v_mfma_f32_16x16x32_bf16 v[40:43], v[52:55], v[36:39], 0
    s_waitcnt vmcnt(6)
    v_and_b32 v11, 1, v56
    v_cmp_ne_u32 s[72:73], s39, v11
    v_mfma_f32_16x16x32_bf16 v[40:43], v[56:59], v[36:39], v[40:43]
    s_waitcnt vmcnt(5)
    v_and_b32 v11, 1, v60
    v_cmp_ne_u32 s[74:75], s39, v11
    v_mfma_f32_16x16x32_bf16 v[40:43], v[60:63], v[36:39], v[40:43]
    s_or_b64 vcc, s[70:71], s[72:73]
    s_waitcnt vmcnt(4)
    v_and_b32 v11, 1, v64
    v_cmp_ne_u32 s[76:77], s39, v11
    v_mfma_f32_16x16x32_bf16 v[40:43], v[64:67], v[36:39], v[40:43]
    s_or_b64 vcc, vcc, s[74:75]
    s_or_b64 vcc, vcc, s[76:77]
    s_cbranch_scc1 Lr0s_p1
    s_nop 4
    v_permlane16_swap_b32 v40, v42
    v_permlane16_swap_b32 v41, v43
    s_mov_b64 exec, s[50:51]
    v_add_f32 v40, v40, v42
    v_add_f32 v41, v41, v43
    v_cvt_pk_bf16_f32 v40, v40, v41
    v_min_u32 v40, s54, v40
    buffer_store_dword v40, v7, s[8:11], s36 offen sc1
    v_mov_b32 v41, -1
    buffer_store_dword v41, v7, s[8:11], s37 offen sc1
    s_mov_b64 exec, -1
    s_xor_b32 s34, s34, 16384
    s_xor_b32 s35, s35, 16384
    s_barrier
    s_sleep 2
    buffer_load_dwordx4 v[44:47], v0, s[8:11], s34 offen sc1
    buffer_load_dwordx4 v[48:51], v0, s[8:11], s34 offen offset:1024 sc1
    buffer_load_dword v10, v8, s[8:11], s35 offen sc1
    s_add_u32 s33, s33, 1
    s_bfe_u32 s39, s33, 0x10001
    s_xor_b32 s38, s38, 524288
    s_xor_b32 s57, s57, 524288
    s_xor_b32 s58, s58, 524288
    s_xor_b32 s59, s59, 524288
    s_xor_b32 s60, s60, 524288
    s_xor_b32 s36, s36, 16384
    s_xor_b32 s37, s37, 16384
    s_and_b32 s17, s33, 7
    s_mul_i32 s17, s17, 131072
    s_add_u32 s43, s45, s17
    s_bfe_u32 s66, s33, 65539
    s_add_u32 s67, s67, 22528
    s_add_u32 s42, s42, 262144
    s_add_u32 s41, s41, 262144
    s_add_u32 s40, s40, 262144
    s_add_u32 s44, s44, 22528
    s_waitcnt vmcnt(5)
    ds_read_b128 v[56:59], v9 offset:0
    ds_read_b128 v[60:63], v9 offset:1024
    ds_read_b128 v[64:67], v9 offset:2048
    ds_read_b128 v[68:71], v9 offset:3072
    v_mov_b64 v[12:13], 0
    v_mov_b64 v[14:15], 0
    v_mov_b64 v[16:17], 0
    v_mov_b64 v[18:19], 0
    v_mov_b64 v[20:21], 0
    v_mov_b64 v[22:23], 0
    v_mov_b64 v[24:25], 0
    v_mov_b64 v[26:27], 0
    v_mov_b64 v[28:29], 0
    v_mov_b64 v[30:31], 0
    v_mov_b64 v[32:33], 0
    v_mov_b64 v[34:35], 0
    s_waitcnt lgkmcnt(0)
    s_branch Lr0s_step
Lr0s_last:
    s_waitcnt vmcnt(0) lgkmcnt(0)
    s_branch Lr_exit
L_w1_0:
    s_cmp_lg_u32 s14, 1
    s_cbranch_scc1 L_w2_0
    s_barrier
    s_mov_b32 m0, 11264
    s_nop 0
    buffer_load_dwordx4 v0, s[8:11], s41 offen offset:0 lds
    buffer_load_dwordx4 v0, s[8:11], s41 offen offset:1024 lds
    s_add_u32 s41, s41, 262144
    s_waitcnt vmcnt(0)
    buffer_load_dwordx4 v[44:47], v0, s[8:11], s34 offen sc1
    buffer_load_dwordx4 v[48:51], v0, s[8:11], s34 offen offset:1024 sc1
    buffer_load_dword v10, v8, s[8:11], s35 offen sc1
    ds_read_b128 v[56:59], v9 offset:4096
    ds_read_b128 v[60:63], v9 offset:5120
    ds_read_b128 v[64:67], v9 offset:6144
    ds_read_b128 v[68:71], v9 offset:7168
    v_mov_b64 v[12:13], 0
    v_mov_b64 v[14:15], 0
    v_mov_b64 v[16:17], 0
    v_mov_b64 v[18:19], 0
    v_mov_b64 v[20:21], 0
    v_mov_b64 v[22:23], 0
    v_mov_b64 v[24:25], 0
    v_mov_b64 v[26:27], 0
    v_mov_b64 v[28:29], 0
    v_mov_b64 v[30:31], 0
    v_mov_b64 v[32:33], 0
    v_mov_b64 v[34:35], 0
    s_waitcnt lgkmcnt(0)
Lr1s_step:
    s_mov_b32 s16, 0
    s_mov_b64 s[70:71], 0
    s_mov_b64 s[72:73], 0
    s_mov_b64 s[74:75], 0
Lr1s_p2:
    s_mov_b64 exec, s[70:71]
    buffer_load_dwordx4 v[44:47], v0, s[8:11], s34 offen sc1
    s_mov_b64 exec, s[72:73]
    buffer_load_dwordx4 v[48:51], v0, s[8:11], s34 offen offset:1024 sc1
    s_mov_b64 exec, s[74:75]
    buffer_load_dword v10, v8, s[8:11], s35 offen sc1
    s_mov_b64 exec, -1
    s_add_u32 s16, s16, 1
    s_cmp_gt_u32 s16, 100000
    s_cbranch_scc1 Lr_abort
    s_waitcnt vmcnt(5)
    v_max3_u32 v11, v44, v45, v46
    v_max_u32 v11, v11, v47
    v_cmp_eq_u32 s[70:71], -1, v11
    s_waitcnt vmcnt(4)
    v_max3_u32 v11, v48, v49, v50
    v_max_u32 v11, v11, v51
    v_cmp_eq_u32 s[72:73], -1, v11
    s_waitcnt vmcnt(3)
    v_cmp_eq_u32 s[74:75], -1, v10
    s_or_b64 vcc, s[70:71], s[72:73]
    s_or_b64 vcc, vcc, s[74:75]
    s_cbranch_scc1 Lr1s_p2
    v_smfmac_f32_16x16x64_bf16 v[12:15], v[44:47], v[152:159], v1
    ds_write_b128 v0, v[44:47] offset:2048
    v_smfmac_f32_16x16x64_bf16 v[16:19], v[44:47], v[160:167], v1
    ds_write_b128 v0, v[48:51] offset:3072
    v_smfmac_f32_16x16x64_bf16 v[20:23], v[44:47], v[168:175], v1
    ds_write_b32 v8, v10 offset:8448
    v_smfmac_f32_16x16x64_bf16 v[24:27], v[44:47], v[56:63], v1
    s_waitcnt lgkmcnt(0)
    s_barrier
    ds_read_b128 v[52:55], v0 offset:0
    v_smfmac_f32_16x16x64_bf16 v[12:15], v[48:51], v[192:199], v1
    ds_read_b128 v[36:39], v0 offset:1024
    v_smfmac_f32_16x16x64_bf16 v[16:19], v[48:51], v[200:207], v1
    ds_read_b128 v[56:59], v9 offset:0
    v_smfmac_f32_16x16x64_bf16 v[20:23], v[48:51], v[208:215], v1
    ds_read_b128 v[60:63], v9 offset:1024
    v_smfmac_f32_16x16x64_bf16 v[24:27], v[48:51], v[64:71], v1
    ds_read_b128 v[40:43], v0 offset:4096
    s_waitcnt lgkmcnt(4)
    v_smfmac_f32_16x16x64_bf16 v[12:15], v[52:55], v[72:79], v1
    v_smfmac_f32_16x16x64_bf16 v[16:19], v[52:55], v[80:87], v1
    ds_read_b128 v[64:67], v9 offset:2048
    v_smfmac_f32_16x16x64_bf16 v[20:23], v[52:55], v[88:95], v1
    ds_read_b128 v[68:71], v9 offset:3072
    s_waitcnt lgkmcnt(3)
    v_smfmac_f32_16x16x64_bf16 v[24:27], v[52:55], v[56:63], v1
    v_smfmac_f32_16x16x64_bf16 v[12:15], v[36:39], v[112:119], v1
    ds_read_b128 v[52:55], v0 offset:5120
    v_smfmac_f32_16x16x64_bf16 v[16:19], v[36:39], v[120:127], v1
    ds_read_b128 v[56:59], v9 offset:8192
    v_smfmac_f32_16x16x64_bf16 v[20:23], v[36:39], v[128:135], v1
    ds_read_b128 v[60:63], v9 offset:9216
    s_waitcnt lgkmcnt(3)
    v_smfmac_f32_16x16x64_bf16 v[24:27], v[36:39], v[64:71], v1
    v_smfmac_f32_16x16x64_bf16 v[12:15], v[40:43], v[232:239], v1
    buffer_load_dwordx4 v[36:39], v0, s[8:11], s42 offen
    v_smfmac_f32_16x16x64_bf16 v[16:19], v[40:43], v[240:247], v1
    ds_read_b128 v[64:67], v9 offset:10240
    v_smfmac_f32_16x16x64_bf16 v[20:23], v[40:43], v[248:255], v1
    ds_read_b128 v[68:71], v9 offset:11264
    s_waitcnt lgkmcnt(2)
    v_smfmac_f32_16x16x64_bf16 v[24:27], v[40:43], v[56:63], v1
    s_waitcnt vmcnt(1)
    ds_read_b128 v[44:47], v0 offset:6144
    v_smfmac_f32_16x16x64_bf16 v[12:15], v[52:55], a[16:23], v1
    buffer_load_dwordx4 v[40:43], v0, s[8:11], s42 offen offset:1024
    v_smfmac_f32_16x16x64_bf16 v[16:19], v[52:55], a[24:31], v1
    ds_read_b128 v[56:59], v9 offset:12288
    v_smfmac_f32_16x16x64_bf16 v[20:23], v[52:55], a[32:39], v1
    ds_read_b128 v[60:63], v9 offset:13312
    s_waitcnt lgkmcnt(3)
    v_smfmac_f32_16x16x64_bf16 v[24:27], v[52:55], v[64:71], v1
    ds_read_b128 v[48:51], v0 offset:7168
    s_waitcnt lgkmcnt(3)
    v_smfmac_f32_16x16x64_bf16 v[12:15], v[44:47], a[56:63], v1
    ds_read_b128 v[52:55], v0 offset:8192
    v_smfmac_f32_16x16x64_bf16 v[16:19], v[44:47], a[64:71], v1
    ds_read_b128 v[64:67], v9 offset:14336
    v_smfmac_f32_16x16x64_bf16 v[20:23], v[44:47], a[72:79], v1
    ds_read_b128 v[68:71], v9 offset:15360
    s_waitcnt lgkmcnt(4)
    v_smfmac_f32_16x16x64_bf16 v[24:27], v[44:47], v[56:63], v1
    s_waitcnt lgkmcnt(3)
    v_smfmac_f32_16x16x64_bf16 v[12:15], v[48:51], a[96:103], v1
    v_smfmac_f32_16x16x64_bf16 v[16:19], v[48:51], a[104:111], v1
    ds_read_b128 v[56:59], v9 offset:16384
    s_waitcnt lgkmcnt(3)
    v_smfmac_f32_16x16x64_bf16 v[12:15], v[52:55], a[136:143], v1
    ds_read_b128 v[60:63], v9 offset:17408
    v_smfmac_f32_16x16x64_bf16 v[16:19], v[52:55], a[144:151], v1
    v_smfmac_f32_16x16x64_bf16 v[20:23], v[48:51], a[112:119], v1
    s_waitcnt lgkmcnt(2)
    v_smfmac_f32_16x16x64_bf16 v[24:27], v[48:51], v[64:71], v1
    ds_read_b128 v[64:67], v0 offset:9216
    s_nop 1
    v_add_f32 v12, v12, v14
    v_smfmac_f32_16x16x64_bf16 v[20:23], v[52:55], a[152:159], v1
    ds_read_b128 v[68:71], v0 offset:10240
    v_add_f32 v16, v16, v18
    s_waitcnt lgkmcnt(2)
    v_smfmac_f32_16x16x64_bf16 v[24:27], v[52:55], v[56:63], v1
    ds_read_b128 v[56:59], v0 offset:11264
    v_add_f32 v13, v13, v15
    v_add_f32 v17, v17, v19
    v_cvt_pk_bf16_f32 v14, v12, v16
    v_cvt_pk_bf16_f32 v15, v13, v17
    ds_write_b32 v2, v14 offset:17408
    ds_write_b32 v2, v15 offset:17696
    v_smfmac_f32_16x16x64_bf16 v[28:31], v[52:55], a[160:167], v1
    ds_read_b128 v[60:63], v0 offset:12288
    v_add_f32 v20, v20, v22
    v_add_f32 v24, v24, v26
    v_add_f32 v21, v21, v23
    v_add_f32 v25, v25, v27
    v_smfmac_f32_16x16x64_bf16 v[32:35], v[52:55], a[168:175], v1
    ds_read_b128 v[12:15], v0 offset:2048
    v_cvt_pk_bf16_f32 v22, v20, v24
    v_cvt_pk_bf16_f32 v23, v21, v25
    ds_write_b32 v2, v22 offset:19712
    ds_write_b32 v2, v23 offset:20000
    v_smfmac_f32_16x16x64_bf16 v[28:31], v[48:51], a[120:127], v1
    ds_read_b128 v[16:19], v0 offset:3072
    v_smfmac_f32_16x16x64_bf16 v[32:35], v[48:51], a[128:135], v1
    ds_read_b128 v[20:23], v0 offset:0
    v_smfmac_f32_16x16x64_bf16 v[28:31], v[44:47], a[80:87], v1
    ds_read_b128 v[24:27], v0 offset:1024
    v_smfmac_f32_16x16x64_bf16 v[32:35], v[44:47], a[88:95], v1
    s_waitcnt lgkmcnt(3)
    s_barrier
    ds_read_b128 v[44:47], v3 offset:17408
    v_smfmac_f32_16x16x64_bf16 v[28:31], v[12:15], v[176:183], v1
    ds_read_b128 v[52:55], v0 offset:4096
    v_smfmac_f32_16x16x64_bf16 v[32:35], v[12:15], v[184:191], v1
    ds_read_b128 v[12:15], v3 offset:19712
    s_waitcnt lgkmcnt(5)
    v_smfmac_f32_16x16x64_bf16 v[28:31], v[16:19], v[216:223], v1
    ds_read_b128 v[48:51], v0 offset:5120
    v_smfmac_f32_16x16x64_bf16 v[32:35], v[16:19], v[224:231], v1
    s_waitcnt lgkmcnt(5)
    v_smfmac_f32_16x16x64_bf16 v[28:31], v[20:23], v[96:103], v1
    v_smfmac_f32_16x16x64_bf16 v[32:35], v[20:23], v[104:111], v1
    ds_read_b128 v[20:23], v3 offset:17472
    s_waitcnt lgkmcnt(5)
    v_smfmac_f32_16x16x64_bf16 v[28:31], v[24:27], v[136:143], v1
    v_smfmac_f32_16x16x64_bf16 v[32:35], v[24:27], v[144:151], v1
    s_waitcnt lgkmcnt(3)
    v_smfmac_f32_16x16x64_bf16 v[28:31], v[52:55], a[0:7], v1
    v_smfmac_f32_16x16x64_bf16 v[32:35], v[52:55], a[8:15], v1
    ds_read_b128 v[52:55], v3 offset:19776
    s_waitcnt lgkmcnt(2)
    v_smfmac_f32_16x16x64_bf16 v[28:31], v[48:51], a[40:47], v1
    v_smfmac_f32_16x16x64_bf16 v[32:35], v[48:51], a[48:55], v1
    ds_read_b128 v[48:51], v3 offset:17536
    v_mfma_f32_16x16x32_bf16 v[24:27], v[12:15], v[44:47], 0
    v_mfma_f32_16x16x32_bf16 v[12:15], v[64:67], v[44:47], 0
    ds_read_b128 v[64:67], v0 offset:13312
    v_mfma_f32_16x16x32_bf16 v[16:19], v[68:71], v[44:47], 0
    ds_read_b128 v[68:71], v0 offset:14336
    s_waitcnt lgkmcnt(3)
    v_mfma_f32_16x16x32_bf16 v[24:27], v[52:55], v[20:23], v[24:27]
    ds_read_b128 v[44:47], v3 offset:19840
    v_add_f32 v28, v28, v30
    v_add_f32 v29, v29, v31
    v_mfma_f32_16x16x32_bf16 v[12:15], v[56:59], v[20:23], v[12:15]
    ds_read_b128 v[52:55], v3 offset:17600
    v_add_f32 v32, v32, v34
    v_add_f32 v33, v33, v35
    v_mfma_f32_16x16x32_bf16 v[16:19], v[60:63], v[20:23], v[16:19]
    ds_read_b128 v[56:59], v0 offset:15360
    v_cvt_pk_bf16_f32 v30, v28, v29
    v_cvt_pk_bf16_f32 v31, v32, v33
    s_waitcnt lgkmcnt(2)
    v_mfma_f32_16x16x32_bf16 v[24:27], v[44:47], v[48:51], v[24:27]
    ds_read_b128 v[20:23], v3 offset:19904
    v_lshrrev_b32 v10, 8, v0
    v_mul_u32_u24 v10, 288, v10
    v_mfma_f32_16x16x32_bf16 v[12:15], v[64:67], v[48:51], v[12:15]
    ds_read_b128 v[60:63], v0 offset:16384
    v_and_b32 v11, 0xf0, v0
    v_add_u32 v10, v10, v11
    v_mfma_f32_16x16x32_bf16 v[16:19], v[68:71], v[48:51], v[16:19]
    ds_read_b128 v[32:35], v10 offset:20288
    v_lshrrev_b32 v11, 1, v0
    v_bfi_b32 v30, 1, s66, v30
    s_waitcnt lgkmcnt(2)
    v_mfma_f32_16x16x32_bf16 v[24:27], v[20:23], v[52:55], v[24:27]
    buffer_store_dwordx2 v[30:31], v11, s[8:11], s43 offen offset:2048 sc1
    v_mov_b32 v49, 0
    v_mov_b32 v50, 0
    v_mfma_f32_16x16x32_bf16 v[12:15], v[56:59], v[52:55], v[12:15]
    v_mov_b64 v[64:65], s[68:69]
    v_mov_b64 v[66:67], s[68:69]
    s_waitcnt lgkmcnt(1)
    v_mfma_f32_16x16x32_bf16 v[16:19], v[60:63], v[52:55], v[16:19]
    s_waitcnt lgkmcnt(0)
    v_bfi_b32 v32, 1, s66, v32
    s_mov_b64 exec, s[52:53]
    buffer_store_dwordx4 v[32:35], v0, s[8:11], s43 offen sc1
    s_mov_b64 exec, -1
    v_max3_f32 v10, v24, v25, v12
    v_max3_f32 v10, v10, v13, v14
    s_nop 0
    v_max3_f32 v10, v10, v15, v16
    v_max3_f32 v10, v10, v17, v18
    v_max_f32 v10, v10, v19
    v_mov_b32 v11, v10
    s_nop 1
    v_permlane32_swap_b32 v10, v11
    v_max_f32 v10, v10, v11
    v_mov_b32 v11, v10
    s_nop 1
    v_permlane16_swap_b32 v10, v11
    v_max_f32 v10, v10, v11
    v_mul_f32 v20, s46, v10
    v_pk_fma_f32 v[24:25], v[24:25], s[46:47], v[20:21] op_sel_hi:[1,1,0] neg_lo:[0,0,1] neg_hi:[0,0,1]
    v_pk_fma_f32 v[12:13], v[12:13], s[46:47], v[20:21] op_sel_hi:[1,1,0] neg_lo:[0,0,1] neg_hi:[0,0,1]
    v_exp_f32 v24, v24
    v_exp_f32 v25, v25
    v_pk_fma_f32 v[14:15], v[14:15], s[46:47], v[20:21] op_sel_hi:[1,1,0] neg_lo:[0,0,1] neg_hi:[0,0,1]
    v_exp_f32 v12, v12
    v_exp_f32 v13, v13
    v_pk_fma_f32 v[16:17], v[16:17], s[46:47], v[20:21] op_sel_hi:[1,1,0] neg_lo:[0,0,1] neg_hi:[0,0,1]
    v_cvt_pk_bf16_f32 v48, v24, v25
    v_exp_f32 v14, v14
    v_pk_fma_f32 v[18:19], v[18:19], s[46:47], v[20:21] op_sel_hi:[1,1,0] neg_lo:[0,0,1] neg_hi:[0,0,1]
    v_cvt_pk_bf16_f32 v51, v24, v25
    v_exp_f32 v15, v15
    v_cvt_pk_bf16_f32 v44, v12, v13
    v_exp_f32 v16, v16
    v_exp_f32 v17, v17
    v_cvt_pk_bf16_f32 v45, v14, v15
    v_exp_f32 v18, v18
    v_exp_f32 v19, v19
    v_cvt_pk_bf16_f32 v46, v16, v17
    v_cvt_pk_bf16_f32 v47, v18, v19
    v_mfma_f32_16x16x16_bf16 v[68:71], v[64:65], v[48:49], 0
    v_mfma_f32_16x16x16_bf16 v[52:55], v[30:31], v[48:49], 0
    v_mfma_f32_16x16x16_bf16 v[56:59], v[30:31], v[50:51], 0
    v_mfma_f32_16x16x32_bf16 v[68:71], v[64:67], v[44:47], v[68:71]
    s_waitcnt vmcnt(3)
    v_mfma_f32_16x16x32_bf16 v[52:55], v[36:39], v[44:47], v[52:55]
    s_waitcnt vmcnt(2)
    v_mfma_f32_16x16x32_bf16 v[56:59], v[40:43], v[44:47], v[56:59]
    ds_read_b128 v[36:39], v0 offset:38912
    ds_read_b128 v[40:43], v0 offset:39936
    ds_read_b128 v[60:63], v9 offset:24576
    s_nop 0
    v_rcp_f32 v10, v68
    s_nop 0
    v_pk_mul_f32 v[52:53], v[52:53], v[10:11] op_sel_hi:[1,0]
    s_nop 0
    v_pk_mul_f32 v[56:57], v[56:57], v[10:11] op_sel_hi:[1,0]
    v_cvt_pk_bf16_f32 v16, v52, v56
    v_cvt_pk_bf16_f32 v17, v53, v57
    v_pk_mul_f32 v[54:55], v[54:55], v[10:11] op_sel_hi:[1,0]
    v_pk_mul_f32 v[58:59], v[58:59], v[10:11] op_sel_hi:[1,0]
    v_cvt_pk_bf16_f32 v18, v54, v58
    v_cvt_pk_bf16_f32 v19, v55, v59
    ds_write_b128 v3, v[16:19] offset:22080
    ds_read_b128 v[64:67], v9 offset:25600
    v_mov_b64 v[12:13], 0
    v_mov_b64 v[14:15], 0
    v_mov_b64 v[20:21], 0
    v_mov_b64 v[22:23], 0
    v_mov_b64 v[24:25], 0
    v_mov_b64 v[26:27], 0
    v_mov_b64 v[32:33], 0
    v_mov_b64 v[34:35], 0
    v_mov_b64 v[44:45], 0
    v_mov_b64 v[46:47], 0
    v_mov_b64 v[48:49], 0
    v_mov_b64 v[50:51], 0
    s_waitcnt lgkmcnt(1)
    s_barrier
    ds_read_b128 v[52:55], v4 offset:22016
    ds_read_b128 v[56:59], v4 offset:22144
    v_mov_b64 v[68:69], 0
    v_mov_b64 v[70:71], 0
    v_mov_b64 v[28:29], 0
    v_mov_b64 v[30:31], 0
    v_mov_b64 v[16:17], 0
    v_mov_b64 v[18:19], 0
    s_cmp_eq_u32 s33, 63
    s_cbranch_scc1 Lr1s_last
    s_waitcnt lgkmcnt(1)
    v_smfmac_f32_16x16x64_bf16 v[28:31], v[52:55], v[60:67], v1
    ds_read_b128 v[60:63], v0 offset:32768
    s_waitcnt lgkmcnt(1)
    v_smfmac_f32_16x16x64_bf16 v[28:31], v[56:59], v[36:43], v1
    ds_read_b128 v[64:67], v0 offset:33792
    ds_read_b128 v[36:39], v9 offset:18432
    v_smfmac_f32_16x16x64_bf16 v[12:15], v[52:55], a[176:183], v1
    ds_read_b128 v[40:43], v9 offset:19456
    v_smfmac_f32_16x16x64_bf16 v[12:15], v[56:59], a[184:191], v1
    buffer_load_dwordx4 v0, s[8:11], s41 offen offset:0 lds
    v_smfmac_f32_16x16x64_bf16 v[20:23], v[52:55], a[192:199], v1
    s_nop 0
    v_add_f32 v28, v28, v30
    v_add_f32 v29, v29, v31
    s_waitcnt lgkmcnt(2)
    v_smfmac_f32_16x16x64_bf16 v[20:23], v[56:59], v[60:67], v1
    ds_read_b128 v[60:63], v9 offset:20480
    v_cvt_pk_bf16_f32 v28, v28, v29
    v_bfi_b32 v28, 1, s39, v28
    buffer_store_dword v28, v8, s[8:11], s38 offen offset:2048 sc1
    s_waitcnt lgkmcnt(1)
    v_smfmac_f32_16x16x64_bf16 v[24:27], v[52:55], v[36:43], v1
    ds_read_b128 v[64:67], v9 offset:21504
    ds_read_b128 v[36:39], v0 offset:34816
    v_add_f32 v12, v12, v14
    v_add_f32 v13, v13, v15
    v_smfmac_f32_16x16x64_bf16 v[24:27], v[56:59], a[200:207], v1
    ds_read_b128 v[40:43], v0 offset:35840
    v_cvt_pk_bf16_f32 v12, v12, v13
    v_bfi_b32 v12, 1, s39, v12
    v_smfmac_f32_16x16x64_bf16 v[32:35], v[52:55], a[208:215], v1
    buffer_load_dwordx4 v0, s[8:11], s41 offen offset:1024 lds
    v_add_f32 v20, v20, v22
    v_add_f32 v21, v21, v23
    v_smfmac_f32_16x16x64_bf16 v[32:35], v[56:59], a[216:223], v1
    v_cvt_pk_bf16_f32 v13, v20, v21
    s_waitcnt lgkmcnt(2)
    v_smfmac_f32_16x16x64_bf16 v[44:47], v[52:55], v[60:67], v1
    ds_read_b128 v[60:63], v0 offset:36864
    v_add_f32 v24, v24, v26
    v_add_f32 v25, v25, v27
    s_waitcnt lgkmcnt(1)
    v_smfmac_f32_16x16x64_bf16 v[44:47], v[56:59], v[36:43], v1
    ds_read_b128 v[64:67], v0 offset:37888
    ds_read_b128 v[36:39], v9 offset:22528
    v_cvt_pk_bf16_f32 v14, v24, v25
    v_smfmac_f32_16x16x64_bf16 v[48:51], v[52:55], a[224:231], v1
    ds_read_b128 v[40:43], v9 offset:23552
    v_add_f32 v32, v32, v34
    v_add_f32 v33, v33, v35
    v_smfmac_f32_16x16x64_bf16 v[48:51], v[56:59], a[232:239], v1
    v_cvt_pk_bf16_f32 v15, v32, v33
    buffer_store_dwordx4 v[12:15], v0, s[8:11], s38 offen offset:0 sc1
    v_smfmac_f32_16x16x64_bf16 v[68:71], v[52:55], a[240:247], v1
    v_add_f32 v44, v44, v46
    v_add_f32 v45, v45, v47
    s_waitcnt lgkmcnt(2)
    v_smfmac_f32_16x16x64_bf16 v[68:71], v[56:59], v[60:67], v1
    v_cvt_pk_bf16_f32 v44, v44, v45
    v_bfi_b32 v44, 1, s39, v44
    s_waitcnt lgkmcnt(0)
    v_smfmac_f32_16x16x64_bf16 v[16:19], v[52:55], v[36:43], v1
    v_add_f32 v48, v48, v50
    v_add_f32 v49, v49, v51
    v_smfmac_f32_16x16x64_bf16 v[16:19], v[56:59], a[248:255], v1
    v_cvt_pk_bf16_f32 v45, v48, v49
    v_add_f32 v68, v68, v70
    v_add_f32 v69, v69, v71
    v_cvt_pk_bf16_f32 v46, v68, v69
    s_nop 3
    v_add_f32 v16, v16, v18
    v_add_f32 v17, v17, v19
    v_cvt_pk_bf16_f32 v47, v16, v17
    buffer_store_dwordx4 v[44:47], v0, s[8:11], s38 offen offset:1024 sc1
    v_bfe_u32 v10, v0, 4, 4
    v_mov_b32 v11, 0x3f80
    v_mov_b32 v40, 0x3f800000
    v_cmp_eq_u32 vcc, 0, v10
    v_cmp_eq_u32 s[48:49], 1, v10
    s_nop 0
    v_cndmask_b32 v36, 0, v11, vcc
    v_cndmask_b32 v36, v36, v40, s[48:49]
    v_cmp_eq_u32 vcc, 2, v10
    v_cmp_eq_u32 s[48:49], 3, v10
    s_nop 0
    v_cndmask_b32 v37, 0, v11, vcc
    v_cndmask_b32 v37, v37, v40, s[48:49]
    v_cmp_eq_u32 vcc, 4, v10
    v_cmp_eq_u32 s[48:49], 5, v10
    s_nop 0
    v_cndmask_b32 v38, 0, v11, vcc
    v_cndmask_b32 v38, v38, v40, s[48:49]
    v_cmp_eq_u32 vcc, 6, v10
    v_cmp_eq_u32 s[48:49], 7, v10
    s_nop 0
    v_cndmask_b32 v39, 0, v11, vcc
    v_cndmask_b32 v39, v39, v40, s[48:49]
    s_sleep 5
    buffer_load_dwordx4 v[52:55], v6, s[8:11], s57 offen sc1
    buffer_load_dwordx4 v[56:59], v6, s[8:11], s58 offen sc1
    buffer_load_dwordx4 v[60:63], v6, s[8:11], s59 offen sc1
    buffer_load_dwordx4 v[64:67], v6, s[8:11], s60 offen sc1
    s_mov_b32 s16, 0
    s_mov_b64 s[70:71], 0
    s_mov_b64 s[72:73], 0
    s_mov_b64 s[74:75], 0
    s_mov_b64 s[76:77], 0
Lr1s_p1:
    s_mov_b64 exec, s[70:71]
    buffer_load_dwordx4 v[52:55], v6, s[8:11], s57 offen sc1
    s_mov_b64 exec, s[72:73]
    buffer_load_dwordx4 v[56:59], v6, s[8:11], s58 offen sc1
    s_mov_b64 exec, s[74:75]
    buffer_load_dwordx4 v[60:63], v6, s[8:11], s59 offen sc1
    s_mov_b64 exec, s[76:77]
    buffer_load_dwordx4 v[64:67], v6, s[8:11], s60 offen sc1
    s_mov_b64 exec, -1
    s_add_u32 s16, s16, 1
    s_cmp_gt_u32 s16, 100000
    s_cbranch_scc1 Lr_abort
    s_waitcnt vmcnt(7)
    v_and_b32 v11, 1, v52
    v_cmp_ne_u32 s[70:71], s39, v11
    v_mfma_f32_16x16x32_bf16 v[40:43], v[52:55], v[36:39], 0
    s_waitcnt vmcnt(6)
    v_and_b32 v11, 1, v56
    v_cmp_ne_u32 s[72:73], s39, v11
    v_mfma_f32_16x16x32_bf16 v[40:43], v[56:59], v[36:39], v[40:43]
    s_waitcnt vmcnt(5)
    v_and_b32 v11, 1, v60
    v_cmp_ne_u32 s[74:75], s39, v11
    v_mfma_f32_16x16x32_bf16 v[40:43], v[60:63], v[36:39], v[40:43]
    s_or_b64 vcc, s[70:71], s[72:73]
    s_waitcnt vmcnt(4)
    v_and_b32 v11, 1, v64
    v_cmp_ne_u32 s[76:77], s39, v11
    v_mfma_f32_16x16x32_bf16 v[40:43], v[64:67], v[36:39], v[40:43]
    s_or_b64 vcc, vcc, s[74:75]
    s_or_b64 vcc, vcc, s[76:77]
    s_cbranch_scc1 Lr1s_p1
    s_nop 4
    v_permlane16_swap_b32 v40, v42
    v_permlane16_swap_b32 v41, v43
    s_mov_b64 exec, s[50:51]
    v_add_f32 v40, v40, v42
    v_add_f32 v41, v41, v43
    v_cvt_pk_bf16_f32 v40, v40, v41
    v_min_u32 v40, s54, v40
    buffer_store_dword v40, v7, s[8:11], s36 offen sc1
    v_mov_b32 v41, -1
    buffer_store_dword v41, v7, s[8:11], s37 offen sc1
    s_mov_b64 exec, -1
    s_xor_b32 s34, s34, 16384
    s_xor_b32 s35, s35, 16384
    s_barrier
    s_sleep 2
    buffer_load_dwordx4 v[44:47], v0, s[8:11], s34 offen sc1
    buffer_load_dwordx4 v[48:51], v0, s[8:11], s34 offen offset:1024 sc1
    buffer_load_dword v10, v8, s[8:11], s35 offen sc1
    s_add_u32 s33, s33, 1
    s_bfe_u32 s39, s33, 0x10001
    s_xor_b32 s38, s38, 524288
    s_xor_b32 s57, s57, 524288
    s_xor_b32 s58, s58, 524288
    s_xor_b32 s59, s59, 524288
    s_xor_b32 s60, s60, 524288
    s_xor_b32 s36, s36, 16384
    s_xor_b32 s37, s37, 16384
    s_and_b32 s17, s33, 7
    s_mul_i32 s17, s17, 131072
    s_add_u32 s43, s45, s17
    s_bfe_u32 s66, s33, 65539
    s_add_u32 s67, s67, 22528
    s_add_u32 s42, s42, 262144
    s_add_u32 s41, s41, 262144
    s_add_u32 s40, s40, 262144
    s_add_u32 s44, s44, 22528
    s_waitcnt vmcnt(5)
    ds_read_b128 v[56:59], v9 offset:4096
    ds_read_b128 v[60:63], v9 offset:5120
    ds_read_b128 v[64:67], v9 offset:6144
    ds_read_b128 v[68:71], v9 offset:7168
    v_mov_b64 v[12:13], 0
    v_mov_b64 v[14:15], 0
    v_mov_b64 v[16:17], 0
    v_mov_b64 v[18:19], 0
    v_mov_b64 v[20:21], 0
    v_mov_b64 v[22:23], 0
    v_mov_b64 v[24:25], 0
    v_mov_b64 v[26:27], 0
    v_mov_b64 v[28:29], 0
    v_mov_b64 v[30:31], 0
    v_mov_b64 v[32:33], 0
    v_mov_b64 v[34:35], 0
    s_waitcnt lgkmcnt(0)
    s_branch Lr1s_step
Lr1s_last:
    s_waitcnt vmcnt(0) lgkmcnt(0)
    s_branch Lr_exit
L_w2_0:
    s_cmp_lg_u32 s14, 2
    s_cbranch_scc1 L_w3_0
    s_barrier
    s_mov_b32 m0, 13312
    s_nop 0
    buffer_load_dwordx4 v0, s[8:11], s41 offen offset:0 lds
    buffer_load_dwordx4 v0, s[8:11], s41 offen offset:1024 lds
    s_add_u32 s41, s41, 262144
    s_waitcnt vmcnt(0)
    buffer_load_dwordx4 v[44:47], v0, s[8:11], s34 offen sc1
    buffer_load_dwordx4 v[48:51], v0, s[8:11], s34 offen offset:1024 sc1
    buffer_load_dword v10, v8, s[8:11], s35 offen sc1
    ds_read_b128 v[56:59], v9 offset:8192
    ds_read_b128 v[60:63], v9 offset:9216
    ds_read_b128 v[64:67], v9 offset:10240
    ds_read_b128 v[68:71], v9 offset:11264
    v_mov_b64 v[12:13], 0
    v_mov_b64 v[14:15], 0
    v_mov_b64 v[16:17], 0
    v_mov_b64 v[18:19], 0
    v_mov_b64 v[20:21], 0
    v_mov_b64 v[22:23], 0
    v_mov_b64 v[24:25], 0
    v_mov_b64 v[26:27], 0
    v_mov_b64 v[28:29], 0
    v_mov_b64 v[30:31], 0
    v_mov_b64 v[32:33], 0
    v_mov_b64 v[34:35], 0
    s_waitcnt lgkmcnt(0)
Lr2s_step:
    s_mov_b32 s16, 0
    s_mov_b64 s[70:71], 0
    s_mov_b64 s[72:73], 0
    s_mov_b64 s[74:75], 0
Lr2s_p2:
    s_mov_b64 exec, s[70:71]
    buffer_load_dwordx4 v[44:47], v0, s[8:11], s34 offen sc1
    s_mov_b64 exec, s[72:73]
    buffer_load_dwordx4 v[48:51], v0, s[8:11], s34 offen offset:1024 sc1
    s_mov_b64 exec, s[74:75]
    buffer_load_dword v10, v8, s[8:11], s35 offen sc1
    s_mov_b64 exec, -1
    s_add_u32 s16, s16, 1
    s_cmp_gt_u32 s16, 100000
    s_cbranch_scc1 Lr_abort
    s_waitcnt vmcnt(5)
    v_max3_u32 v11, v44, v45, v46
    v_max_u32 v11, v11, v47
    v_cmp_eq_u32 s[70:71], -1, v11
    s_waitcnt vmcnt(4)
    v_max3_u32 v11, v48, v49, v50
    v_max_u32 v11, v11, v51
    v_cmp_eq_u32 s[72:73], -1, v11
    s_waitcnt vmcnt(3)
    v_cmp_eq_u32 s[74:75], -1, v10
    s_or_b64 vcc, s[70:71], s[72:73]
    s_or_b64 vcc, vcc, s[74:75]
    s_cbranch_scc1 Lr2s_p2
    v_smfmac_f32_16x16x64_bf16 v[12:15], v[44:47], v[232:239], v1
    ds_write_b128 v0, v[44:47] offset:4096
    v_smfmac_f32_16x16x64_bf16 v[16:19], v[44:47], v[240:247], v1
    ds_write_b128 v0, v[48:51] offset:5120
    v_smfmac_f32_16x16x64_bf16 v[20:23], v[44:47], v[248:255], v1
    ds_write_b32 v8, v10 offset:8704
    v_smfmac_f32_16x16x64_bf16 v[24:27], v[44:47], v[56:63], v1
    s_waitcnt lgkmcnt(0)
    s_barrier
    ds_read_b128 v[52:55], v0 offset:0
    v_smfmac_f32_16x16x64_bf16 v[12:15], v[48:51], a[16:23], v1
    ds_read_b128 v[36:39], v0 offset:1024
    v_smfmac_f32_16x16x64_bf16 v[16:19], v[48:51], a[24:31], v1
    ds_read_b128 v[56:59], v9 offset:0
    v_smfmac_f32_16x16x64_bf16 v[20:23], v[48:51], a[32:39], v1
    ds_read_b128 v[60:63], v9 offset:1024
    v_smfmac_f32_16x16x64_bf16 v[24:27], v[48:51], v[64:71], v1
    ds_read_b128 v[40:43], v0 offset:2048
    s_waitcnt lgkmcnt(4)
    v_smfmac_f32_16x16x64_bf16 v[12:15], v[52:55], v[72:79], v1
    v_smfmac_f32_16x16x64_bf16 v[16:19], v[52:55], v[80:87], v1
    ds_read_b128 v[64:67], v9 offset:2048
    v_smfmac_f32_16x16x64_bf16 v[20:23], v[52:55], v[88:95], v1
    ds_read_b128 v[68:71], v9 offset:3072
    s_waitcnt lgkmcnt(3)
    v_smfmac_f32_16x16x64_bf16 v[24:27], v[52:55], v[56:63], v1
    v_smfmac_f32_16x16x64_bf16 v[12:15], v[36:39], v[112:119], v1
    ds_read_b128 v[52:55], v0 offset:3072
    v_smfmac_f32_16x16x64_bf16 v[16:19], v[36:39], v[120:127], v1
    ds_read_b128 v[56:59], v9 offset:4096
    v_smfmac_f32_16x16x64_bf16 v[20:23], v[36:39], v[128:135], v1
    ds_read_b128 v[60:63], v9 offset:5120
    s_waitcnt lgkmcnt(3)
    v_smfmac_f32_16x16x64_bf16 v[24:27], v[36:39], v[64:71], v1
    v_smfmac_f32_16x16x64_bf16 v[12:15], v[40:43], v[152:159], v1
    buffer_load_dwordx4 v[36:39], v0, s[8:11], s42 offen
    v_smfmac_f32_16x16x64_bf16 v[16:19], v[40:43], v[160:167], v1
    ds_read_b128 v[64:67], v9 offset:6144
    v_smfmac_f32_16x16x64_bf16 v[20:23], v[40:43], v[168:175], v1
    ds_read_b128 v[68:71], v9 offset:7168
    s_waitcnt lgkmcnt(2)
    v_smfmac_f32_16x16x64_bf16 v[24:27], v[40:43], v[56:63], v1
    s_waitcnt vmcnt(1)
    ds_read_b128 v[44:47], v0 offset:6144
    v_smfmac_f32_16x16x64_bf16 v[12:15], v[52:55], v[192:199], v1
    buffer_load_dwordx4 v[40:43], v0, s[8:11], s42 offen offset:1024
    v_smfmac_f32_16x16x64_bf16 v[16:19], v[52:55], v[200:207], v1
    ds_read_b128 v[56:59], v9 offset:12288
    v_smfmac_f32_16x16x64_bf16 v[20:23], v[52:55], v[208:215], v1
    ds_read_b128 v[60:63], v9 offset:13312
    s_waitcnt lgkmcnt(3)
    v_smfmac_f32_16x16x64_bf16 v[24:27], v[52:55], v[64:71], v1
    ds_read_b128 v[48:51], v0 offset:7168
    s_waitcnt lgkmcnt(3)
    v_smfmac_f32_16x16x64_bf16 v[12:15], v[44:47], a[56:63], v1
    ds_read_b128 v[52:55], v0 offset:8192
    v_smfmac_f32_16x16x64_bf16 v[16:19], v[44:47], a[64:71], v1
    ds_read_b128 v[64:67], v9 offset:14336
    v_smfmac_f32_16x16x64_bf16 v[20:23], v[44:47], a[72:79], v1
    ds_read_b128 v[68:71], v9 offset:15360
    s_waitcnt lgkmcnt(4)
    v_smfmac_f32_16x16x64_bf16 v[24:27], v[44:47], v[56:63], v1
    s_waitcnt lgkmcnt(3)
    v_smfmac_f32_16x16x64_bf16 v[12:15], v[48:51], a[96:103], v1
    v_smfmac_f32_16x16x64_bf16 v[16:19], v[48:51], a[104:111], v1
    ds_read_b128 v[56:59], v9 offset:16384
    s_waitcnt lgkmcnt(3)
    v_smfmac_f32_16x16x64_bf16 v[12:15], v[52:55], a[136:143], v1
    ds_read_b128 v[60:63], v9 offset:17408
    v_smfmac_f32_16x16x64_bf16 v[16:19], v[52:55], a[144:151], v1
    v_smfmac_f32_16x16x64_bf16 v[20:23], v[48:51], a[112:119], v1
    s_waitcnt lgkmcnt(2)
    v_smfmac_f32_16x16x64_bf16 v[24:27], v[48:51], v[64:71], v1
    ds_read_b128 v[64:67], v0 offset:9216
    s_nop 1
    v_add_f32 v12, v12, v14
    v_smfmac_f32_16x16x64_bf16 v[20:23], v[52:55], a[152:159], v1
    ds_read_b128 v[68:71], v0 offset:10240
    v_add_f32 v16, v16, v18
    s_waitcnt lgkmcnt(2)
    v_smfmac_f32_16x16x64_bf16 v[24:27], v[52:55], v[56:63], v1
    ds_read_b128 v[56:59], v0 offset:11264
    v_add_f32 v13, v13, v15
    v_add_f32 v17, v17, v19
    v_cvt_pk_bf16_f32 v14, v12, v16
    v_cvt_pk_bf16_f32 v15, v13, v17
    ds_write_b32 v2, v14 offset:17408
    ds_write_b32 v2, v15 offset:17696
    v_smfmac_f32_16x16x64_bf16 v[28:31], v[52:55], a[160:167], v1
    ds_read_b128 v[60:63], v0 offset:12288
    v_add_f32 v20, v20, v22
    v_add_f32 v24, v24, v26
    v_add_f32 v21, v21, v23
    v_add_f32 v25, v25, v27
    v_smfmac_f32_16x16x64_bf16 v[32:35], v[52:55], a[168:175], v1
    ds_read_b128 v[12:15], v0 offset:4096
    v_cvt_pk_bf16_f32 v22, v20, v24
    v_cvt_pk_bf16_f32 v23, v21, v25
    ds_write_b32 v2, v22 offset:19712
    ds_write_b32 v2, v23 offset:20000
    v_smfmac_f32_16x16x64_bf16 v[28:31], v[48:51], a[120:127], v1
    ds_read_b128 v[16:19], v0 offset:5120
    v_smfmac_f32_16x16x64_bf16 v[32:35], v[48:51], a[128:135], v1
    ds_read_b128 v[20:23], v0 offset:0
    v_smfmac_f32_16x16x64_bf16 v[28:31], v[44:47], a[80:87], v1
    ds_read_b128 v[24:27], v0 offset:1024
    v_smfmac_f32_16x16x64_bf16 v[32:35], v[44:47], a[88:95], v1
    s_waitcnt lgkmcnt(3)
    s_barrier
    ds_read_b128 v[44:47], v3 offset:17408
    v_smfmac_f32_16x16x64_bf16 v[28:31], v[12:15], a[0:7], v1
    ds_read_b128 v[52:55], v0 offset:2048
    v_smfmac_f32_16x16x64_bf16 v[32:35], v[12:15], a[8:15], v1
    ds_read_b128 v[12:15], v3 offset:19712
    s_waitcnt lgkmcnt(5)
    v_smfmac_f32_16x16x64_bf16 v[28:31], v[16:19], a[40:47], v1
    ds_read_b128 v[48:51], v0 offset:3072
    v_smfmac_f32_16x16x64_bf16 v[32:35], v[16:19], a[48:55], v1
    s_waitcnt lgkmcnt(5)
    v_smfmac_f32_16x16x64_bf16 v[28:31], v[20:23], v[96:103], v1
    v_smfmac_f32_16x16x64_bf16 v[32:35], v[20:23], v[104:111], v1
    ds_read_b128 v[20:23], v3 offset:17472
    s_waitcnt lgkmcnt(5)
    v_smfmac_f32_16x16x64_bf16 v[28:31], v[24:27], v[136:143], v1
    v_smfmac_f32_16x16x64_bf16 v[32:35], v[24:27], v[144:151], v1
    s_waitcnt lgkmcnt(3)
    v_smfmac_f32_16x16x64_bf16 v[28:31], v[52:55], v[176:183], v1
    v_smfmac_f32_16x16x64_bf16 v[32:35], v[52:55], v[184:191], v1
    ds_read_b128 v[52:55], v3 offset:19776
    s_waitcnt lgkmcnt(2)
    v_smfmac_f32_16x16x64_bf16 v[28:31], v[48:51], v[216:223], v1
    v_smfmac_f32_16x16x64_bf16 v[32:35], v[48:51], v[224:231], v1
    ds_read_b128 v[48:51], v3 offset:17536
    v_mfma_f32_16x16x32_bf16 v[24:27], v[12:15], v[44:47], 0
    v_mfma_f32_16x16x32_bf16 v[12:15], v[64:67], v[44:47], 0
    ds_read_b128 v[64:67], v0 offset:13312
    v_mfma_f32_16x16x32_bf16 v[16:19], v[68:71], v[44:47], 0
    ds_read_b128 v[68:71], v0 offset:14336
    s_waitcnt lgkmcnt(3)
    v_mfma_f32_16x16x32_bf16 v[24:27], v[52:55], v[20:23], v[24:27]
    ds_read_b128 v[44:47], v3 offset:19840
    v_add_f32 v28, v28, v30
    v_add_f32 v29, v29, v31
    v_mfma_f32_16x16x32_bf16 v[12:15], v[56:59], v[20:23], v[12:15]
    ds_read_b128 v[52:55], v3 offset:17600
    v_add_f32 v32, v32, v34
    v_add_f32 v33, v33, v35
    v_mfma_f32_16x16x32_bf16 v[16:19], v[60:63], v[20:23], v[16:19]
    ds_read_b128 v[56:59], v0 offset:15360
    v_cvt_pk_bf16_f32 v30, v28, v29
    v_cvt_pk_bf16_f32 v31, v32, v33
    s_waitcnt lgkmcnt(2)
    v_mfma_f32_16x16x32_bf16 v[24:27], v[44:47], v[48:51], v[24:27]
    ds_read_b128 v[20:23], v3 offset:19904
    v_lshrrev_b32 v10, 8, v0
    v_mul_u32_u24 v10, 288, v10
    v_mfma_f32_16x16x32_bf16 v[12:15], v[64:67], v[48:51], v[12:15]
    ds_read_b128 v[60:63], v0 offset:16384
    v_and_b32 v11, 0xf0, v0
    v_add_u32 v10, v10, v11
    v_mfma_f32_16x16x32_bf16 v[16:19], v[68:71], v[48:51], v[16:19]
    ds_read_b128 v[32:35], v10 offset:20864
    v_lshrrev_b32 v11, 1, v0
    v_bfi_b32 v30, 1, s66, v30
    s_waitcnt lgkmcnt(2)
    v_mfma_f32_16x16x32_bf16 v[24:27], v[20:23], v[52:55], v[24:27]
    buffer_store_dwordx2 v[30:31], v11, s[8:11], s43 offen offset:2048 sc1
    v_mov_b32 v49, 0
    v_mov_b32 v50, 0
    v_mfma_f32_16x16x32_bf16 v[12:15], v[56:59], v[52:55], v[12:15]
    v_mov_b64 v[64:65], s[68:69]
    v_mov_b64 v[66:67], s[68:69]
    s_waitcnt lgkmcnt(1)
    v_mfma_f32_16x16x32_bf16 v[16:19], v[60:63], v[52:55], v[16:19]
    s_waitcnt lgkmcnt(0)
    v_bfi_b32 v32, 1, s66, v32
    s_mov_b64 exec, s[52:53]
    buffer_store_dwordx4 v[32:35], v0, s[8:11], s43 offen sc1
    s_mov_b64 exec, -1
    v_max3_f32 v10, v24, v25, v12
    v_max3_f32 v10, v10, v13, v14
    s_nop 0
    v_max3_f32 v10, v10, v15, v16
    v_max3_f32 v10, v10, v17, v18
    v_max_f32 v10, v10, v19
    v_mov_b32 v11, v10
    s_nop 1
    v_permlane32_swap_b32 v10, v11
    v_max_f32 v10, v10, v11
    v_mov_b32 v11, v10
    s_nop 1
    v_permlane16_swap_b32 v10, v11
    v_max_f32 v10, v10, v11
    v_mul_f32 v20, s46, v10
    v_pk_fma_f32 v[24:25], v[24:25], s[46:47], v[20:21] op_sel_hi:[1,1,0] neg_lo:[0,0,1] neg_hi:[0,0,1]
    v_pk_fma_f32 v[12:13], v[12:13], s[46:47], v[20:21] op_sel_hi:[1,1,0] neg_lo:[0,0,1] neg_hi:[0,0,1]
    v_exp_f32 v24, v24
    v_exp_f32 v25, v25
    v_pk_fma_f32 v[14:15], v[14:15], s[46:47], v[20:21] op_sel_hi:[1,1,0] neg_lo:[0,0,1] neg_hi:[0,0,1]
    v_exp_f32 v12, v12
    v_exp_f32 v13, v13
    v_pk_fma_f32 v[16:17], v[16:17], s[46:47], v[20:21] op_sel_hi:[1,1,0] neg_lo:[0,0,1] neg_hi:[0,0,1]
    v_cvt_pk_bf16_f32 v48, v24, v25
    v_exp_f32 v14, v14
    v_pk_fma_f32 v[18:19], v[18:19], s[46:47], v[20:21] op_sel_hi:[1,1,0] neg_lo:[0,0,1] neg_hi:[0,0,1]
    v_cvt_pk_bf16_f32 v51, v24, v25
    v_exp_f32 v15, v15
    v_cvt_pk_bf16_f32 v44, v12, v13
    v_exp_f32 v16, v16
    v_exp_f32 v17, v17
    v_cvt_pk_bf16_f32 v45, v14, v15
    v_exp_f32 v18, v18
    v_exp_f32 v19, v19
    v_cvt_pk_bf16_f32 v46, v16, v17
    v_cvt_pk_bf16_f32 v47, v18, v19
    v_mfma_f32_16x16x16_bf16 v[68:71], v[64:65], v[48:49], 0
    v_mfma_f32_16x16x16_bf16 v[52:55], v[30:31], v[48:49], 0
    v_mfma_f32_16x16x16_bf16 v[56:59], v[30:31], v[50:51], 0
    v_mfma_f32_16x16x32_bf16 v[68:71], v[64:67], v[44:47], v[68:71]
    s_waitcnt vmcnt(3)
    v_mfma_f32_16x16x32_bf16 v[52:55], v[36:39], v[44:47], v[52:55]
    s_waitcnt vmcnt(2)
    v_mfma_f32_16x16x32_bf16 v[56:59], v[40:43], v[44:47], v[56:59]
    ds_read_b128 v[36:39], v0 offset:47104
    ds_read_b128 v[40:43], v0 offset:48128
    ds_read_b128 v[60:63], v9 offset:24576
    s_nop 0
    v_rcp_f32 v10, v68
    s_nop 0
    v_pk_mul_f32 v[52:53], v[52:53], v[10:11] op_sel_hi:[1,0]
    s_nop 0
    v_pk_mul_f32 v[56:57], v[56:57], v[10:11] op_sel_hi:[1,0]
    v_cvt_pk_bf16_f32 v16, v52, v56
    v_cvt_pk_bf16_f32 v17, v53, v57
    v_pk_mul_f32 v[54:55], v[54:55], v[10:11] op_sel_hi:[1,0]
    v_pk_mul_f32 v[58:59], v[58:59], v[10:11] op_sel_hi:[1,0]
    v_cvt_pk_bf16_f32 v18, v54, v58
    v_cvt_pk_bf16_f32 v19, v55, v59
    ds_write_b128 v3, v[16:19] offset:22144
    ds_read_b128 v[64:67], v9 offset:25600
    v_mov_b64 v[12:13], 0
    v_mov_b64 v[14:15], 0
    v_mov_b64 v[20:21], 0
    v_mov_b64 v[22:23], 0
    v_mov_b64 v[24:25], 0
    v_mov_b64 v[26:27], 0
    v_mov_b64 v[32:33], 0
    v_mov_b64 v[34:35], 0
    v_mov_b64 v[44:45], 0
    v_mov_b64 v[46:47], 0
    v_mov_b64 v[48:49], 0
    v_mov_b64 v[50:51], 0
    s_waitcnt lgkmcnt(1)
    s_barrier
    ds_read_b128 v[52:55], v4 offset:22016
    ds_read_b128 v[56:59], v4 offset:22144
    v_mov_b64 v[68:69], 0
    v_mov_b64 v[70:71], 0
    v_mov_b64 v[28:29], 0
    v_mov_b64 v[30:31], 0
    v_mov_b64 v[16:17], 0
    v_mov_b64 v[18:19], 0
    s_cmp_eq_u32 s33, 63
    s_cbranch_scc1 Lr2s_last
    s_waitcnt lgkmcnt(1)
    v_smfmac_f32_16x16x64_bf16 v[28:31], v[52:55], v[60:67], v1
    ds_read_b128 v[60:63], v0 offset:40960
    s_waitcnt lgkmcnt(1)
    v_smfmac_f32_16x16x64_bf16 v[28:31], v[56:59], v[36:43], v1
    ds_read_b128 v[64:67], v0 offset:41984
    ds_read_b128 v[36:39], v9 offset:18432
    v_smfmac_f32_16x16x64_bf16 v[12:15], v[52:55], a[176:183], v1
    ds_read_b128 v[40:43], v9 offset:19456
    v_smfmac_f32_16x16x64_bf16 v[12:15], v[56:59], a[184:191], v1
    buffer_load_dwordx4 v0, s[8:11], s41 offen offset:0 lds
    v_smfmac_f32_16x16x64_bf16 v[20:23], v[52:55], a[192:199], v1
    s_nop 0
    v_add_f32 v28, v28, v30
    v_add_f32 v29, v29, v31
    s_waitcnt lgkmcnt(2)
    v_smfmac_f32_16x16x64_bf16 v[20:23], v[56:59], v[60:67], v1
    ds_read_b128 v[60:63], v9 offset:20480
    v_cvt_pk_bf16_f32 v28, v28, v29
    v_bfi_b32 v28, 1, s39, v28
    buffer_store_dword v28, v8, s[8:11], s38 offen offset:2048 sc1
    s_waitcnt lgkmcnt(1)
    v_smfmac_f32_16x16x64_bf16 v[24:27], v[52:55], v[36:43], v1
    ds_read_b128 v[64:67], v9 offset:21504
    ds_read_b128 v[36:39], v0 offset:43008
    v_add_f32 v12, v12, v14
    v_add_f32 v13, v13, v15
    v_smfmac_f32_16x16x64_bf16 v[24:27], v[56:59], a[200:207], v1
    ds_read_b128 v[40:43], v0 offset:44032
    v_cvt_pk_bf16_f32 v12, v12, v13
    v_bfi_b32 v12, 1, s39, v12
    v_smfmac_f32_16x16x64_bf16 v[32:35], v[52:55], a[208:215], v1
    buffer_load_dwordx4 v0, s[8:11], s41 offen offset:1024 lds
    v_add_f32 v20, v20, v22
    v_add_f32 v21, v21, v23
    v_smfmac_f32_16x16x64_bf16 v[32:35], v[56:59], a[216:223], v1
    v_cvt_pk_bf16_f32 v13, v20, v21
    s_waitcnt lgkmcnt(2)
    v_smfmac_f32_16x16x64_bf16 v[44:47], v[52:55], v[60:67], v1
    ds_read_b128 v[60:63], v0 offset:45056
    v_add_f32 v24, v24, v26
    v_add_f32 v25, v25, v27
    s_waitcnt lgkmcnt(1)
    v_smfmac_f32_16x16x64_bf16 v[44:47], v[56:59], v[36:43], v1
    ds_read_b128 v[64:67], v0 offset:46080
    ds_read_b128 v[36:39], v9 offset:22528
    v_cvt_pk_bf16_f32 v14, v24, v25
    v_smfmac_f32_16x16x64_bf16 v[48:51], v[52:55], a[224:231], v1
    ds_read_b128 v[40:43], v9 offset:23552
    v_add_f32 v32, v32, v34
    v_add_f32 v33, v33, v35
    v_smfmac_f32_16x16x64_bf16 v[48:51], v[56:59], a[232:239], v1
    v_cvt_pk_bf16_f32 v15, v32, v33
    buffer_store_dwordx4 v[12:15], v0, s[8:11], s38 offen offset:0 sc1
    v_smfmac_f32_16x16x64_bf16 v[68:71], v[52:55], a[240:247], v1
    v_add_f32 v44, v44, v46
    v_add_f32 v45, v45, v47
    s_waitcnt lgkmcnt(2)
    v_smfmac_f32_16x16x64_bf16 v[68:71], v[56:59], v[60:67], v1
    v_cvt_pk_bf16_f32 v44, v44, v45
    v_bfi_b32 v44, 1, s39, v44
    s_waitcnt lgkmcnt(0)
    v_smfmac_f32_16x16x64_bf16 v[16:19], v[52:55], v[36:43], v1
    v_add_f32 v48, v48, v50
    v_add_f32 v49, v49, v51
    v_smfmac_f32_16x16x64_bf16 v[16:19], v[56:59], a[248:255], v1
    v_cvt_pk_bf16_f32 v45, v48, v49
    v_add_f32 v68, v68, v70
    v_add_f32 v69, v69, v71
    v_cvt_pk_bf16_f32 v46, v68, v69
    s_nop 3
    v_add_f32 v16, v16, v18
    v_add_f32 v17, v17, v19
    v_cvt_pk_bf16_f32 v47, v16, v17
    buffer_store_dwordx4 v[44:47], v0, s[8:11], s38 offen offset:1024 sc1
    s_cmp_eq_u32 s62, 0
    s_cbranch_scc1 Lr2s_nojob
    v_bfe_u32 v10, v0, 4, 4
    v_mov_b32 v11, 0x3f80
    v_mov_b32 v40, 0x3f800000
    v_cmp_eq_u32 vcc, 0, v10
    v_cmp_eq_u32 s[48:49], 1, v10
    s_nop 0
    v_cndmask_b32 v36, 0, v11, vcc
    v_cndmask_b32 v36, v36, v40, s[48:49]
    v_cmp_eq_u32 vcc, 2, v10
    v_cmp_eq_u32 s[48:49], 3, v10
    s_nop 0
    v_cndmask_b32 v37, 0, v11, vcc
    v_cndmask_b32 v37, v37, v40, s[48:49]
    v_cmp_eq_u32 vcc, 4, v10
    v_cmp_eq_u32 s[48:49], 5, v10
    s_nop 0
    v_cndmask_b32 v38, 0, v11, vcc
    v_cndmask_b32 v38, v38, v40, s[48:49]
    v_cmp_eq_u32 vcc, 6, v10
    v_cmp_eq_u32 s[48:49], 7, v10
    s_nop 0
    v_cndmask_b32 v39, 0, v11, vcc
    v_cndmask_b32 v39, v39, v40, s[48:49]
    s_sleep 5
    buffer_load_dwordx4 v[52:55], v6, s[8:11], s57 offen sc1
    buffer_load_dwordx4 v[56:59], v6, s[8:11], s58 offen sc1
    buffer_load_dwordx4 v[60:63], v6, s[8:11], s59 offen sc1
    buffer_load_dwordx4 v[64:67], v6, s[8:11], s60 offen sc1
    s_mov_b32 s16, 0
    s_mov_b64 s[70:71], 0
    s_mov_b64 s[72:73], 0
    s_mov_b64 s[74:75], 0
    s_mov_b64 s[76:77], 0
Lr2s_p1:
    s_mov_b64 exec, s[70:71]
    buffer_load_dwordx4 v[52:55], v6, s[8:11], s57 offen sc1
    s_mov_b64 exec, s[72:73]
    buffer_load_dwordx4 v[56:59], v6, s[8:11], s58 offen sc1
    s_mov_b64 exec, s[74:75]
    buffer_load_dwordx4 v[60:63], v6, s[8:11], s59 offen sc1
    s_mov_b64 exec, s[76:77]
    buffer_load_dwordx4 v[64:67], v6, s[8:11], s60 offen sc1
    s_mov_b64 exec, -1
    s_add_u32 s16, s16, 1
    s_cmp_gt_u32 s16, 100000
    s_cbranch_scc1 Lr_abort
    s_waitcnt vmcnt(7)
    v_xor_b32 v10, v52, v53
    v_xor_b32 v11, v54, v55
    v_or_b32 v10, v10, v11
    v_xor_b32 v11, v52, v54
    v_or_b32 v10, v10, v11
    v_xor_b32 v11, s39, v52
    v_or_b32 v10, v10, v11
    v_and_b32 v10, 1, v10
    v_cmp_ne_u32 s[70:71], 0, v10
    v_mfma_f32_16x16x32_bf16 v[40:43], v[52:55], v[36:39], 0
    s_waitcnt vmcnt(6)
    v_xor_b32 v10, v56, v57
    v_xor_b32 v11, v58, v59
    v_or_b32 v10, v10, v11
    v_xor_b32 v11, v56, v58
    v_or_b32 v10, v10, v11
    v_xor_b32 v11, s39, v56
    v_or_b32 v10, v10, v11
    v_and_b32 v10, 1, v10
    v_cmp_ne_u32 s[72:73], 0, v10
    v_mfma_f32_16x16x32_bf16 v[40:43], v[56:59], v[36:39], v[40:43]
    s_waitcnt vmcnt(5)
    v_xor_b32 v10, v60, v61
    v_xor_b32 v11, v62, v63
    v_or_b32 v10, v10, v11
    v_xor_b32 v11, v60, v62
    v_or_b32 v10, v10, v11
    v_xor_b32 v11, s39, v60
    v_or_b32 v10, v10, v11
    v_and_b32 v10, 1, v10
    v_cmp_ne_u32 s[74:75], 0, v10
    v_mfma_f32_16x16x32_bf16 v[40:43], v[60:63], v[36:39], v[40:43]
    s_or_b64 vcc, s[70:71], s[72:73]
    s_waitcnt vmcnt(4)
    v_xor_b32 v10, v64, v65
    v_xor_b32 v11, v66, v67
    v_or_b32 v10, v10, v11
    v_xor_b32 v11, v64, v66
    v_or_b32 v10, v10, v11
    v_xor_b32 v11, s39, v64
    v_or_b32 v10, v10, v11
    v_and_b32 v10, 1, v10
    v_cmp_ne_u32 s[76:77], 0, v10
    v_mfma_f32_16x16x32_bf16 v[40:43], v[64:67], v[36:39], v[40:43]
    s_or_b64 vcc, vcc, s[74:75]
    s_or_b64 vcc, vcc, s[76:77]
    s_cbranch_scc1 Lr2s_p1
    s_nop 4
    v_permlane16_swap_b32 v40, v42
    v_permlane16_swap_b32 v41, v43
    s_mov_b64 exec, s[50:51]
    v_add_f32 v40, v40, v42
    v_add_f32 v41, v41, v43
    v_cvt_pk_bf16_f32 v40, v40, v41
    v_min_u32 v40, s54, v40
    buffer_store_dword v40, v7, s[8:11], s36 offen sc1
    v_mov_b32 v41, -1
    buffer_store_dword v41, v7, s[8:11], s37 offen sc1
    s_mov_b64 exec, -1
    s_branch Lr2s_jobdone
Lr2s_nojob:
Lr2s_jobdone:
    s_xor_b32 s34, s34, 16384
    s_xor_b32 s35, s35, 16384
    s_barrier
    s_sleep 2
    buffer_load_dwordx4 v[44:47], v0, s[8:11], s34 offen sc1
    buffer_load_dwordx4 v[48:51], v0, s[8:11], s34 offen offset:1024 sc1
    buffer_load_dword v10, v8, s[8:11], s35 offen sc1
    s_add_u32 s33, s33, 1
    s_bfe_u32 s39, s33, 0x10001
    s_xor_b32 s38, s38, 524288
    s_xor_b32 s57, s57, 524288
    s_xor_b32 s58, s58, 524288
    s_xor_b32 s59, s59, 524288
    s_xor_b32 s60, s60, 524288
    s_xor_b32 s36, s36, 16384
    s_xor_b32 s37, s37, 16384
    s_and_b32 s17, s33, 7
    s_mul_i32 s17, s17, 131072
    s_add_u32 s43, s45, s17
    s_bfe_u32 s66, s33, 65539
    s_add_u32 s67, s67, 22528
    s_add_u32 s42, s42, 262144
    s_add_u32 s41, s41, 262144
    s_add_u32 s40, s40, 262144
    s_add_u32 s44, s44, 22528
    s_waitcnt vmcnt(6)
    ds_read_b128 v[56:59], v9 offset:8192
    ds_read_b128 v[60:63], v9 offset:9216
    ds_read_b128 v[64:67], v9 offset:10240
    ds_read_b128 v[68:71], v9 offset:11264
    v_mov_b64 v[12:13], 0
    v_mov_b64 v[14:15], 0
    v_mov_b64 v[16:17], 0
    v_mov_b64 v[18:19], 0
    v_mov_b64 v[20:21], 0
    v_mov_b64 v[22:23], 0
    v_mov_b64 v[24:25], 0
    v_mov_b64 v[26:27], 0
    v_mov_b64 v[28:29], 0
    v_mov_b64 v[30:31], 0
    v_mov_b64 v[32:33], 0
    v_mov_b64 v[34:35], 0
    s_waitcnt lgkmcnt(0)
    s_branch Lr2s_step
Lr2s_last:
    s_waitcnt vmcnt(0) lgkmcnt(0)
    s_branch Lr_exit
L_w3_0:
    s_mov_b32 s16, 0
    s_add_u32 s17, s44, 128
    v_and_b32 v11, 16, v8
    v_lshlrev_b32 v11, 3, v11
    v_and_or_b32 v11, v8, 12, v11
Lr3s_fw_11:
    buffer_load_dword v10, v11, s[8:11], s17 offen sc1
    s_add_u32 s16, s16, 1
    s_cmp_gt_u32 s16, 100000
    s_cbranch_scc1 Lr_abort
    s_waitcnt vmcnt(0)
    v_cmp_eq_u32 vcc, 0, v10
    s_nop 0
    s_cbranch_vccz Lr3s_fw_11d
    s_sleep 4
    s_branch Lr3s_fw_11
Lr3s_fw_11d:
    s_barrier
    s_mov_b32 m0, 15360
    s_nop 0
    buffer_load_dwordx4 v0, s[8:11], s41 offen offset:0 lds
    buffer_load_dwordx4 v0, s[8:11], s41 offen offset:1024 lds
    s_add_u32 s41, s41, 262144
    s_waitcnt vmcnt(0)
    buffer_load_dwordx4 v[44:47], v0, s[8:11], s34 offen sc1
    buffer_load_dwordx4 v[48:51], v0, s[8:11], s34 offen offset:1024 sc1
    buffer_load_dword v10, v8, s[8:11], s35 offen sc1
    ds_read_b128 v[56:59], v9 offset:12288
    ds_read_b128 v[60:63], v9 offset:13312
    ds_read_b128 v[64:67], v9 offset:14336
    ds_read_b128 v[68:71], v9 offset:15360
    v_mov_b64 v[12:13], 0
    v_mov_b64 v[14:15], 0
    v_mov_b64 v[16:17], 0
    v_mov_b64 v[18:19], 0
    v_mov_b64 v[20:21], 0
    v_mov_b64 v[22:23], 0
    v_mov_b64 v[24:25], 0
    v_mov_b64 v[26:27], 0
    v_mov_b64 v[28:29], 0
    v_mov_b64 v[30:31], 0
    v_mov_b64 v[32:33], 0
    v_mov_b64 v[34:35], 0
    s_waitcnt lgkmcnt(0)
Lr3s_step:
    s_mov_b32 s16, 0
    s_mov_b64 s[70:71], 0
    s_mov_b64 s[72:73], 0
    s_mov_b64 s[74:75], 0
Lr3s_p2:
    s_mov_b64 exec, s[70:71]
    buffer_load_dwordx4 v[44:47], v0, s[8:11], s34 offen sc1
    s_mov_b64 exec, s[72:73]
    buffer_load_dwordx4 v[48:51], v0, s[8:11], s34 offen offset:1024 sc1
    s_mov_b64 exec, s[74:75]
    buffer_load_dword v10, v8, s[8:11], s35 offen sc1
    s_mov_b64 exec, -1
    s_add_u32 s16, s16, 1
    s_cmp_gt_u32 s16, 100000
    s_cbranch_scc1 Lr_abort
    s_waitcnt vmcnt(5)
    v_max3_u32 v11, v44, v45, v46
    v_max_u32 v11, v11, v47
    v_cmp_eq_u32 s[70:71], -1, v11
    s_waitcnt vmcnt(4)
    v_max3_u32 v11, v48, v49, v50
    v_max_u32 v11, v11, v51
    v_cmp_eq_u32 s[72:73], -1, v11
    s_waitcnt vmcnt(3)
    v_cmp_eq_u32 s[74:75], -1, v10
    s_or_b64 vcc, s[70:71], s[72:73]
    s_or_b64 vcc, vcc, s[74:75]
    s_cbranch_scc1 Lr3s_p2
    v_smfmac_f32_16x16x64_bf16 v[12:15], v[44:47], a[56:63], v1
    ds_write_b128 v0, v[44:47] offset:6144
    v_smfmac_f32_16x16x64_bf16 v[16:19], v[44:47], a[64:71], v1
    ds_write_b128 v0, v[48:51] offset:7168
    v_smfmac_f32_16x16x64_bf16 v[20:23], v[44:47], a[72:79], v1
    ds_write_b32 v8, v10 offset:8960
    v_smfmac_f32_16x16x64_bf16 v[24:27], v[44:47], v[56:63], v1
    s_waitcnt lgkmcnt(0)
    s_barrier
    ds_read_b128 v[52:55], v0 offset:0
    v_smfmac_f32_16x16x64_bf16 v[12:15], v[48:51], a[96:103], v1
    ds_read_b128 v[36:39], v0 offset:1024
    v_smfmac_f32_16x16x64_bf16 v[16:19], v[48:51], a[104:111], v1
    ds_read_b128 v[56:59], v9 offset:0
    v_smfmac_f32_16x16x64_bf16 v[20:23], v[48:51], a[112:119], v1
    ds_read_b128 v[60:63], v9 offset:1024
    v_smfmac_f32_16x16x64_bf16 v[24:27], v[48:51], v[64:71], v1
    ds_read_b128 v[40:43], v0 offset:2048
    s_waitcnt lgkmcnt(4)
    v_smfmac_f32_16x16x64_bf16 v[12:15], v[52:55], v[72:79], v1
    buffer_load_dword v6, v7, s[8:11], s67 offen sc1
    v_smfmac_f32_16x16x64_bf16 v[16:19], v[52:55], v[80:87], v1
    ds_read_b128 v[64:67], v9 offset:2048
    v_smfmac_f32_16x16x64_bf16 v[20:23], v[52:55], v[88:95], v1
    ds_read_b128 v[68:71], v9 offset:3072
    s_waitcnt lgkmcnt(3)
    v_smfmac_f32_16x16x64_bf16 v[24:27], v[52:55], v[56:63], v1
    v_smfmac_f32_16x16x64_bf16 v[12:15], v[36:39], v[112:119], v1
    ds_read_b128 v[52:55], v0 offset:3072
    v_smfmac_f32_16x16x64_bf16 v[16:19], v[36:39], v[120:127], v1
    ds_read_b128 v[56:59], v9 offset:4096
    v_smfmac_f32_16x16x64_bf16 v[20:23], v[36:39], v[128:135], v1
    ds_read_b128 v[60:63], v9 offset:5120
    s_waitcnt lgkmcnt(3)
    v_smfmac_f32_16x16x64_bf16 v[24:27], v[36:39], v[64:71], v1
    v_smfmac_f32_16x16x64_bf16 v[12:15], v[40:43], v[152:159], v1
    buffer_load_dwordx4 v[36:39], v0, s[8:11], s42 offen
    v_smfmac_f32_16x16x64_bf16 v[16:19], v[40:43], v[160:167], v1
    ds_read_b128 v[64:67], v9 offset:6144
    v_smfmac_f32_16x16x64_bf16 v[20:23], v[40:43], v[168:175], v1
    ds_read_b128 v[68:71], v9 offset:7168
    s_waitcnt lgkmcnt(2)
    v_smfmac_f32_16x16x64_bf16 v[24:27], v[40:43], v[56:63], v1
    s_waitcnt vmcnt(2)
    ds_read_b128 v[44:47], v0 offset:4096
    v_smfmac_f32_16x16x64_bf16 v[12:15], v[52:55], v[192:199], v1
    buffer_load_dwordx4 v[40:43], v0, s[8:11], s42 offen offset:1024
    v_smfmac_f32_16x16x64_bf16 v[16:19], v[52:55], v[200:207], v1
    ds_read_b128 v[56:59], v9 offset:8192
    v_smfmac_f32_16x16x64_bf16 v[20:23], v[52:55], v[208:215], v1
    ds_read_b128 v[60:63], v9 offset:9216
    s_waitcnt lgkmcnt(3)
    v_smfmac_f32_16x16x64_bf16 v[24:27], v[52:55], v[64:71], v1
    ds_read_b128 v[48:51], v0 offset:5120
    s_waitcnt lgkmcnt(3)
    v_smfmac_f32_16x16x64_bf16 v[12:15], v[44:47], v[232:239], v1
    ds_read_b128 v[52:55], v0 offset:8192
    v_smfmac_f32_16x16x64_bf16 v[16:19], v[44:47], v[240:247], v1
    ds_read_b128 v[64:67], v9 offset:10240
    v_smfmac_f32_16x16x64_bf16 v[20:23], v[44:47], v[248:255], v1
    ds_read_b128 v[68:71], v9 offset:11264
    s_waitcnt lgkmcnt(4)
    v_smfmac_f32_16x16x64_bf16 v[24:27], v[44:47], v[56:63], v1
    s_waitcnt lgkmcnt(3)
    v_smfmac_f32_16x16x64_bf16 v[12:15], v[48:51], a[16:23], v1
    v_smfmac_f32_16x16x64_bf16 v[16:19], v[48:51], a[24:31], v1
    ds_read_b128 v[56:59], v9 offset:16384
    s_waitcnt lgkmcnt(3)
    v_smfmac_f32_16x16x64_bf16 v[12:15], v[52:55], a[136:143], v1
    ds_read_b128 v[60:63], v9 offset:17408
    v_smfmac_f32_16x16x64_bf16 v[16:19], v[52:55], a[144:151], v1
    v_smfmac_f32_16x16x64_bf16 v[20:23], v[48:51], a[32:39], v1
    s_waitcnt lgkmcnt(2)
    v_smfmac_f32_16x16x64_bf16 v[24:27], v[48:51], v[64:71], v1
    ds_read_b128 v[64:67], v0 offset:9216
    s_nop 1
    v_add_f32 v12, v12, v14
    v_smfmac_f32_16x16x64_bf16 v[20:23], v[52:55], a[152:159], v1
    ds_read_b128 v[68:71], v0 offset:10240
    v_add_f32 v16, v16, v18
    s_waitcnt lgkmcnt(2)
    v_smfmac_f32_16x16x64_bf16 v[24:27], v[52:55], v[56:63], v1
    ds_read_b128 v[56:59], v0 offset:11264
    v_add_f32 v13, v13, v15
    v_add_f32 v17, v17, v19
    v_cvt_pk_bf16_f32 v14, v12, v16
    v_cvt_pk_bf16_f32 v15, v13, v17
    ds_write_b32 v2, v14 offset:17408
    ds_write_b32 v2, v15 offset:17696
    v_smfmac_f32_16x16x64_bf16 v[28:31], v[52:55], a[160:167], v1
    ds_read_b128 v[60:63], v0 offset:12288
    v_add_f32 v20, v20, v22
    v_add_f32 v24, v24, v26
    v_add_f32 v21, v21, v23
    v_add_f32 v25, v25, v27
    v_smfmac_f32_16x16x64_bf16 v[32:35], v[52:55], a[168:175], v1
    ds_read_b128 v[12:15], v0 offset:6144
    v_cvt_pk_bf16_f32 v22, v20, v24
    v_cvt_pk_bf16_f32 v23, v21, v25
    ds_write_b32 v2, v22 offset:19712
    ds_write_b32 v2, v23 offset:20000
    v_smfmac_f32_16x16x64_bf16 v[28:31], v[48:51], a[40:47], v1
    ds_read_b128 v[16:19], v0 offset:7168
    v_smfmac_f32_16x16x64_bf16 v[32:35], v[48:51], a[48:55], v1
    ds_read_b128 v[20:23], v0 offset:0
    v_smfmac_f32_16x16x64_bf16 v[28:31], v[44:47], a[0:7], v1
    ds_read_b128 v[24:27], v0 offset:1024
    v_smfmac_f32_16x16x64_bf16 v[32:35], v[44:47], a[8:15], v1
    s_waitcnt lgkmcnt(3)
    s_barrier
    ds_read_b128 v[44:47], v3 offset:17408
    v_smfmac_f32_16x16x64_bf16 v[28:31], v[12:15], a[80:87], v1
    ds_read_b128 v[52:55], v0 offset:2048
    v_smfmac_f32_16x16x64_bf16 v[32:35], v[12:15], a[88:95], v1
    ds_read_b128 v[12:15], v3 offset:19712
    s_waitcnt lgkmcnt(5)
    v_smfmac_f32_16x16x64_bf16 v[28:31], v[16:19], a[120:127], v1
    ds_read_b128 v[48:51], v0 offset:3072
    v_smfmac_f32_16x16x64_bf16 v[32:35], v[16:19], a[128:135], v1
    s_waitcnt lgkmcnt(5)
    v_smfmac_f32_16x16x64_bf16 v[28:31], v[20:23], v[96:103], v1
    v_smfmac_f32_16x16x64_bf16 v[32:35], v[20:23], v[104:111], v1
    ds_read_b128 v[20:23], v3 offset:17472
    s_waitcnt lgkmcnt(5)
    v_smfmac_f32_16x16x64_bf16 v[28:31], v[24:27], v[136:143], v1
    v_smfmac_f32_16x16x64_bf16 v[32:35], v[24:27], v[144:151], v1
    s_waitcnt lgkmcnt(3)
    v_smfmac_f32_16x16x64_bf16 v[28:31], v[52:55], v[176:183], v1
    v_smfmac_f32_16x16x64_bf16 v[32:35], v[52:55], v[184:191], v1
    ds_read_b128 v[52:55], v3 offset:19776
    s_waitcnt lgkmcnt(2)
    v_smfmac_f32_16x16x64_bf16 v[28:31], v[48:51], v[216:223], v1
    v_smfmac_f32_16x16x64_bf16 v[32:35], v[48:51], v[224:231], v1
    ds_read_b128 v[48:51], v3 offset:17536
    v_mfma_f32_16x16x32_bf16 v[24:27], v[12:15], v[44:47], 0
    s_waitcnt vmcnt(2)
    v_cmp_eq_u32 vcc, 0, v6
    s_nop 0
    s_and_b64 vcc, vcc, s[78:79]
    s_cbranch_scc1 Lr3s_flbad
Lr3s_flok:
    buffer_load_dword v6, v5, s[8:11], s40 offen
    buffer_load_dword v6, v5, s[8:11], s56 offen
    v_mfma_f32_16x16x32_bf16 v[12:15], v[64:67], v[44:47], 0
    ds_read_b128 v[64:67], v0 offset:13312
    v_mfma_f32_16x16x32_bf16 v[16:19], v[68:71], v[44:47], 0
    ds_read_b128 v[68:71], v0 offset:14336
    s_waitcnt lgkmcnt(3)
    v_mfma_f32_16x16x32_bf16 v[24:27], v[52:55], v[20:23], v[24:27]
    ds_read_b128 v[44:47], v3 offset:19840
    v_add_f32 v28, v28, v30
    v_add_f32 v29, v29, v31
    v_mfma_f32_16x16x32_bf16 v[12:15], v[56:59], v[20:23], v[12:15]
    ds_read_b128 v[52:55], v3 offset:17600
    v_add_f32 v32, v32, v34
    v_add_f32 v33, v33, v35
    v_mfma_f32_16x16x32_bf16 v[16:19], v[60:63], v[20:23], v[16:19]
    ds_read_b128 v[56:59], v0 offset:15360
    v_cvt_pk_bf16_f32 v30, v28, v29
    v_cvt_pk_bf16_f32 v31, v32, v33
    s_waitcnt lgkmcnt(2)
    v_mfma_f32_16x16x32_bf16 v[24:27], v[44:47], v[48:51], v[24:27]
    ds_read_b128 v[20:23], v3 offset:19904
    v_lshrrev_b32 v10, 8, v0
    v_mul_u32_u24 v10, 288, v10
    v_mfma_f32_16x16x32_bf16 v[12:15], v[64:67], v[48:51], v[12:15]
    ds_read_b128 v[60:63], v0 offset:16384
    v_and_b32 v11, 0xf0, v0
    v_add_u32 v10, v10, v11
    v_mfma_f32_16x16x32_bf16 v[16:19], v[68:71], v[48:51], v[16:19]
    ds_read_b128 v[32:35], v10 offset:21440
    v_lshrrev_b32 v11, 1, v0
    v_bfi_b32 v30, 1, s66, v30
    s_waitcnt lgkmcnt(2)
    v_mfma_f32_16x16x32_bf16 v[24:27], v[20:23], v[52:55], v[24:27]
    buffer_store_dwordx2 v[30:31], v11, s[8:11], s43 offen offset:2048 sc1
    v_mov_b32 v49, 0
    v_mov_b32 v50, 0
    v_mfma_f32_16x16x32_bf16 v[12:15], v[56:59], v[52:55], v[12:15]
    v_mov_b64 v[64:65], s[68:69]
    v_mov_b64 v[66:67], s[68:69]
    s_waitcnt lgkmcnt(1)
    v_mfma_f32_16x16x32_bf16 v[16:19], v[60:63], v[52:55], v[16:19]
    s_waitcnt lgkmcnt(0)
    v_bfi_b32 v32, 1, s66, v32
    s_mov_b64 exec, s[52:53]
    buffer_store_dwordx4 v[32:35], v0, s[8:11], s43 offen sc1
    s_mov_b64 exec, -1
    v_max3_f32 v10, v24, v25, v12
    v_max3_f32 v10, v10, v13, v14
    s_nop 0
    v_max3_f32 v10, v10, v15, v16
    v_max3_f32 v10, v10, v17, v18
    v_max_f32 v10, v10, v19
    v_mov_b32 v11, v10
    s_nop 1
    v_permlane32_swap_b32 v10, v11
    v_max_f32 v10, v10, v11
    v_mov_b32 v11, v10
    s_nop 1
    v_permlane16_swap_b32 v10, v11
    v_max_f32 v10, v10, v11
    v_mul_f32 v20, s46, v10
    v_pk_fma_f32 v[24:25], v[24:25], s[46:47], v[20:21] op_sel_hi:[1,1,0] neg_lo:[0,0,1] neg_hi:[0,0,1]
    v_pk_fma_f32 v[12:13], v[12:13], s[46:47], v[20:21] op_sel_hi:[1,1,0] neg_lo:[0,0,1] neg_hi:[0,0,1]
    v_exp_f32 v24, v24
    v_exp_f32 v25, v25
    v_pk_fma_f32 v[14:15], v[14:15], s[46:47], v[20:21] op_sel_hi:[1,1,0] neg_lo:[0,0,1] neg_hi:[0,0,1]
    v_exp_f32 v12, v12
    v_exp_f32 v13, v13
    v_pk_fma_f32 v[16:17], v[16:17], s[46:47], v[20:21] op_sel_hi:[1,1,0] neg_lo:[0,0,1] neg_hi:[0,0,1]
    v_cvt_pk_bf16_f32 v48, v24, v25
    v_exp_f32 v14, v14
    v_pk_fma_f32 v[18:19], v[18:19], s[46:47], v[20:21] op_sel_hi:[1,1,0] neg_lo:[0,0,1] neg_hi:[0,0,1]
    v_cvt_pk_bf16_f32 v51, v24, v25
    v_exp_f32 v15, v15
    v_cvt_pk_bf16_f32 v44, v12, v13
    v_exp_f32 v16, v16
    v_exp_f32 v17, v17
    v_cvt_pk_bf16_f32 v45, v14, v15
    v_exp_f32 v18, v18
    v_exp_f32 v19, v19
    v_cvt_pk_bf16_f32 v46, v16, v17
    v_cvt_pk_bf16_f32 v47, v18, v19
    v_mfma_f32_16x16x16_bf16 v[68:71], v[64:65], v[48:49], 0
    v_mfma_f32_16x16x16_bf16 v[52:55], v[30:31], v[48:49], 0
    v_mfma_f32_16x16x16_bf16 v[56:59], v[30:31], v[50:51], 0
    v_mfma_f32_16x16x32_bf16 v[68:71], v[64:67], v[44:47], v[68:71]
    s_waitcnt vmcnt(5)
    v_mfma_f32_16x16x32_bf16 v[52:55], v[36:39], v[44:47], v[52:55]
    s_waitcnt vmcnt(4)
    v_mfma_f32_16x16x32_bf16 v[56:59], v[40:43], v[44:47], v[56:59]
    ds_read_b128 v[36:39], v0 offset:55296
    ds_read_b128 v[40:43], v0 offset:56320
    ds_read_b128 v[60:63], v9 offset:24576
    s_nop 0
    v_rcp_f32 v10, v68
    s_nop 0
    v_pk_mul_f32 v[52:53], v[52:53], v[10:11] op_sel_hi:[1,0]
    s_nop 0
    v_pk_mul_f32 v[56:57], v[56:57], v[10:11] op_sel_hi:[1,0]
    v_cvt_pk_bf16_f32 v16, v52, v56
    v_cvt_pk_bf16_f32 v17, v53, v57
    v_pk_mul_f32 v[54:55], v[54:55], v[10:11] op_sel_hi:[1,0]
    v_pk_mul_f32 v[58:59], v[58:59], v[10:11] op_sel_hi:[1,0]
    v_cvt_pk_bf16_f32 v18, v54, v58
    v_cvt_pk_bf16_f32 v19, v55, v59
    ds_write_b128 v3, v[16:19] offset:22208
    ds_read_b128 v[64:67], v9 offset:25600
    v_mov_b64 v[12:13], 0
    v_mov_b64 v[14:15], 0
    v_mov_b64 v[20:21], 0
    v_mov_b64 v[22:23], 0
    v_mov_b64 v[24:25], 0
    v_mov_b64 v[26:27], 0
    v_mov_b64 v[32:33], 0
    v_mov_b64 v[34:35], 0
    v_mov_b64 v[44:45], 0
    v_mov_b64 v[46:47], 0
    v_mov_b64 v[48:49], 0
    v_mov_b64 v[50:51], 0
    s_waitcnt lgkmcnt(1)
    s_barrier
    ds_read_b128 v[52:55], v4 offset:22016
    ds_read_b128 v[56:59], v4 offset:22144
    v_mov_b64 v[68:69], 0
    v_mov_b64 v[70:71], 0
    v_mov_b64 v[28:29], 0
    v_mov_b64 v[30:31], 0
    v_mov_b64 v[16:17], 0
    v_mov_b64 v[18:19], 0
    s_cmp_eq_u32 s33, 63
    s_cbranch_scc1 Lr3s_last
    s_waitcnt lgkmcnt(1)
    v_smfmac_f32_16x16x64_bf16 v[28:31], v[52:55], v[60:67], v1
    ds_read_b128 v[60:63], v0 offset:49152
    s_waitcnt lgkmcnt(1)
    v_smfmac_f32_16x16x64_bf16 v[28:31], v[56:59], v[36:43], v1
    ds_read_b128 v[64:67], v0 offset:50176
    ds_read_b128 v[36:39], v9 offset:18432
    v_smfmac_f32_16x16x64_bf16 v[12:15], v[52:55], a[176:183], v1
    ds_read_b128 v[40:43], v9 offset:19456
    v_smfmac_f32_16x16x64_bf16 v[12:15], v[56:59], a[184:191], v1
    buffer_load_dwordx4 v0, s[8:11], s41 offen offset:0 lds
    v_smfmac_f32_16x16x64_bf16 v[20:23], v[52:55], a[192:199], v1
    s_nop 0
    v_add_f32 v28, v28, v30
    v_add_f32 v29, v29, v31
    s_waitcnt lgkmcnt(2)
    v_smfmac_f32_16x16x64_bf16 v[20:23], v[56:59], v[60:67], v1
    ds_read_b128 v[60:63], v9 offset:20480
    v_cvt_pk_bf16_f32 v28, v28, v29
    v_bfi_b32 v28, 1, s39, v28
    buffer_store_dword v28, v8, s[8:11], s38 offen offset:2048 sc1
    s_waitcnt lgkmcnt(1)
    v_smfmac_f32_16x16x64_bf16 v[24:27], v[52:55], v[36:43], v1
    ds_read_b128 v[64:67], v9 offset:21504
    ds_read_b128 v[36:39], v0 offset:51200
    v_add_f32 v12, v12, v14
    v_add_f32 v13, v13, v15
    v_smfmac_f32_16x16x64_bf16 v[24:27], v[56:59], a[200:207], v1
    ds_read_b128 v[40:43], v0 offset:52224
    v_cvt_pk_bf16_f32 v12, v12, v13
    v_bfi_b32 v12, 1, s39, v12
    v_smfmac_f32_16x16x64_bf16 v[32:35], v[52:55], a[208:215], v1
    buffer_load_dwordx4 v0, s[8:11], s41 offen offset:1024 lds
    v_add_f32 v20, v20, v22
    v_add_f32 v21, v21, v23
    v_smfmac_f32_16x16x64_bf16 v[32:35], v[56:59], a[216:223], v1
    v_cvt_pk_bf16_f32 v13, v20, v21
    s_waitcnt lgkmcnt(2)
    v_smfmac_f32_16x16x64_bf16 v[44:47], v[52:55], v[60:67], v1
    ds_read_b128 v[60:63], v0 offset:53248
    v_add_f32 v24, v24, v26
    v_add_f32 v25, v25, v27
    s_waitcnt lgkmcnt(1)
    v_smfmac_f32_16x16x64_bf16 v[44:47], v[56:59], v[36:43], v1
    ds_read_b128 v[64:67], v0 offset:54272
    ds_read_b128 v[36:39], v9 offset:22528
    v_cvt_pk_bf16_f32 v14, v24, v25
    v_smfmac_f32_16x16x64_bf16 v[48:51], v[52:55], a[224:231], v1
    ds_read_b128 v[40:43], v9 offset:23552
    v_add_f32 v32, v32, v34
    v_add_f32 v33, v33, v35
    v_smfmac_f32_16x16x64_bf16 v[48:51], v[56:59], a[232:239], v1
    v_cvt_pk_bf16_f32 v15, v32, v33
    buffer_store_dwordx4 v[12:15], v0, s[8:11], s38 offen offset:0 sc1
    v_smfmac_f32_16x16x64_bf16 v[68:71], v[52:55], a[240:247], v1
    v_add_f32 v44, v44, v46
    v_add_f32 v45, v45, v47
    s_waitcnt lgkmcnt(2)
    v_smfmac_f32_16x16x64_bf16 v[68:71], v[56:59], v[60:67], v1
    v_cvt_pk_bf16_f32 v44, v44, v45
    v_bfi_b32 v44, 1, s39, v44
    s_waitcnt lgkmcnt(0)
    v_smfmac_f32_16x16x64_bf16 v[16:19], v[52:55], v[36:43], v1
    v_add_f32 v48, v48, v50
    v_add_f32 v49, v49, v51
    v_smfmac_f32_16x16x64_bf16 v[16:19], v[56:59], a[248:255], v1
    v_cvt_pk_bf16_f32 v45, v48, v49
    v_add_f32 v68, v68, v70
    v_add_f32 v69, v69, v71
    v_cvt_pk_bf16_f32 v46, v68, v69
    s_nop 3
    v_add_f32 v16, v16, v18
    v_add_f32 v17, v17, v19
    v_cvt_pk_bf16_f32 v47, v16, v17
    buffer_store_dwordx4 v[44:47], v0, s[8:11], s38 offen offset:1024 sc1
    s_xor_b32 s34, s34, 16384
    s_xor_b32 s35, s35, 16384
    s_barrier
    s_sleep 2
    buffer_load_dwordx4 v[44:47], v0, s[8:11], s34 offen sc1
    buffer_load_dwordx4 v[48:51], v0, s[8:11], s34 offen offset:1024 sc1
    buffer_load_dword v10, v8, s[8:11], s35 offen sc1
    s_add_u32 s33, s33, 1
    s_bfe_u32 s39, s33, 0x10001
    s_xor_b32 s38, s38, 524288
    s_and_b32 s17, s33, 7
    s_mul_i32 s17, s17, 131072
    s_add_u32 s43, s45, s17
    s_bfe_u32 s66, s33, 65539
    s_add_u32 s67, s67, 22528
    s_cmp_ge_u32 s33, 7
    s_cselect_b64 s[78:79], -1, s[78:79]
    s_add_u32 s56, s56, 262144
    s_add_u32 s42, s42, 262144
    s_add_u32 s41, s41, 262144
    s_add_u32 s40, s40, 262144
    s_add_u32 s44, s44, 22528
    ds_read_b128 v[56:59], v9 offset:12288
    ds_read_b128 v[60:63], v9 offset:13312
    ds_read_b128 v[64:67], v9 offset:14336
    ds_read_b128 v[68:71], v9 offset:15360
    v_mov_b64 v[12:13], 0
    v_mov_b64 v[14:15], 0
    v_mov_b64 v[16:17], 0
    v_mov_b64 v[18:19], 0
    v_mov_b64 v[20:21], 0
    v_mov_b64 v[22:23], 0
    v_mov_b64 v[24:25], 0
    v_mov_b64 v[26:27], 0
    v_mov_b64 v[28:29], 0
    v_mov_b64 v[30:31], 0
    v_mov_b64 v[32:33], 0
    v_mov_b64 v[34:35], 0
    s_waitcnt lgkmcnt(0)
    s_branch Lr3s_step
Lr3s_flbad:
    s_cmp_eq_u32 s33, 63
    s_cbranch_scc1 Lr3s_flok
    s_mov_b32 s16, 0
Lr3s_flp:
    buffer_load_dword v6, v7, s[8:11], s67 offen sc1
    s_add_u32 s16, s16, 1
    s_cmp_gt_u32 s16, 100000
    s_cbranch_scc1 Lr_abort
    s_waitcnt vmcnt(0)
    v_cmp_eq_u32 vcc, 0, v6
    s_nop 0
    s_and_b64 vcc, vcc, s[78:79]
    s_cbranch_scc1 Lr3s_flp
    s_branch Lr3s_flok
Lr3s_last:
    s_waitcnt vmcnt(0) lgkmcnt(0)
    s_branch Lr_exit
Lr_abort:
    s_waitcnt lgkmcnt(0)
    s_mov_b64 exec, -1
    v_mov_b32 v0, 60
    s_lshl_b32 s5, s3, 8
    s_or_b32 s5, s5, s4
    s_or_b32 s5, s5, 0x10000
    v_mov_b32 v1, s5
    global_store_dword v0, v1, s[12:13]
    s_endpgm
Lr_exit:
    s_endpgm
.section .rodata,"a"
.p2align 6
.amdhsa_kernel interleave_layers__sliding_local_dilated__memory_aug_recurrent_mem_tr__prompt_kernel
  .amdhsa_next_free_vgpr 512
  .amdhsa_next_free_sgpr 102
  .amdhsa_accum_offset 256
  .amdhsa_group_segment_fixed_size 0
  .amdhsa_kernarg_size 104
  .amdhsa_user_sgpr_count 2
  .amdhsa_user_sgpr_kernarg_segment_ptr 1
  .amdhsa_system_sgpr_workgroup_id_x 1
.end_amdhsa_kernel
```

```asm
; @launch grid=(256,1,1) block=(256,1,1) lds=163840
.amdgcn_target "amdgcn-amd-amdhsa--gfx950"
.text
.globl interleave_layers__sliding_local_dilated__memory_aug_recurrent_mem_tr__prompt_kernel
.p2align 8
.type interleave_layers__sliding_local_dilated__memory_aug_recurrent_mem_tr__prompt_kernel,@function
interleave_layers__sliding_local_dilated__memory_aug_recurrent_mem_tr__prompt_kernel:
    s_cmp_ge_u32 s2, 256
    s_cbranch_scc1 L_exit
    s_load_dwordx2 s[8:9], s[0:1], 96
    s_mov_b32 s10, 268435456
    s_mov_b32 s11, 0x00020000
    s_waitcnt lgkmcnt(0)
    s_and_b32 s9, s9, 0xffff
    s_load_dwordx2 s[12:13], s[0:1], 88
    v_lshrrev_b32 v1, 6, v0
    s_getreg_b32 s3, hwreg(HW_REG_XCC_ID)
    v_readfirstlane_b32 s14, v1
    s_and_b32 s3, s3, 7
    s_and_b32 s17, s3, 1
    s_lshl_b32 s17, s17, 7
    s_lshl_b32 s18, s3, 1
    s_and_b32 s18, s18, 12
    s_add_u32 s17, s17, s18
    v_mov_b32 v2, 0
    v_mov_b32 v3, 1
    v_mov_b32 v4, s17
    s_mov_b32 s33, 0
    s_waitcnt lgkmcnt(0)
    s_cmp_lg_u32 s14, 0
    s_cbranch_scc1 L_tk_wait
    s_mov_b64 exec, 1
    global_atomic_add v3, v4, v3, s[12:13] sc0
    s_waitcnt vmcnt(0)
    v_readfirstlane_b32 s4, v3
    s_nop 0
    s_cmp_lt_u32 s4, 32
    s_cbranch_scc1 L_tk_have
    v_mov_b32 v3, 1
    v_mov_b32 v4, 32
    global_atomic_add v3, v4, v3, s[12:13] sc0
    s_waitcnt vmcnt(0)
    v_readfirstlane_b32 s5, v3
    s_mov_b64 exec, 0xff
    v_and_b32 v4, 1, v0
    v_lshlrev_b32 v4, 7, v4
    v_lshlrev_b32 v5, 1, v0
    v_and_or_b32 v4, v5, 12, v4
    s_mov_b32 s16, 0
L_hl_poll:
    global_load_dword v5, v4, s[12:13] sc1
    s_add_u32 s16, s16, 1
    s_cmp_gt_u32 s16, 100000
    s_cbranch_scc1 L_abort
    s_mov_b32 s6, 0
    s_waitcnt vmcnt(0)
    v_readlane_b32 s40, v5, 0
    s_nop 0
    s_add_u32 s6, s6, s40
    v_readlane_b32 s41, v5, 1
    s_nop 0
    s_add_u32 s6, s6, s41
    v_readlane_b32 s42, v5, 2
    s_nop 0
    s_add_u32 s6, s6, s42
    v_readlane_b32 s43, v5, 3
    s_nop 0
    s_add_u32 s6, s6, s43
    v_readlane_b32 s44, v5, 4
    s_nop 0
    s_add_u32 s6, s6, s44
    v_readlane_b32 s45, v5, 5
    s_nop 0
    s_add_u32 s6, s6, s45
    v_readlane_b32 s46, v5, 6
    s_nop 0
    s_add_u32 s6, s6, s46
    v_readlane_b32 s47, v5, 7
    s_nop 0
    s_add_u32 s6, s6, s47
    s_cmp_lt_u32 s6, 256
    s_cbranch_scc1 L_hl_poll
    s_mov_b32 s3, 0
    s_mov_b32 s4, 0
    s_min_u32 s6, s47, 32
    s_sub_u32 s7, 32, s6
    s_cmp_lt_u32 s5, s7
    s_cselect_b32 s3, 7, s3
    s_add_u32 s6, s6, s5
    s_cmp_lt_u32 s5, s7
    s_cselect_b32 s4, s6, s4
    s_sub_u32 s5, s5, s7
    s_min_u32 s6, s46, 32
    s_sub_u32 s7, 32, s6
    s_cmp_lt_u32 s5, s7
    s_cselect_b32 s3, 6, s3
    s_add_u32 s6, s6, s5
    s_cmp_lt_u32 s5, s7
    s_cselect_b32 s4, s6, s4
    s_sub_u32 s5, s5, s7
    s_min_u32 s6, s45, 32
    s_sub_u32 s7, 32, s6
    s_cmp_lt_u32 s5, s7
    s_cselect_b32 s3, 5, s3
    s_add_u32 s6, s6, s5
    s_cmp_lt_u32 s5, s7
    s_cselect_b32 s4, s6, s4
    s_sub_u32 s5, s5, s7
    s_min_u32 s6, s44, 32
    s_sub_u32 s7, 32, s6
    s_cmp_lt_u32 s5, s7
    s_cselect_b32 s3, 4, s3
    s_add_u32 s6, s6, s5
    s_cmp_lt_u32 s5, s7
    s_cselect_b32 s4, s6, s4
    s_sub_u32 s5, s5, s7
    s_min_u32 s6, s43, 32
    s_sub_u32 s7, 32, s6
    s_cmp_lt_u32 s5, s7
    s_cselect_b32 s3, 3, s3
    s_add_u32 s6, s6, s5
    s_cmp_lt_u32 s5, s7
    s_cselect_b32 s4, s6, s4
    s_sub_u32 s5, s5, s7
    s_min_u32 s6, s42, 32
    s_sub_u32 s7, 32, s6
    s_cmp_lt_u32 s5, s7
    s_cselect_b32 s3, 2, s3
    s_add_u32 s6, s6, s5
    s_cmp_lt_u32 s5, s7
    s_cselect_b32 s4, s6, s4
    s_sub_u32 s5, s5, s7
    s_min_u32 s6, s41, 32
    s_sub_u32 s7, 32, s6
    s_cmp_lt_u32 s5, s7
    s_cselect_b32 s3, 1, s3
    s_add_u32 s6, s6, s5
    s_cmp_lt_u32 s5, s7
    s_cselect_b32 s4, s6, s4
    s_sub_u32 s5, s5, s7
    s_min_u32 s6, s40, 32
    s_sub_u32 s7, 32, s6
    s_cmp_lt_u32 s5, s7
    s_cselect_b32 s3, 0, s3
    s_add_u32 s6, s6, s5
    s_cmp_lt_u32 s5, s7
    s_cselect_b32 s4, s6, s4
    s_sub_u32 s5, s5, s7
L_tk_have:
    s_lshl_b32 s5, s3, 8
    s_or_b32 s5, s5, s4
    v_mov_b32 v3, s5
    s_mov_b64 exec, 1
    ds_write_b32 v2, v3
    s_mov_b64 exec, -1
L_tk_wait:
    s_waitcnt vmcnt(0) lgkmcnt(0)
    s_barrier
    ds_read_b32 v3, v2
    s_waitcnt lgkmcnt(0)
    v_readfirstlane_b32 s5, v3
    s_nop 0
    s_lshr_b32 s3, s5, 8
    s_and_b32 s4, s5, 255
    s_barrier
    s_cmp_lt_u32 s3, 2
    s_cbranch_scc1 L_role_r
    s_cmp_lg_u32 s3, 2
    s_cbranch_scc1 L_ii2_no
    s_cmp_lt_u32 s4, 32
    s_cbranch_scc1 L_noinit
L_ii2_no:
    s_cmp_lg_u32 s3, 3
    s_cbranch_scc1 L_ii3_no
    s_cmp_lt_u32 s4, 16
    s_cbranch_scc1 L_noinit
    s_cmp_lt_u32 s4, 32
    s_add_u32 s6, s4, 4294967280
    s_cmp_lt_u32 s4, 32
    s_cbranch_scc1 L_doinit
L_ii3_no:
    s_cmp_lg_u32 s3, 4
    s_cbranch_scc1 L_ii4_no
    s_cmp_lt_u32 s4, 21
    s_cbranch_scc1 L_noinit
    s_cmp_lt_u32 s4, 32
    s_add_u32 s6, s4, 4294967291
    s_cmp_lt_u32 s4, 32
    s_cbranch_scc1 L_doinit
L_ii4_no:
    s_cmp_lg_u32 s3, 5
    s_cbranch_scc1 L_ii5_no
    s_cmp_lt_u32 s4, 32
    s_add_u32 s6, s4, 27
    s_cmp_lt_u32 s4, 32
    s_cbranch_scc1 L_doinit
L_ii5_no:
    s_cmp_lg_u32 s3, 6
    s_cbranch_scc1 L_ii6_no
    s_cmp_lt_u32 s4, 32
    s_add_u32 s6, s4, 59
    s_cmp_lt_u32 s4, 32
    s_cbranch_scc1 L_doinit
L_ii6_no:
    s_cmp_lg_u32 s3, 7
    s_cbranch_scc1 L_ii7_no
    s_cmp_lt_u32 s4, 32
    s_add_u32 s6, s4, 91
    s_cmp_lt_u32 s4, 32
    s_cbranch_scc1 L_doinit
L_ii7_no:
    s_endpgm
L_doinit:
    s_load_dwordx2 s[20:21], s[0:1], 0
    s_mov_b32 s22, 2359296
    s_mov_b32 s23, 0x00020000
    s_waitcnt lgkmcnt(0)
    s_and_b32 s21, s21, 0xffff
    v_lshlrev_b32 v7, 4, v0
    v_mov_b32 v12, 0
    v_mov_b32 v13, 0
    v_mov_b32 v14, 0
    v_mov_b32 v15, 0
    s_mov_b32 s46, s6
Li_loop:
    s_cmp_ge_u32 s46, 136
    s_cbranch_scc1 Li_nofl
    s_mul_i32 s41, s46, 22528
    s_add_u32 s41, s41, 180224
    s_sub_u32 s42, s46, 128
    s_lshl_b32 s42, s42, 12
    s_add_u32 s42, s42, 3080192
    s_cmp_ge_u32 s46, 128
    s_cselect_b32 s41, s42, s41
    buffer_store_dwordx4 v[12:15], v7, s[8:11], s41 offen sc1
    s_cbranch_scc1 Li_nofl
    s_add_u32 s41, s41, 4096
    buffer_store_dwordx4 v[12:15], v7, s[8:11], s41 offen sc1
    s_add_u32 s41, s41, 4096
    buffer_store_dwordx4 v[12:15], v7, s[8:11], s41 offen sc1
    s_add_u32 s41, s41, 4096
    buffer_store_dwordx4 v[12:15], v7, s[8:11], s41 offen sc1
    s_add_u32 s41, s41, 4096
    buffer_store_dwordx4 v[12:15], v7, s[8:11], s41 offen sc1
    s_add_u32 s41, s41, 4096
    v_cmp_gt_u32 vcc, 128, v0
    s_nop 0
    s_and_saveexec_b64 s[42:43], vcc
    s_cbranch_execz Li_fl5
    buffer_store_dwordx4 v[12:15], v7, s[8:11], s41 offen sc1
Li_fl5:
    s_mov_b64 exec, s[42:43]
Li_nofl:
    s_cmp_ge_u32 s46, 64
    s_cbranch_scc1 Li_rest
    s_mul_i32 s42, s46, 6144
    s_add_u32 s42, s42, 15728640
    s_add_u32 s43, s42, 2048
    buffer_store_dwordx4 v[12:15], v7, s[8:11], s43 offen sc1
    s_branch Li_done
Li_rest:
    s_cmp_ge_u32 s46, 192
    s_cbranch_scc1 Li_done
    s_sub_u32 s41, s46, 64
    s_lshr_b32 s42, s41, 6
    s_and_b32 s41, s41, 63
    s_mul_i32 s42, s42, 786432
    s_mul_i32 s41, s41, 6144
    s_add_u32 s41, s41, s42
    s_add_u32 s41, s41, 16126464
    v_cmp_gt_u32 vcc, 96, v0
    s_nop 0
    s_and_saveexec_b64 s[44:45], vcc
    s_cbranch_execz Li_rest2
    buffer_store_dwordx4 v[12:15], v7, s[8:11], s41 offen sc1
Li_rest2:
    s_mov_b64 exec, s[44:45]
Li_done:
    s_add_u32 s46, s46, 123
    s_cmp_lt_u32 s46, 192
    s_cbranch_scc1 Li_loop
    v_and_b32 v1, 31, v0
    v_lshrrev_b32 v2, 5, v0
    v_mul_u32_u24 v3, 1152, v1
    v_mul_u32_u24 v5, 144, v2
    v_add_u32 v3, v3, v5
    s_sub_u32 s47, s6, 59
    s_mul_i32 s41, s47, 36864
    s_cmp_lt_u32 s6, 59
    s_cselect_b32 s41, 0x7f000000, s41
    buffer_load_dwordx4 v[64:67], v3, s[20:23], s41 offen offset:0
    buffer_load_dwordx4 v[68:71], v3, s[20:23], s41 offen offset:16
    buffer_load_dwordx4 v[72:75], v3, s[20:23], s41 offen offset:32
    buffer_load_dwordx4 v[76:79], v3, s[20:23], s41 offen offset:48
    buffer_load_dwordx4 v[80:83], v3, s[20:23], s41 offen offset:64
    buffer_load_dwordx4 v[84:87], v3, s[20:23], s41 offen offset:80
    buffer_load_dwordx4 v[88:91], v3, s[20:23], s41 offen offset:96
    buffer_load_dwordx4 v[92:95], v3, s[20:23], s41 offen offset:112
    buffer_load_dwordx4 v[96:99], v3, s[20:23], s41 offen offset:128
    s_waitcnt vmcnt(9)
    s_barrier
    s_cmp_lg_u32 s14, 0
    s_cbranch_scc1 Li_mid
    v_mov_b32 v2, 160
    v_mov_b32 v3, 1
    s_mov_b64 exec, 1
    global_atomic_add v2, v3, s[12:13]
    s_mov_b64 exec, -1
Li_mid:
    s_cmp_lt_u32 s6, 59
    s_cbranch_scc1 Li_end
    s_waitcnt vmcnt(0)
    v_and_b32 v1, 31, v0
    v_lshrrev_b32 v2, 5, v0
    v_mul_u32_u24 v4, 4608, v2
    v_lshl_add_u32 v4, v1, 4, v4
    s_mul_i32 s41, s47, 36864
    s_add_u32 s41, s41, 6291456
    s_mul_i32 s42, s47, 6144
    s_add_u32 s42, s42, 15728640
    v_mov_b32 v60, 0
    v_mov_b32 v61, 0
    buffer_store_dwordx4 v[64:67], v4, s[8:11], s41 offen offset:0 sc1
    buffer_store_dwordx4 v[68:71], v4, s[8:11], s41 offen offset:512 sc1
    buffer_store_dwordx4 v[72:75], v4, s[8:11], s41 offen offset:1024 sc1
    buffer_store_dwordx4 v[76:79], v4, s[8:11], s41 offen offset:1536 sc1
    buffer_store_dwordx4 v[80:83], v4, s[8:11], s41 offen offset:2048 sc1
    buffer_store_dwordx4 v[84:87], v4, s[8:11], s41 offen offset:2560 sc1
    buffer_store_dwordx4 v[88:91], v4, s[8:11], s41 offen offset:3072 sc1
    buffer_store_dwordx4 v[92:95], v4, s[8:11], s41 offen offset:3584 sc1
    v_add_u32 v4, 4096, v4
    buffer_store_dwordx4 v[96:99], v4, s[8:11], s41 offen offset:0 sc1
    v_mov_b32 v62, 0x3f803f80
    v_dot2c_f32_bf16 v60, v64, v62
    v_dot2c_f32_bf16 v61, v64, v64
    v_dot2c_f32_bf16 v60, v65, v62
    v_dot2c_f32_bf16 v61, v65, v65
    v_dot2c_f32_bf16 v60, v66, v62
    v_dot2c_f32_bf16 v61, v66, v66
    v_dot2c_f32_bf16 v60, v67, v62
    v_dot2c_f32_bf16 v61, v67, v67
    v_dot2c_f32_bf16 v60, v68, v62
    v_dot2c_f32_bf16 v61, v68, v68
    v_dot2c_f32_bf16 v60, v69, v62
    v_dot2c_f32_bf16 v61, v69, v69
    v_dot2c_f32_bf16 v60, v70, v62
    v_dot2c_f32_bf16 v61, v70, v70
    v_dot2c_f32_bf16 v60, v71, v62
    v_dot2c_f32_bf16 v61, v71, v71
    v_dot2c_f32_bf16 v60, v72, v62
    v_dot2c_f32_bf16 v61, v72, v72
    v_dot2c_f32_bf16 v60, v73, v62
    v_dot2c_f32_bf16 v61, v73, v73
    v_dot2c_f32_bf16 v60, v74, v62
    v_dot2c_f32_bf16 v61, v74, v74
    v_dot2c_f32_bf16 v60, v75, v62
    v_dot2c_f32_bf16 v61, v75, v75
    v_dot2c_f32_bf16 v60, v76, v62
    v_dot2c_f32_bf16 v61, v76, v76
    v_dot2c_f32_bf16 v60, v77, v62
    v_dot2c_f32_bf16 v61, v77, v77
    v_dot2c_f32_bf16 v60, v78, v62
    v_dot2c_f32_bf16 v61, v78, v78
    v_dot2c_f32_bf16 v60, v79, v62
    v_dot2c_f32_bf16 v61, v79, v79
    v_dot2c_f32_bf16 v60, v80, v62
    v_dot2c_f32_bf16 v61, v80, v80
    v_dot2c_f32_bf16 v60, v81, v62
    v_dot2c_f32_bf16 v61, v81, v81
    v_dot2c_f32_bf16 v60, v82, v62
    v_dot2c_f32_bf16 v61, v82, v82
    v_dot2c_f32_bf16 v60, v83, v62
    v_dot2c_f32_bf16 v61, v83, v83
    v_dot2c_f32_bf16 v60, v84, v62
    v_dot2c_f32_bf16 v61, v84, v84
    v_dot2c_f32_bf16 v60, v85, v62
    v_dot2c_f32_bf16 v61, v85, v85
    v_dot2c_f32_bf16 v60, v86, v62
    v_dot2c_f32_bf16 v61, v86, v86
    v_dot2c_f32_bf16 v60, v87, v62
    v_dot2c_f32_bf16 v61, v87, v87
    v_dot2c_f32_bf16 v60, v88, v62
    v_dot2c_f32_bf16 v61, v88, v88
    v_dot2c_f32_bf16 v60, v89, v62
    v_dot2c_f32_bf16 v61, v89, v89
    v_dot2c_f32_bf16 v60, v90, v62
    v_dot2c_f32_bf16 v61, v90, v90
    v_dot2c_f32_bf16 v60, v91, v62
    v_dot2c_f32_bf16 v61, v91, v91
    v_dot2c_f32_bf16 v60, v92, v62
    v_dot2c_f32_bf16 v61, v92, v92
    v_dot2c_f32_bf16 v60, v93, v62
    v_dot2c_f32_bf16 v61, v93, v93
    v_dot2c_f32_bf16 v60, v94, v62
    v_dot2c_f32_bf16 v61, v94, v94
    v_dot2c_f32_bf16 v60, v95, v62
    v_dot2c_f32_bf16 v61, v95, v95
    v_dot2c_f32_bf16 v60, v96, v62
    v_dot2c_f32_bf16 v61, v96, v96
    v_dot2c_f32_bf16 v60, v97, v62
    v_dot2c_f32_bf16 v61, v97, v97
    v_dot2c_f32_bf16 v60, v98, v62
    v_dot2c_f32_bf16 v61, v98, v98
    v_dot2c_f32_bf16 v60, v99, v62
    v_dot2c_f32_bf16 v61, v99, v99
    s_nop 3
    v_lshrrev_b32 v5, 1, v2
    v_lshlrev_b32 v5, 9, v5
    v_lshl_add_u32 v5, v1, 4, v5
    v_and_b32 v6, 1, v2
    v_lshl_add_u32 v5, v6, 3, v5
    buffer_store_dwordx2 v[60:61], v5, s[8:11], s42 offen sc1
    s_waitcnt vmcnt(0)
    s_cmp_lg_u32 s14, 0
    s_cbranch_scc1 Li_pw_d
    v_mov_b32 v5, 160
    s_mov_b32 s16, 0
Li_pw:
    global_load_dword v6, v5, s[12:13] sc1
    s_add_u32 s16, s16, 1
    s_cmp_gt_u32 s16, 100000
    s_cbranch_scc1 L_abort
    s_waitcnt vmcnt(0)
    v_cmp_gt_u32 vcc, 123, v6
    s_nop 0
    s_cbranch_vccz Li_pw_d
    s_sleep 2
    s_branch Li_pw
Li_pw_d:
    s_barrier
    s_cmp_lg_u32 s14, 0
    s_cbranch_scc1 Li_end
    v_lshrrev_b32 v5, 2, v0
    v_lshlrev_b32 v5, 7, v5
    v_and_b32 v6, 3, v0
    v_lshl_add_u32 v5, v6, 2, v5
    v_mov_b32 v6, 1
    s_mul_i32 s41, s47, 22528
    s_mov_b32 exec_lo, -1
    s_mov_b32 exec_hi, 0xffff
    s_add_u32 s41, s41, 180224
    buffer_store_dword v6, v5, s[8:11], s41 offen offset:0 sc1
    s_mov_b64 exec, -1
Li_end:
L_noinit:
    s_cmp_lg_u32 s3, 2
    s_cbranch_scc1 L_cls2_no
    s_add_u32 s15, s4, 0
    s_cmp_lt_u32 s4, 32
    s_cbranch_scc1 L_role_p
    s_endpgm
L_cls2_no:
    s_cmp_lg_u32 s3, 3
    s_cbranch_scc1 L_cls3_no
    s_add_u32 s15, s4, 32
    s_cmp_lt_u32 s4, 32
    s_cbranch_scc1 L_role_p
    s_endpgm
L_cls3_no:
    s_cmp_lg_u32 s3, 4
    s_cbranch_scc1 L_cls4_no
    s_add_u32 s15, s4, 0
    s_cmp_lt_u32 s4, 16
    s_cbranch_scc1 L_role_aq
    s_add_u32 s15, s4, 4294967280
    s_cmp_lt_u32 s4, 21
    s_cbranch_scc1 L_role_awo
    s_add_u32 s15, s4, 43
    s_cmp_lt_u32 s4, 32
    s_cbranch_scc1 L_role_p
    s_endpgm
L_cls4_no:
    s_cmp_lg_u32 s3, 5
    s_cbranch_scc1 L_cls5_no
    s_add_u32 s15, s4, 16
    s_cmp_lt_u32 s4, 16
    s_cbranch_scc1 L_role_aq
    s_add_u32 s15, s4, 4294967285
    s_cmp_lt_u32 s4, 21
    s_cbranch_scc1 L_role_awo
    s_add_u32 s15, s4, 54
    s_cmp_lt_u32 s4, 32
    s_cbranch_scc1 L_role_p
    s_endpgm
L_cls5_no:
    s_cmp_lg_u32 s3, 6
    s_cbranch_scc1 L_cls6_no
    s_add_u32 s15, s4, 0
    s_cmp_lt_u32 s4, 8
    s_cbranch_scc1 L_role_ta
    s_add_u32 s15, s4, 4294967288
    s_cmp_lt_u32 s4, 32
    s_cbranch_scc1 L_role_tw
    s_endpgm
L_cls6_no:
    s_cmp_lg_u32 s3, 7
    s_cbranch_scc1 L_cls7_no
    s_add_u32 s15, s4, 8
    s_cmp_lt_u32 s4, 8
    s_cbranch_scc1 L_role_ta
    s_add_u32 s15, s4, 16
    s_cmp_lt_u32 s4, 20
    s_cbranch_scc1 L_role_tw
    s_add_u32 s15, s4, 66
    s_cmp_lt_u32 s4, 30
    s_cbranch_scc1 L_role_p
    s_endpgm
L_cls7_no:
L_exit:
    s_endpgm
L_abort:
    s_waitcnt lgkmcnt(0)
    s_mov_b64 exec, -1
    v_mov_b32 v0, 60
    s_lshl_b32 s5, s3, 8
    s_or_b32 s5, s5, s4
    s_or_b32 s5, s5, 0x10000
    v_mov_b32 v1, s5
    global_store_dword v0, v1, s[12:13]
    s_endpgm
.p2align 6
L_role_p:
    v_and_b32 v5, 63, v0
    v_lshlrev_b32 v0, 4, v5
    v_and_b32 v7, 15, v5
    v_lshrrev_b32 v8, 4, v5
    v_min_u32 v1, 17, v5
    v_lshrrev_b32 v6, 2, v1
    v_and_b32 v1, 3, v1
    v_lshlrev_b32 v1, 2, v1
    v_lshl_add_u32 v1, v6, 7, v1
    v_mov_b32 v3, 1
    v_mov_b32 v4, 0
    s_mov_b32 s44, 0x05040100
    s_mov_b32 s45, 0x07060302
    s_cmp_ge_u32 s15, 48
    s_cselect_b32 s63, 1, 0
    s_cselect_b32 s17, 48, 0
    s_sub_u32 s15, s15, s17
    s_lshr_b32 s50, s15, 4
    s_and_b32 s51, s15, 15
    s_lshl_b32 s51, s51, 1
    s_lshr_b32 s17, s14, 1
    s_add_u32 s51, s51, s17
    s_and_b32 s47, s14, 1
    s_lshl_b32 s17, s50, 3
    s_add_u32 s17, s17, 40
    s_load_dwordx2 s[20:21], s[0:1], s17
    s_mov_b32 s22, 4718592
    s_mov_b32 s23, 0x00020000
    s_lshl_b32 s49, s51, 8
    s_lshl_b32 s17, s47, 7
    s_add_u32 s49, s49, s17
    s_cmp_eq_u32 s63, 0
    s_cbranch_scc1 Lp_noord
    s_cmp_lg_u32 s14, 0
    s_cbranch_scc1 Lp_ord_d
    v_mov_b32 v5, 48
    s_mov_b32 s16, 0
Lp_ord:
    global_load_dword v6, v5, s[12:13] sc1
    s_add_u32 s16, s16, 1
    s_cmp_gt_u32 s16, 100000
    s_cbranch_scc1 L_role_p_abort
    s_waitcnt vmcnt(0)
    v_cmp_gt_u32 vcc, 1, v6
    s_nop 0
    s_cbranch_vccz Lp_ord_d
    s_sleep 64
    s_branch Lp_ord
Lp_ord_d:
    s_barrier
Lp_noord:
    v_lshrrev_b32 v5, 4, v0
    v_lshrrev_b32 v211, 3, v5
    v_lshlrev_b32 v211, 13, v211
    v_and_b32 v6, 7, v5
    v_lshl_add_u32 v211, v6, 4, v211
    v_lshrrev_b32 v210, 1, v8
    v_lshlrev_b32 v210, 3, v210
    v_lshrrev_b32 v6, 2, v7
    v_add_u32 v210, v210, v6
    v_lshlrev_b32 v210, 7, v210
    s_lshl_b32 s17, s14, 15
    v_add_u32 v210, s17, v210
    v_and_b32 v13, 1, v8
    v_and_b32 v6, 1, v7
    v_lshlrev_b32 v6, 3, v6
    v_lshl_add_u32 v6, v13, 4, v6
    v_bfe_u32 v9, v7, 1, 1
    v_lshl_add_u32 v6, v9, 5, v6
    v_and_b32 v9, 3, v7
    v_lshlrev_b32 v9, 3, v9
    v_lshl_add_u32 v13, v13, 5, v9
    s_cmp_eq_u32 s50, 2
    s_cselect_b64 vcc, -1, 0
    v_cndmask_b32 v6, v6, v13, vcc
    v_add_u32 v210, v210, v6
    s_waitcnt lgkmcnt(0)
    s_and_b32 s21, s21, 0xffff
    s_lshl_b32 s46, s14, 15
    s_add_u32 m0, s46, 0
    s_add_u32 s17, s49, 0
    buffer_load_dwordx4 v211, s[20:23], s17 offen lds
    s_add_u32 m0, s46, 1024
    s_add_u32 s17, s49, 65536
    buffer_load_dwordx4 v211, s[20:23], s17 offen lds
    s_add_u32 m0, s46, 2048
    s_add_u32 s17, s49, 131072
    buffer_load_dwordx4 v211, s[20:23], s17 offen lds
    s_add_u32 m0, s46, 3072
    s_add_u32 s17, s49, 196608
    buffer_load_dwordx4 v211, s[20:23], s17 offen lds
    s_add_u32 m0, s46, 4096
    s_add_u32 s17, s49, 262144
    buffer_load_dwordx4 v211, s[20:23], s17 offen lds
    s_add_u32 m0, s46, 5120
    s_add_u32 s17, s49, 327680
    buffer_load_dwordx4 v211, s[20:23], s17 offen lds
    s_add_u32 m0, s46, 6144
    s_add_u32 s17, s49, 393216
    buffer_load_dwordx4 v211, s[20:23], s17 offen lds
    s_add_u32 m0, s46, 7168
    s_add_u32 s17, s49, 458752
    buffer_load_dwordx4 v211, s[20:23], s17 offen lds
    s_add_u32 m0, s46, 8192
    s_add_u32 s17, s49, 524288
    buffer_load_dwordx4 v211, s[20:23], s17 offen lds
    s_add_u32 m0, s46, 9216
    s_add_u32 s17, s49, 589824
    buffer_load_dwordx4 v211, s[20:23], s17 offen lds
    s_add_u32 m0, s46, 10240
    s_add_u32 s17, s49, 655360
    buffer_load_dwordx4 v211, s[20:23], s17 offen lds
    s_add_u32 m0, s46, 11264
    s_add_u32 s17, s49, 720896
    buffer_load_dwordx4 v211, s[20:23], s17 offen lds
    s_add_u32 m0, s46, 12288
    s_add_u32 s17, s49, 786432
    buffer_load_dwordx4 v211, s[20:23], s17 offen lds
    s_add_u32 m0, s46, 13312
    s_add_u32 s17, s49, 851968
    buffer_load_dwordx4 v211, s[20:23], s17 offen lds
    s_add_u32 m0, s46, 14336
    s_add_u32 s17, s49, 917504
    buffer_load_dwordx4 v211, s[20:23], s17 offen lds
    s_add_u32 m0, s46, 15360
    s_add_u32 s17, s49, 983040
    buffer_load_dwordx4 v211, s[20:23], s17 offen lds
    s_add_u32 m0, s46, 16384
    s_add_u32 s17, s49, 1048576
    buffer_load_dwordx4 v211, s[20:23], s17 offen lds
    s_add_u32 m0, s46, 17408
    s_add_u32 s17, s49, 1114112
    buffer_load_dwordx4 v211, s[20:23], s17 offen lds
    s_add_u32 m0, s46, 18432
    s_add_u32 s17, s49, 1179648
    buffer_load_dwordx4 v211, s[20:23], s17 offen lds
    s_add_u32 m0, s46, 19456
    s_add_u32 s17, s49, 1245184
    buffer_load_dwordx4 v211, s[20:23], s17 offen lds
    s_add_u32 m0, s46, 20480
    s_add_u32 s17, s49, 1310720
    buffer_load_dwordx4 v211, s[20:23], s17 offen lds
    s_add_u32 m0, s46, 21504
    s_add_u32 s17, s49, 1376256
    buffer_load_dwordx4 v211, s[20:23], s17 offen lds
    s_add_u32 m0, s46, 22528
    s_add_u32 s17, s49, 1441792
    buffer_load_dwordx4 v211, s[20:23], s17 offen lds
    s_add_u32 m0, s46, 23552
    s_add_u32 s17, s49, 1507328
    buffer_load_dwordx4 v211, s[20:23], s17 offen lds
    s_add_u32 m0, s46, 24576
    s_add_u32 s17, s49, 1572864
    buffer_load_dwordx4 v211, s[20:23], s17 offen lds
    s_add_u32 m0, s46, 25600
    s_add_u32 s17, s49, 1638400
    buffer_load_dwordx4 v211, s[20:23], s17 offen lds
    s_add_u32 m0, s46, 26624
    s_add_u32 s17, s49, 1703936
    buffer_load_dwordx4 v211, s[20:23], s17 offen lds
    s_add_u32 m0, s46, 27648
    s_add_u32 s17, s49, 1769472
    buffer_load_dwordx4 v211, s[20:23], s17 offen lds
    s_add_u32 m0, s46, 28672
    s_add_u32 s17, s49, 1835008
    buffer_load_dwordx4 v211, s[20:23], s17 offen lds
    s_add_u32 m0, s46, 29696
    s_add_u32 s17, s49, 1900544
    buffer_load_dwordx4 v211, s[20:23], s17 offen lds
    s_add_u32 m0, s46, 30720
    s_add_u32 s17, s49, 1966080
    buffer_load_dwordx4 v211, s[20:23], s17 offen lds
    s_add_u32 m0, s46, 31744
    s_add_u32 s17, s49, 2031616
    buffer_load_dwordx4 v211, s[20:23], s17 offen lds
    s_waitcnt vmcnt(30)
    ds_read_b64_tr_b16 a[0:1], v210 offset:0
    ds_read_b64_tr_b16 a[2:3], v210 offset:512
    ds_read_b64_tr_b16 a[144:145], v210 offset:64
    ds_read_b64_tr_b16 a[146:147], v210 offset:576
    s_waitcnt lgkmcnt(0)
    s_add_u32 m0, s46, 0
    s_add_u32 s17, s49, 2097152
    buffer_load_dwordx4 v211, s[20:23], s17 offen lds
    s_add_u32 m0, s46, 1024
    s_add_u32 s17, s49, 2162688
    buffer_load_dwordx4 v211, s[20:23], s17 offen lds
    s_waitcnt vmcnt(30)
    ds_read_b64_tr_b16 a[4:5], v210 offset:2048
    ds_read_b64_tr_b16 a[6:7], v210 offset:2560
    ds_read_b64_tr_b16 a[148:149], v210 offset:2112
    ds_read_b64_tr_b16 a[150:151], v210 offset:2624
    s_waitcnt lgkmcnt(0)
    s_add_u32 m0, s46, 2048
    s_add_u32 s17, s49, 2228224
    buffer_load_dwordx4 v211, s[20:23], s17 offen lds
    s_add_u32 m0, s46, 3072
    s_add_u32 s17, s49, 2293760
    buffer_load_dwordx4 v211, s[20:23], s17 offen lds
    s_waitcnt vmcnt(30)
    ds_read_b64_tr_b16 a[8:9], v210 offset:4096
    ds_read_b64_tr_b16 a[10:11], v210 offset:4608
    ds_read_b64_tr_b16 a[152:153], v210 offset:4160
    ds_read_b64_tr_b16 a[154:155], v210 offset:4672
    s_waitcnt lgkmcnt(0)
    s_add_u32 m0, s46, 4096
    s_add_u32 s17, s49, 2359296
    buffer_load_dwordx4 v211, s[20:23], s17 offen lds
    s_add_u32 m0, s46, 5120
    s_add_u32 s17, s49, 2424832
    buffer_load_dwordx4 v211, s[20:23], s17 offen lds
    s_waitcnt vmcnt(30)
    ds_read_b64_tr_b16 a[12:13], v210 offset:6144
    ds_read_b64_tr_b16 a[14:15], v210 offset:6656
    ds_read_b64_tr_b16 a[156:157], v210 offset:6208
    ds_read_b64_tr_b16 a[158:159], v210 offset:6720
    s_waitcnt lgkmcnt(0)
    s_add_u32 m0, s46, 6144
    s_add_u32 s17, s49, 2490368
    buffer_load_dwordx4 v211, s[20:23], s17 offen lds
    s_add_u32 m0, s46, 7168
    s_add_u32 s17, s49, 2555904
    buffer_load_dwordx4 v211, s[20:23], s17 offen lds
    s_waitcnt vmcnt(30)
    ds_read_b64_tr_b16 a[16:17], v210 offset:8192
    ds_read_b64_tr_b16 a[18:19], v210 offset:8704
    ds_read_b64_tr_b16 a[160:161], v210 offset:8256
    ds_read_b64_tr_b16 a[162:163], v210 offset:8768
    s_waitcnt lgkmcnt(0)
    s_add_u32 m0, s46, 8192
    s_add_u32 s17, s49, 2621440
    buffer_load_dwordx4 v211, s[20:23], s17 offen lds
    s_add_u32 m0, s46, 9216
    s_add_u32 s17, s49, 2686976
    buffer_load_dwordx4 v211, s[20:23], s17 offen lds
    s_waitcnt vmcnt(30)
    ds_read_b64_tr_b16 a[20:21], v210 offset:10240
    ds_read_b64_tr_b16 a[22:23], v210 offset:10752
    ds_read_b64_tr_b16 a[164:165], v210 offset:10304
    ds_read_b64_tr_b16 a[166:167], v210 offset:10816
    s_waitcnt lgkmcnt(0)
    s_add_u32 m0, s46, 10240
    s_add_u32 s17, s49, 2752512
    buffer_load_dwordx4 v211, s[20:23], s17 offen lds
    s_add_u32 m0, s46, 11264
    s_add_u32 s17, s49, 2818048
    buffer_load_dwordx4 v211, s[20:23], s17 offen lds
    s_waitcnt vmcnt(30)
    ds_read_b64_tr_b16 a[24:25], v210 offset:12288
    ds_read_b64_tr_b16 a[26:27], v210 offset:12800
    ds_read_b64_tr_b16 a[168:169], v210 offset:12352
    ds_read_b64_tr_b16 a[170:171], v210 offset:12864
    s_waitcnt lgkmcnt(0)
    s_add_u32 m0, s46, 12288
    s_add_u32 s17, s49, 2883584
    buffer_load_dwordx4 v211, s[20:23], s17 offen lds
    s_add_u32 m0, s46, 13312
    s_add_u32 s17, s49, 2949120
    buffer_load_dwordx4 v211, s[20:23], s17 offen lds
    s_waitcnt vmcnt(30)
    ds_read_b64_tr_b16 a[28:29], v210 offset:14336
    ds_read_b64_tr_b16 a[30:31], v210 offset:14848
    ds_read_b64_tr_b16 a[172:173], v210 offset:14400
    ds_read_b64_tr_b16 a[174:175], v210 offset:14912
    s_waitcnt lgkmcnt(0)
    s_add_u32 m0, s46, 14336
    s_add_u32 s17, s49, 3014656
    buffer_load_dwordx4 v211, s[20:23], s17 offen lds
    s_add_u32 m0, s46, 15360
    s_add_u32 s17, s49, 3080192
    buffer_load_dwordx4 v211, s[20:23], s17 offen lds
    s_waitcnt vmcnt(30)
    ds_read_b64_tr_b16 a[32:33], v210 offset:16384
    ds_read_b64_tr_b16 a[34:35], v210 offset:16896
    ds_read_b64_tr_b16 a[176:177], v210 offset:16448
    ds_read_b64_tr_b16 a[178:179], v210 offset:16960
    s_waitcnt lgkmcnt(0)
    s_add_u32 m0, s46, 16384
    s_add_u32 s17, s49, 3145728
    buffer_load_dwordx4 v211, s[20:23], s17 offen lds
    s_add_u32 m0, s46, 17408
    s_add_u32 s17, s49, 3211264
    buffer_load_dwordx4 v211, s[20:23], s17 offen lds
    s_waitcnt vmcnt(30)
    ds_read_b64_tr_b16 a[36:37], v210 offset:18432
    ds_read_b64_tr_b16 a[38:39], v210 offset:18944
    ds_read_b64_tr_b16 a[180:181], v210 offset:18496
    ds_read_b64_tr_b16 a[182:183], v210 offset:19008
    s_waitcnt lgkmcnt(0)
    s_add_u32 m0, s46, 18432
    s_add_u32 s17, s49, 3276800
    buffer_load_dwordx4 v211, s[20:23], s17 offen lds
    s_add_u32 m0, s46, 19456
    s_add_u32 s17, s49, 3342336
    buffer_load_dwordx4 v211, s[20:23], s17 offen lds
    s_waitcnt vmcnt(30)
    ds_read_b64_tr_b16 a[40:41], v210 offset:20480
    ds_read_b64_tr_b16 a[42:43], v210 offset:20992
    ds_read_b64_tr_b16 a[184:185], v210 offset:20544
    ds_read_b64_tr_b16 a[186:187], v210 offset:21056
    s_waitcnt lgkmcnt(0)
    s_add_u32 m0, s46, 20480
    s_add_u32 s17, s49, 3407872
    buffer_load_dwordx4 v211, s[20:23], s17 offen lds
    s_add_u32 m0, s46, 21504
    s_add_u32 s17, s49, 3473408
    buffer_load_dwordx4 v211, s[20:23], s17 offen lds
    s_waitcnt vmcnt(30)
    ds_read_b64_tr_b16 a[44:45], v210 offset:22528
    ds_read_b64_tr_b16 a[46:47], v210 offset:23040
    ds_read_b64_tr_b16 a[188:189], v210 offset:22592
    ds_read_b64_tr_b16 a[190:191], v210 offset:23104
    s_waitcnt lgkmcnt(0)
    s_add_u32 m0, s46, 22528
    s_add_u32 s17, s49, 3538944
    buffer_load_dwordx4 v211, s[20:23], s17 offen lds
    s_add_u32 m0, s46, 23552
    s_add_u32 s17, s49, 3604480
    buffer_load_dwordx4 v211, s[20:23], s17 offen lds
    s_waitcnt vmcnt(30)
    ds_read_b64_tr_b16 a[48:49], v210 offset:24576
    ds_read_b64_tr_b16 a[50:51], v210 offset:25088
    ds_read_b64_tr_b16 a[192:193], v210 offset:24640
    ds_read_b64_tr_b16 a[194:195], v210 offset:25152
    s_waitcnt lgkmcnt(0)
    s_add_u32 m0, s46, 24576
    s_add_u32 s17, s49, 3670016
    buffer_load_dwordx4 v211, s[20:23], s17 offen lds
    s_add_u32 m0, s46, 25600
    s_add_u32 s17, s49, 3735552
    buffer_load_dwordx4 v211, s[20:23], s17 offen lds
    s_waitcnt vmcnt(30)
    ds_read_b64_tr_b16 a[52:53], v210 offset:26624
    ds_read_b64_tr_b16 a[54:55], v210 offset:27136
    ds_read_b64_tr_b16 a[196:197], v210 offset:26688
    ds_read_b64_tr_b16 a[198:199], v210 offset:27200
    s_waitcnt lgkmcnt(0)
    s_add_u32 m0, s46, 26624
    s_add_u32 s17, s49, 3801088
    buffer_load_dwordx4 v211, s[20:23], s17 offen lds
    s_add_u32 m0, s46, 27648
    s_add_u32 s17, s49, 3866624
    buffer_load_dwordx4 v211, s[20:23], s17 offen lds
    s_waitcnt vmcnt(30)
    ds_read_b64_tr_b16 a[56:57], v210 offset:28672
    ds_read_b64_tr_b16 a[58:59], v210 offset:29184
    ds_read_b64_tr_b16 a[200:201], v210 offset:28736
    ds_read_b64_tr_b16 a[202:203], v210 offset:29248
    s_waitcnt lgkmcnt(0)
    s_add_u32 m0, s46, 28672
    s_add_u32 s17, s49, 3932160
    buffer_load_dwordx4 v211, s[20:23], s17 offen lds
    s_add_u32 m0, s46, 29696
    s_add_u32 s17, s49, 3997696
    buffer_load_dwordx4 v211, s[20:23], s17 offen lds
    s_waitcnt vmcnt(30)
    ds_read_b64_tr_b16 a[60:61], v210 offset:30720
    ds_read_b64_tr_b16 a[62:63], v210 offset:31232
    ds_read_b64_tr_b16 a[204:205], v210 offset:30784
    ds_read_b64_tr_b16 a[206:207], v210 offset:31296
    s_waitcnt lgkmcnt(0)
    s_add_u32 m0, s46, 30720
    s_add_u32 s17, s49, 4063232
    buffer_load_dwordx4 v211, s[20:23], s17 offen lds
    s_add_u32 m0, s46, 31744
    s_add_u32 s17, s49, 4128768
    buffer_load_dwordx4 v211, s[20:23], s17 offen lds
    s_waitcnt vmcnt(30)
    ds_read_b64_tr_b16 a[64:65], v210 offset:0
    ds_read_b64_tr_b16 a[66:67], v210 offset:512
    ds_read_b64_tr_b16 a[208:209], v210 offset:64
    ds_read_b64_tr_b16 a[210:211], v210 offset:576
    s_waitcnt lgkmcnt(0)
    s_add_u32 m0, s46, 0
    s_add_u32 s17, s49, 4194304
    buffer_load_dwordx4 v211, s[20:23], s17 offen lds
    s_add_u32 m0, s46, 1024
    s_add_u32 s17, s49, 4259840
    buffer_load_dwordx4 v211, s[20:23], s17 offen lds
    s_waitcnt vmcnt(30)
    ds_read_b64_tr_b16 a[68:69], v210 offset:2048
    ds_read_b64_tr_b16 a[70:71], v210 offset:2560
    ds_read_b64_tr_b16 a[212:213], v210 offset:2112
    ds_read_b64_tr_b16 a[214:215], v210 offset:2624
    s_waitcnt lgkmcnt(0)
    s_add_u32 m0, s46, 2048
    s_add_u32 s17, s49, 4325376
    buffer_load_dwordx4 v211, s[20:23], s17 offen lds
    s_add_u32 m0, s46, 3072
    s_add_u32 s17, s49, 4390912
    buffer_load_dwordx4 v211, s[20:23], s17 offen lds
    s_waitcnt vmcnt(30)
    ds_read_b64_tr_b16 a[72:73], v210 offset:4096
    ds_read_b64_tr_b16 a[74:75], v210 offset:4608
    ds_read_b64_tr_b16 a[216:217], v210 offset:4160
    ds_read_b64_tr_b16 a[218:219], v210 offset:4672
    s_waitcnt lgkmcnt(0)
    s_add_u32 m0, s46, 4096
    s_add_u32 s17, s49, 4456448
    buffer_load_dwordx4 v211, s[20:23], s17 offen lds
    s_add_u32 m0, s46, 5120
    s_add_u32 s17, s49, 4521984
    buffer_load_dwordx4 v211, s[20:23], s17 offen lds
    s_waitcnt vmcnt(30)
    ds_read_b64_tr_b16 a[76:77], v210 offset:6144
    ds_read_b64_tr_b16 a[78:79], v210 offset:6656
    ds_read_b64_tr_b16 a[220:221], v210 offset:6208
    ds_read_b64_tr_b16 a[222:223], v210 offset:6720
    s_waitcnt lgkmcnt(0)
    s_add_u32 m0, s46, 6144
    s_add_u32 s17, s49, 4587520
    buffer_load_dwordx4 v211, s[20:23], s17 offen lds
    s_add_u32 m0, s46, 7168
    s_add_u32 s17, s49, 4653056
    buffer_load_dwordx4 v211, s[20:23], s17 offen lds
    s_waitcnt vmcnt(30)
    ds_read_b64_tr_b16 a[80:81], v210 offset:8192
    ds_read_b64_tr_b16 a[82:83], v210 offset:8704
    ds_read_b64_tr_b16 a[224:225], v210 offset:8256
    ds_read_b64_tr_b16 a[226:227], v210 offset:8768
    s_waitcnt vmcnt(28)
    ds_read_b64_tr_b16 a[84:85], v210 offset:10240
    ds_read_b64_tr_b16 a[86:87], v210 offset:10752
    ds_read_b64_tr_b16 a[228:229], v210 offset:10304
    ds_read_b64_tr_b16 a[230:231], v210 offset:10816
    s_waitcnt vmcnt(26)
    ds_read_b64_tr_b16 a[88:89], v210 offset:12288
    ds_read_b64_tr_b16 a[90:91], v210 offset:12800
    ds_read_b64_tr_b16 a[232:233], v210 offset:12352
    ds_read_b64_tr_b16 a[234:235], v210 offset:12864
    s_waitcnt vmcnt(24)
    ds_read_b64_tr_b16 a[92:93], v210 offset:14336
    ds_read_b64_tr_b16 a[94:95], v210 offset:14848
    ds_read_b64_tr_b16 a[236:237], v210 offset:14400
    ds_read_b64_tr_b16 a[238:239], v210 offset:14912
    s_waitcnt vmcnt(22)
    ds_read_b64_tr_b16 a[96:97], v210 offset:16384
    ds_read_b64_tr_b16 a[98:99], v210 offset:16896
    ds_read_b64_tr_b16 a[240:241], v210 offset:16448
    ds_read_b64_tr_b16 a[242:243], v210 offset:16960
    s_waitcnt vmcnt(20)
    ds_read_b64_tr_b16 a[100:101], v210 offset:18432
    ds_read_b64_tr_b16 a[102:103], v210 offset:18944
    ds_read_b64_tr_b16 a[244:245], v210 offset:18496
    ds_read_b64_tr_b16 a[246:247], v210 offset:19008
    s_waitcnt vmcnt(18)
    ds_read_b64_tr_b16 a[104:105], v210 offset:20480
    ds_read_b64_tr_b16 a[106:107], v210 offset:20992
    ds_read_b64_tr_b16 a[248:249], v210 offset:20544
    ds_read_b64_tr_b16 a[250:251], v210 offset:21056
    s_waitcnt vmcnt(16)
    ds_read_b64_tr_b16 a[108:109], v210 offset:22528
    ds_read_b64_tr_b16 a[110:111], v210 offset:23040
    ds_read_b64_tr_b16 a[252:253], v210 offset:22592
    ds_read_b64_tr_b16 a[254:255], v210 offset:23104
    s_waitcnt vmcnt(14)
    ds_read_b64_tr_b16 a[112:113], v210 offset:24576
    ds_read_b64_tr_b16 a[114:115], v210 offset:25088
    ds_read_b64_tr_b16 v[224:225], v210 offset:24640
    ds_read_b64_tr_b16 v[226:227], v210 offset:25152
    s_waitcnt vmcnt(12)
    ds_read_b64_tr_b16 a[116:117], v210 offset:26624
    ds_read_b64_tr_b16 a[118:119], v210 offset:27136
    ds_read_b64_tr_b16 v[228:229], v210 offset:26688
    ds_read_b64_tr_b16 v[230:231], v210 offset:27200
    s_waitcnt vmcnt(10)
    ds_read_b64_tr_b16 a[120:121], v210 offset:28672
    ds_read_b64_tr_b16 a[122:123], v210 offset:29184
    ds_read_b64_tr_b16 v[232:233], v210 offset:28736
    ds_read_b64_tr_b16 v[234:235], v210 offset:29248
    s_waitcnt vmcnt(8)
    ds_read_b64_tr_b16 a[124:125], v210 offset:30720
    ds_read_b64_tr_b16 a[126:127], v210 offset:31232
    ds_read_b64_tr_b16 v[236:237], v210 offset:30784
    ds_read_b64_tr_b16 v[238:239], v210 offset:31296
    s_waitcnt vmcnt(6)
    ds_read_b64_tr_b16 a[128:129], v210 offset:0
    ds_read_b64_tr_b16 a[130:131], v210 offset:512
    ds_read_b64_tr_b16 v[240:241], v210 offset:64
    ds_read_b64_tr_b16 v[242:243], v210 offset:576
    s_waitcnt vmcnt(4)
    ds_read_b64_tr_b16 a[132:133], v210 offset:2048
    ds_read_b64_tr_b16 a[134:135], v210 offset:2560
    ds_read_b64_tr_b16 v[244:245], v210 offset:2112
    ds_read_b64_tr_b16 v[246:247], v210 offset:2624
    s_waitcnt vmcnt(2)
    ds_read_b64_tr_b16 a[136:137], v210 offset:4096
    ds_read_b64_tr_b16 a[138:139], v210 offset:4608
    ds_read_b64_tr_b16 v[248:249], v210 offset:4160
    ds_read_b64_tr_b16 v[250:251], v210 offset:4672
    s_waitcnt vmcnt(0)
    ds_read_b64_tr_b16 a[140:141], v210 offset:6144
    ds_read_b64_tr_b16 a[142:143], v210 offset:6656
    ds_read_b64_tr_b16 v[252:253], v210 offset:6208
    ds_read_b64_tr_b16 v[254:255], v210 offset:6720
    s_waitcnt vmcnt(0) lgkmcnt(0)
    v_bfe_u32 v10, v0, 4, 5
    v_lshrrev_b32 v5, 9, v0
    v_lshlrev_b32 v10, 4, v10
    v_mul_u32_u24 v6, 2560, v5
    v_add_u32 v10, v10, v6
    v_add_u32 v10, 114688, v10
    s_lshl_b32 s67, s14, 10
    v_bfe_u32 v6, v0, 8, 1
    v_lshlrev_b32 v13, 10, v6
    v_lshl_add_u32 v13, v7, 4, v13
    v_lshl_add_u32 v13, v5, 8, v13
    v_mov_b32 v212, 1
    v_mov_b32 v213, 1
    s_mul_i32 s52, s50, 16777216
    s_lshl_b32 s17, s51, 13
    s_add_u32 s52, s52, s17
    s_lshl_b32 s17, s47, 12
    s_add_u32 s52, s52, s17
    s_add_u32 s52, s52, 44040192
    s_lshl_b32 s49, s51, 9
    s_lshl_b32 s17, s50, 7
    s_add_u32 s49, s49, s17
    s_lshl_b32 s17, s47, 3
    s_add_u32 s49, s49, s17
    s_add_u32 s49, s49, 185600
    v_mov_b32 v48, 0x3f803f80
    v_mov_b32 v49, 0x3f803f80
    v_mov_b32 v50, 0x3f803f80
    v_mov_b32 v51, 0x3f803f80
    s_lshl_b32 s17, s14, 8
    s_add_u32 s17, s17, 110592
    v_bfe_u32 v5, v0, 4, 5
    v_lshl_add_u32 v14, v5, 2, s17
    v_lshrrev_b32 v5, 9, v0
    v_lshl_add_u32 v214, v5, 4, s17
    s_cmp_eq_u32 s50, 2
    s_cbranch_scc1 Lp_v
    v_mfma_f32_32x32x16_bf16 v[148:163], a[0:3], v[48:51], 0
    v_mfma_f32_32x32x16_bf16 v[148:163], a[4:7], v[48:51], v[148:163]
    v_mfma_f32_32x32x16_bf16 v[148:163], a[8:11], v[48:51], v[148:163]
    v_mfma_f32_32x32x16_bf16 v[148:163], a[12:15], v[48:51], v[148:163]
    v_mfma_f32_32x32x16_bf16 v[148:163], a[16:19], v[48:51], v[148:163]
    v_mfma_f32_32x32x16_bf16 v[148:163], a[20:23], v[48:51], v[148:163]
    v_mfma_f32_32x32x16_bf16 v[148:163], a[24:27], v[48:51], v[148:163]
    v_mfma_f32_32x32x16_bf16 v[148:163], a[28:31], v[48:51], v[148:163]
    v_mfma_f32_32x32x16_bf16 v[148:163], a[32:35], v[48:51], v[148:163]
    v_mfma_f32_32x32x16_bf16 v[148:163], a[36:39], v[48:51], v[148:163]
    v_mfma_f32_32x32x16_bf16 v[148:163], a[40:43], v[48:51], v[148:163]
    v_mfma_f32_32x32x16_bf16 v[148:163], a[44:47], v[48:51], v[148:163]
    v_mfma_f32_32x32x16_bf16 v[148:163], a[48:51], v[48:51], v[148:163]
    v_mfma_f32_32x32x16_bf16 v[148:163], a[52:55], v[48:51], v[148:163]
    v_mfma_f32_32x32x16_bf16 v[148:163], a[56:59], v[48:51], v[148:163]
    v_mfma_f32_32x32x16_bf16 v[148:163], a[60:63], v[48:51], v[148:163]
    v_mfma_f32_32x32x16_bf16 v[148:163], a[64:67], v[48:51], v[148:163]
    v_mfma_f32_32x32x16_bf16 v[148:163], a[68:71], v[48:51], v[148:163]
    v_mfma_f32_32x32x16_bf16 v[148:163], a[72:75], v[48:51], v[148:163]
    v_mfma_f32_32x32x16_bf16 v[148:163], a[76:79], v[48:51], v[148:163]
    v_mfma_f32_32x32x16_bf16 v[148:163], a[80:83], v[48:51], v[148:163]
    v_mfma_f32_32x32x16_bf16 v[148:163], a[84:87], v[48:51], v[148:163]
    v_mfma_f32_32x32x16_bf16 v[148:163], a[88:91], v[48:51], v[148:163]
    v_mfma_f32_32x32x16_bf16 v[148:163], a[92:95], v[48:51], v[148:163]
    v_mfma_f32_32x32x16_bf16 v[148:163], a[96:99], v[48:51], v[148:163]
    v_mfma_f32_32x32x16_bf16 v[148:163], a[100:103], v[48:51], v[148:163]
    v_mfma_f32_32x32x16_bf16 v[148:163], a[104:107], v[48:51], v[148:163]
    v_mfma_f32_32x32x16_bf16 v[148:163], a[108:111], v[48:51], v[148:163]
    v_mfma_f32_32x32x16_bf16 v[148:163], a[112:115], v[48:51], v[148:163]
    v_mfma_f32_32x32x16_bf16 v[148:163], a[116:119], v[48:51], v[148:163]
    v_mfma_f32_32x32x16_bf16 v[148:163], a[120:123], v[48:51], v[148:163]
    v_mfma_f32_32x32x16_bf16 v[148:163], a[124:127], v[48:51], v[148:163]
    v_mfma_f32_32x32x16_bf16 v[148:163], a[128:131], v[48:51], v[148:163]
    v_mfma_f32_32x32x16_bf16 v[148:163], a[132:135], v[48:51], v[148:163]
    v_mfma_f32_32x32x16_bf16 v[148:163], a[136:139], v[48:51], v[148:163]
    v_mfma_f32_32x32x16_bf16 v[148:163], a[140:143], v[48:51], v[148:163]
    v_mfma_f32_32x32x16_bf16 v[164:179], a[144:147], v[48:51], 0
    v_mfma_f32_32x32x16_bf16 v[164:179], a[148:151], v[48:51], v[164:179]
    v_mfma_f32_32x32x16_bf16 v[164:179], a[152:155], v[48:51], v[164:179]
    v_mfma_f32_32x32x16_bf16 v[164:179], a[156:159], v[48:51], v[164:179]
    v_mfma_f32_32x32x16_bf16 v[164:179], a[160:163], v[48:51], v[164:179]
    v_mfma_f32_32x32x16_bf16 v[164:179], a[164:167], v[48:51], v[164:179]
    v_mfma_f32_32x32x16_bf16 v[164:179], a[168:171], v[48:51], v[164:179]
    v_mfma_f32_32x32x16_bf16 v[164:179], a[172:175], v[48:51], v[164:179]
    v_mfma_f32_32x32x16_bf16 v[164:179], a[176:179], v[48:51], v[164:179]
    v_mfma_f32_32x32x16_bf16 v[164:179], a[180:183], v[48:51], v[164:179]
    v_mfma_f32_32x32x16_bf16 v[164:179], a[184:187], v[48:51], v[164:179]
    v_mfma_f32_32x32x16_bf16 v[164:179], a[188:191], v[48:51], v[164:179]
    v_mfma_f32_32x32x16_bf16 v[164:179], a[192:195], v[48:51], v[164:179]
    v_mfma_f32_32x32x16_bf16 v[164:179], a[196:199], v[48:51], v[164:179]
    v_mfma_f32_32x32x16_bf16 v[164:179], a[200:203], v[48:51], v[164:179]
    v_mfma_f32_32x32x16_bf16 v[164:179], a[204:207], v[48:51], v[164:179]
    v_mfma_f32_32x32x16_bf16 v[164:179], a[208:211], v[48:51], v[164:179]
    v_mfma_f32_32x32x16_bf16 v[164:179], a[212:215], v[48:51], v[164:179]
    v_mfma_f32_32x32x16_bf16 v[164:179], a[216:219], v[48:51], v[164:179]
    v_mfma_f32_32x32x16_bf16 v[164:179], a[220:223], v[48:51], v[164:179]
    v_mfma_f32_32x32x16_bf16 v[164:179], a[224:227], v[48:51], v[164:179]
    v_mfma_f32_32x32x16_bf16 v[164:179], a[228:231], v[48:51], v[164:179]
    v_mfma_f32_32x32x16_bf16 v[164:179], a[232:235], v[48:51], v[164:179]
    v_mfma_f32_32x32x16_bf16 v[164:179], a[236:239], v[48:51], v[164:179]
    v_mfma_f32_32x32x16_bf16 v[164:179], a[240:243], v[48:51], v[164:179]
    v_mfma_f32_32x32x16_bf16 v[164:179], a[244:247], v[48:51], v[164:179]
    v_mfma_f32_32x32x16_bf16 v[164:179], a[248:251], v[48:51], v[164:179]
    v_mfma_f32_32x32x16_bf16 v[164:179], a[252:255], v[48:51], v[164:179]
    v_mfma_f32_32x32x16_bf16 v[164:179], v[224:227], v[48:51], v[164:179]
    v_mfma_f32_32x32x16_bf16 v[164:179], v[228:231], v[48:51], v[164:179]
    v_mfma_f32_32x32x16_bf16 v[164:179], v[232:235], v[48:51], v[164:179]
    v_mfma_f32_32x32x16_bf16 v[164:179], v[236:239], v[48:51], v[164:179]
    v_mfma_f32_32x32x16_bf16 v[164:179], v[240:243], v[48:51], v[164:179]
    v_mfma_f32_32x32x16_bf16 v[164:179], v[244:247], v[48:51], v[164:179]
    v_mfma_f32_32x32x16_bf16 v[164:179], v[248:251], v[48:51], v[164:179]
    v_mfma_f32_32x32x16_bf16 v[164:179], v[252:255], v[48:51], v[164:179]
    s_mov_b32 s66, 114688
    s_mov_b32 s71, 0x2000
    s_mov_b32 s36, s63
    s_mov_b32 s34, s63
    s_mov_b32 s37, 0
    s_lshl_b32 s56, s63, 6
    s_mul_i32 s58, s14, 9216
    s_mov_b32 s40, 36864
    s_mov_b32 s59, s58
    s_mov_b32 s43, 0
    s_mov_b32 s28, s8
    s_mov_b32 s29, s9
    s_mov_b32 s30, 0
    s_mov_b32 s31, 0x00020000
    s_mul_i32 s41, s63, 4718592
    s_add_u32 s41, s41, s58
    s_add_u32 s41, s41, 8650752
    s_mul_i32 s42, s56, 22528
    s_add_u32 s42, s42, 183808
    s_cmp_lg_u32 s14, 0
    s_cbranch_scc1 LpQ_ini_d
    v_mov_b32 v5, 160
    s_mov_b32 s16, 0
LpQ_ini:
    global_load_dword v6, v5, s[12:13] sc1
    s_add_u32 s16, s16, 1
    s_cmp_gt_u32 s16, 100000
    s_cbranch_scc1 L_role_p_abort
    s_waitcnt vmcnt(0)
    v_cmp_gt_u32 vcc, 123, v6
    s_nop 0
    s_cbranch_vccz LpQ_ini_d
    s_sleep 8
    s_branch LpQ_ini
LpQ_ini_d:
    s_barrier
    s_branch LpQ_poll
LpQ_item:
    s_waitcnt vmcnt(4)
LpQ_go:
    s_barrier
    s_xor_b32 s40, s40, 36864
    s_xor_b32 s59, s59, 36864
    s_xor_b32 s66, s66, 0x2000
    s_xor_b32 s71, s71, 0x2000
    s_mov_b32 s35, s37
    s_mov_b32 s57, s56
    s_add_u32 s37, s37, 1
    s_add_u32 s56, s56, 1
    s_add_u32 s41, s41, 36864
    s_add_u32 s42, s42, 22528
    s_mov_b32 s62, 0
    v_add_u32 v9, s40, v0
    v_add_u32 v5, s71, v10
    ds_read_b128 v[48:51], v9 offset:0
    ds_read_b128 v[52:55], v9 offset:1024
    ds_read_b128 v[56:59], v9 offset:2048
    s_waitcnt lgkmcnt(2)
    v_mfma_f32_32x32x16_bf16 v[16:31], a[0:3], v[48:51], 0
    ds_read_b128 v[60:63], v9 offset:3072
    ds_read_b128 v[96:99], v5 offset:0
    ds_read_b128 v[100:103], v5 offset:512
    s_waitcnt lgkmcnt(4)
    v_mfma_f32_32x32x16_bf16 v[16:31], a[4:7], v[52:55], v[16:31]
    ds_read_b128 v[64:67], v9 offset:4096
    ds_read_b128 v[104:107], v5 offset:1024
    ds_read_b128 v[108:111], v5 offset:1536
    s_waitcnt lgkmcnt(6)
    v_mfma_f32_32x32x16_bf16 v[16:31], a[8:11], v[56:59], v[16:31]
    ds_read_b128 v[68:71], v9 offset:5120
    ds_read_b128 v[112:115], v5 offset:2048
    s_waitcnt lgkmcnt(7)
    v_mfma_f32_32x32x16_bf16 v[16:31], a[12:15], v[60:63], v[16:31]
    ds_read_b128 v[72:75], v9 offset:6144
    s_waitcnt lgkmcnt(6)
    v_add_f32 v96, v96, v100
    s_waitcnt lgkmcnt(5)
    v_mfma_f32_32x32x16_bf16 v[16:31], a[16:19], v[64:67], v[16:31]
    ds_read_b128 v[76:79], v9 offset:7168
    v_add_f32 v97, v97, v101
    v_add_f32 v98, v98, v102
    s_waitcnt lgkmcnt(3)
    v_mfma_f32_32x32x16_bf16 v[16:31], a[20:23], v[68:71], v[16:31]
    ds_read_b128 v[80:83], v9 offset:8192
    v_add_f32 v99, v99, v103
    v_add_f32 v96, v96, v104
    s_waitcnt lgkmcnt(2)
    v_mfma_f32_32x32x16_bf16 v[16:31], a[24:27], v[72:75], v[16:31]
    ds_read_b128 v[84:87], v9 offset:9216
    v_add_f32 v97, v97, v105
    v_add_f32 v98, v98, v106
    s_waitcnt lgkmcnt(2)
    v_mfma_f32_32x32x16_bf16 v[16:31], a[28:31], v[76:79], v[16:31]
    ds_read_b128 v[88:91], v9 offset:10240
    v_add_f32 v99, v99, v107
    v_add_f32 v96, v96, v108
    s_waitcnt lgkmcnt(2)
    v_mfma_f32_32x32x16_bf16 v[16:31], a[32:35], v[80:83], v[16:31]
    ds_read_b128 v[92:95], v9 offset:11264
    v_add_f32 v97, v97, v109
    v_add_f32 v98, v98, v110
    v_mfma_f32_32x32x16_bf16 v[32:47], a[144:147], v[48:51], 0
    v_add_f32 v99, v99, v111
    v_add_f32 v96, v96, v112
    s_waitcnt lgkmcnt(2)
    v_mfma_f32_32x32x16_bf16 v[16:31], a[36:39], v[84:87], v[16:31]
    ds_read_b128 v[48:51], v9 offset:12288
    v_add_f32 v97, v97, v113
    v_add_f32 v98, v98, v114
    v_mfma_f32_32x32x16_bf16 v[32:47], a[148:151], v[52:55], v[32:47]
    v_add_f32 v99, v99, v115
    v_add_f32 v96, v96, v98
    s_waitcnt lgkmcnt(2)
    v_mfma_f32_32x32x16_bf16 v[16:31], a[40:43], v[88:91], v[16:31]
    ds_read_b128 v[52:55], v9 offset:13312
    v_add_f32 v97, v97, v99
    v_mov_b32 v98, v96
    v_mfma_f32_32x32x16_bf16 v[32:47], a[152:155], v[56:59], v[32:47]
    v_mov_b32 v99, v97
    v_permlane32_swap_b32 v96, v98
    s_waitcnt lgkmcnt(2)
    v_mfma_f32_32x32x16_bf16 v[16:31], a[44:47], v[92:95], v[16:31]
    ds_read_b128 v[56:59], v9 offset:14336
    v_permlane32_swap_b32 v97, v99
    v_add_f32 v96, v96, v98
    v_mfma_f32_32x32x16_bf16 v[32:47], a[156:159], v[60:63], v[32:47]
    v_add_f32 v97, v97, v99
    v_mul_f32 v96, 0x3ae38e39, v96
    s_waitcnt lgkmcnt(2)
    v_mfma_f32_32x32x16_bf16 v[16:31], a[48:51], v[48:51], v[16:31]
    ds_read_b128 v[60:63], v9 offset:15360
    v_mul_f32 v97, 0x3ae38e39, v97
    v_fma_f32 v97, -v96, v96, v97
    v_mfma_f32_32x32x16_bf16 v[32:47], a[160:163], v[64:67], v[32:47]
    v_max_f32 v97, 0, v97
    v_add_f32 v97, 0x3727c5ac, v97
    s_waitcnt lgkmcnt(2)
    v_mfma_f32_32x32x16_bf16 v[16:31], a[52:55], v[52:55], v[16:31]
    ds_read_b128 v[64:67], v9 offset:16384
    v_rsq_f32 v116, v97
    s_nop 0
    v_mul_f32 v117, v96, v116
    v_mfma_f32_32x32x16_bf16 v[32:47], a[164:167], v[68:71], v[32:47]
    s_mul_i32 s46, s34, 50331648
    s_lshl_b32 s19, s35, 18
    s_waitcnt lgkmcnt(2)
    v_mfma_f32_32x32x16_bf16 v[16:31], a[56:59], v[56:59], v[16:31]
    ds_read_b128 v[68:71], v9 offset:17408
    s_waitcnt vmcnt(0)
    buffer_load_dword v2, v1, s[8:11], s42 offen sc1
    s_cmp_lg_u32 s43, 0
    s_cselect_b64 exec, 1, 0
    buffer_store_dwordx2 v[212:213], v4, s[8:11], s43 offen sc1
    s_mov_b64 exec, -1
    s_mov_b32 s43, 0
    v_mfma_f32_32x32x16_bf16 v[32:47], a[168:171], v[72:75], v[32:47]
    s_add_u32 s46, s46, s19
    s_add_u32 s46, s46, s52
    s_waitcnt lgkmcnt(2)
    v_mfma_f32_32x32x16_bf16 v[16:31], a[60:63], v[60:63], v[16:31]
    ds_read_b128 v[72:75], v9 offset:18432
    v_mfma_f32_32x32x16_bf16 v[32:47], a[172:175], v[76:79], v[32:47]
    s_waitcnt lgkmcnt(2)
    v_mfma_f32_32x32x16_bf16 v[16:31], a[64:67], v[64:67], v[16:31]
    ds_read_b128 v[76:79], v9 offset:19456
    v_mfma_f32_32x32x16_bf16 v[32:47], a[176:179], v[80:83], v[32:47]
    s_waitcnt lgkmcnt(2)
    v_mfma_f32_32x32x16_bf16 v[16:31], a[68:71], v[68:71], v[16:31]
    ds_read_b128 v[80:83], v9 offset:20480
    v_mfma_f32_32x32x16_bf16 v[32:47], a[180:183], v[84:87], v[32:47]
    s_waitcnt lgkmcnt(2)
    v_mfma_f32_32x32x16_bf16 v[16:31], a[72:75], v[72:75], v[16:31]
    ds_read_b128 v[84:87], v9 offset:21504
    v_mfma_f32_32x32x16_bf16 v[32:47], a[184:187], v[88:91], v[32:47]
    s_waitcnt lgkmcnt(2)
    v_mfma_f32_32x32x16_bf16 v[16:31], a[76:79], v[76:79], v[16:31]
    ds_read_b128 v[88:91], v9 offset:22528
    v_mfma_f32_32x32x16_bf16 v[32:47], a[188:191], v[92:95], v[32:47]
    s_waitcnt lgkmcnt(2)
    v_mfma_f32_32x32x16_bf16 v[16:31], a[80:83], v[80:83], v[16:31]
    ds_read_b128 v[92:95], v9 offset:23552
    v_mfma_f32_32x32x16_bf16 v[32:47], a[192:195], v[48:51], v[32:47]
    s_waitcnt lgkmcnt(2)
    v_mfma_f32_32x32x16_bf16 v[16:31], a[84:87], v[84:87], v[16:31]
    ds_read_b128 v[48:51], v9 offset:24576
    v_mfma_f32_32x32x16_bf16 v[32:47], a[196:199], v[52:55], v[32:47]
    s_waitcnt lgkmcnt(2)
    v_mfma_f32_32x32x16_bf16 v[16:31], a[88:91], v[88:91], v[16:31]
    ds_read_b128 v[52:55], v9 offset:25600
    v_mfma_f32_32x32x16_bf16 v[32:47], a[200:203], v[56:59], v[32:47]
    s_waitcnt lgkmcnt(2)
    v_mfma_f32_32x32x16_bf16 v[16:31], a[92:95], v[92:95], v[16:31]
    ds_read_b128 v[56:59], v9 offset:26624
    v_mfma_f32_32x32x16_bf16 v[32:47], a[204:207], v[60:63], v[32:47]
    s_waitcnt lgkmcnt(2)
    v_mfma_f32_32x32x16_bf16 v[16:31], a[96:99], v[48:51], v[16:31]
    ds_read_b128 v[60:63], v9 offset:27648
    v_mfma_f32_32x32x16_bf16 v[32:47], a[208:211], v[64:67], v[32:47]
    s_waitcnt lgkmcnt(2)
    v_mfma_f32_32x32x16_bf16 v[16:31], a[100:103], v[52:55], v[16:31]
    ds_read_b128 v[64:67], v9 offset:28672
    s_waitcnt vmcnt(1)
    v_cmp_eq_u32 vcc, 0, v2
    s_nop 0
    s_cmp_eq_u64 vcc, 0
    s_cselect_b32 s62, 1, 0
    s_cmp_lt_u32 s37, 64
    s_cselect_b32 s62, s62, 0
    s_cmp_lg_u32 s62, 0
    s_cselect_b32 s30, 268435456, 0
    v_mfma_f32_32x32x16_bf16 v[32:47], a[212:215], v[68:71], v[32:47]
    s_waitcnt lgkmcnt(2)
    v_mfma_f32_32x32x16_bf16 v[16:31], a[104:107], v[56:59], v[16:31]
    ds_read_b128 v[68:71], v9 offset:29696
    s_add_u32 m0, s59, 0
    s_add_u32 s47, s41, 0
    buffer_load_dwordx4 v0, s[28:31], s47 offen offset:0 lds
    v_mfma_f32_32x32x16_bf16 v[32:47], a[216:219], v[72:75], v[32:47]
    s_waitcnt lgkmcnt(2)
    v_mfma_f32_32x32x16_bf16 v[16:31], a[108:111], v[60:63], v[16:31]
    ds_read_b128 v[72:75], v9 offset:30720
    buffer_load_dwordx4 v0, s[28:31], s47 offen offset:1024 lds
    v_mfma_f32_32x32x16_bf16 v[32:47], a[220:223], v[76:79], v[32:47]
    s_waitcnt lgkmcnt(2)
    v_mfma_f32_32x32x16_bf16 v[16:31], a[112:115], v[64:67], v[16:31]
    ds_read_b128 v[76:79], v9 offset:31744
    buffer_load_dwordx4 v0, s[28:31], s47 offen offset:2048 lds
    v_mfma_f32_32x32x16_bf16 v[32:47], a[224:227], v[80:83], v[32:47]
    s_waitcnt lgkmcnt(2)
    v_mfma_f32_32x32x16_bf16 v[16:31], a[116:119], v[68:71], v[16:31]
    ds_read_b128 v[80:83], v9 offset:32768
    buffer_load_dwordx4 v0, s[28:31], s47 offen offset:3072 lds
    v_mfma_f32_32x32x16_bf16 v[32:47], a[228:231], v[84:87], v[32:47]
    s_waitcnt lgkmcnt(2)
    v_mfma_f32_32x32x16_bf16 v[16:31], a[120:123], v[72:75], v[16:31]
    ds_read_b128 v[84:87], v9 offset:33792
    s_add_u32 m0, s59, 4096
    s_add_u32 s47, s41, 4096
    buffer_load_dwordx4 v0, s[28:31], s47 offen offset:0 lds
    v_mfma_f32_32x32x16_bf16 v[32:47], a[232:235], v[88:91], v[32:47]
    s_waitcnt lgkmcnt(2)
    v_mfma_f32_32x32x16_bf16 v[16:31], a[124:127], v[76:79], v[16:31]
    ds_read_b128 v[88:91], v9 offset:34816
    buffer_load_dwordx4 v0, s[28:31], s47 offen offset:1024 lds
    v_mfma_f32_32x32x16_bf16 v[32:47], a[236:239], v[92:95], v[32:47]
    s_waitcnt lgkmcnt(2)
    v_mfma_f32_32x32x16_bf16 v[16:31], a[128:131], v[80:83], v[16:31]
    ds_read_b128 v[92:95], v9 offset:35840
    buffer_load_dwordx4 v0, s[28:31], s47 offen offset:2048 lds
    v_mfma_f32_32x32x16_bf16 v[32:47], a[240:243], v[48:51], v[32:47]
    s_waitcnt lgkmcnt(2)
    v_mfma_f32_32x32x16_bf16 v[16:31], a[132:135], v[84:87], v[16:31]
    buffer_load_dwordx4 v0, s[28:31], s47 offen offset:3072 lds
    v_mfma_f32_32x32x16_bf16 v[32:47], a[244:247], v[52:55], v[32:47]
    s_waitcnt lgkmcnt(1)
    v_mfma_f32_32x32x16_bf16 v[16:31], a[136:139], v[88:91], v[16:31]
    s_add_u32 m0, s59, 8192
    s_add_u32 s47, s41, 8192
    buffer_load_dwordx4 v0, s[28:31], s47 offen offset:0 lds
    v_mfma_f32_32x32x16_bf16 v[32:47], a[248:251], v[56:59], v[32:47]
    s_waitcnt lgkmcnt(0)
    v_mfma_f32_32x32x16_bf16 v[16:31], a[140:143], v[92:95], v[16:31]
    s_mul_i32 s48, s36, 786432
    s_mul_i32 s18, s37, 6144
    s_add_u32 s48, s48, s18
    s_add_u32 s48, s48, 16125952
    s_add_u32 m0, s66, 4096
    s_nop 0
    buffer_load_dwordx4 v0, s[28:31], s48 offen lds
    v_mfma_f32_32x32x16_bf16 v[32:47], a[252:255], v[60:63], v[32:47]
    v_mfma_f32_32x32x16_bf16 v[32:47], v[224:227], v[64:67], v[32:47]
    s_add_u32 m0, s66, s67
    s_sub_u32 s48, s48, 4096
    s_add_u32 s48, s48, s67
    buffer_load_dwordx4 v0, s[28:31], s48 offen lds
    v_mfma_f32_32x32x16_bf16 v[32:47], v[228:231], v[68:71], v[32:47]
    v_mul_f32 v180, v117, v148
    v_fma_f32 v16, v16, v116, -v180
    v_mul_f32 v184, v117, v152
    v_fma_f32 v20, v20, v116, -v184
    v_cvt_pk_bf16_f32 v196, v16, v20
    v_mfma_f32_32x32x16_bf16 v[32:47], v[232:235], v[72:75], v[32:47]
    v_mul_f32 v181, v117, v149
    v_fma_f32 v17, v17, v116, -v181
    v_mul_f32 v185, v117, v153
    v_fma_f32 v21, v21, v116, -v185
    v_cvt_pk_bf16_f32 v197, v17, v21
    v_mfma_f32_32x32x16_bf16 v[32:47], v[236:239], v[76:79], v[32:47]
    v_mul_f32 v182, v117, v150
    v_fma_f32 v18, v18, v116, -v182
    v_mul_f32 v186, v117, v154
    v_fma_f32 v22, v22, v116, -v186
    v_cvt_pk_bf16_f32 v198, v18, v22
    v_mfma_f32_32x32x16_bf16 v[32:47], v[240:243], v[80:83], v[32:47]
    v_mul_f32 v183, v117, v151
    v_fma_f32 v19, v19, v116, -v183
    v_mul_f32 v187, v117, v155
    v_fma_f32 v23, v23, v116, -v187
    v_cvt_pk_bf16_f32 v199, v19, v23
    v_mfma_f32_32x32x16_bf16 v[32:47], v[244:247], v[84:87], v[32:47]
    buffer_store_dwordx4 v[196:199], v13, s[8:11], s46 offen offset:0 sc1
    v_mul_f32 v188, v117, v156
    v_fma_f32 v24, v24, v116, -v188
    v_mul_f32 v192, v117, v160
    v_fma_f32 v28, v28, v116, -v192
    v_mfma_f32_32x32x16_bf16 v[32:47], v[248:251], v[88:91], v[32:47]
    v_cvt_pk_bf16_f32 v200, v24, v28
    v_mul_f32 v189, v117, v157
    v_fma_f32 v25, v25, v116, -v189
    v_mul_f32 v193, v117, v161
    v_fma_f32 v29, v29, v116, -v193
    v_mfma_f32_32x32x16_bf16 v[32:47], v[252:255], v[92:95], v[32:47]
    v_cvt_pk_bf16_f32 v201, v25, v29
    v_mul_f32 v190, v117, v158
    v_fma_f32 v26, v26, v116, -v190
    v_mul_f32 v194, v117, v162
    v_fma_f32 v30, v30, v116, -v194
    v_cvt_pk_bf16_f32 v202, v26, v30
    v_mul_f32 v191, v117, v159
    v_fma_f32 v27, v27, v116, -v191
    v_mul_f32 v195, v117, v163
    v_fma_f32 v31, v31, v116, -v195
    v_cvt_pk_bf16_f32 v203, v27, v31
    buffer_store_dwordx4 v[200:203], v13, s[8:11], s46 offen offset:512 sc1
    v_mul_f32 v180, v117, v164
    v_fma_f32 v32, v32, v116, -v180
    v_mul_f32 v184, v117, v168
    v_fma_f32 v36, v36, v116, -v184
    v_cvt_pk_bf16_f32 v196, v32, v36
    v_mul_f32 v181, v117, v165
    v_fma_f32 v33, v33, v116, -v181
    v_mul_f32 v185, v117, v169
    v_fma_f32 v37, v37, v116, -v185
    v_cvt_pk_bf16_f32 v197, v33, v37
    v_mul_f32 v182, v117, v166
    v_fma_f32 v34, v34, v116, -v182
    v_mul_f32 v186, v117, v170
    v_fma_f32 v38, v38, v116, -v186
    v_cvt_pk_bf16_f32 v198, v34, v38
    v_mul_f32 v183, v117, v167
    v_fma_f32 v35, v35, v116, -v183
    v_mul_f32 v187, v117, v171
    v_fma_f32 v39, v39, v116, -v187
    v_cvt_pk_bf16_f32 v199, v35, v39
    buffer_store_dwordx4 v[196:199], v13, s[8:11], s46 offen offset:2048 sc1
    v_mul_f32 v188, v117, v172
    v_fma_f32 v40, v40, v116, -v188
    v_mul_f32 v192, v117, v176
    v_fma_f32 v44, v44, v116, -v192
    v_cvt_pk_bf16_f32 v200, v40, v44
    v_mul_f32 v189, v117, v173
    v_fma_f32 v41, v41, v116, -v189
    v_mul_f32 v193, v117, v177
    v_fma_f32 v45, v45, v116, -v193
    v_cvt_pk_bf16_f32 v201, v41, v45
    v_mul_f32 v190, v117, v174
    v_fma_f32 v42, v42, v116, -v190
    v_mul_f32 v194, v117, v178
    v_fma_f32 v46, v46, v116, -v194
    v_cvt_pk_bf16_f32 v202, v42, v46
    v_mul_f32 v191, v117, v175
    v_fma_f32 v43, v43, v116, -v191
    v_mul_f32 v195, v117, v179
    v_fma_f32 v47, v47, v116, -v195
    v_cvt_pk_bf16_f32 v203, v43, v47
    buffer_store_dwordx4 v[200:203], v13, s[8:11], s46 offen offset:2560 sc1
    s_mul_i32 s43, s57, 22528
    s_add_u32 s43, s43, s49
    s_cmp_lg_u32 s62, 0
    s_cbranch_scc1 LpQ_item
    buffer_load_dword v2, v1, s[8:11], s42 offen sc1
    s_waitcnt vmcnt(0)
    s_cmp_ge_u32 s37, 64
    s_cbranch_scc1 LpQ_fin
    v_cmp_eq_u32 vcc, 0, v2
    s_nop 0
    s_cbranch_vccnz LpQ_pub
    s_add_u32 m0, s59, 0
    s_add_u32 s47, s41, 0
    buffer_load_dwordx4 v0, s[8:11], s47 offen offset:0 lds
    buffer_load_dwordx4 v0, s[8:11], s47 offen offset:1024 lds
    buffer_load_dwordx4 v0, s[8:11], s47 offen offset:2048 lds
    buffer_load_dwordx4 v0, s[8:11], s47 offen offset:3072 lds
    s_add_u32 m0, s59, 4096
    s_add_u32 s47, s41, 4096
    buffer_load_dwordx4 v0, s[8:11], s47 offen offset:0 lds
    buffer_load_dwordx4 v0, s[8:11], s47 offen offset:1024 lds
    buffer_load_dwordx4 v0, s[8:11], s47 offen offset:2048 lds
    buffer_load_dwordx4 v0, s[8:11], s47 offen offset:3072 lds
    s_add_u32 m0, s59, 8192
    s_add_u32 s47, s41, 8192
    buffer_load_dwordx4 v0, s[8:11], s47 offen offset:0 lds
    s_mul_i32 s48, s36, 786432
    s_mul_i32 s18, s37, 6144
    s_add_u32 s48, s48, s18
    s_add_u32 s48, s48, 16125952
    s_add_u32 m0, s66, 4096
    s_nop 0
    buffer_load_dwordx4 v0, s[8:11], s48 offen lds
    s_add_u32 m0, s66, s67
    s_sub_u32 s48, s48, 4096
    s_add_u32 s48, s48, s67
    buffer_load_dwordx4 v0, s[8:11], s48 offen lds
    s_cmp_lg_u32 s43, 0
    s_cselect_b64 exec, 1, 0
    buffer_store_dwordx2 v[212:213], v4, s[8:11], s43 offen sc1
    s_mov_b64 exec, -1
    s_mov_b32 s43, 0
    s_waitcnt vmcnt(1)
    s_branch LpQ_go
LpQ_fin:
    s_cmp_lg_u32 s43, 0
    s_cselect_b64 exec, 1, 0
    buffer_store_dwordx2 v[212:213], v4, s[8:11], s43 offen sc1
    s_mov_b64 exec, -1
    s_mov_b32 s43, 0
    s_branch L_role_p_exit
LpQ_pub:
    s_cmp_lg_u32 s43, 0
    s_cselect_b64 exec, 1, 0
    buffer_store_dwordx2 v[212:213], v4, s[8:11], s43 offen sc1
    s_mov_b64 exec, -1
    s_mov_b32 s43, 0
LpQ_poll:
    s_mov_b32 s16, 0
LpQ_pl:
    buffer_load_dword v2, v1, s[8:11], s42 offen sc1
    s_add_u32 s16, s16, 1
    s_cmp_gt_u32 s16, 100000
    s_cbranch_scc1 L_role_p_abort
    s_waitcnt vmcnt(0)
    v_cmp_eq_u32 vcc, 0, v2
    s_nop 0
    s_cbranch_vccz LpQ_pld
    s_sleep 4
    s_branch LpQ_pl
LpQ_pld:
    s_add_u32 m0, s59, 0
    s_add_u32 s47, s41, 0
    buffer_load_dwordx4 v0, s[8:11], s47 offen offset:0 lds
    buffer_load_dwordx4 v0, s[8:11], s47 offen offset:1024 lds
    buffer_load_dwordx4 v0, s[8:11], s47 offen offset:2048 lds
    buffer_load_dwordx4 v0, s[8:11], s47 offen offset:3072 lds
    s_add_u32 m0, s59, 4096
    s_add_u32 s47, s41, 4096
    buffer_load_dwordx4 v0, s[8:11], s47 offen offset:0 lds
    buffer_load_dwordx4 v0, s[8:11], s47 offen offset:1024 lds
    buffer_load_dwordx4 v0, s[8:11], s47 offen offset:2048 lds
    buffer_load_dwordx4 v0, s[8:11], s47 offen offset:3072 lds
    s_add_u32 m0, s59, 8192
    s_add_u32 s47, s41, 8192
    buffer_load_dwordx4 v0, s[8:11], s47 offen offset:0 lds
    s_mul_i32 s48, s36, 786432
    s_mul_i32 s18, s37, 6144
    s_add_u32 s48, s48, s18
    s_add_u32 s48, s48, 16125952
    s_add_u32 m0, s66, 4096
    s_nop 0
    buffer_load_dwordx4 v0, s[8:11], s48 offen lds
    s_add_u32 m0, s66, s67
    s_sub_u32 s48, s48, 4096
    s_add_u32 s48, s48, s67
    buffer_load_dwordx4 v0, s[8:11], s48 offen lds
    s_waitcnt vmcnt(0)
    s_branch LpQ_go
Lp_v:
    v_mfma_f32_32x32x16_bf16 v[16:31], v[48:51], a[0:3], 0
    v_mfma_f32_32x32x16_bf16 v[16:31], v[48:51], a[4:7], v[16:31]
    v_mfma_f32_32x32x16_bf16 v[16:31], v[48:51], a[8:11], v[16:31]
    v_mfma_f32_32x32x16_bf16 v[16:31], v[48:51], a[12:15], v[16:31]
    v_mfma_f32_32x32x16_bf16 v[16:31], v[48:51], a[16:19], v[16:31]
    v_mfma_f32_32x32x16_bf16 v[16:31], v[48:51], a[20:23], v[16:31]
    v_mfma_f32_32x32x16_bf16 v[16:31], v[48:51], a[24:27], v[16:31]
    v_mfma_f32_32x32x16_bf16 v[16:31], v[48:51], a[28:31], v[16:31]
    v_mfma_f32_32x32x16_bf16 v[16:31], v[48:51], a[32:35], v[16:31]
    v_mfma_f32_32x32x16_bf16 v[16:31], v[48:51], a[36:39], v[16:31]
    v_mfma_f32_32x32x16_bf16 v[16:31], v[48:51], a[40:43], v[16:31]
    v_mfma_f32_32x32x16_bf16 v[16:31], v[48:51], a[44:47], v[16:31]
    v_mfma_f32_32x32x16_bf16 v[16:31], v[48:51], a[48:51], v[16:31]
    v_mfma_f32_32x32x16_bf16 v[16:31], v[48:51], a[52:55], v[16:31]
    v_mfma_f32_32x32x16_bf16 v[16:31], v[48:51], a[56:59], v[16:31]
    v_mfma_f32_32x32x16_bf16 v[16:31], v[48:51], a[60:63], v[16:31]
    v_mfma_f32_32x32x16_bf16 v[16:31], v[48:51], a[64:67], v[16:31]
    v_mfma_f32_32x32x16_bf16 v[16:31], v[48:51], a[68:71], v[16:31]
    v_mfma_f32_32x32x16_bf16 v[16:31], v[48:51], a[72:75], v[16:31]
    v_mfma_f32_32x32x16_bf16 v[16:31], v[48:51], a[76:79], v[16:31]
    v_mfma_f32_32x32x16_bf16 v[16:31], v[48:51], a[80:83], v[16:31]
    v_mfma_f32_32x32x16_bf16 v[16:31], v[48:51], a[84:87], v[16:31]
    v_mfma_f32_32x32x16_bf16 v[16:31], v[48:51], a[88:91], v[16:31]
    v_mfma_f32_32x32x16_bf16 v[16:31], v[48:51], a[92:95], v[16:31]
    v_mfma_f32_32x32x16_bf16 v[16:31], v[48:51], a[96:99], v[16:31]
    v_mfma_f32_32x32x16_bf16 v[16:31], v[48:51], a[100:103], v[16:31]
    v_mfma_f32_32x32x16_bf16 v[16:31], v[48:51], a[104:107], v[16:31]
    v_mfma_f32_32x32x16_bf16 v[16:31], v[48:51], a[108:111], v[16:31]
    v_mfma_f32_32x32x16_bf16 v[16:31], v[48:51], a[112:115], v[16:31]
    v_mfma_f32_32x32x16_bf16 v[16:31], v[48:51], a[116:119], v[16:31]
    v_mfma_f32_32x32x16_bf16 v[16:31], v[48:51], a[120:123], v[16:31]
    v_mfma_f32_32x32x16_bf16 v[16:31], v[48:51], a[124:127], v[16:31]
    v_mfma_f32_32x32x16_bf16 v[16:31], v[48:51], a[128:131], v[16:31]
    v_mfma_f32_32x32x16_bf16 v[16:31], v[48:51], a[132:135], v[16:31]
    v_mfma_f32_32x32x16_bf16 v[16:31], v[48:51], a[136:139], v[16:31]
    v_mfma_f32_32x32x16_bf16 v[16:31], v[48:51], a[140:143], v[16:31]
    v_mfma_f32_32x32x16_bf16 v[32:47], v[48:51], a[144:147], 0
    v_mfma_f32_32x32x16_bf16 v[32:47], v[48:51], a[148:151], v[32:47]
    v_mfma_f32_32x32x16_bf16 v[32:47], v[48:51], a[152:155], v[32:47]
    v_mfma_f32_32x32x16_bf16 v[32:47], v[48:51], a[156:159], v[32:47]
    v_mfma_f32_32x32x16_bf16 v[32:47], v[48:51], a[160:163], v[32:47]
    v_mfma_f32_32x32x16_bf16 v[32:47], v[48:51], a[164:167], v[32:47]
    v_mfma_f32_32x32x16_bf16 v[32:47], v[48:51], a[168:171], v[32:47]
    v_mfma_f32_32x32x16_bf16 v[32:47], v[48:51], a[172:175], v[32:47]
    v_mfma_f32_32x32x16_bf16 v[32:47], v[48:51], a[176:179], v[32:47]
    v_mfma_f32_32x32x16_bf16 v[32:47], v[48:51], a[180:183], v[32:47]
    v_mfma_f32_32x32x16_bf16 v[32:47], v[48:51], a[184:187], v[32:47]
    v_mfma_f32_32x32x16_bf16 v[32:47], v[48:51], a[188:191], v[32:47]
    v_mfma_f32_32x32x16_bf16 v[32:47], v[48:51], a[192:195], v[32:47]
    v_mfma_f32_32x32x16_bf16 v[32:47], v[48:51], a[196:199], v[32:47]
    v_mfma_f32_32x32x16_bf16 v[32:47], v[48:51], a[200:203], v[32:47]
    v_mfma_f32_32x32x16_bf16 v[32:47], v[48:51], a[204:207], v[32:47]
    v_mfma_f32_32x32x16_bf16 v[32:47], v[48:51], a[208:211], v[32:47]
    v_mfma_f32_32x32x16_bf16 v[32:47], v[48:51], a[212:215], v[32:47]
    v_mfma_f32_32x32x16_bf16 v[32:47], v[48:51], a[216:219], v[32:47]
    v_mfma_f32_32x32x16_bf16 v[32:47], v[48:51], a[220:223], v[32:47]
    v_mfma_f32_32x32x16_bf16 v[32:47], v[48:51], a[224:227], v[32:47]
    v_mfma_f32_32x32x16_bf16 v[32:47], v[48:51], a[228:231], v[32:47]
    v_mfma_f32_32x32x16_bf16 v[32:47], v[48:51], a[232:235], v[32:47]
    v_mfma_f32_32x32x16_bf16 v[32:47], v[48:51], a[236:239], v[32:47]
    v_mfma_f32_32x32x16_bf16 v[32:47], v[48:51], a[240:243], v[32:47]
    v_mfma_f32_32x32x16_bf16 v[32:47], v[48:51], a[244:247], v[32:47]
    v_mfma_f32_32x32x16_bf16 v[32:47], v[48:51], a[248:251], v[32:47]
    v_mfma_f32_32x32x16_bf16 v[32:47], v[48:51], a[252:255], v[32:47]
    v_mfma_f32_32x32x16_bf16 v[32:47], v[48:51], v[224:227], v[32:47]
    v_mfma_f32_32x32x16_bf16 v[32:47], v[48:51], v[228:231], v[32:47]
    v_mfma_f32_32x32x16_bf16 v[32:47], v[48:51], v[232:235], v[32:47]
    v_mfma_f32_32x32x16_bf16 v[32:47], v[48:51], v[236:239], v[32:47]
    v_mfma_f32_32x32x16_bf16 v[32:47], v[48:51], v[240:243], v[32:47]
    v_mfma_f32_32x32x16_bf16 v[32:47], v[48:51], v[244:247], v[32:47]
    v_mfma_f32_32x32x16_bf16 v[32:47], v[48:51], v[248:251], v[32:47]
    v_mfma_f32_32x32x16_bf16 v[32:47], v[48:51], v[252:255], v[32:47]
    v_mov_b32 v11, v16
    s_nop 10
    v_mov_b32 v12, v32
    s_mov_b32 s66, 114688
    s_mov_b32 s71, 0x2000
    s_mov_b32 s36, s63
    s_mov_b32 s34, s63
    s_mov_b32 s37, 0
    s_lshl_b32 s56, s63, 6
    s_mul_i32 s58, s14, 9216
    s_mov_b32 s40, 36864
    s_mov_b32 s59, s58
    s_mov_b32 s43, 0
    s_mov_b32 s28, s8
    s_mov_b32 s29, s9
    s_mov_b32 s30, 0
    s_mov_b32 s31, 0x00020000
    s_mul_i32 s41, s63, 4718592
    s_add_u32 s41, s41, s58
    s_add_u32 s41, s41, 8650752
    s_mul_i32 s42, s56, 22528
    s_add_u32 s42, s42, 183808
    s_cmp_lg_u32 s14, 0
    s_cbranch_scc1 LpV_ini_d
    v_mov_b32 v5, 160
    s_mov_b32 s16, 0
LpV_ini:
    global_load_dword v6, v5, s[12:13] sc1
    s_add_u32 s16, s16, 1
    s_cmp_gt_u32 s16, 100000
    s_cbranch_scc1 L_role_p_abort
    s_waitcnt vmcnt(0)
    v_cmp_gt_u32 vcc, 123, v6
    s_nop 0
    s_cbranch_vccz LpV_ini_d
    s_sleep 8
    s_branch LpV_ini
LpV_ini_d:
    s_barrier
    s_branch LpV_poll
LpV_item:
    s_waitcnt vmcnt(4)
LpV_go:
    s_barrier
    s_xor_b32 s40, s40, 36864
    s_xor_b32 s59, s59, 36864
    s_xor_b32 s66, s66, 0x2000
    s_xor_b32 s71, s71, 0x2000
    s_mov_b32 s35, s37
    s_mov_b32 s57, s56
    s_add_u32 s37, s37, 1
    s_add_u32 s56, s56, 1
    s_add_u32 s41, s41, 36864
    s_add_u32 s42, s42, 22528
    s_mov_b32 s62, 0
    v_add_u32 v9, s40, v0
    v_add_u32 v5, s71, v10
    ds_read_b128 v[48:51], v9 offset:0
    ds_read_b128 v[52:55], v9 offset:1024
    ds_read_b128 v[56:59], v9 offset:2048
    s_waitcnt lgkmcnt(2)
    v_mfma_f32_32x32x16_bf16 v[16:31], v[48:51], a[0:3], 0
    ds_read_b128 v[60:63], v9 offset:3072
    ds_read_b128 v[96:99], v5 offset:0
    ds_read_b128 v[100:103], v5 offset:512
    s_waitcnt lgkmcnt(4)
    v_mfma_f32_32x32x16_bf16 v[16:31], v[52:55], a[4:7], v[16:31]
    ds_read_b128 v[64:67], v9 offset:4096
    ds_read_b128 v[104:107], v5 offset:1024
    ds_read_b128 v[108:111], v5 offset:1536
    s_waitcnt lgkmcnt(6)
    v_mfma_f32_32x32x16_bf16 v[16:31], v[56:59], a[8:11], v[16:31]
    ds_read_b128 v[68:71], v9 offset:5120
    ds_read_b128 v[112:115], v5 offset:2048
    s_waitcnt lgkmcnt(7)
    v_mfma_f32_32x32x16_bf16 v[16:31], v[60:63], a[12:15], v[16:31]
    ds_read_b128 v[72:75], v9 offset:6144
    s_waitcnt lgkmcnt(6)
    v_add_f32 v96, v96, v100
    s_waitcnt lgkmcnt(5)
    v_mfma_f32_32x32x16_bf16 v[16:31], v[64:67], a[16:19], v[16:31]
    ds_read_b128 v[76:79], v9 offset:7168
    v_add_f32 v97, v97, v101
    v_add_f32 v98, v98, v102
    s_waitcnt lgkmcnt(3)
    v_mfma_f32_32x32x16_bf16 v[16:31], v[68:71], a[20:23], v[16:31]
    ds_read_b128 v[80:83], v9 offset:8192
    v_add_f32 v99, v99, v103
    v_add_f32 v96, v96, v104
    s_waitcnt lgkmcnt(2)
    v_mfma_f32_32x32x16_bf16 v[16:31], v[72:75], a[24:27], v[16:31]
    ds_read_b128 v[84:87], v9 offset:9216
    v_add_f32 v97, v97, v105
    v_add_f32 v98, v98, v106
    s_waitcnt lgkmcnt(2)
    v_mfma_f32_32x32x16_bf16 v[16:31], v[76:79], a[28:31], v[16:31]
    ds_read_b128 v[88:91], v9 offset:10240
    v_add_f32 v99, v99, v107
    v_add_f32 v96, v96, v108
    s_waitcnt lgkmcnt(2)
    v_mfma_f32_32x32x16_bf16 v[16:31], v[80:83], a[32:35], v[16:31]
    ds_read_b128 v[92:95], v9 offset:11264
    v_add_f32 v97, v97, v109
    v_add_f32 v98, v98, v110
    v_mfma_f32_32x32x16_bf16 v[32:47], v[48:51], a[144:147], 0
    v_add_f32 v99, v99, v111
    v_add_f32 v96, v96, v112
    s_waitcnt lgkmcnt(2)
    v_mfma_f32_32x32x16_bf16 v[16:31], v[84:87], a[36:39], v[16:31]
    ds_read_b128 v[48:51], v9 offset:12288
    v_add_f32 v97, v97, v113
    v_add_f32 v98, v98, v114
    v_mfma_f32_32x32x16_bf16 v[32:47], v[52:55], a[148:151], v[32:47]
    v_add_f32 v99, v99, v115
    v_add_f32 v96, v96, v98
    s_waitcnt lgkmcnt(2)
    v_mfma_f32_32x32x16_bf16 v[16:31], v[88:91], a[40:43], v[16:31]
    ds_read_b128 v[52:55], v9 offset:13312
    v_add_f32 v97, v97, v99
    v_mov_b32 v98, v96
    v_mfma_f32_32x32x16_bf16 v[32:47], v[56:59], a[152:155], v[32:47]
    v_mov_b32 v99, v97
    v_permlane32_swap_b32 v96, v98
    s_waitcnt lgkmcnt(2)
    v_mfma_f32_32x32x16_bf16 v[16:31], v[92:95], a[44:47], v[16:31]
    ds_read_b128 v[56:59], v9 offset:14336
    v_permlane32_swap_b32 v97, v99
    v_add_f32 v96, v96, v98
    v_mfma_f32_32x32x16_bf16 v[32:47], v[60:63], a[156:159], v[32:47]
    v_add_f32 v97, v97, v99
    v_mul_f32 v96, 0x3ae38e39, v96
    s_waitcnt lgkmcnt(2)
    v_mfma_f32_32x32x16_bf16 v[16:31], v[48:51], a[48:51], v[16:31]
    ds_read_b128 v[60:63], v9 offset:15360
    v_mul_f32 v97, 0x3ae38e39, v97
    v_fma_f32 v97, -v96, v96, v97
    v_mfma_f32_32x32x16_bf16 v[32:47], v[64:67], a[160:163], v[32:47]
    v_max_f32 v97, 0, v97
    v_add_f32 v97, 0x3727c5ac, v97
    s_waitcnt lgkmcnt(2)
    v_mfma_f32_32x32x16_bf16 v[16:31], v[52:55], a[52:55], v[16:31]
    ds_read_b128 v[64:67], v9 offset:16384
    v_rsq_f32 v116, v97
    s_nop 0
    v_mul_f32 v117, v96, v116
    v_mfma_f32_32x32x16_bf16 v[32:47], v[68:71], a[164:167], v[32:47]
    ds_write2_b32 v14, v116, v117 offset0:0 offset1:32
    ds_read_b128 v[116:119], v214 offset:0
    s_waitcnt lgkmcnt(4)
    v_mfma_f32_32x32x16_bf16 v[16:31], v[56:59], a[56:59], v[16:31]
    ds_read_b128 v[68:71], v9 offset:17408
    s_waitcnt vmcnt(0)
    buffer_load_dword v2, v1, s[8:11], s42 offen sc1
    s_cmp_lg_u32 s43, 0
    s_cselect_b64 exec, 1, 0
    buffer_store_dwordx2 v[212:213], v4, s[8:11], s43 offen sc1
    s_mov_b64 exec, -1
    s_mov_b32 s43, 0
    v_mfma_f32_32x32x16_bf16 v[32:47], v[72:75], a[168:171], v[32:47]
    ds_read_b128 v[120:123], v214 offset:32
    ds_read_b128 v[124:127], v214 offset:64
    s_waitcnt lgkmcnt(6)
    v_mfma_f32_32x32x16_bf16 v[16:31], v[60:63], a[60:63], v[16:31]
    ds_read_b128 v[72:75], v9 offset:18432
    ds_read_b128 v[128:131], v214 offset:96
    ds_read_b128 v[132:135], v214 offset:128
    v_mfma_f32_32x32x16_bf16 v[32:47], v[76:79], a[172:175], v[32:47]
    ds_read_b128 v[136:139], v214 offset:160
    ds_read_b128 v[140:143], v214 offset:192
    s_waitcnt lgkmcnt(10)
    v_mfma_f32_32x32x16_bf16 v[16:31], v[64:67], a[64:67], v[16:31]
    ds_read_b128 v[76:79], v9 offset:19456
    ds_read_b128 v[144:147], v214 offset:224
    s_mul_i32 s46, s34, 50331648
    v_mfma_f32_32x32x16_bf16 v[32:47], v[80:83], a[176:179], v[32:47]
    s_lshl_b32 s19, s35, 18
    s_add_u32 s46, s46, s19
    s_waitcnt lgkmcnt(9)
    v_mfma_f32_32x32x16_bf16 v[16:31], v[68:71], a[68:71], v[16:31]
    ds_read_b128 v[80:83], v9 offset:20480
    s_add_u32 s46, s46, s52
    v_mfma_f32_32x32x16_bf16 v[32:47], v[84:87], a[180:183], v[32:47]
    s_waitcnt lgkmcnt(7)
    v_mfma_f32_32x32x16_bf16 v[16:31], v[72:75], a[72:75], v[16:31]
    ds_read_b128 v[84:87], v9 offset:21504
    v_mfma_f32_32x32x16_bf16 v[32:47], v[88:91], a[184:187], v[32:47]
    s_waitcnt lgkmcnt(3)
    v_mfma_f32_32x32x16_bf16 v[16:31], v[76:79], a[76:79], v[16:31]
    ds_read_b128 v[88:91], v9 offset:22528
    v_mfma_f32_32x32x16_bf16 v[32:47], v[92:95], a[188:191], v[32:47]
    s_waitcnt lgkmcnt(2)
    v_mfma_f32_32x32x16_bf16 v[16:31], v[80:83], a[80:83], v[16:31]
    ds_read_b128 v[92:95], v9 offset:23552
    v_mfma_f32_32x32x16_bf16 v[32:47], v[48:51], a[192:195], v[32:47]
    s_waitcnt lgkmcnt(2)
    v_mfma_f32_32x32x16_bf16 v[16:31], v[84:87], a[84:87], v[16:31]
    ds_read_b128 v[48:51], v9 offset:24576
    v_mfma_f32_32x32x16_bf16 v[32:47], v[52:55], a[196:199], v[32:47]
    s_waitcnt lgkmcnt(2)
    v_mfma_f32_32x32x16_bf16 v[16:31], v[88:91], a[88:91], v[16:31]
    ds_read_b128 v[52:55], v9 offset:25600
    v_mfma_f32_32x32x16_bf16 v[32:47], v[56:59], a[200:203], v[32:47]
    s_waitcnt lgkmcnt(2)
    v_mfma_f32_32x32x16_bf16 v[16:31], v[92:95], a[92:95], v[16:31]
    ds_read_b128 v[56:59], v9 offset:26624
    v_mfma_f32_32x32x16_bf16 v[32:47], v[60:63], a[204:207], v[32:47]
    s_waitcnt lgkmcnt(2)
    v_mfma_f32_32x32x16_bf16 v[16:31], v[48:51], a[96:99], v[16:31]
    ds_read_b128 v[60:63], v9 offset:27648
    v_mfma_f32_32x32x16_bf16 v[32:47], v[64:67], a[208:211], v[32:47]
    s_waitcnt lgkmcnt(2)
    v_mfma_f32_32x32x16_bf16 v[16:31], v[52:55], a[100:103], v[16:31]
    ds_read_b128 v[64:67], v9 offset:28672
    s_waitcnt vmcnt(1)
    v_cmp_eq_u32 vcc, 0, v2
    s_nop 0
    s_cmp_eq_u64 vcc, 0
    s_cselect_b32 s62, 1, 0
    s_cmp_lt_u32 s37, 64
    s_cselect_b32 s62, s62, 0
    s_cmp_lg_u32 s62, 0
    s_cselect_b32 s30, 268435456, 0
    v_mfma_f32_32x32x16_bf16 v[32:47], v[68:71], a[212:215], v[32:47]
    s_waitcnt lgkmcnt(2)
    v_mfma_f32_32x32x16_bf16 v[16:31], v[56:59], a[104:107], v[16:31]
    ds_read_b128 v[68:71], v9 offset:29696
    s_add_u32 m0, s59, 0
    s_add_u32 s47, s41, 0
    buffer_load_dwordx4 v0, s[28:31], s47 offen offset:0 lds
    v_mfma_f32_32x32x16_bf16 v[32:47], v[72:75], a[216:219], v[32:47]
    s_waitcnt lgkmcnt(2)
    v_mfma_f32_32x32x16_bf16 v[16:31], v[60:63], a[108:111], v[16:31]
    ds_read_b128 v[72:75], v9 offset:30720
    buffer_load_dwordx4 v0, s[28:31], s47 offen offset:1024 lds
    v_mfma_f32_32x32x16_bf16 v[32:47], v[76:79], a[220:223], v[32:47]
    s_waitcnt lgkmcnt(2)
    v_mfma_f32_32x32x16_bf16 v[16:31], v[64:67], a[112:115], v[16:31]
    ds_read_b128 v[76:79], v9 offset:31744
    buffer_load_dwordx4 v0, s[28:31], s47 offen offset:2048 lds
    v_mfma_f32_32x32x16_bf16 v[32:47], v[80:83], a[224:227], v[32:47]
    s_waitcnt lgkmcnt(2)
    v_mfma_f32_32x32x16_bf16 v[16:31], v[68:71], a[116:119], v[16:31]
    ds_read_b128 v[80:83], v9 offset:32768
    buffer_load_dwordx4 v0, s[28:31], s47 offen offset:3072 lds
    v_mfma_f32_32x32x16_bf16 v[32:47], v[84:87], a[228:231], v[32:47]
    s_waitcnt lgkmcnt(2)
    v_mfma_f32_32x32x16_bf16 v[16:31], v[72:75], a[120:123], v[16:31]
    ds_read_b128 v[84:87], v9 offset:33792
    s_add_u32 m0, s59, 4096
    s_add_u32 s47, s41, 4096
    buffer_load_dwordx4 v0, s[28:31], s47 offen offset:0 lds
    v_mfma_f32_32x32x16_bf16 v[32:47], v[88:91], a[232:235], v[32:47]
    s_waitcnt lgkmcnt(2)
    v_mfma_f32_32x32x16_bf16 v[16:31], v[76:79], a[124:127], v[16:31]
    ds_read_b128 v[88:91], v9 offset:34816
    buffer_load_dwordx4 v0, s[28:31], s47 offen offset:1024 lds
    v_mfma_f32_32x32x16_bf16 v[32:47], v[92:95], a[236:239], v[32:47]
    s_waitcnt lgkmcnt(2)
    v_mfma_f32_32x32x16_bf16 v[16:31], v[80:83], a[128:131], v[16:31]
    ds_read_b128 v[92:95], v9 offset:35840
    buffer_load_dwordx4 v0, s[28:31], s47 offen offset:2048 lds
    v_mfma_f32_32x32x16_bf16 v[32:47], v[48:51], a[240:243], v[32:47]
    s_waitcnt lgkmcnt(2)
    v_mfma_f32_32x32x16_bf16 v[16:31], v[84:87], a[132:135], v[16:31]
    buffer_load_dwordx4 v0, s[28:31], s47 offen offset:3072 lds
    v_mfma_f32_32x32x16_bf16 v[32:47], v[52:55], a[244:247], v[32:47]
    s_waitcnt lgkmcnt(1)
    v_mfma_f32_32x32x16_bf16 v[16:31], v[88:91], a[136:139], v[16:31]
    s_add_u32 m0, s59, 8192
    s_add_u32 s47, s41, 8192
    buffer_load_dwordx4 v0, s[28:31], s47 offen offset:0 lds
    v_mfma_f32_32x32x16_bf16 v[32:47], v[56:59], a[248:251], v[32:47]
    s_waitcnt lgkmcnt(0)
    v_mfma_f32_32x32x16_bf16 v[16:31], v[92:95], a[140:143], v[16:31]
    s_mul_i32 s48, s36, 786432
    s_mul_i32 s18, s37, 6144
    s_add_u32 s48, s48, s18
    s_add_u32 s48, s48, 16125952
    s_add_u32 m0, s66, 4096
    s_nop 0
    buffer_load_dwordx4 v0, s[28:31], s48 offen lds
    v_mfma_f32_32x32x16_bf16 v[32:47], v[60:63], a[252:255], v[32:47]
    v_mfma_f32_32x32x16_bf16 v[32:47], v[64:67], v[224:227], v[32:47]
    s_add_u32 m0, s66, s67
    s_sub_u32 s48, s48, 4096
    s_add_u32 s48, s48, s67
    buffer_load_dwordx4 v0, s[28:31], s48 offen lds
    v_mfma_f32_32x32x16_bf16 v[32:47], v[68:71], v[228:231], v[32:47]
    v_mul_f32 v180, v11, v132
    v_fma_f32 v16, v16, v116, -v180
    v_mul_f32 v181, v11, v133
    v_fma_f32 v17, v17, v117, -v181
    v_cvt_pk_bf16_f32 v196, v16, v17
    v_mfma_f32_32x32x16_bf16 v[32:47], v[72:75], v[232:235], v[32:47]
    v_mul_f32 v182, v11, v134
    v_fma_f32 v18, v18, v118, -v182
    v_mul_f32 v183, v11, v135
    v_fma_f32 v19, v19, v119, -v183
    v_cvt_pk_bf16_f32 v197, v18, v19
    v_mfma_f32_32x32x16_bf16 v[32:47], v[76:79], v[236:239], v[32:47]
    v_mul_f32 v188, v11, v140
    v_fma_f32 v24, v24, v124, -v188
    v_mul_f32 v189, v11, v141
    v_fma_f32 v25, v25, v125, -v189
    v_cvt_pk_bf16_f32 v198, v24, v25
    v_mfma_f32_32x32x16_bf16 v[32:47], v[80:83], v[240:243], v[32:47]
    v_mul_f32 v190, v11, v142
    v_fma_f32 v26, v26, v126, -v190
    v_mul_f32 v191, v11, v143
    v_fma_f32 v27, v27, v127, -v191
    v_cvt_pk_bf16_f32 v199, v26, v27
    v_mfma_f32_32x32x16_bf16 v[32:47], v[84:87], v[244:247], v[32:47]
    buffer_store_dwordx4 v[196:199], v13, s[8:11], s46 offen offset:0 sc1
    v_mul_f32 v184, v11, v136
    v_fma_f32 v20, v20, v120, -v184
    v_mul_f32 v185, v11, v137
    v_fma_f32 v21, v21, v121, -v185
    v_mfma_f32_32x32x16_bf16 v[32:47], v[88:91], v[248:251], v[32:47]
    v_cvt_pk_bf16_f32 v200, v20, v21
    v_mul_f32 v186, v11, v138
    v_fma_f32 v22, v22, v122, -v186
    v_mul_f32 v187, v11, v139
    v_fma_f32 v23, v23, v123, -v187
    v_mfma_f32_32x32x16_bf16 v[32:47], v[92:95], v[252:255], v[32:47]
    v_cvt_pk_bf16_f32 v201, v22, v23
    v_mul_f32 v192, v11, v144
    v_fma_f32 v28, v28, v128, -v192
    v_mul_f32 v193, v11, v145
    v_fma_f32 v29, v29, v129, -v193
    v_cvt_pk_bf16_f32 v202, v28, v29
    v_mul_f32 v194, v11, v146
    v_fma_f32 v30, v30, v130, -v194
    v_mul_f32 v195, v11, v147
    v_fma_f32 v31, v31, v131, -v195
    v_cvt_pk_bf16_f32 v203, v30, v31
    buffer_store_dwordx4 v[200:203], v13, s[8:11], s46 offen offset:512 sc1
    v_mul_f32 v180, v12, v132
    v_fma_f32 v32, v32, v116, -v180
    v_mul_f32 v181, v12, v133
    v_fma_f32 v33, v33, v117, -v181
    v_cvt_pk_bf16_f32 v196, v32, v33
    v_mul_f32 v182, v12, v134
    v_fma_f32 v34, v34, v118, -v182
    v_mul_f32 v183, v12, v135
    v_fma_f32 v35, v35, v119, -v183
    v_cvt_pk_bf16_f32 v197, v34, v35
    v_mul_f32 v188, v12, v140
    v_fma_f32 v40, v40, v124, -v188
    v_mul_f32 v189, v12, v141
    v_fma_f32 v41, v41, v125, -v189
    v_cvt_pk_bf16_f32 v198, v40, v41
    v_mul_f32 v190, v12, v142
    v_fma_f32 v42, v42, v126, -v190
    v_mul_f32 v191, v12, v143
    v_fma_f32 v43, v43, v127, -v191
    v_cvt_pk_bf16_f32 v199, v42, v43
    buffer_store_dwordx4 v[196:199], v13, s[8:11], s46 offen offset:2048 sc1
    v_mul_f32 v184, v12, v136
    v_fma_f32 v36, v36, v120, -v184
    v_mul_f32 v185, v12, v137
    v_fma_f32 v37, v37, v121, -v185
    v_cvt_pk_bf16_f32 v200, v36, v37
    v_mul_f32 v186, v12, v138
    v_fma_f32 v38, v38, v122, -v186
    v_mul_f32 v187, v12, v139
    v_fma_f32 v39, v39, v123, -v187
    v_cvt_pk_bf16_f32 v201, v38, v39
    v_mul_f32 v192, v12, v144
    v_fma_f32 v44, v44, v128, -v192
    v_mul_f32 v193, v12, v145
    v_fma_f32 v45, v45, v129, -v193
    v_cvt_pk_bf16_f32 v202, v44, v45
    v_mul_f32 v194, v12, v146
    v_fma_f32 v46, v46, v130, -v194
    v_mul_f32 v195, v12, v147
    v_fma_f32 v47, v47, v131, -v195
    v_cvt_pk_bf16_f32 v203, v46, v47
    buffer_store_dwordx4 v[200:203], v13, s[8:11], s46 offen offset:2560 sc1
    s_mul_i32 s43, s57, 22528
    s_add_u32 s43, s43, s49
    s_cmp_lg_u32 s62, 0
    s_cbranch_scc1 LpV_item
    buffer_load_dword v2, v1, s[8:11], s42 offen sc1
    s_waitcnt vmcnt(0)
    s_cmp_ge_u32 s37, 64
    s_cbranch_scc1 LpV_fin
    v_cmp_eq_u32 vcc, 0, v2
    s_nop 0
    s_cbranch_vccnz LpV_pub
    s_add_u32 m0, s59, 0
    s_add_u32 s47, s41, 0
    buffer_load_dwordx4 v0, s[8:11], s47 offen offset:0 lds
    buffer_load_dwordx4 v0, s[8:11], s47 offen offset:1024 lds
    buffer_load_dwordx4 v0, s[8:11], s47 offen offset:2048 lds
    buffer_load_dwordx4 v0, s[8:11], s47 offen offset:3072 lds
    s_add_u32 m0, s59, 4096
    s_add_u32 s47, s41, 4096
    buffer_load_dwordx4 v0, s[8:11], s47 offen offset:0 lds
    buffer_load_dwordx4 v0, s[8:11], s47 offen offset:1024 lds
    buffer_load_dwordx4 v0, s[8:11], s47 offen offset:2048 lds
    buffer_load_dwordx4 v0, s[8:11], s47 offen offset:3072 lds
    s_add_u32 m0, s59, 8192
    s_add_u32 s47, s41, 8192
    buffer_load_dwordx4 v0, s[8:11], s47 offen offset:0 lds
    s_mul_i32 s48, s36, 786432
    s_mul_i32 s18, s37, 6144
    s_add_u32 s48, s48, s18
    s_add_u32 s48, s48, 16125952
    s_add_u32 m0, s66, 4096
    s_nop 0
    buffer_load_dwordx4 v0, s[8:11], s48 offen lds
    s_add_u32 m0, s66, s67
    s_sub_u32 s48, s48, 4096
    s_add_u32 s48, s48, s67
    buffer_load_dwordx4 v0, s[8:11], s48 offen lds
    s_cmp_lg_u32 s43, 0
    s_cselect_b64 exec, 1, 0
    buffer_store_dwordx2 v[212:213], v4, s[8:11], s43 offen sc1
    s_mov_b64 exec, -1
    s_mov_b32 s43, 0
    s_waitcnt vmcnt(1)
    s_branch LpV_go
LpV_fin:
    s_cmp_lg_u32 s43, 0
    s_cselect_b64 exec, 1, 0
    buffer_store_dwordx2 v[212:213], v4, s[8:11], s43 offen sc1
    s_mov_b64 exec, -1
    s_mov_b32 s43, 0
    s_branch L_role_p_exit
LpV_pub:
    s_cmp_lg_u32 s43, 0
    s_cselect_b64 exec, 1, 0
    buffer_store_dwordx2 v[212:213], v4, s[8:11], s43 offen sc1
    s_mov_b64 exec, -1
    s_mov_b32 s43, 0
LpV_poll:
    s_mov_b32 s16, 0
LpV_pl:
    buffer_load_dword v2, v1, s[8:11], s42 offen sc1
    s_add_u32 s16, s16, 1
    s_cmp_gt_u32 s16, 100000
    s_cbranch_scc1 L_role_p_abort
    s_waitcnt vmcnt(0)
    v_cmp_eq_u32 vcc, 0, v2
    s_nop 0
    s_cbranch_vccz LpV_pld
    s_sleep 4
    s_branch LpV_pl
LpV_pld:
    s_add_u32 m0, s59, 0
    s_add_u32 s47, s41, 0
    buffer_load_dwordx4 v0, s[8:11], s47 offen offset:0 lds
    buffer_load_dwordx4 v0, s[8:11], s47 offen offset:1024 lds
    buffer_load_dwordx4 v0, s[8:11], s47 offen offset:2048 lds
    buffer_load_dwordx4 v0, s[8:11], s47 offen offset:3072 lds
    s_add_u32 m0, s59, 4096
    s_add_u32 s47, s41, 4096
    buffer_load_dwordx4 v0, s[8:11], s47 offen offset:0 lds
    buffer_load_dwordx4 v0, s[8:11], s47 offen offset:1024 lds
    buffer_load_dwordx4 v0, s[8:11], s47 offen offset:2048 lds
    buffer_load_dwordx4 v0, s[8:11], s47 offen offset:3072 lds
    s_add_u32 m0, s59, 8192
    s_add_u32 s47, s41, 8192
    buffer_load_dwordx4 v0, s[8:11], s47 offen offset:0 lds
    s_mul_i32 s48, s36, 786432
    s_mul_i32 s18, s37, 6144
    s_add_u32 s48, s48, s18
    s_add_u32 s48, s48, 16125952
    s_add_u32 m0, s66, 4096
    s_nop 0
    buffer_load_dwordx4 v0, s[8:11], s48 offen lds
    s_add_u32 m0, s66, s67
    s_sub_u32 s48, s48, 4096
    s_add_u32 s48, s48, s67
    buffer_load_dwordx4 v0, s[8:11], s48 offen lds
    s_waitcnt vmcnt(0)
    s_branch LpV_go
L_role_p_abort:
    s_waitcnt lgkmcnt(0)
    s_mov_b64 exec, -1
    v_mov_b32 v0, 60
    s_lshl_b32 s5, s3, 8
    s_or_b32 s5, s5, s4
    s_or_b32 s5, s5, 0x10000
    v_mov_b32 v1, s5
    global_store_dword v0, v1, s[12:13]
    s_endpgm
L_role_p_exit:
    s_cmp_lg_u32 s63, 0
    s_cbranch_scc1 L_p_end
    s_cmp_ge_u32 s15, 24
    s_cbranch_scc1 L_p_end
    s_add_u32 s15, s15, 36
    v_lshrrev_b32 v0, 4, v0
    s_waitcnt vmcnt(0) lgkmcnt(0)
    s_barrier
    s_branch L_role_tw
L_p_end:
    s_endpgm
.p2align 6
L_role_tw:
    v_and_b32 v5, 63, v0
    v_lshlrev_b32 v0, 4, v5
    v_and_b32 v7, 15, v5
    v_lshrrev_b32 v8, 4, v5
    v_min_u32 v1, 31, v5
    v_lshrrev_b32 v6, 2, v1
    v_and_b32 v1, 3, v1
    v_lshlrev_b32 v1, 2, v1
    v_lshl_add_u32 v1, v6, 7, v1
    v_mov_b32 v3, 1
    v_mov_b32 v4, 0
    s_mov_b32 s44, 0x05040100
    s_mov_b32 s45, 0x07060302
    s_cmp_lt_u32 s15, 24
    s_cbranch_scc1 Ltw_noord
    s_cmp_lg_u32 s14, 0
    s_cbranch_scc1 Ltw_ord_d
    v_mov_b32 v5, 48
    s_mov_b32 s16, 0
Ltw_ord:
    global_load_dword v6, v5, s[12:13] sc1
    s_add_u32 s16, s16, 1
    s_cmp_gt_u32 s16, 100000
    s_cbranch_scc1 L_role_tw_abort
    s_waitcnt vmcnt(0)
    v_cmp_gt_u32 vcc, 1, v6
    s_nop 0
    s_cbranch_vccz Ltw_ord_d
    s_sleep 64
    s_branch Ltw_ord
Ltw_ord_d:
    s_barrier
Ltw_noord:
    s_load_dwordx2 s[20:21], s[0:1], 64
    s_mov_b32 s22, 4718592
    s_mov_b32 s23, 0x00020000
    s_waitcnt lgkmcnt(0)
    s_and_b32 s21, s21, 0xffff
    s_load_dwordx2 s[24:25], s[0:1], 80
    s_mov_b32 s26, 2359296
    s_mov_b32 s27, 0x00020000
    s_waitcnt lgkmcnt(0)
    s_and_b32 s25, s25, 0xffff
    s_mul_i32 s17, s15, 43
    s_lshr_b32 s32, s17, 9
    s_mul_i32 s17, s32, 12
    s_sub_u32 s50, s15, s17
    s_add_u32 s33, s32, 31
    s_cmp_eq_u32 s32, 2
    s_cselect_b32 s33, 0, s33
    s_cmp_lt_u32 s32, 2
    s_cselect_b32 s33, 64, s33
    s_cselect_b32 s32, s32, 64
    s_mul_i32 s49, s50, 96
    s_mul_i32 s17, s14, 1179648
    s_add_u32 s49, s49, s17
    v_mul_u32_u24 v5, 4608, v8
    v_lshl_add_u32 v9, v7, 2, v5
    v_add_u32 v10, 18432, v9
    v_and_b32 v6, 14, v7
    v_lshl_add_u32 v12, v6, 1, v5
    v_add_u32 v12, 64, v12
    v_add_u32 v13, 18432, v12
    v_and_b32 v5, 1, v7
    v_mov_b32 v11, s44
    v_mov_b32 v6, s45
    v_cmp_eq_u32 vcc, 1, v5
    s_nop 1
    v_cndmask_b32 v11, v11, v6, vcc
    s_add_u32 s17, s49, 0
    buffer_load_dword v16, v9, s[20:23], s17 offen
    buffer_load_dword v17, v10, s[20:23], s17 offen
    buffer_load_dword v18, v12, s[20:23], s17 offen
    buffer_load_dword v19, v13, s[20:23], s17 offen
    s_add_u32 s17, s49, 1152
    buffer_load_dword v20, v9, s[20:23], s17 offen
    buffer_load_dword v21, v10, s[20:23], s17 offen
    buffer_load_dword v22, v12, s[20:23], s17 offen
    buffer_load_dword v23, v13, s[20:23], s17 offen
    s_add_u32 s17, s49, 2304
    buffer_load_dword v24, v9, s[20:23], s17 offen
    buffer_load_dword v25, v10, s[20:23], s17 offen
    buffer_load_dword v26, v12, s[20:23], s17 offen
    buffer_load_dword v27, v13, s[20:23], s17 offen
    s_add_u32 s17, s49, 3456
    buffer_load_dword v28, v9, s[20:23], s17 offen
    buffer_load_dword v29, v10, s[20:23], s17 offen
    buffer_load_dword v30, v12, s[20:23], s17 offen
    buffer_load_dword v31, v13, s[20:23], s17 offen
    s_add_u32 s17, s49, 36864
    buffer_load_dword v32, v9, s[20:23], s17 offen
    buffer_load_dword v33, v10, s[20:23], s17 offen
    buffer_load_dword v34, v12, s[20:23], s17 offen
    buffer_load_dword v35, v13, s[20:23], s17 offen
    s_add_u32 s17, s49, 38016
    buffer_load_dword v36, v9, s[20:23], s17 offen
    buffer_load_dword v37, v10, s[20:23], s17 offen
    buffer_load_dword v38, v12, s[20:23], s17 offen
    buffer_load_dword v39, v13, s[20:23], s17 offen
    s_add_u32 s17, s49, 39168
    buffer_load_dword v40, v9, s[20:23], s17 offen
    buffer_load_dword v41, v10, s[20:23], s17 offen
    buffer_load_dword v42, v12, s[20:23], s17 offen
    buffer_load_dword v43, v13, s[20:23], s17 offen
    s_add_u32 s17, s49, 40320
    buffer_load_dword v44, v9, s[20:23], s17 offen
    buffer_load_dword v45, v10, s[20:23], s17 offen
    buffer_load_dword v46, v12, s[20:23], s17 offen
    buffer_load_dword v47, v13, s[20:23], s17 offen
    s_add_u32 s17, s49, 73728
    buffer_load_dword v48, v9, s[20:23], s17 offen
    buffer_load_dword v49, v10, s[20:23], s17 offen
    buffer_load_dword v50, v12, s[20:23], s17 offen
    buffer_load_dword v51, v13, s[20:23], s17 offen
    s_add_u32 s17, s49, 74880
    buffer_load_dword v52, v9, s[20:23], s17 offen
    buffer_load_dword v53, v10, s[20:23], s17 offen
    buffer_load_dword v54, v12, s[20:23], s17 offen
    buffer_load_dword v55, v13, s[20:23], s17 offen
    s_add_u32 s17, s49, 76032
    buffer_load_dword v56, v9, s[20:23], s17 offen
    buffer_load_dword v57, v10, s[20:23], s17 offen
    buffer_load_dword v58, v12, s[20:23], s17 offen
    buffer_load_dword v59, v13, s[20:23], s17 offen
    s_add_u32 s17, s49, 77184
    buffer_load_dword v60, v9, s[20:23], s17 offen
    buffer_load_dword v61, v10, s[20:23], s17 offen
    buffer_load_dword v62, v12, s[20:23], s17 offen
    buffer_load_dword v63, v13, s[20:23], s17 offen
    s_add_u32 s17, s49, 110592
    buffer_load_dword v64, v9, s[20:23], s17 offen
    buffer_load_dword v65, v10, s[20:23], s17 offen
    buffer_load_dword v66, v12, s[20:23], s17 offen
    buffer_load_dword v67, v13, s[20:23], s17 offen
    s_add_u32 s17, s49, 111744
    buffer_load_dword v68, v9, s[20:23], s17 offen
    buffer_load_dword v69, v10, s[20:23], s17 offen
    buffer_load_dword v70, v12, s[20:23], s17 offen
    buffer_load_dword v71, v13, s[20:23], s17 offen
    s_add_u32 s17, s49, 112896
    buffer_load_dword v72, v9, s[20:23], s17 offen
    buffer_load_dword v73, v10, s[20:23], s17 offen
    buffer_load_dword v74, v12, s[20:23], s17 offen
    buffer_load_dword v75, v13, s[20:23], s17 offen
    s_waitcnt vmcnt(58)
    v_perm_b32 v5, v17, v16, s44
    v_perm_b32 v6, v17, v16, s45
    s_waitcnt vmcnt(56)
    v_perm_b32 v128, v19, v18, v11
    v_accvgpr_write_b32 a0, v5
    v_accvgpr_write_b32 a4, v6
    s_add_u32 s17, s49, 114048
    buffer_load_dword v76, v9, s[20:23], s17 offen
    buffer_load_dword v77, v10, s[20:23], s17 offen
    buffer_load_dword v78, v12, s[20:23], s17 offen
    buffer_load_dword v79, v13, s[20:23], s17 offen
    s_waitcnt vmcnt(58)
    v_perm_b32 v5, v21, v20, s44
    v_perm_b32 v6, v21, v20, s45
    s_waitcnt vmcnt(56)
    v_perm_b32 v129, v23, v22, v11
    v_accvgpr_write_b32 a1, v5
    v_accvgpr_write_b32 a5, v6
    s_add_u32 s17, s49, 147456
    buffer_load_dword v80, v9, s[20:23], s17 offen
    buffer_load_dword v81, v10, s[20:23], s17 offen
    buffer_load_dword v82, v12, s[20:23], s17 offen
    buffer_load_dword v83, v13, s[20:23], s17 offen
    s_waitcnt vmcnt(58)
    v_perm_b32 v5, v25, v24, s44
    v_perm_b32 v6, v25, v24, s45
    s_waitcnt vmcnt(56)
    v_perm_b32 v130, v27, v26, v11
    v_accvgpr_write_b32 a2, v5
    v_accvgpr_write_b32 a6, v6
    s_add_u32 s17, s49, 148608
    buffer_load_dword v84, v9, s[20:23], s17 offen
    buffer_load_dword v85, v10, s[20:23], s17 offen
    buffer_load_dword v86, v12, s[20:23], s17 offen
    buffer_load_dword v87, v13, s[20:23], s17 offen
    s_waitcnt vmcnt(58)
    v_perm_b32 v5, v29, v28, s44
    v_perm_b32 v6, v29, v28, s45
    s_waitcnt vmcnt(56)
    v_perm_b32 v131, v31, v30, v11
    v_accvgpr_write_b32 a3, v5
    v_accvgpr_write_b32 a7, v6
    s_add_u32 s17, s49, 149760
    buffer_load_dword v88, v9, s[20:23], s17 offen
    buffer_load_dword v89, v10, s[20:23], s17 offen
    buffer_load_dword v90, v12, s[20:23], s17 offen
    buffer_load_dword v91, v13, s[20:23], s17 offen
    s_waitcnt vmcnt(58)
    v_perm_b32 v5, v33, v32, s44
    v_perm_b32 v6, v33, v32, s45
    s_waitcnt vmcnt(56)
    v_perm_b32 v132, v35, v34, v11
    v_accvgpr_write_b32 a8, v5
    v_accvgpr_write_b32 a12, v6
    s_add_u32 s17, s49, 150912
    buffer_load_dword v92, v9, s[20:23], s17 offen
    buffer_load_dword v93, v10, s[20:23], s17 offen
    buffer_load_dword v94, v12, s[20:23], s17 offen
    buffer_load_dword v95, v13, s[20:23], s17 offen
    s_waitcnt vmcnt(58)
    v_perm_b32 v5, v37, v36, s44
    v_perm_b32 v6, v37, v36, s45
    s_waitcnt vmcnt(56)
    v_perm_b32 v133, v39, v38, v11
    v_accvgpr_write_b32 a9, v5
    v_accvgpr_write_b32 a13, v6
    s_add_u32 s17, s49, 184320
    buffer_load_dword v96, v9, s[20:23], s17 offen
    buffer_load_dword v97, v10, s[20:23], s17 offen
    buffer_load_dword v98, v12, s[20:23], s17 offen
    buffer_load_dword v99, v13, s[20:23], s17 offen
    s_waitcnt vmcnt(58)
    v_perm_b32 v5, v41, v40, s44
    v_perm_b32 v6, v41, v40, s45
    s_waitcnt vmcnt(56)
    v_perm_b32 v134, v43, v42, v11
    v_accvgpr_write_b32 a10, v5
    v_accvgpr_write_b32 a14, v6
    s_add_u32 s17, s49, 185472
    buffer_load_dword v100, v9, s[20:23], s17 offen
    buffer_load_dword v101, v10, s[20:23], s17 offen
    buffer_load_dword v102, v12, s[20:23], s17 offen
    buffer_load_dword v103, v13, s[20:23], s17 offen
    s_waitcnt vmcnt(58)
    v_perm_b32 v5, v45, v44, s44
    v_perm_b32 v6, v45, v44, s45
    s_waitcnt vmcnt(56)
    v_perm_b32 v135, v47, v46, v11
    v_accvgpr_write_b32 a11, v5
    v_accvgpr_write_b32 a15, v6
    s_add_u32 s17, s49, 186624
    buffer_load_dword v104, v9, s[20:23], s17 offen
    buffer_load_dword v105, v10, s[20:23], s17 offen
    buffer_load_dword v106, v12, s[20:23], s17 offen
    buffer_load_dword v107, v13, s[20:23], s17 offen
    s_waitcnt vmcnt(58)
    v_perm_b32 v5, v49, v48, s44
    v_perm_b32 v6, v49, v48, s45
    s_waitcnt vmcnt(56)
    v_perm_b32 v136, v51, v50, v11
    v_accvgpr_write_b32 a16, v5
    v_accvgpr_write_b32 a20, v6
    s_add_u32 s17, s49, 187776
    buffer_load_dword v108, v9, s[20:23], s17 offen
    buffer_load_dword v109, v10, s[20:23], s17 offen
    buffer_load_dword v110, v12, s[20:23], s17 offen
    buffer_load_dword v111, v13, s[20:23], s17 offen
    s_waitcnt vmcnt(58)
    v_perm_b32 v5, v53, v52, s44
    v_perm_b32 v6, v53, v52, s45
    s_waitcnt vmcnt(56)
    v_perm_b32 v137, v55, v54, v11
    v_accvgpr_write_b32 a17, v5
    v_accvgpr_write_b32 a21, v6
    s_add_u32 s17, s49, 221184
    buffer_load_dword v112, v9, s[20:23], s17 offen
    buffer_load_dword v113, v10, s[20:23], s17 offen
    buffer_load_dword v114, v12, s[20:23], s17 offen
    buffer_load_dword v115, v13, s[20:23], s17 offen
    s_waitcnt vmcnt(58)
    v_perm_b32 v5, v57, v56, s44
    v_perm_b32 v6, v57, v56, s45
    s_waitcnt vmcnt(56)
    v_perm_b32 v138, v59, v58, v11
    v_accvgpr_write_b32 a18, v5
    v_accvgpr_write_b32 a22, v6
    s_add_u32 s17, s49, 222336
    buffer_load_dword v116, v9, s[20:23], s17 offen
    buffer_load_dword v117, v10, s[20:23], s17 offen
    buffer_load_dword v118, v12, s[20:23], s17 offen
    buffer_load_dword v119, v13, s[20:23], s17 offen
    s_waitcnt vmcnt(58)
    v_perm_b32 v5, v61, v60, s44
    v_perm_b32 v6, v61, v60, s45
    s_waitcnt vmcnt(56)
    v_perm_b32 v139, v63, v62, v11
    v_accvgpr_write_b32 a19, v5
    v_accvgpr_write_b32 a23, v6
    s_add_u32 s17, s49, 223488
    buffer_load_dword v120, v9, s[20:23], s17 offen
    buffer_load_dword v121, v10, s[20:23], s17 offen
    buffer_load_dword v122, v12, s[20:23], s17 offen
    buffer_load_dword v123, v13, s[20:23], s17 offen
    s_waitcnt vmcnt(58)
    v_perm_b32 v5, v65, v64, s44
    v_perm_b32 v6, v65, v64, s45
    s_waitcnt vmcnt(56)
    v_perm_b32 v140, v67, v66, v11
    v_accvgpr_write_b32 a24, v5
    v_accvgpr_write_b32 a28, v6
    s_add_u32 s17, s49, 224640
    buffer_load_dword v124, v9, s[20:23], s17 offen
    buffer_load_dword v125, v10, s[20:23], s17 offen
    buffer_load_dword v126, v12, s[20:23], s17 offen
    buffer_load_dword v127, v13, s[20:23], s17 offen
    s_waitcnt vmcnt(58)
    v_perm_b32 v5, v69, v68, s44
    v_perm_b32 v6, v69, v68, s45
    s_waitcnt vmcnt(56)
    v_perm_b32 v141, v71, v70, v11
    v_accvgpr_write_b32 a25, v5
    v_accvgpr_write_b32 a29, v6
    s_add_u32 s17, s49, 258048
    buffer_load_dword v16, v9, s[20:23], s17 offen
    buffer_load_dword v17, v10, s[20:23], s17 offen
    buffer_load_dword v18, v12, s[20:23], s17 offen
    buffer_load_dword v19, v13, s[20:23], s17 offen
    s_waitcnt vmcnt(58)
    v_perm_b32 v5, v73, v72, s44
    v_perm_b32 v6, v73, v72, s45
    s_waitcnt vmcnt(56)
    v_perm_b32 v142, v75, v74, v11
    v_accvgpr_write_b32 a26, v5
    v_accvgpr_write_b32 a30, v6
    s_add_u32 s17, s49, 259200
    buffer_load_dword v20, v9, s[20:23], s17 offen
    buffer_load_dword v21, v10, s[20:23], s17 offen
    buffer_load_dword v22, v12, s[20:23], s17 offen
    buffer_load_dword v23, v13, s[20:23], s17 offen
    s_waitcnt vmcnt(58)
    v_perm_b32 v5, v77, v76, s44
    v_perm_b32 v6, v77, v76, s45
    s_waitcnt vmcnt(56)
    v_perm_b32 v143, v79, v78, v11
    v_accvgpr_write_b32 a27, v5
    v_accvgpr_write_b32 a31, v6
    s_add_u32 s17, s49, 260352
    buffer_load_dword v24, v9, s[20:23], s17 offen
    buffer_load_dword v25, v10, s[20:23], s17 offen
    buffer_load_dword v26, v12, s[20:23], s17 offen
    buffer_load_dword v27, v13, s[20:23], s17 offen
    s_waitcnt vmcnt(58)
    v_perm_b32 v5, v81, v80, s44
    v_perm_b32 v6, v81, v80, s45
    s_waitcnt vmcnt(56)
    v_perm_b32 v144, v83, v82, v11
    v_accvgpr_write_b32 a32, v5
    v_accvgpr_write_b32 a36, v6
    s_add_u32 s17, s49, 261504
    buffer_load_dword v28, v9, s[20:23], s17 offen
    buffer_load_dword v29, v10, s[20:23], s17 offen
    buffer_load_dword v30, v12, s[20:23], s17 offen
    buffer_load_dword v31, v13, s[20:23], s17 offen
    s_waitcnt vmcnt(58)
    v_perm_b32 v5, v85, v84, s44
    v_perm_b32 v6, v85, v84, s45
    s_waitcnt vmcnt(56)
    v_perm_b32 v145, v87, v86, v11
    v_accvgpr_write_b32 a33, v5
    v_accvgpr_write_b32 a37, v6
    s_add_u32 s17, s49, 294912
    buffer_load_dword v32, v9, s[20:23], s17 offen
    buffer_load_dword v33, v10, s[20:23], s17 offen
    buffer_load_dword v34, v12, s[20:23], s17 offen
    buffer_load_dword v35, v13, s[20:23], s17 offen
    s_waitcnt vmcnt(58)
    v_perm_b32 v5, v89, v88, s44
    v_perm_b32 v6, v89, v88, s45
    s_waitcnt vmcnt(56)
    v_perm_b32 v146, v91, v90, v11
    v_accvgpr_write_b32 a34, v5
    v_accvgpr_write_b32 a38, v6
    s_add_u32 s17, s49, 296064
    buffer_load_dword v36, v9, s[20:23], s17 offen
    buffer_load_dword v37, v10, s[20:23], s17 offen
    buffer_load_dword v38, v12, s[20:23], s17 offen
    buffer_load_dword v39, v13, s[20:23], s17 offen
    s_waitcnt vmcnt(58)
    v_perm_b32 v5, v93, v92, s44
    v_perm_b32 v6, v93, v92, s45
    s_waitcnt vmcnt(56)
    v_perm_b32 v147, v95, v94, v11
    v_accvgpr_write_b32 a35, v5
    v_accvgpr_write_b32 a39, v6
    s_add_u32 s17, s49, 297216
    buffer_load_dword v40, v9, s[20:23], s17 offen
    buffer_load_dword v41, v10, s[20:23], s17 offen
    buffer_load_dword v42, v12, s[20:23], s17 offen
    buffer_load_dword v43, v13, s[20:23], s17 offen
    s_waitcnt vmcnt(58)
    v_perm_b32 v5, v97, v96, s44
    v_perm_b32 v6, v97, v96, s45
    s_waitcnt vmcnt(56)
    v_perm_b32 v148, v99, v98, v11
    v_accvgpr_write_b32 a40, v5
    v_accvgpr_write_b32 a44, v6
    s_add_u32 s17, s49, 298368
    buffer_load_dword v44, v9, s[20:23], s17 offen
    buffer_load_dword v45, v10, s[20:23], s17 offen
    buffer_load_dword v46, v12, s[20:23], s17 offen
    buffer_load_dword v47, v13, s[20:23], s17 offen
    s_waitcnt vmcnt(58)
    v_perm_b32 v5, v101, v100, s44
    v_perm_b32 v6, v101, v100, s45
    s_waitcnt vmcnt(56)
    v_perm_b32 v149, v103, v102, v11
    v_accvgpr_write_b32 a41, v5
    v_accvgpr_write_b32 a45, v6
    s_add_u32 s17, s49, 331776
    buffer_load_dword v48, v9, s[20:23], s17 offen
    buffer_load_dword v49, v10, s[20:23], s17 offen
    buffer_load_dword v50, v12, s[20:23], s17 offen
    buffer_load_dword v51, v13, s[20:23], s17 offen
    s_waitcnt vmcnt(58)
    v_perm_b32 v5, v105, v104, s44
    v_perm_b32 v6, v105, v104, s45
    s_waitcnt vmcnt(56)
    v_perm_b32 v150, v107, v106, v11
    v_accvgpr_write_b32 a42, v5
    v_accvgpr_write_b32 a46, v6
    s_add_u32 s17, s49, 332928
    buffer_load_dword v52, v9, s[20:23], s17 offen
    buffer_load_dword v53, v10, s[20:23], s17 offen
    buffer_load_dword v54, v12, s[20:23], s17 offen
    buffer_load_dword v55, v13, s[20:23], s17 offen
    s_waitcnt vmcnt(58)
    v_perm_b32 v5, v109, v108, s44
    v_perm_b32 v6, v109, v108, s45
    s_waitcnt vmcnt(56)
    v_perm_b32 v151, v111, v110, v11
    v_accvgpr_write_b32 a43, v5
    v_accvgpr_write_b32 a47, v6
    s_add_u32 s17, s49, 334080
    buffer_load_dword v56, v9, s[20:23], s17 offen
    buffer_load_dword v57, v10, s[20:23], s17 offen
    buffer_load_dword v58, v12, s[20:23], s17 offen
    buffer_load_dword v59, v13, s[20:23], s17 offen
    s_waitcnt vmcnt(58)
    v_perm_b32 v5, v113, v112, s44
    v_perm_b32 v6, v113, v112, s45
    s_waitcnt vmcnt(56)
    v_perm_b32 v152, v115, v114, v11
    v_accvgpr_write_b32 a48, v5
    v_accvgpr_write_b32 a52, v6
    s_add_u32 s17, s49, 335232
    buffer_load_dword v60, v9, s[20:23], s17 offen
    buffer_load_dword v61, v10, s[20:23], s17 offen
    buffer_load_dword v62, v12, s[20:23], s17 offen
    buffer_load_dword v63, v13, s[20:23], s17 offen
    s_waitcnt vmcnt(58)
    v_perm_b32 v5, v117, v116, s44
    v_perm_b32 v6, v117, v116, s45
    s_waitcnt vmcnt(56)
    v_perm_b32 v153, v119, v118, v11
    v_accvgpr_write_b32 a49, v5
    v_accvgpr_write_b32 a53, v6
    s_add_u32 s17, s49, 368640
    buffer_load_dword v64, v9, s[20:23], s17 offen
    buffer_load_dword v65, v10, s[20:23], s17 offen
    buffer_load_dword v66, v12, s[20:23], s17 offen
    buffer_load_dword v67, v13, s[20:23], s17 offen
    s_waitcnt vmcnt(58)
    v_perm_b32 v5, v121, v120, s44
    v_perm_b32 v6, v121, v120, s45
    s_waitcnt vmcnt(56)
    v_perm_b32 v154, v123, v122, v11
    v_accvgpr_write_b32 a50, v5
    v_accvgpr_write_b32 a54, v6
    s_add_u32 s17, s49, 369792
    buffer_load_dword v68, v9, s[20:23], s17 offen
    buffer_load_dword v69, v10, s[20:23], s17 offen
    buffer_load_dword v70, v12, s[20:23], s17 offen
    buffer_load_dword v71, v13, s[20:23], s17 offen
    s_waitcnt vmcnt(58)
    v_perm_b32 v5, v125, v124, s44
    v_perm_b32 v6, v125, v124, s45
    s_waitcnt vmcnt(56)
    v_perm_b32 v155, v127, v126, v11
    v_accvgpr_write_b32 a51, v5
    v_accvgpr_write_b32 a55, v6
    s_add_u32 s17, s49, 370944
    buffer_load_dword v72, v9, s[20:23], s17 offen
    buffer_load_dword v73, v10, s[20:23], s17 offen
    buffer_load_dword v74, v12, s[20:23], s17 offen
    buffer_load_dword v75, v13, s[20:23], s17 offen
    s_waitcnt vmcnt(58)
    v_perm_b32 v5, v17, v16, s44
    v_perm_b32 v6, v17, v16, s45
    s_waitcnt vmcnt(56)
    v_perm_b32 v156, v19, v18, v11
    v_accvgpr_write_b32 a56, v5
    v_accvgpr_write_b32 a60, v6
    s_add_u32 s17, s49, 372096
    buffer_load_dword v76, v9, s[20:23], s17 offen
    buffer_load_dword v77, v10, s[20:23], s17 offen
    buffer_load_dword v78, v12, s[20:23], s17 offen
    buffer_load_dword v79, v13, s[20:23], s17 offen
    s_waitcnt vmcnt(58)
    v_perm_b32 v5, v21, v20, s44
    v_perm_b32 v6, v21, v20, s45
    s_waitcnt vmcnt(56)
    v_perm_b32 v157, v23, v22, v11
    v_accvgpr_write_b32 a57, v5
    v_accvgpr_write_b32 a61, v6
    s_add_u32 s17, s49, 405504
    buffer_load_dword v80, v9, s[20:23], s17 offen
    buffer_load_dword v81, v10, s[20:23], s17 offen
    buffer_load_dword v82, v12, s[20:23], s17 offen
    buffer_load_dword v83, v13, s[20:23], s17 offen
    s_waitcnt vmcnt(58)
    v_perm_b32 v5, v25, v24, s44
    v_perm_b32 v6, v25, v24, s45
    s_waitcnt vmcnt(56)
    v_perm_b32 v158, v27, v26, v11
    v_accvgpr_write_b32 a58, v5
    v_accvgpr_write_b32 a62, v6
    s_add_u32 s17, s49, 406656
    buffer_load_dword v84, v9, s[20:23], s17 offen
    buffer_load_dword v85, v10, s[20:23], s17 offen
    buffer_load_dword v86, v12, s[20:23], s17 offen
    buffer_load_dword v87, v13, s[20:23], s17 offen
    s_waitcnt vmcnt(58)
    v_perm_b32 v5, v29, v28, s44
    v_perm_b32 v6, v29, v28, s45
    s_waitcnt vmcnt(56)
    v_perm_b32 v159, v31, v30, v11
    v_accvgpr_write_b32 a59, v5
    v_accvgpr_write_b32 a63, v6
    s_add_u32 s17, s49, 407808
    buffer_load_dword v88, v9, s[20:23], s17 offen
    buffer_load_dword v89, v10, s[20:23], s17 offen
    buffer_load_dword v90, v12, s[20:23], s17 offen
    buffer_load_dword v91, v13, s[20:23], s17 offen
    s_waitcnt vmcnt(58)
    v_perm_b32 v5, v33, v32, s44
    v_perm_b32 v6, v33, v32, s45
    s_waitcnt vmcnt(56)
    v_perm_b32 v160, v35, v34, v11
    v_accvgpr_write_b32 a64, v5
    v_accvgpr_write_b32 a68, v6
    s_add_u32 s17, s49, 408960
    buffer_load_dword v92, v9, s[20:23], s17 offen
    buffer_load_dword v93, v10, s[20:23], s17 offen
    buffer_load_dword v94, v12, s[20:23], s17 offen
    buffer_load_dword v95, v13, s[20:23], s17 offen
    s_waitcnt vmcnt(58)
    v_perm_b32 v5, v37, v36, s44
    v_perm_b32 v6, v37, v36, s45
    s_waitcnt vmcnt(56)
    v_perm_b32 v161, v39, v38, v11
    v_accvgpr_write_b32 a65, v5
    v_accvgpr_write_b32 a69, v6
    s_add_u32 s17, s49, 442368
    buffer_load_dword v96, v9, s[20:23], s17 offen
    buffer_load_dword v97, v10, s[20:23], s17 offen
    buffer_load_dword v98, v12, s[20:23], s17 offen
    buffer_load_dword v99, v13, s[20:23], s17 offen
    s_waitcnt vmcnt(58)
    v_perm_b32 v5, v41, v40, s44
    v_perm_b32 v6, v41, v40, s45
    s_waitcnt vmcnt(56)
    v_perm_b32 v162, v43, v42, v11
    v_accvgpr_write_b32 a66, v5
    v_accvgpr_write_b32 a70, v6
    s_add_u32 s17, s49, 443520
    buffer_load_dword v100, v9, s[20:23], s17 offen
    buffer_load_dword v101, v10, s[20:23], s17 offen
    buffer_load_dword v102, v12, s[20:23], s17 offen
    buffer_load_dword v103, v13, s[20:23], s17 offen
    s_waitcnt vmcnt(58)
    v_perm_b32 v5, v45, v44, s44
    v_perm_b32 v6, v45, v44, s45
    s_waitcnt vmcnt(56)
    v_perm_b32 v163, v47, v46, v11
    v_accvgpr_write_b32 a67, v5
    v_accvgpr_write_b32 a71, v6
    s_add_u32 s17, s49, 444672
    buffer_load_dword v104, v9, s[20:23], s17 offen
    buffer_load_dword v105, v10, s[20:23], s17 offen
    buffer_load_dword v106, v12, s[20:23], s17 offen
    buffer_load_dword v107, v13, s[20:23], s17 offen
    s_waitcnt vmcnt(58)
    v_perm_b32 v5, v49, v48, s44
    v_perm_b32 v6, v49, v48, s45
    s_waitcnt vmcnt(56)
    v_perm_b32 v164, v51, v50, v11
    v_accvgpr_write_b32 a72, v5
    v_accvgpr_write_b32 a76, v6
    s_add_u32 s17, s49, 445824
    buffer_load_dword v108, v9, s[20:23], s17 offen
    buffer_load_dword v109, v10, s[20:23], s17 offen
    buffer_load_dword v110, v12, s[20:23], s17 offen
    buffer_load_dword v111, v13, s[20:23], s17 offen
    s_waitcnt vmcnt(58)
    v_perm_b32 v5, v53, v52, s44
    v_perm_b32 v6, v53, v52, s45
    s_waitcnt vmcnt(56)
    v_perm_b32 v165, v55, v54, v11
    v_accvgpr_write_b32 a73, v5
    v_accvgpr_write_b32 a77, v6
    s_add_u32 s17, s49, 479232
    buffer_load_dword v112, v9, s[20:23], s17 offen
    buffer_load_dword v113, v10, s[20:23], s17 offen
    buffer_load_dword v114, v12, s[20:23], s17 offen
    buffer_load_dword v115, v13, s[20:23], s17 offen
    s_waitcnt vmcnt(58)
    v_perm_b32 v5, v57, v56, s44
    v_perm_b32 v6, v57, v56, s45
    s_waitcnt vmcnt(56)
    v_perm_b32 v166, v59, v58, v11
    v_accvgpr_write_b32 a74, v5
    v_accvgpr_write_b32 a78, v6
    s_add_u32 s17, s49, 480384
    buffer_load_dword v116, v9, s[20:23], s17 offen
    buffer_load_dword v117, v10, s[20:23], s17 offen
    buffer_load_dword v118, v12, s[20:23], s17 offen
    buffer_load_dword v119, v13, s[20:23], s17 offen
    s_waitcnt vmcnt(58)
    v_perm_b32 v5, v61, v60, s44
    v_perm_b32 v6, v61, v60, s45
    s_waitcnt vmcnt(56)
    v_perm_b32 v167, v63, v62, v11
    v_accvgpr_write_b32 a75, v5
    v_accvgpr_write_b32 a79, v6
    s_add_u32 s17, s49, 481536
    buffer_load_dword v120, v9, s[20:23], s17 offen
    buffer_load_dword v121, v10, s[20:23], s17 offen
    buffer_load_dword v122, v12, s[20:23], s17 offen
    buffer_load_dword v123, v13, s[20:23], s17 offen
    s_waitcnt vmcnt(58)
    v_perm_b32 v5, v65, v64, s44
    v_perm_b32 v6, v65, v64, s45
    s_waitcnt vmcnt(56)
    v_perm_b32 v168, v67, v66, v11
    v_accvgpr_write_b32 a80, v5
    v_accvgpr_write_b32 a84, v6
    s_add_u32 s17, s49, 482688
    buffer_load_dword v124, v9, s[20:23], s17 offen
    buffer_load_dword v125, v10, s[20:23], s17 offen
    buffer_load_dword v126, v12, s[20:23], s17 offen
    buffer_load_dword v127, v13, s[20:23], s17 offen
    s_waitcnt vmcnt(58)
    v_perm_b32 v5, v69, v68, s44
    v_perm_b32 v6, v69, v68, s45
    s_waitcnt vmcnt(56)
    v_perm_b32 v169, v71, v70, v11
    v_accvgpr_write_b32 a81, v5
    v_accvgpr_write_b32 a85, v6
    s_add_u32 s17, s49, 516096
    buffer_load_dword v16, v9, s[20:23], s17 offen
    buffer_load_dword v17, v10, s[20:23], s17 offen
    buffer_load_dword v18, v12, s[20:23], s17 offen
    buffer_load_dword v19, v13, s[20:23], s17 offen
    s_waitcnt vmcnt(58)
    v_perm_b32 v5, v73, v72, s44
    v_perm_b32 v6, v73, v72, s45
    s_waitcnt vmcnt(56)
    v_perm_b32 v170, v75, v74, v11
    v_accvgpr_write_b32 a82, v5
    v_accvgpr_write_b32 a86, v6
    s_add_u32 s17, s49, 517248
    buffer_load_dword v20, v9, s[20:23], s17 offen
    buffer_load_dword v21, v10, s[20:23], s17 offen
    buffer_load_dword v22, v12, s[20:23], s17 offen
    buffer_load_dword v23, v13, s[20:23], s17 offen
    s_waitcnt vmcnt(58)
    v_perm_b32 v5, v77, v76, s44
    v_perm_b32 v6, v77, v76, s45
    s_waitcnt vmcnt(56)
    v_perm_b32 v171, v79, v78, v11
    v_accvgpr_write_b32 a83, v5
    v_accvgpr_write_b32 a87, v6
    s_add_u32 s17, s49, 518400
    buffer_load_dword v24, v9, s[20:23], s17 offen
    buffer_load_dword v25, v10, s[20:23], s17 offen
    buffer_load_dword v26, v12, s[20:23], s17 offen
    buffer_load_dword v27, v13, s[20:23], s17 offen
    s_waitcnt vmcnt(58)
    v_perm_b32 v5, v81, v80, s44
    v_perm_b32 v6, v81, v80, s45
    s_waitcnt vmcnt(56)
    v_perm_b32 v172, v83, v82, v11
    v_accvgpr_write_b32 a88, v5
    v_accvgpr_write_b32 a92, v6
    s_add_u32 s17, s49, 519552
    buffer_load_dword v28, v9, s[20:23], s17 offen
    buffer_load_dword v29, v10, s[20:23], s17 offen
    buffer_load_dword v30, v12, s[20:23], s17 offen
    buffer_load_dword v31, v13, s[20:23], s17 offen
    s_waitcnt vmcnt(58)
    v_perm_b32 v5, v85, v84, s44
    v_perm_b32 v6, v85, v84, s45
    s_waitcnt vmcnt(56)
    v_perm_b32 v173, v87, v86, v11
    v_accvgpr_write_b32 a89, v5
    v_accvgpr_write_b32 a93, v6
    s_add_u32 s17, s49, 552960
    buffer_load_dword v32, v9, s[20:23], s17 offen
    buffer_load_dword v33, v10, s[20:23], s17 offen
    buffer_load_dword v34, v12, s[20:23], s17 offen
    buffer_load_dword v35, v13, s[20:23], s17 offen
    s_waitcnt vmcnt(58)
    v_perm_b32 v5, v89, v88, s44
    v_perm_b32 v6, v89, v88, s45
    s_waitcnt vmcnt(56)
    v_perm_b32 v174, v91, v90, v11
    v_accvgpr_write_b32 a90, v5
    v_accvgpr_write_b32 a94, v6
    s_add_u32 s17, s49, 554112
    buffer_load_dword v36, v9, s[20:23], s17 offen
    buffer_load_dword v37, v10, s[20:23], s17 offen
    buffer_load_dword v38, v12, s[20:23], s17 offen
    buffer_load_dword v39, v13, s[20:23], s17 offen
    s_waitcnt vmcnt(58)
    v_perm_b32 v5, v93, v92, s44
    v_perm_b32 v6, v93, v92, s45
    s_waitcnt vmcnt(56)
    v_perm_b32 v175, v95, v94, v11
    v_accvgpr_write_b32 a91, v5
    v_accvgpr_write_b32 a95, v6
    s_add_u32 s17, s49, 555264
    buffer_load_dword v40, v9, s[20:23], s17 offen
    buffer_load_dword v41, v10, s[20:23], s17 offen
    buffer_load_dword v42, v12, s[20:23], s17 offen
    buffer_load_dword v43, v13, s[20:23], s17 offen
    s_waitcnt vmcnt(58)
    v_perm_b32 v5, v97, v96, s44
    v_perm_b32 v6, v97, v96, s45
    s_waitcnt vmcnt(56)
    v_perm_b32 v176, v99, v98, v11
    v_accvgpr_write_b32 a96, v5
    v_accvgpr_write_b32 a100, v6
    s_add_u32 s17, s49, 556416
    buffer_load_dword v44, v9, s[20:23], s17 offen
    buffer_load_dword v45, v10, s[20:23], s17 offen
    buffer_load_dword v46, v12, s[20:23], s17 offen
    buffer_load_dword v47, v13, s[20:23], s17 offen
    s_waitcnt vmcnt(58)
    v_perm_b32 v5, v101, v100, s44
    v_perm_b32 v6, v101, v100, s45
    s_waitcnt vmcnt(56)
    v_perm_b32 v177, v103, v102, v11
    v_accvgpr_write_b32 a97, v5
    v_accvgpr_write_b32 a101, v6
    s_add_u32 s17, s49, 589824
    buffer_load_dword v48, v9, s[20:23], s17 offen
    buffer_load_dword v49, v10, s[20:23], s17 offen
    buffer_load_dword v50, v12, s[20:23], s17 offen
    buffer_load_dword v51, v13, s[20:23], s17 offen
    s_waitcnt vmcnt(58)
    v_perm_b32 v5, v105, v104, s44
    v_perm_b32 v6, v105, v104, s45
    s_waitcnt vmcnt(56)
    v_perm_b32 v178, v107, v106, v11
    v_accvgpr_write_b32 a98, v5
    v_accvgpr_write_b32 a102, v6
    s_add_u32 s17, s49, 590976
    buffer_load_dword v52, v9, s[20:23], s17 offen
    buffer_load_dword v53, v10, s[20:23], s17 offen
    buffer_load_dword v54, v12, s[20:23], s17 offen
    buffer_load_dword v55, v13, s[20:23], s17 offen
    s_waitcnt vmcnt(58)
    v_perm_b32 v5, v109, v108, s44
    v_perm_b32 v6, v109, v108, s45
    s_waitcnt vmcnt(56)
    v_perm_b32 v179, v111, v110, v11
    v_accvgpr_write_b32 a99, v5
    v_accvgpr_write_b32 a103, v6
    s_add_u32 s17, s49, 592128
    buffer_load_dword v56, v9, s[20:23], s17 offen
    buffer_load_dword v57, v10, s[20:23], s17 offen
    buffer_load_dword v58, v12, s[20:23], s17 offen
    buffer_load_dword v59, v13, s[20:23], s17 offen
    s_waitcnt vmcnt(58)
    v_perm_b32 v5, v113, v112, s44
    v_perm_b32 v6, v113, v112, s45
    s_waitcnt vmcnt(56)
    v_perm_b32 v180, v115, v114, v11
    v_accvgpr_write_b32 a104, v5
    v_accvgpr_write_b32 a108, v6
    s_add_u32 s17, s49, 593280
    buffer_load_dword v60, v9, s[20:23], s17 offen
    buffer_load_dword v61, v10, s[20:23], s17 offen
    buffer_load_dword v62, v12, s[20:23], s17 offen
    buffer_load_dword v63, v13, s[20:23], s17 offen
    s_waitcnt vmcnt(58)
    v_perm_b32 v5, v117, v116, s44
    v_perm_b32 v6, v117, v116, s45
    s_waitcnt vmcnt(56)
    v_perm_b32 v181, v119, v118, v11
    v_accvgpr_write_b32 a105, v5
    v_accvgpr_write_b32 a109, v6
    s_add_u32 s17, s49, 626688
    buffer_load_dword v64, v9, s[20:23], s17 offen
    buffer_load_dword v65, v10, s[20:23], s17 offen
    buffer_load_dword v66, v12, s[20:23], s17 offen
    buffer_load_dword v67, v13, s[20:23], s17 offen
    s_waitcnt vmcnt(58)
    v_perm_b32 v5, v121, v120, s44
    v_perm_b32 v6, v121, v120, s45
    s_waitcnt vmcnt(56)
    v_perm_b32 v182, v123, v122, v11
    v_accvgpr_write_b32 a106, v5
    v_accvgpr_write_b32 a110, v6
    s_add_u32 s17, s49, 627840
    buffer_load_dword v68, v9, s[20:23], s17 offen
    buffer_load_dword v69, v10, s[20:23], s17 offen
    buffer_load_dword v70, v12, s[20:23], s17 offen
    buffer_load_dword v71, v13, s[20:23], s17 offen
    s_waitcnt vmcnt(58)
    v_perm_b32 v5, v125, v124, s44
    v_perm_b32 v6, v125, v124, s45
    s_waitcnt vmcnt(56)
    v_perm_b32 v183, v127, v126, v11
    v_accvgpr_write_b32 a107, v5
    v_accvgpr_write_b32 a111, v6
    s_add_u32 s17, s49, 628992
    buffer_load_dword v72, v9, s[20:23], s17 offen
    buffer_load_dword v73, v10, s[20:23], s17 offen
    buffer_load_dword v74, v12, s[20:23], s17 offen
    buffer_load_dword v75, v13, s[20:23], s17 offen
    s_waitcnt vmcnt(58)
    v_perm_b32 v5, v17, v16, s44
    v_perm_b32 v6, v17, v16, s45
    s_waitcnt vmcnt(56)
    v_perm_b32 v184, v19, v18, v11
    v_accvgpr_write_b32 a112, v5
    v_accvgpr_write_b32 a116, v6
    s_add_u32 s17, s49, 630144
    buffer_load_dword v76, v9, s[20:23], s17 offen
    buffer_load_dword v77, v10, s[20:23], s17 offen
    buffer_load_dword v78, v12, s[20:23], s17 offen
    buffer_load_dword v79, v13, s[20:23], s17 offen
    s_waitcnt vmcnt(58)
    v_perm_b32 v5, v21, v20, s44
    v_perm_b32 v6, v21, v20, s45
    s_waitcnt vmcnt(56)
    v_perm_b32 v185, v23, v22, v11
    v_accvgpr_write_b32 a113, v5
    v_accvgpr_write_b32 a117, v6
    s_add_u32 s17, s49, 663552
    buffer_load_dword v80, v9, s[20:23], s17 offen
    buffer_load_dword v81, v10, s[20:23], s17 offen
    buffer_load_dword v82, v12, s[20:23], s17 offen
    buffer_load_dword v83, v13, s[20:23], s17 offen
    s_waitcnt vmcnt(58)
    v_perm_b32 v5, v25, v24, s44
    v_perm_b32 v6, v25, v24, s45
    s_waitcnt vmcnt(56)
    v_perm_b32 v186, v27, v26, v11
    v_accvgpr_write_b32 a114, v5
    v_accvgpr_write_b32 a118, v6
    s_add_u32 s17, s49, 664704
    buffer_load_dword v84, v9, s[20:23], s17 offen
    buffer_load_dword v85, v10, s[20:23], s17 offen
    buffer_load_dword v86, v12, s[20:23], s17 offen
    buffer_load_dword v87, v13, s[20:23], s17 offen
    s_waitcnt vmcnt(58)
    v_perm_b32 v5, v29, v28, s44
    v_perm_b32 v6, v29, v28, s45
    s_waitcnt vmcnt(56)
    v_perm_b32 v187, v31, v30, v11
    v_accvgpr_write_b32 a115, v5
    v_accvgpr_write_b32 a119, v6
    s_add_u32 s17, s49, 665856
    buffer_load_dword v88, v9, s[20:23], s17 offen
    buffer_load_dword v89, v10, s[20:23], s17 offen
    buffer_load_dword v90, v12, s[20:23], s17 offen
    buffer_load_dword v91, v13, s[20:23], s17 offen
    s_waitcnt vmcnt(58)
    v_perm_b32 v5, v33, v32, s44
    v_perm_b32 v6, v33, v32, s45
    s_waitcnt vmcnt(56)
    v_perm_b32 v188, v35, v34, v11
    v_accvgpr_write_b32 a120, v5
    v_accvgpr_write_b32 a124, v6
    s_add_u32 s17, s49, 667008
    buffer_load_dword v92, v9, s[20:23], s17 offen
    buffer_load_dword v93, v10, s[20:23], s17 offen
    buffer_load_dword v94, v12, s[20:23], s17 offen
    buffer_load_dword v95, v13, s[20:23], s17 offen
    s_waitcnt vmcnt(58)
    v_perm_b32 v5, v37, v36, s44
    v_perm_b32 v6, v37, v36, s45
    s_waitcnt vmcnt(56)
    v_perm_b32 v189, v39, v38, v11
    v_accvgpr_write_b32 a121, v5
    v_accvgpr_write_b32 a125, v6
    s_add_u32 s17, s49, 700416
    buffer_load_dword v96, v9, s[20:23], s17 offen
    buffer_load_dword v97, v10, s[20:23], s17 offen
    buffer_load_dword v98, v12, s[20:23], s17 offen
    buffer_load_dword v99, v13, s[20:23], s17 offen
    s_waitcnt vmcnt(58)
    v_perm_b32 v5, v41, v40, s44
    v_perm_b32 v6, v41, v40, s45
    s_waitcnt vmcnt(56)
    v_perm_b32 v190, v43, v42, v11
    v_accvgpr_write_b32 a122, v5
    v_accvgpr_write_b32 a126, v6
    s_add_u32 s17, s49, 701568
    buffer_load_dword v100, v9, s[20:23], s17 offen
    buffer_load_dword v101, v10, s[20:23], s17 offen
    buffer_load_dword v102, v12, s[20:23], s17 offen
    buffer_load_dword v103, v13, s[20:23], s17 offen
    s_waitcnt vmcnt(58)
    v_perm_b32 v5, v45, v44, s44
    v_perm_b32 v6, v45, v44, s45
    s_waitcnt vmcnt(56)
    v_perm_b32 v191, v47, v46, v11
    v_accvgpr_write_b32 a123, v5
    v_accvgpr_write_b32 a127, v6
    s_add_u32 s17, s49, 702720
    buffer_load_dword v104, v9, s[20:23], s17 offen
    buffer_load_dword v105, v10, s[20:23], s17 offen
    buffer_load_dword v106, v12, s[20:23], s17 offen
    buffer_load_dword v107, v13, s[20:23], s17 offen
    s_waitcnt vmcnt(58)
    v_perm_b32 v5, v49, v48, s44
    v_perm_b32 v6, v49, v48, s45
    s_waitcnt vmcnt(56)
    v_perm_b32 v192, v51, v50, v11
    v_accvgpr_write_b32 a128, v5
    v_accvgpr_write_b32 a132, v6
    s_add_u32 s17, s49, 703872
    buffer_load_dword v108, v9, s[20:23], s17 offen
    buffer_load_dword v109, v10, s[20:23], s17 offen
    buffer_load_dword v110, v12, s[20:23], s17 offen
    buffer_load_dword v111, v13, s[20:23], s17 offen
    s_waitcnt vmcnt(58)
    v_perm_b32 v5, v53, v52, s44
    v_perm_b32 v6, v53, v52, s45
    s_waitcnt vmcnt(56)
    v_perm_b32 v193, v55, v54, v11
    v_accvgpr_write_b32 a129, v5
    v_accvgpr_write_b32 a133, v6
    s_add_u32 s17, s49, 737280
    buffer_load_dword v112, v9, s[20:23], s17 offen
    buffer_load_dword v113, v10, s[20:23], s17 offen
    buffer_load_dword v114, v12, s[20:23], s17 offen
    buffer_load_dword v115, v13, s[20:23], s17 offen
    s_waitcnt vmcnt(58)
    v_perm_b32 v5, v57, v56, s44
    v_perm_b32 v6, v57, v56, s45
    s_waitcnt vmcnt(56)
    v_perm_b32 v194, v59, v58, v11
    v_accvgpr_write_b32 a130, v5
    v_accvgpr_write_b32 a134, v6
    s_add_u32 s17, s49, 738432
    buffer_load_dword v116, v9, s[20:23], s17 offen
    buffer_load_dword v117, v10, s[20:23], s17 offen
    buffer_load_dword v118, v12, s[20:23], s17 offen
    buffer_load_dword v119, v13, s[20:23], s17 offen
    s_waitcnt vmcnt(58)
    v_perm_b32 v5, v61, v60, s44
    v_perm_b32 v6, v61, v60, s45
    s_waitcnt vmcnt(56)
    v_perm_b32 v195, v63, v62, v11
    v_accvgpr_write_b32 a131, v5
    v_accvgpr_write_b32 a135, v6
    s_add_u32 s17, s49, 739584
    buffer_load_dword v120, v9, s[20:23], s17 offen
    buffer_load_dword v121, v10, s[20:23], s17 offen
    buffer_load_dword v122, v12, s[20:23], s17 offen
    buffer_load_dword v123, v13, s[20:23], s17 offen
    s_waitcnt vmcnt(58)
    v_perm_b32 v5, v65, v64, s44
    v_perm_b32 v6, v65, v64, s45
    s_waitcnt vmcnt(56)
    v_perm_b32 v196, v67, v66, v11
    v_accvgpr_write_b32 a136, v5
    v_accvgpr_write_b32 a140, v6
    s_add_u32 s17, s49, 740736
    buffer_load_dword v124, v9, s[20:23], s17 offen
    buffer_load_dword v125, v10, s[20:23], s17 offen
    buffer_load_dword v126, v12, s[20:23], s17 offen
    buffer_load_dword v127, v13, s[20:23], s17 offen
    s_waitcnt vmcnt(58)
    v_perm_b32 v5, v69, v68, s44
    v_perm_b32 v6, v69, v68, s45
    s_waitcnt vmcnt(56)
    v_perm_b32 v197, v71, v70, v11
    v_accvgpr_write_b32 a137, v5
    v_accvgpr_write_b32 a141, v6
    s_add_u32 s17, s49, 774144
    buffer_load_dword v16, v9, s[20:23], s17 offen
    buffer_load_dword v17, v10, s[20:23], s17 offen
    buffer_load_dword v18, v12, s[20:23], s17 offen
    buffer_load_dword v19, v13, s[20:23], s17 offen
    s_waitcnt vmcnt(58)
    v_perm_b32 v5, v73, v72, s44
    v_perm_b32 v6, v73, v72, s45
    s_waitcnt vmcnt(56)
    v_perm_b32 v198, v75, v74, v11
    v_accvgpr_write_b32 a138, v5
    v_accvgpr_write_b32 a142, v6
    s_add_u32 s17, s49, 775296
    buffer_load_dword v20, v9, s[20:23], s17 offen
    buffer_load_dword v21, v10, s[20:23], s17 offen
    buffer_load_dword v22, v12, s[20:23], s17 offen
    buffer_load_dword v23, v13, s[20:23], s17 offen
    s_waitcnt vmcnt(58)
    v_perm_b32 v5, v77, v76, s44
    v_perm_b32 v6, v77, v76, s45
    s_waitcnt vmcnt(56)
    v_perm_b32 v199, v79, v78, v11
    v_accvgpr_write_b32 a139, v5
    v_accvgpr_write_b32 a143, v6
    s_add_u32 s17, s49, 776448
    buffer_load_dword v24, v9, s[20:23], s17 offen
    buffer_load_dword v25, v10, s[20:23], s17 offen
    buffer_load_dword v26, v12, s[20:23], s17 offen
    buffer_load_dword v27, v13, s[20:23], s17 offen
    s_waitcnt vmcnt(58)
    v_perm_b32 v5, v81, v80, s44
    v_perm_b32 v6, v81, v80, s45
    s_waitcnt vmcnt(56)
    v_perm_b32 v200, v83, v82, v11
    v_accvgpr_write_b32 a144, v5
    v_accvgpr_write_b32 a148, v6
    s_add_u32 s17, s49, 777600
    buffer_load_dword v28, v9, s[20:23], s17 offen
    buffer_load_dword v29, v10, s[20:23], s17 offen
    buffer_load_dword v30, v12, s[20:23], s17 offen
    buffer_load_dword v31, v13, s[20:23], s17 offen
    s_waitcnt vmcnt(58)
    v_perm_b32 v5, v85, v84, s44
    v_perm_b32 v6, v85, v84, s45
    s_waitcnt vmcnt(56)
    v_perm_b32 v201, v87, v86, v11
    v_accvgpr_write_b32 a145, v5
    v_accvgpr_write_b32 a149, v6
    s_add_u32 s17, s49, 811008
    buffer_load_dword v32, v9, s[20:23], s17 offen
    buffer_load_dword v33, v10, s[20:23], s17 offen
    buffer_load_dword v34, v12, s[20:23], s17 offen
    buffer_load_dword v35, v13, s[20:23], s17 offen
    s_waitcnt vmcnt(58)
    v_perm_b32 v5, v89, v88, s44
    v_perm_b32 v6, v89, v88, s45
    s_waitcnt vmcnt(56)
    v_perm_b32 v202, v91, v90, v11
    v_accvgpr_write_b32 a146, v5
    v_accvgpr_write_b32 a150, v6
    s_add_u32 s17, s49, 812160
    buffer_load_dword v36, v9, s[20:23], s17 offen
    buffer_load_dword v37, v10, s[20:23], s17 offen
    buffer_load_dword v38, v12, s[20:23], s17 offen
    buffer_load_dword v39, v13, s[20:23], s17 offen
    s_waitcnt vmcnt(58)
    v_perm_b32 v5, v93, v92, s44
    v_perm_b32 v6, v93, v92, s45
    s_waitcnt vmcnt(56)
    v_perm_b32 v203, v95, v94, v11
    v_accvgpr_write_b32 a147, v5
    v_accvgpr_write_b32 a151, v6
    s_add_u32 s17, s49, 813312
    buffer_load_dword v40, v9, s[20:23], s17 offen
    buffer_load_dword v41, v10, s[20:23], s17 offen
    buffer_load_dword v42, v12, s[20:23], s17 offen
    buffer_load_dword v43, v13, s[20:23], s17 offen
    s_waitcnt vmcnt(58)
    v_perm_b32 v5, v97, v96, s44
    v_perm_b32 v6, v97, v96, s45
    s_waitcnt vmcnt(56)
    v_perm_b32 v204, v99, v98, v11
    v_accvgpr_write_b32 a152, v5
    v_accvgpr_write_b32 a156, v6
    s_add_u32 s17, s49, 814464
    buffer_load_dword v44, v9, s[20:23], s17 offen
    buffer_load_dword v45, v10, s[20:23], s17 offen
    buffer_load_dword v46, v12, s[20:23], s17 offen
    buffer_load_dword v47, v13, s[20:23], s17 offen
    s_waitcnt vmcnt(58)
    v_perm_b32 v5, v101, v100, s44
    v_perm_b32 v6, v101, v100, s45
    s_waitcnt vmcnt(56)
    v_perm_b32 v205, v103, v102, v11
    v_accvgpr_write_b32 a153, v5
    v_accvgpr_write_b32 a157, v6
    s_add_u32 s17, s49, 847872
    buffer_load_dword v48, v9, s[20:23], s17 offen
    buffer_load_dword v49, v10, s[20:23], s17 offen
    buffer_load_dword v50, v12, s[20:23], s17 offen
    buffer_load_dword v51, v13, s[20:23], s17 offen
    s_waitcnt vmcnt(58)
    v_perm_b32 v5, v105, v104, s44
    v_perm_b32 v6, v105, v104, s45
    s_waitcnt vmcnt(56)
    v_perm_b32 v206, v107, v106, v11
    v_accvgpr_write_b32 a154, v5
    v_accvgpr_write_b32 a158, v6
    s_add_u32 s17, s49, 849024
    buffer_load_dword v52, v9, s[20:23], s17 offen
    buffer_load_dword v53, v10, s[20:23], s17 offen
    buffer_load_dword v54, v12, s[20:23], s17 offen
    buffer_load_dword v55, v13, s[20:23], s17 offen
    s_waitcnt vmcnt(58)
    v_perm_b32 v5, v109, v108, s44
    v_perm_b32 v6, v109, v108, s45
    s_waitcnt vmcnt(56)
    v_perm_b32 v207, v111, v110, v11
    v_accvgpr_write_b32 a155, v5
    v_accvgpr_write_b32 a159, v6
    s_add_u32 s17, s49, 850176
    buffer_load_dword v56, v9, s[20:23], s17 offen
    buffer_load_dword v57, v10, s[20:23], s17 offen
    buffer_load_dword v58, v12, s[20:23], s17 offen
    buffer_load_dword v59, v13, s[20:23], s17 offen
    s_waitcnt vmcnt(58)
    v_perm_b32 v5, v113, v112, s44
    v_perm_b32 v6, v113, v112, s45
    s_waitcnt vmcnt(56)
    v_perm_b32 v208, v115, v114, v11
    v_accvgpr_write_b32 a160, v5
    v_accvgpr_write_b32 a164, v6
    s_add_u32 s17, s49, 851328
    buffer_load_dword v60, v9, s[20:23], s17 offen
    buffer_load_dword v61, v10, s[20:23], s17 offen
    buffer_load_dword v62, v12, s[20:23], s17 offen
    buffer_load_dword v63, v13, s[20:23], s17 offen
    s_waitcnt vmcnt(58)
    v_perm_b32 v5, v117, v116, s44
    v_perm_b32 v6, v117, v116, s45
    s_waitcnt vmcnt(56)
    v_perm_b32 v209, v119, v118, v11
    v_accvgpr_write_b32 a161, v5
    v_accvgpr_write_b32 a165, v6
    s_add_u32 s17, s49, 884736
    buffer_load_dword v64, v9, s[20:23], s17 offen
    buffer_load_dword v65, v10, s[20:23], s17 offen
    buffer_load_dword v66, v12, s[20:23], s17 offen
    buffer_load_dword v67, v13, s[20:23], s17 offen
    s_waitcnt vmcnt(58)
    v_perm_b32 v5, v121, v120, s44
    v_perm_b32 v6, v121, v120, s45
    s_waitcnt vmcnt(56)
    v_perm_b32 v210, v123, v122, v11
    v_accvgpr_write_b32 a162, v5
    v_accvgpr_write_b32 a166, v6
    s_add_u32 s17, s49, 885888
    buffer_load_dword v68, v9, s[20:23], s17 offen
    buffer_load_dword v69, v10, s[20:23], s17 offen
    buffer_load_dword v70, v12, s[20:23], s17 offen
    buffer_load_dword v71, v13, s[20:23], s17 offen
    s_waitcnt vmcnt(58)
    v_perm_b32 v5, v125, v124, s44
    v_perm_b32 v6, v125, v124, s45
    s_waitcnt vmcnt(56)
    v_perm_b32 v211, v127, v126, v11
    v_accvgpr_write_b32 a163, v5
    v_accvgpr_write_b32 a167, v6
    s_add_u32 s17, s49, 887040
    buffer_load_dword v72, v9, s[20:23], s17 offen
    buffer_load_dword v73, v10, s[20:23], s17 offen
    buffer_load_dword v74, v12, s[20:23], s17 offen
    buffer_load_dword v75, v13, s[20:23], s17 offen
    s_waitcnt vmcnt(58)
    v_perm_b32 v5, v17, v16, s44
    v_perm_b32 v6, v17, v16, s45
    s_waitcnt vmcnt(56)
    v_perm_b32 v212, v19, v18, v11
    v_accvgpr_write_b32 a168, v5
    v_accvgpr_write_b32 a172, v6
    s_add_u32 s17, s49, 888192
    buffer_load_dword v76, v9, s[20:23], s17 offen
    buffer_load_dword v77, v10, s[20:23], s17 offen
    buffer_load_dword v78, v12, s[20:23], s17 offen
    buffer_load_dword v79, v13, s[20:23], s17 offen
    s_waitcnt vmcnt(58)
    v_perm_b32 v5, v21, v20, s44
    v_perm_b32 v6, v21, v20, s45
    s_waitcnt vmcnt(56)
    v_perm_b32 v213, v23, v22, v11
    v_accvgpr_write_b32 a169, v5
    v_accvgpr_write_b32 a173, v6
    s_add_u32 s17, s49, 921600
    buffer_load_dword v80, v9, s[20:23], s17 offen
    buffer_load_dword v81, v10, s[20:23], s17 offen
    buffer_load_dword v82, v12, s[20:23], s17 offen
    buffer_load_dword v83, v13, s[20:23], s17 offen
    s_waitcnt vmcnt(58)
    v_perm_b32 v5, v25, v24, s44
    v_perm_b32 v6, v25, v24, s45
    s_waitcnt vmcnt(56)
    v_perm_b32 v214, v27, v26, v11
    v_accvgpr_write_b32 a170, v5
    v_accvgpr_write_b32 a174, v6
    s_add_u32 s17, s49, 922752
    buffer_load_dword v84, v9, s[20:23], s17 offen
    buffer_load_dword v85, v10, s[20:23], s17 offen
    buffer_load_dword v86, v12, s[20:23], s17 offen
    buffer_load_dword v87, v13, s[20:23], s17 offen
    s_waitcnt vmcnt(58)
    v_perm_b32 v5, v29, v28, s44
    v_perm_b32 v6, v29, v28, s45
    s_waitcnt vmcnt(56)
    v_perm_b32 v215, v31, v30, v11
    v_accvgpr_write_b32 a171, v5
    v_accvgpr_write_b32 a175, v6
    s_add_u32 s17, s49, 923904
    buffer_load_dword v88, v9, s[20:23], s17 offen
    buffer_load_dword v89, v10, s[20:23], s17 offen
    buffer_load_dword v90, v12, s[20:23], s17 offen
    buffer_load_dword v91, v13, s[20:23], s17 offen
    s_waitcnt vmcnt(58)
    v_perm_b32 v5, v33, v32, s44
    v_perm_b32 v6, v33, v32, s45
    s_waitcnt vmcnt(56)
    v_perm_b32 v216, v35, v34, v11
    v_accvgpr_write_b32 a176, v5
    v_accvgpr_write_b32 a180, v6
    s_add_u32 s17, s49, 925056
    buffer_load_dword v92, v9, s[20:23], s17 offen
    buffer_load_dword v93, v10, s[20:23], s17 offen
    buffer_load_dword v94, v12, s[20:23], s17 offen
    buffer_load_dword v95, v13, s[20:23], s17 offen
    s_waitcnt vmcnt(58)
    v_perm_b32 v5, v37, v36, s44
    v_perm_b32 v6, v37, v36, s45
    s_waitcnt vmcnt(56)
    v_perm_b32 v217, v39, v38, v11
    v_accvgpr_write_b32 a177, v5
    v_accvgpr_write_b32 a181, v6
    s_add_u32 s17, s49, 958464
    buffer_load_dword v96, v9, s[20:23], s17 offen
    buffer_load_dword v97, v10, s[20:23], s17 offen
    buffer_load_dword v98, v12, s[20:23], s17 offen
    buffer_load_dword v99, v13, s[20:23], s17 offen
    s_waitcnt vmcnt(58)
    v_perm_b32 v5, v41, v40, s44
    v_perm_b32 v6, v41, v40, s45
    s_waitcnt vmcnt(56)
    v_perm_b32 v218, v43, v42, v11
    v_accvgpr_write_b32 a178, v5
    v_accvgpr_write_b32 a182, v6
    s_add_u32 s17, s49, 959616
    buffer_load_dword v100, v9, s[20:23], s17 offen
    buffer_load_dword v101, v10, s[20:23], s17 offen
    buffer_load_dword v102, v12, s[20:23], s17 offen
    buffer_load_dword v103, v13, s[20:23], s17 offen
    s_waitcnt vmcnt(58)
    v_perm_b32 v5, v45, v44, s44
    v_perm_b32 v6, v45, v44, s45
    s_waitcnt vmcnt(56)
    v_perm_b32 v219, v47, v46, v11
    v_accvgpr_write_b32 a179, v5
    v_accvgpr_write_b32 a183, v6
    s_add_u32 s17, s49, 960768
    buffer_load_dword v104, v9, s[20:23], s17 offen
    buffer_load_dword v105, v10, s[20:23], s17 offen
    buffer_load_dword v106, v12, s[20:23], s17 offen
    buffer_load_dword v107, v13, s[20:23], s17 offen
    s_waitcnt vmcnt(58)
    v_perm_b32 v5, v49, v48, s44
    v_perm_b32 v6, v49, v48, s45
    s_waitcnt vmcnt(56)
    v_perm_b32 v220, v51, v50, v11
    v_accvgpr_write_b32 a184, v5
    v_accvgpr_write_b32 a188, v6
    s_add_u32 s17, s49, 961920
    buffer_load_dword v108, v9, s[20:23], s17 offen
    buffer_load_dword v109, v10, s[20:23], s17 offen
    buffer_load_dword v110, v12, s[20:23], s17 offen
    buffer_load_dword v111, v13, s[20:23], s17 offen
    s_waitcnt vmcnt(58)
    v_perm_b32 v5, v53, v52, s44
    v_perm_b32 v6, v53, v52, s45
    s_waitcnt vmcnt(56)
    v_perm_b32 v221, v55, v54, v11
    v_accvgpr_write_b32 a185, v5
    v_accvgpr_write_b32 a189, v6
    s_add_u32 s17, s49, 995328
    buffer_load_dword v112, v9, s[20:23], s17 offen
    buffer_load_dword v113, v10, s[20:23], s17 offen
    buffer_load_dword v114, v12, s[20:23], s17 offen
    buffer_load_dword v115, v13, s[20:23], s17 offen
    s_waitcnt vmcnt(58)
    v_perm_b32 v5, v57, v56, s44
    v_perm_b32 v6, v57, v56, s45
    s_waitcnt vmcnt(56)
    v_perm_b32 v222, v59, v58, v11
    v_accvgpr_write_b32 a186, v5
    v_accvgpr_write_b32 a190, v6
    s_add_u32 s17, s49, 996480
    buffer_load_dword v116, v9, s[20:23], s17 offen
    buffer_load_dword v117, v10, s[20:23], s17 offen
    buffer_load_dword v118, v12, s[20:23], s17 offen
    buffer_load_dword v119, v13, s[20:23], s17 offen
    s_waitcnt vmcnt(58)
    v_perm_b32 v5, v61, v60, s44
    v_perm_b32 v6, v61, v60, s45
    s_waitcnt vmcnt(56)
    v_perm_b32 v223, v63, v62, v11
    v_accvgpr_write_b32 a187, v5
    v_accvgpr_write_b32 a191, v6
    s_add_u32 s17, s49, 997632
    buffer_load_dword v120, v9, s[20:23], s17 offen
    buffer_load_dword v121, v10, s[20:23], s17 offen
    buffer_load_dword v122, v12, s[20:23], s17 offen
    buffer_load_dword v123, v13, s[20:23], s17 offen
    s_waitcnt vmcnt(58)
    v_perm_b32 v5, v65, v64, s44
    v_perm_b32 v6, v65, v64, s45
    s_waitcnt vmcnt(56)
    v_perm_b32 v224, v67, v66, v11
    v_accvgpr_write_b32 a192, v5
    v_accvgpr_write_b32 a196, v6
    s_add_u32 s17, s49, 998784
    buffer_load_dword v124, v9, s[20:23], s17 offen
    buffer_load_dword v125, v10, s[20:23], s17 offen
    buffer_load_dword v126, v12, s[20:23], s17 offen
    buffer_load_dword v127, v13, s[20:23], s17 offen
    s_waitcnt vmcnt(58)
    v_perm_b32 v5, v69, v68, s44
    v_perm_b32 v6, v69, v68, s45
    s_waitcnt vmcnt(56)
    v_perm_b32 v225, v71, v70, v11
    v_accvgpr_write_b32 a193, v5
    v_accvgpr_write_b32 a197, v6
    s_add_u32 s17, s49, 1032192
    buffer_load_dword v16, v9, s[20:23], s17 offen
    buffer_load_dword v17, v10, s[20:23], s17 offen
    buffer_load_dword v18, v12, s[20:23], s17 offen
    buffer_load_dword v19, v13, s[20:23], s17 offen
    s_waitcnt vmcnt(58)
    v_perm_b32 v5, v73, v72, s44
    v_perm_b32 v6, v73, v72, s45
    s_waitcnt vmcnt(56)
    v_perm_b32 v226, v75, v74, v11
    v_accvgpr_write_b32 a194, v5
    v_accvgpr_write_b32 a198, v6
    s_add_u32 s17, s49, 1033344
    buffer_load_dword v20, v9, s[20:23], s17 offen
    buffer_load_dword v21, v10, s[20:23], s17 offen
    buffer_load_dword v22, v12, s[20:23], s17 offen
    buffer_load_dword v23, v13, s[20:23], s17 offen
    s_waitcnt vmcnt(58)
    v_perm_b32 v5, v77, v76, s44
    v_perm_b32 v6, v77, v76, s45
    s_waitcnt vmcnt(56)
    v_perm_b32 v227, v79, v78, v11
    v_accvgpr_write_b32 a195, v5
    v_accvgpr_write_b32 a199, v6
    s_add_u32 s17, s49, 1034496
    buffer_load_dword v24, v9, s[20:23], s17 offen
    buffer_load_dword v25, v10, s[20:23], s17 offen
    buffer_load_dword v26, v12, s[20:23], s17 offen
    buffer_load_dword v27, v13, s[20:23], s17 offen
    s_waitcnt vmcnt(58)
    v_perm_b32 v5, v81, v80, s44
    v_perm_b32 v6, v81, v80, s45
    s_waitcnt vmcnt(56)
    v_perm_b32 v228, v83, v82, v11
    v_accvgpr_write_b32 a200, v5
    v_accvgpr_write_b32 a204, v6
    s_add_u32 s17, s49, 1035648
    buffer_load_dword v28, v9, s[20:23], s17 offen
    buffer_load_dword v29, v10, s[20:23], s17 offen
    buffer_load_dword v30, v12, s[20:23], s17 offen
    buffer_load_dword v31, v13, s[20:23], s17 offen
    s_waitcnt vmcnt(58)
    v_perm_b32 v5, v85, v84, s44
    v_perm_b32 v6, v85, v84, s45
    s_waitcnt vmcnt(56)
    v_perm_b32 v229, v87, v86, v11
    v_accvgpr_write_b32 a201, v5
    v_accvgpr_write_b32 a205, v6
    s_add_u32 s17, s49, 1069056
    buffer_load_dword v32, v9, s[20:23], s17 offen
    buffer_load_dword v33, v10, s[20:23], s17 offen
    buffer_load_dword v34, v12, s[20:23], s17 offen
    buffer_load_dword v35, v13, s[20:23], s17 offen
    s_waitcnt vmcnt(58)
    v_perm_b32 v5, v89, v88, s44
    v_perm_b32 v6, v89, v88, s45
    s_waitcnt vmcnt(56)
    v_perm_b32 v230, v91, v90, v11
    v_accvgpr_write_b32 a202, v5
    v_accvgpr_write_b32 a206, v6
    s_add_u32 s17, s49, 1070208
    buffer_load_dword v36, v9, s[20:23], s17 offen
    buffer_load_dword v37, v10, s[20:23], s17 offen
    buffer_load_dword v38, v12, s[20:23], s17 offen
    buffer_load_dword v39, v13, s[20:23], s17 offen
    s_waitcnt vmcnt(58)
    v_perm_b32 v5, v93, v92, s44
    v_perm_b32 v6, v93, v92, s45
    s_waitcnt vmcnt(56)
    v_perm_b32 v231, v95, v94, v11
    v_accvgpr_write_b32 a203, v5
    v_accvgpr_write_b32 a207, v6
    s_add_u32 s17, s49, 1071360
    buffer_load_dword v40, v9, s[20:23], s17 offen
    buffer_load_dword v41, v10, s[20:23], s17 offen
    buffer_load_dword v42, v12, s[20:23], s17 offen
    buffer_load_dword v43, v13, s[20:23], s17 offen
    s_waitcnt vmcnt(58)
    v_perm_b32 v5, v97, v96, s44
    v_perm_b32 v6, v97, v96, s45
    s_waitcnt vmcnt(56)
    v_perm_b32 v232, v99, v98, v11
    v_accvgpr_write_b32 a208, v5
    v_accvgpr_write_b32 a212, v6
    s_add_u32 s17, s49, 1072512
    buffer_load_dword v44, v9, s[20:23], s17 offen
    buffer_load_dword v45, v10, s[20:23], s17 offen
    buffer_load_dword v46, v12, s[20:23], s17 offen
    buffer_load_dword v47, v13, s[20:23], s17 offen
    s_waitcnt vmcnt(58)
    v_perm_b32 v5, v101, v100, s44
    v_perm_b32 v6, v101, v100, s45
    s_waitcnt vmcnt(56)
    v_perm_b32 v233, v103, v102, v11
    v_accvgpr_write_b32 a209, v5
    v_accvgpr_write_b32 a213, v6
    s_add_u32 s17, s49, 1105920
    buffer_load_dword v48, v9, s[20:23], s17 offen
    buffer_load_dword v49, v10, s[20:23], s17 offen
    buffer_load_dword v50, v12, s[20:23], s17 offen
    buffer_load_dword v51, v13, s[20:23], s17 offen
    s_waitcnt vmcnt(58)
    v_perm_b32 v5, v105, v104, s44
    v_perm_b32 v6, v105, v104, s45
    s_waitcnt vmcnt(56)
    v_perm_b32 v234, v107, v106, v11
    v_accvgpr_write_b32 a210, v5
    v_accvgpr_write_b32 a214, v6
    s_add_u32 s17, s49, 1107072
    buffer_load_dword v52, v9, s[20:23], s17 offen
    buffer_load_dword v53, v10, s[20:23], s17 offen
    buffer_load_dword v54, v12, s[20:23], s17 offen
    buffer_load_dword v55, v13, s[20:23], s17 offen
    s_waitcnt vmcnt(58)
    v_perm_b32 v5, v109, v108, s44
    v_perm_b32 v6, v109, v108, s45
    s_waitcnt vmcnt(56)
    v_perm_b32 v235, v111, v110, v11
    v_accvgpr_write_b32 a211, v5
    v_accvgpr_write_b32 a215, v6
    s_add_u32 s17, s49, 1108224
    buffer_load_dword v56, v9, s[20:23], s17 offen
    buffer_load_dword v57, v10, s[20:23], s17 offen
    buffer_load_dword v58, v12, s[20:23], s17 offen
    buffer_load_dword v59, v13, s[20:23], s17 offen
    s_waitcnt vmcnt(58)
    v_perm_b32 v5, v113, v112, s44
    v_perm_b32 v6, v113, v112, s45
    s_waitcnt vmcnt(56)
    v_perm_b32 v236, v115, v114, v11
    v_accvgpr_write_b32 a216, v5
    v_accvgpr_write_b32 a220, v6
    s_add_u32 s17, s49, 1109376
    buffer_load_dword v60, v9, s[20:23], s17 offen
    buffer_load_dword v61, v10, s[20:23], s17 offen
    buffer_load_dword v62, v12, s[20:23], s17 offen
    buffer_load_dword v63, v13, s[20:23], s17 offen
    s_waitcnt vmcnt(58)
    v_perm_b32 v5, v117, v116, s44
    v_perm_b32 v6, v117, v116, s45
    s_waitcnt vmcnt(56)
    v_perm_b32 v237, v119, v118, v11
    v_accvgpr_write_b32 a217, v5
    v_accvgpr_write_b32 a221, v6
    s_add_u32 s17, s49, 1142784
    buffer_load_dword v64, v9, s[20:23], s17 offen
    buffer_load_dword v65, v10, s[20:23], s17 offen
    buffer_load_dword v66, v12, s[20:23], s17 offen
    buffer_load_dword v67, v13, s[20:23], s17 offen
    s_waitcnt vmcnt(58)
    v_perm_b32 v5, v121, v120, s44
    v_perm_b32 v6, v121, v120, s45
    s_waitcnt vmcnt(56)
    v_perm_b32 v238, v123, v122, v11
    v_accvgpr_write_b32 a218, v5
    v_accvgpr_write_b32 a222, v6
    s_add_u32 s17, s49, 1143936
    buffer_load_dword v68, v9, s[20:23], s17 offen
    buffer_load_dword v69, v10, s[20:23], s17 offen
    buffer_load_dword v70, v12, s[20:23], s17 offen
    buffer_load_dword v71, v13, s[20:23], s17 offen
    s_waitcnt vmcnt(58)
    v_perm_b32 v5, v125, v124, s44
    v_perm_b32 v6, v125, v124, s45
    s_waitcnt vmcnt(56)
    v_perm_b32 v239, v127, v126, v11
    v_accvgpr_write_b32 a219, v5
    v_accvgpr_write_b32 a223, v6
    s_add_u32 s17, s49, 1145088
    buffer_load_dword v72, v9, s[20:23], s17 offen
    buffer_load_dword v73, v10, s[20:23], s17 offen
    buffer_load_dword v74, v12, s[20:23], s17 offen
    buffer_load_dword v75, v13, s[20:23], s17 offen
    s_waitcnt vmcnt(58)
    v_perm_b32 v5, v17, v16, s44
    v_perm_b32 v6, v17, v16, s45
    s_waitcnt vmcnt(56)
    v_perm_b32 v240, v19, v18, v11
    v_accvgpr_write_b32 a224, v5
    v_accvgpr_write_b32 a228, v6
    s_add_u32 s17, s49, 1146240
    buffer_load_dword v76, v9, s[20:23], s17 offen
    buffer_load_dword v77, v10, s[20:23], s17 offen
    buffer_load_dword v78, v12, s[20:23], s17 offen
    buffer_load_dword v79, v13, s[20:23], s17 offen
    s_waitcnt vmcnt(58)
    v_perm_b32 v5, v21, v20, s44
    v_perm_b32 v6, v21, v20, s45
    s_waitcnt vmcnt(56)
    v_perm_b32 v241, v23, v22, v11
    v_accvgpr_write_b32 a225, v5
    v_accvgpr_write_b32 a229, v6
    s_waitcnt vmcnt(54)
    v_perm_b32 v5, v25, v24, s44
    v_perm_b32 v6, v25, v24, s45
    s_waitcnt vmcnt(52)
    v_perm_b32 v242, v27, v26, v11
    v_accvgpr_write_b32 a226, v5
    v_accvgpr_write_b32 a230, v6
    s_waitcnt vmcnt(50)
    v_perm_b32 v5, v29, v28, s44
    v_perm_b32 v6, v29, v28, s45
    s_waitcnt vmcnt(48)
    v_perm_b32 v243, v31, v30, v11
    v_accvgpr_write_b32 a227, v5
    v_accvgpr_write_b32 a231, v6
    s_waitcnt vmcnt(46)
    v_perm_b32 v5, v33, v32, s44
    v_perm_b32 v6, v33, v32, s45
    s_waitcnt vmcnt(44)
    v_perm_b32 v244, v35, v34, v11
    v_accvgpr_write_b32 a232, v5
    v_accvgpr_write_b32 a236, v6
    s_waitcnt vmcnt(42)
    v_perm_b32 v5, v37, v36, s44
    v_perm_b32 v6, v37, v36, s45
    s_waitcnt vmcnt(40)
    v_perm_b32 v245, v39, v38, v11
    v_accvgpr_write_b32 a233, v5
    v_accvgpr_write_b32 a237, v6
    s_waitcnt vmcnt(38)
    v_perm_b32 v5, v41, v40, s44
    v_perm_b32 v6, v41, v40, s45
    s_waitcnt vmcnt(36)
    v_perm_b32 v246, v43, v42, v11
    v_accvgpr_write_b32 a234, v5
    v_accvgpr_write_b32 a238, v6
    s_waitcnt vmcnt(34)
    v_perm_b32 v5, v45, v44, s44
    v_perm_b32 v6, v45, v44, s45
    s_waitcnt vmcnt(32)
    v_perm_b32 v247, v47, v46, v11
    v_accvgpr_write_b32 a235, v5
    v_accvgpr_write_b32 a239, v6
    s_waitcnt vmcnt(30)
    v_perm_b32 v5, v49, v48, s44
    v_perm_b32 v6, v49, v48, s45
    s_waitcnt vmcnt(28)
    v_perm_b32 v248, v51, v50, v11
    v_accvgpr_write_b32 a240, v5
    v_accvgpr_write_b32 a244, v6
    s_waitcnt vmcnt(26)
    v_perm_b32 v5, v53, v52, s44
    v_perm_b32 v6, v53, v52, s45
    s_waitcnt vmcnt(24)
    v_perm_b32 v249, v55, v54, v11
    v_accvgpr_write_b32 a241, v5
    v_accvgpr_write_b32 a245, v6
    s_waitcnt vmcnt(22)
    v_perm_b32 v5, v57, v56, s44
    v_perm_b32 v6, v57, v56, s45
    s_waitcnt vmcnt(20)
    v_perm_b32 v250, v59, v58, v11
    v_accvgpr_write_b32 a242, v5
    v_accvgpr_write_b32 a246, v6
    s_waitcnt vmcnt(18)
    v_perm_b32 v5, v61, v60, s44
    v_perm_b32 v6, v61, v60, s45
    s_waitcnt vmcnt(16)
    v_perm_b32 v251, v63, v62, v11
    v_accvgpr_write_b32 a243, v5
    v_accvgpr_write_b32 a247, v6
    s_waitcnt vmcnt(14)
    v_perm_b32 v5, v65, v64, s44
    v_perm_b32 v6, v65, v64, s45
    s_waitcnt vmcnt(12)
    v_perm_b32 v252, v67, v66, v11
    v_accvgpr_write_b32 a248, v5
    v_accvgpr_write_b32 a252, v6
    s_waitcnt vmcnt(10)
    v_perm_b32 v5, v69, v68, s44
    v_perm_b32 v6, v69, v68, s45
    s_waitcnt vmcnt(8)
    v_perm_b32 v253, v71, v70, v11
    v_accvgpr_write_b32 a249, v5
    v_accvgpr_write_b32 a253, v6
    s_waitcnt vmcnt(6)
    v_perm_b32 v5, v73, v72, s44
    v_perm_b32 v6, v73, v72, s45
    s_waitcnt vmcnt(4)
    v_perm_b32 v254, v75, v74, v11
    v_accvgpr_write_b32 a250, v5
    v_accvgpr_write_b32 a254, v6
    s_waitcnt vmcnt(2)
    v_perm_b32 v5, v77, v76, s44
    v_perm_b32 v6, v77, v76, s45
    s_waitcnt vmcnt(0)
    v_perm_b32 v255, v79, v78, v11
    v_accvgpr_write_b32 a251, v5
    v_accvgpr_write_b32 a255, v6
    s_and_b32 s51, s14, 1
    s_lshl_b32 s17, s51, 4
    v_add_u32 v5, s17, v7
    v_lshlrev_b32 v14, 4, v5
    v_mul_u32_u24 v13, 1152, v5
    s_mul_i32 s17, s50, 96
    v_add_u32 v13, s17, v13
    s_mul_i32 s17, s50, 3072
    v_add_u32 v12, s17, v14
    s_lshl_b32 s17, s50, 9
    v_add_u32 v14, s17, v14
    s_lshl_b32 s49, s50, 7
    s_lshl_b32 s17, s14, 2
    s_add_u32 s49, s49, s17
    s_add_u32 s49, s49, 1622016
    s_mul_i32 s17, s14, 6144
    v_add_u32 v48, s17, v0
    v_mov_b32 v49, 0x10000
    v_lshrrev_b32 v51, 4, v0
    v_min_u32 v51, 42, v51
    s_mul_i32 s17, s50, 43
    v_add_u32 v51, s17, v51
    v_lshlrev_b32 v51, 7, v51
    s_cmp_gt_u32 s14, 1
    s_cbranch_scc1 Ltw_z
    v_lshl_add_u32 v12, v8, 9, v12
    v_lshl_add_u32 v13, v8, 4, v13
    s_lshl_b32 s58, s14, 16
    s_add_u32 s58, s58, 144703488
    s_mov_b32 s43, 0
    s_mov_b32 s28, s8
    s_mov_b32 s29, s9
    s_mov_b32 s30, 0
    s_mov_b32 s31, 0x00020000
    s_mul_i32 s17, s51, 3072
    v_add_u32 v50, s17, v0
    ds_write2_b32 v49, v4, v4 offset0:0 offset1:1
    s_waitcnt lgkmcnt(0)
    s_cmp_lg_u32 s14, 0
    s_cbranch_scc1 LtwX_ini_d
    v_mov_b32 v5, 160
    s_mov_b32 s16, 0
LtwX_ini:
    global_load_dword v6, v5, s[12:13] sc1
    s_add_u32 s16, s16, 1
    s_cmp_gt_u32 s16, 100000
    s_cbranch_scc1 L_role_tw_abort
    s_waitcnt vmcnt(0)
    v_cmp_gt_u32 vcc, 123, v6
    s_nop 0
    s_cbranch_vccz LtwX_ini_d
    s_sleep 8
    s_branch LtwX_ini
LtwX_ini_d:
    s_barrier
LtwX_idle:
    s_cmp_lg_u32 s14, 0
    s_cbranch_scc1 LtwX_nw0
    s_mul_i32 s60, s32, 22528
    s_add_u32 s60, s60, 184448
    s_cmp_lt_u32 s32, 64
    s_cselect_b32 s60, s60, 3080192
    s_mul_i32 s61, s33, 22528
    s_add_u32 s61, s61, 1626240
    s_cmp_lt_u32 s33, 64
    s_cselect_b32 s61, s61, 3080192
    s_mov_b32 s16, 0
LtwX_p_1:
    buffer_load_dword v2, v1, s[8:11], s60 offen sc1
    buffer_load_dword v15, v1, s[8:11], s61 offen sc1
    s_add_u32 s16, s16, 1
    s_cmp_gt_u32 s16, 100000
    s_cbranch_scc1 L_role_tw_abort
    s_waitcnt vmcnt(1)
    v_cmp_eq_u32 vcc, 0, v2
    s_waitcnt vmcnt(0)
    v_cmp_eq_u32 s[54:55], 0, v15
    s_nop 0
    s_cmp_eq_u64 s[54:55], 0
    s_cselect_b32 s62, 2, 0
    s_cmp_eq_u64 vcc, 0
    s_cselect_b32 s62, 1, s62
    s_cmp_lg_u32 s62, 0
    s_cbranch_scc1 LtwX_p_1d
    s_sleep 4
    s_branch LtwX_p_1
LtwX_p_1d:
    v_mov_b32 v5, s62
    ds_write_b32 v49, v5
    s_waitcnt lgkmcnt(0)
LtwX_nw0:
    s_barrier
    ds_read_b32 v6, v49
    v_xor_b32 v49, 4, v49
    s_waitcnt lgkmcnt(0)
    v_readfirstlane_b32 s62, v6
    s_nop 0
    s_cmp_eq_u32 s62, 0
    s_cbranch_scc1 L_role_tw_abort
    s_cmp_lt_u32 s33, 33
    s_cselect_b32 s38, 1, 3
    s_cmp_eq_u32 s62, 2
    s_cselect_b32 s36, 1, 0
    s_cselect_b32 s37, s33, s32
    s_cselect_b32 s17, s38, 0
    s_add_u32 s33, s33, s17
    s_cmp_eq_u32 s62, 1
    s_cselect_b32 s17, 2, 0
    s_add_u32 s32, s32, s17
    s_lshl_b32 s56, s36, 6
    s_add_u32 s56, s56, s37
    s_lshl_b32 s46, s56, 18
    s_add_u32 s46, s46, s58
    s_mul_i32 s41, s36, 4718592
    s_mul_i32 s17, s37, 36864
    s_add_u32 s41, s41, s17
    s_add_u32 s41, s41, 8650752
    s_cmp_ge_u32 s37, 64
    s_cbranch_scc1 L_role_tw_abort
    buffer_load_dword v10, v51, s[8:11], s46 offen
    s_add_u32 s48, s46, 0
    buffer_load_dwordx4 v[64:67], v0, s[8:11], s48 offen offset:0
    buffer_load_dwordx4 v[68:71], v0, s[8:11], s48 offen offset:1024
    buffer_load_dwordx4 v[72:75], v0, s[8:11], s48 offen offset:2048
    buffer_load_dwordx4 v[76:79], v0, s[8:11], s48 offen offset:3072
    s_add_u32 s48, s46, 4096
    buffer_load_dwordx4 v[80:83], v0, s[8:11], s48 offen offset:0
    buffer_load_dwordx4 v[84:87], v0, s[8:11], s48 offen offset:1024
    buffer_load_dwordx4 v[88:91], v0, s[8:11], s48 offen offset:2048
    buffer_load_dwordx4 v[92:95], v0, s[8:11], s48 offen offset:3072
    s_add_u32 s48, s46, 8192
    buffer_load_dwordx4 v[96:99], v0, s[8:11], s48 offen offset:0
    buffer_load_dwordx4 v[100:103], v0, s[8:11], s48 offen offset:1024
    buffer_load_dwordx4 v[104:107], v0, s[8:11], s48 offen offset:2048
    buffer_load_dwordx4 v[108:111], v0, s[8:11], s48 offen offset:3072
    s_add_u32 s48, s46, 12288
    buffer_load_dwordx4 v[112:115], v0, s[8:11], s48 offen offset:0
    buffer_load_dwordx4 v[116:119], v0, s[8:11], s48 offen offset:1024
    buffer_load_dwordx4 v[120:123], v0, s[8:11], s48 offen offset:2048
    buffer_load_dwordx4 v[40:43], v12, s[8:11], s41 offen
LtwX_item:
    s_mov_b32 s34, s36
    s_mov_b32 s35, s37
    s_mov_b32 s47, s41
    buffer_load_dwordx4 v[124:127], v0, s[8:11], s48 offen offset:3072
    s_waitcnt vmcnt(16)
    v_mfma_f32_16x16x32_bf16 v[16:19], a[0:3], v[64:67], 0
    v_mfma_f32_16x16x32_bf16 v[20:23], a[4:7], v[64:67], 0
    v_mfma_f32_16x16x32_bf16 v[24:27], v[128:131], v[64:67], 0
    s_add_u32 s48, s46, 16384
    buffer_load_dwordx4 v[64:67], v0, s[8:11], s48 offen offset:0
    s_waitcnt vmcnt(16)
    v_mfma_f32_16x16x32_bf16 v[28:31], a[0:3], v[68:71], 0
    v_mfma_f32_16x16x32_bf16 v[32:35], a[4:7], v[68:71], 0
    v_mfma_f32_16x16x32_bf16 v[36:39], v[128:131], v[68:71], 0
    buffer_load_dwordx4 v[68:71], v0, s[8:11], s48 offen offset:1024
    s_waitcnt vmcnt(16)
    v_mfma_f32_16x16x32_bf16 v[16:19], a[8:11], v[72:75], v[16:19]
    v_mfma_f32_16x16x32_bf16 v[20:23], a[12:15], v[72:75], v[20:23]
    v_mfma_f32_16x16x32_bf16 v[24:27], v[132:135], v[72:75], v[24:27]
    buffer_load_dwordx4 v[72:75], v0, s[8:11], s48 offen offset:2048
    s_waitcnt vmcnt(16)
    v_mfma_f32_16x16x32_bf16 v[28:31], a[8:11], v[76:79], v[28:31]
    v_mfma_f32_16x16x32_bf16 v[32:35], a[12:15], v[76:79], v[32:35]
    v_mfma_f32_16x16x32_bf16 v[36:39], v[132:135], v[76:79], v[36:39]
    buffer_load_dwordx4 v[76:79], v0, s[8:11], s48 offen offset:3072
    s_waitcnt vmcnt(16)
    v_mfma_f32_16x16x32_bf16 v[16:19], a[16:19], v[80:83], v[16:19]
    v_mfma_f32_16x16x32_bf16 v[20:23], a[20:23], v[80:83], v[20:23]
    v_mfma_f32_16x16x32_bf16 v[24:27], v[136:139], v[80:83], v[24:27]
    s_add_u32 s48, s46, 20480
    buffer_load_dwordx4 v[80:83], v0, s[8:11], s48 offen offset:0
    s_waitcnt vmcnt(16)
    v_mfma_f32_16x16x32_bf16 v[28:31], a[16:19], v[84:87], v[28:31]
    v_mfma_f32_16x16x32_bf16 v[32:35], a[20:23], v[84:87], v[32:35]
    v_mfma_f32_16x16x32_bf16 v[36:39], v[136:139], v[84:87], v[36:39]
    buffer_load_dwordx4 v[84:87], v0, s[8:11], s48 offen offset:1024
    s_waitcnt vmcnt(16)
    v_mfma_f32_16x16x32_bf16 v[16:19], a[24:27], v[88:91], v[16:19]
    v_mfma_f32_16x16x32_bf16 v[20:23], a[28:31], v[88:91], v[20:23]
    v_mfma_f32_16x16x32_bf16 v[24:27], v[140:143], v[88:91], v[24:27]
    buffer_load_dwordx4 v[88:91], v0, s[8:11], s48 offen offset:2048
    s_waitcnt vmcnt(16)
    v_mfma_f32_16x16x32_bf16 v[28:31], a[24:27], v[92:95], v[28:31]
    v_mfma_f32_16x16x32_bf16 v[32:35], a[28:31], v[92:95], v[32:35]
    v_mfma_f32_16x16x32_bf16 v[36:39], v[140:143], v[92:95], v[36:39]
    buffer_load_dwordx4 v[92:95], v0, s[8:11], s48 offen offset:3072
    s_waitcnt vmcnt(16)
    v_mfma_f32_16x16x32_bf16 v[16:19], a[32:35], v[96:99], v[16:19]
    v_mfma_f32_16x16x32_bf16 v[20:23], a[36:39], v[96:99], v[20:23]
    v_mfma_f32_16x16x32_bf16 v[24:27], v[144:147], v[96:99], v[24:27]
    s_add_u32 s48, s46, 24576
    buffer_load_dwordx4 v[96:99], v0, s[8:11], s48 offen offset:0
    s_waitcnt vmcnt(16)
    v_mfma_f32_16x16x32_bf16 v[28:31], a[32:35], v[100:103], v[28:31]
    v_mfma_f32_16x16x32_bf16 v[32:35], a[36:39], v[100:103], v[32:35]
    v_mfma_f32_16x16x32_bf16 v[36:39], v[144:147], v[100:103], v[36:39]
    buffer_load_dwordx4 v[100:103], v0, s[8:11], s48 offen offset:1024
    s_waitcnt vmcnt(16)
    v_mfma_f32_16x16x32_bf16 v[16:19], a[40:43], v[104:107], v[16:19]
    v_mfma_f32_16x16x32_bf16 v[20:23], a[44:47], v[104:107], v[20:23]
    v_mfma_f32_16x16x32_bf16 v[24:27], v[148:151], v[104:107], v[24:27]
    buffer_load_dwordx4 v[104:107], v0, s[8:11], s48 offen offset:2048
    s_waitcnt vmcnt(16)
    v_mfma_f32_16x16x32_bf16 v[28:31], a[40:43], v[108:111], v[28:31]
    v_mfma_f32_16x16x32_bf16 v[32:35], a[44:47], v[108:111], v[32:35]
    v_mfma_f32_16x16x32_bf16 v[36:39], v[148:151], v[108:111], v[36:39]
    buffer_load_dwordx4 v[108:111], v0, s[8:11], s48 offen offset:3072
    s_waitcnt vmcnt(16)
    v_mfma_f32_16x16x32_bf16 v[16:19], a[48:51], v[112:115], v[16:19]
    v_mfma_f32_16x16x32_bf16 v[20:23], a[52:55], v[112:115], v[20:23]
    v_mfma_f32_16x16x32_bf16 v[24:27], v[152:155], v[112:115], v[24:27]
    s_add_u32 s48, s46, 28672
    buffer_load_dwordx4 v[112:115], v0, s[8:11], s48 offen offset:0
    s_waitcnt vmcnt(16)
    v_mfma_f32_16x16x32_bf16 v[28:31], a[48:51], v[116:119], v[28:31]
    v_mfma_f32_16x16x32_bf16 v[32:35], a[52:55], v[116:119], v[32:35]
    v_mfma_f32_16x16x32_bf16 v[36:39], v[152:155], v[116:119], v[36:39]
    buffer_load_dwordx4 v[116:119], v0, s[8:11], s48 offen offset:1024
    s_waitcnt vmcnt(16)
    v_mfma_f32_16x16x32_bf16 v[16:19], a[56:59], v[120:123], v[16:19]
    v_mfma_f32_16x16x32_bf16 v[20:23], a[60:63], v[120:123], v[20:23]
    v_mfma_f32_16x16x32_bf16 v[24:27], v[156:159], v[120:123], v[24:27]
    buffer_load_dwordx4 v[120:123], v0, s[8:11], s48 offen offset:2048
    s_waitcnt vmcnt(15)
    v_mfma_f32_16x16x32_bf16 v[28:31], a[56:59], v[124:127], v[28:31]
    v_mfma_f32_16x16x32_bf16 v[32:35], a[60:63], v[124:127], v[32:35]
    v_mfma_f32_16x16x32_bf16 v[36:39], v[156:159], v[124:127], v[36:39]
    buffer_load_dwordx4 v[124:127], v0, s[8:11], s48 offen offset:3072
    s_waitcnt vmcnt(15)
    v_mfma_f32_16x16x32_bf16 v[16:19], a[64:67], v[64:67], v[16:19]
    v_mfma_f32_16x16x32_bf16 v[20:23], a[68:71], v[64:67], v[20:23]
    v_mfma_f32_16x16x32_bf16 v[24:27], v[160:163], v[64:67], v[24:27]
    s_add_u32 s48, s46, 32768
    buffer_load_dwordx4 v[64:67], v0, s[8:11], s48 offen offset:0
    s_waitcnt vmcnt(15)
    v_mfma_f32_16x16x32_bf16 v[28:31], a[64:67], v[68:71], v[28:31]
    v_mfma_f32_16x16x32_bf16 v[32:35], a[68:71], v[68:71], v[32:35]
    v_mfma_f32_16x16x32_bf16 v[36:39], v[160:163], v[68:71], v[36:39]
    s_cmp_lg_u32 s43, 0
    s_cselect_b64 exec, 1, 0
    buffer_store_dword v3, v4, s[8:11], s43 offen sc1
    s_mov_b64 exec, -1
    s_mov_b32 s43, 0
    buffer_load_dwordx4 v[68:71], v0, s[8:11], s48 offen offset:1024
    s_waitcnt vmcnt(16)
    v_mfma_f32_16x16x32_bf16 v[16:19], a[72:75], v[72:75], v[16:19]
    v_mfma_f32_16x16x32_bf16 v[20:23], a[76:79], v[72:75], v[20:23]
    v_mfma_f32_16x16x32_bf16 v[24:27], v[164:167], v[72:75], v[24:27]
    buffer_load_dwordx4 v[72:75], v0, s[8:11], s48 offen offset:2048
    s_waitcnt vmcnt(16)
    v_mfma_f32_16x16x32_bf16 v[28:31], a[72:75], v[76:79], v[28:31]
    v_mfma_f32_16x16x32_bf16 v[32:35], a[76:79], v[76:79], v[32:35]
    v_mfma_f32_16x16x32_bf16 v[36:39], v[164:167], v[76:79], v[36:39]
    buffer_load_dwordx4 v[76:79], v0, s[8:11], s48 offen offset:3072
    s_waitcnt vmcnt(16)
    v_mfma_f32_16x16x32_bf16 v[16:19], a[80:83], v[80:83], v[16:19]
    v_mfma_f32_16x16x32_bf16 v[20:23], a[84:87], v[80:83], v[20:23]
    v_mfma_f32_16x16x32_bf16 v[24:27], v[168:171], v[80:83], v[24:27]
    s_add_u32 s48, s46, 36864
    buffer_load_dwordx4 v[80:83], v0, s[8:11], s48 offen offset:0
    s_waitcnt vmcnt(16)
    v_mfma_f32_16x16x32_bf16 v[28:31], a[80:83], v[84:87], v[28:31]
    v_mfma_f32_16x16x32_bf16 v[32:35], a[84:87], v[84:87], v[32:35]
    v_mfma_f32_16x16x32_bf16 v[36:39], v[168:171], v[84:87], v[36:39]
    buffer_load_dwordx4 v[84:87], v0, s[8:11], s48 offen offset:1024
    s_waitcnt vmcnt(16)
    v_mfma_f32_16x16x32_bf16 v[16:19], a[88:91], v[88:91], v[16:19]
    v_mfma_f32_16x16x32_bf16 v[20:23], a[92:95], v[88:91], v[20:23]
    v_mfma_f32_16x16x32_bf16 v[24:27], v[172:175], v[88:91], v[24:27]
    buffer_load_dwordx4 v[88:91], v0, s[8:11], s48 offen offset:2048
    s_waitcnt vmcnt(16)
    v_mfma_f32_16x16x32_bf16 v[28:31], a[88:91], v[92:95], v[28:31]
    v_mfma_f32_16x16x32_bf16 v[32:35], a[92:95], v[92:95], v[32:35]
    v_mfma_f32_16x16x32_bf16 v[36:39], v[172:175], v[92:95], v[36:39]
    buffer_load_dwordx4 v[92:95], v0, s[8:11], s48 offen offset:3072
    s_waitcnt vmcnt(16)
    v_mfma_f32_16x16x32_bf16 v[16:19], a[96:99], v[96:99], v[16:19]
    v_mfma_f32_16x16x32_bf16 v[20:23], a[100:103], v[96:99], v[20:23]
    v_mfma_f32_16x16x32_bf16 v[24:27], v[176:179], v[96:99], v[24:27]
    s_add_u32 s48, s46, 40960
    buffer_load_dwordx4 v[96:99], v0, s[8:11], s48 offen offset:0
    s_waitcnt vmcnt(16)
    v_mfma_f32_16x16x32_bf16 v[28:31], a[96:99], v[100:103], v[28:31]
    v_mfma_f32_16x16x32_bf16 v[32:35], a[100:103], v[100:103], v[32:35]
    v_mfma_f32_16x16x32_bf16 v[36:39], v[176:179], v[100:103], v[36:39]
    buffer_load_dwordx4 v[100:103], v0, s[8:11], s48 offen offset:1024
    s_waitcnt vmcnt(16)
    v_mfma_f32_16x16x32_bf16 v[16:19], a[104:107], v[104:107], v[16:19]
    v_mfma_f32_16x16x32_bf16 v[20:23], a[108:111], v[104:107], v[20:23]
    v_mfma_f32_16x16x32_bf16 v[24:27], v[180:183], v[104:107], v[24:27]
    s_cmp_lg_u32 s14, 0
    s_cbranch_scc1 LtwX_nw1
    s_mul_i32 s60, s32, 22528
    s_add_u32 s60, s60, 184448
    s_cmp_lt_u32 s32, 64
    s_cselect_b32 s60, s60, 3080192
    s_mul_i32 s61, s33, 22528
    s_add_u32 s61, s61, 1626240
    s_cmp_lt_u32 s33, 64
    s_cselect_b32 s61, s61, 3080192
    buffer_load_dword v2, v1, s[8:11], s60 offen sc1
    buffer_load_dword v15, v1, s[8:11], s61 offen sc1
LtwX_nw1:
    buffer_load_dwordx4 v[104:107], v0, s[8:11], s48 offen offset:2048
    s_waitcnt vmcnt(16)
    v_mfma_f32_16x16x32_bf16 v[28:31], a[104:107], v[108:111], v[28:31]
    v_mfma_f32_16x16x32_bf16 v[32:35], a[108:111], v[108:111], v[32:35]
    v_mfma_f32_16x16x32_bf16 v[36:39], v[180:183], v[108:111], v[36:39]
    buffer_load_dwordx4 v[108:111], v0, s[8:11], s48 offen offset:3072
    s_waitcnt vmcnt(16)
    v_mfma_f32_16x16x32_bf16 v[16:19], a[112:115], v[112:115], v[16:19]
    v_mfma_f32_16x16x32_bf16 v[20:23], a[116:119], v[112:115], v[20:23]
    v_mfma_f32_16x16x32_bf16 v[24:27], v[184:187], v[112:115], v[24:27]
    s_add_u32 s48, s46, 45056
    buffer_load_dwordx4 v[112:115], v0, s[8:11], s48 offen offset:0
    s_waitcnt vmcnt(16)
    v_mfma_f32_16x16x32_bf16 v[28:31], a[112:115], v[116:119], v[28:31]
    v_mfma_f32_16x16x32_bf16 v[32:35], a[116:119], v[116:119], v[32:35]
    v_mfma_f32_16x16x32_bf16 v[36:39], v[184:187], v[116:119], v[36:39]
    buffer_load_dwordx4 v[116:119], v0, s[8:11], s48 offen offset:1024
    s_waitcnt vmcnt(16)
    v_mfma_f32_16x16x32_bf16 v[16:19], a[120:123], v[120:123], v[16:19]
    v_mfma_f32_16x16x32_bf16 v[20:23], a[124:127], v[120:123], v[20:23]
    v_mfma_f32_16x16x32_bf16 v[24:27], v[188:191], v[120:123], v[24:27]
    buffer_load_dwordx4 v[120:123], v0, s[8:11], s48 offen offset:2048
    s_waitcnt vmcnt(16)
    v_mfma_f32_16x16x32_bf16 v[28:31], a[120:123], v[124:127], v[28:31]
    v_mfma_f32_16x16x32_bf16 v[32:35], a[124:127], v[124:127], v[32:35]
    v_mfma_f32_16x16x32_bf16 v[36:39], v[188:191], v[124:127], v[36:39]
    buffer_load_dwordx4 v[124:127], v0, s[8:11], s48 offen offset:3072
    s_waitcnt vmcnt(16)
    v_mfma_f32_16x16x32_bf16 v[16:19], a[128:131], v[64:67], v[16:19]
    v_mfma_f32_16x16x32_bf16 v[20:23], a[132:135], v[64:67], v[20:23]
    v_mfma_f32_16x16x32_bf16 v[24:27], v[192:195], v[64:67], v[24:27]
    s_add_u32 s48, s46, 49152
    buffer_load_dwordx4 v[64:67], v0, s[8:11], s48 offen offset:0
    s_waitcnt vmcnt(15)
    v_mfma_f32_16x16x32_bf16 v[28:31], a[128:131], v[68:71], v[28:31]
    v_mfma_f32_16x16x32_bf16 v[32:35], a[132:135], v[68:71], v[32:35]
    v_mfma_f32_16x16x32_bf16 v[36:39], v[192:195], v[68:71], v[36:39]
    buffer_load_dwordx4 v[68:71], v0, s[8:11], s48 offen offset:1024
    s_waitcnt vmcnt(15)
    v_mfma_f32_16x16x32_bf16 v[16:19], a[136:139], v[72:75], v[16:19]
    v_mfma_f32_16x16x32_bf16 v[20:23], a[140:143], v[72:75], v[20:23]
    v_mfma_f32_16x16x32_bf16 v[24:27], v[196:199], v[72:75], v[24:27]
    buffer_load_dwordx4 v[72:75], v0, s[8:11], s48 offen offset:2048
    s_waitcnt vmcnt(15)
    v_mfma_f32_16x16x32_bf16 v[28:31], a[136:139], v[76:79], v[28:31]
    v_mfma_f32_16x16x32_bf16 v[32:35], a[140:143], v[76:79], v[32:35]
    v_mfma_f32_16x16x32_bf16 v[36:39], v[196:199], v[76:79], v[36:39]
    buffer_load_dwordx4 v[76:79], v0, s[8:11], s48 offen offset:3072
    s_waitcnt vmcnt(15)
    v_mfma_f32_16x16x32_bf16 v[16:19], a[144:147], v[80:83], v[16:19]
    v_mfma_f32_16x16x32_bf16 v[20:23], a[148:151], v[80:83], v[20:23]
    v_mfma_f32_16x16x32_bf16 v[24:27], v[200:203], v[80:83], v[24:27]
    s_add_u32 s48, s46, 53248
    buffer_load_dwordx4 v[80:83], v0, s[8:11], s48 offen offset:0
    s_waitcnt vmcnt(15)
    v_mfma_f32_16x16x32_bf16 v[28:31], a[144:147], v[84:87], v[28:31]
    v_mfma_f32_16x16x32_bf16 v[32:35], a[148:151], v[84:87], v[32:35]
    v_mfma_f32_16x16x32_bf16 v[36:39], v[200:203], v[84:87], v[36:39]
    buffer_load_dwordx4 v[84:87], v0, s[8:11], s48 offen offset:1024
    s_waitcnt vmcnt(15)
    v_mfma_f32_16x16x32_bf16 v[16:19], a[152:155], v[88:91], v[16:19]
    v_mfma_f32_16x16x32_bf16 v[20:23], a[156:159], v[88:91], v[20:23]
    v_mfma_f32_16x16x32_bf16 v[24:27], v[204:207], v[88:91], v[24:27]
    buffer_load_dwordx4 v[88:91], v0, s[8:11], s48 offen offset:2048
    s_waitcnt vmcnt(15)
    v_mfma_f32_16x16x32_bf16 v[28:31], a[152:155], v[92:95], v[28:31]
    v_mfma_f32_16x16x32_bf16 v[32:35], a[156:159], v[92:95], v[32:35]
    v_mfma_f32_16x16x32_bf16 v[36:39], v[204:207], v[92:95], v[36:39]
    buffer_load_dwordx4 v[92:95], v0, s[8:11], s48 offen offset:3072
    s_waitcnt vmcnt(15)
    v_mfma_f32_16x16x32_bf16 v[16:19], a[160:163], v[96:99], v[16:19]
    v_mfma_f32_16x16x32_bf16 v[20:23], a[164:167], v[96:99], v[20:23]
    v_mfma_f32_16x16x32_bf16 v[24:27], v[208:211], v[96:99], v[24:27]
    s_add_u32 s48, s46, 57344
    buffer_load_dwordx4 v[96:99], v0, s[8:11], s48 offen offset:0
    s_waitcnt vmcnt(15)
    v_mfma_f32_16x16x32_bf16 v[28:31], a[160:163], v[100:103], v[28:31]
    v_mfma_f32_16x16x32_bf16 v[32:35], a[164:167], v[100:103], v[32:35]
    v_mfma_f32_16x16x32_bf16 v[36:39], v[208:211], v[100:103], v[36:39]
    buffer_load_dwordx4 v[100:103], v0, s[8:11], s48 offen offset:1024
    s_waitcnt vmcnt(15)
    v_mfma_f32_16x16x32_bf16 v[16:19], a[168:171], v[104:107], v[16:19]
    v_mfma_f32_16x16x32_bf16 v[20:23], a[172:175], v[104:107], v[20:23]
    v_mfma_f32_16x16x32_bf16 v[24:27], v[212:215], v[104:107], v[24:27]
    buffer_load_dwordx4 v[104:107], v0, s[8:11], s48 offen offset:2048
    s_waitcnt vmcnt(15)
    v_mfma_f32_16x16x32_bf16 v[28:31], a[168:171], v[108:111], v[28:31]
    v_mfma_f32_16x16x32_bf16 v[32:35], a[172:175], v[108:111], v[32:35]
    v_mfma_f32_16x16x32_bf16 v[36:39], v[212:215], v[108:111], v[36:39]
    buffer_load_dwordx4 v[108:111], v0, s[8:11], s48 offen offset:3072
    s_waitcnt vmcnt(15)
    v_mfma_f32_16x16x32_bf16 v[16:19], a[176:179], v[112:115], v[16:19]
    v_mfma_f32_16x16x32_bf16 v[20:23], a[180:183], v[112:115], v[20:23]
    v_mfma_f32_16x16x32_bf16 v[24:27], v[216:219], v[112:115], v[24:27]
    s_cmp_lg_u32 s14, 0
    s_cbranch_scc1 LtwX_nw2
    v_cmp_eq_u32 vcc, 0, v2
    v_cmp_eq_u32 s[54:55], 0, v15
    s_nop 0
    s_cmp_eq_u64 s[54:55], 0
    s_cselect_b32 s62, 2, 0
    s_cmp_eq_u64 vcc, 0
    s_cselect_b32 s62, 1, s62
    v_mov_b32 v5, s62
    ds_write_b32 v49, v5
    s_waitcnt lgkmcnt(0)
LtwX_nw2:
    s_barrier
    ds_read_b32 v6, v49
    v_xor_b32 v49, 4, v49
    s_add_u32 s48, s46, 61440
    buffer_load_dwordx4 v[112:115], v0, s[8:11], s48 offen offset:0
    s_waitcnt vmcnt(15)
    v_mfma_f32_16x16x32_bf16 v[28:31], a[176:179], v[116:119], v[28:31]
    v_mfma_f32_16x16x32_bf16 v[32:35], a[180:183], v[116:119], v[32:35]
    v_mfma_f32_16x16x32_bf16 v[36:39], v[216:219], v[116:119], v[36:39]
    buffer_load_dwordx4 v[116:119], v0, s[8:11], s48 offen offset:1024
    s_waitcnt vmcnt(15)
    v_mfma_f32_16x16x32_bf16 v[16:19], a[184:187], v[120:123], v[16:19]
    v_mfma_f32_16x16x32_bf16 v[20:23], a[188:191], v[120:123], v[20:23]
    v_mfma_f32_16x16x32_bf16 v[24:27], v[220:223], v[120:123], v[24:27]
    buffer_load_dwordx4 v[120:123], v0, s[8:11], s48 offen offset:2048
    s_waitcnt vmcnt(15)
    v_mfma_f32_16x16x32_bf16 v[28:31], a[184:187], v[124:127], v[28:31]
    v_mfma_f32_16x16x32_bf16 v[32:35], a[188:191], v[124:127], v[32:35]
    v_mfma_f32_16x16x32_bf16 v[36:39], v[220:223], v[124:127], v[36:39]
    s_waitcnt lgkmcnt(0)
    v_readfirstlane_b32 s62, v6
    s_cmp_lt_u32 s33, 33
    s_cselect_b32 s38, 1, 3
    s_cmp_eq_u32 s62, 2
    s_cselect_b32 s36, 1, 0
    s_cselect_b32 s37, s33, s32
    s_cselect_b32 s17, s38, 0
    s_add_u32 s33, s33, s17
    s_cmp_eq_u32 s62, 1
    s_cselect_b32 s17, 2, 0
    s_add_u32 s32, s32, s17
    s_lshl_b32 s56, s36, 6
    s_add_u32 s56, s56, s37
    buffer_load_dwordx4 v[124:127], v0, s[8:11], s48 offen offset:3072
    s_waitcnt vmcnt(15)
    v_mfma_f32_16x16x32_bf16 v[16:19], a[192:195], v[64:67], v[16:19]
    v_mfma_f32_16x16x32_bf16 v[20:23], a[196:199], v[64:67], v[20:23]
    v_mfma_f32_16x16x32_bf16 v[24:27], v[224:227], v[64:67], v[24:27]
    s_cmp_lt_u32 s37, 64
    s_cselect_b32 s62, s62, 0
    s_lshl_b32 s46, s56, 18
    s_add_u32 s46, s46, s58
    s_mul_i32 s41, s36, 4718592
    s_mul_i32 s17, s37, 36864
    s_add_u32 s41, s41, s17
    s_add_u32 s41, s41, 8650752
    s_cmp_lg_u32 s62, 0
    s_cselect_b32 s30, 268435456, 0
    buffer_load_dword v10, v51, s[28:31], s46 offen
    s_add_u32 s48, s46, 0
    buffer_load_dwordx4 v[64:67], v0, s[28:31], s48 offen offset:0
    s_waitcnt vmcnt(15)
    v_mfma_f32_16x16x32_bf16 v[28:31], a[192:195], v[68:71], v[28:31]
    v_mfma_f32_16x16x32_bf16 v[32:35], a[196:199], v[68:71], v[32:35]
    v_mfma_f32_16x16x32_bf16 v[36:39], v[224:227], v[68:71], v[36:39]
    buffer_load_dwordx4 v[68:71], v0, s[28:31], s48 offen offset:1024
    s_waitcnt vmcnt(15)
    v_mfma_f32_16x16x32_bf16 v[16:19], a[200:203], v[72:75], v[16:19]
    v_mfma_f32_16x16x32_bf16 v[20:23], a[204:207], v[72:75], v[20:23]
    v_mfma_f32_16x16x32_bf16 v[24:27], v[228:231], v[72:75], v[24:27]
    buffer_load_dwordx4 v[72:75], v0, s[28:31], s48 offen offset:2048
    s_waitcnt vmcnt(15)
    v_mfma_f32_16x16x32_bf16 v[28:31], a[200:203], v[76:79], v[28:31]
    v_mfma_f32_16x16x32_bf16 v[32:35], a[204:207], v[76:79], v[32:35]
    v_mfma_f32_16x16x32_bf16 v[36:39], v[228:231], v[76:79], v[36:39]
    buffer_load_dwordx4 v[76:79], v0, s[28:31], s48 offen offset:3072
    s_waitcnt vmcnt(15)
    v_mfma_f32_16x16x32_bf16 v[16:19], a[208:211], v[80:83], v[16:19]
    v_mfma_f32_16x16x32_bf16 v[20:23], a[212:215], v[80:83], v[20:23]
    v_mfma_f32_16x16x32_bf16 v[24:27], v[232:235], v[80:83], v[24:27]
    s_add_u32 s48, s46, 4096
    buffer_load_dwordx4 v[80:83], v0, s[28:31], s48 offen offset:0
    s_waitcnt vmcnt(15)
    v_mfma_f32_16x16x32_bf16 v[28:31], a[208:211], v[84:87], v[28:31]
    v_mfma_f32_16x16x32_bf16 v[32:35], a[212:215], v[84:87], v[32:35]
    v_mfma_f32_16x16x32_bf16 v[36:39], v[232:235], v[84:87], v[36:39]
    buffer_load_dwordx4 v[84:87], v0, s[28:31], s48 offen offset:1024
    s_waitcnt vmcnt(15)
    v_mfma_f32_16x16x32_bf16 v[16:19], a[216:219], v[88:91], v[16:19]
    v_mfma_f32_16x16x32_bf16 v[20:23], a[220:223], v[88:91], v[20:23]
    v_mfma_f32_16x16x32_bf16 v[24:27], v[236:239], v[88:91], v[24:27]
    buffer_load_dwordx4 v[88:91], v0, s[28:31], s48 offen offset:2048
    s_waitcnt vmcnt(15)
    v_mfma_f32_16x16x32_bf16 v[28:31], a[216:219], v[92:95], v[28:31]
    v_mfma_f32_16x16x32_bf16 v[32:35], a[220:223], v[92:95], v[32:35]
    v_mfma_f32_16x16x32_bf16 v[36:39], v[236:239], v[92:95], v[36:39]
    buffer_load_dwordx4 v[92:95], v0, s[28:31], s48 offen offset:3072
    s_waitcnt vmcnt(15)
    v_mfma_f32_16x16x32_bf16 v[16:19], a[224:227], v[96:99], v[16:19]
    v_mfma_f32_16x16x32_bf16 v[20:23], a[228:231], v[96:99], v[20:23]
    v_mfma_f32_16x16x32_bf16 v[24:27], v[240:243], v[96:99], v[24:27]
    s_add_u32 s48, s46, 8192
    buffer_load_dwordx4 v[96:99], v0, s[28:31], s48 offen offset:0
    s_waitcnt vmcnt(15)
    v_mfma_f32_16x16x32_bf16 v[28:31], a[224:227], v[100:103], v[28:31]
    v_mfma_f32_16x16x32_bf16 v[32:35], a[228:231], v[100:103], v[32:35]
    v_mfma_f32_16x16x32_bf16 v[36:39], v[240:243], v[100:103], v[36:39]
    buffer_load_dwordx4 v[100:103], v0, s[28:31], s48 offen offset:1024
    s_waitcnt vmcnt(15)
    v_mfma_f32_16x16x32_bf16 v[16:19], a[232:235], v[104:107], v[16:19]
    v_mfma_f32_16x16x32_bf16 v[20:23], a[236:239], v[104:107], v[20:23]
    v_mfma_f32_16x16x32_bf16 v[24:27], v[244:247], v[104:107], v[24:27]
    buffer_load_dwordx4 v[104:107], v0, s[28:31], s48 offen offset:2048
    s_waitcnt vmcnt(15)
    v_mfma_f32_16x16x32_bf16 v[28:31], a[232:235], v[108:111], v[28:31]
    v_mfma_f32_16x16x32_bf16 v[32:35], a[236:239], v[108:111], v[32:35]
    v_mfma_f32_16x16x32_bf16 v[36:39], v[244:247], v[108:111], v[36:39]
    buffer_load_dwordx4 v[108:111], v0, s[28:31], s48 offen offset:3072
    s_waitcnt vmcnt(15)
    v_mfma_f32_16x16x32_bf16 v[16:19], a[240:243], v[112:115], v[16:19]
    v_mfma_f32_16x16x32_bf16 v[20:23], a[244:247], v[112:115], v[20:23]
    v_mfma_f32_16x16x32_bf16 v[24:27], v[248:251], v[112:115], v[24:27]
    s_add_u32 s48, s46, 12288
    buffer_load_dwordx4 v[112:115], v0, s[28:31], s48 offen offset:0
    s_waitcnt vmcnt(15)
    v_mfma_f32_16x16x32_bf16 v[28:31], a[240:243], v[116:119], v[28:31]
    v_mfma_f32_16x16x32_bf16 v[32:35], a[244:247], v[116:119], v[32:35]
    v_mfma_f32_16x16x32_bf16 v[36:39], v[248:251], v[116:119], v[36:39]
    buffer_load_dwordx4 v[116:119], v0, s[28:31], s48 offen offset:1024
    s_waitcnt vmcnt(15)
    v_mfma_f32_16x16x32_bf16 v[16:19], a[248:251], v[120:123], v[16:19]
    v_mfma_f32_16x16x32_bf16 v[20:23], a[252:255], v[120:123], v[20:23]
    v_mfma_f32_16x16x32_bf16 v[24:27], v[252:255], v[120:123], v[24:27]
    buffer_load_dwordx4 v[120:123], v0, s[28:31], s48 offen offset:2048
    s_waitcnt vmcnt(15)
    v_mfma_f32_16x16x32_bf16 v[28:31], a[248:251], v[124:127], v[28:31]
    v_mfma_f32_16x16x32_bf16 v[32:35], a[252:255], v[124:127], v[32:35]
    v_mfma_f32_16x16x32_bf16 v[36:39], v[252:255], v[124:127], v[36:39]
    s_nop 5
    ds_write_b128 v48, v[16:19] offset:0
    ds_write_b128 v48, v[20:23] offset:1024
    ds_write_b128 v48, v[24:27] offset:2048
    ds_write_b128 v48, v[28:31] offset:3072
    ds_write_b128 v48, v[32:35] offset:4096
    ds_write_b128 v48, v[36:39] offset:5120
    s_waitcnt lgkmcnt(0)
    s_barrier
    ds_read_b128 v[24:27], v50 offset:0
    ds_read_b128 v[28:31], v50 offset:1024
    ds_read_b128 v[32:35], v50 offset:6144
    ds_read_b128 v[36:39], v50 offset:7168
    ds_read_b128 v[56:59], v50 offset:12288
    ds_read_b128 v[60:63], v50 offset:13312
    ds_read_b128 v[124:127], v50 offset:18432
    ds_read_b128 v[52:55], v50 offset:19456
    v_xor_b32 v48, 0x8000, v48
    v_xor_b32 v50, 0x8000, v50
    v_lshlrev_b32 v16, 16, v40
    v_and_b32 v20, 0xffff0000, v40
    v_lshlrev_b32 v17, 16, v41
    v_and_b32 v21, 0xffff0000, v41
    v_lshlrev_b32 v18, 16, v42
    v_and_b32 v22, 0xffff0000, v42
    v_lshlrev_b32 v19, 16, v43
    v_and_b32 v23, 0xffff0000, v43
    buffer_load_dwordx4 v[40:43], v12, s[28:31], s41 offen
    s_waitcnt lgkmcnt(7)
    v_add_f32 v16, v16, v24
    v_add_f32 v17, v17, v25
    v_add_f32 v18, v18, v26
    v_add_f32 v19, v19, v27
    s_waitcnt lgkmcnt(6)
    v_add_f32 v20, v20, v28
    v_add_f32 v21, v21, v29
    v_add_f32 v22, v22, v30
    v_add_f32 v23, v23, v31
    s_waitcnt lgkmcnt(5)
    v_add_f32 v16, v16, v32
    v_add_f32 v17, v17, v33
    v_add_f32 v18, v18, v34
    v_add_f32 v19, v19, v35
    s_waitcnt lgkmcnt(4)
    v_add_f32 v20, v20, v36
    v_add_f32 v21, v21, v37
    v_add_f32 v22, v22, v38
    v_add_f32 v23, v23, v39
    s_waitcnt lgkmcnt(3)
    v_add_f32 v16, v16, v56
    v_add_f32 v17, v17, v57
    v_add_f32 v18, v18, v58
    v_add_f32 v19, v19, v59
    s_waitcnt lgkmcnt(2)
    v_add_f32 v20, v20, v60
    v_add_f32 v21, v21, v61
    v_add_f32 v22, v22, v62
    v_add_f32 v23, v23, v63
    s_waitcnt lgkmcnt(1)
    v_add_f32 v16, v16, v124
    v_add_f32 v17, v17, v125
    v_add_f32 v18, v18, v126
    v_add_f32 v19, v19, v127
    s_waitcnt lgkmcnt(0)
    v_add_f32 v20, v20, v52
    v_add_f32 v21, v21, v53
    v_add_f32 v22, v22, v54
    v_add_f32 v23, v23, v55
    v_cvt_pk_bf16_f32 v52, v16, v20
    v_cvt_pk_bf16_f32 v53, v17, v21
    v_cvt_pk_bf16_f32 v54, v18, v22
    v_cvt_pk_bf16_f32 v55, v19, v23
    s_cmp_eq_u32 s34, 0
    s_cbranch_scc1 LtwX_l0
    s_mul_i32 s17, s35, 36864
    buffer_store_dwordx4 v[52:55], v13, s[24:27], s17 offen
    s_cmp_lg_u32 s62, 0
    s_cbranch_scc1 LtwX_item
LtwX_chk:
    s_min_u32 s17, s32, s33
    s_cmp_lt_u32 s17, 64
    s_cbranch_scc1 LtwX_idle
    s_branch L_role_tw_exit
LtwX_l0:
    s_add_u32 s47, s47, 2359296
    buffer_store_dwordx4 v[52:55], v12, s[8:11], s47 offen sc1
    v_add_f32 v44, v16, v17
    v_mul_f32 v45, v16, v16
    v_fmac_f32 v45, v17, v17
    v_add_f32 v44, v44, v18
    v_fmac_f32 v45, v18, v18
    v_add_f32 v44, v44, v19
    v_fmac_f32 v45, v19, v19
    v_add_f32 v44, v44, v20
    v_fmac_f32 v45, v20, v20
    v_add_f32 v44, v44, v21
    v_fmac_f32 v45, v21, v21
    v_add_f32 v44, v44, v22
    v_fmac_f32 v45, v22, v22
    v_add_f32 v44, v44, v23
    v_fmac_f32 v45, v23, v23
    v_mov_b32 v46, v44
    v_mov_b32 v47, v45
    s_nop 0
    v_permlane32_swap_b32 v44, v46
    v_permlane32_swap_b32 v45, v47
    v_add_f32 v44, v44, v46
    v_add_f32 v45, v45, v47
    v_mov_b32 v46, v44
    v_mov_b32 v47, v45
    s_nop 0
    v_permlane16_swap_b32 v44, v46
    v_permlane16_swap_b32 v45, v47
    v_add_f32 v44, v44, v46
    v_add_f32 v45, v45, v47
    s_mul_i32 s17, s35, 6144
    s_add_u32 s17, s17, 16515072
    s_mov_b64 exec, 0xffff
    buffer_store_dwordx2 v[44:45], v14, s[8:11], s17 offen sc1
    s_mov_b64 exec, -1
    s_mul_i32 s43, s35, 22528
    s_add_u32 s43, s43, s49
    s_cmp_lg_u32 s62, 0
    s_cbranch_scc1 LtwX_item
    s_waitcnt vmcnt(0)
    s_mov_b64 exec, 1
    buffer_store_dword v3, v4, s[8:11], s43 offen sc1
    s_mov_b64 exec, -1
    s_mov_b32 s43, 0
    s_branch LtwX_chk
Ltw_z:
    v_lshrrev_b32 v5, 1, v8
    v_lshl_add_u32 v12, v5, 9, v12
    v_and_b32 v5, 1, v8
    v_lshl_add_u32 v12, v5, 3, v12
    v_add_u32 v12, 2048, v12
    v_lshl_add_u32 v13, v8, 3, v13
    v_add_u32 v13, 64, v13
    v_add_u32 v14, 8, v14
    s_lshl_b32 s58, s14, 16
    s_add_u32 s58, s58, 144703488
    s_mov_b32 s43, 0
    s_mov_b32 s28, s8
    s_mov_b32 s29, s9
    s_mov_b32 s30, 0
    s_mov_b32 s31, 0x00020000
    s_mul_i32 s17, s51, 3072
    v_add_u32 v50, s17, v0
    ds_write2_b32 v49, v4, v4 offset0:0 offset1:1
    s_waitcnt lgkmcnt(0)
    s_cmp_lg_u32 s14, 0
    s_cbranch_scc1 LtwZ_ini_d
    v_mov_b32 v5, 160
    s_mov_b32 s16, 0
LtwZ_ini:
    global_load_dword v6, v5, s[12:13] sc1
    s_add_u32 s16, s16, 1
    s_cmp_gt_u32 s16, 100000
    s_cbranch_scc1 L_role_tw_abort
    s_waitcnt vmcnt(0)
    v_cmp_gt_u32 vcc, 123, v6
    s_nop 0
    s_cbranch_vccz LtwZ_ini_d
    s_sleep 8
    s_branch LtwZ_ini
LtwZ_ini_d:
    s_barrier
LtwZ_idle:
    s_barrier
    ds_read_b32 v6, v49
    v_xor_b32 v49, 4, v49
    s_waitcnt lgkmcnt(0)
    v_readfirstlane_b32 s62, v6
    s_nop 0
    s_cmp_eq_u32 s62, 0
    s_cbranch_scc1 L_role_tw_abort
    s_cmp_lt_u32 s33, 33
    s_cselect_b32 s38, 1, 3
    s_cmp_eq_u32 s62, 2
    s_cselect_b32 s36, 1, 0
    s_cselect_b32 s37, s33, s32
    s_cselect_b32 s17, s38, 0
    s_add_u32 s33, s33, s17
    s_cmp_eq_u32 s62, 1
    s_cselect_b32 s17, 2, 0
    s_add_u32 s32, s32, s17
    s_lshl_b32 s56, s36, 6
    s_add_u32 s56, s56, s37
    s_lshl_b32 s46, s56, 18
    s_add_u32 s46, s46, s58
    s_mul_i32 s41, s36, 4718592
    s_mul_i32 s17, s37, 36864
    s_add_u32 s41, s41, s17
    s_add_u32 s41, s41, 8650752
    s_cmp_ge_u32 s37, 64
    s_cbranch_scc1 L_role_tw_abort
    buffer_load_dword v10, v51, s[8:11], s46 offen
    s_add_u32 s48, s46, 0
    buffer_load_dwordx4 v[64:67], v0, s[8:11], s48 offen offset:0
    buffer_load_dwordx4 v[68:71], v0, s[8:11], s48 offen offset:1024
    buffer_load_dwordx4 v[72:75], v0, s[8:11], s48 offen offset:2048
    buffer_load_dwordx4 v[76:79], v0, s[8:11], s48 offen offset:3072
    s_add_u32 s48, s46, 4096
    buffer_load_dwordx4 v[80:83], v0, s[8:11], s48 offen offset:0
    buffer_load_dwordx4 v[84:87], v0, s[8:11], s48 offen offset:1024
    buffer_load_dwordx4 v[88:91], v0, s[8:11], s48 offen offset:2048
    buffer_load_dwordx4 v[92:95], v0, s[8:11], s48 offen offset:3072
    s_add_u32 s48, s46, 8192
    buffer_load_dwordx4 v[96:99], v0, s[8:11], s48 offen offset:0
    buffer_load_dwordx4 v[100:103], v0, s[8:11], s48 offen offset:1024
    buffer_load_dwordx4 v[104:107], v0, s[8:11], s48 offen offset:2048
    buffer_load_dwordx4 v[108:111], v0, s[8:11], s48 offen offset:3072
    s_add_u32 s48, s46, 12288
    buffer_load_dwordx4 v[112:115], v0, s[8:11], s48 offen offset:0
    buffer_load_dwordx4 v[116:119], v0, s[8:11], s48 offen offset:1024
    buffer_load_dwordx4 v[120:123], v0, s[8:11], s48 offen offset:2048
    buffer_load_dwordx2 v[40:41], v12, s[8:11], s41 offen
LtwZ_item:
    s_mov_b32 s34, s36
    s_mov_b32 s35, s37
    s_mov_b32 s47, s41
    buffer_load_dwordx4 v[124:127], v0, s[8:11], s48 offen offset:3072
    s_waitcnt vmcnt(16)
    v_mfma_f32_16x16x32_bf16 v[16:19], a[0:3], v[64:67], 0
    v_mfma_f32_16x16x32_bf16 v[20:23], a[4:7], v[64:67], 0
    v_mfma_f32_16x16x32_bf16 v[24:27], v[128:131], v[64:67], 0
    s_add_u32 s48, s46, 16384
    buffer_load_dwordx4 v[64:67], v0, s[8:11], s48 offen offset:0
    s_waitcnt vmcnt(16)
    v_mfma_f32_16x16x32_bf16 v[28:31], a[0:3], v[68:71], 0
    v_mfma_f32_16x16x32_bf16 v[32:35], a[4:7], v[68:71], 0
    v_mfma_f32_16x16x32_bf16 v[36:39], v[128:131], v[68:71], 0
    buffer_load_dwordx4 v[68:71], v0, s[8:11], s48 offen offset:1024
    s_waitcnt vmcnt(16)
    v_mfma_f32_16x16x32_bf16 v[16:19], a[8:11], v[72:75], v[16:19]
    v_mfma_f32_16x16x32_bf16 v[20:23], a[12:15], v[72:75], v[20:23]
    v_mfma_f32_16x16x32_bf16 v[24:27], v[132:135], v[72:75], v[24:27]
    buffer_load_dwordx4 v[72:75], v0, s[8:11], s48 offen offset:2048
    s_waitcnt vmcnt(16)
    v_mfma_f32_16x16x32_bf16 v[28:31], a[8:11], v[76:79], v[28:31]
    v_mfma_f32_16x16x32_bf16 v[32:35], a[12:15], v[76:79], v[32:35]
    v_mfma_f32_16x16x32_bf16 v[36:39], v[132:135], v[76:79], v[36:39]
    buffer_load_dwordx4 v[76:79], v0, s[8:11], s48 offen offset:3072
    s_waitcnt vmcnt(16)
    v_mfma_f32_16x16x32_bf16 v[16:19], a[16:19], v[80:83], v[16:19]
    v_mfma_f32_16x16x32_bf16 v[20:23], a[20:23], v[80:83], v[20:23]
    v_mfma_f32_16x16x32_bf16 v[24:27], v[136:139], v[80:83], v[24:27]
    s_add_u32 s48, s46, 20480
    buffer_load_dwordx4 v[80:83], v0, s[8:11], s48 offen offset:0
    s_waitcnt vmcnt(16)
    v_mfma_f32_16x16x32_bf16 v[28:31], a[16:19], v[84:87], v[28:31]
    v_mfma_f32_16x16x32_bf16 v[32:35], a[20:23], v[84:87], v[32:35]
    v_mfma_f32_16x16x32_bf16 v[36:39], v[136:139], v[84:87], v[36:39]
    buffer_load_dwordx4 v[84:87], v0, s[8:11], s48 offen offset:1024
    s_waitcnt vmcnt(16)
    v_mfma_f32_16x16x32_bf16 v[16:19], a[24:27], v[88:91], v[16:19]
    v_mfma_f32_16x16x32_bf16 v[20:23], a[28:31], v[88:91], v[20:23]
    v_mfma_f32_16x16x32_bf16 v[24:27], v[140:143], v[88:91], v[24:27]
    buffer_load_dwordx4 v[88:91], v0, s[8:11], s48 offen offset:2048
    s_waitcnt vmcnt(16)
    v_mfma_f32_16x16x32_bf16 v[28:31], a[24:27], v[92:95], v[28:31]
    v_mfma_f32_16x16x32_bf16 v[32:35], a[28:31], v[92:95], v[32:35]
    v_mfma_f32_16x16x32_bf16 v[36:39], v[140:143], v[92:95], v[36:39]
    buffer_load_dwordx4 v[92:95], v0, s[8:11], s48 offen offset:3072
    s_waitcnt vmcnt(16)
    v_mfma_f32_16x16x32_bf16 v[16:19], a[32:35], v[96:99], v[16:19]
    v_mfma_f32_16x16x32_bf16 v[20:23], a[36:39], v[96:99], v[20:23]
    v_mfma_f32_16x16x32_bf16 v[24:27], v[144:147], v[96:99], v[24:27]
    s_add_u32 s48, s46, 24576
    buffer_load_dwordx4 v[96:99], v0, s[8:11], s48 offen offset:0
    s_waitcnt vmcnt(16)
    v_mfma_f32_16x16x32_bf16 v[28:31], a[32:35], v[100:103], v[28:31]
    v_mfma_f32_16x16x32_bf16 v[32:35], a[36:39], v[100:103], v[32:35]
    v_mfma_f32_16x16x32_bf16 v[36:39], v[144:147], v[100:103], v[36:39]
    buffer_load_dwordx4 v[100:103], v0, s[8:11], s48 offen offset:1024
    s_waitcnt vmcnt(16)
    v_mfma_f32_16x16x32_bf16 v[16:19], a[40:43], v[104:107], v[16:19]
    v_mfma_f32_16x16x32_bf16 v[20:23], a[44:47], v[104:107], v[20:23]
    v_mfma_f32_16x16x32_bf16 v[24:27], v[148:151], v[104:107], v[24:27]
    buffer_load_dwordx4 v[104:107], v0, s[8:11], s48 offen offset:2048
    s_waitcnt vmcnt(16)
    v_mfma_f32_16x16x32_bf16 v[28:31], a[40:43], v[108:111], v[28:31]
    v_mfma_f32_16x16x32_bf16 v[32:35], a[44:47], v[108:111], v[32:35]
    v_mfma_f32_16x16x32_bf16 v[36:39], v[148:151], v[108:111], v[36:39]
    buffer_load_dwordx4 v[108:111], v0, s[8:11], s48 offen offset:3072
    s_waitcnt vmcnt(16)
    v_mfma_f32_16x16x32_bf16 v[16:19], a[48:51], v[112:115], v[16:19]
    v_mfma_f32_16x16x32_bf16 v[20:23], a[52:55], v[112:115], v[20:23]
    v_mfma_f32_16x16x32_bf16 v[24:27], v[152:155], v[112:115], v[24:27]
    s_add_u32 s48, s46, 28672
    buffer_load_dwordx4 v[112:115], v0, s[8:11], s48 offen offset:0
    s_waitcnt vmcnt(16)
    v_mfma_f32_16x16x32_bf16 v[28:31], a[48:51], v[116:119], v[28:31]
    v_mfma_f32_16x16x32_bf16 v[32:35], a[52:55], v[116:119], v[32:35]
    v_mfma_f32_16x16x32_bf16 v[36:39], v[152:155], v[116:119], v[36:39]
    buffer_load_dwordx4 v[116:119], v0, s[8:11], s48 offen offset:1024
    s_waitcnt vmcnt(16)
    v_mfma_f32_16x16x32_bf16 v[16:19], a[56:59], v[120:123], v[16:19]
    v_mfma_f32_16x16x32_bf16 v[20:23], a[60:63], v[120:123], v[20:23]
    v_mfma_f32_16x16x32_bf16 v[24:27], v[156:159], v[120:123], v[24:27]
    buffer_load_dwordx4 v[120:123], v0, s[8:11], s48 offen offset:2048
    s_waitcnt vmcnt(15)
    v_mfma_f32_16x16x32_bf16 v[28:31], a[56:59], v[124:127], v[28:31]
    v_mfma_f32_16x16x32_bf16 v[32:35], a[60:63], v[124:127], v[32:35]
    v_mfma_f32_16x16x32_bf16 v[36:39], v[156:159], v[124:127], v[36:39]
    buffer_load_dwordx4 v[124:127], v0, s[8:11], s48 offen offset:3072
    s_waitcnt vmcnt(15)
    v_mfma_f32_16x16x32_bf16 v[16:19], a[64:67], v[64:67], v[16:19]
    v_mfma_f32_16x16x32_bf16 v[20:23], a[68:71], v[64:67], v[20:23]
    v_mfma_f32_16x16x32_bf16 v[24:27], v[160:163], v[64:67], v[24:27]
    s_add_u32 s48, s46, 32768
    buffer_load_dwordx4 v[64:67], v0, s[8:11], s48 offen offset:0
    s_waitcnt vmcnt(15)
    v_mfma_f32_16x16x32_bf16 v[28:31], a[64:67], v[68:71], v[28:31]
    v_mfma_f32_16x16x32_bf16 v[32:35], a[68:71], v[68:71], v[32:35]
    v_mfma_f32_16x16x32_bf16 v[36:39], v[160:163], v[68:71], v[36:39]
    s_cmp_lg_u32 s43, 0
    s_cselect_b64 exec, 1, 0
    buffer_store_dword v3, v4, s[8:11], s43 offen sc1
    s_mov_b64 exec, -1
    s_mov_b32 s43, 0
    buffer_load_dwordx4 v[68:71], v0, s[8:11], s48 offen offset:1024
    s_waitcnt vmcnt(16)
    v_mfma_f32_16x16x32_bf16 v[16:19], a[72:75], v[72:75], v[16:19]
    v_mfma_f32_16x16x32_bf16 v[20:23], a[76:79], v[72:75], v[20:23]
    v_mfma_f32_16x16x32_bf16 v[24:27], v[164:167], v[72:75], v[24:27]
    buffer_load_dwordx4 v[72:75], v0, s[8:11], s48 offen offset:2048
    s_waitcnt vmcnt(16)
    v_mfma_f32_16x16x32_bf16 v[28:31], a[72:75], v[76:79], v[28:31]
    v_mfma_f32_16x16x32_bf16 v[32:35], a[76:79], v[76:79], v[32:35]
    v_mfma_f32_16x16x32_bf16 v[36:39], v[164:167], v[76:79], v[36:39]
    buffer_load_dwordx4 v[76:79], v0, s[8:11], s48 offen offset:3072
    s_waitcnt vmcnt(16)
    v_mfma_f32_16x16x32_bf16 v[16:19], a[80:83], v[80:83], v[16:19]
    v_mfma_f32_16x16x32_bf16 v[20:23], a[84:87], v[80:83], v[20:23]
    v_mfma_f32_16x16x32_bf16 v[24:27], v[168:171], v[80:83], v[24:27]
    s_add_u32 s48, s46, 36864
    buffer_load_dwordx4 v[80:83], v0, s[8:11], s48 offen offset:0
    s_waitcnt vmcnt(16)
    v_mfma_f32_16x16x32_bf16 v[28:31], a[80:83], v[84:87], v[28:31]
    v_mfma_f32_16x16x32_bf16 v[32:35], a[84:87], v[84:87], v[32:35]
    v_mfma_f32_16x16x32_bf16 v[36:39], v[168:171], v[84:87], v[36:39]
    buffer_load_dwordx4 v[84:87], v0, s[8:11], s48 offen offset:1024
    s_waitcnt vmcnt(16)
    v_mfma_f32_16x16x32_bf16 v[16:19], a[88:91], v[88:91], v[16:19]
    v_mfma_f32_16x16x32_bf16 v[20:23], a[92:95], v[88:91], v[20:23]
    v_mfma_f32_16x16x32_bf16 v[24:27], v[172:175], v[88:91], v[24:27]
    buffer_load_dwordx4 v[88:91], v0, s[8:11], s48 offen offset:2048
    s_waitcnt vmcnt(16)
    v_mfma_f32_16x16x32_bf16 v[28:31], a[88:91], v[92:95], v[28:31]
    v_mfma_f32_16x16x32_bf16 v[32:35], a[92:95], v[92:95], v[32:35]
    v_mfma_f32_16x16x32_bf16 v[36:39], v[172:175], v[92:95], v[36:39]
    buffer_load_dwordx4 v[92:95], v0, s[8:11], s48 offen offset:3072
    s_waitcnt vmcnt(16)
    v_mfma_f32_16x16x32_bf16 v[16:19], a[96:99], v[96:99], v[16:19]
    v_mfma_f32_16x16x32_bf16 v[20:23], a[100:103], v[96:99], v[20:23]
    v_mfma_f32_16x16x32_bf16 v[24:27], v[176:179], v[96:99], v[24:27]
    s_add_u32 s48, s46, 40960
    buffer_load_dwordx4 v[96:99], v0, s[8:11], s48 offen offset:0
    s_waitcnt vmcnt(16)
    v_mfma_f32_16x16x32_bf16 v[28:31], a[96:99], v[100:103], v[28:31]
    v_mfma_f32_16x16x32_bf16 v[32:35], a[100:103], v[100:103], v[32:35]
    v_mfma_f32_16x16x32_bf16 v[36:39], v[176:179], v[100:103], v[36:39]
    buffer_load_dwordx4 v[100:103], v0, s[8:11], s48 offen offset:1024
    s_waitcnt vmcnt(16)
    v_mfma_f32_16x16x32_bf16 v[16:19], a[104:107], v[104:107], v[16:19]
    v_mfma_f32_16x16x32_bf16 v[20:23], a[108:111], v[104:107], v[20:23]
    v_mfma_f32_16x16x32_bf16 v[24:27], v[180:183], v[104:107], v[24:27]
    buffer_load_dwordx4 v[104:107], v0, s[8:11], s48 offen offset:2048
    s_waitcnt vmcnt(16)
    v_mfma_f32_16x16x32_bf16 v[28:31], a[104:107], v[108:111], v[28:31]
    v_mfma_f32_16x16x32_bf16 v[32:35], a[108:111], v[108:111], v[32:35]
    v_mfma_f32_16x16x32_bf16 v[36:39], v[180:183], v[108:111], v[36:39]
    buffer_load_dwordx4 v[108:111], v0, s[8:11], s48 offen offset:3072
    s_waitcnt vmcnt(16)
    v_mfma_f32_16x16x32_bf16 v[16:19], a[112:115], v[112:115], v[16:19]
    v_mfma_f32_16x16x32_bf16 v[20:23], a[116:119], v[112:115], v[20:23]
    v_mfma_f32_16x16x32_bf16 v[24:27], v[184:187], v[112:115], v[24:27]
    s_add_u32 s48, s46, 45056
    buffer_load_dwordx4 v[112:115], v0, s[8:11], s48 offen offset:0
    s_waitcnt vmcnt(16)
    v_mfma_f32_16x16x32_bf16 v[28:31], a[112:115], v[116:119], v[28:31]
    v_mfma_f32_16x16x32_bf16 v[32:35], a[116:119], v[116:119], v[32:35]
    v_mfma_f32_16x16x32_bf16 v[36:39], v[184:187], v[116:119], v[36:39]
    buffer_load_dwordx4 v[116:119], v0, s[8:11], s48 offen offset:1024
    s_waitcnt vmcnt(16)
    v_mfma_f32_16x16x32_bf16 v[16:19], a[120:123], v[120:123], v[16:19]
    v_mfma_f32_16x16x32_bf16 v[20:23], a[124:127], v[120:123], v[20:23]
    v_mfma_f32_16x16x32_bf16 v[24:27], v[188:191], v[120:123], v[24:27]
    buffer_load_dwordx4 v[120:123], v0, s[8:11], s48 offen offset:2048
    s_waitcnt vmcnt(16)
    v_mfma_f32_16x16x32_bf16 v[28:31], a[120:123], v[124:127], v[28:31]
    v_mfma_f32_16x16x32_bf16 v[32:35], a[124:127], v[124:127], v[32:35]
    v_mfma_f32_16x16x32_bf16 v[36:39], v[188:191], v[124:127], v[36:39]
    buffer_load_dwordx4 v[124:127], v0, s[8:11], s48 offen offset:3072
    s_waitcnt vmcnt(16)
    v_mfma_f32_16x16x32_bf16 v[16:19], a[128:131], v[64:67], v[16:19]
    v_mfma_f32_16x16x32_bf16 v[20:23], a[132:135], v[64:67], v[20:23]
    v_mfma_f32_16x16x32_bf16 v[24:27], v[192:195], v[64:67], v[24:27]
    s_add_u32 s48, s46, 49152
    buffer_load_dwordx4 v[64:67], v0, s[8:11], s48 offen offset:0
    s_waitcnt vmcnt(15)
    v_mfma_f32_16x16x32_bf16 v[28:31], a[128:131], v[68:71], v[28:31]
    v_mfma_f32_16x16x32_bf16 v[32:35], a[132:135], v[68:71], v[32:35]
    v_mfma_f32_16x16x32_bf16 v[36:39], v[192:195], v[68:71], v[36:39]
    buffer_load_dwordx4 v[68:71], v0, s[8:11], s48 offen offset:1024
    s_waitcnt vmcnt(15)
    v_mfma_f32_16x16x32_bf16 v[16:19], a[136:139], v[72:75], v[16:19]
    v_mfma_f32_16x16x32_bf16 v[20:23], a[140:143], v[72:75], v[20:23]
    v_mfma_f32_16x16x32_bf16 v[24:27], v[196:199], v[72:75], v[24:27]
    buffer_load_dwordx4 v[72:75], v0, s[8:11], s48 offen offset:2048
    s_waitcnt vmcnt(15)
    v_mfma_f32_16x16x32_bf16 v[28:31], a[136:139], v[76:79], v[28:31]
    v_mfma_f32_16x16x32_bf16 v[32:35], a[140:143], v[76:79], v[32:35]
    v_mfma_f32_16x16x32_bf16 v[36:39], v[196:199], v[76:79], v[36:39]
    buffer_load_dwordx4 v[76:79], v0, s[8:11], s48 offen offset:3072
    s_waitcnt vmcnt(15)
    v_mfma_f32_16x16x32_bf16 v[16:19], a[144:147], v[80:83], v[16:19]
    v_mfma_f32_16x16x32_bf16 v[20:23], a[148:151], v[80:83], v[20:23]
    v_mfma_f32_16x16x32_bf16 v[24:27], v[200:203], v[80:83], v[24:27]
    s_add_u32 s48, s46, 53248
    buffer_load_dwordx4 v[80:83], v0, s[8:11], s48 offen offset:0
    s_waitcnt vmcnt(15)
    v_mfma_f32_16x16x32_bf16 v[28:31], a[144:147], v[84:87], v[28:31]
    v_mfma_f32_16x16x32_bf16 v[32:35], a[148:151], v[84:87], v[32:35]
    v_mfma_f32_16x16x32_bf16 v[36:39], v[200:203], v[84:87], v[36:39]
    buffer_load_dwordx4 v[84:87], v0, s[8:11], s48 offen offset:1024
    s_waitcnt vmcnt(15)
    v_mfma_f32_16x16x32_bf16 v[16:19], a[152:155], v[88:91], v[16:19]
    v_mfma_f32_16x16x32_bf16 v[20:23], a[156:159], v[88:91], v[20:23]
    v_mfma_f32_16x16x32_bf16 v[24:27], v[204:207], v[88:91], v[24:27]
    buffer_load_dwordx4 v[88:91], v0, s[8:11], s48 offen offset:2048
    s_waitcnt vmcnt(15)
    v_mfma_f32_16x16x32_bf16 v[28:31], a[152:155], v[92:95], v[28:31]
    v_mfma_f32_16x16x32_bf16 v[32:35], a[156:159], v[92:95], v[32:35]
    v_mfma_f32_16x16x32_bf16 v[36:39], v[204:207], v[92:95], v[36:39]
    buffer_load_dwordx4 v[92:95], v0, s[8:11], s48 offen offset:3072
    s_waitcnt vmcnt(15)
    v_mfma_f32_16x16x32_bf16 v[16:19], a[160:163], v[96:99], v[16:19]
    v_mfma_f32_16x16x32_bf16 v[20:23], a[164:167], v[96:99], v[20:23]
    v_mfma_f32_16x16x32_bf16 v[24:27], v[208:211], v[96:99], v[24:27]
    s_add_u32 s48, s46, 57344
    buffer_load_dwordx4 v[96:99], v0, s[8:11], s48 offen offset:0
    s_waitcnt vmcnt(15)
    v_mfma_f32_16x16x32_bf16 v[28:31], a[160:163], v[100:103], v[28:31]
    v_mfma_f32_16x16x32_bf16 v[32:35], a[164:167], v[100:103], v[32:35]
    v_mfma_f32_16x16x32_bf16 v[36:39], v[208:211], v[100:103], v[36:39]
    buffer_load_dwordx4 v[100:103], v0, s[8:11], s48 offen offset:1024
    s_waitcnt vmcnt(15)
    v_mfma_f32_16x16x32_bf16 v[16:19], a[168:171], v[104:107], v[16:19]
    v_mfma_f32_16x16x32_bf16 v[20:23], a[172:175], v[104:107], v[20:23]
    v_mfma_f32_16x16x32_bf16 v[24:27], v[212:215], v[104:107], v[24:27]
    buffer_load_dwordx4 v[104:107], v0, s[8:11], s48 offen offset:2048
    s_waitcnt vmcnt(15)
    v_mfma_f32_16x16x32_bf16 v[28:31], a[168:171], v[108:111], v[28:31]
    v_mfma_f32_16x16x32_bf16 v[32:35], a[172:175], v[108:111], v[32:35]
    v_mfma_f32_16x16x32_bf16 v[36:39], v[212:215], v[108:111], v[36:39]
    buffer_load_dwordx4 v[108:111], v0, s[8:11], s48 offen offset:3072
    s_waitcnt vmcnt(15)
    v_mfma_f32_16x16x32_bf16 v[16:19], a[176:179], v[112:115], v[16:19]
    v_mfma_f32_16x16x32_bf16 v[20:23], a[180:183], v[112:115], v[20:23]
    v_mfma_f32_16x16x32_bf16 v[24:27], v[216:219], v[112:115], v[24:27]
    s_barrier
    ds_read_b32 v6, v49
    v_xor_b32 v49, 4, v49
    s_add_u32 s48, s46, 61440
    buffer_load_dwordx4 v[112:115], v0, s[8:11], s48 offen offset:0
    s_waitcnt vmcnt(15)
    v_mfma_f32_16x16x32_bf16 v[28:31], a[176:179], v[116:119], v[28:31]
    v_mfma_f32_16x16x32_bf16 v[32:35], a[180:183], v[116:119], v[32:35]
    v_mfma_f32_16x16x32_bf16 v[36:39], v[216:219], v[116:119], v[36:39]
    buffer_load_dwordx4 v[116:119], v0, s[8:11], s48 offen offset:1024
    s_waitcnt vmcnt(15)
    v_mfma_f32_16x16x32_bf16 v[16:19], a[184:187], v[120:123], v[16:19]
    v_mfma_f32_16x16x32_bf16 v[20:23], a[188:191], v[120:123], v[20:23]
    v_mfma_f32_16x16x32_bf16 v[24:27], v[220:223], v[120:123], v[24:27]
    buffer_load_dwordx4 v[120:123], v0, s[8:11], s48 offen offset:2048
    s_waitcnt vmcnt(15)
    v_mfma_f32_16x16x32_bf16 v[28:31], a[184:187], v[124:127], v[28:31]
    v_mfma_f32_16x16x32_bf16 v[32:35], a[188:191], v[124:127], v[32:35]
    v_mfma_f32_16x16x32_bf16 v[36:39], v[220:223], v[124:127], v[36:39]
    s_waitcnt lgkmcnt(0)
    v_readfirstlane_b32 s62, v6
    s_cmp_lt_u32 s33, 33
    s_cselect_b32 s38, 1, 3
    s_cmp_eq_u32 s62, 2
    s_cselect_b32 s36, 1, 0
    s_cselect_b32 s37, s33, s32
    s_cselect_b32 s17, s38, 0
    s_add_u32 s33, s33, s17
    s_cmp_eq_u32 s62, 1
    s_cselect_b32 s17, 2, 0
    s_add_u32 s32, s32, s17
    s_lshl_b32 s56, s36, 6
    s_add_u32 s56, s56, s37
    buffer_load_dwordx4 v[124:127], v0, s[8:11], s48 offen offset:3072
    s_waitcnt vmcnt(15)
    v_mfma_f32_16x16x32_bf16 v[16:19], a[192:195], v[64:67], v[16:19]
    v_mfma_f32_16x16x32_bf16 v[20:23], a[196:199], v[64:67], v[20:23]
    v_mfma_f32_16x16x32_bf16 v[24:27], v[224:227], v[64:67], v[24:27]
    s_cmp_lt_u32 s37, 64
    s_cselect_b32 s62, s62, 0
    s_lshl_b32 s46, s56, 18
    s_add_u32 s46, s46, s58
    s_mul_i32 s41, s36, 4718592
    s_mul_i32 s17, s37, 36864
    s_add_u32 s41, s41, s17
    s_add_u32 s41, s41, 8650752
    s_cmp_lg_u32 s62, 0
    s_cselect_b32 s30, 268435456, 0
    buffer_load_dword v10, v51, s[28:31], s46 offen
    s_add_u32 s48, s46, 0
    buffer_load_dwordx4 v[64:67], v0, s[28:31], s48 offen offset:0
    s_waitcnt vmcnt(15)
    v_mfma_f32_16x16x32_bf16 v[28:31], a[192:195], v[68:71], v[28:31]
    v_mfma_f32_16x16x32_bf16 v[32:35], a[196:199], v[68:71], v[32:35]
    v_mfma_f32_16x16x32_bf16 v[36:39], v[224:227], v[68:71], v[36:39]
    buffer_load_dwordx4 v[68:71], v0, s[28:31], s48 offen offset:1024
    s_waitcnt vmcnt(15)
    v_mfma_f32_16x16x32_bf16 v[16:19], a[200:203], v[72:75], v[16:19]
    v_mfma_f32_16x16x32_bf16 v[20:23], a[204:207], v[72:75], v[20:23]
    v_mfma_f32_16x16x32_bf16 v[24:27], v[228:231], v[72:75], v[24:27]
    buffer_load_dwordx4 v[72:75], v0, s[28:31], s48 offen offset:2048
    s_waitcnt vmcnt(15)
    v_mfma_f32_16x16x32_bf16 v[28:31], a[200:203], v[76:79], v[28:31]
    v_mfma_f32_16x16x32_bf16 v[32:35], a[204:207], v[76:79], v[32:35]
    v_mfma_f32_16x16x32_bf16 v[36:39], v[228:231], v[76:79], v[36:39]
    buffer_load_dwordx4 v[76:79], v0, s[28:31], s48 offen offset:3072
    s_waitcnt vmcnt(15)
    v_mfma_f32_16x16x32_bf16 v[16:19], a[208:211], v[80:83], v[16:19]
    v_mfma_f32_16x16x32_bf16 v[20:23], a[212:215], v[80:83], v[20:23]
    v_mfma_f32_16x16x32_bf16 v[24:27], v[232:235], v[80:83], v[24:27]
    s_add_u32 s48, s46, 4096
    buffer_load_dwordx4 v[80:83], v0, s[28:31], s48 offen offset:0
    s_waitcnt vmcnt(15)
    v_mfma_f32_16x16x32_bf16 v[28:31], a[208:211], v[84:87], v[28:31]
    v_mfma_f32_16x16x32_bf16 v[32:35], a[212:215], v[84:87], v[32:35]
    v_mfma_f32_16x16x32_bf16 v[36:39], v[232:235], v[84:87], v[36:39]
    buffer_load_dwordx4 v[84:87], v0, s[28:31], s48 offen offset:1024
    s_waitcnt vmcnt(15)
    v_mfma_f32_16x16x32_bf16 v[16:19], a[216:219], v[88:91], v[16:19]
    v_mfma_f32_16x16x32_bf16 v[20:23], a[220:223], v[88:91], v[20:23]
    v_mfma_f32_16x16x32_bf16 v[24:27], v[236:239], v[88:91], v[24:27]
    buffer_load_dwordx4 v[88:91], v0, s[28:31], s48 offen offset:2048
    s_waitcnt vmcnt(15)
    v_mfma_f32_16x16x32_bf16 v[28:31], a[216:219], v[92:95], v[28:31]
    v_mfma_f32_16x16x32_bf16 v[32:35], a[220:223], v[92:95], v[32:35]
    v_mfma_f32_16x16x32_bf16 v[36:39], v[236:239], v[92:95], v[36:39]
    buffer_load_dwordx4 v[92:95], v0, s[28:31], s48 offen offset:3072
    s_waitcnt vmcnt(15)
    v_mfma_f32_16x16x32_bf16 v[16:19], a[224:227], v[96:99], v[16:19]
    v_mfma_f32_16x16x32_bf16 v[20:23], a[228:231], v[96:99], v[20:23]
    v_mfma_f32_16x16x32_bf16 v[24:27], v[240:243], v[96:99], v[24:27]
    s_add_u32 s48, s46, 8192
    buffer_load_dwordx4 v[96:99], v0, s[28:31], s48 offen offset:0
    s_waitcnt vmcnt(15)
    v_mfma_f32_16x16x32_bf16 v[28:31], a[224:227], v[100:103], v[28:31]
    v_mfma_f32_16x16x32_bf16 v[32:35], a[228:231], v[100:103], v[32:35]
    v_mfma_f32_16x16x32_bf16 v[36:39], v[240:243], v[100:103], v[36:39]
    buffer_load_dwordx4 v[100:103], v0, s[28:31], s48 offen offset:1024
    s_waitcnt vmcnt(15)
    v_mfma_f32_16x16x32_bf16 v[16:19], a[232:235], v[104:107], v[16:19]
    v_mfma_f32_16x16x32_bf16 v[20:23], a[236:239], v[104:107], v[20:23]
    v_mfma_f32_16x16x32_bf16 v[24:27], v[244:247], v[104:107], v[24:27]
    buffer_load_dwordx4 v[104:107], v0, s[28:31], s48 offen offset:2048
    s_waitcnt vmcnt(15)
    v_mfma_f32_16x16x32_bf16 v[28:31], a[232:235], v[108:111], v[28:31]
    v_mfma_f32_16x16x32_bf16 v[32:35], a[236:239], v[108:111], v[32:35]
    v_mfma_f32_16x16x32_bf16 v[36:39], v[244:247], v[108:111], v[36:39]
    buffer_load_dwordx4 v[108:111], v0, s[28:31], s48 offen offset:3072
    s_waitcnt vmcnt(15)
    v_mfma_f32_16x16x32_bf16 v[16:19], a[240:243], v[112:115], v[16:19]
    v_mfma_f32_16x16x32_bf16 v[20:23], a[244:247], v[112:115], v[20:23]
    v_mfma_f32_16x16x32_bf16 v[24:27], v[248:251], v[112:115], v[24:27]
    s_add_u32 s48, s46, 12288
    buffer_load_dwordx4 v[112:115], v0, s[28:31], s48 offen offset:0
    s_waitcnt vmcnt(15)
    v_mfma_f32_16x16x32_bf16 v[28:31], a[240:243], v[116:119], v[28:31]
    v_mfma_f32_16x16x32_bf16 v[32:35], a[244:247], v[116:119], v[32:35]
    v_mfma_f32_16x16x32_bf16 v[36:39], v[248:251], v[116:119], v[36:39]
    buffer_load_dwordx4 v[116:119], v0, s[28:31], s48 offen offset:1024
    s_waitcnt vmcnt(15)
    v_mfma_f32_16x16x32_bf16 v[16:19], a[248:251], v[120:123], v[16:19]
    v_mfma_f32_16x16x32_bf16 v[20:23], a[252:255], v[120:123], v[20:23]
    v_mfma_f32_16x16x32_bf16 v[24:27], v[252:255], v[120:123], v[24:27]
    buffer_load_dwordx4 v[120:123], v0, s[28:31], s48 offen offset:2048
    s_waitcnt vmcnt(15)
    v_mfma_f32_16x16x32_bf16 v[28:31], a[248:251], v[124:127], v[28:31]
    v_mfma_f32_16x16x32_bf16 v[32:35], a[252:255], v[124:127], v[32:35]
    v_mfma_f32_16x16x32_bf16 v[36:39], v[252:255], v[124:127], v[36:39]
    s_nop 5
    ds_write_b128 v48, v[16:19] offset:0
    ds_write_b128 v48, v[20:23] offset:1024
    ds_write_b128 v48, v[24:27] offset:2048
    ds_write_b128 v48, v[28:31] offset:3072
    ds_write_b128 v48, v[32:35] offset:4096
    ds_write_b128 v48, v[36:39] offset:5120
    s_waitcnt lgkmcnt(0)
    s_barrier
    ds_read_b128 v[24:27], v50 offset:2048
    ds_read_b128 v[28:31], v50 offset:8192
    ds_read_b128 v[32:35], v50 offset:14336
    ds_read_b128 v[36:39], v50 offset:20480
    v_xor_b32 v48, 0x8000, v48
    v_xor_b32 v50, 0x8000, v50
    v_lshlrev_b32 v16, 16, v40
    v_and_b32 v17, 0xffff0000, v40
    v_lshlrev_b32 v18, 16, v41
    v_and_b32 v19, 0xffff0000, v41
    buffer_load_dwordx2 v[40:41], v12, s[28:31], s41 offen
    s_waitcnt lgkmcnt(3)
    v_add_f32 v16, v16, v24
    v_add_f32 v17, v17, v25
    v_add_f32 v18, v18, v26
    v_add_f32 v19, v19, v27
    s_waitcnt lgkmcnt(2)
    v_add_f32 v16, v16, v28
    v_add_f32 v17, v17, v29
    v_add_f32 v18, v18, v30
    v_add_f32 v19, v19, v31
    s_waitcnt lgkmcnt(1)
    v_add_f32 v16, v16, v32
    v_add_f32 v17, v17, v33
    v_add_f32 v18, v18, v34
    v_add_f32 v19, v19, v35
    s_waitcnt lgkmcnt(0)
    v_add_f32 v16, v16, v36
    v_add_f32 v17, v17, v37
    v_add_f32 v18, v18, v38
    v_add_f32 v19, v19, v39
    v_cvt_pk_bf16_f32 v52, v16, v17
    v_cvt_pk_bf16_f32 v53, v18, v19
    s_cmp_eq_u32 s34, 0
    s_cbranch_scc1 LtwZ_l0
    s_mul_i32 s17, s35, 36864
    buffer_store_dwordx2 v[52:53], v13, s[24:27], s17 offen
    s_cmp_lg_u32 s62, 0
    s_cbranch_scc1 LtwZ_item
LtwZ_chk:
    s_min_u32 s17, s32, s33
    s_cmp_lt_u32 s17, 64
    s_cbranch_scc1 LtwZ_idle
    s_branch L_role_tw_exit
LtwZ_l0:
    s_add_u32 s47, s47, 2359296
    buffer_store_dwordx2 v[52:53], v12, s[8:11], s47 offen sc1
    v_add_f32 v44, v16, v17
    v_mul_f32 v45, v16, v16
    v_fmac_f32 v45, v17, v17
    v_add_f32 v44, v44, v18
    v_fmac_f32 v45, v18, v18
    v_add_f32 v44, v44, v19
    v_fmac_f32 v45, v19, v19
    v_mov_b32 v46, v44
    v_mov_b32 v47, v45
    s_nop 0
    v_permlane32_swap_b32 v44, v46
    v_permlane32_swap_b32 v45, v47
    v_add_f32 v44, v44, v46
    v_add_f32 v45, v45, v47
    v_mov_b32 v46, v44
    v_mov_b32 v47, v45
    s_nop 0
    v_permlane16_swap_b32 v44, v46
    v_permlane16_swap_b32 v45, v47
    v_add_f32 v44, v44, v46
    v_add_f32 v45, v45, v47
    s_mul_i32 s17, s35, 6144
    s_add_u32 s17, s17, 16515072
    s_mov_b64 exec, 0xffff
    buffer_store_dwordx2 v[44:45], v14, s[8:11], s17 offen sc1
    s_mov_b64 exec, -1
    s_mul_i32 s43, s35, 22528
    s_add_u32 s43, s43, s49
    s_cmp_lg_u32 s62, 0
    s_cbranch_scc1 LtwZ_item
    s_waitcnt vmcnt(0)
    s_mov_b64 exec, 1
    buffer_store_dword v3, v4, s[8:11], s43 offen sc1
    s_mov_b64 exec, -1
    s_mov_b32 s43, 0
    s_branch LtwZ_chk
L_role_tw_abort:
    s_waitcnt lgkmcnt(0)
    s_mov_b64 exec, -1
    v_mov_b32 v0, 60
    s_lshl_b32 s5, s3, 8
    s_or_b32 s5, s5, s4
    s_or_b32 s5, s5, 0x10000
    v_mov_b32 v1, s5
    global_store_dword v0, v1, s[12:13]
    s_endpgm
L_role_tw_exit:
    s_endpgm
.p2align 6
L_role_awo:
    v_and_b32 v5, 63, v0
    v_lshlrev_b32 v0, 4, v5
    v_and_b32 v7, 15, v5
    v_lshrrev_b32 v8, 4, v5
    v_min_u32 v1, 63, v5
    v_lshrrev_b32 v6, 2, v1
    v_and_b32 v1, 3, v1
    v_lshlrev_b32 v1, 2, v1
    v_lshl_add_u32 v1, v6, 7, v1
    v_mov_b32 v3, 1
    v_mov_b32 v4, 0
    s_mov_b32 s44, 0x05040100
    s_mov_b32 s45, 0x07060302
    s_cmp_lt_u32 s15, 5
    s_cbranch_scc1 Lawo_noord
    s_cmp_lg_u32 s14, 0
    s_cbranch_scc1 Lawo_ord_d
    v_mov_b32 v5, 48
    s_mov_b32 s16, 0
Lawo_ord:
    global_load_dword v6, v5, s[12:13] sc1
    s_add_u32 s16, s16, 1
    s_cmp_gt_u32 s16, 100000
    s_cbranch_scc1 L_role_awo_abort
    s_waitcnt vmcnt(0)
    v_cmp_gt_u32 vcc, 1, v6
    s_nop 0
    s_cbranch_vccz Lawo_ord_d
    s_sleep 64
    s_branch Lawo_ord
Lawo_ord_d:
    s_barrier
Lawo_noord:
    s_load_dwordx2 s[20:21], s[0:1], 16
    s_mov_b32 s22, 663552
    s_mov_b32 s23, 0x00020000
    s_waitcnt lgkmcnt(0)
    s_and_b32 s21, s21, 0xffff
    s_cmp_ge_u32 s15, 5
    s_cselect_b32 s63, 1, 0
    s_cselect_b32 s17, 5, 0
    s_sub_u32 s15, s15, s17
    s_lshl_b32 s50, s15, 2
    s_add_u32 s50, s50, s14
    s_min_u32 s50, s50, 17
    s_lshl_b32 s49, s50, 6
    v_bfe_u32 v10, v0, 4, 5
    v_and_b32 v14, 19, v10
    v_bfe_u32 v5, v10, 2, 1
    v_lshl_add_u32 v14, v5, 3, v14
    v_bfe_u32 v5, v10, 3, 1
    v_lshl_add_u32 v14, v5, 2, v14
    v_and_b32 v5, 1, v14
    v_mov_b32 v11, s44
    v_mov_b32 v6, s45
    v_cmp_eq_u32 vcc, 1, v5
    s_nop 1
    v_cndmask_b32 v11, v11, v6, vcc
    v_and_b32 v14, 30, v14
    v_lshlrev_b32 v14, 1, v14
    v_lshrrev_b32 v9, 9, v0
    v_mul_u32_u24 v5, 9216, v9
    v_add_u32 v12, v5, v14
    v_add_u32 v13, 1152, v12
    s_add_u32 s17, s49, 0
    buffer_load_dword v16, v12, s[20:23], s17 offen
    buffer_load_dword v17, v13, s[20:23], s17 offen
    s_add_u32 s17, s49, 2304
    buffer_load_dword v18, v12, s[20:23], s17 offen
    buffer_load_dword v19, v13, s[20:23], s17 offen
    s_add_u32 s17, s49, 4608
    buffer_load_dword v20, v12, s[20:23], s17 offen
    buffer_load_dword v21, v13, s[20:23], s17 offen
    s_add_u32 s17, s49, 6912
    buffer_load_dword v22, v12, s[20:23], s17 offen
    buffer_load_dword v23, v13, s[20:23], s17 offen
    s_add_u32 s17, s49, 23040
    buffer_load_dword v24, v12, s[20:23], s17 offen
    buffer_load_dword v25, v13, s[20:23], s17 offen
    s_add_u32 s17, s49, 25344
    buffer_load_dword v26, v12, s[20:23], s17 offen
    buffer_load_dword v27, v13, s[20:23], s17 offen
    s_add_u32 s17, s49, 27648
    buffer_load_dword v28, v12, s[20:23], s17 offen
    buffer_load_dword v29, v13, s[20:23], s17 offen
    s_add_u32 s17, s49, 29952
    buffer_load_dword v30, v12, s[20:23], s17 offen
    buffer_load_dword v31, v13, s[20:23], s17 offen
    s_add_u32 s17, s49, 41472
    buffer_load_dword v32, v12, s[20:23], s17 offen
    buffer_load_dword v33, v13, s[20:23], s17 offen
    s_add_u32 s17, s49, 43776
    buffer_load_dword v34, v12, s[20:23], s17 offen
    buffer_load_dword v35, v13, s[20:23], s17 offen
    s_add_u32 s17, s49, 46080
    buffer_load_dword v36, v12, s[20:23], s17 offen
    buffer_load_dword v37, v13, s[20:23], s17 offen
    s_add_u32 s17, s49, 48384
    buffer_load_dword v38, v12, s[20:23], s17 offen
    buffer_load_dword v39, v13, s[20:23], s17 offen
    s_add_u32 s17, s49, 64512
    buffer_load_dword v40, v12, s[20:23], s17 offen
    buffer_load_dword v41, v13, s[20:23], s17 offen
    s_add_u32 s17, s49, 66816
    buffer_load_dword v42, v12, s[20:23], s17 offen
    buffer_load_dword v43, v13, s[20:23], s17 offen
    s_add_u32 s17, s49, 69120
    buffer_load_dword v44, v12, s[20:23], s17 offen
    buffer_load_dword v45, v13, s[20:23], s17 offen
    s_add_u32 s17, s49, 71424
    buffer_load_dword v46, v12, s[20:23], s17 offen
    buffer_load_dword v47, v13, s[20:23], s17 offen
    s_add_u32 s17, s49, 82944
    buffer_load_dword v48, v12, s[20:23], s17 offen
    buffer_load_dword v49, v13, s[20:23], s17 offen
    s_add_u32 s17, s49, 85248
    buffer_load_dword v50, v12, s[20:23], s17 offen
    buffer_load_dword v51, v13, s[20:23], s17 offen
    s_add_u32 s17, s49, 87552
    buffer_load_dword v52, v12, s[20:23], s17 offen
    buffer_load_dword v53, v13, s[20:23], s17 offen
    s_add_u32 s17, s49, 89856
    buffer_load_dword v54, v12, s[20:23], s17 offen
    buffer_load_dword v55, v13, s[20:23], s17 offen
    s_add_u32 s17, s49, 105984
    buffer_load_dword v56, v12, s[20:23], s17 offen
    buffer_load_dword v57, v13, s[20:23], s17 offen
    s_add_u32 s17, s49, 108288
    buffer_load_dword v58, v12, s[20:23], s17 offen
    buffer_load_dword v59, v13, s[20:23], s17 offen
    s_add_u32 s17, s49, 110592
    buffer_load_dword v60, v12, s[20:23], s17 offen
    buffer_load_dword v61, v13, s[20:23], s17 offen
    s_add_u32 s17, s49, 112896
    buffer_load_dword v62, v12, s[20:23], s17 offen
    buffer_load_dword v63, v13, s[20:23], s17 offen
    s_add_u32 s17, s49, 124416
    buffer_load_dword v64, v12, s[20:23], s17 offen
    buffer_load_dword v65, v13, s[20:23], s17 offen
    s_add_u32 s17, s49, 126720
    buffer_load_dword v66, v12, s[20:23], s17 offen
    buffer_load_dword v67, v13, s[20:23], s17 offen
    s_add_u32 s17, s49, 129024
    buffer_load_dword v68, v12, s[20:23], s17 offen
    buffer_load_dword v69, v13, s[20:23], s17 offen
    s_add_u32 s17, s49, 131328
    buffer_load_dword v70, v12, s[20:23], s17 offen
    buffer_load_dword v71, v13, s[20:23], s17 offen
    s_add_u32 s17, s49, 147456
    buffer_load_dword v72, v12, s[20:23], s17 offen
    buffer_load_dword v73, v13, s[20:23], s17 offen
    s_waitcnt vmcnt(56)
    v_perm_b32 v112, v17, v16, v11
    s_add_u32 s17, s49, 149760
    buffer_load_dword v74, v12, s[20:23], s17 offen
    buffer_load_dword v75, v13, s[20:23], s17 offen
    s_waitcnt vmcnt(56)
    v_perm_b32 v113, v19, v18, v11
    s_add_u32 s17, s49, 152064
    buffer_load_dword v76, v12, s[20:23], s17 offen
    buffer_load_dword v77, v13, s[20:23], s17 offen
    s_waitcnt vmcnt(56)
    v_perm_b32 v114, v21, v20, v11
    s_add_u32 s17, s49, 154368
    buffer_load_dword v78, v12, s[20:23], s17 offen
    buffer_load_dword v79, v13, s[20:23], s17 offen
    s_waitcnt vmcnt(56)
    v_perm_b32 v115, v23, v22, v11
    s_add_u32 s17, s49, 165888
    buffer_load_dword v80, v12, s[20:23], s17 offen
    buffer_load_dword v81, v13, s[20:23], s17 offen
    s_waitcnt vmcnt(56)
    v_perm_b32 v116, v25, v24, v11
    s_add_u32 s17, s49, 168192
    buffer_load_dword v82, v12, s[20:23], s17 offen
    buffer_load_dword v83, v13, s[20:23], s17 offen
    s_waitcnt vmcnt(56)
    v_perm_b32 v117, v27, v26, v11
    s_add_u32 s17, s49, 170496
    buffer_load_dword v84, v12, s[20:23], s17 offen
    buffer_load_dword v85, v13, s[20:23], s17 offen
    s_waitcnt vmcnt(56)
    v_perm_b32 v118, v29, v28, v11
    s_add_u32 s17, s49, 172800
    buffer_load_dword v86, v12, s[20:23], s17 offen
    buffer_load_dword v87, v13, s[20:23], s17 offen
    s_waitcnt vmcnt(56)
    v_perm_b32 v119, v31, v30, v11
    s_add_u32 s17, s49, 188928
    buffer_load_dword v88, v12, s[20:23], s17 offen
    buffer_load_dword v89, v13, s[20:23], s17 offen
    s_waitcnt vmcnt(56)
    v_perm_b32 v120, v33, v32, v11
    s_add_u32 s17, s49, 191232
    buffer_load_dword v90, v12, s[20:23], s17 offen
    buffer_load_dword v91, v13, s[20:23], s17 offen
    s_waitcnt vmcnt(56)
    v_perm_b32 v121, v35, v34, v11
    s_add_u32 s17, s49, 193536
    buffer_load_dword v92, v12, s[20:23], s17 offen
    buffer_load_dword v93, v13, s[20:23], s17 offen
    s_waitcnt vmcnt(56)
    v_perm_b32 v122, v37, v36, v11
    s_add_u32 s17, s49, 195840
    buffer_load_dword v94, v12, s[20:23], s17 offen
    buffer_load_dword v95, v13, s[20:23], s17 offen
    s_waitcnt vmcnt(56)
    v_perm_b32 v123, v39, v38, v11
    s_add_u32 s17, s49, 207360
    buffer_load_dword v96, v12, s[20:23], s17 offen
    buffer_load_dword v97, v13, s[20:23], s17 offen
    s_waitcnt vmcnt(56)
    v_perm_b32 v124, v41, v40, v11
    s_add_u32 s17, s49, 209664
    buffer_load_dword v98, v12, s[20:23], s17 offen
    buffer_load_dword v99, v13, s[20:23], s17 offen
    s_waitcnt vmcnt(56)
    v_perm_b32 v125, v43, v42, v11
    s_add_u32 s17, s49, 211968
    buffer_load_dword v100, v12, s[20:23], s17 offen
    buffer_load_dword v101, v13, s[20:23], s17 offen
    s_waitcnt vmcnt(56)
    v_perm_b32 v126, v45, v44, v11
    s_add_u32 s17, s49, 214272
    buffer_load_dword v102, v12, s[20:23], s17 offen
    buffer_load_dword v103, v13, s[20:23], s17 offen
    s_waitcnt vmcnt(56)
    v_perm_b32 v127, v47, v46, v11
    s_add_u32 s17, s49, 230400
    buffer_load_dword v104, v12, s[20:23], s17 offen
    buffer_load_dword v105, v13, s[20:23], s17 offen
    s_waitcnt vmcnt(56)
    v_perm_b32 v128, v49, v48, v11
    s_add_u32 s17, s49, 232704
    buffer_load_dword v106, v12, s[20:23], s17 offen
    buffer_load_dword v107, v13, s[20:23], s17 offen
    s_waitcnt vmcnt(56)
    v_perm_b32 v129, v51, v50, v11
    s_add_u32 s17, s49, 235008
    buffer_load_dword v108, v12, s[20:23], s17 offen
    buffer_load_dword v109, v13, s[20:23], s17 offen
    s_waitcnt vmcnt(56)
    v_perm_b32 v130, v53, v52, v11
    s_add_u32 s17, s49, 237312
    buffer_load_dword v110, v12, s[20:23], s17 offen
    buffer_load_dword v111, v13, s[20:23], s17 offen
    s_waitcnt vmcnt(56)
    v_perm_b32 v131, v55, v54, v11
    s_add_u32 s17, s49, 248832
    buffer_load_dword v16, v12, s[20:23], s17 offen
    buffer_load_dword v17, v13, s[20:23], s17 offen
    s_waitcnt vmcnt(56)
    v_perm_b32 v132, v57, v56, v11
    s_add_u32 s17, s49, 251136
    buffer_load_dword v18, v12, s[20:23], s17 offen
    buffer_load_dword v19, v13, s[20:23], s17 offen
    s_waitcnt vmcnt(56)
    v_perm_b32 v133, v59, v58, v11
    s_add_u32 s17, s49, 253440
    buffer_load_dword v20, v12, s[20:23], s17 offen
    buffer_load_dword v21, v13, s[20:23], s17 offen
    s_waitcnt vmcnt(56)
    v_perm_b32 v134, v61, v60, v11
    s_add_u32 s17, s49, 255744
    buffer_load_dword v22, v12, s[20:23], s17 offen
    buffer_load_dword v23, v13, s[20:23], s17 offen
    s_waitcnt vmcnt(56)
    v_perm_b32 v135, v63, v62, v11
    s_add_u32 s17, s49, 271872
    buffer_load_dword v24, v12, s[20:23], s17 offen
    buffer_load_dword v25, v13, s[20:23], s17 offen
    s_waitcnt vmcnt(56)
    v_perm_b32 v136, v65, v64, v11
    s_add_u32 s17, s49, 274176
    buffer_load_dword v26, v12, s[20:23], s17 offen
    buffer_load_dword v27, v13, s[20:23], s17 offen
    s_waitcnt vmcnt(56)
    v_perm_b32 v137, v67, v66, v11
    s_add_u32 s17, s49, 276480
    buffer_load_dword v28, v12, s[20:23], s17 offen
    buffer_load_dword v29, v13, s[20:23], s17 offen
    s_waitcnt vmcnt(56)
    v_perm_b32 v138, v69, v68, v11
    s_add_u32 s17, s49, 278784
    buffer_load_dword v30, v12, s[20:23], s17 offen
    buffer_load_dword v31, v13, s[20:23], s17 offen
    s_waitcnt vmcnt(56)
    v_perm_b32 v139, v71, v70, v11
    s_add_u32 s17, s49, 290304
    buffer_load_dword v32, v12, s[20:23], s17 offen
    buffer_load_dword v33, v13, s[20:23], s17 offen
    s_waitcnt vmcnt(56)
    v_perm_b32 v140, v73, v72, v11
    s_add_u32 s17, s49, 292608
    buffer_load_dword v34, v12, s[20:23], s17 offen
    buffer_load_dword v35, v13, s[20:23], s17 offen
    s_waitcnt vmcnt(56)
    v_perm_b32 v141, v75, v74, v11
    s_add_u32 s17, s49, 294912
    buffer_load_dword v36, v12, s[20:23], s17 offen
    buffer_load_dword v37, v13, s[20:23], s17 offen
    s_waitcnt vmcnt(56)
    v_perm_b32 v142, v77, v76, v11
    s_add_u32 s17, s49, 297216
    buffer_load_dword v38, v12, s[20:23], s17 offen
    buffer_load_dword v39, v13, s[20:23], s17 offen
    s_waitcnt vmcnt(56)
    v_perm_b32 v143, v79, v78, v11
    s_add_u32 s17, s49, 313344
    buffer_load_dword v40, v12, s[20:23], s17 offen
    buffer_load_dword v41, v13, s[20:23], s17 offen
    s_waitcnt vmcnt(56)
    v_perm_b32 v144, v81, v80, v11
    s_add_u32 s17, s49, 315648
    buffer_load_dword v42, v12, s[20:23], s17 offen
    buffer_load_dword v43, v13, s[20:23], s17 offen
    s_waitcnt vmcnt(56)
    v_perm_b32 v145, v83, v82, v11
    s_add_u32 s17, s49, 317952
    buffer_load_dword v44, v12, s[20:23], s17 offen
    buffer_load_dword v45, v13, s[20:23], s17 offen
    s_waitcnt vmcnt(56)
    v_perm_b32 v146, v85, v84, v11
    s_add_u32 s17, s49, 320256
    buffer_load_dword v46, v12, s[20:23], s17 offen
    buffer_load_dword v47, v13, s[20:23], s17 offen
    s_waitcnt vmcnt(56)
    v_perm_b32 v147, v87, v86, v11
    s_add_u32 s17, s49, 331776
    buffer_load_dword v48, v12, s[20:23], s17 offen
    buffer_load_dword v49, v13, s[20:23], s17 offen
    s_waitcnt vmcnt(56)
    v_perm_b32 v148, v89, v88, v11
    s_add_u32 s17, s49, 334080
    buffer_load_dword v50, v12, s[20:23], s17 offen
    buffer_load_dword v51, v13, s[20:23], s17 offen
    s_waitcnt vmcnt(56)
    v_perm_b32 v149, v91, v90, v11
    s_add_u32 s17, s49, 336384
    buffer_load_dword v52, v12, s[20:23], s17 offen
    buffer_load_dword v53, v13, s[20:23], s17 offen
    s_waitcnt vmcnt(56)
    v_perm_b32 v150, v93, v92, v11
    s_add_u32 s17, s49, 338688
    buffer_load_dword v54, v12, s[20:23], s17 offen
    buffer_load_dword v55, v13, s[20:23], s17 offen
    s_waitcnt vmcnt(56)
    v_perm_b32 v151, v95, v94, v11
    s_add_u32 s17, s49, 354816
    buffer_load_dword v56, v12, s[20:23], s17 offen
    buffer_load_dword v57, v13, s[20:23], s17 offen
    s_waitcnt vmcnt(56)
    v_perm_b32 v152, v97, v96, v11
    s_add_u32 s17, s49, 357120
    buffer_load_dword v58, v12, s[20:23], s17 offen
    buffer_load_dword v59, v13, s[20:23], s17 offen
    s_waitcnt vmcnt(56)
    v_perm_b32 v153, v99, v98, v11
    s_add_u32 s17, s49, 359424
    buffer_load_dword v60, v12, s[20:23], s17 offen
    buffer_load_dword v61, v13, s[20:23], s17 offen
    s_waitcnt vmcnt(56)
    v_perm_b32 v154, v101, v100, v11
    s_add_u32 s17, s49, 361728
    buffer_load_dword v62, v12, s[20:23], s17 offen
    buffer_load_dword v63, v13, s[20:23], s17 offen
    s_waitcnt vmcnt(56)
    v_perm_b32 v155, v103, v102, v11
    s_add_u32 s17, s49, 373248
    buffer_load_dword v64, v12, s[20:23], s17 offen
    buffer_load_dword v65, v13, s[20:23], s17 offen
    s_waitcnt vmcnt(56)
    v_perm_b32 v156, v105, v104, v11
    s_add_u32 s17, s49, 375552
    buffer_load_dword v66, v12, s[20:23], s17 offen
    buffer_load_dword v67, v13, s[20:23], s17 offen
    s_waitcnt vmcnt(56)
    v_perm_b32 v157, v107, v106, v11
    s_add_u32 s17, s49, 377856
    buffer_load_dword v68, v12, s[20:23], s17 offen
    buffer_load_dword v69, v13, s[20:23], s17 offen
    s_waitcnt vmcnt(56)
    v_perm_b32 v158, v109, v108, v11
    s_add_u32 s17, s49, 380160
    buffer_load_dword v70, v12, s[20:23], s17 offen
    buffer_load_dword v71, v13, s[20:23], s17 offen
    s_waitcnt vmcnt(56)
    v_perm_b32 v159, v111, v110, v11
    s_add_u32 s17, s49, 396288
    buffer_load_dword v72, v12, s[20:23], s17 offen
    buffer_load_dword v73, v13, s[20:23], s17 offen
    s_waitcnt vmcnt(56)
    v_perm_b32 v160, v17, v16, v11
    s_add_u32 s17, s49, 398592
    buffer_load_dword v74, v12, s[20:23], s17 offen
    buffer_load_dword v75, v13, s[20:23], s17 offen
    s_waitcnt vmcnt(56)
    v_perm_b32 v161, v19, v18, v11
    s_add_u32 s17, s49, 400896
    buffer_load_dword v76, v12, s[20:23], s17 offen
    buffer_load_dword v77, v13, s[20:23], s17 offen
    s_waitcnt vmcnt(56)
    v_perm_b32 v162, v21, v20, v11
    s_add_u32 s17, s49, 403200
    buffer_load_dword v78, v12, s[20:23], s17 offen
    buffer_load_dword v79, v13, s[20:23], s17 offen
    s_waitcnt vmcnt(56)
    v_perm_b32 v163, v23, v22, v11
    s_add_u32 s17, s49, 414720
    buffer_load_dword v80, v12, s[20:23], s17 offen
    buffer_load_dword v81, v13, s[20:23], s17 offen
    s_waitcnt vmcnt(56)
    v_perm_b32 v164, v25, v24, v11
    s_add_u32 s17, s49, 417024
    buffer_load_dword v82, v12, s[20:23], s17 offen
    buffer_load_dword v83, v13, s[20:23], s17 offen
    s_waitcnt vmcnt(56)
    v_perm_b32 v165, v27, v26, v11
    s_add_u32 s17, s49, 419328
    buffer_load_dword v84, v12, s[20:23], s17 offen
    buffer_load_dword v85, v13, s[20:23], s17 offen
    s_waitcnt vmcnt(56)
    v_perm_b32 v166, v29, v28, v11
    s_add_u32 s17, s49, 421632
    buffer_load_dword v86, v12, s[20:23], s17 offen
    buffer_load_dword v87, v13, s[20:23], s17 offen
    s_waitcnt vmcnt(56)
    v_perm_b32 v167, v31, v30, v11
    s_add_u32 s17, s49, 437760
    buffer_load_dword v88, v12, s[20:23], s17 offen
    buffer_load_dword v89, v13, s[20:23], s17 offen
    s_waitcnt vmcnt(56)
    v_perm_b32 v168, v33, v32, v11
    s_add_u32 s17, s49, 440064
    buffer_load_dword v90, v12, s[20:23], s17 offen
    buffer_load_dword v91, v13, s[20:23], s17 offen
    s_waitcnt vmcnt(56)
    v_perm_b32 v169, v35, v34, v11
    s_add_u32 s17, s49, 442368
    buffer_load_dword v92, v12, s[20:23], s17 offen
    buffer_load_dword v93, v13, s[20:23], s17 offen
    s_waitcnt vmcnt(56)
    v_perm_b32 v170, v37, v36, v11
    s_add_u32 s17, s49, 444672
    buffer_load_dword v94, v12, s[20:23], s17 offen
    buffer_load_dword v95, v13, s[20:23], s17 offen
    s_waitcnt vmcnt(56)
    v_perm_b32 v171, v39, v38, v11
    s_add_u32 s17, s49, 456192
    buffer_load_dword v96, v12, s[20:23], s17 offen
    buffer_load_dword v97, v13, s[20:23], s17 offen
    s_waitcnt vmcnt(56)
    v_perm_b32 v172, v41, v40, v11
    s_add_u32 s17, s49, 458496
    buffer_load_dword v98, v12, s[20:23], s17 offen
    buffer_load_dword v99, v13, s[20:23], s17 offen
    s_waitcnt vmcnt(56)
    v_perm_b32 v173, v43, v42, v11
    s_add_u32 s17, s49, 460800
    buffer_load_dword v100, v12, s[20:23], s17 offen
    buffer_load_dword v101, v13, s[20:23], s17 offen
    s_waitcnt vmcnt(56)
    v_perm_b32 v174, v45, v44, v11
    s_add_u32 s17, s49, 463104
    buffer_load_dword v102, v12, s[20:23], s17 offen
    buffer_load_dword v103, v13, s[20:23], s17 offen
    s_waitcnt vmcnt(56)
    v_perm_b32 v175, v47, v46, v11
    s_add_u32 s17, s49, 479232
    buffer_load_dword v104, v12, s[20:23], s17 offen
    buffer_load_dword v105, v13, s[20:23], s17 offen
    s_waitcnt vmcnt(56)
    v_perm_b32 v176, v49, v48, v11
    s_add_u32 s17, s49, 481536
    buffer_load_dword v106, v12, s[20:23], s17 offen
    buffer_load_dword v107, v13, s[20:23], s17 offen
    s_waitcnt vmcnt(56)
    v_perm_b32 v177, v51, v50, v11
    s_add_u32 s17, s49, 483840
    buffer_load_dword v108, v12, s[20:23], s17 offen
    buffer_load_dword v109, v13, s[20:23], s17 offen
    s_waitcnt vmcnt(56)
    v_perm_b32 v178, v53, v52, v11
    s_add_u32 s17, s49, 486144
    buffer_load_dword v110, v12, s[20:23], s17 offen
    buffer_load_dword v111, v13, s[20:23], s17 offen
    s_waitcnt vmcnt(56)
    v_perm_b32 v179, v55, v54, v11
    s_add_u32 s17, s49, 497664
    buffer_load_dword v16, v12, s[20:23], s17 offen
    buffer_load_dword v17, v13, s[20:23], s17 offen
    s_waitcnt vmcnt(56)
    v_perm_b32 v180, v57, v56, v11
    s_add_u32 s17, s49, 499968
    buffer_load_dword v18, v12, s[20:23], s17 offen
    buffer_load_dword v19, v13, s[20:23], s17 offen
    s_waitcnt vmcnt(56)
    v_perm_b32 v181, v59, v58, v11
    s_add_u32 s17, s49, 502272
    buffer_load_dword v20, v12, s[20:23], s17 offen
    buffer_load_dword v21, v13, s[20:23], s17 offen
    s_waitcnt vmcnt(56)
    v_perm_b32 v182, v61, v60, v11
    s_add_u32 s17, s49, 504576
    buffer_load_dword v22, v12, s[20:23], s17 offen
    buffer_load_dword v23, v13, s[20:23], s17 offen
    s_waitcnt vmcnt(56)
    v_perm_b32 v183, v63, v62, v11
    s_add_u32 s17, s49, 520704
    buffer_load_dword v24, v12, s[20:23], s17 offen
    buffer_load_dword v25, v13, s[20:23], s17 offen
    s_waitcnt vmcnt(56)
    v_perm_b32 v184, v65, v64, v11
    s_add_u32 s17, s49, 523008
    buffer_load_dword v26, v12, s[20:23], s17 offen
    buffer_load_dword v27, v13, s[20:23], s17 offen
    s_waitcnt vmcnt(56)
    v_perm_b32 v185, v67, v66, v11
    s_add_u32 s17, s49, 525312
    buffer_load_dword v28, v12, s[20:23], s17 offen
    buffer_load_dword v29, v13, s[20:23], s17 offen
    s_waitcnt vmcnt(56)
    v_perm_b32 v186, v69, v68, v11
    s_add_u32 s17, s49, 527616
    buffer_load_dword v30, v12, s[20:23], s17 offen
    buffer_load_dword v31, v13, s[20:23], s17 offen
    s_waitcnt vmcnt(56)
    v_perm_b32 v187, v71, v70, v11
    s_add_u32 s17, s49, 539136
    buffer_load_dword v32, v12, s[20:23], s17 offen
    buffer_load_dword v33, v13, s[20:23], s17 offen
    s_waitcnt vmcnt(56)
    v_perm_b32 v188, v73, v72, v11
    s_add_u32 s17, s49, 541440
    buffer_load_dword v34, v12, s[20:23], s17 offen
    buffer_load_dword v35, v13, s[20:23], s17 offen
    s_waitcnt vmcnt(56)
    v_perm_b32 v189, v75, v74, v11
    s_add_u32 s17, s49, 543744
    buffer_load_dword v36, v12, s[20:23], s17 offen
    buffer_load_dword v37, v13, s[20:23], s17 offen
    s_waitcnt vmcnt(56)
    v_perm_b32 v190, v77, v76, v11
    s_add_u32 s17, s49, 546048
    buffer_load_dword v38, v12, s[20:23], s17 offen
    buffer_load_dword v39, v13, s[20:23], s17 offen
    s_waitcnt vmcnt(56)
    v_perm_b32 v191, v79, v78, v11
    s_add_u32 s17, s49, 562176
    buffer_load_dword v40, v12, s[20:23], s17 offen
    buffer_load_dword v41, v13, s[20:23], s17 offen
    s_waitcnt vmcnt(56)
    v_perm_b32 v192, v81, v80, v11
    s_add_u32 s17, s49, 564480
    buffer_load_dword v42, v12, s[20:23], s17 offen
    buffer_load_dword v43, v13, s[20:23], s17 offen
    s_waitcnt vmcnt(56)
    v_perm_b32 v193, v83, v82, v11
    s_add_u32 s17, s49, 566784
    buffer_load_dword v44, v12, s[20:23], s17 offen
    buffer_load_dword v45, v13, s[20:23], s17 offen
    s_waitcnt vmcnt(56)
    v_perm_b32 v194, v85, v84, v11
    s_add_u32 s17, s49, 569088
    buffer_load_dword v46, v12, s[20:23], s17 offen
    buffer_load_dword v47, v13, s[20:23], s17 offen
    s_waitcnt vmcnt(56)
    v_perm_b32 v195, v87, v86, v11
    s_add_u32 s17, s49, 580608
    buffer_load_dword v48, v12, s[20:23], s17 offen
    buffer_load_dword v49, v13, s[20:23], s17 offen
    s_waitcnt vmcnt(56)
    v_perm_b32 v196, v89, v88, v11
    s_add_u32 s17, s49, 582912
    buffer_load_dword v50, v12, s[20:23], s17 offen
    buffer_load_dword v51, v13, s[20:23], s17 offen
    s_waitcnt vmcnt(56)
    v_perm_b32 v197, v91, v90, v11
    s_add_u32 s17, s49, 585216
    buffer_load_dword v52, v12, s[20:23], s17 offen
    buffer_load_dword v53, v13, s[20:23], s17 offen
    s_waitcnt vmcnt(56)
    v_perm_b32 v198, v93, v92, v11
    s_add_u32 s17, s49, 587520
    buffer_load_dword v54, v12, s[20:23], s17 offen
    buffer_load_dword v55, v13, s[20:23], s17 offen
    s_waitcnt vmcnt(56)
    v_perm_b32 v199, v95, v94, v11
    s_add_u32 s17, s49, 603648
    buffer_load_dword v56, v12, s[20:23], s17 offen
    buffer_load_dword v57, v13, s[20:23], s17 offen
    s_waitcnt vmcnt(56)
    v_perm_b32 v200, v97, v96, v11
    s_add_u32 s17, s49, 605952
    buffer_load_dword v58, v12, s[20:23], s17 offen
    buffer_load_dword v59, v13, s[20:23], s17 offen
    s_waitcnt vmcnt(56)
    v_perm_b32 v201, v99, v98, v11
    s_add_u32 s17, s49, 608256
    buffer_load_dword v60, v12, s[20:23], s17 offen
    buffer_load_dword v61, v13, s[20:23], s17 offen
    s_waitcnt vmcnt(56)
    v_perm_b32 v202, v101, v100, v11
    s_add_u32 s17, s49, 610560
    buffer_load_dword v62, v12, s[20:23], s17 offen
    buffer_load_dword v63, v13, s[20:23], s17 offen
    s_waitcnt vmcnt(56)
    v_perm_b32 v203, v103, v102, v11
    s_add_u32 s17, s49, 622080
    buffer_load_dword v64, v12, s[20:23], s17 offen
    buffer_load_dword v65, v13, s[20:23], s17 offen
    s_waitcnt vmcnt(56)
    v_perm_b32 v204, v105, v104, v11
    s_add_u32 s17, s49, 624384
    buffer_load_dword v66, v12, s[20:23], s17 offen
    buffer_load_dword v67, v13, s[20:23], s17 offen
    s_waitcnt vmcnt(56)
    v_perm_b32 v205, v107, v106, v11
    s_add_u32 s17, s49, 626688
    buffer_load_dword v68, v12, s[20:23], s17 offen
    buffer_load_dword v69, v13, s[20:23], s17 offen
    s_waitcnt vmcnt(56)
    v_perm_b32 v206, v109, v108, v11
    s_add_u32 s17, s49, 628992
    buffer_load_dword v70, v12, s[20:23], s17 offen
    buffer_load_dword v71, v13, s[20:23], s17 offen
    s_waitcnt vmcnt(56)
    v_perm_b32 v207, v111, v110, v11
    s_add_u32 s17, s49, 645120
    buffer_load_dword v72, v12, s[20:23], s17 offen
    buffer_load_dword v73, v13, s[20:23], s17 offen
    s_waitcnt vmcnt(56)
    v_perm_b32 v208, v17, v16, v11
    s_add_u32 s17, s49, 647424
    buffer_load_dword v74, v12, s[20:23], s17 offen
    buffer_load_dword v75, v13, s[20:23], s17 offen
    s_waitcnt vmcnt(56)
    v_perm_b32 v209, v19, v18, v11
    s_add_u32 s17, s49, 649728
    buffer_load_dword v76, v12, s[20:23], s17 offen
    buffer_load_dword v77, v13, s[20:23], s17 offen
    s_waitcnt vmcnt(56)
    v_perm_b32 v210, v21, v20, v11
    s_add_u32 s17, s49, 652032
    buffer_load_dword v78, v12, s[20:23], s17 offen
    buffer_load_dword v79, v13, s[20:23], s17 offen
    s_waitcnt vmcnt(56)
    v_perm_b32 v211, v23, v22, v11
    s_waitcnt vmcnt(54)
    v_perm_b32 v212, v25, v24, v11
    s_waitcnt vmcnt(52)
    v_perm_b32 v213, v27, v26, v11
    s_waitcnt vmcnt(50)
    v_perm_b32 v214, v29, v28, v11
    s_waitcnt vmcnt(48)
    v_perm_b32 v215, v31, v30, v11
    s_waitcnt vmcnt(46)
    v_perm_b32 v216, v33, v32, v11
    s_waitcnt vmcnt(44)
    v_perm_b32 v217, v35, v34, v11
    s_waitcnt vmcnt(42)
    v_perm_b32 v218, v37, v36, v11
    s_waitcnt vmcnt(40)
    v_perm_b32 v219, v39, v38, v11
    s_waitcnt vmcnt(38)
    v_perm_b32 v220, v41, v40, v11
    s_waitcnt vmcnt(36)
    v_perm_b32 v221, v43, v42, v11
    s_waitcnt vmcnt(34)
    v_perm_b32 v222, v45, v44, v11
    s_waitcnt vmcnt(32)
    v_perm_b32 v223, v47, v46, v11
    s_waitcnt vmcnt(30)
    v_perm_b32 v224, v49, v48, v11
    s_waitcnt vmcnt(28)
    v_perm_b32 v225, v51, v50, v11
    s_waitcnt vmcnt(26)
    v_perm_b32 v226, v53, v52, v11
    s_waitcnt vmcnt(24)
    v_perm_b32 v227, v55, v54, v11
    s_waitcnt vmcnt(22)
    v_perm_b32 v228, v57, v56, v11
    s_waitcnt vmcnt(20)
    v_perm_b32 v229, v59, v58, v11
    s_waitcnt vmcnt(18)
    v_perm_b32 v230, v61, v60, v11
    s_waitcnt vmcnt(16)
    v_perm_b32 v231, v63, v62, v11
    s_waitcnt vmcnt(14)
    v_perm_b32 v232, v65, v64, v11
    s_waitcnt vmcnt(12)
    v_perm_b32 v233, v67, v66, v11
    s_waitcnt vmcnt(10)
    v_perm_b32 v234, v69, v68, v11
    s_waitcnt vmcnt(8)
    v_perm_b32 v235, v71, v70, v11
    s_waitcnt vmcnt(6)
    v_perm_b32 v236, v73, v72, v11
    s_waitcnt vmcnt(4)
    v_perm_b32 v237, v75, v74, v11
    s_waitcnt vmcnt(2)
    v_perm_b32 v238, v77, v76, v11
    s_waitcnt vmcnt(0)
    v_perm_b32 v239, v79, v78, v11
    v_mul_u32_u24 v5, 82944, v9
    v_add_u32 v12, v5, v14
    v_add_u32 v13, 1152, v12
    s_add_u32 s17, s49, 18432
    buffer_load_dword v16, v12, s[20:23], s17 offen
    buffer_load_dword v17, v13, s[20:23], s17 offen
    s_add_u32 s17, s49, 20736
    buffer_load_dword v18, v12, s[20:23], s17 offen
    buffer_load_dword v19, v13, s[20:23], s17 offen
    s_add_u32 s17, s49, 59904
    buffer_load_dword v20, v12, s[20:23], s17 offen
    buffer_load_dword v21, v13, s[20:23], s17 offen
    s_add_u32 s17, s49, 62208
    buffer_load_dword v22, v12, s[20:23], s17 offen
    buffer_load_dword v23, v13, s[20:23], s17 offen
    s_add_u32 s17, s49, 184320
    buffer_load_dword v24, v12, s[20:23], s17 offen
    buffer_load_dword v25, v13, s[20:23], s17 offen
    s_add_u32 s17, s49, 186624
    buffer_load_dword v26, v12, s[20:23], s17 offen
    buffer_load_dword v27, v13, s[20:23], s17 offen
    s_add_u32 s17, s49, 225792
    buffer_load_dword v28, v12, s[20:23], s17 offen
    buffer_load_dword v29, v13, s[20:23], s17 offen
    s_add_u32 s17, s49, 228096
    buffer_load_dword v30, v12, s[20:23], s17 offen
    buffer_load_dword v31, v13, s[20:23], s17 offen
    s_add_u32 s17, s49, 350208
    buffer_load_dword v32, v12, s[20:23], s17 offen
    buffer_load_dword v33, v13, s[20:23], s17 offen
    s_add_u32 s17, s49, 352512
    buffer_load_dword v34, v12, s[20:23], s17 offen
    buffer_load_dword v35, v13, s[20:23], s17 offen
    s_add_u32 s17, s49, 391680
    buffer_load_dword v36, v12, s[20:23], s17 offen
    buffer_load_dword v37, v13, s[20:23], s17 offen
    s_add_u32 s17, s49, 393984
    buffer_load_dword v38, v12, s[20:23], s17 offen
    buffer_load_dword v39, v13, s[20:23], s17 offen
    s_add_u32 s17, s49, 516096
    buffer_load_dword v40, v12, s[20:23], s17 offen
    buffer_load_dword v41, v13, s[20:23], s17 offen
    s_add_u32 s17, s49, 518400
    buffer_load_dword v42, v12, s[20:23], s17 offen
    buffer_load_dword v43, v13, s[20:23], s17 offen
    s_add_u32 s17, s49, 557568
    buffer_load_dword v44, v12, s[20:23], s17 offen
    buffer_load_dword v45, v13, s[20:23], s17 offen
    s_add_u32 s17, s49, 559872
    buffer_load_dword v46, v12, s[20:23], s17 offen
    buffer_load_dword v47, v13, s[20:23], s17 offen
    s_waitcnt vmcnt(30)
    v_perm_b32 v240, v17, v16, v11
    s_waitcnt vmcnt(28)
    v_perm_b32 v241, v19, v18, v11
    s_waitcnt vmcnt(26)
    v_perm_b32 v242, v21, v20, v11
    s_waitcnt vmcnt(24)
    v_perm_b32 v243, v23, v22, v11
    s_waitcnt vmcnt(22)
    v_perm_b32 v244, v25, v24, v11
    s_waitcnt vmcnt(20)
    v_perm_b32 v245, v27, v26, v11
    s_waitcnt vmcnt(18)
    v_perm_b32 v246, v29, v28, v11
    s_waitcnt vmcnt(16)
    v_perm_b32 v247, v31, v30, v11
    s_waitcnt vmcnt(14)
    v_perm_b32 v248, v33, v32, v11
    s_waitcnt vmcnt(12)
    v_perm_b32 v249, v35, v34, v11
    s_waitcnt vmcnt(10)
    v_perm_b32 v250, v37, v36, v11
    s_waitcnt vmcnt(8)
    v_perm_b32 v251, v39, v38, v11
    s_waitcnt vmcnt(6)
    v_perm_b32 v252, v41, v40, v11
    s_waitcnt vmcnt(4)
    v_perm_b32 v253, v43, v42, v11
    s_waitcnt vmcnt(2)
    v_perm_b32 v254, v45, v44, v11
    s_waitcnt vmcnt(0)
    v_perm_b32 v255, v47, v46, v11
    v_lshlrev_b32 v10, 4, v10
    v_lshl_add_u32 v14, v9, 9, v10
    s_lshl_b32 s17, s50, 11
    v_add_u32 v14, s17, v14
    s_lshr_b32 s17, s50, 1
    s_lshl_b32 s17, s17, 9
    s_and_b32 s18, s50, 1
    s_lshl_b32 s18, s18, 3
    s_add_u32 s17, s17, s18
    v_add_u32 v10, s17, v10
    s_lshr_b32 s49, s50, 2
    s_lshl_b32 s49, s49, 7
    s_and_b32 s17, s50, 3
    s_lshl_b32 s17, s17, 2
    s_add_u32 s49, s49, s17
    s_add_u32 s49, s49, 183808
    s_mov_b32 s36, s63
    s_mov_b32 s34, s63
    s_mov_b32 s37, 0
    s_lshl_b32 s56, s63, 6
    s_mul_i32 s58, s14, 9216
    s_mov_b32 s40, 36864
    s_mov_b32 s59, s58
    s_mov_b32 s43, 0
    s_mov_b32 s28, s8
    s_mov_b32 s29, s9
    s_mov_b32 s30, 0
    s_mov_b32 s31, 0x00020000
    s_mul_i32 s41, s63, 2359296
    s_add_u32 s41, s41, s58
    s_add_u32 s41, s41, 17301504
    s_mul_i32 s42, s56, 22528
    s_add_u32 s42, s42, 181760
    s_cmp_lg_u32 s14, 0
    s_cbranch_scc1 Lawo_ini_d
    v_mov_b32 v5, 160
    s_mov_b32 s16, 0
Lawo_ini:
    global_load_dword v6, v5, s[12:13] sc1
    s_add_u32 s16, s16, 1
    s_cmp_gt_u32 s16, 100000
    s_cbranch_scc1 L_role_awo_abort
    s_waitcnt vmcnt(0)
    v_cmp_gt_u32 vcc, 123, v6
    s_nop 0
    s_cbranch_vccz Lawo_ini_d
    s_sleep 8
    s_branch Lawo_ini
Lawo_ini_d:
    s_barrier
    s_branch Lawo_poll
Lawo_item:
    s_waitcnt vmcnt(3)
Lawo_go:
    s_barrier
    s_xor_b32 s40, s40, 36864
    s_xor_b32 s59, s59, 36864
    s_xor_b32 s66, s66, 0x2000
    s_xor_b32 s71, s71, 0x2000
    s_mov_b32 s35, s37
    s_mov_b32 s57, s56
    s_add_u32 s37, s37, 1
    s_add_u32 s56, s56, 1
    s_add_u32 s41, s41, 36864
    s_add_u32 s42, s42, 22528
    s_mov_b32 s62, 0
    v_add_u32 v9, s40, v0
    ds_read_b128 v[32:35], v9 offset:0
    ds_read_b128 v[36:39], v9 offset:1024
    ds_read_b128 v[40:43], v9 offset:2048
    ds_read_b128 v[44:47], v9 offset:3072
    ds_read_b128 v[48:51], v9 offset:4096
    ds_read_b128 v[52:55], v9 offset:5120
    ds_read_b128 v[56:59], v9 offset:6144
    v_lshlrev_b32 v16, 16, v64
    v_and_b32 v17, 0xffff0000, v64
    v_lshlrev_b32 v18, 16, v65
    v_and_b32 v19, 0xffff0000, v65
    v_lshlrev_b32 v20, 16, v66
    v_and_b32 v21, 0xffff0000, v66
    v_lshlrev_b32 v22, 16, v67
    v_and_b32 v23, 0xffff0000, v67
    v_lshlrev_b32 v24, 16, v68
    v_and_b32 v25, 0xffff0000, v68
    v_lshlrev_b32 v26, 16, v69
    v_and_b32 v27, 0xffff0000, v69
    v_lshlrev_b32 v28, 16, v70
    v_and_b32 v29, 0xffff0000, v70
    v_lshlrev_b32 v30, 16, v71
    v_and_b32 v31, 0xffff0000, v71
    s_waitcnt lgkmcnt(6)
    s_nop 0
    v_mfma_f32_32x32x16_bf16 v[16:31], v[112:115], v[32:35], v[16:31]
    ds_read_b128 v[60:63], v9 offset:7168
    s_mul_i32 s46, s34, 4718592
    s_waitcnt lgkmcnt(6)
    v_mfma_f32_32x32x16_bf16 v[16:31], v[116:119], v[36:39], v[16:31]
    ds_read_b128 v[32:35], v9 offset:8192
    s_mul_i32 s51, s35, 36864
    s_waitcnt lgkmcnt(6)
    v_mfma_f32_32x32x16_bf16 v[16:31], v[120:123], v[40:43], v[16:31]
    ds_read_b128 v[36:39], v9 offset:9216
    s_add_u32 s46, s46, s51
    s_waitcnt lgkmcnt(6)
    v_mfma_f32_32x32x16_bf16 v[16:31], v[124:127], v[44:47], v[16:31]
    ds_read_b128 v[40:43], v9 offset:10240
    s_add_u32 s46, s46, 8650752
    s_waitcnt lgkmcnt(6)
    v_mfma_f32_32x32x16_bf16 v[16:31], v[128:131], v[48:51], v[16:31]
    ds_read_b128 v[44:47], v9 offset:11264
    s_mul_i32 s52, s34, 786432
    s_waitcnt lgkmcnt(6)
    v_mfma_f32_32x32x16_bf16 v[16:31], v[132:135], v[52:55], v[16:31]
    ds_read_b128 v[48:51], v9 offset:12288
    s_mul_i32 s51, s35, 6144
    s_waitcnt lgkmcnt(6)
    v_mfma_f32_32x32x16_bf16 v[16:31], v[136:139], v[56:59], v[16:31]
    ds_read_b128 v[52:55], v9 offset:13312
    s_add_u32 s52, s52, s51
    s_waitcnt lgkmcnt(6)
    v_mfma_f32_32x32x16_bf16 v[16:31], v[140:143], v[60:63], v[16:31]
    ds_read_b128 v[56:59], v9 offset:14336
    s_add_u32 s52, s52, 16121856
    s_waitcnt lgkmcnt(6)
    v_mfma_f32_32x32x16_bf16 v[16:31], v[144:147], v[32:35], v[16:31]
    ds_read_b128 v[60:63], v9 offset:15360
    s_waitcnt lgkmcnt(6)
    v_mfma_f32_32x32x16_bf16 v[16:31], v[148:151], v[36:39], v[16:31]
    ds_read_b128 v[32:35], v9 offset:16384
    s_waitcnt lgkmcnt(6)
    v_mfma_f32_32x32x16_bf16 v[16:31], v[152:155], v[40:43], v[16:31]
    ds_read_b128 v[36:39], v9 offset:17408
    s_waitcnt lgkmcnt(6)
    v_mfma_f32_32x32x16_bf16 v[16:31], v[156:159], v[44:47], v[16:31]
    ds_read_b128 v[40:43], v9 offset:18432
    s_waitcnt lgkmcnt(6)
    v_mfma_f32_32x32x16_bf16 v[16:31], v[160:163], v[48:51], v[16:31]
    ds_read_b128 v[44:47], v9 offset:19456
    s_waitcnt lgkmcnt(6)
    v_mfma_f32_32x32x16_bf16 v[16:31], v[164:167], v[52:55], v[16:31]
    ds_read_b128 v[48:51], v9 offset:20480
    s_waitcnt lgkmcnt(6)
    v_mfma_f32_32x32x16_bf16 v[16:31], v[168:171], v[56:59], v[16:31]
    ds_read_b128 v[52:55], v9 offset:21504
    s_waitcnt vmcnt(0)
    buffer_load_dword v2, v1, s[8:11], s42 offen sc1
    s_cmp_lg_u32 s43, 0
    s_cselect_b64 exec, 1, 0
    buffer_store_dword v3, v4, s[8:11], s43 offen sc1
    s_mov_b64 exec, -1
    s_mov_b32 s43, 0
    s_waitcnt lgkmcnt(6)
    v_mfma_f32_32x32x16_bf16 v[16:31], v[172:175], v[60:63], v[16:31]
    ds_read_b128 v[56:59], v9 offset:22528
    s_waitcnt lgkmcnt(6)
    v_mfma_f32_32x32x16_bf16 v[16:31], v[176:179], v[32:35], v[16:31]
    ds_read_b128 v[60:63], v9 offset:23552
    s_waitcnt lgkmcnt(6)
    v_mfma_f32_32x32x16_bf16 v[16:31], v[180:183], v[36:39], v[16:31]
    ds_read_b128 v[32:35], v9 offset:24576
    s_waitcnt lgkmcnt(6)
    v_mfma_f32_32x32x16_bf16 v[16:31], v[184:187], v[40:43], v[16:31]
    ds_read_b128 v[36:39], v9 offset:25600
    s_waitcnt lgkmcnt(6)
    v_mfma_f32_32x32x16_bf16 v[16:31], v[188:191], v[44:47], v[16:31]
    ds_read_b128 v[40:43], v9 offset:26624
    s_waitcnt lgkmcnt(6)
    v_mfma_f32_32x32x16_bf16 v[16:31], v[192:195], v[48:51], v[16:31]
    ds_read_b128 v[44:47], v9 offset:27648
    s_waitcnt lgkmcnt(6)
    v_mfma_f32_32x32x16_bf16 v[16:31], v[196:199], v[52:55], v[16:31]
    ds_read_b128 v[48:51], v9 offset:28672
    s_waitcnt lgkmcnt(6)
    v_mfma_f32_32x32x16_bf16 v[16:31], v[200:203], v[56:59], v[16:31]
    ds_read_b128 v[52:55], v9 offset:29696
    s_waitcnt lgkmcnt(6)
    v_mfma_f32_32x32x16_bf16 v[16:31], v[204:207], v[60:63], v[16:31]
    ds_read_b128 v[56:59], v9 offset:30720
    s_waitcnt lgkmcnt(6)
    v_mfma_f32_32x32x16_bf16 v[16:31], v[208:211], v[32:35], v[16:31]
    ds_read_b128 v[60:63], v9 offset:31744
    s_waitcnt lgkmcnt(6)
    v_mfma_f32_32x32x16_bf16 v[16:31], v[212:215], v[36:39], v[16:31]
    ds_read_b128 v[32:35], v9 offset:32768
    s_waitcnt lgkmcnt(6)
    v_mfma_f32_32x32x16_bf16 v[16:31], v[216:219], v[40:43], v[16:31]
    ds_read_b128 v[36:39], v9 offset:33792
    s_waitcnt lgkmcnt(6)
    v_mfma_f32_32x32x16_bf16 v[16:31], v[220:223], v[44:47], v[16:31]
    ds_read_b128 v[40:43], v9 offset:34816
    s_waitcnt lgkmcnt(6)
    v_mfma_f32_32x32x16_bf16 v[16:31], v[224:227], v[48:51], v[16:31]
    ds_read_b128 v[44:47], v9 offset:35840
    s_waitcnt lgkmcnt(6)
    v_mfma_f32_32x32x16_bf16 v[16:31], v[228:231], v[52:55], v[16:31]
    s_waitcnt lgkmcnt(5)
    v_mfma_f32_32x32x16_bf16 v[16:31], v[232:235], v[56:59], v[16:31]
    s_waitcnt lgkmcnt(4)
    v_mfma_f32_32x32x16_bf16 v[16:31], v[236:239], v[60:63], v[16:31]
    s_waitcnt lgkmcnt(3)
    v_mfma_f32_32x32x16_bf16 v[16:31], v[240:243], v[32:35], v[16:31]
    s_waitcnt vmcnt(1)
    v_cmp_eq_u32 vcc, 0, v2
    s_nop 0
    s_cmp_eq_u64 vcc, 0
    s_cselect_b32 s62, 1, 0
    s_cmp_lt_u32 s37, 64
    s_cselect_b32 s62, s62, 0
    s_cmp_lg_u32 s62, 0
    s_cselect_b32 s30, 268435456, 0
    s_waitcnt lgkmcnt(2)
    v_mfma_f32_32x32x16_bf16 v[16:31], v[244:247], v[36:39], v[16:31]
    s_add_u32 m0, s59, 0
    s_add_u32 s47, s41, 0
    buffer_load_dwordx4 v0, s[28:31], s47 offen offset:0 lds
    buffer_load_dwordx4 v0, s[28:31], s47 offen offset:1024 lds
    s_waitcnt lgkmcnt(1)
    v_mfma_f32_32x32x16_bf16 v[16:31], v[248:251], v[40:43], v[16:31]
    buffer_load_dwordx4 v0, s[28:31], s47 offen offset:2048 lds
    buffer_load_dwordx4 v0, s[28:31], s47 offen offset:3072 lds
    s_waitcnt lgkmcnt(0)
    v_mfma_f32_32x32x16_bf16 v[16:31], v[252:255], v[44:47], v[16:31]
    s_add_u32 m0, s59, 4096
    s_add_u32 s47, s41, 4096
    buffer_load_dwordx4 v0, s[28:31], s47 offen offset:0 lds
    buffer_load_dwordx4 v0, s[28:31], s47 offen offset:1024 lds
    buffer_load_dwordx4 v0, s[28:31], s47 offen offset:2048 lds
    buffer_load_dwordx4 v0, s[28:31], s47 offen offset:3072 lds
    s_add_u32 m0, s59, 8192
    s_add_u32 s47, s41, 8192
    buffer_load_dwordx4 v0, s[28:31], s47 offen offset:0 lds
    s_mul_i32 s48, s36, 4718592
    s_mul_i32 s18, s37, 36864
    s_add_u32 s48, s48, s18
    s_add_u32 s48, s48, 6291456
    buffer_load_dwordx4 v[64:67], v14, s[28:31], s48 offen offset:0
    buffer_load_dwordx4 v[68:71], v14, s[28:31], s48 offen offset:1024
    v_cvt_pk_bf16_f32 v32, v16, v17
    v_cvt_pk_bf16_f32 v33, v18, v19
    v_cvt_pk_bf16_f32 v34, v20, v21
    v_cvt_pk_bf16_f32 v35, v22, v23
    buffer_store_dwordx4 v[32:35], v14, s[8:11], s46 offen offset:0 sc1
    v_cvt_pk_bf16_f32 v36, v24, v25
    v_cvt_pk_bf16_f32 v37, v26, v27
    v_cvt_pk_bf16_f32 v38, v28, v29
    v_cvt_pk_bf16_f32 v39, v30, v31
    buffer_store_dwordx4 v[36:39], v14, s[8:11], s46 offen offset:1024 sc1
    v_add_f32 v72, v16, v17
    v_mul_f32 v73, v16, v16
    v_fmac_f32 v73, v17, v17
    v_add_f32 v72, v72, v18
    v_fmac_f32 v73, v18, v18
    v_add_f32 v72, v72, v19
    v_fmac_f32 v73, v19, v19
    v_add_f32 v72, v72, v20
    v_fmac_f32 v73, v20, v20
    v_add_f32 v72, v72, v21
    v_fmac_f32 v73, v21, v21
    v_add_f32 v72, v72, v22
    v_fmac_f32 v73, v22, v22
    v_add_f32 v72, v72, v23
    v_fmac_f32 v73, v23, v23
    v_add_f32 v72, v72, v24
    v_fmac_f32 v73, v24, v24
    v_add_f32 v72, v72, v25
    v_fmac_f32 v73, v25, v25
    v_add_f32 v72, v72, v26
    v_fmac_f32 v73, v26, v26
    v_add_f32 v72, v72, v27
    v_fmac_f32 v73, v27, v27
    v_add_f32 v72, v72, v28
    v_fmac_f32 v73, v28, v28
    v_add_f32 v72, v72, v29
    v_fmac_f32 v73, v29, v29
    v_add_f32 v72, v72, v30
    v_fmac_f32 v73, v30, v30
    v_add_f32 v72, v72, v31
    v_fmac_f32 v73, v31, v31
    v_mov_b32 v74, v72
    v_mov_b32 v75, v73
    s_nop 0
    v_permlane32_swap_b32 v72, v74
    v_permlane32_swap_b32 v73, v75
    v_add_f32 v72, v72, v74
    v_add_f32 v73, v73, v75
    buffer_store_dwordx2 v[72:73], v10, s[8:11], s52 offen sc1
    s_mul_i32 s43, s57, 22528
    s_add_u32 s43, s43, s49
    s_cmp_lg_u32 s62, 0
    s_cbranch_scc1 Lawo_item
    buffer_load_dword v2, v1, s[8:11], s42 offen sc1
    s_waitcnt vmcnt(0)
    s_cmp_ge_u32 s37, 64
    s_cbranch_scc1 Lawo_fin
    v_cmp_eq_u32 vcc, 0, v2
    s_nop 0
    s_cbranch_vccnz Lawo_pub
    s_add_u32 m0, s59, 0
    s_add_u32 s47, s41, 0
    buffer_load_dwordx4 v0, s[8:11], s47 offen offset:0 lds
    buffer_load_dwordx4 v0, s[8:11], s47 offen offset:1024 lds
    buffer_load_dwordx4 v0, s[8:11], s47 offen offset:2048 lds
    buffer_load_dwordx4 v0, s[8:11], s47 offen offset:3072 lds
    s_add_u32 m0, s59, 4096
    s_add_u32 s47, s41, 4096
    buffer_load_dwordx4 v0, s[8:11], s47 offen offset:0 lds
    buffer_load_dwordx4 v0, s[8:11], s47 offen offset:1024 lds
    buffer_load_dwordx4 v0, s[8:11], s47 offen offset:2048 lds
    buffer_load_dwordx4 v0, s[8:11], s47 offen offset:3072 lds
    s_add_u32 m0, s59, 8192
    s_add_u32 s47, s41, 8192
    buffer_load_dwordx4 v0, s[8:11], s47 offen offset:0 lds
    s_mul_i32 s48, s36, 4718592
    s_mul_i32 s18, s37, 36864
    s_add_u32 s48, s48, s18
    s_add_u32 s48, s48, 6291456
    buffer_load_dwordx4 v[64:67], v14, s[8:11], s48 offen offset:0
    buffer_load_dwordx4 v[68:71], v14, s[8:11], s48 offen offset:1024
    s_cmp_lg_u32 s43, 0
    s_cselect_b64 exec, 1, 0
    buffer_store_dword v3, v4, s[8:11], s43 offen sc1
    s_mov_b64 exec, -1
    s_mov_b32 s43, 0
    s_waitcnt vmcnt(1)
    s_branch Lawo_go
Lawo_fin:
    s_cmp_lg_u32 s43, 0
    s_cselect_b64 exec, 1, 0
    buffer_store_dword v3, v4, s[8:11], s43 offen sc1
    s_mov_b64 exec, -1
    s_mov_b32 s43, 0
    s_branch L_role_awo_exit
Lawo_pub:
    s_cmp_lg_u32 s43, 0
    s_cselect_b64 exec, 1, 0
    buffer_store_dword v3, v4, s[8:11], s43 offen sc1
    s_mov_b64 exec, -1
    s_mov_b32 s43, 0
Lawo_poll:
    s_mov_b32 s16, 0
Lawo_pl:
    buffer_load_dword v2, v1, s[8:11], s42 offen sc1
    s_add_u32 s16, s16, 1
    s_cmp_gt_u32 s16, 100000
    s_cbranch_scc1 L_role_awo_abort
    s_waitcnt vmcnt(0)
    v_cmp_eq_u32 vcc, 0, v2
    s_nop 0
    s_cbranch_vccz Lawo_pld
    s_sleep 2
    s_branch Lawo_pl
Lawo_pld:
    s_add_u32 m0, s59, 0
    s_add_u32 s47, s41, 0
    buffer_load_dwordx4 v0, s[8:11], s47 offen offset:0 lds
    buffer_load_dwordx4 v0, s[8:11], s47 offen offset:1024 lds
    buffer_load_dwordx4 v0, s[8:11], s47 offen offset:2048 lds
    buffer_load_dwordx4 v0, s[8:11], s47 offen offset:3072 lds
    s_add_u32 m0, s59, 4096
    s_add_u32 s47, s41, 4096
    buffer_load_dwordx4 v0, s[8:11], s47 offen offset:0 lds
    buffer_load_dwordx4 v0, s[8:11], s47 offen offset:1024 lds
    buffer_load_dwordx4 v0, s[8:11], s47 offen offset:2048 lds
    buffer_load_dwordx4 v0, s[8:11], s47 offen offset:3072 lds
    s_add_u32 m0, s59, 8192
    s_add_u32 s47, s41, 8192
    buffer_load_dwordx4 v0, s[8:11], s47 offen offset:0 lds
    s_mul_i32 s48, s36, 4718592
    s_mul_i32 s18, s37, 36864
    s_add_u32 s48, s48, s18
    s_add_u32 s48, s48, 6291456
    buffer_load_dwordx4 v[64:67], v14, s[8:11], s48 offen offset:0
    buffer_load_dwordx4 v[68:71], v14, s[8:11], s48 offen offset:1024
    s_waitcnt vmcnt(0)
    s_branch Lawo_go
L_role_awo_abort:
    s_waitcnt lgkmcnt(0)
    s_mov_b64 exec, -1
    v_mov_b32 v0, 60
    s_lshl_b32 s5, s3, 8
    s_or_b32 s5, s5, s4
    s_or_b32 s5, s5, 0x10000
    v_mov_b32 v1, s5
    global_store_dword v0, v1, s[12:13]
    s_endpgm
L_role_awo_exit:
    s_endpgm
.p2align 6
L_role_aq:
    v_and_b32 v5, 63, v0
    v_lshlrev_b32 v0, 4, v5
    v_and_b32 v7, 15, v5
    v_lshrrev_b32 v8, 4, v5
    v_min_u32 v1, 47, v5
    v_lshrrev_b32 v6, 2, v1
    v_and_b32 v1, 3, v1
    v_lshlrev_b32 v1, 2, v1
    v_lshl_add_u32 v1, v6, 7, v1
    v_mov_b32 v3, 1
    v_mov_b32 v4, 0
    s_mov_b32 s44, 0x05040100
    s_mov_b32 s45, 0x07060302
    s_lshr_b32 s63, s15, 4
    s_and_b32 s15, s15, 15
    s_lshl_b32 s50, s15, 1
    s_lshr_b32 s17, s14, 1
    s_add_u32 s50, s50, s17
    s_and_b32 s51, s14, 1
    s_mul_i32 s49, s50, 36
    s_cmp_eq_u32 s63, 0
    s_cbranch_scc1 Laq_noord
    s_cmp_lg_u32 s14, 0
    s_cbranch_scc1 Laq_ord_d
    v_mov_b32 v5, 48
    s_mov_b32 s16, 0
Laq_ord:
    global_load_dword v6, v5, s[12:13] sc1
    s_add_u32 s16, s16, 1
    s_cmp_gt_u32 s16, 100000
    s_cbranch_scc1 L_role_aq_abort
    s_waitcnt vmcnt(0)
    v_cmp_gt_u32 vcc, 1, v6
    s_nop 0
    s_cbranch_vccz Laq_ord_d
    s_sleep 64
    s_branch Laq_ord
Laq_ord_d:
    s_barrier
Laq_noord:
    s_load_dwordx2 s[20:21], s[0:1], 8
    s_mov_b32 s22, 1990656
    s_mov_b32 s23, 0x00020000
    s_waitcnt lgkmcnt(0)
    s_and_b32 s21, s21, 0xffff
    v_lshrrev_b32 v24, 4, v0
    v_add_u32 v24, 0, v24
    v_mul_u32_u24 v25, 4370, v24
    v_lshrrev_b32 v25, 16, v25
    v_mul_u32_u24 v26, 15, v25
    v_sub_u32 v24, v24, v26
    v_mul_u32_u24 v16, 3456, v25
    v_mul_u32_u24 v25, 13108, v24
    v_lshrrev_b32 v25, 16, v25
    v_mul_u32_u24 v26, 5, v25
    v_sub_u32 v24, v24, v26
    v_mul_u32_u24 v25, 1152, v25
    v_lshlrev_b32 v24, 4, v24
    v_add3_u32 v16, v16, v24, v25
    v_lshrrev_b32 v24, 4, v0
    v_add_u32 v24, 64, v24
    v_mul_u32_u24 v25, 4370, v24
    v_lshrrev_b32 v25, 16, v25
    v_mul_u32_u24 v26, 15, v25
    v_sub_u32 v24, v24, v26
    v_mul_u32_u24 v17, 3456, v25
    v_mul_u32_u24 v25, 13108, v24
    v_lshrrev_b32 v25, 16, v25
    v_mul_u32_u24 v26, 5, v25
    v_sub_u32 v24, v24, v26
    v_mul_u32_u24 v25, 1152, v25
    v_lshlrev_b32 v24, 4, v24
    v_add3_u32 v17, v17, v24, v25
    s_mul_i32 s49, s15, 72
    s_and_b32 s48, s49, 15
    s_and_b32 s49, s49, -16
    s_mul_i32 s17, s14, 27648
    s_add_u32 s49, s49, s17
    s_mul_i32 s46, s14, 1920
    s_mov_b32 s54, -1
    s_mov_b32 s55, 0x00ffffff
    s_add_u32 s17, s49, 0
    s_add_u32 m0, s46, 0
    s_nop 0
    buffer_load_dwordx4 v16, s[20:23], s17 offen lds
    s_add_u32 m0, s46, 1024
    s_mov_b64 exec, s[54:55]
    buffer_load_dwordx4 v17, s[20:23], s17 offen lds
    s_mov_b64 exec, -1
    s_add_u32 s17, s49, 110592
    s_add_u32 m0, s46, 7680
    s_nop 0
    buffer_load_dwordx4 v16, s[20:23], s17 offen lds
    s_add_u32 m0, s46, 8704
    s_mov_b64 exec, s[54:55]
    buffer_load_dwordx4 v17, s[20:23], s17 offen lds
    s_mov_b64 exec, -1
    s_add_u32 s17, s49, 221184
    s_add_u32 m0, s46, 15360
    s_nop 0
    buffer_load_dwordx4 v16, s[20:23], s17 offen lds
    s_add_u32 m0, s46, 16384
    s_mov_b64 exec, s[54:55]
    buffer_load_dwordx4 v17, s[20:23], s17 offen lds
    s_mov_b64 exec, -1
    s_add_u32 s17, s49, 331776
    s_add_u32 m0, s46, 23040
    s_nop 0
    buffer_load_dwordx4 v16, s[20:23], s17 offen lds
    s_add_u32 m0, s46, 24064
    s_mov_b64 exec, s[54:55]
    buffer_load_dwordx4 v17, s[20:23], s17 offen lds
    s_mov_b64 exec, -1
    s_add_u32 s17, s49, 442368
    s_add_u32 m0, s46, 30720
    s_nop 0
    buffer_load_dwordx4 v16, s[20:23], s17 offen lds
    s_add_u32 m0, s46, 31744
    s_mov_b64 exec, s[54:55]
    buffer_load_dwordx4 v17, s[20:23], s17 offen lds
    s_mov_b64 exec, -1
    s_add_u32 s17, s49, 552960
    s_add_u32 m0, s46, 38400
    s_nop 0
    buffer_load_dwordx4 v16, s[20:23], s17 offen lds
    s_add_u32 m0, s46, 39424
    s_mov_b64 exec, s[54:55]
    buffer_load_dwordx4 v17, s[20:23], s17 offen lds
    s_mov_b64 exec, -1
    s_add_u32 s17, s49, 663552
    s_add_u32 m0, s46, 46080
    s_nop 0
    buffer_load_dwordx4 v16, s[20:23], s17 offen lds
    s_add_u32 m0, s46, 47104
    s_mov_b64 exec, s[54:55]
    buffer_load_dwordx4 v17, s[20:23], s17 offen lds
    s_mov_b64 exec, -1
    s_add_u32 s17, s49, 774144
    s_add_u32 m0, s46, 53760
    s_nop 0
    buffer_load_dwordx4 v16, s[20:23], s17 offen lds
    s_add_u32 m0, s46, 54784
    s_mov_b64 exec, s[54:55]
    buffer_load_dwordx4 v17, s[20:23], s17 offen lds
    s_mov_b64 exec, -1
    s_add_u32 s17, s49, 884736
    s_add_u32 m0, s46, 61440
    s_nop 0
    buffer_load_dwordx4 v16, s[20:23], s17 offen lds
    s_add_u32 m0, s46, 62464
    s_mov_b64 exec, s[54:55]
    buffer_load_dwordx4 v17, s[20:23], s17 offen lds
    s_mov_b64 exec, -1
    s_add_u32 s17, s49, 995328
    s_add_u32 m0, s46, 69120
    s_nop 0
    buffer_load_dwordx4 v16, s[20:23], s17 offen lds
    s_add_u32 m0, s46, 70144
    s_mov_b64 exec, s[54:55]
    buffer_load_dwordx4 v17, s[20:23], s17 offen lds
    s_mov_b64 exec, -1
    s_add_u32 s17, s49, 1105920
    s_add_u32 m0, s46, 76800
    s_nop 0
    buffer_load_dwordx4 v16, s[20:23], s17 offen lds
    s_add_u32 m0, s46, 77824
    s_mov_b64 exec, s[54:55]
    buffer_load_dwordx4 v17, s[20:23], s17 offen lds
    s_mov_b64 exec, -1
    s_add_u32 s17, s49, 1216512
    s_add_u32 m0, s46, 84480
    s_nop 0
    buffer_load_dwordx4 v16, s[20:23], s17 offen lds
    s_add_u32 m0, s46, 85504
    s_mov_b64 exec, s[54:55]
    buffer_load_dwordx4 v17, s[20:23], s17 offen lds
    s_mov_b64 exec, -1
    s_lshr_b32 s47, s14, 1
    s_mul_i32 s17, s47, 40
    s_add_u32 s17, s17, s48
    s_mul_i32 s18, s47, 4
    s_add_u32 s18, s18, s48
    s_add_u32 s18, s18, 32
    s_lshl_b32 s19, s47, 4
    s_add_u32 s19, s19, 138240
    v_lshrrev_b32 v5, 2, v7
    v_lshl_add_u32 v5, v8, 3, v5
    v_and_b32 v6, 3, v7
    v_mul_u32_u24 v19, 240, v5
    v_add_u32 v19, s17, v19
    v_lshl_add_u32 v19, v6, 3, v19
    v_lshlrev_b32 v20, 5, v5
    v_add_u32 v20, s19, v20
    v_mov_b32 v22, 156672
    v_cmp_eq_u32 vcc, 0, v6
    s_nop 1
    v_cndmask_b32 v20, v22, v20, vcc
    v_cndmask_b32 v21, 0, -1, vcc
    v_bfe_u32 v5, v0, 4, 5
    v_mul_u32_u24 v23, 240, v5
    v_add_u32 v23, s18, v23
    v_lshlrev_b32 v28, 5, v5
    v_add_u32 v28, s19, v28
    v_mov_b32 v24, 0
    v_mov_b32 v25, 0
    v_mov_b32 v26, 0
    v_mov_b32 v27, 0
    v_lshlrev_b32 v22, 4, v7
    v_add_u32 v22, 156672, v22
    ds_write_b128 v22, v[24:27]
    v_mov_b32 v104, 0x3f803f80
    v_mov_b32 v105, 0x3f803f80
    v_mov_b32 v106, 0x3f803f80
    v_mov_b32 v107, 0x3f803f80
    s_waitcnt vmcnt(12) lgkmcnt(0)
    s_barrier
    v_add_u32 v60, 0, v23
    v_mov_b32 v59, 0
    ds_read_b32 v56, v60
    ds_read_b32 v57, v60 offset:80
    ds_read_b32 v58, v60 offset:160
    v_add_u32 v68, 7680, v23
    v_mov_b32 v67, 0
    ds_read_b32 v64, v68
    ds_read_b32 v65, v68 offset:80
    ds_read_b32 v66, v68 offset:160
    v_add_u32 v76, 15360, v23
    v_mov_b32 v75, 0
    ds_read_b32 v72, v76
    ds_read_b32 v73, v76 offset:80
    ds_read_b32 v74, v76 offset:160
    v_add_u32 v84, 23040, v23
    v_mov_b32 v83, 0
    ds_read_b32 v80, v84
    ds_read_b32 v81, v84 offset:80
    ds_read_b32 v82, v84 offset:160
    v_add_u32 v92, 30720, v23
    v_mov_b32 v91, 0
    ds_read_b32 v88, v92
    ds_read_b32 v89, v92 offset:80
    ds_read_b32 v90, v92 offset:160
    v_add_u32 v100, 38400, v23
    v_mov_b32 v99, 0
    ds_read_b32 v96, v100
    ds_read_b32 v97, v100 offset:80
    ds_read_b32 v98, v100 offset:160
    v_add_u32 v61, 0, v19
    ds_read_b64_tr_b16 v[152:153], v61 offset:0
    ds_read_b64_tr_b16 v[224:225], v61 offset:80
    ds_read_b64_tr_b16 a[112:113], v61 offset:160
    ds_read_b64_tr_b16 v[154:155], v61 offset:960
    ds_read_b64_tr_b16 v[226:227], v61 offset:1040
    ds_read_b64_tr_b16 a[114:115], v61 offset:1120
    v_add_u32 v69, 7680, v19
    ds_read_b64_tr_b16 v[156:157], v69 offset:0
    ds_read_b64_tr_b16 v[228:229], v69 offset:80
    ds_read_b64_tr_b16 a[116:117], v69 offset:160
    ds_read_b64_tr_b16 v[158:159], v69 offset:960
    ds_read_b64_tr_b16 v[230:231], v69 offset:1040
    ds_read_b64_tr_b16 a[118:119], v69 offset:1120
    v_add_u32 v77, 15360, v19
    ds_read_b64_tr_b16 v[160:161], v77 offset:0
    ds_read_b64_tr_b16 v[232:233], v77 offset:80
    ds_read_b64_tr_b16 a[120:121], v77 offset:160
    ds_read_b64_tr_b16 v[162:163], v77 offset:960
    ds_read_b64_tr_b16 v[234:235], v77 offset:1040
    ds_read_b64_tr_b16 a[122:123], v77 offset:1120
    v_add_u32 v85, 23040, v19
    ds_read_b64_tr_b16 v[164:165], v85 offset:0
    ds_read_b64_tr_b16 v[236:237], v85 offset:80
    ds_read_b64_tr_b16 a[124:125], v85 offset:160
    ds_read_b64_tr_b16 v[166:167], v85 offset:960
    ds_read_b64_tr_b16 v[238:239], v85 offset:1040
    ds_read_b64_tr_b16 a[126:127], v85 offset:1120
    v_add_u32 v93, 30720, v19
    ds_read_b64_tr_b16 v[168:169], v93 offset:0
    ds_read_b64_tr_b16 v[240:241], v93 offset:80
    ds_read_b64_tr_b16 a[128:129], v93 offset:160
    ds_read_b64_tr_b16 v[170:171], v93 offset:960
    ds_read_b64_tr_b16 v[242:243], v93 offset:1040
    ds_read_b64_tr_b16 a[130:131], v93 offset:1120
    v_add_u32 v101, 38400, v19
    ds_read_b64_tr_b16 v[172:173], v101 offset:0
    ds_read_b64_tr_b16 v[244:245], v101 offset:80
    ds_read_b64_tr_b16 a[132:133], v101 offset:160
    ds_read_b64_tr_b16 v[174:175], v101 offset:960
    ds_read_b64_tr_b16 v[246:247], v101 offset:1040
    ds_read_b64_tr_b16 a[134:135], v101 offset:1120
    s_waitcnt lgkmcnt(15)
    ds_write_b64 v28, v[56:57] offset:0
    ds_write_b64 v28, v[58:59] offset:8
    ds_write_b64 v28, v[64:65] offset:1024
    ds_write_b64 v28, v[66:67] offset:1032
    ds_write_b64 v28, v[72:73] offset:2048
    ds_write_b64 v28, v[74:75] offset:2056
    ds_write_b64 v28, v[80:81] offset:3072
    ds_write_b64 v28, v[82:83] offset:3080
    ds_write_b64 v28, v[88:89] offset:4096
    ds_write_b64 v28, v[90:91] offset:4104
    ds_write_b64 v28, v[96:97] offset:5120
    ds_write_b64 v28, v[98:99] offset:5128
    s_waitcnt lgkmcnt(0)
    v_and_b32 v56, 0, v21
    v_add_u32 v56, v56, v20
    ds_read_b64_tr_b16 a[40:41], v56 offset:0
    ds_read_b64_tr_b16 a[42:43], v56 offset:128
    v_and_b32 v57, 8, v21
    v_add_u32 v57, v57, v20
    ds_read_b64_tr_b16 a[184:185], v57 offset:0
    ds_read_b64_tr_b16 a[186:187], v57 offset:128
    v_and_b32 v64, 1024, v21
    v_add_u32 v64, v64, v20
    ds_read_b64_tr_b16 a[44:45], v64 offset:0
    ds_read_b64_tr_b16 a[46:47], v64 offset:128
    v_and_b32 v65, 1032, v21
    v_add_u32 v65, v65, v20
    ds_read_b64_tr_b16 a[188:189], v65 offset:0
    ds_read_b64_tr_b16 a[190:191], v65 offset:128
    v_and_b32 v72, 2048, v21
    v_add_u32 v72, v72, v20
    ds_read_b64_tr_b16 a[48:49], v72 offset:0
    ds_read_b64_tr_b16 a[50:51], v72 offset:128
    v_and_b32 v73, 2056, v21
    v_add_u32 v73, v73, v20
    ds_read_b64_tr_b16 a[192:193], v73 offset:0
    ds_read_b64_tr_b16 a[194:195], v73 offset:128
    v_and_b32 v80, 3072, v21
    v_add_u32 v80, v80, v20
    ds_read_b64_tr_b16 a[52:53], v80 offset:0
    ds_read_b64_tr_b16 a[54:55], v80 offset:128
    v_and_b32 v81, 3080, v21
    v_add_u32 v81, v81, v20
    ds_read_b64_tr_b16 a[196:197], v81 offset:0
    ds_read_b64_tr_b16 a[198:199], v81 offset:128
    v_and_b32 v88, 4096, v21
    v_add_u32 v88, v88, v20
    ds_read_b64_tr_b16 a[56:57], v88 offset:0
    ds_read_b64_tr_b16 a[58:59], v88 offset:128
    v_and_b32 v89, 4104, v21
    v_add_u32 v89, v89, v20
    ds_read_b64_tr_b16 a[200:201], v89 offset:0
    ds_read_b64_tr_b16 a[202:203], v89 offset:128
    v_and_b32 v96, 5120, v21
    v_add_u32 v96, v96, v20
    ds_read_b64_tr_b16 a[60:61], v96 offset:0
    ds_read_b64_tr_b16 a[62:63], v96 offset:128
    v_and_b32 v97, 5128, v21
    v_add_u32 v97, v97, v20
    ds_read_b64_tr_b16 a[204:205], v97 offset:0
    ds_read_b64_tr_b16 a[206:207], v97 offset:128
    s_waitcnt lgkmcnt(0)
    s_add_u32 s17, s49, 1327104
    s_add_u32 m0, s46, 92160
    s_nop 0
    buffer_load_dwordx4 v16, s[20:23], s17 offen lds
    s_add_u32 m0, s46, 93184
    s_mov_b64 exec, s[54:55]
    buffer_load_dwordx4 v17, s[20:23], s17 offen lds
    s_mov_b64 exec, -1
    s_add_u32 s17, s49, 1437696
    s_add_u32 m0, s46, 99840
    s_nop 0
    buffer_load_dwordx4 v16, s[20:23], s17 offen lds
    s_add_u32 m0, s46, 100864
    s_mov_b64 exec, s[54:55]
    buffer_load_dwordx4 v17, s[20:23], s17 offen lds
    s_mov_b64 exec, -1
    s_add_u32 s17, s49, 1548288
    s_add_u32 m0, s46, 107520
    s_nop 0
    buffer_load_dwordx4 v16, s[20:23], s17 offen lds
    s_add_u32 m0, s46, 108544
    s_mov_b64 exec, s[54:55]
    buffer_load_dwordx4 v17, s[20:23], s17 offen lds
    s_mov_b64 exec, -1
    s_add_u32 s17, s49, 1658880
    s_add_u32 m0, s46, 115200
    s_nop 0
    buffer_load_dwordx4 v16, s[20:23], s17 offen lds
    s_add_u32 m0, s46, 116224
    s_mov_b64 exec, s[54:55]
    buffer_load_dwordx4 v17, s[20:23], s17 offen lds
    s_mov_b64 exec, -1
    s_add_u32 s17, s49, 1769472
    s_add_u32 m0, s46, 122880
    s_nop 0
    buffer_load_dwordx4 v16, s[20:23], s17 offen lds
    s_add_u32 m0, s46, 123904
    s_mov_b64 exec, s[54:55]
    buffer_load_dwordx4 v17, s[20:23], s17 offen lds
    s_mov_b64 exec, -1
    s_add_u32 s17, s49, 1880064
    s_add_u32 m0, s46, 130560
    s_nop 0
    buffer_load_dwordx4 v16, s[20:23], s17 offen lds
    s_add_u32 m0, s46, 131584
    s_mov_b64 exec, s[54:55]
    buffer_load_dwordx4 v17, s[20:23], s17 offen lds
    s_mov_b64 exec, -1
    v_mfma_f32_16x16x32_bf16 v[36:39], v[152:155], v[104:107], 0
    v_mfma_f32_16x16x32_bf16 v[40:43], v[224:227], v[104:107], 0
    v_mfma_f32_16x16x32_bf16 v[44:47], a[40:43], v[104:107], 0
    v_mfma_f32_16x16x32_bf16 v[48:51], v[104:107], a[112:115], 0
    v_mfma_f32_16x16x32_bf16 v[52:55], v[104:107], a[184:187], 0
    v_mfma_f32_16x16x32_bf16 v[36:39], v[156:159], v[104:107], v[36:39]
    v_mfma_f32_16x16x32_bf16 v[40:43], v[228:231], v[104:107], v[40:43]
    v_mfma_f32_16x16x32_bf16 v[44:47], a[44:47], v[104:107], v[44:47]
    v_mfma_f32_16x16x32_bf16 v[48:51], v[104:107], a[116:119], v[48:51]
    v_mfma_f32_16x16x32_bf16 v[52:55], v[104:107], a[188:191], v[52:55]
    v_mfma_f32_16x16x32_bf16 v[36:39], v[160:163], v[104:107], v[36:39]
    v_mfma_f32_16x16x32_bf16 v[40:43], v[232:235], v[104:107], v[40:43]
    v_mfma_f32_16x16x32_bf16 v[44:47], a[48:51], v[104:107], v[44:47]
    v_mfma_f32_16x16x32_bf16 v[48:51], v[104:107], a[120:123], v[48:51]
    v_mfma_f32_16x16x32_bf16 v[52:55], v[104:107], a[192:195], v[52:55]
    v_mfma_f32_16x16x32_bf16 v[36:39], v[164:167], v[104:107], v[36:39]
    v_mfma_f32_16x16x32_bf16 v[40:43], v[236:239], v[104:107], v[40:43]
    v_mfma_f32_16x16x32_bf16 v[44:47], a[52:55], v[104:107], v[44:47]
    v_mfma_f32_16x16x32_bf16 v[48:51], v[104:107], a[124:127], v[48:51]
    v_mfma_f32_16x16x32_bf16 v[52:55], v[104:107], a[196:199], v[52:55]
    v_mfma_f32_16x16x32_bf16 v[36:39], v[168:171], v[104:107], v[36:39]
    v_mfma_f32_16x16x32_bf16 v[40:43], v[240:243], v[104:107], v[40:43]
    v_mfma_f32_16x16x32_bf16 v[44:47], a[56:59], v[104:107], v[44:47]
    v_mfma_f32_16x16x32_bf16 v[48:51], v[104:107], a[128:131], v[48:51]
    v_mfma_f32_16x16x32_bf16 v[52:55], v[104:107], a[200:203], v[52:55]
    v_mfma_f32_16x16x32_bf16 v[36:39], v[172:175], v[104:107], v[36:39]
    v_mfma_f32_16x16x32_bf16 v[40:43], v[244:247], v[104:107], v[40:43]
    v_mfma_f32_16x16x32_bf16 v[44:47], a[60:63], v[104:107], v[44:47]
    v_mfma_f32_16x16x32_bf16 v[48:51], v[104:107], a[132:135], v[48:51]
    v_mfma_f32_16x16x32_bf16 v[52:55], v[104:107], a[204:207], v[52:55]
    s_waitcnt vmcnt(12)
    s_barrier
    v_add_u32 v60, 46080, v23
    v_mov_b32 v59, 0
    ds_read_b32 v56, v60
    ds_read_b32 v57, v60 offset:80
    ds_read_b32 v58, v60 offset:160
    v_add_u32 v68, 53760, v23
    v_mov_b32 v67, 0
    ds_read_b32 v64, v68
    ds_read_b32 v65, v68 offset:80
    ds_read_b32 v66, v68 offset:160
    v_add_u32 v76, 61440, v23
    v_mov_b32 v75, 0
    ds_read_b32 v72, v76
    ds_read_b32 v73, v76 offset:80
    ds_read_b32 v74, v76 offset:160
    v_add_u32 v84, 69120, v23
    v_mov_b32 v83, 0
    ds_read_b32 v80, v84
    ds_read_b32 v81, v84 offset:80
    ds_read_b32 v82, v84 offset:160
    v_add_u32 v92, 76800, v23
    v_mov_b32 v91, 0
    ds_read_b32 v88, v92
    ds_read_b32 v89, v92 offset:80
    ds_read_b32 v90, v92 offset:160
    v_add_u32 v100, 84480, v23
    v_mov_b32 v99, 0
    ds_read_b32 v96, v100
    ds_read_b32 v97, v100 offset:80
    ds_read_b32 v98, v100 offset:160
    v_add_u32 v61, 46080, v19
    ds_read_b64_tr_b16 v[176:177], v61 offset:0
    ds_read_b64_tr_b16 v[248:249], v61 offset:80
    ds_read_b64_tr_b16 a[136:137], v61 offset:160
    ds_read_b64_tr_b16 v[178:179], v61 offset:960
    ds_read_b64_tr_b16 v[250:251], v61 offset:1040
    ds_read_b64_tr_b16 a[138:139], v61 offset:1120
    v_add_u32 v69, 53760, v19
    ds_read_b64_tr_b16 v[180:181], v69 offset:0
    ds_read_b64_tr_b16 v[252:253], v69 offset:80
    ds_read_b64_tr_b16 a[140:141], v69 offset:160
    ds_read_b64_tr_b16 v[182:183], v69 offset:960
    ds_read_b64_tr_b16 v[254:255], v69 offset:1040
    ds_read_b64_tr_b16 a[142:143], v69 offset:1120
    v_add_u32 v77, 61440, v19
    ds_read_b64_tr_b16 v[184:185], v77 offset:0
    ds_read_b64_tr_b16 a[0:1], v77 offset:80
    ds_read_b64_tr_b16 a[144:145], v77 offset:160
    ds_read_b64_tr_b16 v[186:187], v77 offset:960
    ds_read_b64_tr_b16 a[2:3], v77 offset:1040
    ds_read_b64_tr_b16 a[146:147], v77 offset:1120
    v_add_u32 v85, 69120, v19
    ds_read_b64_tr_b16 v[188:189], v85 offset:0
    ds_read_b64_tr_b16 a[4:5], v85 offset:80
    ds_read_b64_tr_b16 a[148:149], v85 offset:160
    ds_read_b64_tr_b16 v[190:191], v85 offset:960
    ds_read_b64_tr_b16 a[6:7], v85 offset:1040
    ds_read_b64_tr_b16 a[150:151], v85 offset:1120
    v_add_u32 v93, 76800, v19
    ds_read_b64_tr_b16 v[192:193], v93 offset:0
    ds_read_b64_tr_b16 a[8:9], v93 offset:80
    ds_read_b64_tr_b16 a[152:153], v93 offset:160
    ds_read_b64_tr_b16 v[194:195], v93 offset:960
    ds_read_b64_tr_b16 a[10:11], v93 offset:1040
    ds_read_b64_tr_b16 a[154:155], v93 offset:1120
    v_add_u32 v101, 84480, v19
    ds_read_b64_tr_b16 v[196:197], v101 offset:0
    ds_read_b64_tr_b16 a[12:13], v101 offset:80
    ds_read_b64_tr_b16 a[156:157], v101 offset:160
    ds_read_b64_tr_b16 v[198:199], v101 offset:960
    ds_read_b64_tr_b16 a[14:15], v101 offset:1040
    ds_read_b64_tr_b16 a[158:159], v101 offset:1120
    s_waitcnt lgkmcnt(15)
    ds_write_b64 v28, v[56:57] offset:6144
    ds_write_b64 v28, v[58:59] offset:6152
    ds_write_b64 v28, v[64:65] offset:7168
    ds_write_b64 v28, v[66:67] offset:7176
    ds_write_b64 v28, v[72:73] offset:8192
    ds_write_b64 v28, v[74:75] offset:8200
    ds_write_b64 v28, v[80:81] offset:9216
    ds_write_b64 v28, v[82:83] offset:9224
    ds_write_b64 v28, v[88:89] offset:10240
    ds_write_b64 v28, v[90:91] offset:10248
    ds_write_b64 v28, v[96:97] offset:11264
    ds_write_b64 v28, v[98:99] offset:11272
    s_waitcnt lgkmcnt(0)
    v_and_b32 v56, 6144, v21
    v_add_u32 v56, v56, v20
    ds_read_b64_tr_b16 a[64:65], v56 offset:0
    ds_read_b64_tr_b16 a[66:67], v56 offset:128
    v_and_b32 v57, 6152, v21
    v_add_u32 v57, v57, v20
    ds_read_b64_tr_b16 a[208:209], v57 offset:0
    ds_read_b64_tr_b16 a[210:211], v57 offset:128
    v_and_b32 v64, 7168, v21
    v_add_u32 v64, v64, v20
    ds_read_b64_tr_b16 a[68:69], v64 offset:0
    ds_read_b64_tr_b16 a[70:71], v64 offset:128
    v_and_b32 v65, 7176, v21
    v_add_u32 v65, v65, v20
    ds_read_b64_tr_b16 a[212:213], v65 offset:0
    ds_read_b64_tr_b16 a[214:215], v65 offset:128
    v_and_b32 v72, 8192, v21
    v_add_u32 v72, v72, v20
    ds_read_b64_tr_b16 a[72:73], v72 offset:0
    ds_read_b64_tr_b16 a[74:75], v72 offset:128
    v_and_b32 v73, 8200, v21
    v_add_u32 v73, v73, v20
    ds_read_b64_tr_b16 a[216:217], v73 offset:0
    ds_read_b64_tr_b16 a[218:219], v73 offset:128
    v_and_b32 v80, 9216, v21
    v_add_u32 v80, v80, v20
    ds_read_b64_tr_b16 a[76:77], v80 offset:0
    ds_read_b64_tr_b16 a[78:79], v80 offset:128
    v_and_b32 v81, 9224, v21
    v_add_u32 v81, v81, v20
    ds_read_b64_tr_b16 a[220:221], v81 offset:0
    ds_read_b64_tr_b16 a[222:223], v81 offset:128
    v_and_b32 v88, 10240, v21
    v_add_u32 v88, v88, v20
    ds_read_b64_tr_b16 a[80:81], v88 offset:0
    ds_read_b64_tr_b16 a[82:83], v88 offset:128
    v_and_b32 v89, 10248, v21
    v_add_u32 v89, v89, v20
    ds_read_b64_tr_b16 a[224:225], v89 offset:0
    ds_read_b64_tr_b16 a[226:227], v89 offset:128
    v_and_b32 v96, 11264, v21
    v_add_u32 v96, v96, v20
    ds_read_b64_tr_b16 a[84:85], v96 offset:0
    ds_read_b64_tr_b16 a[86:87], v96 offset:128
    v_and_b32 v97, 11272, v21
    v_add_u32 v97, v97, v20
    ds_read_b64_tr_b16 a[228:229], v97 offset:0
    ds_read_b64_tr_b16 a[230:231], v97 offset:128
    s_waitcnt lgkmcnt(0)
    v_mfma_f32_16x16x32_bf16 v[36:39], v[176:179], v[104:107], v[36:39]
    v_mfma_f32_16x16x32_bf16 v[40:43], v[248:251], v[104:107], v[40:43]
    v_mfma_f32_16x16x32_bf16 v[44:47], a[64:67], v[104:107], v[44:47]
    v_mfma_f32_16x16x32_bf16 v[48:51], v[104:107], a[136:139], v[48:51]
    v_mfma_f32_16x16x32_bf16 v[52:55], v[104:107], a[208:211], v[52:55]
    v_mfma_f32_16x16x32_bf16 v[36:39], v[180:183], v[104:107], v[36:39]
    v_mfma_f32_16x16x32_bf16 v[40:43], v[252:255], v[104:107], v[40:43]
    v_mfma_f32_16x16x32_bf16 v[44:47], a[68:71], v[104:107], v[44:47]
    v_mfma_f32_16x16x32_bf16 v[48:51], v[104:107], a[140:143], v[48:51]
    v_mfma_f32_16x16x32_bf16 v[52:55], v[104:107], a[212:215], v[52:55]
    v_mfma_f32_16x16x32_bf16 v[36:39], v[184:187], v[104:107], v[36:39]
    v_mfma_f32_16x16x32_bf16 v[40:43], a[0:3], v[104:107], v[40:43]
    v_mfma_f32_16x16x32_bf16 v[44:47], a[72:75], v[104:107], v[44:47]
    v_mfma_f32_16x16x32_bf16 v[48:51], v[104:107], a[144:147], v[48:51]
    v_mfma_f32_16x16x32_bf16 v[52:55], v[104:107], a[216:219], v[52:55]
    v_mfma_f32_16x16x32_bf16 v[36:39], v[188:191], v[104:107], v[36:39]
    v_mfma_f32_16x16x32_bf16 v[40:43], a[4:7], v[104:107], v[40:43]
    v_mfma_f32_16x16x32_bf16 v[44:47], a[76:79], v[104:107], v[44:47]
    v_mfma_f32_16x16x32_bf16 v[48:51], v[104:107], a[148:151], v[48:51]
    v_mfma_f32_16x16x32_bf16 v[52:55], v[104:107], a[220:223], v[52:55]
    v_mfma_f32_16x16x32_bf16 v[36:39], v[192:195], v[104:107], v[36:39]
    v_mfma_f32_16x16x32_bf16 v[40:43], a[8:11], v[104:107], v[40:43]
    v_mfma_f32_16x16x32_bf16 v[44:47], a[80:83], v[104:107], v[44:47]
    v_mfma_f32_16x16x32_bf16 v[48:51], v[104:107], a[152:155], v[48:51]
    v_mfma_f32_16x16x32_bf16 v[52:55], v[104:107], a[224:227], v[52:55]
    v_mfma_f32_16x16x32_bf16 v[36:39], v[196:199], v[104:107], v[36:39]
    v_mfma_f32_16x16x32_bf16 v[40:43], a[12:15], v[104:107], v[40:43]
    v_mfma_f32_16x16x32_bf16 v[44:47], a[84:87], v[104:107], v[44:47]
    v_mfma_f32_16x16x32_bf16 v[48:51], v[104:107], a[156:159], v[48:51]
    v_mfma_f32_16x16x32_bf16 v[52:55], v[104:107], a[228:231], v[52:55]
    s_waitcnt vmcnt(0)
    s_barrier
    v_add_u32 v60, 92160, v23
    v_mov_b32 v59, 0
    ds_read_b32 v56, v60
    ds_read_b32 v57, v60 offset:80
    ds_read_b32 v58, v60 offset:160
    v_add_u32 v68, 99840, v23
    v_mov_b32 v67, 0
    ds_read_b32 v64, v68
    ds_read_b32 v65, v68 offset:80
    ds_read_b32 v66, v68 offset:160
    v_add_u32 v76, 107520, v23
    v_mov_b32 v75, 0
    ds_read_b32 v72, v76
    ds_read_b32 v73, v76 offset:80
    ds_read_b32 v74, v76 offset:160
    v_add_u32 v84, 115200, v23
    v_mov_b32 v83, 0
    ds_read_b32 v80, v84
    ds_read_b32 v81, v84 offset:80
    ds_read_b32 v82, v84 offset:160
    v_add_u32 v92, 122880, v23
    v_mov_b32 v91, 0
    ds_read_b32 v88, v92
    ds_read_b32 v89, v92 offset:80
    ds_read_b32 v90, v92 offset:160
    v_add_u32 v100, 130560, v23
    v_mov_b32 v99, 0
    ds_read_b32 v96, v100
    ds_read_b32 v97, v100 offset:80
    ds_read_b32 v98, v100 offset:160
    v_add_u32 v61, 92160, v19
    ds_read_b64_tr_b16 v[200:201], v61 offset:0
    ds_read_b64_tr_b16 a[16:17], v61 offset:80
    ds_read_b64_tr_b16 a[160:161], v61 offset:160
    ds_read_b64_tr_b16 v[202:203], v61 offset:960
    ds_read_b64_tr_b16 a[18:19], v61 offset:1040
    ds_read_b64_tr_b16 a[162:163], v61 offset:1120
    v_add_u32 v69, 99840, v19
    ds_read_b64_tr_b16 v[204:205], v69 offset:0
    ds_read_b64_tr_b16 a[20:21], v69 offset:80
    ds_read_b64_tr_b16 a[164:165], v69 offset:160
    ds_read_b64_tr_b16 v[206:207], v69 offset:960
    ds_read_b64_tr_b16 a[22:23], v69 offset:1040
    ds_read_b64_tr_b16 a[166:167], v69 offset:1120
    v_add_u32 v77, 107520, v19
    ds_read_b64_tr_b16 v[208:209], v77 offset:0
    ds_read_b64_tr_b16 a[24:25], v77 offset:80
    ds_read_b64_tr_b16 a[168:169], v77 offset:160
    ds_read_b64_tr_b16 v[210:211], v77 offset:960
    ds_read_b64_tr_b16 a[26:27], v77 offset:1040
    ds_read_b64_tr_b16 a[170:171], v77 offset:1120
    v_add_u32 v85, 115200, v19
    ds_read_b64_tr_b16 v[212:213], v85 offset:0
    ds_read_b64_tr_b16 a[28:29], v85 offset:80
    ds_read_b64_tr_b16 a[172:173], v85 offset:160
    ds_read_b64_tr_b16 v[214:215], v85 offset:960
    ds_read_b64_tr_b16 a[30:31], v85 offset:1040
    ds_read_b64_tr_b16 a[174:175], v85 offset:1120
    v_add_u32 v93, 122880, v19
    ds_read_b64_tr_b16 v[216:217], v93 offset:0
    ds_read_b64_tr_b16 a[32:33], v93 offset:80
    ds_read_b64_tr_b16 a[176:177], v93 offset:160
    ds_read_b64_tr_b16 v[218:219], v93 offset:960
    ds_read_b64_tr_b16 a[34:35], v93 offset:1040
    ds_read_b64_tr_b16 a[178:179], v93 offset:1120
    v_add_u32 v101, 130560, v19
    ds_read_b64_tr_b16 v[220:221], v101 offset:0
    ds_read_b64_tr_b16 a[36:37], v101 offset:80
    ds_read_b64_tr_b16 a[180:181], v101 offset:160
    ds_read_b64_tr_b16 v[222:223], v101 offset:960
    ds_read_b64_tr_b16 a[38:39], v101 offset:1040
    ds_read_b64_tr_b16 a[182:183], v101 offset:1120
    s_waitcnt lgkmcnt(15)
    ds_write_b64 v28, v[56:57] offset:12288
    ds_write_b64 v28, v[58:59] offset:12296
    ds_write_b64 v28, v[64:65] offset:13312
    ds_write_b64 v28, v[66:67] offset:13320
    ds_write_b64 v28, v[72:73] offset:14336
    ds_write_b64 v28, v[74:75] offset:14344
    ds_write_b64 v28, v[80:81] offset:15360
    ds_write_b64 v28, v[82:83] offset:15368
    ds_write_b64 v28, v[88:89] offset:16384
    ds_write_b64 v28, v[90:91] offset:16392
    ds_write_b64 v28, v[96:97] offset:17408
    ds_write_b64 v28, v[98:99] offset:17416
    s_waitcnt lgkmcnt(0)
    v_and_b32 v56, 12288, v21
    v_add_u32 v56, v56, v20
    ds_read_b64_tr_b16 a[88:89], v56 offset:0
    ds_read_b64_tr_b16 a[90:91], v56 offset:128
    v_and_b32 v57, 12296, v21
    v_add_u32 v57, v57, v20
    ds_read_b64_tr_b16 a[232:233], v57 offset:0
    ds_read_b64_tr_b16 a[234:235], v57 offset:128
    v_and_b32 v64, 13312, v21
    v_add_u32 v64, v64, v20
    ds_read_b64_tr_b16 a[92:93], v64 offset:0
    ds_read_b64_tr_b16 a[94:95], v64 offset:128
    v_and_b32 v65, 13320, v21
    v_add_u32 v65, v65, v20
    ds_read_b64_tr_b16 a[236:237], v65 offset:0
    ds_read_b64_tr_b16 a[238:239], v65 offset:128
    v_and_b32 v72, 14336, v21
    v_add_u32 v72, v72, v20
    ds_read_b64_tr_b16 a[96:97], v72 offset:0
    ds_read_b64_tr_b16 a[98:99], v72 offset:128
    v_and_b32 v73, 14344, v21
    v_add_u32 v73, v73, v20
    ds_read_b64_tr_b16 a[240:241], v73 offset:0
    ds_read_b64_tr_b16 a[242:243], v73 offset:128
    v_and_b32 v80, 15360, v21
    v_add_u32 v80, v80, v20
    ds_read_b64_tr_b16 a[100:101], v80 offset:0
    ds_read_b64_tr_b16 a[102:103], v80 offset:128
    v_and_b32 v81, 15368, v21
    v_add_u32 v81, v81, v20
    ds_read_b64_tr_b16 a[244:245], v81 offset:0
    ds_read_b64_tr_b16 a[246:247], v81 offset:128
    v_and_b32 v88, 16384, v21
    v_add_u32 v88, v88, v20
    ds_read_b64_tr_b16 a[104:105], v88 offset:0
    ds_read_b64_tr_b16 a[106:107], v88 offset:128
    v_and_b32 v89, 16392, v21
    v_add_u32 v89, v89, v20
    ds_read_b64_tr_b16 a[248:249], v89 offset:0
    ds_read_b64_tr_b16 a[250:251], v89 offset:128
    v_and_b32 v96, 17408, v21
    v_add_u32 v96, v96, v20
    ds_read_b64_tr_b16 a[108:109], v96 offset:0
    ds_read_b64_tr_b16 a[110:111], v96 offset:128
    v_and_b32 v97, 17416, v21
    v_add_u32 v97, v97, v20
    ds_read_b64_tr_b16 a[252:253], v97 offset:0
    ds_read_b64_tr_b16 a[254:255], v97 offset:128
    s_waitcnt lgkmcnt(0)
    v_mfma_f32_16x16x32_bf16 v[36:39], v[200:203], v[104:107], v[36:39]
    v_mfma_f32_16x16x32_bf16 v[40:43], a[16:19], v[104:107], v[40:43]
    v_mfma_f32_16x16x32_bf16 v[44:47], a[88:91], v[104:107], v[44:47]
    v_mfma_f32_16x16x32_bf16 v[48:51], v[104:107], a[160:163], v[48:51]
    v_mfma_f32_16x16x32_bf16 v[52:55], v[104:107], a[232:235], v[52:55]
    v_mfma_f32_16x16x32_bf16 v[36:39], v[204:207], v[104:107], v[36:39]
    v_mfma_f32_16x16x32_bf16 v[40:43], a[20:23], v[104:107], v[40:43]
    v_mfma_f32_16x16x32_bf16 v[44:47], a[92:95], v[104:107], v[44:47]
    v_mfma_f32_16x16x32_bf16 v[48:51], v[104:107], a[164:167], v[48:51]
    v_mfma_f32_16x16x32_bf16 v[52:55], v[104:107], a[236:239], v[52:55]
    v_mfma_f32_16x16x32_bf16 v[36:39], v[208:211], v[104:107], v[36:39]
    v_mfma_f32_16x16x32_bf16 v[40:43], a[24:27], v[104:107], v[40:43]
    v_mfma_f32_16x16x32_bf16 v[44:47], a[96:99], v[104:107], v[44:47]
    v_mfma_f32_16x16x32_bf16 v[48:51], v[104:107], a[168:171], v[48:51]
    v_mfma_f32_16x16x32_bf16 v[52:55], v[104:107], a[240:243], v[52:55]
    v_mfma_f32_16x16x32_bf16 v[36:39], v[212:215], v[104:107], v[36:39]
    v_mfma_f32_16x16x32_bf16 v[40:43], a[28:31], v[104:107], v[40:43]
    v_mfma_f32_16x16x32_bf16 v[44:47], a[100:103], v[104:107], v[44:47]
    v_mfma_f32_16x16x32_bf16 v[48:51], v[104:107], a[172:175], v[48:51]
    v_mfma_f32_16x16x32_bf16 v[52:55], v[104:107], a[244:247], v[52:55]
    v_mfma_f32_16x16x32_bf16 v[36:39], v[216:219], v[104:107], v[36:39]
    v_mfma_f32_16x16x32_bf16 v[40:43], a[32:35], v[104:107], v[40:43]
    v_mfma_f32_16x16x32_bf16 v[44:47], a[104:107], v[104:107], v[44:47]
    v_mfma_f32_16x16x32_bf16 v[48:51], v[104:107], a[176:179], v[48:51]
    v_mfma_f32_16x16x32_bf16 v[52:55], v[104:107], a[248:251], v[52:55]
    v_mfma_f32_16x16x32_bf16 v[36:39], v[220:223], v[104:107], v[36:39]
    v_mfma_f32_16x16x32_bf16 v[40:43], a[36:39], v[104:107], v[40:43]
    v_mfma_f32_16x16x32_bf16 v[44:47], a[108:111], v[104:107], v[44:47]
    v_mfma_f32_16x16x32_bf16 v[48:51], v[104:107], a[180:183], v[48:51]
    v_mfma_f32_16x16x32_bf16 v[52:55], v[104:107], a[252:255], v[52:55]
    s_barrier
    v_lshlrev_b32 v10, 5, v7
    s_lshl_b32 s17, s51, 4
    v_add_u32 v10, s17, v10
    v_mul_u32_u24 v6, 1536, v8
    v_add_u32 v10, v10, v6
    s_lshl_b32 s17, s14, 7
    s_add_u32 s17, s17, 73728
    v_lshl_add_u32 v11, v7, 3, s17
    v_lshl_add_u32 v12, v8, 5, s17
    v_lshlrev_b32 v13, 5, v7
    s_lshl_b32 s17, s51, 4
    v_add_u32 v13, s17, v13
    s_lshr_b32 s17, s50, 2
    s_add_u32 s17, s17, 64
    s_lshl_b32 s17, s17, 9
    s_and_b32 s18, s50, 3
    s_lshl_b32 s18, s18, 2
    s_add_u32 s17, s17, s18
    v_add_u32 v14, s17, v13
    v_lshrrev_b32 v5, 1, v8
    v_lshl_add_u32 v13, v5, 9, v13
    v_and_b32 v5, 1, v8
    v_lshl_add_u32 v13, v5, 3, v13
    s_lshl_b32 s17, s50, 10
    v_add_u32 v13, s17, v13
    s_lshl_b32 s49, s15, 7
    s_lshl_b32 s17, s14, 2
    s_add_u32 s49, s49, s17
    s_add_u32 s49, s49, 181760
    s_mov_b32 s52, 0x3eae1a93
    v_mov_b32 v6, 0xf149f2ca
    v_lshl_add_u32 v5, v8, 2, 0
    v_sub_u32 v5, v5, v7
    v_cmp_le_i32 vcc, 9, v5
    s_nop 1
    v_cndmask_b32 v72, v6, v4, vcc
    v_add_u32 v5, 7, v5
    v_cmp_ge_u32 vcc, 7, v5
    s_nop 1
    v_cndmask_b32 v76, v6, v4, vcc
    v_lshl_add_u32 v5, v8, 2, 1
    v_sub_u32 v5, v5, v7
    v_cmp_le_i32 vcc, 9, v5
    s_nop 1
    v_cndmask_b32 v73, v6, v4, vcc
    v_add_u32 v5, 7, v5
    v_cmp_ge_u32 vcc, 7, v5
    s_nop 1
    v_cndmask_b32 v77, v6, v4, vcc
    v_lshl_add_u32 v5, v8, 2, 2
    v_sub_u32 v5, v5, v7
    v_cmp_le_i32 vcc, 9, v5
    s_nop 1
    v_cndmask_b32 v74, v6, v4, vcc
    v_add_u32 v5, 7, v5
    v_cmp_ge_u32 vcc, 7, v5
    s_nop 1
    v_cndmask_b32 v78, v6, v4, vcc
    v_lshl_add_u32 v5, v8, 2, 3
    v_sub_u32 v5, v5, v7
    v_cmp_le_i32 vcc, 9, v5
    s_nop 1
    v_cndmask_b32 v75, v6, v4, vcc
    v_add_u32 v5, 7, v5
    v_cmp_ge_u32 vcc, 7, v5
    s_nop 1
    v_cndmask_b32 v79, v6, v4, vcc
    v_and_b32 v111, 0x200, v0
    v_lshl_add_u32 v111, v7, 5, v111
    v_and_b32 v5, 1, v8
    v_lshl_add_u32 v111, v5, 4, v111
    v_mov_b32 v112, 0
    v_mov_b32 v113, 0
    v_mov_b32 v114, 0
    v_mov_b32 v115, 0
    v_mov_b32 v136, 0
    v_mov_b32 v137, 0
    v_mov_b32 v138, 0
    v_mov_b32 v139, 0
    v_mov_b32 v140, 0
    v_mov_b32 v141, 0
    v_mov_b32 v142, 0
    v_mov_b32 v143, 0
    v_mov_b32 v116, 0x3f803f80
    v_mov_b32 v117, 0x3f803f80
    v_mov_b32 v118, 0x3f803f80
    v_mov_b32 v119, 0x3f803f80
    v_mov_b32 v131, 0
    v_mov_b32 v135, 0
    v_mbcnt_lo_u32_b32 v24, -1, 0
    v_mbcnt_hi_u32_b32 v24, -1, v24
    v_and_b32 v25, 1, v24
    v_lshlrev_b32 v25, 7, v25
    v_lshlrev_b32 v24, 1, v24
    v_and_or_b32 v24, v24, 12, v25
    s_mov_b32 s16, 0
Laq_pure:
    global_load_dword v25, v24, s[12:13] sc1
    s_add_u32 s16, s16, 1
    s_cmp_gt_u32 s16, 100000
    s_cbranch_scc1 L_role_aq_abort
    s_mov_b32 s6, 0
    s_waitcnt vmcnt(0)
    v_readlane_b32 s7, v25, 0
    s_nop 0
    s_add_u32 s6, s6, s7
    v_readlane_b32 s7, v25, 1
    s_nop 0
    s_add_u32 s6, s6, s7
    v_readlane_b32 s7, v25, 2
    s_nop 0
    s_add_u32 s6, s6, s7
    v_readlane_b32 s7, v25, 3
    s_nop 0
    s_add_u32 s6, s6, s7
    v_readlane_b32 s7, v25, 4
    s_nop 0
    s_add_u32 s6, s6, s7
    v_readlane_b32 s7, v25, 5
    s_nop 0
    s_add_u32 s6, s6, s7
    v_readlane_b32 s7, v25, 6
    s_nop 0
    s_add_u32 s6, s6, s7
    v_readlane_b32 s7, v25, 7
    s_nop 0
    s_add_u32 s6, s6, s7
    v_readlane_b32 s7, v25, s3
    s_nop 0
    s_cmp_ge_u32 s7, 32
    s_cselect_b32 s61, 1, 0
    s_cselect_b32 s6, 256, s6
    s_cmp_lt_u32 s6, 256
    s_cbranch_scc1 Laq_pure
    s_cmp_eq_u32 s61, 0
    s_cbranch_scc1 Laq_slow
    s_mov_b32 s36, s63
    s_mov_b32 s34, s63
    s_mov_b32 s37, 0
    s_lshl_b32 s56, s63, 6
    s_mul_i32 s58, s14, 9216
    s_mov_b32 s40, 36864
    s_mov_b32 s59, s58
    s_mov_b32 s43, 0
    s_mov_b32 s28, s8
    s_mov_b32 s29, s9
    s_mov_b32 s30, 0
    s_mov_b32 s31, 0x00020000
    s_mul_i32 s41, s63, 4718592
    s_add_u32 s41, s41, s58
    s_add_u32 s41, s41, 6291456
    s_mul_i32 s42, s56, 22528
    s_add_u32 s42, s42, 180224
    s_cmp_lg_u32 s14, 0
    s_cbranch_scc1 Laqf_ini_d
    v_mov_b32 v5, 160
    s_mov_b32 s16, 0
Laqf_ini:
    global_load_dword v6, v5, s[12:13] sc1
    s_add_u32 s16, s16, 1
    s_cmp_gt_u32 s16, 100000
    s_cbranch_scc1 L_role_aq_abort
    s_waitcnt vmcnt(0)
    v_cmp_gt_u32 vcc, 123, v6
    s_nop 0
    s_cbranch_vccz Laqf_ini_d
    s_sleep 8
    s_branch Laqf_ini
Laqf_ini_d:
    s_barrier
    s_branch Laqf_poll
Laqf_item:
    s_waitcnt vmcnt(2)
Laqf_go:
    s_barrier
    s_xor_b32 s40, s40, 36864
    s_xor_b32 s59, s59, 36864
    s_xor_b32 s66, s66, 0x2000
    s_xor_b32 s71, s71, 0x2000
    s_mov_b32 s35, s37
    s_mov_b32 s57, s56
    s_add_u32 s37, s37, 1
    s_add_u32 s56, s56, 1
    s_add_u32 s41, s41, 36864
    s_add_u32 s42, s42, 22528
    s_mov_b32 s62, 0
    v_lshlrev_b32 v9, 9, v8
    v_lshl_add_u32 v9, v7, 4, v9
    s_lshl_b32 s17, s51, 8
    s_add_u32 s17, s17, s40
    v_add_u32 v9, s17, v9
    ds_read_b128 v[56:59], v9 offset:0
    ds_read_b128 v[60:63], v9 offset:2048
    ds_read_b128 v[64:67], v9 offset:4096
    ds_read_b128 v[104:107], v9 offset:6144
    s_waitcnt lgkmcnt(3)
    v_mfma_f32_16x16x32_bf16 v[16:19], v[152:155], v[56:59], 0
    v_add_f32 v80, v80, v84
    v_mfma_f32_16x16x32_bf16 v[20:23], v[224:227], v[56:59], 0
    v_add_f32 v81, v81, v85
    v_mfma_f32_16x16x32_bf16 v[24:27], a[40:43], v[56:59], 0
    v_add_f32 v82, v82, v86
    ds_read_b128 v[56:59], v9 offset:8192
    s_waitcnt lgkmcnt(3)
    v_mfma_f32_16x16x32_bf16 v[16:19], v[156:159], v[60:63], v[16:19]
    v_add_f32 v83, v83, v87
    v_mfma_f32_16x16x32_bf16 v[20:23], v[228:231], v[60:63], v[20:23]
    v_add_f32 v80, v80, v88
    v_mfma_f32_16x16x32_bf16 v[24:27], a[44:47], v[60:63], v[24:27]
    v_add_f32 v81, v81, v89
    ds_read_b128 v[60:63], v9 offset:10240
    s_waitcnt lgkmcnt(3)
    v_mfma_f32_16x16x32_bf16 v[16:19], v[160:163], v[64:67], v[16:19]
    v_add_f32 v82, v82, v90
    v_mfma_f32_16x16x32_bf16 v[20:23], v[232:235], v[64:67], v[20:23]
    v_add_f32 v83, v83, v91
    v_mfma_f32_16x16x32_bf16 v[24:27], a[48:51], v[64:67], v[24:27]
    v_add_f32 v80, v80, v82
    ds_read_b128 v[64:67], v9 offset:12288
    s_waitcnt lgkmcnt(3)
    v_mfma_f32_16x16x32_bf16 v[16:19], v[164:167], v[104:107], v[16:19]
    v_add_f32 v81, v81, v83
    v_mfma_f32_16x16x32_bf16 v[20:23], v[236:239], v[104:107], v[20:23]
    v_mov_b32 v82, v80
    v_mfma_f32_16x16x32_bf16 v[24:27], a[52:55], v[104:107], v[24:27]
    v_mov_b32 v83, v81
    ds_read_b128 v[104:107], v9 offset:14336
    s_waitcnt lgkmcnt(3)
    v_mfma_f32_16x16x32_bf16 v[16:19], v[168:171], v[56:59], v[16:19]
    v_permlane32_swap_b32 v80, v82
    v_mfma_f32_16x16x32_bf16 v[20:23], v[240:243], v[56:59], v[20:23]
    v_permlane32_swap_b32 v81, v83
    v_mfma_f32_16x16x32_bf16 v[24:27], a[56:59], v[56:59], v[24:27]
    v_add_f32 v80, v80, v82
    ds_read_b128 v[56:59], v9 offset:16384
    s_waitcnt lgkmcnt(3)
    v_mfma_f32_16x16x32_bf16 v[16:19], v[172:175], v[60:63], v[16:19]
    v_add_f32 v81, v81, v83
    v_mfma_f32_16x16x32_bf16 v[20:23], v[244:247], v[60:63], v[20:23]
    v_mov_b32 v82, v80
    v_mfma_f32_16x16x32_bf16 v[24:27], a[60:63], v[60:63], v[24:27]
    v_mov_b32 v83, v81
    ds_read_b128 v[60:63], v9 offset:18432
    s_waitcnt lgkmcnt(3)
    v_mfma_f32_16x16x32_bf16 v[16:19], v[176:179], v[64:67], v[16:19]
    v_permlane16_swap_b32 v80, v82
    v_mfma_f32_16x16x32_bf16 v[20:23], v[248:251], v[64:67], v[20:23]
    v_permlane16_swap_b32 v81, v83
    v_mfma_f32_16x16x32_bf16 v[24:27], a[64:67], v[64:67], v[24:27]
    v_add_f32 v80, v80, v82
    ds_read_b128 v[64:67], v9 offset:20480
    s_waitcnt lgkmcnt(3)
    v_mfma_f32_16x16x32_bf16 v[16:19], v[180:183], v[104:107], v[16:19]
    v_add_f32 v81, v81, v83
    v_mfma_f32_16x16x32_bf16 v[20:23], v[252:255], v[104:107], v[20:23]
    v_mul_f32 v80, 0x3ae38e39, v80
    v_mfma_f32_16x16x32_bf16 v[24:27], a[68:71], v[104:107], v[24:27]
    v_mul_f32 v81, 0x3ae38e39, v81
    ds_read_b128 v[104:107], v9 offset:22528
    s_waitcnt lgkmcnt(3)
    v_mfma_f32_16x16x32_bf16 v[16:19], v[184:187], v[56:59], v[16:19]
    v_fma_f32 v81, -v80, v80, v81
    v_mfma_f32_16x16x32_bf16 v[20:23], a[0:3], v[56:59], v[20:23]
    v_max_f32 v81, 0, v81
    v_mfma_f32_16x16x32_bf16 v[24:27], a[72:75], v[56:59], v[24:27]
    v_add_f32 v81, 0x3727c5ac, v81
    ds_read_b128 v[56:59], v9 offset:24576
    s_waitcnt lgkmcnt(3)
    v_mfma_f32_16x16x32_bf16 v[16:19], v[188:191], v[60:63], v[16:19]
    v_rsq_f32 v92, v81
    v_mfma_f32_16x16x32_bf16 v[20:23], a[4:7], v[60:63], v[20:23]
    v_mul_f32 v93, v80, v92
    v_mfma_f32_16x16x32_bf16 v[24:27], a[76:79], v[60:63], v[24:27]
    ds_write_b64 v11, v[92:93]
    ds_read_b128 v[60:63], v9 offset:26624
    s_waitcnt lgkmcnt(4)
    v_mfma_f32_16x16x32_bf16 v[16:19], v[192:195], v[64:67], v[16:19]
    ds_read_b128 v[96:99], v12
    v_mfma_f32_16x16x32_bf16 v[20:23], a[8:11], v[64:67], v[20:23]
    ds_read_b128 v[100:103], v12 offset:16
    v_mfma_f32_16x16x32_bf16 v[24:27], a[80:83], v[64:67], v[24:27]
    s_waitcnt vmcnt(0)
    buffer_load_dword v2, v1, s[8:11], s42 offen sc1
    s_cmp_lg_u32 s43, 0
    s_cselect_b64 exec, 1, 0
    buffer_store_dword v3, v4, s[8:11], s43 offen
    s_mov_b64 exec, -1
    s_mov_b32 s43, 0
    ds_read_b128 v[64:67], v9 offset:28672
    s_waitcnt lgkmcnt(6)
    v_mfma_f32_16x16x32_bf16 v[16:19], v[196:199], v[104:107], v[16:19]
    v_mfma_f32_16x16x32_bf16 v[20:23], a[12:15], v[104:107], v[20:23]
    v_mfma_f32_16x16x32_bf16 v[24:27], a[84:87], v[104:107], v[24:27]
    ds_read_b128 v[104:107], v9 offset:30720
    s_waitcnt lgkmcnt(6)
    v_mfma_f32_16x16x32_bf16 v[16:19], v[200:203], v[56:59], v[16:19]
    v_mfma_f32_16x16x32_bf16 v[20:23], a[16:19], v[56:59], v[20:23]
    v_mfma_f32_16x16x32_bf16 v[24:27], a[88:91], v[56:59], v[24:27]
    ds_read_b128 v[56:59], v9 offset:32768
    s_waitcnt lgkmcnt(5)
    v_mfma_f32_16x16x32_bf16 v[16:19], v[204:207], v[60:63], v[16:19]
    v_mfma_f32_16x16x32_bf16 v[20:23], a[20:23], v[60:63], v[20:23]
    v_mfma_f32_16x16x32_bf16 v[24:27], a[92:95], v[60:63], v[24:27]
    ds_read_b128 v[60:63], v9 offset:34816
    s_waitcnt lgkmcnt(3)
    v_mfma_f32_16x16x32_bf16 v[16:19], v[208:211], v[64:67], v[16:19]
    v_mfma_f32_16x16x32_bf16 v[20:23], a[24:27], v[64:67], v[20:23]
    v_mfma_f32_16x16x32_bf16 v[24:27], a[96:99], v[64:67], v[24:27]
    ds_read_b128 v[64:67], v9 offset:0
    s_waitcnt lgkmcnt(3)
    v_mfma_f32_16x16x32_bf16 v[16:19], v[212:215], v[104:107], v[16:19]
    v_mfma_f32_16x16x32_bf16 v[20:23], a[28:31], v[104:107], v[20:23]
    v_mfma_f32_16x16x32_bf16 v[24:27], a[100:103], v[104:107], v[24:27]
    ds_read_b128 v[104:107], v9 offset:2048
    s_waitcnt lgkmcnt(3)
    v_mfma_f32_16x16x32_bf16 v[16:19], v[216:219], v[56:59], v[16:19]
    v_mfma_f32_16x16x32_bf16 v[20:23], a[32:35], v[56:59], v[20:23]
    v_mfma_f32_16x16x32_bf16 v[24:27], a[104:107], v[56:59], v[24:27]
    ds_read_b128 v[56:59], v9 offset:4096
    s_waitcnt lgkmcnt(3)
    v_mfma_f32_16x16x32_bf16 v[16:19], v[220:223], v[60:63], v[16:19]
    v_mfma_f32_16x16x32_bf16 v[20:23], a[36:39], v[60:63], v[20:23]
    v_mfma_f32_16x16x32_bf16 v[24:27], a[108:111], v[60:63], v[24:27]
    ds_read_b128 v[60:63], v9 offset:6144
    s_waitcnt lgkmcnt(3)
    v_mfma_f32_16x16x32_bf16 v[28:31], v[64:67], a[112:115], 0
    v_mfma_f32_16x16x32_bf16 v[32:35], v[64:67], a[184:187], 0
    ds_read_b128 v[64:67], v9 offset:8192
    s_waitcnt lgkmcnt(3)
    v_mfma_f32_16x16x32_bf16 v[28:31], v[104:107], a[116:119], v[28:31]
    v_mul_f32 v94, v93, v36
    v_fma_f32 v16, v16, v92, -v94
    v_mfma_f32_16x16x32_bf16 v[32:35], v[104:107], a[188:191], v[32:35]
    v_mul_f32 v94, v93, v37
    v_fma_f32 v17, v17, v92, -v94
    ds_read_b128 v[104:107], v9 offset:10240
    s_waitcnt lgkmcnt(3)
    v_mfma_f32_16x16x32_bf16 v[28:31], v[56:59], a[120:123], v[28:31]
    v_mul_f32 v94, v93, v38
    v_fma_f32 v18, v18, v92, -v94
    v_mfma_f32_16x16x32_bf16 v[32:35], v[56:59], a[192:195], v[32:35]
    v_mul_f32 v94, v93, v39
    v_fma_f32 v19, v19, v92, -v94
    ds_read_b128 v[56:59], v9 offset:12288
    s_waitcnt lgkmcnt(3)
    v_mfma_f32_16x16x32_bf16 v[28:31], v[60:63], a[124:127], v[28:31]
    v_mul_f32 v94, v93, v44
    v_fma_f32 v24, v24, v92, -v94
    v_mfma_f32_16x16x32_bf16 v[32:35], v[60:63], a[196:199], v[32:35]
    v_mul_f32 v94, v93, v45
    v_fma_f32 v25, v25, v92, -v94
    ds_read_b128 v[60:63], v9 offset:14336
    s_waitcnt lgkmcnt(3)
    v_mfma_f32_16x16x32_bf16 v[28:31], v[64:67], a[128:131], v[28:31]
    v_mul_f32 v94, v93, v46
    v_fma_f32 v26, v26, v92, -v94
    v_mfma_f32_16x16x32_bf16 v[32:35], v[64:67], a[200:203], v[32:35]
    v_mul_f32 v94, v93, v47
    v_fma_f32 v27, v27, v92, -v94
    s_waitcnt vmcnt(1)
    v_cmp_eq_u32 vcc, 0, v2
    s_nop 0
    s_cmp_eq_u64 vcc, 0
    s_cselect_b32 s62, 1, 0
    s_cmp_lt_u32 s37, 64
    s_cselect_b32 s62, s62, 0
    s_cmp_lg_u32 s62, 0
    s_cselect_b32 s30, 268435456, 0
    ds_read_b128 v[64:67], v9 offset:16384
    s_waitcnt lgkmcnt(3)
    v_mfma_f32_16x16x32_bf16 v[28:31], v[104:107], a[132:135], v[28:31]
    v_mul_f32 v94, v93, v40
    v_fma_f32 v20, v20, v92, -v94
    v_mfma_f32_16x16x32_bf16 v[32:35], v[104:107], a[204:207], v[32:35]
    v_mul_f32 v94, v93, v41
    v_fma_f32 v21, v21, v92, -v94
    s_add_u32 m0, s59, 0
    s_add_u32 s47, s41, 0
    buffer_load_dwordx4 v111, s[28:31], s47 offen offset:0 lds
    ds_read_b128 v[104:107], v9 offset:18432
    s_waitcnt lgkmcnt(3)
    v_mfma_f32_16x16x32_bf16 v[28:31], v[56:59], a[136:139], v[28:31]
    v_mul_f32 v94, v93, v42
    v_fma_f32 v22, v22, v92, -v94
    v_mfma_f32_16x16x32_bf16 v[32:35], v[56:59], a[208:211], v[32:35]
    v_mul_f32 v94, v93, v43
    v_fma_f32 v23, v23, v92, -v94
    buffer_load_dwordx4 v111, s[28:31], s47 offen offset:1024 lds
    ds_read_b128 v[56:59], v9 offset:20480
    s_waitcnt lgkmcnt(3)
    v_mfma_f32_16x16x32_bf16 v[28:31], v[60:63], a[140:143], v[28:31]
    v_cvt_pk_bf16_f32 v128, v16, v17
    v_cvt_pk_bf16_f32 v129, v18, v19
    v_mfma_f32_16x16x32_bf16 v[32:35], v[60:63], a[212:215], v[32:35]
    v_cvt_pk_bf16_f32 v130, v24, v25
    v_cvt_pk_bf16_f32 v132, v20, v21
    buffer_load_dwordx4 v111, s[28:31], s47 offen offset:2048 lds
    ds_read_b128 v[60:63], v9 offset:22528
    s_waitcnt lgkmcnt(3)
    v_mfma_f32_16x16x32_bf16 v[28:31], v[64:67], a[144:147], v[28:31]
    v_cvt_pk_bf16_f32 v133, v22, v23
    v_cvt_pk_bf16_f32 v134, v26, v27
    v_mfma_f32_16x16x32_bf16 v[32:35], v[64:67], a[216:219], v[32:35]
    s_cmp_eq_u32 s35, 0
    s_cselect_b32 s46, 0xf149f2ca, 0
    buffer_load_dwordx4 v111, s[28:31], s47 offen offset:3072 lds
    ds_read_b128 v[64:67], v9 offset:24576
    s_waitcnt lgkmcnt(3)
    v_mfma_f32_16x16x32_bf16 v[28:31], v[104:107], a[148:151], v[28:31]
    v_mfma_f32_16x16x32_bf16 v[144:147], v[112:115], v[128:131], 0
    v_mfma_f32_16x16x32_bf16 v[32:35], v[104:107], a[220:223], v[32:35]
    v_mfma_f32_16x16x32_bf16 v[148:151], v[132:135], v[128:131], 0
    s_add_u32 m0, s59, 4096
    s_add_u32 s47, s41, 4096
    buffer_load_dwordx4 v111, s[28:31], s47 offen offset:0 lds
    ds_read_b128 v[104:107], v9 offset:26624
    s_waitcnt lgkmcnt(3)
    v_mfma_f32_16x16x32_bf16 v[28:31], v[56:59], a[152:155], v[28:31]
    v_mov_b32 v112, v132
    v_mfma_f32_16x16x32_bf16 v[32:35], v[56:59], a[224:227], v[32:35]
    v_mov_b32 v113, v133
    v_mov_b32 v114, v134
    buffer_load_dwordx4 v111, s[28:31], s47 offen offset:1024 lds
    ds_read_b128 v[56:59], v9 offset:28672
    s_waitcnt lgkmcnt(3)
    v_mfma_f32_16x16x32_bf16 v[28:31], v[60:63], a[156:159], v[28:31]
    v_mfma_f32_16x16x32_bf16 v[32:35], v[60:63], a[228:231], v[32:35]
    v_fma_f32 v144, v144, s52, v72
    buffer_load_dwordx4 v111, s[28:31], s47 offen offset:2048 lds
    ds_read_b128 v[60:63], v9 offset:30720
    s_waitcnt lgkmcnt(3)
    v_mfma_f32_16x16x32_bf16 v[28:31], v[64:67], a[160:163], v[28:31]
    v_fma_f32 v145, v145, s52, v73
    v_fma_f32 v146, v146, s52, v74
    v_fma_f32 v147, v147, s52, v75
    v_mfma_f32_16x16x32_bf16 v[32:35], v[64:67], a[232:235], v[32:35]
    v_fma_f32 v148, v148, s52, v76
    v_fma_f32 v149, v149, s52, v77
    v_fma_f32 v150, v150, s52, v78
    buffer_load_dwordx4 v111, s[28:31], s47 offen offset:3072 lds
    ds_read_b128 v[64:67], v9 offset:32768
    s_waitcnt lgkmcnt(3)
    v_mfma_f32_16x16x32_bf16 v[28:31], v[104:107], a[164:167], v[28:31]
    v_fma_f32 v151, v151, s52, v79
    v_add_f32 v144, s46, v144
    v_add_f32 v145, s46, v145
    v_mfma_f32_16x16x32_bf16 v[32:35], v[104:107], a[236:239], v[32:35]
    v_add_f32 v146, s46, v146
    v_add_f32 v147, s46, v147
    v_max3_f32 v5, v144, v145, v146
    s_add_u32 m0, s59, 8192
    s_add_u32 s47, s41, 8192
    buffer_load_dwordx4 v111, s[28:31], s47 offen offset:0 lds
    ds_read_b128 v[104:107], v9 offset:34816
    s_waitcnt lgkmcnt(3)
    v_mfma_f32_16x16x32_bf16 v[28:31], v[56:59], a[168:171], v[28:31]
    v_max3_f32 v5, v5, v147, v148
    v_max3_f32 v5, v5, v149, v150
    v_max_f32 v5, v5, v151
    v_mfma_f32_16x16x32_bf16 v[32:35], v[56:59], a[240:243], v[32:35]
    v_mov_b32 v6, v5
    s_nop 1
    v_permlane32_swap_b32 v5, v6
    s_mul_i32 s48, s36, 786432
    s_mul_i32 s18, s37, 6144
    s_add_u32 s48, s48, s18
    s_add_u32 s48, s48, 15728640
    buffer_load_dwordx4 v[80:83], v10, s[28:31], s48 offen offset:0
    s_waitcnt lgkmcnt(2)
    v_mfma_f32_16x16x32_bf16 v[28:31], v[60:63], a[172:175], v[28:31]
    v_max_f32 v5, v5, v6
    v_mov_b32 v6, v5
    v_mfma_f32_16x16x32_bf16 v[32:35], v[60:63], a[244:247], v[32:35]
    s_nop 0
    v_permlane16_swap_b32 v5, v6
    v_max_f32 v5, v5, v6
    v_sub_f32 v144, v144, v5
    buffer_load_dwordx4 v[84:87], v10, s[28:31], s48 offen offset:512
    s_waitcnt lgkmcnt(1)
    v_mfma_f32_16x16x32_bf16 v[28:31], v[64:67], a[176:179], v[28:31]
    v_sub_f32 v145, v145, v5
    v_sub_f32 v146, v146, v5
    v_sub_f32 v147, v147, v5
    v_mfma_f32_16x16x32_bf16 v[32:35], v[64:67], a[248:251], v[32:35]
    v_sub_f32 v148, v148, v5
    v_sub_f32 v149, v149, v5
    v_sub_f32 v150, v150, v5
    buffer_load_dwordx4 v[88:91], v10, s[28:31], s48 offen offset:1024
    s_waitcnt lgkmcnt(0)
    v_mfma_f32_16x16x32_bf16 v[28:31], v[104:107], a[180:183], v[28:31]
    v_sub_f32 v151, v151, v5
    v_exp_f32 v144, v144
    v_exp_f32 v145, v145
    v_mfma_f32_16x16x32_bf16 v[32:35], v[104:107], a[252:255], v[32:35]
    v_exp_f32 v146, v146
    v_exp_f32 v147, v147
    v_exp_f32 v148, v148
    v_exp_f32 v149, v149
    v_exp_f32 v150, v150
    v_exp_f32 v151, v151
    v_cvt_pk_bf16_f32 v68, v144, v145
    v_cvt_pk_bf16_f32 v69, v146, v147
    v_cvt_pk_bf16_f32 v70, v148, v149
    v_cvt_pk_bf16_f32 v71, v150, v151
    s_nop 1
    v_mfma_f32_16x16x32_bf16 v[16:19], v[116:119], v[68:71], 0
    s_mul_i32 s46, s57, 36864
    s_add_u32 s46, s46, 17301504
    s_nop 5
    v_rcp_f32 v6, v16
    v_mul_f32 v94, v97, v48
    v_fma_f32 v28, v28, v96, -v94
    v_mul_f32 v94, v99, v49
    v_fma_f32 v29, v29, v98, -v94
    v_mul_f32 v94, v101, v50
    v_fma_f32 v30, v30, v100, -v94
    v_mul_f32 v94, v103, v51
    v_fma_f32 v31, v31, v102, -v94
    v_cvt_pk_bf16_f32 v138, v28, v29
    v_cvt_pk_bf16_f32 v139, v30, v31
    v_mul_f32 v94, v97, v52
    v_fma_f32 v32, v32, v96, -v94
    v_mfma_f32_16x16x32_bf16 v[20:23], v[136:139], v[68:71], 0
    v_mul_f32 v94, v99, v53
    v_fma_f32 v33, v33, v98, -v94
    v_mul_f32 v94, v101, v54
    v_fma_f32 v34, v34, v100, -v94
    v_mul_f32 v94, v103, v55
    v_fma_f32 v35, v35, v102, -v94
    v_cvt_pk_bf16_f32 v142, v32, v33
    v_cvt_pk_bf16_f32 v143, v34, v35
    v_mov_b32 v136, v138
    v_mov_b32 v137, v139
    v_mfma_f32_16x16x32_bf16 v[24:27], v[140:143], v[68:71], 0
    v_mul_f32 v20, v6, v20
    v_mul_f32 v21, v6, v21
    v_mul_f32 v22, v6, v22
    v_mul_f32 v23, v6, v23
    v_cvt_pk_bf16_f32 v20, v20, v21
    v_cvt_pk_bf16_f32 v21, v22, v23
    buffer_store_dwordx2 v[20:21], v13, s[8:11], s46 offen
    v_mov_b32 v140, v142
    v_mov_b32 v141, v143
    v_mul_f32 v24, v6, v24
    v_mul_f32 v25, v6, v25
    v_cvt_pk_bf16_f32 v24, v24, v25
    s_mov_b64 exec, 0xffff
    buffer_store_dword v24, v14, s[8:11], s46 offen
    s_mov_b64 exec, -1
    s_mul_i32 s43, s57, 22528
    s_add_u32 s43, s43, s49
    s_cmp_lg_u32 s62, 0
    s_cbranch_scc1 Laqf_item
    buffer_load_dword v2, v1, s[8:11], s42 offen sc1
    s_waitcnt vmcnt(0)
    s_cmp_ge_u32 s37, 64
    s_cbranch_scc1 Laqf_fin
    v_cmp_eq_u32 vcc, 0, v2
    s_nop 0
    s_cbranch_vccnz Laqf_pub
    s_add_u32 m0, s59, 0
    s_add_u32 s47, s41, 0
    buffer_load_dwordx4 v111, s[8:11], s47 offen offset:0 lds
    buffer_load_dwordx4 v111, s[8:11], s47 offen offset:1024 lds
    buffer_load_dwordx4 v111, s[8:11], s47 offen offset:2048 lds
    buffer_load_dwordx4 v111, s[8:11], s47 offen offset:3072 lds
    s_add_u32 m0, s59, 4096
    s_add_u32 s47, s41, 4096
    buffer_load_dwordx4 v111, s[8:11], s47 offen offset:0 lds
    buffer_load_dwordx4 v111, s[8:11], s47 offen offset:1024 lds
    buffer_load_dwordx4 v111, s[8:11], s47 offen offset:2048 lds
    buffer_load_dwordx4 v111, s[8:11], s47 offen offset:3072 lds
    s_add_u32 m0, s59, 8192
    s_add_u32 s47, s41, 8192
    buffer_load_dwordx4 v111, s[8:11], s47 offen offset:0 lds
    s_mul_i32 s48, s36, 786432
    s_mul_i32 s18, s37, 6144
    s_add_u32 s48, s48, s18
    s_add_u32 s48, s48, 15728640
    buffer_load_dwordx4 v[80:83], v10, s[8:11], s48 offen offset:0
    buffer_load_dwordx4 v[84:87], v10, s[8:11], s48 offen offset:512
    buffer_load_dwordx4 v[88:91], v10, s[8:11], s48 offen offset:1024
    s_cmp_lg_u32 s43, 0
    s_cselect_b64 exec, 1, 0
    buffer_store_dword v3, v4, s[8:11], s43 offen
    s_mov_b64 exec, -1
    s_mov_b32 s43, 0
    s_waitcnt vmcnt(1)
    s_branch Laqf_go
Laqf_fin:
    s_cmp_lg_u32 s43, 0
    s_cselect_b64 exec, 1, 0
    buffer_store_dword v3, v4, s[8:11], s43 offen
    s_mov_b64 exec, -1
    s_mov_b32 s43, 0
    s_branch L_role_aq_exit
Laqf_pub:
    s_cmp_lg_u32 s43, 0
    s_cselect_b64 exec, 1, 0
    buffer_store_dword v3, v4, s[8:11], s43 offen
    s_mov_b64 exec, -1
    s_mov_b32 s43, 0
Laqf_poll:
    s_mov_b32 s16, 0
Laqf_pl:
    buffer_load_dword v2, v1, s[8:11], s42 offen sc1
    s_add_u32 s16, s16, 1
    s_cmp_gt_u32 s16, 100000
    s_cbranch_scc1 L_role_aq_abort
    s_waitcnt vmcnt(0)
    v_cmp_eq_u32 vcc, 0, v2
    s_nop 0
    s_cbranch_vccz Laqf_pld
    s_sleep 4
    s_branch Laqf_pl
Laqf_pld:
    s_add_u32 m0, s59, 0
    s_add_u32 s47, s41, 0
    buffer_load_dwordx4 v111, s[8:11], s47 offen offset:0 lds
    buffer_load_dwordx4 v111, s[8:11], s47 offen offset:1024 lds
    buffer_load_dwordx4 v111, s[8:11], s47 offen offset:2048 lds
    buffer_load_dwordx4 v111, s[8:11], s47 offen offset:3072 lds
    s_add_u32 m0, s59, 4096
    s_add_u32 s47, s41, 4096
    buffer_load_dwordx4 v111, s[8:11], s47 offen offset:0 lds
    buffer_load_dwordx4 v111, s[8:11], s47 offen offset:1024 lds
    buffer_load_dwordx4 v111, s[8:11], s47 offen offset:2048 lds
    buffer_load_dwordx4 v111, s[8:11], s47 offen offset:3072 lds
    s_add_u32 m0, s59, 8192
    s_add_u32 s47, s41, 8192
    buffer_load_dwordx4 v111, s[8:11], s47 offen offset:0 lds
    s_mul_i32 s48, s36, 786432
    s_mul_i32 s18, s37, 6144
    s_add_u32 s48, s48, s18
    s_add_u32 s48, s48, 15728640
    buffer_load_dwordx4 v[80:83], v10, s[8:11], s48 offen offset:0
    buffer_load_dwordx4 v[84:87], v10, s[8:11], s48 offen offset:512
    buffer_load_dwordx4 v[88:91], v10, s[8:11], s48 offen offset:1024
    s_waitcnt vmcnt(0)
    s_branch Laqf_go
Laq_slow:
    s_mov_b32 s36, s63
    s_mov_b32 s34, s63
    s_mov_b32 s37, 0
    s_lshl_b32 s56, s63, 6
    s_mul_i32 s58, s14, 9216
    s_mov_b32 s40, 36864
    s_mov_b32 s59, s58
    s_mov_b32 s43, 0
    s_mov_b32 s28, s8
    s_mov_b32 s29, s9
    s_mov_b32 s30, 0
    s_mov_b32 s31, 0x00020000
    s_mul_i32 s41, s63, 4718592
    s_add_u32 s41, s41, s58
    s_add_u32 s41, s41, 6291456
    s_mul_i32 s42, s56, 22528
    s_add_u32 s42, s42, 180224
    s_cmp_lg_u32 s14, 0
    s_cbranch_scc1 Laq_ini_d
    v_mov_b32 v5, 160
    s_mov_b32 s16, 0
Laq_ini:
    global_load_dword v6, v5, s[12:13] sc1
    s_add_u32 s16, s16, 1
    s_cmp_gt_u32 s16, 100000
    s_cbranch_scc1 L_role_aq_abort
    s_waitcnt vmcnt(0)
    v_cmp_gt_u32 vcc, 123, v6
    s_nop 0
    s_cbranch_vccz Laq_ini_d
    s_sleep 8
    s_branch Laq_ini
Laq_ini_d:
    s_barrier
    s_branch Laq_poll
Laq_item:
    s_waitcnt vmcnt(2)
Laq_go:
    s_barrier
    s_xor_b32 s40, s40, 36864
    s_xor_b32 s59, s59, 36864
    s_xor_b32 s66, s66, 0x2000
    s_xor_b32 s71, s71, 0x2000
    s_mov_b32 s35, s37
    s_mov_b32 s57, s56
    s_add_u32 s37, s37, 1
    s_add_u32 s56, s56, 1
    s_add_u32 s41, s41, 36864
    s_add_u32 s42, s42, 22528
    s_mov_b32 s62, 0
    v_lshlrev_b32 v9, 9, v8
    v_lshl_add_u32 v9, v7, 4, v9
    s_lshl_b32 s17, s51, 8
    s_add_u32 s17, s17, s40
    v_add_u32 v9, s17, v9
    ds_read_b128 v[56:59], v9 offset:0
    ds_read_b128 v[60:63], v9 offset:2048
    ds_read_b128 v[64:67], v9 offset:4096
    ds_read_b128 v[104:107], v9 offset:6144
    s_waitcnt lgkmcnt(3)
    v_mfma_f32_16x16x32_bf16 v[16:19], v[152:155], v[56:59], 0
    v_add_f32 v80, v80, v84
    v_mfma_f32_16x16x32_bf16 v[20:23], v[224:227], v[56:59], 0
    v_add_f32 v81, v81, v85
    v_mfma_f32_16x16x32_bf16 v[24:27], a[40:43], v[56:59], 0
    v_add_f32 v82, v82, v86
    ds_read_b128 v[56:59], v9 offset:8192
    s_waitcnt lgkmcnt(3)
    v_mfma_f32_16x16x32_bf16 v[16:19], v[156:159], v[60:63], v[16:19]
    v_add_f32 v83, v83, v87
    v_mfma_f32_16x16x32_bf16 v[20:23], v[228:231], v[60:63], v[20:23]
    v_add_f32 v80, v80, v88
    v_mfma_f32_16x16x32_bf16 v[24:27], a[44:47], v[60:63], v[24:27]
    v_add_f32 v81, v81, v89
    ds_read_b128 v[60:63], v9 offset:10240
    s_waitcnt lgkmcnt(3)
    v_mfma_f32_16x16x32_bf16 v[16:19], v[160:163], v[64:67], v[16:19]
    v_add_f32 v82, v82, v90
    v_mfma_f32_16x16x32_bf16 v[20:23], v[232:235], v[64:67], v[20:23]
    v_add_f32 v83, v83, v91
    v_mfma_f32_16x16x32_bf16 v[24:27], a[48:51], v[64:67], v[24:27]
    v_add_f32 v80, v80, v82
    ds_read_b128 v[64:67], v9 offset:12288
    s_waitcnt lgkmcnt(3)
    v_mfma_f32_16x16x32_bf16 v[16:19], v[164:167], v[104:107], v[16:19]
    v_add_f32 v81, v81, v83
    v_mfma_f32_16x16x32_bf16 v[20:23], v[236:239], v[104:107], v[20:23]
    v_mov_b32 v82, v80
    v_mfma_f32_16x16x32_bf16 v[24:27], a[52:55], v[104:107], v[24:27]
    v_mov_b32 v83, v81
    ds_read_b128 v[104:107], v9 offset:14336
    s_waitcnt lgkmcnt(3)
    v_mfma_f32_16x16x32_bf16 v[16:19], v[168:171], v[56:59], v[16:19]
    v_permlane32_swap_b32 v80, v82
    v_mfma_f32_16x16x32_bf16 v[20:23], v[240:243], v[56:59], v[20:23]
    v_permlane32_swap_b32 v81, v83
    v_mfma_f32_16x16x32_bf16 v[24:27], a[56:59], v[56:59], v[24:27]
    v_add_f32 v80, v80, v82
    ds_read_b128 v[56:59], v9 offset:16384
    s_waitcnt lgkmcnt(3)
    v_mfma_f32_16x16x32_bf16 v[16:19], v[172:175], v[60:63], v[16:19]
    v_add_f32 v81, v81, v83
    v_mfma_f32_16x16x32_bf16 v[20:23], v[244:247], v[60:63], v[20:23]
    v_mov_b32 v82, v80
    v_mfma_f32_16x16x32_bf16 v[24:27], a[60:63], v[60:63], v[24:27]
    v_mov_b32 v83, v81
    ds_read_b128 v[60:63], v9 offset:18432
    s_waitcnt lgkmcnt(3)
    v_mfma_f32_16x16x32_bf16 v[16:19], v[176:179], v[64:67], v[16:19]
    v_permlane16_swap_b32 v80, v82
    v_mfma_f32_16x16x32_bf16 v[20:23], v[248:251], v[64:67], v[20:23]
    v_permlane16_swap_b32 v81, v83
    v_mfma_f32_16x16x32_bf16 v[24:27], a[64:67], v[64:67], v[24:27]
    v_add_f32 v80, v80, v82
    ds_read_b128 v[64:67], v9 offset:20480
    s_waitcnt lgkmcnt(3)
    v_mfma_f32_16x16x32_bf16 v[16:19], v[180:183], v[104:107], v[16:19]
    v_add_f32 v81, v81, v83
    v_mfma_f32_16x16x32_bf16 v[20:23], v[252:255], v[104:107], v[20:23]
    v_mul_f32 v80, 0x3ae38e39, v80
    v_mfma_f32_16x16x32_bf16 v[24:27], a[68:71], v[104:107], v[24:27]
    v_mul_f32 v81, 0x3ae38e39, v81
    ds_read_b128 v[104:107], v9 offset:22528
    s_waitcnt lgkmcnt(3)
    v_mfma_f32_16x16x32_bf16 v[16:19], v[184:187], v[56:59], v[16:19]
    v_fma_f32 v81, -v80, v80, v81
    v_mfma_f32_16x16x32_bf16 v[20:23], a[0:3], v[56:59], v[20:23]
    v_max_f32 v81, 0, v81
    v_mfma_f32_16x16x32_bf16 v[24:27], a[72:75], v[56:59], v[24:27]
    v_add_f32 v81, 0x3727c5ac, v81
    ds_read_b128 v[56:59], v9 offset:24576
    s_waitcnt lgkmcnt(3)
    v_mfma_f32_16x16x32_bf16 v[16:19], v[188:191], v[60:63], v[16:19]
    v_rsq_f32 v92, v81
    v_mfma_f32_16x16x32_bf16 v[20:23], a[4:7], v[60:63], v[20:23]
    v_mul_f32 v93, v80, v92
    v_mfma_f32_16x16x32_bf16 v[24:27], a[76:79], v[60:63], v[24:27]
    ds_write_b64 v11, v[92:93]
    ds_read_b128 v[60:63], v9 offset:26624
    s_waitcnt lgkmcnt(4)
    v_mfma_f32_16x16x32_bf16 v[16:19], v[192:195], v[64:67], v[16:19]
    ds_read_b128 v[96:99], v12
    v_mfma_f32_16x16x32_bf16 v[20:23], a[8:11], v[64:67], v[20:23]
    ds_read_b128 v[100:103], v12 offset:16
    v_mfma_f32_16x16x32_bf16 v[24:27], a[80:83], v[64:67], v[24:27]
    s_waitcnt vmcnt(0)
    buffer_load_dword v2, v1, s[8:11], s42 offen sc1
    s_cmp_lg_u32 s43, 0
    s_cselect_b64 exec, 1, 0
    buffer_store_dword v3, v4, s[8:11], s43 offen sc1
    s_mov_b64 exec, -1
    s_mov_b32 s43, 0
    ds_read_b128 v[64:67], v9 offset:28672
    s_waitcnt lgkmcnt(6)
    v_mfma_f32_16x16x32_bf16 v[16:19], v[196:199], v[104:107], v[16:19]
    v_mfma_f32_16x16x32_bf16 v[20:23], a[12:15], v[104:107], v[20:23]
    v_mfma_f32_16x16x32_bf16 v[24:27], a[84:87], v[104:107], v[24:27]
    ds_read_b128 v[104:107], v9 offset:30720
    s_waitcnt lgkmcnt(6)
    v_mfma_f32_16x16x32_bf16 v[16:19], v[200:203], v[56:59], v[16:19]
    v_mfma_f32_16x16x32_bf16 v[20:23], a[16:19], v[56:59], v[20:23]
    v_mfma_f32_16x16x32_bf16 v[24:27], a[88:91], v[56:59], v[24:27]
    ds_read_b128 v[56:59], v9 offset:32768
    s_waitcnt lgkmcnt(5)
    v_mfma_f32_16x16x32_bf16 v[16:19], v[204:207], v[60:63], v[16:19]
    v_mfma_f32_16x16x32_bf16 v[20:23], a[20:23], v[60:63], v[20:23]
    v_mfma_f32_16x16x32_bf16 v[24:27], a[92:95], v[60:63], v[24:27]
    ds_read_b128 v[60:63], v9 offset:34816
    s_waitcnt lgkmcnt(3)
    v_mfma_f32_16x16x32_bf16 v[16:19], v[208:211], v[64:67], v[16:19]
    v_mfma_f32_16x16x32_bf16 v[20:23], a[24:27], v[64:67], v[20:23]
    v_mfma_f32_16x16x32_bf16 v[24:27], a[96:99], v[64:67], v[24:27]
    ds_read_b128 v[64:67], v9 offset:0
    s_waitcnt lgkmcnt(3)
    v_mfma_f32_16x16x32_bf16 v[16:19], v[212:215], v[104:107], v[16:19]
    v_mfma_f32_16x16x32_bf16 v[20:23], a[28:31], v[104:107], v[20:23]
    v_mfma_f32_16x16x32_bf16 v[24:27], a[100:103], v[104:107], v[24:27]
    ds_read_b128 v[104:107], v9 offset:2048
    s_waitcnt lgkmcnt(3)
    v_mfma_f32_16x16x32_bf16 v[16:19], v[216:219], v[56:59], v[16:19]
    v_mfma_f32_16x16x32_bf16 v[20:23], a[32:35], v[56:59], v[20:23]
    v_mfma_f32_16x16x32_bf16 v[24:27], a[104:107], v[56:59], v[24:27]
    ds_read_b128 v[56:59], v9 offset:4096
    s_waitcnt lgkmcnt(3)
    v_mfma_f32_16x16x32_bf16 v[16:19], v[220:223], v[60:63], v[16:19]
    v_mfma_f32_16x16x32_bf16 v[20:23], a[36:39], v[60:63], v[20:23]
    v_mfma_f32_16x16x32_bf16 v[24:27], a[108:111], v[60:63], v[24:27]
    ds_read_b128 v[60:63], v9 offset:6144
    s_waitcnt lgkmcnt(3)
    v_mfma_f32_16x16x32_bf16 v[28:31], v[64:67], a[112:115], 0
    v_mfma_f32_16x16x32_bf16 v[32:35], v[64:67], a[184:187], 0
    ds_read_b128 v[64:67], v9 offset:8192
    s_waitcnt lgkmcnt(3)
    v_mfma_f32_16x16x32_bf16 v[28:31], v[104:107], a[116:119], v[28:31]
    v_mul_f32 v94, v93, v36
    v_fma_f32 v16, v16, v92, -v94
    v_mfma_f32_16x16x32_bf16 v[32:35], v[104:107], a[188:191], v[32:35]
    v_mul_f32 v94, v93, v37
    v_fma_f32 v17, v17, v92, -v94
    ds_read_b128 v[104:107], v9 offset:10240
    s_waitcnt lgkmcnt(3)
    v_mfma_f32_16x16x32_bf16 v[28:31], v[56:59], a[120:123], v[28:31]
    v_mul_f32 v94, v93, v38
    v_fma_f32 v18, v18, v92, -v94
    v_mfma_f32_16x16x32_bf16 v[32:35], v[56:59], a[192:195], v[32:35]
    v_mul_f32 v94, v93, v39
    v_fma_f32 v19, v19, v92, -v94
    ds_read_b128 v[56:59], v9 offset:12288
    s_waitcnt lgkmcnt(3)
    v_mfma_f32_16x16x32_bf16 v[28:31], v[60:63], a[124:127], v[28:31]
    v_mul_f32 v94, v93, v44
    v_fma_f32 v24, v24, v92, -v94
    v_mfma_f32_16x16x32_bf16 v[32:35], v[60:63], a[196:199], v[32:35]
    v_mul_f32 v94, v93, v45
    v_fma_f32 v25, v25, v92, -v94
    ds_read_b128 v[60:63], v9 offset:14336
    s_waitcnt lgkmcnt(3)
    v_mfma_f32_16x16x32_bf16 v[28:31], v[64:67], a[128:131], v[28:31]
    v_mul_f32 v94, v93, v46
    v_fma_f32 v26, v26, v92, -v94
    v_mfma_f32_16x16x32_bf16 v[32:35], v[64:67], a[200:203], v[32:35]
    v_mul_f32 v94, v93, v47
    v_fma_f32 v27, v27, v92, -v94
    s_waitcnt vmcnt(1)
    v_cmp_eq_u32 vcc, 0, v2
    s_nop 0
    s_cmp_eq_u64 vcc, 0
    s_cselect_b32 s62, 1, 0
    s_cmp_lt_u32 s37, 64
    s_cselect_b32 s62, s62, 0
    s_cmp_lg_u32 s62, 0
    s_cselect_b32 s30, 268435456, 0
    ds_read_b128 v[64:67], v9 offset:16384
    s_waitcnt lgkmcnt(3)
    v_mfma_f32_16x16x32_bf16 v[28:31], v[104:107], a[132:135], v[28:31]
    v_mul_f32 v94, v93, v40
    v_fma_f32 v20, v20, v92, -v94
    v_mfma_f32_16x16x32_bf16 v[32:35], v[104:107], a[204:207], v[32:35]
    v_mul_f32 v94, v93, v41
    v_fma_f32 v21, v21, v92, -v94
    s_add_u32 m0, s59, 0
    s_add_u32 s47, s41, 0
    buffer_load_dwordx4 v111, s[28:31], s47 offen offset:0 lds
    ds_read_b128 v[104:107], v9 offset:18432
    s_waitcnt lgkmcnt(3)
    v_mfma_f32_16x16x32_bf16 v[28:31], v[56:59], a[136:139], v[28:31]
    v_mul_f32 v94, v93, v42
    v_fma_f32 v22, v22, v92, -v94
    v_mfma_f32_16x16x32_bf16 v[32:35], v[56:59], a[208:211], v[32:35]
    v_mul_f32 v94, v93, v43
    v_fma_f32 v23, v23, v92, -v94
    buffer_load_dwordx4 v111, s[28:31], s47 offen offset:1024 lds
    ds_read_b128 v[56:59], v9 offset:20480
    s_waitcnt lgkmcnt(3)
    v_mfma_f32_16x16x32_bf16 v[28:31], v[60:63], a[140:143], v[28:31]
    v_cvt_pk_bf16_f32 v128, v16, v17
    v_cvt_pk_bf16_f32 v129, v18, v19
    v_mfma_f32_16x16x32_bf16 v[32:35], v[60:63], a[212:215], v[32:35]
    v_cvt_pk_bf16_f32 v130, v24, v25
    v_cvt_pk_bf16_f32 v132, v20, v21
    buffer_load_dwordx4 v111, s[28:31], s47 offen offset:2048 lds
    ds_read_b128 v[60:63], v9 offset:22528
    s_waitcnt lgkmcnt(3)
    v_mfma_f32_16x16x32_bf16 v[28:31], v[64:67], a[144:147], v[28:31]
    v_cvt_pk_bf16_f32 v133, v22, v23
    v_cvt_pk_bf16_f32 v134, v26, v27
    v_mfma_f32_16x16x32_bf16 v[32:35], v[64:67], a[216:219], v[32:35]
    s_cmp_eq_u32 s35, 0
    s_cselect_b32 s46, 0xf149f2ca, 0
    buffer_load_dwordx4 v111, s[28:31], s47 offen offset:3072 lds
    ds_read_b128 v[64:67], v9 offset:24576
    s_waitcnt lgkmcnt(3)
    v_mfma_f32_16x16x32_bf16 v[28:31], v[104:107], a[148:151], v[28:31]
    v_mfma_f32_16x16x32_bf16 v[144:147], v[112:115], v[128:131], 0
    v_mfma_f32_16x16x32_bf16 v[32:35], v[104:107], a[220:223], v[32:35]
    v_mfma_f32_16x16x32_bf16 v[148:151], v[132:135], v[128:131], 0
    s_add_u32 m0, s59, 4096
    s_add_u32 s47, s41, 4096
    buffer_load_dwordx4 v111, s[28:31], s47 offen offset:0 lds
    ds_read_b128 v[104:107], v9 offset:26624
    s_waitcnt lgkmcnt(3)
    v_mfma_f32_16x16x32_bf16 v[28:31], v[56:59], a[152:155], v[28:31]
    v_mov_b32 v112, v132
    v_mfma_f32_16x16x32_bf16 v[32:35], v[56:59], a[224:227], v[32:35]
    v_mov_b32 v113, v133
    v_mov_b32 v114, v134
    buffer_load_dwordx4 v111, s[28:31], s47 offen offset:1024 lds
    ds_read_b128 v[56:59], v9 offset:28672
    s_waitcnt lgkmcnt(3)
    v_mfma_f32_16x16x32_bf16 v[28:31], v[60:63], a[156:159], v[28:31]
    v_mfma_f32_16x16x32_bf16 v[32:35], v[60:63], a[228:231], v[32:35]
    v_fma_f32 v144, v144, s52, v72
    buffer_load_dwordx4 v111, s[28:31], s47 offen offset:2048 lds
    ds_read_b128 v[60:63], v9 offset:30720
    s_waitcnt lgkmcnt(3)
    v_mfma_f32_16x16x32_bf16 v[28:31], v[64:67], a[160:163], v[28:31]
    v_fma_f32 v145, v145, s52, v73
    v_fma_f32 v146, v146, s52, v74
    v_fma_f32 v147, v147, s52, v75
    v_mfma_f32_16x16x32_bf16 v[32:35], v[64:67], a[232:235], v[32:35]
    v_fma_f32 v148, v148, s52, v76
    v_fma_f32 v149, v149, s52, v77
    v_fma_f32 v150, v150, s52, v78
    buffer_load_dwordx4 v111, s[28:31], s47 offen offset:3072 lds
    ds_read_b128 v[64:67], v9 offset:32768
    s_waitcnt lgkmcnt(3)
    v_mfma_f32_16x16x32_bf16 v[28:31], v[104:107], a[164:167], v[28:31]
    v_fma_f32 v151, v151, s52, v79
    v_add_f32 v144, s46, v144
    v_add_f32 v145, s46, v145
    v_mfma_f32_16x16x32_bf16 v[32:35], v[104:107], a[236:239], v[32:35]
    v_add_f32 v146, s46, v146
    v_add_f32 v147, s46, v147
    v_max3_f32 v5, v144, v145, v146
    s_add_u32 m0, s59, 8192
    s_add_u32 s47, s41, 8192
    buffer_load_dwordx4 v111, s[28:31], s47 offen offset:0 lds
    ds_read_b128 v[104:107], v9 offset:34816
    s_waitcnt lgkmcnt(3)
    v_mfma_f32_16x16x32_bf16 v[28:31], v[56:59], a[168:171], v[28:31]
    v_max3_f32 v5, v5, v147, v148
    v_max3_f32 v5, v5, v149, v150
    v_max_f32 v5, v5, v151
    v_mfma_f32_16x16x32_bf16 v[32:35], v[56:59], a[240:243], v[32:35]
    v_mov_b32 v6, v5
    s_nop 1
    v_permlane32_swap_b32 v5, v6
    s_mul_i32 s48, s36, 786432
    s_mul_i32 s18, s37, 6144
    s_add_u32 s48, s48, s18
    s_add_u32 s48, s48, 15728640
    buffer_load_dwordx4 v[80:83], v10, s[28:31], s48 offen offset:0
    s_waitcnt lgkmcnt(2)
    v_mfma_f32_16x16x32_bf16 v[28:31], v[60:63], a[172:175], v[28:31]
    v_max_f32 v5, v5, v6
    v_mov_b32 v6, v5
    v_mfma_f32_16x16x32_bf16 v[32:35], v[60:63], a[244:247], v[32:35]
    s_nop 0
    v_permlane16_swap_b32 v5, v6
    v_max_f32 v5, v5, v6
    v_sub_f32 v144, v144, v5
    buffer_load_dwordx4 v[84:87], v10, s[28:31], s48 offen offset:512
    s_waitcnt lgkmcnt(1)
    v_mfma_f32_16x16x32_bf16 v[28:31], v[64:67], a[176:179], v[28:31]
    v_sub_f32 v145, v145, v5
    v_sub_f32 v146, v146, v5
    v_sub_f32 v147, v147, v5
    v_mfma_f32_16x16x32_bf16 v[32:35], v[64:67], a[248:251], v[32:35]
    v_sub_f32 v148, v148, v5
    v_sub_f32 v149, v149, v5
    v_sub_f32 v150, v150, v5
    buffer_load_dwordx4 v[88:91], v10, s[28:31], s48 offen offset:1024
    s_waitcnt lgkmcnt(0)
    v_mfma_f32_16x16x32_bf16 v[28:31], v[104:107], a[180:183], v[28:31]
    v_sub_f32 v151, v151, v5
    v_exp_f32 v144, v144
    v_exp_f32 v145, v145
    v_mfma_f32_16x16x32_bf16 v[32:35], v[104:107], a[252:255], v[32:35]
    v_exp_f32 v146, v146
    v_exp_f32 v147, v147
    v_exp_f32 v148, v148
    v_exp_f32 v149, v149
    v_exp_f32 v150, v150
    v_exp_f32 v151, v151
    v_cvt_pk_bf16_f32 v68, v144, v145
    v_cvt_pk_bf16_f32 v69, v146, v147
    v_cvt_pk_bf16_f32 v70, v148, v149
    v_cvt_pk_bf16_f32 v71, v150, v151
    s_nop 1
    v_mfma_f32_16x16x32_bf16 v[16:19], v[116:119], v[68:71], 0
    s_mul_i32 s46, s57, 36864
    s_add_u32 s46, s46, 17301504
    s_nop 5
    v_rcp_f32 v6, v16
    v_mul_f32 v94, v97, v48
    v_fma_f32 v28, v28, v96, -v94
    v_mul_f32 v94, v99, v49
    v_fma_f32 v29, v29, v98, -v94
    v_mul_f32 v94, v101, v50
    v_fma_f32 v30, v30, v100, -v94
    v_mul_f32 v94, v103, v51
    v_fma_f32 v31, v31, v102, -v94
    v_cvt_pk_bf16_f32 v138, v28, v29
    v_cvt_pk_bf16_f32 v139, v30, v31
    v_mul_f32 v94, v97, v52
    v_fma_f32 v32, v32, v96, -v94
    v_mfma_f32_16x16x32_bf16 v[20:23], v[136:139], v[68:71], 0
    v_mul_f32 v94, v99, v53
    v_fma_f32 v33, v33, v98, -v94
    v_mul_f32 v94, v101, v54
    v_fma_f32 v34, v34, v100, -v94
    v_mul_f32 v94, v103, v55
    v_fma_f32 v35, v35, v102, -v94
    v_cvt_pk_bf16_f32 v142, v32, v33
    v_cvt_pk_bf16_f32 v143, v34, v35
    v_mov_b32 v136, v138
    v_mov_b32 v137, v139
    v_mfma_f32_16x16x32_bf16 v[24:27], v[140:143], v[68:71], 0
    v_mul_f32 v20, v6, v20
    v_mul_f32 v21, v6, v21
    v_mul_f32 v22, v6, v22
    v_mul_f32 v23, v6, v23
    v_cvt_pk_bf16_f32 v20, v20, v21
    v_cvt_pk_bf16_f32 v21, v22, v23
    buffer_store_dwordx2 v[20:21], v13, s[8:11], s46 offen sc1
    v_mov_b32 v140, v142
    v_mov_b32 v141, v143
    v_mul_f32 v24, v6, v24
    v_mul_f32 v25, v6, v25
    v_cvt_pk_bf16_f32 v24, v24, v25
    s_mov_b64 exec, 0xffff
    buffer_store_dword v24, v14, s[8:11], s46 offen sc1
    s_mov_b64 exec, -1
    s_mul_i32 s43, s57, 22528
    s_add_u32 s43, s43, s49
    s_cmp_lg_u32 s62, 0
    s_cbranch_scc1 Laq_item
    buffer_load_dword v2, v1, s[8:11], s42 offen sc1
    s_waitcnt vmcnt(0)
    s_cmp_ge_u32 s37, 64
    s_cbranch_scc1 Laq_fin
    v_cmp_eq_u32 vcc, 0, v2
    s_nop 0
    s_cbranch_vccnz Laq_pub
    s_add_u32 m0, s59, 0
    s_add_u32 s47, s41, 0
    buffer_load_dwordx4 v111, s[8:11], s47 offen offset:0 lds
    buffer_load_dwordx4 v111, s[8:11], s47 offen offset:1024 lds
    buffer_load_dwordx4 v111, s[8:11], s47 offen offset:2048 lds
    buffer_load_dwordx4 v111, s[8:11], s47 offen offset:3072 lds
    s_add_u32 m0, s59, 4096
    s_add_u32 s47, s41, 4096
    buffer_load_dwordx4 v111, s[8:11], s47 offen offset:0 lds
    buffer_load_dwordx4 v111, s[8:11], s47 offen offset:1024 lds
    buffer_load_dwordx4 v111, s[8:11], s47 offen offset:2048 lds
    buffer_load_dwordx4 v111, s[8:11], s47 offen offset:3072 lds
    s_add_u32 m0, s59, 8192
    s_add_u32 s47, s41, 8192
    buffer_load_dwordx4 v111, s[8:11], s47 offen offset:0 lds
    s_mul_i32 s48, s36, 786432
    s_mul_i32 s18, s37, 6144
    s_add_u32 s48, s48, s18
    s_add_u32 s48, s48, 15728640
    buffer_load_dwordx4 v[80:83], v10, s[8:11], s48 offen offset:0
    buffer_load_dwordx4 v[84:87], v10, s[8:11], s48 offen offset:512
    buffer_load_dwordx4 v[88:91], v10, s[8:11], s48 offen offset:1024
    s_cmp_lg_u32 s43, 0
    s_cselect_b64 exec, 1, 0
    buffer_store_dword v3, v4, s[8:11], s43 offen sc1
    s_mov_b64 exec, -1
    s_mov_b32 s43, 0
    s_waitcnt vmcnt(1)
    s_branch Laq_go
Laq_fin:
    s_cmp_lg_u32 s43, 0
    s_cselect_b64 exec, 1, 0
    buffer_store_dword v3, v4, s[8:11], s43 offen sc1
    s_mov_b64 exec, -1
    s_mov_b32 s43, 0
    s_branch L_role_aq_exit
Laq_pub:
    s_cmp_lg_u32 s43, 0
    s_cselect_b64 exec, 1, 0
    buffer_store_dword v3, v4, s[8:11], s43 offen sc1
    s_mov_b64 exec, -1
    s_mov_b32 s43, 0
Laq_poll:
    s_mov_b32 s16, 0
Laq_pl:
    buffer_load_dword v2, v1, s[8:11], s42 offen sc1
    s_add_u32 s16, s16, 1
    s_cmp_gt_u32 s16, 100000
    s_cbranch_scc1 L_role_aq_abort
    s_waitcnt vmcnt(0)
    v_cmp_eq_u32 vcc, 0, v2
    s_nop 0
    s_cbranch_vccz Laq_pld
    s_sleep 4
    s_branch Laq_pl
Laq_pld:
    s_add_u32 m0, s59, 0
    s_add_u32 s47, s41, 0
    buffer_load_dwordx4 v111, s[8:11], s47 offen offset:0 lds
    buffer_load_dwordx4 v111, s[8:11], s47 offen offset:1024 lds
    buffer_load_dwordx4 v111, s[8:11], s47 offen offset:2048 lds
    buffer_load_dwordx4 v111, s[8:11], s47 offen offset:3072 lds
    s_add_u32 m0, s59, 4096
    s_add_u32 s47, s41, 4096
    buffer_load_dwordx4 v111, s[8:11], s47 offen offset:0 lds
    buffer_load_dwordx4 v111, s[8:11], s47 offen offset:1024 lds
    buffer_load_dwordx4 v111, s[8:11], s47 offen offset:2048 lds
    buffer_load_dwordx4 v111, s[8:11], s47 offen offset:3072 lds
    s_add_u32 m0, s59, 8192
    s_add_u32 s47, s41, 8192
    buffer_load_dwordx4 v111, s[8:11], s47 offen offset:0 lds
    s_mul_i32 s48, s36, 786432
    s_mul_i32 s18, s37, 6144
    s_add_u32 s48, s48, s18
    s_add_u32 s48, s48, 15728640
    buffer_load_dwordx4 v[80:83], v10, s[8:11], s48 offen offset:0
    buffer_load_dwordx4 v[84:87], v10, s[8:11], s48 offen offset:512
    buffer_load_dwordx4 v[88:91], v10, s[8:11], s48 offen offset:1024
    s_waitcnt vmcnt(0)
    s_branch Laq_go
L_role_aq_abort:
    s_waitcnt lgkmcnt(0)
    s_mov_b64 exec, -1
    v_mov_b32 v0, 60
    s_lshl_b32 s5, s3, 8
    s_or_b32 s5, s5, s4
    s_or_b32 s5, s5, 0x10000
    v_mov_b32 v1, s5
    global_store_dword v0, v1, s[12:13]
    s_endpgm
L_role_aq_exit:
    s_and_b32 s6, s15, 15
    s_add_u32 s6, s6, s14
    s_cmp_lg_u32 s6, 0
    s_cbranch_scc1 L_role_aq_nowb
    s_waitcnt vmcnt(0)
    buffer_wbl2 sc1
    s_waitcnt vmcnt(0)
L_role_aq_nowb:
    s_endpgm
.p2align 6
L_role_ta:
    v_and_b32 v5, 63, v0
    v_lshlrev_b32 v0, 4, v5
    v_and_b32 v7, 15, v5
    v_lshrrev_b32 v8, 4, v5
    v_min_u32 v1, 11, v5
    v_lshrrev_b32 v6, 2, v1
    v_and_b32 v1, 3, v1
    v_lshlrev_b32 v1, 2, v1
    v_lshl_add_u32 v1, v6, 7, v1
    v_mov_b32 v3, 1
    v_mov_b32 v4, 0
    s_mov_b32 s44, 0x05040100
    s_mov_b32 s45, 0x07060302
    s_lshl_b32 s17, s15, 2
    s_add_u32 s17, s17, s14
    s_lshr_b32 s36, s17, 5
    s_and_b32 s50, s17, 31
    s_mov_b32 s37, 0
    s_mov_b32 s52, 0x3e0293ee
    v_lshrrev_b32 v5, 2, v7
    v_and_b32 v6, 1, v7
    v_lshl_add_u32 v5, v5, 1, v6
    v_lshlrev_b32 v9, 8, v5
    v_lshl_add_u32 v9, v8, 4, v9
    v_lshrrev_b32 v10, 1, v0
    v_mov_b32 v6, 0xf149f2ca
    v_mov_b32 v21, 0
    v_mov_b32 v22, 0
    s_mul_i32 s42, s36, 1441792
    s_lshl_b32 s17, s50, 9
    s_add_u32 s42, s42, s17
    s_add_u32 s42, s42, 185600
    s_mul_i32 s51, s36, 50331648
    s_lshl_b32 s17, s50, 13
    s_add_u32 s51, s51, s17
    s_add_u32 s51, s51, 44040192
    s_lshl_b32 s47, s36, 11
    s_add_u32 s47, s47, s50
    s_lshl_b32 s48, s47, 13
    s_add_u32 s48, s48, 144703488
    s_mul_i32 s35, s36, 256
    s_add_u32 s35, s35, s50
    s_lshl_b32 s35, s35, 12
    s_add_u32 s35, s35, 27262976
    s_mul_i32 s43, s36, 1441792
    s_lshr_b32 s17, s50, 2
    s_lshl_b32 s17, s17, 7
    s_add_u32 s43, s43, s17
    s_lshl_b32 s17, s14, 2
    s_add_u32 s43, s43, s17
    s_add_u32 s43, s43, 184448
    s_mov_b32 s28, s8
    s_mov_b32 s29, s9
    s_mov_b32 s30, 0
    s_mov_b32 s31, 0x00020000
    s_mov_b32 s39, 0
    s_mov_b32 s49, 0
    s_mov_b32 s66, 0
    s_lshl_b32 s47, s36, 2
    s_add_u32 s47, s47, 192
    v_mov_b32 v16, 0x3f803f80
    v_lshl_add_u32 v5, v8, 2, 0
    v_cmp_le_u32 vcc, v5, v7
    s_nop 1
    v_cndmask_b32 v236, v6, v4, vcc
    v_mov_b32 v17, 0x3f803f80
    v_lshl_add_u32 v5, v8, 2, 1
    v_cmp_le_u32 vcc, v5, v7
    s_nop 1
    v_cndmask_b32 v237, v6, v4, vcc
    v_mov_b32 v18, 0x3f803f80
    v_lshl_add_u32 v5, v8, 2, 2
    v_cmp_le_u32 vcc, v5, v7
    s_nop 1
    v_cndmask_b32 v238, v6, v4, vcc
    v_mov_b32 v19, 0x3f803f80
    v_lshl_add_u32 v5, v8, 2, 3
    v_cmp_le_u32 vcc, v5, v7
    s_nop 1
    v_cndmask_b32 v239, v6, v4, vcc
    s_cmp_lg_u32 s14, 0
    s_cbranch_scc1 Lta_ini_d
    v_mov_b32 v5, 160
    s_mov_b32 s16, 0
Lta_ini:
    global_load_dword v6, v5, s[12:13] sc1
    s_add_u32 s16, s16, 1
    s_cmp_gt_u32 s16, 100000
    s_cbranch_scc1 L_role_ta_abort
    s_waitcnt vmcnt(0)
    v_cmp_gt_u32 vcc, 123, v6
    s_nop 0
    s_cbranch_vccz Lta_ini_d
    s_sleep 64
    s_branch Lta_ini
Lta_ini_d:
    s_barrier
    s_cmp_lg_u32 s14, 0
    s_cbranch_scc1 Lta_team_d
    v_mov_b32 v5, s47
    s_mov_b32 s16, 0
Lta_team:
    global_load_dword v6, v5, s[12:13] sc1
    s_add_u32 s16, s16, 1
    s_cmp_gt_u32 s16, 100000
    s_cbranch_scc1 L_role_ta_abort
    s_waitcnt vmcnt(0)
    v_cmp_gt_u32 vcc, 32, v6
    s_nop 0
    s_cbranch_vccz Lta_team_d
    s_sleep 64
    s_branch Lta_team
Lta_team_d:
    s_barrier
    v_mbcnt_lo_u32_b32 v5, -1, 0
    v_mbcnt_hi_u32_b32 v5, -1, v5
    v_and_b32 v6, 1, v5
    v_lshlrev_b32 v6, 7, v6
    v_lshlrev_b32 v5, 1, v5
    v_and_or_b32 v5, v5, 12, v6
    s_mov_b32 s16, 0
Lta_pure:
    global_load_dword v6, v5, s[12:13] sc1
    s_add_u32 s16, s16, 1
    s_cmp_gt_u32 s16, 100000
    s_cbranch_scc1 L_role_ta_abort
    s_mov_b32 s6, 0
    s_waitcnt vmcnt(0)
    v_readlane_b32 s7, v6, 0
    s_nop 0
    s_add_u32 s6, s6, s7
    v_readlane_b32 s7, v6, 1
    s_nop 0
    s_add_u32 s6, s6, s7
    v_readlane_b32 s7, v6, 2
    s_nop 0
    s_add_u32 s6, s6, s7
    v_readlane_b32 s7, v6, 3
    s_nop 0
    s_add_u32 s6, s6, s7
    v_readlane_b32 s7, v6, 4
    s_nop 0
    s_add_u32 s6, s6, s7
    v_readlane_b32 s7, v6, 5
    s_nop 0
    s_add_u32 s6, s6, s7
    v_readlane_b32 s7, v6, 6
    s_nop 0
    s_add_u32 s6, s6, s7
    v_readlane_b32 s7, v6, 7
    s_nop 0
    s_add_u32 s6, s6, s7
    v_readlane_b32 s7, v6, s3
    s_nop 0
    s_cmp_ge_u32 s7, 32
    s_cselect_b32 s61, 1, 0
    s_cselect_b32 s6, 256, s6
    s_cmp_lt_u32 s6, 256
    s_cbranch_scc1 Lta_pure
LtaF0:
    s_sub_u32 s17, s37, 33
    s_mul_i32 s18, s17, 43
    s_lshr_b32 s18, s18, 7
    s_mul_i32 s18, s18, 3
    s_cmp_eq_u32 s18, s17
    s_cselect_b32 s18, 1, 0
    s_cmp_lt_u32 s37, 34
    s_cselect_b32 s18, 1, s18
    s_cmp_eq_u32 s36, 0
    s_cselect_b32 s18, 1, s18
    s_and_b32 s18, s18, s61
    s_cbranch_scc0 LtaS0_in
LtaF0_in:
    s_and_b32 s17, s37, 7
    s_mul_i32 s17, s17, 131072
    s_add_u32 s47, s35, s17
    s_bfe_u32 s34, s37, 65539
    s_cmp_eq_u32 s39, 1
    s_cbranch_scc1 LtaF0_have
    s_waitcnt vmcnt(0)
    s_and_b32 s17, s49, s66
    s_cselect_b64 exec, 1, 0
    buffer_store_dword v3, v4, s[8:11], s43 offen
    s_andn2_b32 s17, s49, s66
    s_cselect_b64 exec, 1, 0
    buffer_store_dword v3, v4, s[8:11], s43 offen sc1
    s_mov_b64 exec, -1
    s_add_u32 s43, s43, s49
    s_mov_b32 s49, 0
    s_mov_b32 s16, 0
LtaF0_f_2:
    buffer_load_dword v2, v1, s[8:11], s42 offen sc1
    s_add_u32 s16, s16, 1
    s_cmp_gt_u32 s16, 100000
    s_cbranch_scc1 L_role_ta_abort
    s_waitcnt vmcnt(0)
    v_cmp_eq_u32 vcc, 0, v2
    s_nop 0
    s_cbranch_vccz LtaF0_fd_3
    s_sleep 4
    s_branch LtaF0_f_2
LtaF0_fd_3:
    s_add_u32 s46, s51, 0
    buffer_load_dwordx4 v[140:143], v0, s[8:11], s46 offen offset:0
    buffer_load_dwordx4 v[144:147], v0, s[8:11], s46 offen offset:1024
    buffer_load_dwordx4 v[148:151], v0, s[8:11], s46 offen offset:2048
    buffer_load_dwordx4 v[152:155], v0, s[8:11], s46 offen offset:3072
    s_add_u32 s46, s51, 4096
    buffer_load_dwordx4 v[156:159], v0, s[8:11], s46 offen offset:0
    buffer_load_dwordx4 v[160:163], v0, s[8:11], s46 offen offset:1024
    buffer_load_dwordx4 v[164:167], v0, s[8:11], s46 offen offset:2048
    buffer_load_dwordx4 v[168:171], v0, s[8:11], s46 offen offset:3072
    s_add_u32 s46, s51, 16777216
    buffer_load_dwordx4 v[172:175], v0, s[8:11], s46 offen offset:0
    buffer_load_dwordx4 v[176:179], v0, s[8:11], s46 offen offset:1024
    buffer_load_dwordx4 v[180:183], v0, s[8:11], s46 offen offset:2048
    buffer_load_dwordx4 v[184:187], v0, s[8:11], s46 offen offset:3072
    s_add_u32 s46, s51, 16781312
    buffer_load_dwordx4 v[188:191], v0, s[8:11], s46 offen offset:0
    buffer_load_dwordx4 v[192:195], v0, s[8:11], s46 offen offset:1024
    buffer_load_dwordx4 v[196:199], v0, s[8:11], s46 offen offset:2048
    buffer_load_dwordx4 v[200:203], v0, s[8:11], s46 offen offset:3072
    s_add_u32 s46, s51, 33554432
    buffer_load_dwordx4 v[204:207], v0, s[8:11], s46 offen offset:0
    buffer_load_dwordx4 v[208:211], v0, s[8:11], s46 offen offset:1024
    buffer_load_dwordx4 v[212:215], v0, s[8:11], s46 offen offset:2048
    buffer_load_dwordx4 v[216:219], v0, s[8:11], s46 offen offset:3072
    s_add_u32 s46, s51, 33558528
    buffer_load_dwordx4 v[220:223], v0, s[8:11], s46 offen offset:0
    buffer_load_dwordx4 v[224:227], v0, s[8:11], s46 offen offset:1024
    buffer_load_dwordx4 v[228:231], v0, s[8:11], s46 offen offset:2048
    buffer_load_dwordx4 v[232:235], v0, s[8:11], s46 offen offset:3072
LtaF0_have:
    s_add_u32 s17, s42, 22528
    buffer_load_dword v15, v1, s[8:11], s17 offen sc1
    buffer_load_dwordx4 v[52:55], v9, s[8:11], s47 offen offset:0 sc1
    buffer_load_dwordx4 v[56:59], v9, s[8:11], s47 offen offset:64 sc1
    buffer_load_dwordx4 v[60:63], v9, s[8:11], s47 offen offset:128 sc1
    buffer_load_dwordx4 v[64:67], v9, s[8:11], s47 offen offset:192 sc1
    buffer_load_dwordx2 v[68:69], v10, s[8:11], s47 offen offset:2048 sc1
    buffer_load_dwordx2 v[70:71], v10, s[8:11], s47 offen offset:2560 sc1
    buffer_load_dwordx2 v[72:73], v10, s[8:11], s47 offen offset:3072 sc1
    buffer_load_dwordx2 v[74:75], v10, s[8:11], s47 offen offset:3584 sc1
    s_waitcnt vmcnt(9)
    s_and_b32 s17, s49, s66
    s_cselect_b64 exec, 1, 0
    buffer_store_dword v3, v4, s[8:11], s43 offen
    s_andn2_b32 s17, s49, s66
    s_cselect_b64 exec, 1, 0
    buffer_store_dword v3, v4, s[8:11], s43 offen sc1
    s_mov_b64 exec, -1
    s_add_u32 s43, s43, s49
    s_mov_b32 s49, 0
    v_mfma_f32_16x16x32_bf16 v[32:35], v[172:175], v[140:143], 0
    v_mfma_f32_16x16x32_bf16 v[36:39], v[172:175], v[144:147], 0
    v_mfma_f32_16x16x32_bf16 v[40:43], v[176:179], v[144:147], 0
    v_mfma_f32_16x16x32_bf16 v[32:35], v[180:183], v[148:151], v[32:35]
    v_mfma_f32_16x16x32_bf16 v[36:39], v[180:183], v[152:155], v[36:39]
    v_mfma_f32_16x16x32_bf16 v[40:43], v[184:187], v[152:155], v[40:43]
    v_mfma_f32_16x16x32_bf16 v[32:35], v[188:191], v[156:159], v[32:35]
    v_mfma_f32_16x16x32_bf16 v[36:39], v[188:191], v[160:163], v[36:39]
    v_mfma_f32_16x16x32_bf16 v[40:43], v[192:195], v[160:163], v[40:43]
    v_mfma_f32_16x16x32_bf16 v[32:35], v[196:199], v[164:167], v[32:35]
    v_mfma_f32_16x16x32_bf16 v[36:39], v[196:199], v[168:171], v[36:39]
    v_mfma_f32_16x16x32_bf16 v[40:43], v[200:203], v[168:171], v[40:43]
    s_waitcnt vmcnt(2)
    v_cmp_eq_u32 vcc, 0, v15
    s_add_u32 s51, s51, 262144
    s_add_u32 s42, s42, 22528
    s_add_u32 s37, s37, 1
    s_cmp_eq_u64 vcc, 0
    s_cselect_b32 s39, 1, 0
    s_cmp_lt_u32 s37, 64
    s_cselect_b32 s39, s39, 0
    s_cmp_eq_u32 s39, 1
    s_cselect_b32 s30, 268435456, 0
    v_fma_f32 v32, v32, s52, v236
    v_fma_f32 v33, v33, s52, v237
    v_fma_f32 v34, v34, s52, v238
    v_fma_f32 v35, v35, s52, v239
    v_mul_f32 v36, s52, v36
    v_mul_f32 v37, s52, v37
    v_mul_f32 v38, s52, v38
    v_mul_f32 v39, s52, v39
    v_fma_f32 v40, v40, s52, v236
    v_fma_f32 v41, v41, s52, v237
    v_fma_f32 v42, v42, s52, v238
    v_fma_f32 v43, v43, s52, v239
    v_xor_b32 v5, s34, v52
    v_xor_b32 v6, s34, v56
    v_or_b32 v5, v5, v6
    v_xor_b32 v6, s34, v60
    v_or_b32 v5, v5, v6
    v_xor_b32 v6, s34, v64
    v_or_b32 v5, v5, v6
    v_xor_b32 v6, s34, v68
    v_or_b32 v5, v5, v6
    v_xor_b32 v6, s34, v70
    v_or_b32 v5, v5, v6
    v_xor_b32 v6, s34, v72
    v_or_b32 v5, v5, v6
    v_xor_b32 v6, s34, v74
    v_or_b32 v5, v5, v6
    v_and_b32 v5, 1, v5
    v_cmp_ne_u32 vcc, 0, v5
    s_nop 0
    s_cbranch_vccz LtaF0_r
    s_mov_b32 s16, 0
LtaF0_rp:
    buffer_load_dwordx4 v[52:55], v9, s[8:11], s47 offen offset:0 sc1
    buffer_load_dwordx4 v[56:59], v9, s[8:11], s47 offen offset:64 sc1
    buffer_load_dwordx4 v[60:63], v9, s[8:11], s47 offen offset:128 sc1
    buffer_load_dwordx4 v[64:67], v9, s[8:11], s47 offen offset:192 sc1
    buffer_load_dwordx2 v[68:69], v10, s[8:11], s47 offen offset:2048 sc1
    buffer_load_dwordx2 v[70:71], v10, s[8:11], s47 offen offset:2560 sc1
    buffer_load_dwordx2 v[72:73], v10, s[8:11], s47 offen offset:3072 sc1
    buffer_load_dwordx2 v[74:75], v10, s[8:11], s47 offen offset:3584 sc1
    s_add_u32 s16, s16, 1
    s_cmp_gt_u32 s16, 100000
    s_cbranch_scc1 L_role_ta_abort
    s_waitcnt vmcnt(0)
    v_xor_b32 v5, s34, v52
    v_xor_b32 v6, s34, v56
    v_or_b32 v5, v5, v6
    v_xor_b32 v6, s34, v60
    v_or_b32 v5, v5, v6
    v_xor_b32 v6, s34, v64
    v_or_b32 v5, v5, v6
    v_xor_b32 v6, s34, v68
    v_or_b32 v5, v5, v6
    v_xor_b32 v6, s34, v70
    v_or_b32 v5, v5, v6
    v_xor_b32 v6, s34, v72
    v_or_b32 v5, v5, v6
    v_xor_b32 v6, s34, v74
    v_or_b32 v5, v5, v6
    v_and_b32 v5, 1, v5
    v_cmp_ne_u32 vcc, 0, v5
    s_nop 0
    s_cbranch_vccz LtaF0_r
    s_sleep 2
    s_branch LtaF0_rp
LtaF0_r:
    s_and_b32 s17, s37, 3
    s_cmp_eq_u32 s17, 0
    s_cselect_b32 s17, s36, 0
    s_cmp_lg_u32 s17, 0
    s_cselect_b64 exec, 1, 0
    s_sub_u32 s17, s42, 22528
    buffer_store_dword v3, v4, s[8:11], s17 offen offset:384 sc1
    s_mov_b64 exec, -1
    s_add_u32 s46, s51, 0
    buffer_load_dwordx4 a[0:3], v0, s[28:31], s46 offen offset:0
    buffer_load_dwordx4 a[4:7], v0, s[28:31], s46 offen offset:1024
    v_mfma_f32_16x16x32_bf16 v[44:47], v[52:55], v[140:143], 0
    v_mfma_f32_16x16x32_bf16 v[48:51], v[52:55], v[144:147], 0
    v_mfma_f32_16x16x32_bf16 v[44:47], v[56:59], v[148:151], v[44:47]
    v_mfma_f32_16x16x32_bf16 v[48:51], v[56:59], v[152:155], v[48:51]
    v_mfma_f32_16x16x32_bf16 v[44:47], v[60:63], v[156:159], v[44:47]
    v_mfma_f32_16x16x32_bf16 v[48:51], v[60:63], v[160:163], v[48:51]
    v_mfma_f32_16x16x32_bf16 v[44:47], v[64:67], v[164:167], v[44:47]
    v_mfma_f32_16x16x32_bf16 v[48:51], v[64:67], v[168:171], v[48:51]
    v_max3_f32 v5, v32, v33, v34
    v_max_f32 v5, v5, v35
    s_nop 4
    v_mul_f32 v44, s52, v44
    v_mul_f32 v45, s52, v45
    v_max3_f32 v5, v5, v44, v45
    v_mov_b32 v6, v5
    buffer_load_dwordx4 a[8:11], v0, s[28:31], s46 offen offset:2048
    s_nop 0
    v_permlane32_swap_b32 v5, v6
    v_max_f32 v5, v5, v6
    v_mov_b32 v6, v5
    buffer_load_dwordx4 a[12:15], v0, s[28:31], s46 offen offset:3072
    s_nop 0
    v_permlane16_swap_b32 v5, v6
    v_max_f32 v5, v5, v6
    v_sub_f32 v32, v32, v5
    v_sub_f32 v33, v33, v5
    v_sub_f32 v34, v34, v5
    v_sub_f32 v35, v35, v5
    v_sub_f32 v44, v44, v5
    v_sub_f32 v45, v45, v5
    v_exp_f32 v32, v32
    v_exp_f32 v33, v33
    v_exp_f32 v34, v34
    v_exp_f32 v35, v35
    v_exp_f32 v44, v44
    v_exp_f32 v45, v45
    v_cvt_pk_bf16_f32 v24, v32, v33
    v_cvt_pk_bf16_f32 v25, v34, v35
    v_mov_b32 v26, 0
    v_mov_b32 v27, 0
    v_cvt_pk_bf16_f32 v20, v44, v45
    v_cvt_pk_bf16_f32 v23, v44, v45
    v_mfma_f32_16x16x32_bf16 v[28:31], v[16:19], v[24:27], 0
    v_mfma_f32_16x16x32_bf16 v[76:79], v[204:207], v[24:27], 0
    v_mfma_f32_16x16x32_bf16 v[80:83], v[208:211], v[24:27], 0
    s_add_u32 s46, s51, 4096
    buffer_load_dwordx4 a[16:19], v0, s[28:31], s46 offen offset:0
    v_mfma_f32_16x16x32_bf16 v[84:87], v[212:215], v[24:27], 0
    v_mfma_f32_16x16x32_bf16 v[88:91], v[216:219], v[24:27], 0
    buffer_load_dwordx4 a[20:23], v0, s[28:31], s46 offen offset:1024
    v_mfma_f32_16x16x32_bf16 v[92:95], v[220:223], v[24:27], 0
    v_mfma_f32_16x16x32_bf16 v[96:99], v[224:227], v[24:27], 0
    buffer_load_dwordx4 a[24:27], v0, s[28:31], s46 offen offset:2048
    v_mfma_f32_16x16x16_bf16 v[28:31], v[16:17], v[20:21], v[28:31]
    v_mfma_f32_16x16x32_bf16 v[100:103], v[228:231], v[24:27], 0
    v_mfma_f32_16x16x32_bf16 v[104:107], v[232:235], v[24:27], 0
    buffer_load_dwordx4 a[28:31], v0, s[28:31], s46 offen offset:3072
    v_mfma_f32_16x16x16_bf16 v[76:79], v[68:69], v[20:21], v[76:79]
    v_mfma_f32_16x16x16_bf16 v[80:83], v[68:69], v[22:23], v[80:83]
    s_nop 2
    v_rcp_f32 v6, v28
    v_mfma_f32_16x16x16_bf16 v[84:87], v[70:71], v[20:21], v[84:87]
    v_mfma_f32_16x16x16_bf16 v[88:91], v[70:71], v[22:23], v[88:91]
    s_nop 0
    v_mul_f32 v76, v6, v76
    v_mul_f32 v80, v6, v80
    v_cvt_pk_bf16_f32 v108, v76, v80
    v_mul_f32 v77, v6, v77
    v_mul_f32 v81, v6, v81
    v_cvt_pk_bf16_f32 v109, v77, v81
    v_mul_f32 v78, v6, v78
    v_mul_f32 v82, v6, v82
    v_cvt_pk_bf16_f32 v110, v78, v82
    v_mul_f32 v79, v6, v79
    v_mul_f32 v83, v6, v83
    v_cvt_pk_bf16_f32 v111, v79, v83
    s_add_u32 s17, s48, 0
    buffer_store_dwordx4 v[108:111], v0, s[8:11], s17 offen offset:0
    s_add_u32 s46, s51, 16777216
    buffer_load_dwordx4 a[32:35], v0, s[28:31], s46 offen offset:0
    v_mfma_f32_16x16x16_bf16 v[92:95], v[72:73], v[20:21], v[92:95]
    v_mfma_f32_16x16x16_bf16 v[96:99], v[72:73], v[22:23], v[96:99]
    v_mul_f32 v84, v6, v84
    v_mul_f32 v88, v6, v88
    v_cvt_pk_bf16_f32 v112, v84, v88
    v_mul_f32 v85, v6, v85
    v_mul_f32 v89, v6, v89
    v_cvt_pk_bf16_f32 v113, v85, v89
    v_mul_f32 v86, v6, v86
    v_mul_f32 v90, v6, v90
    v_cvt_pk_bf16_f32 v114, v86, v90
    v_mul_f32 v87, v6, v87
    v_mul_f32 v91, v6, v91
    v_cvt_pk_bf16_f32 v115, v87, v91
    buffer_store_dwordx4 v[112:115], v0, s[8:11], s17 offen offset:2048
    buffer_load_dwordx4 a[36:39], v0, s[28:31], s46 offen offset:1024
    v_mfma_f32_16x16x16_bf16 v[100:103], v[74:75], v[20:21], v[100:103]
    v_mfma_f32_16x16x16_bf16 v[104:107], v[74:75], v[22:23], v[104:107]
    v_mul_f32 v92, v6, v92
    v_mul_f32 v96, v6, v96
    v_cvt_pk_bf16_f32 v116, v92, v96
    v_mul_f32 v93, v6, v93
    v_mul_f32 v97, v6, v97
    v_cvt_pk_bf16_f32 v117, v93, v97
    v_mul_f32 v94, v6, v94
    v_mul_f32 v98, v6, v98
    v_cvt_pk_bf16_f32 v118, v94, v98
    v_mul_f32 v95, v6, v95
    v_mul_f32 v99, v6, v99
    v_cvt_pk_bf16_f32 v119, v95, v99
    s_add_u32 s17, s48, 4096
    buffer_store_dwordx4 v[116:119], v0, s[8:11], s17 offen offset:0
    buffer_load_dwordx4 a[40:43], v0, s[28:31], s46 offen offset:2048
    v_mul_f32 v100, v6, v100
    v_mul_f32 v104, v6, v104
    v_cvt_pk_bf16_f32 v120, v100, v104
    v_mul_f32 v101, v6, v101
    v_mul_f32 v105, v6, v105
    v_cvt_pk_bf16_f32 v121, v101, v105
    v_mul_f32 v102, v6, v102
    v_mul_f32 v106, v6, v106
    v_cvt_pk_bf16_f32 v122, v102, v106
    v_mul_f32 v103, v6, v103
    v_mul_f32 v107, v6, v107
    v_cvt_pk_bf16_f32 v123, v103, v107
    buffer_store_dwordx4 v[120:123], v0, s[8:11], s17 offen offset:2048
    buffer_load_dwordx4 a[44:47], v0, s[28:31], s46 offen offset:3072
    v_max3_f32 v5, v36, v37, v38
    v_max_f32 v5, v5, v39
    v_max3_f32 v5, v5, v40, v41
    v_max3_f32 v5, v5, v42, v43
    v_mul_f32 v48, s52, v48
    v_mul_f32 v49, s52, v49
    v_max3_f32 v5, v5, v48, v49
    v_mov_b32 v6, v5
    s_add_u32 s46, s51, 16781312
    buffer_load_dwordx4 a[48:51], v0, s[28:31], s46 offen offset:0
    v_permlane32_swap_b32 v5, v6
    v_max_f32 v5, v5, v6
    v_mov_b32 v6, v5
    buffer_load_dwordx4 a[52:55], v0, s[28:31], s46 offen offset:1024
    s_nop 0
    v_permlane16_swap_b32 v5, v6
    v_max_f32 v5, v5, v6
    v_sub_f32 v36, v36, v5
    v_sub_f32 v37, v37, v5
    v_sub_f32 v38, v38, v5
    v_sub_f32 v39, v39, v5
    v_sub_f32 v40, v40, v5
    v_sub_f32 v41, v41, v5
    v_sub_f32 v42, v42, v5
    v_sub_f32 v43, v43, v5
    v_sub_f32 v48, v48, v5
    v_sub_f32 v49, v49, v5
    v_exp_f32 v36, v36
    v_exp_f32 v37, v37
    v_exp_f32 v38, v38
    v_exp_f32 v39, v39
    v_exp_f32 v40, v40
    v_exp_f32 v41, v41
    v_exp_f32 v42, v42
    v_exp_f32 v43, v43
    v_exp_f32 v48, v48
    v_exp_f32 v49, v49
    v_cvt_pk_bf16_f32 v24, v36, v37
    v_cvt_pk_bf16_f32 v25, v38, v39
    v_cvt_pk_bf16_f32 v26, v40, v41
    v_cvt_pk_bf16_f32 v27, v42, v43
    v_cvt_pk_bf16_f32 v20, v48, v49
    v_cvt_pk_bf16_f32 v23, v48, v49
    v_mfma_f32_16x16x32_bf16 v[28:31], v[16:19], v[24:27], 0
    v_mfma_f32_16x16x32_bf16 v[76:79], v[204:207], v[24:27], 0
    v_mfma_f32_16x16x32_bf16 v[80:83], v[208:211], v[24:27], 0
    buffer_load_dwordx4 a[56:59], v0, s[28:31], s46 offen offset:2048
    v_mfma_f32_16x16x32_bf16 v[84:87], v[212:215], v[24:27], 0
    v_mfma_f32_16x16x32_bf16 v[88:91], v[216:219], v[24:27], 0
    buffer_load_dwordx4 a[60:63], v0, s[28:31], s46 offen offset:3072
    v_mfma_f32_16x16x32_bf16 v[92:95], v[220:223], v[24:27], 0
    v_mfma_f32_16x16x32_bf16 v[96:99], v[224:227], v[24:27], 0
    s_add_u32 s46, s51, 33554432
    buffer_load_dwordx4 a[64:67], v0, s[28:31], s46 offen offset:0
    v_mfma_f32_16x16x16_bf16 v[28:31], v[16:17], v[20:21], v[28:31]
    v_mfma_f32_16x16x32_bf16 v[100:103], v[228:231], v[24:27], 0
    v_mfma_f32_16x16x32_bf16 v[104:107], v[232:235], v[24:27], 0
    buffer_load_dwordx4 a[68:71], v0, s[28:31], s46 offen offset:1024
    v_mfma_f32_16x16x16_bf16 v[76:79], v[68:69], v[20:21], v[76:79]
    v_mfma_f32_16x16x16_bf16 v[80:83], v[68:69], v[22:23], v[80:83]
    s_nop 2
    v_rcp_f32 v6, v28
    v_mfma_f32_16x16x16_bf16 v[84:87], v[70:71], v[20:21], v[84:87]
    v_mfma_f32_16x16x16_bf16 v[88:91], v[70:71], v[22:23], v[88:91]
    s_nop 0
    v_mul_f32 v76, v6, v76
    v_mul_f32 v80, v6, v80
    v_cvt_pk_bf16_f32 v124, v76, v80
    v_mul_f32 v77, v6, v77
    v_mul_f32 v81, v6, v81
    v_cvt_pk_bf16_f32 v125, v77, v81
    v_mul_f32 v78, v6, v78
    v_mul_f32 v82, v6, v82
    v_cvt_pk_bf16_f32 v126, v78, v82
    v_mul_f32 v79, v6, v79
    v_mul_f32 v83, v6, v83
    v_cvt_pk_bf16_f32 v127, v79, v83
    s_add_u32 s17, s48, 0
    buffer_store_dwordx4 v[124:127], v0, s[8:11], s17 offen offset:1024
    buffer_load_dwordx4 a[72:75], v0, s[28:31], s46 offen offset:2048
    v_mfma_f32_16x16x16_bf16 v[92:95], v[72:73], v[20:21], v[92:95]
    v_mfma_f32_16x16x16_bf16 v[96:99], v[72:73], v[22:23], v[96:99]
    v_mul_f32 v84, v6, v84
    v_mul_f32 v88, v6, v88
    v_cvt_pk_bf16_f32 v128, v84, v88
    v_mul_f32 v85, v6, v85
    v_mul_f32 v89, v6, v89
    v_cvt_pk_bf16_f32 v129, v85, v89
    v_mul_f32 v86, v6, v86
    v_mul_f32 v90, v6, v90
    v_cvt_pk_bf16_f32 v130, v86, v90
    v_mul_f32 v87, v6, v87
    v_mul_f32 v91, v6, v91
    v_cvt_pk_bf16_f32 v131, v87, v91
    buffer_store_dwordx4 v[128:131], v0, s[8:11], s17 offen offset:3072
    buffer_load_dwordx4 a[76:79], v0, s[28:31], s46 offen offset:3072
    v_mfma_f32_16x16x16_bf16 v[100:103], v[74:75], v[20:21], v[100:103]
    v_mfma_f32_16x16x16_bf16 v[104:107], v[74:75], v[22:23], v[104:107]
    v_mul_f32 v92, v6, v92
    v_mul_f32 v96, v6, v96
    v_cvt_pk_bf16_f32 v132, v92, v96
    v_mul_f32 v93, v6, v93
    v_mul_f32 v97, v6, v97
    v_cvt_pk_bf16_f32 v133, v93, v97
    v_mul_f32 v94, v6, v94
    v_mul_f32 v98, v6, v98
    v_cvt_pk_bf16_f32 v134, v94, v98
    v_mul_f32 v95, v6, v95
    v_mul_f32 v99, v6, v99
    v_cvt_pk_bf16_f32 v135, v95, v99
    s_add_u32 s17, s48, 4096
    buffer_store_dwordx4 v[132:135], v0, s[8:11], s17 offen offset:1024
    s_add_u32 s46, s51, 33558528
    buffer_load_dwordx4 a[80:83], v0, s[28:31], s46 offen offset:0
    v_mul_f32 v100, v6, v100
    v_mul_f32 v104, v6, v104
    v_cvt_pk_bf16_f32 v136, v100, v104
    v_mul_f32 v101, v6, v101
    v_mul_f32 v105, v6, v105
    v_cvt_pk_bf16_f32 v137, v101, v105
    v_mul_f32 v102, v6, v102
    v_mul_f32 v106, v6, v106
    v_cvt_pk_bf16_f32 v138, v102, v106
    v_mul_f32 v103, v6, v103
    v_mul_f32 v107, v6, v107
    v_cvt_pk_bf16_f32 v139, v103, v107
    buffer_store_dwordx4 v[136:139], v0, s[8:11], s17 offen offset:3072
    buffer_load_dwordx4 a[84:87], v0, s[28:31], s46 offen offset:1024
    buffer_load_dwordx4 a[88:91], v0, s[28:31], s46 offen offset:2048
    buffer_load_dwordx4 a[92:95], v0, s[28:31], s46 offen offset:3072
    s_add_u32 s48, s48, 262144
    s_mov_b32 s49, 22528
    s_mov_b32 s66, -1
    s_cmp_ge_u32 s37, 64
    s_cbranch_scc1 LtaF_end
LtaF1:
    s_sub_u32 s17, s37, 33
    s_mul_i32 s18, s17, 43
    s_lshr_b32 s18, s18, 7
    s_mul_i32 s18, s18, 3
    s_cmp_eq_u32 s18, s17
    s_cselect_b32 s18, 1, 0
    s_cmp_lt_u32 s37, 34
    s_cselect_b32 s18, 1, s18
    s_cmp_eq_u32 s36, 0
    s_cselect_b32 s18, 1, s18
    s_and_b32 s18, s18, s61
    s_cbranch_scc0 LtaS1_in
LtaF1_in:
    s_and_b32 s17, s37, 7
    s_mul_i32 s17, s17, 131072
    s_add_u32 s47, s35, s17
    s_bfe_u32 s34, s37, 65539
    s_cmp_eq_u32 s39, 1
    s_cbranch_scc1 LtaF1_have
    s_waitcnt vmcnt(0)
    s_and_b32 s17, s49, s66
    s_cselect_b64 exec, 1, 0
    buffer_store_dword v3, v4, s[8:11], s43 offen
    s_andn2_b32 s17, s49, s66
    s_cselect_b64 exec, 1, 0
    buffer_store_dword v3, v4, s[8:11], s43 offen sc1
    s_mov_b64 exec, -1
    s_add_u32 s43, s43, s49
    s_mov_b32 s49, 0
    s_mov_b32 s16, 0
LtaF1_f_4:
    buffer_load_dword v2, v1, s[8:11], s42 offen sc1
    s_add_u32 s16, s16, 1
    s_cmp_gt_u32 s16, 100000
    s_cbranch_scc1 L_role_ta_abort
    s_waitcnt vmcnt(0)
    v_cmp_eq_u32 vcc, 0, v2
    s_nop 0
    s_cbranch_vccz LtaF1_fd_5
    s_sleep 4
    s_branch LtaF1_f_4
LtaF1_fd_5:
    s_add_u32 s46, s51, 0
    buffer_load_dwordx4 a[0:3], v0, s[8:11], s46 offen offset:0
    buffer_load_dwordx4 a[4:7], v0, s[8:11], s46 offen offset:1024
    buffer_load_dwordx4 a[8:11], v0, s[8:11], s46 offen offset:2048
    buffer_load_dwordx4 a[12:15], v0, s[8:11], s46 offen offset:3072
    s_add_u32 s46, s51, 4096
    buffer_load_dwordx4 a[16:19], v0, s[8:11], s46 offen offset:0
    buffer_load_dwordx4 a[20:23], v0, s[8:11], s46 offen offset:1024
    buffer_load_dwordx4 a[24:27], v0, s[8:11], s46 offen offset:2048
    buffer_load_dwordx4 a[28:31], v0, s[8:11], s46 offen offset:3072
    s_add_u32 s46, s51, 16777216
    buffer_load_dwordx4 a[32:35], v0, s[8:11], s46 offen offset:0
    buffer_load_dwordx4 a[36:39], v0, s[8:11], s46 offen offset:1024
    buffer_load_dwordx4 a[40:43], v0, s[8:11], s46 offen offset:2048
    buffer_load_dwordx4 a[44:47], v0, s[8:11], s46 offen offset:3072
    s_add_u32 s46, s51, 16781312
    buffer_load_dwordx4 a[48:51], v0, s[8:11], s46 offen offset:0
    buffer_load_dwordx4 a[52:55], v0, s[8:11], s46 offen offset:1024
    buffer_load_dwordx4 a[56:59], v0, s[8:11], s46 offen offset:2048
    buffer_load_dwordx4 a[60:63], v0, s[8:11], s46 offen offset:3072
    s_add_u32 s46, s51, 33554432
    buffer_load_dwordx4 a[64:67], v0, s[8:11], s46 offen offset:0
    buffer_load_dwordx4 a[68:71], v0, s[8:11], s46 offen offset:1024
    buffer_load_dwordx4 a[72:75], v0, s[8:11], s46 offen offset:2048
    buffer_load_dwordx4 a[76:79], v0, s[8:11], s46 offen offset:3072
    s_add_u32 s46, s51, 33558528
    buffer_load_dwordx4 a[80:83], v0, s[8:11], s46 offen offset:0
    buffer_load_dwordx4 a[84:87], v0, s[8:11], s46 offen offset:1024
    buffer_load_dwordx4 a[88:91], v0, s[8:11], s46 offen offset:2048
    buffer_load_dwordx4 a[92:95], v0, s[8:11], s46 offen offset:3072
LtaF1_have:
    s_add_u32 s17, s42, 22528
    buffer_load_dword v15, v1, s[8:11], s17 offen sc1
    buffer_load_dwordx4 v[52:55], v9, s[8:11], s47 offen offset:0 sc1
    buffer_load_dwordx4 v[56:59], v9, s[8:11], s47 offen offset:64 sc1
    buffer_load_dwordx4 v[60:63], v9, s[8:11], s47 offen offset:128 sc1
    buffer_load_dwordx4 v[64:67], v9, s[8:11], s47 offen offset:192 sc1
    buffer_load_dwordx2 v[68:69], v10, s[8:11], s47 offen offset:2048 sc1
    buffer_load_dwordx2 v[70:71], v10, s[8:11], s47 offen offset:2560 sc1
    buffer_load_dwordx2 v[72:73], v10, s[8:11], s47 offen offset:3072 sc1
    buffer_load_dwordx2 v[74:75], v10, s[8:11], s47 offen offset:3584 sc1
    s_waitcnt vmcnt(9)
    s_and_b32 s17, s49, s66
    s_cselect_b64 exec, 1, 0
    buffer_store_dword v3, v4, s[8:11], s43 offen
    s_andn2_b32 s17, s49, s66
    s_cselect_b64 exec, 1, 0
    buffer_store_dword v3, v4, s[8:11], s43 offen sc1
    s_mov_b64 exec, -1
    s_add_u32 s43, s43, s49
    s_mov_b32 s49, 0
    v_mfma_f32_16x16x32_bf16 v[32:35], a[32:35], a[0:3], 0
    v_mfma_f32_16x16x32_bf16 v[36:39], a[32:35], a[4:7], 0
    v_mfma_f32_16x16x32_bf16 v[40:43], a[36:39], a[4:7], 0
    v_mfma_f32_16x16x32_bf16 v[32:35], a[40:43], a[8:11], v[32:35]
    v_mfma_f32_16x16x32_bf16 v[36:39], a[40:43], a[12:15], v[36:39]
    v_mfma_f32_16x16x32_bf16 v[40:43], a[44:47], a[12:15], v[40:43]
    v_mfma_f32_16x16x32_bf16 v[32:35], a[48:51], a[16:19], v[32:35]
    v_mfma_f32_16x16x32_bf16 v[36:39], a[48:51], a[20:23], v[36:39]
    v_mfma_f32_16x16x32_bf16 v[40:43], a[52:55], a[20:23], v[40:43]
    v_mfma_f32_16x16x32_bf16 v[32:35], a[56:59], a[24:27], v[32:35]
    v_mfma_f32_16x16x32_bf16 v[36:39], a[56:59], a[28:31], v[36:39]
    v_mfma_f32_16x16x32_bf16 v[40:43], a[60:63], a[28:31], v[40:43]
    s_waitcnt vmcnt(2)
    v_cmp_eq_u32 vcc, 0, v15
    s_add_u32 s51, s51, 262144
    s_add_u32 s42, s42, 22528
    s_add_u32 s37, s37, 1
    s_cmp_eq_u64 vcc, 0
    s_cselect_b32 s39, 1, 0
    s_cmp_lt_u32 s37, 64
    s_cselect_b32 s39, s39, 0
    s_cmp_eq_u32 s39, 1
    s_cselect_b32 s30, 268435456, 0
    v_fma_f32 v32, v32, s52, v236
    v_fma_f32 v33, v33, s52, v237
    v_fma_f32 v34, v34, s52, v238
    v_fma_f32 v35, v35, s52, v239
    v_mul_f32 v36, s52, v36
    v_mul_f32 v37, s52, v37
    v_mul_f32 v38, s52, v38
    v_mul_f32 v39, s52, v39
    v_fma_f32 v40, v40, s52, v236
    v_fma_f32 v41, v41, s52, v237
    v_fma_f32 v42, v42, s52, v238
    v_fma_f32 v43, v43, s52, v239
    v_xor_b32 v5, s34, v52
    v_xor_b32 v6, s34, v56
    v_or_b32 v5, v5, v6
    v_xor_b32 v6, s34, v60
    v_or_b32 v5, v5, v6
    v_xor_b32 v6, s34, v64
    v_or_b32 v5, v5, v6
    v_xor_b32 v6, s34, v68
    v_or_b32 v5, v5, v6
    v_xor_b32 v6, s34, v70
    v_or_b32 v5, v5, v6
    v_xor_b32 v6, s34, v72
    v_or_b32 v5, v5, v6
    v_xor_b32 v6, s34, v74
    v_or_b32 v5, v5, v6
    v_and_b32 v5, 1, v5
    v_cmp_ne_u32 vcc, 0, v5
    s_nop 0
    s_cbranch_vccz LtaF1_r
    s_mov_b32 s16, 0
LtaF1_rp:
    buffer_load_dwordx4 v[52:55], v9, s[8:11], s47 offen offset:0 sc1
    buffer_load_dwordx4 v[56:59], v9, s[8:11], s47 offen offset:64 sc1
    buffer_load_dwordx4 v[60:63], v9, s[8:11], s47 offen offset:128 sc1
    buffer_load_dwordx4 v[64:67], v9, s[8:11], s47 offen offset:192 sc1
    buffer_load_dwordx2 v[68:69], v10, s[8:11], s47 offen offset:2048 sc1
    buffer_load_dwordx2 v[70:71], v10, s[8:11], s47 offen offset:2560 sc1
    buffer_load_dwordx2 v[72:73], v10, s[8:11], s47 offen offset:3072 sc1
    buffer_load_dwordx2 v[74:75], v10, s[8:11], s47 offen offset:3584 sc1
    s_add_u32 s16, s16, 1
    s_cmp_gt_u32 s16, 100000
    s_cbranch_scc1 L_role_ta_abort
    s_waitcnt vmcnt(0)
    v_xor_b32 v5, s34, v52
    v_xor_b32 v6, s34, v56
    v_or_b32 v5, v5, v6
    v_xor_b32 v6, s34, v60
    v_or_b32 v5, v5, v6
    v_xor_b32 v6, s34, v64
    v_or_b32 v5, v5, v6
    v_xor_b32 v6, s34, v68
    v_or_b32 v5, v5, v6
    v_xor_b32 v6, s34, v70
    v_or_b32 v5, v5, v6
    v_xor_b32 v6, s34, v72
    v_or_b32 v5, v5, v6
    v_xor_b32 v6, s34, v74
    v_or_b32 v5, v5, v6
    v_and_b32 v5, 1, v5
    v_cmp_ne_u32 vcc, 0, v5
    s_nop 0
    s_cbranch_vccz LtaF1_r
    s_sleep 2
    s_branch LtaF1_rp
LtaF1_r:
    s_and_b32 s17, s37, 3
    s_cmp_eq_u32 s17, 0
    s_cselect_b32 s17, s36, 0
    s_cmp_lg_u32 s17, 0
    s_cselect_b64 exec, 1, 0
    s_sub_u32 s17, s42, 22528
    buffer_store_dword v3, v4, s[8:11], s17 offen offset:384 sc1
    s_mov_b64 exec, -1
    s_add_u32 s46, s51, 0
    buffer_load_dwordx4 v[140:143], v0, s[28:31], s46 offen offset:0
    buffer_load_dwordx4 v[144:147], v0, s[28:31], s46 offen offset:1024
    v_mfma_f32_16x16x32_bf16 v[44:47], v[52:55], a[0:3], 0
    v_mfma_f32_16x16x32_bf16 v[48:51], v[52:55], a[4:7], 0
    v_mfma_f32_16x16x32_bf16 v[44:47], v[56:59], a[8:11], v[44:47]
    v_mfma_f32_16x16x32_bf16 v[48:51], v[56:59], a[12:15], v[48:51]
    v_mfma_f32_16x16x32_bf16 v[44:47], v[60:63], a[16:19], v[44:47]
    v_mfma_f32_16x16x32_bf16 v[48:51], v[60:63], a[20:23], v[48:51]
    v_mfma_f32_16x16x32_bf16 v[44:47], v[64:67], a[24:27], v[44:47]
    v_mfma_f32_16x16x32_bf16 v[48:51], v[64:67], a[28:31], v[48:51]
    v_max3_f32 v5, v32, v33, v34
    v_max_f32 v5, v5, v35
    s_nop 4
    v_mul_f32 v44, s52, v44
    v_mul_f32 v45, s52, v45
    v_max3_f32 v5, v5, v44, v45
    v_mov_b32 v6, v5
    buffer_load_dwordx4 v[148:151], v0, s[28:31], s46 offen offset:2048
    s_nop 0
    v_permlane32_swap_b32 v5, v6
    v_max_f32 v5, v5, v6
    v_mov_b32 v6, v5
    buffer_load_dwordx4 v[152:155], v0, s[28:31], s46 offen offset:3072
    s_nop 0
    v_permlane16_swap_b32 v5, v6
    v_max_f32 v5, v5, v6
    v_sub_f32 v32, v32, v5
    v_sub_f32 v33, v33, v5
    v_sub_f32 v34, v34, v5
    v_sub_f32 v35, v35, v5
    v_sub_f32 v44, v44, v5
    v_sub_f32 v45, v45, v5
    v_exp_f32 v32, v32
    v_exp_f32 v33, v33
    v_exp_f32 v34, v34
    v_exp_f32 v35, v35
    v_exp_f32 v44, v44
    v_exp_f32 v45, v45
    v_cvt_pk_bf16_f32 v24, v32, v33
    v_cvt_pk_bf16_f32 v25, v34, v35
    v_mov_b32 v26, 0
    v_mov_b32 v27, 0
    v_cvt_pk_bf16_f32 v20, v44, v45
    v_cvt_pk_bf16_f32 v23, v44, v45
    v_mfma_f32_16x16x32_bf16 v[28:31], v[16:19], v[24:27], 0
    v_mfma_f32_16x16x32_bf16 v[76:79], a[64:67], v[24:27], 0
    v_mfma_f32_16x16x32_bf16 v[80:83], a[68:71], v[24:27], 0
    s_add_u32 s46, s51, 4096
    buffer_load_dwordx4 v[156:159], v0, s[28:31], s46 offen offset:0
    v_mfma_f32_16x16x32_bf16 v[84:87], a[72:75], v[24:27], 0
    v_mfma_f32_16x16x32_bf16 v[88:91], a[76:79], v[24:27], 0
    buffer_load_dwordx4 v[160:163], v0, s[28:31], s46 offen offset:1024
    v_mfma_f32_16x16x32_bf16 v[92:95], a[80:83], v[24:27], 0
    v_mfma_f32_16x16x32_bf16 v[96:99], a[84:87], v[24:27], 0
    buffer_load_dwordx4 v[164:167], v0, s[28:31], s46 offen offset:2048
    v_mfma_f32_16x16x16_bf16 v[28:31], v[16:17], v[20:21], v[28:31]
    v_mfma_f32_16x16x32_bf16 v[100:103], a[88:91], v[24:27], 0
    v_mfma_f32_16x16x32_bf16 v[104:107], a[92:95], v[24:27], 0
    buffer_load_dwordx4 v[168:171], v0, s[28:31], s46 offen offset:3072
    v_mfma_f32_16x16x16_bf16 v[76:79], v[68:69], v[20:21], v[76:79]
    v_mfma_f32_16x16x16_bf16 v[80:83], v[68:69], v[22:23], v[80:83]
    s_nop 2
    v_rcp_f32 v6, v28
    v_mfma_f32_16x16x16_bf16 v[84:87], v[70:71], v[20:21], v[84:87]
    v_mfma_f32_16x16x16_bf16 v[88:91], v[70:71], v[22:23], v[88:91]
    s_nop 0
    v_mul_f32 v76, v6, v76
    v_mul_f32 v80, v6, v80
    v_cvt_pk_bf16_f32 v108, v76, v80
    v_mul_f32 v77, v6, v77
    v_mul_f32 v81, v6, v81
    v_cvt_pk_bf16_f32 v109, v77, v81
    v_mul_f32 v78, v6, v78
    v_mul_f32 v82, v6, v82
    v_cvt_pk_bf16_f32 v110, v78, v82
    v_mul_f32 v79, v6, v79
    v_mul_f32 v83, v6, v83
    v_cvt_pk_bf16_f32 v111, v79, v83
    s_add_u32 s17, s48, 0
    buffer_store_dwordx4 v[108:111], v0, s[8:11], s17 offen offset:0
    s_add_u32 s46, s51, 16777216
    buffer_load_dwordx4 v[172:175], v0, s[28:31], s46 offen offset:0
    v_mfma_f32_16x16x16_bf16 v[92:95], v[72:73], v[20:21], v[92:95]
    v_mfma_f32_16x16x16_bf16 v[96:99], v[72:73], v[22:23], v[96:99]
    v_mul_f32 v84, v6, v84
    v_mul_f32 v88, v6, v88
    v_cvt_pk_bf16_f32 v112, v84, v88
    v_mul_f32 v85, v6, v85
    v_mul_f32 v89, v6, v89
    v_cvt_pk_bf16_f32 v113, v85, v89
    v_mul_f32 v86, v6, v86
    v_mul_f32 v90, v6, v90
    v_cvt_pk_bf16_f32 v114, v86, v90
    v_mul_f32 v87, v6, v87
    v_mul_f32 v91, v6, v91
    v_cvt_pk_bf16_f32 v115, v87, v91
    buffer_store_dwordx4 v[112:115], v0, s[8:11], s17 offen offset:2048
    buffer_load_dwordx4 v[176:179], v0, s[28:31], s46 offen offset:1024
    v_mfma_f32_16x16x16_bf16 v[100:103], v[74:75], v[20:21], v[100:103]
    v_mfma_f32_16x16x16_bf16 v[104:107], v[74:75], v[22:23], v[104:107]
    v_mul_f32 v92, v6, v92
    v_mul_f32 v96, v6, v96
    v_cvt_pk_bf16_f32 v116, v92, v96
    v_mul_f32 v93, v6, v93
    v_mul_f32 v97, v6, v97
    v_cvt_pk_bf16_f32 v117, v93, v97
    v_mul_f32 v94, v6, v94
    v_mul_f32 v98, v6, v98
    v_cvt_pk_bf16_f32 v118, v94, v98
    v_mul_f32 v95, v6, v95
    v_mul_f32 v99, v6, v99
    v_cvt_pk_bf16_f32 v119, v95, v99
    s_add_u32 s17, s48, 4096
    buffer_store_dwordx4 v[116:119], v0, s[8:11], s17 offen offset:0
    buffer_load_dwordx4 v[180:183], v0, s[28:31], s46 offen offset:2048
    v_mul_f32 v100, v6, v100
    v_mul_f32 v104, v6, v104
    v_cvt_pk_bf16_f32 v120, v100, v104
    v_mul_f32 v101, v6, v101
    v_mul_f32 v105, v6, v105
    v_cvt_pk_bf16_f32 v121, v101, v105
    v_mul_f32 v102, v6, v102
    v_mul_f32 v106, v6, v106
    v_cvt_pk_bf16_f32 v122, v102, v106
    v_mul_f32 v103, v6, v103
    v_mul_f32 v107, v6, v107
    v_cvt_pk_bf16_f32 v123, v103, v107
    buffer_store_dwordx4 v[120:123], v0, s[8:11], s17 offen offset:2048
    buffer_load_dwordx4 v[184:187], v0, s[28:31], s46 offen offset:3072
    v_max3_f32 v5, v36, v37, v38
    v_max_f32 v5, v5, v39
    v_max3_f32 v5, v5, v40, v41
    v_max3_f32 v5, v5, v42, v43
    v_mul_f32 v48, s52, v48
    v_mul_f32 v49, s52, v49
    v_max3_f32 v5, v5, v48, v49
    v_mov_b32 v6, v5
    s_add_u32 s46, s51, 16781312
    buffer_load_dwordx4 v[188:191], v0, s[28:31], s46 offen offset:0
    v_permlane32_swap_b32 v5, v6
    v_max_f32 v5, v5, v6
    v_mov_b32 v6, v5
    buffer_load_dwordx4 v[192:195], v0, s[28:31], s46 offen offset:1024
    s_nop 0
    v_permlane16_swap_b32 v5, v6
    v_max_f32 v5, v5, v6
    v_sub_f32 v36, v36, v5
    v_sub_f32 v37, v37, v5
    v_sub_f32 v38, v38, v5
    v_sub_f32 v39, v39, v5
    v_sub_f32 v40, v40, v5
    v_sub_f32 v41, v41, v5
    v_sub_f32 v42, v42, v5
    v_sub_f32 v43, v43, v5
    v_sub_f32 v48, v48, v5
    v_sub_f32 v49, v49, v5
    v_exp_f32 v36, v36
    v_exp_f32 v37, v37
    v_exp_f32 v38, v38
    v_exp_f32 v39, v39
    v_exp_f32 v40, v40
    v_exp_f32 v41, v41
    v_exp_f32 v42, v42
    v_exp_f32 v43, v43
    v_exp_f32 v48, v48
    v_exp_f32 v49, v49
    v_cvt_pk_bf16_f32 v24, v36, v37
    v_cvt_pk_bf16_f32 v25, v38, v39
    v_cvt_pk_bf16_f32 v26, v40, v41
    v_cvt_pk_bf16_f32 v27, v42, v43
    v_cvt_pk_bf16_f32 v20, v48, v49
    v_cvt_pk_bf16_f32 v23, v48, v49
    v_mfma_f32_16x16x32_bf16 v[28:31], v[16:19], v[24:27], 0
    v_mfma_f32_16x16x32_bf16 v[76:79], a[64:67], v[24:27], 0
    v_mfma_f32_16x16x32_bf16 v[80:83], a[68:71], v[24:27], 0
    buffer_load_dwordx4 v[196:199], v0, s[28:31], s46 offen offset:2048
    v_mfma_f32_16x16x32_bf16 v[84:87], a[72:75], v[24:27], 0
    v_mfma_f32_16x16x32_bf16 v[88:91], a[76:79], v[24:27], 0
    buffer_load_dwordx4 v[200:203], v0, s[28:31], s46 offen offset:3072
    v_mfma_f32_16x16x32_bf16 v[92:95], a[80:83], v[24:27], 0
    v_mfma_f32_16x16x32_bf16 v[96:99], a[84:87], v[24:27], 0
    s_add_u32 s46, s51, 33554432
    buffer_load_dwordx4 v[204:207], v0, s[28:31], s46 offen offset:0
    v_mfma_f32_16x16x16_bf16 v[28:31], v[16:17], v[20:21], v[28:31]
    v_mfma_f32_16x16x32_bf16 v[100:103], a[88:91], v[24:27], 0
    v_mfma_f32_16x16x32_bf16 v[104:107], a[92:95], v[24:27], 0
    buffer_load_dwordx4 v[208:211], v0, s[28:31], s46 offen offset:1024
    v_mfma_f32_16x16x16_bf16 v[76:79], v[68:69], v[20:21], v[76:79]
    v_mfma_f32_16x16x16_bf16 v[80:83], v[68:69], v[22:23], v[80:83]
    s_nop 2
    v_rcp_f32 v6, v28
    v_mfma_f32_16x16x16_bf16 v[84:87], v[70:71], v[20:21], v[84:87]
    v_mfma_f32_16x16x16_bf16 v[88:91], v[70:71], v[22:23], v[88:91]
    s_nop 0
    v_mul_f32 v76, v6, v76
    v_mul_f32 v80, v6, v80
    v_cvt_pk_bf16_f32 v124, v76, v80
    v_mul_f32 v77, v6, v77
    v_mul_f32 v81, v6, v81
    v_cvt_pk_bf16_f32 v125, v77, v81
    v_mul_f32 v78, v6, v78
    v_mul_f32 v82, v6, v82
    v_cvt_pk_bf16_f32 v126, v78, v82
    v_mul_f32 v79, v6, v79
    v_mul_f32 v83, v6, v83
    v_cvt_pk_bf16_f32 v127, v79, v83
    s_add_u32 s17, s48, 0
    buffer_store_dwordx4 v[124:127], v0, s[8:11], s17 offen offset:1024
    buffer_load_dwordx4 v[212:215], v0, s[28:31], s46 offen offset:2048
    v_mfma_f32_16x16x16_bf16 v[92:95], v[72:73], v[20:21], v[92:95]
    v_mfma_f32_16x16x16_bf16 v[96:99], v[72:73], v[22:23], v[96:99]
    v_mul_f32 v84, v6, v84
    v_mul_f32 v88, v6, v88
    v_cvt_pk_bf16_f32 v128, v84, v88
    v_mul_f32 v85, v6, v85
    v_mul_f32 v89, v6, v89
    v_cvt_pk_bf16_f32 v129, v85, v89
    v_mul_f32 v86, v6, v86
    v_mul_f32 v90, v6, v90
    v_cvt_pk_bf16_f32 v130, v86, v90
    v_mul_f32 v87, v6, v87
    v_mul_f32 v91, v6, v91
    v_cvt_pk_bf16_f32 v131, v87, v91
    buffer_store_dwordx4 v[128:131], v0, s[8:11], s17 offen offset:3072
    buffer_load_dwordx4 v[216:219], v0, s[28:31], s46 offen offset:3072
    v_mfma_f32_16x16x16_bf16 v[100:103], v[74:75], v[20:21], v[100:103]
    v_mfma_f32_16x16x16_bf16 v[104:107], v[74:75], v[22:23], v[104:107]
    v_mul_f32 v92, v6, v92
    v_mul_f32 v96, v6, v96
    v_cvt_pk_bf16_f32 v132, v92, v96
    v_mul_f32 v93, v6, v93
    v_mul_f32 v97, v6, v97
    v_cvt_pk_bf16_f32 v133, v93, v97
    v_mul_f32 v94, v6, v94
    v_mul_f32 v98, v6, v98
    v_cvt_pk_bf16_f32 v134, v94, v98
    v_mul_f32 v95, v6, v95
    v_mul_f32 v99, v6, v99
    v_cvt_pk_bf16_f32 v135, v95, v99
    s_add_u32 s17, s48, 4096
    buffer_store_dwordx4 v[132:135], v0, s[8:11], s17 offen offset:1024
    s_add_u32 s46, s51, 33558528
    buffer_load_dwordx4 v[220:223], v0, s[28:31], s46 offen offset:0
    v_mul_f32 v100, v6, v100
    v_mul_f32 v104, v6, v104
    v_cvt_pk_bf16_f32 v136, v100, v104
    v_mul_f32 v101, v6, v101
    v_mul_f32 v105, v6, v105
    v_cvt_pk_bf16_f32 v137, v101, v105
    v_mul_f32 v102, v6, v102
    v_mul_f32 v106, v6, v106
    v_cvt_pk_bf16_f32 v138, v102, v106
    v_mul_f32 v103, v6, v103
    v_mul_f32 v107, v6, v107
    v_cvt_pk_bf16_f32 v139, v103, v107
    buffer_store_dwordx4 v[136:139], v0, s[8:11], s17 offen offset:3072
    buffer_load_dwordx4 v[224:227], v0, s[28:31], s46 offen offset:1024
    buffer_load_dwordx4 v[228:231], v0, s[28:31], s46 offen offset:2048
    buffer_load_dwordx4 v[232:235], v0, s[28:31], s46 offen offset:3072
    s_add_u32 s48, s48, 262144
    s_mov_b32 s49, 22528
    s_mov_b32 s66, -1
    s_cmp_ge_u32 s37, 64
    s_cbranch_scc1 LtaF_end
    s_branch LtaF0
LtaF_end:
    s_waitcnt vmcnt(0)
    s_and_b32 s17, s49, s66
    s_cselect_b64 exec, 1, 0
    buffer_store_dword v3, v4, s[8:11], s43 offen
    s_andn2_b32 s17, s49, s66
    s_cselect_b64 exec, 1, 0
    buffer_store_dword v3, v4, s[8:11], s43 offen sc1
    s_mov_b64 exec, -1
    s_add_u32 s43, s43, s49
    s_mov_b32 s49, 0
    s_branch L_role_ta_exit
LtaS0:
    s_sub_u32 s17, s37, 33
    s_mul_i32 s18, s17, 43
    s_lshr_b32 s18, s18, 7
    s_mul_i32 s18, s18, 3
    s_cmp_eq_u32 s18, s17
    s_cselect_b32 s18, 1, 0
    s_cmp_lt_u32 s37, 34
    s_cselect_b32 s18, 1, s18
    s_cmp_eq_u32 s36, 0
    s_cselect_b32 s18, 1, s18
    s_and_b32 s18, s18, s61
    s_cbranch_scc1 LtaF0_in
LtaS0_in:
    s_and_b32 s17, s37, 7
    s_mul_i32 s17, s17, 131072
    s_add_u32 s47, s35, s17
    s_bfe_u32 s34, s37, 65539
    s_cmp_eq_u32 s39, 1
    s_cbranch_scc1 LtaS0_have
    s_waitcnt vmcnt(0)
    s_and_b32 s17, s49, s66
    s_cselect_b64 exec, 1, 0
    buffer_store_dword v3, v4, s[8:11], s43 offen
    s_andn2_b32 s17, s49, s66
    s_cselect_b64 exec, 1, 0
    buffer_store_dword v3, v4, s[8:11], s43 offen sc1
    s_mov_b64 exec, -1
    s_add_u32 s43, s43, s49
    s_mov_b32 s49, 0
    s_mov_b32 s16, 0
LtaS0_f_6:
    buffer_load_dword v2, v1, s[8:11], s42 offen sc1
    s_add_u32 s16, s16, 1
    s_cmp_gt_u32 s16, 100000
    s_cbranch_scc1 L_role_ta_abort
    s_waitcnt vmcnt(0)
    v_cmp_eq_u32 vcc, 0, v2
    s_nop 0
    s_cbranch_vccz LtaS0_fd_7
    s_sleep 4
    s_branch LtaS0_f_6
LtaS0_fd_7:
    s_add_u32 s46, s51, 0
    buffer_load_dwordx4 v[140:143], v0, s[8:11], s46 offen offset:0
    buffer_load_dwordx4 v[144:147], v0, s[8:11], s46 offen offset:1024
    buffer_load_dwordx4 v[148:151], v0, s[8:11], s46 offen offset:2048
    buffer_load_dwordx4 v[152:155], v0, s[8:11], s46 offen offset:3072
    s_add_u32 s46, s51, 4096
    buffer_load_dwordx4 v[156:159], v0, s[8:11], s46 offen offset:0
    buffer_load_dwordx4 v[160:163], v0, s[8:11], s46 offen offset:1024
    buffer_load_dwordx4 v[164:167], v0, s[8:11], s46 offen offset:2048
    buffer_load_dwordx4 v[168:171], v0, s[8:11], s46 offen offset:3072
    s_add_u32 s46, s51, 16777216
    buffer_load_dwordx4 v[172:175], v0, s[8:11], s46 offen offset:0
    buffer_load_dwordx4 v[176:179], v0, s[8:11], s46 offen offset:1024
    buffer_load_dwordx4 v[180:183], v0, s[8:11], s46 offen offset:2048
    buffer_load_dwordx4 v[184:187], v0, s[8:11], s46 offen offset:3072
    s_add_u32 s46, s51, 16781312
    buffer_load_dwordx4 v[188:191], v0, s[8:11], s46 offen offset:0
    buffer_load_dwordx4 v[192:195], v0, s[8:11], s46 offen offset:1024
    buffer_load_dwordx4 v[196:199], v0, s[8:11], s46 offen offset:2048
    buffer_load_dwordx4 v[200:203], v0, s[8:11], s46 offen offset:3072
    s_add_u32 s46, s51, 33554432
    buffer_load_dwordx4 v[204:207], v0, s[8:11], s46 offen offset:0
    buffer_load_dwordx4 v[208:211], v0, s[8:11], s46 offen offset:1024
    buffer_load_dwordx4 v[212:215], v0, s[8:11], s46 offen offset:2048
    buffer_load_dwordx4 v[216:219], v0, s[8:11], s46 offen offset:3072
    s_add_u32 s46, s51, 33558528
    buffer_load_dwordx4 v[220:223], v0, s[8:11], s46 offen offset:0
    buffer_load_dwordx4 v[224:227], v0, s[8:11], s46 offen offset:1024
    buffer_load_dwordx4 v[228:231], v0, s[8:11], s46 offen offset:2048
    buffer_load_dwordx4 v[232:235], v0, s[8:11], s46 offen offset:3072
LtaS0_have:
    s_add_u32 s17, s42, 22528
    buffer_load_dword v15, v1, s[8:11], s17 offen sc1
    buffer_load_dwordx4 v[52:55], v9, s[8:11], s47 offen offset:0 sc1
    buffer_load_dwordx4 v[56:59], v9, s[8:11], s47 offen offset:64 sc1
    buffer_load_dwordx4 v[60:63], v9, s[8:11], s47 offen offset:128 sc1
    buffer_load_dwordx4 v[64:67], v9, s[8:11], s47 offen offset:192 sc1
    buffer_load_dwordx2 v[68:69], v10, s[8:11], s47 offen offset:2048 sc1
    buffer_load_dwordx2 v[70:71], v10, s[8:11], s47 offen offset:2560 sc1
    buffer_load_dwordx2 v[72:73], v10, s[8:11], s47 offen offset:3072 sc1
    buffer_load_dwordx2 v[74:75], v10, s[8:11], s47 offen offset:3584 sc1
    s_waitcnt vmcnt(9)
    s_and_b32 s17, s49, s66
    s_cselect_b64 exec, 1, 0
    buffer_store_dword v3, v4, s[8:11], s43 offen
    s_andn2_b32 s17, s49, s66
    s_cselect_b64 exec, 1, 0
    buffer_store_dword v3, v4, s[8:11], s43 offen sc1
    s_mov_b64 exec, -1
    s_add_u32 s43, s43, s49
    s_mov_b32 s49, 0
    v_mfma_f32_16x16x32_bf16 v[32:35], v[172:175], v[140:143], 0
    v_mfma_f32_16x16x32_bf16 v[36:39], v[172:175], v[144:147], 0
    v_mfma_f32_16x16x32_bf16 v[40:43], v[176:179], v[144:147], 0
    v_mfma_f32_16x16x32_bf16 v[32:35], v[180:183], v[148:151], v[32:35]
    v_mfma_f32_16x16x32_bf16 v[36:39], v[180:183], v[152:155], v[36:39]
    v_mfma_f32_16x16x32_bf16 v[40:43], v[184:187], v[152:155], v[40:43]
    v_mfma_f32_16x16x32_bf16 v[32:35], v[188:191], v[156:159], v[32:35]
    v_mfma_f32_16x16x32_bf16 v[36:39], v[188:191], v[160:163], v[36:39]
    v_mfma_f32_16x16x32_bf16 v[40:43], v[192:195], v[160:163], v[40:43]
    v_mfma_f32_16x16x32_bf16 v[32:35], v[196:199], v[164:167], v[32:35]
    v_mfma_f32_16x16x32_bf16 v[36:39], v[196:199], v[168:171], v[36:39]
    v_mfma_f32_16x16x32_bf16 v[40:43], v[200:203], v[168:171], v[40:43]
    s_waitcnt vmcnt(2)
    v_cmp_eq_u32 vcc, 0, v15
    s_add_u32 s51, s51, 262144
    s_add_u32 s42, s42, 22528
    s_add_u32 s37, s37, 1
    s_cmp_eq_u64 vcc, 0
    s_cselect_b32 s39, 1, 0
    s_cmp_lt_u32 s37, 64
    s_cselect_b32 s39, s39, 0
    s_cmp_eq_u32 s39, 1
    s_cselect_b32 s30, 268435456, 0
    v_fma_f32 v32, v32, s52, v236
    v_fma_f32 v33, v33, s52, v237
    v_fma_f32 v34, v34, s52, v238
    v_fma_f32 v35, v35, s52, v239
    v_mul_f32 v36, s52, v36
    v_mul_f32 v37, s52, v37
    v_mul_f32 v38, s52, v38
    v_mul_f32 v39, s52, v39
    v_fma_f32 v40, v40, s52, v236
    v_fma_f32 v41, v41, s52, v237
    v_fma_f32 v42, v42, s52, v238
    v_fma_f32 v43, v43, s52, v239
    v_xor_b32 v5, s34, v52
    v_xor_b32 v6, s34, v56
    v_or_b32 v5, v5, v6
    v_xor_b32 v6, s34, v60
    v_or_b32 v5, v5, v6
    v_xor_b32 v6, s34, v64
    v_or_b32 v5, v5, v6
    v_xor_b32 v6, s34, v68
    v_or_b32 v5, v5, v6
    v_xor_b32 v6, s34, v70
    v_or_b32 v5, v5, v6
    v_xor_b32 v6, s34, v72
    v_or_b32 v5, v5, v6
    v_xor_b32 v6, s34, v74
    v_or_b32 v5, v5, v6
    v_and_b32 v5, 1, v5
    v_cmp_ne_u32 vcc, 0, v5
    s_nop 0
    s_cbranch_vccz LtaS0_r
    s_mov_b32 s16, 0
LtaS0_rp:
    buffer_load_dwordx4 v[52:55], v9, s[8:11], s47 offen offset:0 sc1
    buffer_load_dwordx4 v[56:59], v9, s[8:11], s47 offen offset:64 sc1
    buffer_load_dwordx4 v[60:63], v9, s[8:11], s47 offen offset:128 sc1
    buffer_load_dwordx4 v[64:67], v9, s[8:11], s47 offen offset:192 sc1
    buffer_load_dwordx2 v[68:69], v10, s[8:11], s47 offen offset:2048 sc1
    buffer_load_dwordx2 v[70:71], v10, s[8:11], s47 offen offset:2560 sc1
    buffer_load_dwordx2 v[72:73], v10, s[8:11], s47 offen offset:3072 sc1
    buffer_load_dwordx2 v[74:75], v10, s[8:11], s47 offen offset:3584 sc1
    s_add_u32 s16, s16, 1
    s_cmp_gt_u32 s16, 100000
    s_cbranch_scc1 L_role_ta_abort
    s_waitcnt vmcnt(0)
    v_xor_b32 v5, s34, v52
    v_xor_b32 v6, s34, v56
    v_or_b32 v5, v5, v6
    v_xor_b32 v6, s34, v60
    v_or_b32 v5, v5, v6
    v_xor_b32 v6, s34, v64
    v_or_b32 v5, v5, v6
    v_xor_b32 v6, s34, v68
    v_or_b32 v5, v5, v6
    v_xor_b32 v6, s34, v70
    v_or_b32 v5, v5, v6
    v_xor_b32 v6, s34, v72
    v_or_b32 v5, v5, v6
    v_xor_b32 v6, s34, v74
    v_or_b32 v5, v5, v6
    v_and_b32 v5, 1, v5
    v_cmp_ne_u32 vcc, 0, v5
    s_nop 0
    s_cbranch_vccz LtaS0_r
    s_sleep 2
    s_branch LtaS0_rp
LtaS0_r:
    s_and_b32 s17, s37, 3
    s_cmp_eq_u32 s17, 0
    s_cselect_b32 s17, s36, 0
    s_cmp_lg_u32 s17, 0
    s_cselect_b64 exec, 1, 0
    s_sub_u32 s17, s42, 22528
    buffer_store_dword v3, v4, s[8:11], s17 offen offset:384 sc1
    s_mov_b64 exec, -1
    s_add_u32 s46, s51, 0
    buffer_load_dwordx4 a[0:3], v0, s[28:31], s46 offen offset:0
    buffer_load_dwordx4 a[4:7], v0, s[28:31], s46 offen offset:1024
    v_mfma_f32_16x16x32_bf16 v[44:47], v[52:55], v[140:143], 0
    v_mfma_f32_16x16x32_bf16 v[48:51], v[52:55], v[144:147], 0
    v_mfma_f32_16x16x32_bf16 v[44:47], v[56:59], v[148:151], v[44:47]
    v_mfma_f32_16x16x32_bf16 v[48:51], v[56:59], v[152:155], v[48:51]
    v_mfma_f32_16x16x32_bf16 v[44:47], v[60:63], v[156:159], v[44:47]
    v_mfma_f32_16x16x32_bf16 v[48:51], v[60:63], v[160:163], v[48:51]
    v_mfma_f32_16x16x32_bf16 v[44:47], v[64:67], v[164:167], v[44:47]
    v_mfma_f32_16x16x32_bf16 v[48:51], v[64:67], v[168:171], v[48:51]
    v_max3_f32 v5, v32, v33, v34
    v_max_f32 v5, v5, v35
    s_nop 4
    v_mul_f32 v44, s52, v44
    v_mul_f32 v45, s52, v45
    v_max3_f32 v5, v5, v44, v45
    v_mov_b32 v6, v5
    buffer_load_dwordx4 a[8:11], v0, s[28:31], s46 offen offset:2048
    s_nop 0
    v_permlane32_swap_b32 v5, v6
    v_max_f32 v5, v5, v6
    v_mov_b32 v6, v5
    buffer_load_dwordx4 a[12:15], v0, s[28:31], s46 offen offset:3072
    s_nop 0
    v_permlane16_swap_b32 v5, v6
    v_max_f32 v5, v5, v6
    v_sub_f32 v32, v32, v5
    v_sub_f32 v33, v33, v5
    v_sub_f32 v34, v34, v5
    v_sub_f32 v35, v35, v5
    v_sub_f32 v44, v44, v5
    v_sub_f32 v45, v45, v5
    v_exp_f32 v32, v32
    v_exp_f32 v33, v33
    v_exp_f32 v34, v34
    v_exp_f32 v35, v35
    v_exp_f32 v44, v44
    v_exp_f32 v45, v45
    v_cvt_pk_bf16_f32 v24, v32, v33
    v_cvt_pk_bf16_f32 v25, v34, v35
    v_mov_b32 v26, 0
    v_mov_b32 v27, 0
    v_cvt_pk_bf16_f32 v20, v44, v45
    v_cvt_pk_bf16_f32 v23, v44, v45
    v_mfma_f32_16x16x32_bf16 v[28:31], v[16:19], v[24:27], 0
    v_mfma_f32_16x16x32_bf16 v[76:79], v[204:207], v[24:27], 0
    v_mfma_f32_16x16x32_bf16 v[80:83], v[208:211], v[24:27], 0
    s_add_u32 s46, s51, 4096
    buffer_load_dwordx4 a[16:19], v0, s[28:31], s46 offen offset:0
    v_mfma_f32_16x16x32_bf16 v[84:87], v[212:215], v[24:27], 0
    v_mfma_f32_16x16x32_bf16 v[88:91], v[216:219], v[24:27], 0
    buffer_load_dwordx4 a[20:23], v0, s[28:31], s46 offen offset:1024
    v_mfma_f32_16x16x32_bf16 v[92:95], v[220:223], v[24:27], 0
    v_mfma_f32_16x16x32_bf16 v[96:99], v[224:227], v[24:27], 0
    buffer_load_dwordx4 a[24:27], v0, s[28:31], s46 offen offset:2048
    v_mfma_f32_16x16x16_bf16 v[28:31], v[16:17], v[20:21], v[28:31]
    v_mfma_f32_16x16x32_bf16 v[100:103], v[228:231], v[24:27], 0
    v_mfma_f32_16x16x32_bf16 v[104:107], v[232:235], v[24:27], 0
    buffer_load_dwordx4 a[28:31], v0, s[28:31], s46 offen offset:3072
    v_mfma_f32_16x16x16_bf16 v[76:79], v[68:69], v[20:21], v[76:79]
    v_mfma_f32_16x16x16_bf16 v[80:83], v[68:69], v[22:23], v[80:83]
    s_nop 2
    v_rcp_f32 v6, v28
    v_mfma_f32_16x16x16_bf16 v[84:87], v[70:71], v[20:21], v[84:87]
    v_mfma_f32_16x16x16_bf16 v[88:91], v[70:71], v[22:23], v[88:91]
    s_nop 0
    v_mul_f32 v76, v6, v76
    v_mul_f32 v80, v6, v80
    v_cvt_pk_bf16_f32 v108, v76, v80
    v_mul_f32 v77, v6, v77
    v_mul_f32 v81, v6, v81
    v_cvt_pk_bf16_f32 v109, v77, v81
    v_mul_f32 v78, v6, v78
    v_mul_f32 v82, v6, v82
    v_cvt_pk_bf16_f32 v110, v78, v82
    v_mul_f32 v79, v6, v79
    v_mul_f32 v83, v6, v83
    v_cvt_pk_bf16_f32 v111, v79, v83
    s_add_u32 s17, s48, 0
    buffer_store_dwordx4 v[108:111], v0, s[8:11], s17 offen offset:0 sc1
    s_add_u32 s46, s51, 16777216
    buffer_load_dwordx4 a[32:35], v0, s[28:31], s46 offen offset:0
    v_mfma_f32_16x16x16_bf16 v[92:95], v[72:73], v[20:21], v[92:95]
    v_mfma_f32_16x16x16_bf16 v[96:99], v[72:73], v[22:23], v[96:99]
    v_mul_f32 v84, v6, v84
    v_mul_f32 v88, v6, v88
    v_cvt_pk_bf16_f32 v112, v84, v88
    v_mul_f32 v85, v6, v85
    v_mul_f32 v89, v6, v89
    v_cvt_pk_bf16_f32 v113, v85, v89
    v_mul_f32 v86, v6, v86
    v_mul_f32 v90, v6, v90
    v_cvt_pk_bf16_f32 v114, v86, v90
    v_mul_f32 v87, v6, v87
    v_mul_f32 v91, v6, v91
    v_cvt_pk_bf16_f32 v115, v87, v91
    buffer_store_dwordx4 v[112:115], v0, s[8:11], s17 offen offset:2048 sc1
    buffer_load_dwordx4 a[36:39], v0, s[28:31], s46 offen offset:1024
    v_mfma_f32_16x16x16_bf16 v[100:103], v[74:75], v[20:21], v[100:103]
    v_mfma_f32_16x16x16_bf16 v[104:107], v[74:75], v[22:23], v[104:107]
    v_mul_f32 v92, v6, v92
    v_mul_f32 v96, v6, v96
    v_cvt_pk_bf16_f32 v116, v92, v96
    v_mul_f32 v93, v6, v93
    v_mul_f32 v97, v6, v97
    v_cvt_pk_bf16_f32 v117, v93, v97
    v_mul_f32 v94, v6, v94
    v_mul_f32 v98, v6, v98
    v_cvt_pk_bf16_f32 v118, v94, v98
    v_mul_f32 v95, v6, v95
    v_mul_f32 v99, v6, v99
    v_cvt_pk_bf16_f32 v119, v95, v99
    s_add_u32 s17, s48, 4096
    buffer_store_dwordx4 v[116:119], v0, s[8:11], s17 offen offset:0 sc1
    buffer_load_dwordx4 a[40:43], v0, s[28:31], s46 offen offset:2048
    v_mul_f32 v100, v6, v100
    v_mul_f32 v104, v6, v104
    v_cvt_pk_bf16_f32 v120, v100, v104
    v_mul_f32 v101, v6, v101
    v_mul_f32 v105, v6, v105
    v_cvt_pk_bf16_f32 v121, v101, v105
    v_mul_f32 v102, v6, v102
    v_mul_f32 v106, v6, v106
    v_cvt_pk_bf16_f32 v122, v102, v106
    v_mul_f32 v103, v6, v103
    v_mul_f32 v107, v6, v107
    v_cvt_pk_bf16_f32 v123, v103, v107
    buffer_store_dwordx4 v[120:123], v0, s[8:11], s17 offen offset:2048 sc1
    buffer_load_dwordx4 a[44:47], v0, s[28:31], s46 offen offset:3072
    v_max3_f32 v5, v36, v37, v38
    v_max_f32 v5, v5, v39
    v_max3_f32 v5, v5, v40, v41
    v_max3_f32 v5, v5, v42, v43
    v_mul_f32 v48, s52, v48
    v_mul_f32 v49, s52, v49
    v_max3_f32 v5, v5, v48, v49
    v_mov_b32 v6, v5
    s_add_u32 s46, s51, 16781312
    buffer_load_dwordx4 a[48:51], v0, s[28:31], s46 offen offset:0
    v_permlane32_swap_b32 v5, v6
    v_max_f32 v5, v5, v6
    v_mov_b32 v6, v5
    buffer_load_dwordx4 a[52:55], v0, s[28:31], s46 offen offset:1024
    s_nop 0
    v_permlane16_swap_b32 v5, v6
    v_max_f32 v5, v5, v6
    v_sub_f32 v36, v36, v5
    v_sub_f32 v37, v37, v5
    v_sub_f32 v38, v38, v5
    v_sub_f32 v39, v39, v5
    v_sub_f32 v40, v40, v5
    v_sub_f32 v41, v41, v5
    v_sub_f32 v42, v42, v5
    v_sub_f32 v43, v43, v5
    v_sub_f32 v48, v48, v5
    v_sub_f32 v49, v49, v5
    v_exp_f32 v36, v36
    v_exp_f32 v37, v37
    v_exp_f32 v38, v38
    v_exp_f32 v39, v39
    v_exp_f32 v40, v40
    v_exp_f32 v41, v41
    v_exp_f32 v42, v42
    v_exp_f32 v43, v43
    v_exp_f32 v48, v48
    v_exp_f32 v49, v49
    v_cvt_pk_bf16_f32 v24, v36, v37
    v_cvt_pk_bf16_f32 v25, v38, v39
    v_cvt_pk_bf16_f32 v26, v40, v41
    v_cvt_pk_bf16_f32 v27, v42, v43
    v_cvt_pk_bf16_f32 v20, v48, v49
    v_cvt_pk_bf16_f32 v23, v48, v49
    v_mfma_f32_16x16x32_bf16 v[28:31], v[16:19], v[24:27], 0
    v_mfma_f32_16x16x32_bf16 v[76:79], v[204:207], v[24:27], 0
    v_mfma_f32_16x16x32_bf16 v[80:83], v[208:211], v[24:27], 0
    buffer_load_dwordx4 a[56:59], v0, s[28:31], s46 offen offset:2048
    v_mfma_f32_16x16x32_bf16 v[84:87], v[212:215], v[24:27], 0
    v_mfma_f32_16x16x32_bf16 v[88:91], v[216:219], v[24:27], 0
    buffer_load_dwordx4 a[60:63], v0, s[28:31], s46 offen offset:3072
    v_mfma_f32_16x16x32_bf16 v[92:95], v[220:223], v[24:27], 0
    v_mfma_f32_16x16x32_bf16 v[96:99], v[224:227], v[24:27], 0
    s_add_u32 s46, s51, 33554432
    buffer_load_dwordx4 a[64:67], v0, s[28:31], s46 offen offset:0
    v_mfma_f32_16x16x16_bf16 v[28:31], v[16:17], v[20:21], v[28:31]
    v_mfma_f32_16x16x32_bf16 v[100:103], v[228:231], v[24:27], 0
    v_mfma_f32_16x16x32_bf16 v[104:107], v[232:235], v[24:27], 0
    buffer_load_dwordx4 a[68:71], v0, s[28:31], s46 offen offset:1024
    v_mfma_f32_16x16x16_bf16 v[76:79], v[68:69], v[20:21], v[76:79]
    v_mfma_f32_16x16x16_bf16 v[80:83], v[68:69], v[22:23], v[80:83]
    s_nop 2
    v_rcp_f32 v6, v28
    v_mfma_f32_16x16x16_bf16 v[84:87], v[70:71], v[20:21], v[84:87]
    v_mfma_f32_16x16x16_bf16 v[88:91], v[70:71], v[22:23], v[88:91]
    s_nop 0
    v_mul_f32 v76, v6, v76
    v_mul_f32 v80, v6, v80
    v_cvt_pk_bf16_f32 v124, v76, v80
    v_mul_f32 v77, v6, v77
    v_mul_f32 v81, v6, v81
    v_cvt_pk_bf16_f32 v125, v77, v81
    v_mul_f32 v78, v6, v78
    v_mul_f32 v82, v6, v82
    v_cvt_pk_bf16_f32 v126, v78, v82
    v_mul_f32 v79, v6, v79
    v_mul_f32 v83, v6, v83
    v_cvt_pk_bf16_f32 v127, v79, v83
    s_add_u32 s17, s48, 0
    buffer_store_dwordx4 v[124:127], v0, s[8:11], s17 offen offset:1024 sc1
    buffer_load_dwordx4 a[72:75], v0, s[28:31], s46 offen offset:2048
    v_mfma_f32_16x16x16_bf16 v[92:95], v[72:73], v[20:21], v[92:95]
    v_mfma_f32_16x16x16_bf16 v[96:99], v[72:73], v[22:23], v[96:99]
    v_mul_f32 v84, v6, v84
    v_mul_f32 v88, v6, v88
    v_cvt_pk_bf16_f32 v128, v84, v88
    v_mul_f32 v85, v6, v85
    v_mul_f32 v89, v6, v89
    v_cvt_pk_bf16_f32 v129, v85, v89
    v_mul_f32 v86, v6, v86
    v_mul_f32 v90, v6, v90
    v_cvt_pk_bf16_f32 v130, v86, v90
    v_mul_f32 v87, v6, v87
    v_mul_f32 v91, v6, v91
    v_cvt_pk_bf16_f32 v131, v87, v91
    buffer_store_dwordx4 v[128:131], v0, s[8:11], s17 offen offset:3072 sc1
    buffer_load_dwordx4 a[76:79], v0, s[28:31], s46 offen offset:3072
    v_mfma_f32_16x16x16_bf16 v[100:103], v[74:75], v[20:21], v[100:103]
    v_mfma_f32_16x16x16_bf16 v[104:107], v[74:75], v[22:23], v[104:107]
    v_mul_f32 v92, v6, v92
    v_mul_f32 v96, v6, v96
    v_cvt_pk_bf16_f32 v132, v92, v96
    v_mul_f32 v93, v6, v93
    v_mul_f32 v97, v6, v97
    v_cvt_pk_bf16_f32 v133, v93, v97
    v_mul_f32 v94, v6, v94
    v_mul_f32 v98, v6, v98
    v_cvt_pk_bf16_f32 v134, v94, v98
    v_mul_f32 v95, v6, v95
    v_mul_f32 v99, v6, v99
    v_cvt_pk_bf16_f32 v135, v95, v99
    s_add_u32 s17, s48, 4096
    buffer_store_dwordx4 v[132:135], v0, s[8:11], s17 offen offset:1024 sc1
    s_add_u32 s46, s51, 33558528
    buffer_load_dwordx4 a[80:83], v0, s[28:31], s46 offen offset:0
    v_mul_f32 v100, v6, v100
    v_mul_f32 v104, v6, v104
    v_cvt_pk_bf16_f32 v136, v100, v104
    v_mul_f32 v101, v6, v101
    v_mul_f32 v105, v6, v105
    v_cvt_pk_bf16_f32 v137, v101, v105
    v_mul_f32 v102, v6, v102
    v_mul_f32 v106, v6, v106
    v_cvt_pk_bf16_f32 v138, v102, v106
    v_mul_f32 v103, v6, v103
    v_mul_f32 v107, v6, v107
    v_cvt_pk_bf16_f32 v139, v103, v107
    buffer_store_dwordx4 v[136:139], v0, s[8:11], s17 offen offset:3072 sc1
    buffer_load_dwordx4 a[84:87], v0, s[28:31], s46 offen offset:1024
    buffer_load_dwordx4 a[88:91], v0, s[28:31], s46 offen offset:2048
    buffer_load_dwordx4 a[92:95], v0, s[28:31], s46 offen offset:3072
    s_add_u32 s48, s48, 262144
    s_mov_b32 s49, 22528
    s_mov_b32 s66, 0
    s_cmp_ge_u32 s37, 64
    s_cbranch_scc1 LtaS_end
LtaS1:
    s_sub_u32 s17, s37, 33
    s_mul_i32 s18, s17, 43
    s_lshr_b32 s18, s18, 7
    s_mul_i32 s18, s18, 3
    s_cmp_eq_u32 s18, s17
    s_cselect_b32 s18, 1, 0
    s_cmp_lt_u32 s37, 34
    s_cselect_b32 s18, 1, s18
    s_cmp_eq_u32 s36, 0
    s_cselect_b32 s18, 1, s18
    s_and_b32 s18, s18, s61
    s_cbranch_scc1 LtaF1_in
LtaS1_in:
    s_and_b32 s17, s37, 7
    s_mul_i32 s17, s17, 131072
    s_add_u32 s47, s35, s17
    s_bfe_u32 s34, s37, 65539
    s_cmp_eq_u32 s39, 1
    s_cbranch_scc1 LtaS1_have
    s_waitcnt vmcnt(0)
    s_and_b32 s17, s49, s66
    s_cselect_b64 exec, 1, 0
    buffer_store_dword v3, v4, s[8:11], s43 offen
    s_andn2_b32 s17, s49, s66
    s_cselect_b64 exec, 1, 0
    buffer_store_dword v3, v4, s[8:11], s43 offen sc1
    s_mov_b64 exec, -1
    s_add_u32 s43, s43, s49
    s_mov_b32 s49, 0
    s_mov_b32 s16, 0
LtaS1_f_8:
    buffer_load_dword v2, v1, s[8:11], s42 offen sc1
    s_add_u32 s16, s16, 1
    s_cmp_gt_u32 s16, 100000
    s_cbranch_scc1 L_role_ta_abort
    s_waitcnt vmcnt(0)
    v_cmp_eq_u32 vcc, 0, v2
    s_nop 0
    s_cbranch_vccz LtaS1_fd_9
    s_sleep 4
    s_branch LtaS1_f_8
LtaS1_fd_9:
    s_add_u32 s46, s51, 0
    buffer_load_dwordx4 a[0:3], v0, s[8:11], s46 offen offset:0
    buffer_load_dwordx4 a[4:7], v0, s[8:11], s46 offen offset:1024
    buffer_load_dwordx4 a[8:11], v0, s[8:11], s46 offen offset:2048
    buffer_load_dwordx4 a[12:15], v0, s[8:11], s46 offen offset:3072
    s_add_u32 s46, s51, 4096
    buffer_load_dwordx4 a[16:19], v0, s[8:11], s46 offen offset:0
    buffer_load_dwordx4 a[20:23], v0, s[8:11], s46 offen offset:1024
    buffer_load_dwordx4 a[24:27], v0, s[8:11], s46 offen offset:2048
    buffer_load_dwordx4 a[28:31], v0, s[8:11], s46 offen offset:3072
    s_add_u32 s46, s51, 16777216
    buffer_load_dwordx4 a[32:35], v0, s[8:11], s46 offen offset:0
    buffer_load_dwordx4 a[36:39], v0, s[8:11], s46 offen offset:1024
    buffer_load_dwordx4 a[40:43], v0, s[8:11], s46 offen offset:2048
    buffer_load_dwordx4 a[44:47], v0, s[8:11], s46 offen offset:3072
    s_add_u32 s46, s51, 16781312
    buffer_load_dwordx4 a[48:51], v0, s[8:11], s46 offen offset:0
    buffer_load_dwordx4 a[52:55], v0, s[8:11], s46 offen offset:1024
    buffer_load_dwordx4 a[56:59], v0, s[8:11], s46 offen offset:2048
    buffer_load_dwordx4 a[60:63], v0, s[8:11], s46 offen offset:3072
    s_add_u32 s46, s51, 33554432
    buffer_load_dwordx4 a[64:67], v0, s[8:11], s46 offen offset:0
    buffer_load_dwordx4 a[68:71], v0, s[8:11], s46 offen offset:1024
    buffer_load_dwordx4 a[72:75], v0, s[8:11], s46 offen offset:2048
    buffer_load_dwordx4 a[76:79], v0, s[8:11], s46 offen offset:3072
    s_add_u32 s46, s51, 33558528
    buffer_load_dwordx4 a[80:83], v0, s[8:11], s46 offen offset:0
    buffer_load_dwordx4 a[84:87], v0, s[8:11], s46 offen offset:1024
    buffer_load_dwordx4 a[88:91], v0, s[8:11], s46 offen offset:2048
    buffer_load_dwordx4 a[92:95], v0, s[8:11], s46 offen offset:3072
LtaS1_have:
    s_add_u32 s17, s42, 22528
    buffer_load_dword v15, v1, s[8:11], s17 offen sc1
    buffer_load_dwordx4 v[52:55], v9, s[8:11], s47 offen offset:0 sc1
    buffer_load_dwordx4 v[56:59], v9, s[8:11], s47 offen offset:64 sc1
    buffer_load_dwordx4 v[60:63], v9, s[8:11], s47 offen offset:128 sc1
    buffer_load_dwordx4 v[64:67], v9, s[8:11], s47 offen offset:192 sc1
    buffer_load_dwordx2 v[68:69], v10, s[8:11], s47 offen offset:2048 sc1
    buffer_load_dwordx2 v[70:71], v10, s[8:11], s47 offen offset:2560 sc1
    buffer_load_dwordx2 v[72:73], v10, s[8:11], s47 offen offset:3072 sc1
    buffer_load_dwordx2 v[74:75], v10, s[8:11], s47 offen offset:3584 sc1
    s_waitcnt vmcnt(9)
    s_and_b32 s17, s49, s66
    s_cselect_b64 exec, 1, 0
    buffer_store_dword v3, v4, s[8:11], s43 offen
    s_andn2_b32 s17, s49, s66
    s_cselect_b64 exec, 1, 0
    buffer_store_dword v3, v4, s[8:11], s43 offen sc1
    s_mov_b64 exec, -1
    s_add_u32 s43, s43, s49
    s_mov_b32 s49, 0
    v_mfma_f32_16x16x32_bf16 v[32:35], a[32:35], a[0:3], 0
    v_mfma_f32_16x16x32_bf16 v[36:39], a[32:35], a[4:7], 0
    v_mfma_f32_16x16x32_bf16 v[40:43], a[36:39], a[4:7], 0
    v_mfma_f32_16x16x32_bf16 v[32:35], a[40:43], a[8:11], v[32:35]
    v_mfma_f32_16x16x32_bf16 v[36:39], a[40:43], a[12:15], v[36:39]
    v_mfma_f32_16x16x32_bf16 v[40:43], a[44:47], a[12:15], v[40:43]
    v_mfma_f32_16x16x32_bf16 v[32:35], a[48:51], a[16:19], v[32:35]
    v_mfma_f32_16x16x32_bf16 v[36:39], a[48:51], a[20:23], v[36:39]
    v_mfma_f32_16x16x32_bf16 v[40:43], a[52:55], a[20:23], v[40:43]
    v_mfma_f32_16x16x32_bf16 v[32:35], a[56:59], a[24:27], v[32:35]
    v_mfma_f32_16x16x32_bf16 v[36:39], a[56:59], a[28:31], v[36:39]
    v_mfma_f32_16x16x32_bf16 v[40:43], a[60:63], a[28:31], v[40:43]
    s_waitcnt vmcnt(2)
    v_cmp_eq_u32 vcc, 0, v15
    s_add_u32 s51, s51, 262144
    s_add_u32 s42, s42, 22528
    s_add_u32 s37, s37, 1
    s_cmp_eq_u64 vcc, 0
    s_cselect_b32 s39, 1, 0
    s_cmp_lt_u32 s37, 64
    s_cselect_b32 s39, s39, 0
    s_cmp_eq_u32 s39, 1
    s_cselect_b32 s30, 268435456, 0
    v_fma_f32 v32, v32, s52, v236
    v_fma_f32 v33, v33, s52, v237
    v_fma_f32 v34, v34, s52, v238
    v_fma_f32 v35, v35, s52, v239
    v_mul_f32 v36, s52, v36
    v_mul_f32 v37, s52, v37
    v_mul_f32 v38, s52, v38
    v_mul_f32 v39, s52, v39
    v_fma_f32 v40, v40, s52, v236
    v_fma_f32 v41, v41, s52, v237
    v_fma_f32 v42, v42, s52, v238
    v_fma_f32 v43, v43, s52, v239
    v_xor_b32 v5, s34, v52
    v_xor_b32 v6, s34, v56
    v_or_b32 v5, v5, v6
    v_xor_b32 v6, s34, v60
    v_or_b32 v5, v5, v6
    v_xor_b32 v6, s34, v64
    v_or_b32 v5, v5, v6
    v_xor_b32 v6, s34, v68
    v_or_b32 v5, v5, v6
    v_xor_b32 v6, s34, v70
    v_or_b32 v5, v5, v6
    v_xor_b32 v6, s34, v72
    v_or_b32 v5, v5, v6
    v_xor_b32 v6, s34, v74
    v_or_b32 v5, v5, v6
    v_and_b32 v5, 1, v5
    v_cmp_ne_u32 vcc, 0, v5
    s_nop 0
    s_cbranch_vccz LtaS1_r
    s_mov_b32 s16, 0
LtaS1_rp:
    buffer_load_dwordx4 v[52:55], v9, s[8:11], s47 offen offset:0 sc1
    buffer_load_dwordx4 v[56:59], v9, s[8:11], s47 offen offset:64 sc1
    buffer_load_dwordx4 v[60:63], v9, s[8:11], s47 offen offset:128 sc1
    buffer_load_dwordx4 v[64:67], v9, s[8:11], s47 offen offset:192 sc1
    buffer_load_dwordx2 v[68:69], v10, s[8:11], s47 offen offset:2048 sc1
    buffer_load_dwordx2 v[70:71], v10, s[8:11], s47 offen offset:2560 sc1
    buffer_load_dwordx2 v[72:73], v10, s[8:11], s47 offen offset:3072 sc1
    buffer_load_dwordx2 v[74:75], v10, s[8:11], s47 offen offset:3584 sc1
    s_add_u32 s16, s16, 1
    s_cmp_gt_u32 s16, 100000
    s_cbranch_scc1 L_role_ta_abort
    s_waitcnt vmcnt(0)
    v_xor_b32 v5, s34, v52
    v_xor_b32 v6, s34, v56
    v_or_b32 v5, v5, v6
    v_xor_b32 v6, s34, v60
    v_or_b32 v5, v5, v6
    v_xor_b32 v6, s34, v64
    v_or_b32 v5, v5, v6
    v_xor_b32 v6, s34, v68
    v_or_b32 v5, v5, v6
    v_xor_b32 v6, s34, v70
    v_or_b32 v5, v5, v6
    v_xor_b32 v6, s34, v72
    v_or_b32 v5, v5, v6
    v_xor_b32 v6, s34, v74
    v_or_b32 v5, v5, v6
    v_and_b32 v5, 1, v5
    v_cmp_ne_u32 vcc, 0, v5
    s_nop 0
    s_cbranch_vccz LtaS1_r
    s_sleep 2
    s_branch LtaS1_rp
LtaS1_r:
    s_and_b32 s17, s37, 3
    s_cmp_eq_u32 s17, 0
    s_cselect_b32 s17, s36, 0
    s_cmp_lg_u32 s17, 0
    s_cselect_b64 exec, 1, 0
    s_sub_u32 s17, s42, 22528
    buffer_store_dword v3, v4, s[8:11], s17 offen offset:384 sc1
    s_mov_b64 exec, -1
    s_add_u32 s46, s51, 0
    buffer_load_dwordx4 v[140:143], v0, s[28:31], s46 offen offset:0
    buffer_load_dwordx4 v[144:147], v0, s[28:31], s46 offen offset:1024
    v_mfma_f32_16x16x32_bf16 v[44:47], v[52:55], a[0:3], 0
    v_mfma_f32_16x16x32_bf16 v[48:51], v[52:55], a[4:7], 0
    v_mfma_f32_16x16x32_bf16 v[44:47], v[56:59], a[8:11], v[44:47]
    v_mfma_f32_16x16x32_bf16 v[48:51], v[56:59], a[12:15], v[48:51]
    v_mfma_f32_16x16x32_bf16 v[44:47], v[60:63], a[16:19], v[44:47]
    v_mfma_f32_16x16x32_bf16 v[48:51], v[60:63], a[20:23], v[48:51]
    v_mfma_f32_16x16x32_bf16 v[44:47], v[64:67], a[24:27], v[44:47]
    v_mfma_f32_16x16x32_bf16 v[48:51], v[64:67], a[28:31], v[48:51]
    v_max3_f32 v5, v32, v33, v34
    v_max_f32 v5, v5, v35
    s_nop 4
    v_mul_f32 v44, s52, v44
    v_mul_f32 v45, s52, v45
    v_max3_f32 v5, v5, v44, v45
    v_mov_b32 v6, v5
    buffer_load_dwordx4 v[148:151], v0, s[28:31], s46 offen offset:2048
    s_nop 0
    v_permlane32_swap_b32 v5, v6
    v_max_f32 v5, v5, v6
    v_mov_b32 v6, v5
    buffer_load_dwordx4 v[152:155], v0, s[28:31], s46 offen offset:3072
    s_nop 0
    v_permlane16_swap_b32 v5, v6
    v_max_f32 v5, v5, v6
    v_sub_f32 v32, v32, v5
    v_sub_f32 v33, v33, v5
    v_sub_f32 v34, v34, v5
    v_sub_f32 v35, v35, v5
    v_sub_f32 v44, v44, v5
    v_sub_f32 v45, v45, v5
    v_exp_f32 v32, v32
    v_exp_f32 v33, v33
    v_exp_f32 v34, v34
    v_exp_f32 v35, v35
    v_exp_f32 v44, v44
    v_exp_f32 v45, v45
    v_cvt_pk_bf16_f32 v24, v32, v33
    v_cvt_pk_bf16_f32 v25, v34, v35
    v_mov_b32 v26, 0
    v_mov_b32 v27, 0
    v_cvt_pk_bf16_f32 v20, v44, v45
    v_cvt_pk_bf16_f32 v23, v44, v45
    v_mfma_f32_16x16x32_bf16 v[28:31], v[16:19], v[24:27], 0
    v_mfma_f32_16x16x32_bf16 v[76:79], a[64:67], v[24:27], 0
    v_mfma_f32_16x16x32_bf16 v[80:83], a[68:71], v[24:27], 0
    s_add_u32 s46, s51, 4096
    buffer_load_dwordx4 v[156:159], v0, s[28:31], s46 offen offset:0
    v_mfma_f32_16x16x32_bf16 v[84:87], a[72:75], v[24:27], 0
    v_mfma_f32_16x16x32_bf16 v[88:91], a[76:79], v[24:27], 0
    buffer_load_dwordx4 v[160:163], v0, s[28:31], s46 offen offset:1024
    v_mfma_f32_16x16x32_bf16 v[92:95], a[80:83], v[24:27], 0
    v_mfma_f32_16x16x32_bf16 v[96:99], a[84:87], v[24:27], 0
    buffer_load_dwordx4 v[164:167], v0, s[28:31], s46 offen offset:2048
    v_mfma_f32_16x16x16_bf16 v[28:31], v[16:17], v[20:21], v[28:31]
    v_mfma_f32_16x16x32_bf16 v[100:103], a[88:91], v[24:27], 0
    v_mfma_f32_16x16x32_bf16 v[104:107], a[92:95], v[24:27], 0
    buffer_load_dwordx4 v[168:171], v0, s[28:31], s46 offen offset:3072
    v_mfma_f32_16x16x16_bf16 v[76:79], v[68:69], v[20:21], v[76:79]
    v_mfma_f32_16x16x16_bf16 v[80:83], v[68:69], v[22:23], v[80:83]
    s_nop 2
    v_rcp_f32 v6, v28
    v_mfma_f32_16x16x16_bf16 v[84:87], v[70:71], v[20:21], v[84:87]
    v_mfma_f32_16x16x16_bf16 v[88:91], v[70:71], v[22:23], v[88:91]
    s_nop 0
    v_mul_f32 v76, v6, v76
    v_mul_f32 v80, v6, v80
    v_cvt_pk_bf16_f32 v108, v76, v80
    v_mul_f32 v77, v6, v77
    v_mul_f32 v81, v6, v81
    v_cvt_pk_bf16_f32 v109, v77, v81
    v_mul_f32 v78, v6, v78
    v_mul_f32 v82, v6, v82
    v_cvt_pk_bf16_f32 v110, v78, v82
    v_mul_f32 v79, v6, v79
    v_mul_f32 v83, v6, v83
    v_cvt_pk_bf16_f32 v111, v79, v83
    s_add_u32 s17, s48, 0
    buffer_store_dwordx4 v[108:111], v0, s[8:11], s17 offen offset:0 sc1
    s_add_u32 s46, s51, 16777216
    buffer_load_dwordx4 v[172:175], v0, s[28:31], s46 offen offset:0
    v_mfma_f32_16x16x16_bf16 v[92:95], v[72:73], v[20:21], v[92:95]
    v_mfma_f32_16x16x16_bf16 v[96:99], v[72:73], v[22:23], v[96:99]
    v_mul_f32 v84, v6, v84
    v_mul_f32 v88, v6, v88
    v_cvt_pk_bf16_f32 v112, v84, v88
    v_mul_f32 v85, v6, v85
    v_mul_f32 v89, v6, v89
    v_cvt_pk_bf16_f32 v113, v85, v89
    v_mul_f32 v86, v6, v86
    v_mul_f32 v90, v6, v90
    v_cvt_pk_bf16_f32 v114, v86, v90
    v_mul_f32 v87, v6, v87
    v_mul_f32 v91, v6, v91
    v_cvt_pk_bf16_f32 v115, v87, v91
    buffer_store_dwordx4 v[112:115], v0, s[8:11], s17 offen offset:2048 sc1
    buffer_load_dwordx4 v[176:179], v0, s[28:31], s46 offen offset:1024
    v_mfma_f32_16x16x16_bf16 v[100:103], v[74:75], v[20:21], v[100:103]
    v_mfma_f32_16x16x16_bf16 v[104:107], v[74:75], v[22:23], v[104:107]
    v_mul_f32 v92, v6, v92
    v_mul_f32 v96, v6, v96
    v_cvt_pk_bf16_f32 v116, v92, v96
    v_mul_f32 v93, v6, v93
    v_mul_f32 v97, v6, v97
    v_cvt_pk_bf16_f32 v117, v93, v97
    v_mul_f32 v94, v6, v94
    v_mul_f32 v98, v6, v98
    v_cvt_pk_bf16_f32 v118, v94, v98
    v_mul_f32 v95, v6, v95
    v_mul_f32 v99, v6, v99
    v_cvt_pk_bf16_f32 v119, v95, v99
    s_add_u32 s17, s48, 4096
    buffer_store_dwordx4 v[116:119], v0, s[8:11], s17 offen offset:0 sc1
    buffer_load_dwordx4 v[180:183], v0, s[28:31], s46 offen offset:2048
    v_mul_f32 v100, v6, v100
    v_mul_f32 v104, v6, v104
    v_cvt_pk_bf16_f32 v120, v100, v104
    v_mul_f32 v101, v6, v101
    v_mul_f32 v105, v6, v105
    v_cvt_pk_bf16_f32 v121, v101, v105
    v_mul_f32 v102, v6, v102
    v_mul_f32 v106, v6, v106
    v_cvt_pk_bf16_f32 v122, v102, v106
    v_mul_f32 v103, v6, v103
    v_mul_f32 v107, v6, v107
    v_cvt_pk_bf16_f32 v123, v103, v107
    buffer_store_dwordx4 v[120:123], v0, s[8:11], s17 offen offset:2048 sc1
    buffer_load_dwordx4 v[184:187], v0, s[28:31], s46 offen offset:3072
    v_max3_f32 v5, v36, v37, v38
    v_max_f32 v5, v5, v39
    v_max3_f32 v5, v5, v40, v41
    v_max3_f32 v5, v5, v42, v43
    v_mul_f32 v48, s52, v48
    v_mul_f32 v49, s52, v49
    v_max3_f32 v5, v5, v48, v49
    v_mov_b32 v6, v5
    s_add_u32 s46, s51, 16781312
    buffer_load_dwordx4 v[188:191], v0, s[28:31], s46 offen offset:0
    v_permlane32_swap_b32 v5, v6
    v_max_f32 v5, v5, v6
    v_mov_b32 v6, v5
    buffer_load_dwordx4 v[192:195], v0, s[28:31], s46 offen offset:1024
    s_nop 0
    v_permlane16_swap_b32 v5, v6
    v_max_f32 v5, v5, v6
    v_sub_f32 v36, v36, v5
    v_sub_f32 v37, v37, v5
    v_sub_f32 v38, v38, v5
    v_sub_f32 v39, v39, v5
    v_sub_f32 v40, v40, v5
    v_sub_f32 v41, v41, v5
    v_sub_f32 v42, v42, v5
    v_sub_f32 v43, v43, v5
    v_sub_f32 v48, v48, v5
    v_sub_f32 v49, v49, v5
    v_exp_f32 v36, v36
    v_exp_f32 v37, v37
    v_exp_f32 v38, v38
    v_exp_f32 v39, v39
    v_exp_f32 v40, v40
    v_exp_f32 v41, v41
    v_exp_f32 v42, v42
    v_exp_f32 v43, v43
    v_exp_f32 v48, v48
    v_exp_f32 v49, v49
    v_cvt_pk_bf16_f32 v24, v36, v37
    v_cvt_pk_bf16_f32 v25, v38, v39
    v_cvt_pk_bf16_f32 v26, v40, v41
    v_cvt_pk_bf16_f32 v27, v42, v43
    v_cvt_pk_bf16_f32 v20, v48, v49
    v_cvt_pk_bf16_f32 v23, v48, v49
    v_mfma_f32_16x16x32_bf16 v[28:31], v[16:19], v[24:27], 0
    v_mfma_f32_16x16x32_bf16 v[76:79], a[64:67], v[24:27], 0
    v_mfma_f32_16x16x32_bf16 v[80:83], a[68:71], v[24:27], 0
    buffer_load_dwordx4 v[196:199], v0, s[28:31], s46 offen offset:2048
    v_mfma_f32_16x16x32_bf16 v[84:87], a[72:75], v[24:27], 0
    v_mfma_f32_16x16x32_bf16 v[88:91], a[76:79], v[24:27], 0
    buffer_load_dwordx4 v[200:203], v0, s[28:31], s46 offen offset:3072
    v_mfma_f32_16x16x32_bf16 v[92:95], a[80:83], v[24:27], 0
    v_mfma_f32_16x16x32_bf16 v[96:99], a[84:87], v[24:27], 0
    s_add_u32 s46, s51, 33554432
    buffer_load_dwordx4 v[204:207], v0, s[28:31], s46 offen offset:0
    v_mfma_f32_16x16x16_bf16 v[28:31], v[16:17], v[20:21], v[28:31]
    v_mfma_f32_16x16x32_bf16 v[100:103], a[88:91], v[24:27], 0
    v_mfma_f32_16x16x32_bf16 v[104:107], a[92:95], v[24:27], 0
    buffer_load_dwordx4 v[208:211], v0, s[28:31], s46 offen offset:1024
    v_mfma_f32_16x16x16_bf16 v[76:79], v[68:69], v[20:21], v[76:79]
    v_mfma_f32_16x16x16_bf16 v[80:83], v[68:69], v[22:23], v[80:83]
    s_nop 2
    v_rcp_f32 v6, v28
    v_mfma_f32_16x16x16_bf16 v[84:87], v[70:71], v[20:21], v[84:87]
    v_mfma_f32_16x16x16_bf16 v[88:91], v[70:71], v[22:23], v[88:91]
    s_nop 0
    v_mul_f32 v76, v6, v76
    v_mul_f32 v80, v6, v80
    v_cvt_pk_bf16_f32 v124, v76, v80
    v_mul_f32 v77, v6, v77
    v_mul_f32 v81, v6, v81
    v_cvt_pk_bf16_f32 v125, v77, v81
    v_mul_f32 v78, v6, v78
    v_mul_f32 v82, v6, v82
    v_cvt_pk_bf16_f32 v126, v78, v82
    v_mul_f32 v79, v6, v79
    v_mul_f32 v83, v6, v83
    v_cvt_pk_bf16_f32 v127, v79, v83
    s_add_u32 s17, s48, 0
    buffer_store_dwordx4 v[124:127], v0, s[8:11], s17 offen offset:1024 sc1
    buffer_load_dwordx4 v[212:215], v0, s[28:31], s46 offen offset:2048
    v_mfma_f32_16x16x16_bf16 v[92:95], v[72:73], v[20:21], v[92:95]
    v_mfma_f32_16x16x16_bf16 v[96:99], v[72:73], v[22:23], v[96:99]
    v_mul_f32 v84, v6, v84
    v_mul_f32 v88, v6, v88
    v_cvt_pk_bf16_f32 v128, v84, v88
    v_mul_f32 v85, v6, v85
    v_mul_f32 v89, v6, v89
    v_cvt_pk_bf16_f32 v129, v85, v89
    v_mul_f32 v86, v6, v86
    v_mul_f32 v90, v6, v90
    v_cvt_pk_bf16_f32 v130, v86, v90
    v_mul_f32 v87, v6, v87
    v_mul_f32 v91, v6, v91
    v_cvt_pk_bf16_f32 v131, v87, v91
    buffer_store_dwordx4 v[128:131], v0, s[8:11], s17 offen offset:3072 sc1
    buffer_load_dwordx4 v[216:219], v0, s[28:31], s46 offen offset:3072
    v_mfma_f32_16x16x16_bf16 v[100:103], v[74:75], v[20:21], v[100:103]
    v_mfma_f32_16x16x16_bf16 v[104:107], v[74:75], v[22:23], v[104:107]
    v_mul_f32 v92, v6, v92
    v_mul_f32 v96, v6, v96
    v_cvt_pk_bf16_f32 v132, v92, v96
    v_mul_f32 v93, v6, v93
    v_mul_f32 v97, v6, v97
    v_cvt_pk_bf16_f32 v133, v93, v97
    v_mul_f32 v94, v6, v94
    v_mul_f32 v98, v6, v98
    v_cvt_pk_bf16_f32 v134, v94, v98
    v_mul_f32 v95, v6, v95
    v_mul_f32 v99, v6, v99
    v_cvt_pk_bf16_f32 v135, v95, v99
    s_add_u32 s17, s48, 4096
    buffer_store_dwordx4 v[132:135], v0, s[8:11], s17 offen offset:1024 sc1
    s_add_u32 s46, s51, 33558528
    buffer_load_dwordx4 v[220:223], v0, s[28:31], s46 offen offset:0
    v_mul_f32 v100, v6, v100
    v_mul_f32 v104, v6, v104
    v_cvt_pk_bf16_f32 v136, v100, v104
    v_mul_f32 v101, v6, v101
    v_mul_f32 v105, v6, v105
    v_cvt_pk_bf16_f32 v137, v101, v105
    v_mul_f32 v102, v6, v102
    v_mul_f32 v106, v6, v106
    v_cvt_pk_bf16_f32 v138, v102, v106
    v_mul_f32 v103, v6, v103
    v_mul_f32 v107, v6, v107
    v_cvt_pk_bf16_f32 v139, v103, v107
    buffer_store_dwordx4 v[136:139], v0, s[8:11], s17 offen offset:3072 sc1
    buffer_load_dwordx4 v[224:227], v0, s[28:31], s46 offen offset:1024
    buffer_load_dwordx4 v[228:231], v0, s[28:31], s46 offen offset:2048
    buffer_load_dwordx4 v[232:235], v0, s[28:31], s46 offen offset:3072
    s_add_u32 s48, s48, 262144
    s_mov_b32 s49, 22528
    s_mov_b32 s66, 0
    s_cmp_ge_u32 s37, 64
    s_cbranch_scc1 LtaS_end
    s_branch LtaS0
LtaS_end:
    s_waitcnt vmcnt(0)
    s_and_b32 s17, s49, s66
    s_cselect_b64 exec, 1, 0
    buffer_store_dword v3, v4, s[8:11], s43 offen
    s_andn2_b32 s17, s49, s66
    s_cselect_b64 exec, 1, 0
    buffer_store_dword v3, v4, s[8:11], s43 offen sc1
    s_mov_b64 exec, -1
    s_add_u32 s43, s43, s49
    s_mov_b32 s49, 0
    s_branch L_role_ta_exit
L_role_ta_abort:
    s_waitcnt lgkmcnt(0)
    s_mov_b64 exec, -1
    v_mov_b32 v0, 60
    s_lshl_b32 s5, s3, 8
    s_or_b32 s5, s5, s4
    s_or_b32 s5, s5, 0x10000
    v_mov_b32 v1, s5
    global_store_dword v0, v1, s[12:13]
    s_endpgm
L_role_ta_exit:
    s_and_b32 s6, s15, 7
    s_add_u32 s6, s6, s14
    s_cmp_lg_u32 s6, 0
    s_cbranch_scc1 L_role_ta_nowb
    s_waitcnt vmcnt(0)
    buffer_wbl2 sc1
    s_waitcnt vmcnt(0)
L_role_ta_nowb:
    s_endpgm
.p2align 6
L_role_r:
    s_mov_b32 s32, s3
    s_mov_b32 s15, s4
    v_and_b32 v10, 63, v0
    v_and_b32 v60, 15, v10
    v_lshrrev_b32 v61, 4, v10
    v_lshlrev_b32 v0, 4, v10
    v_lshlrev_b32 v8, 2, v10
    s_mul_i32 s17, s14, 26624
    s_add_u32 s17, s17, 57344
    v_add_u32 v9, s17, v0
    s_mov_b32 s54, 0xfffffffe
    s_mov_b32 s46, 0x3e0293ee
    s_mov_b32 s47, 0x3e0293ee
    s_mov_b32 s50, 0x00ff00ff
    s_mov_b32 s51, 0x00ff00ff
    s_mov_b32 s52, -1
    s_mov_b32 s53, 0
    s_mov_b32 s68, 0x3f803f80
    s_mov_b32 s69, 0x3f803f80
    s_mov_b32 s39, 0
    v_lshrrev_b32 v63, 2, v60
    v_and_b32 v64, 1, v60
    v_lshl_add_u32 v62, v63, 1, v64
    v_bfe_u32 v65, v60, 1, 1
    v_mov_b32 v1, 0x4444
    v_mov_b32 v63, 0xeeee
    v_cmp_eq_u32 vcc, 0, v65
    s_nop 1
    v_cndmask_b32 v1, v63, v1, vcc
    v_mul_u32_u24 v63, 576, v61
    v_lshl_add_u32 v2, v60, 2, v63
    s_lshl_b32 s17, s14, 6
    v_add_u32 v2, s17, v2
    v_mul_u32_u24 v63, 288, v62
    v_lshl_add_u32 v3, v61, 4, v63
    v_lshl_add_u32 v4, v61, 5, v63
    v_lshl_add_u32 v4, v65, 4, v4
    s_cmp_eq_u32 s32, 0
    s_cbranch_scc1 Lr_noord
    s_cmp_lg_u32 s14, 0
    s_cbranch_scc1 Lr_ord_d
    v_mov_b32 v63, 48
    s_mov_b32 s16, 0
Lr_ord:
    global_load_dword v64, v63, s[12:13] sc1
    s_add_u32 s16, s16, 1
    s_cmp_gt_u32 s16, 100000
    s_cbranch_scc1 Lr_abort
    s_waitcnt vmcnt(0)
    v_cmp_gt_u32 vcc, 16, v64
    s_nop 0
    s_cbranch_vccz Lr_ord_d
    s_sleep 32
    s_branch Lr_ord
Lr_ord_d:
    s_barrier
Lr_noord:
    s_load_dwordx2 s[20:21], s[0:1], 40
    s_mov_b32 s22, 4718592
    s_mov_b32 s23, 0x00020000
    s_waitcnt lgkmcnt(0)
    s_and_b32 s21, s21, 0xffff
    s_load_dwordx2 s[24:25], s[0:1], 48
    s_mov_b32 s26, 4718592
    s_mov_b32 s27, 0x00020000
    s_waitcnt lgkmcnt(0)
    s_and_b32 s25, s25, 0xffff
    s_load_dwordx2 s[28:29], s[0:1], 56
    s_mov_b32 s30, 4718592
    s_mov_b32 s31, 0x00020000
    s_waitcnt lgkmcnt(0)
    s_and_b32 s29, s29, 0xffff
    s_load_dwordx2 s[80:81], s[0:1], 64
    s_mov_b32 s82, 4718592
    s_mov_b32 s83, 0x00020000
    s_waitcnt lgkmcnt(0)
    s_and_b32 s81, s81, 0xffff
    v_lshlrev_b32 v71, 1, v61
    v_xor_b32 v71, v71, v60
    v_lshlrev_b32 v71, 4, v71
    v_lshl_add_u32 v62, v61, 13, v71
    v_xor_b32 v63, 128, v62
    v_lshrrev_b32 v64, 1, v61
    v_lshlrev_b32 v64, 3, v64
    v_and_b32 v65, 1, v61
    v_lshl_add_u32 v64, v65, 2, v64
    v_lshl_add_u32 v64, v64, 13, v71
    v_xor_b32 v65, 128, v64
    s_mul_i32 s57, s14, 1179648
    s_lshl_b32 s17, s15, 8
    s_add_u32 s57, s57, s17
    s_lshl_b32 s58, s14, 12
    v_lshrrev_b32 v71, 2, v60
    v_lshl_add_u32 v66, v61, 3, v71
    v_lshlrev_b32 v66, 8, v66
    v_bfe_u32 v67, v60, 1, 1
    s_lshl_b32 s17, s14, 2
    v_add_u32 v67, s17, v67
    v_lshlrev_b32 v71, 1, v71
    v_xor_b32 v67, v67, v71
    v_and_b32 v71, 1, v61
    v_lshlrev_b32 v71, 3, v71
    v_xor_b32 v67, v67, v71
    v_and_b32 v71, 1, v60
    v_lshl_add_u32 v66, v71, 3, v66
    v_xor_b32 v71, 2, v67
    v_lshl_add_u32 v67, v71, 4, v66
    v_xor_b32 v71, 2, v71
    v_lshl_add_u32 v66, v71, 4, v66
    v_lshrrev_b32 v71, 2, v60
    v_lshl_add_u32 v70, v61, 2, v71
    v_mul_u32_u24 v70, 1152, v70
    v_and_b32 v71, 3, v60
    v_lshl_add_u32 v70, v71, 3, v70
    s_mul_i32 s17, s14, 288
    v_add_u32 v70, s17, v70
    v_add_u32 v71, 0, v10
    v_mul_u32_u24 v59, 911, v71
    v_lshrrev_b32 v59, 16, v59
    v_mul_u32_u24 v60, 72, v59
    v_sub_u32 v71, v71, v60
    v_and_b32 v60, 1, v59
    v_lshlrev_b32 v60, 4, v60
    v_lshrrev_b32 v59, 1, v59
    v_lshl_add_u32 v60, v59, 2, v60
    v_mul_u32_u24 v60, 1152, v60
    v_lshl_add_u32 v50, v71, 4, v60
    v_add_u32 v71, 64, v10
    v_mul_u32_u24 v59, 911, v71
    v_lshrrev_b32 v59, 16, v59
    v_mul_u32_u24 v60, 72, v59
    v_sub_u32 v71, v71, v60
    v_and_b32 v60, 1, v59
    v_lshlrev_b32 v60, 4, v60
    v_lshrrev_b32 v59, 1, v59
    v_lshl_add_u32 v60, v59, 2, v60
    v_mul_u32_u24 v60, 1152, v60
    v_lshl_add_u32 v51, v71, 4, v60
    v_add_u32 v71, 128, v10
    v_mul_u32_u24 v59, 911, v71
    v_lshrrev_b32 v59, 16, v59
    v_mul_u32_u24 v60, 72, v59
    v_sub_u32 v71, v71, v60
    v_and_b32 v60, 1, v59
    v_lshlrev_b32 v60, 4, v60
    v_lshrrev_b32 v59, 1, v59
    v_lshl_add_u32 v60, v59, 2, v60
    v_mul_u32_u24 v60, 1152, v60
    v_lshl_add_u32 v52, v71, 4, v60
    v_add_u32 v71, 192, v10
    v_mul_u32_u24 v59, 911, v71
    v_lshrrev_b32 v59, 16, v59
    v_mul_u32_u24 v60, 72, v59
    v_sub_u32 v71, v71, v60
    v_and_b32 v60, 1, v59
    v_lshlrev_b32 v60, 4, v60
    v_lshrrev_b32 v59, 1, v59
    v_lshl_add_u32 v60, v59, 2, v60
    v_mul_u32_u24 v60, 1152, v60
    v_lshl_add_u32 v53, v71, 4, v60
    v_add_u32 v71, 256, v10
    v_mul_u32_u24 v59, 911, v71
    v_lshrrev_b32 v59, 16, v59
    v_mul_u32_u24 v60, 72, v59
    v_sub_u32 v71, v71, v60
    v_and_b32 v60, 1, v59
    v_lshlrev_b32 v60, 4, v60
    v_lshrrev_b32 v59, 1, v59
    v_lshl_add_u32 v60, v59, 2, v60
    v_mul_u32_u24 v60, 1152, v60
    v_lshl_add_u32 v54, v71, 4, v60
    s_lshr_b32 s17, s14, 1
    s_lshl_b32 s17, s17, 3
    s_and_b32 s18, s14, 1
    s_lshl_b32 s18, s18, 1
    s_add_u32 s17, s17, s18
    s_lshl_b32 s18, s15, 7
    s_add_u32 s17, s17, s18
    s_mul_i32 s59, s17, 1152
    s_mul_i32 s60, s14, 4608
    s_add_u32 m0, s58, 49152
    s_add_u32 s17, s57, 0
    buffer_load_dwordx4 v62, s[20:23], s17 offen lds
    s_add_u32 m0, s58, 50176
    s_add_u32 s17, s57, 32768
    buffer_load_dwordx4 v62, s[20:23], s17 offen lds
    s_add_u32 m0, s58, 51200
    s_add_u32 s17, s57, 65536
    buffer_load_dwordx4 v63, s[20:23], s17 offen lds
    s_add_u32 m0, s58, 52224
    s_add_u32 s17, s57, 98304
    buffer_load_dwordx4 v63, s[20:23], s17 offen lds
    s_add_u32 m0, s58, 65536
    s_add_u32 s17, s57, 0
    buffer_load_dwordx4 v62, s[24:27], s17 offen lds
    s_add_u32 m0, s58, 66560
    s_add_u32 s17, s57, 32768
    buffer_load_dwordx4 v62, s[24:27], s17 offen lds
    s_add_u32 m0, s58, 67584
    s_add_u32 s17, s57, 65536
    buffer_load_dwordx4 v63, s[24:27], s17 offen lds
    s_add_u32 m0, s58, 68608
    s_add_u32 s17, s57, 98304
    buffer_load_dwordx4 v63, s[24:27], s17 offen lds
    s_add_u32 m0, s58, 81920
    s_add_u32 s17, s57, 0
    buffer_load_dwordx4 v62, s[28:31], s17 offen lds
    s_add_u32 m0, s58, 82944
    s_add_u32 s17, s57, 32768
    buffer_load_dwordx4 v62, s[28:31], s17 offen lds
    s_add_u32 m0, s58, 83968
    s_add_u32 s17, s57, 65536
    buffer_load_dwordx4 v63, s[28:31], s17 offen lds
    s_add_u32 m0, s58, 84992
    s_add_u32 s17, s57, 98304
    buffer_load_dwordx4 v63, s[28:31], s17 offen lds
    s_add_u32 m0, s58, 98304
    s_add_u32 s17, s57, 131072
    buffer_load_dwordx4 v62, s[20:23], s17 offen lds
    s_add_u32 m0, s58, 99328
    s_add_u32 s17, s57, 163840
    buffer_load_dwordx4 v62, s[20:23], s17 offen lds
    s_add_u32 m0, s58, 100352
    s_add_u32 s17, s57, 196608
    buffer_load_dwordx4 v63, s[20:23], s17 offen lds
    s_add_u32 m0, s58, 101376
    s_add_u32 s17, s57, 229376
    buffer_load_dwordx4 v63, s[20:23], s17 offen lds
    s_add_u32 m0, s58, 114688
    s_add_u32 s17, s57, 131072
    buffer_load_dwordx4 v62, s[24:27], s17 offen lds
    s_add_u32 m0, s58, 115712
    s_add_u32 s17, s57, 163840
    buffer_load_dwordx4 v62, s[24:27], s17 offen lds
    s_add_u32 m0, s58, 116736
    s_add_u32 s17, s57, 196608
    buffer_load_dwordx4 v63, s[24:27], s17 offen lds
    s_add_u32 m0, s58, 117760
    s_add_u32 s17, s57, 229376
    buffer_load_dwordx4 v63, s[24:27], s17 offen lds
    s_add_u32 m0, s58, 131072
    s_add_u32 s17, s57, 131072
    buffer_load_dwordx4 v62, s[28:31], s17 offen lds
    s_add_u32 m0, s58, 132096
    s_add_u32 s17, s57, 163840
    buffer_load_dwordx4 v62, s[28:31], s17 offen lds
    s_add_u32 m0, s58, 133120
    s_add_u32 s17, s57, 196608
    buffer_load_dwordx4 v63, s[28:31], s17 offen lds
    s_add_u32 m0, s58, 134144
    s_add_u32 s17, s57, 229376
    buffer_load_dwordx4 v63, s[28:31], s17 offen lds
    s_add_u32 m0, s58, 147456
    s_add_u32 s17, s57, 262144
    buffer_load_dwordx4 v62, s[20:23], s17 offen lds
    s_add_u32 m0, s58, 148480
    s_add_u32 s17, s57, 294912
    buffer_load_dwordx4 v62, s[20:23], s17 offen lds
    s_add_u32 m0, s58, 149504
    s_add_u32 s17, s57, 327680
    buffer_load_dwordx4 v63, s[20:23], s17 offen lds
    s_add_u32 m0, s58, 150528
    s_add_u32 s17, s57, 360448
    buffer_load_dwordx4 v63, s[20:23], s17 offen lds
    s_add_u32 m0, s58, 0
    s_add_u32 s17, s57, 262144
    buffer_load_dwordx4 v62, s[24:27], s17 offen lds
    s_add_u32 m0, s58, 1024
    s_add_u32 s17, s57, 294912
    buffer_load_dwordx4 v62, s[24:27], s17 offen lds
    s_add_u32 m0, s58, 2048
    s_add_u32 s17, s57, 327680
    buffer_load_dwordx4 v63, s[24:27], s17 offen lds
    s_add_u32 m0, s58, 3072
    s_add_u32 s17, s57, 360448
    buffer_load_dwordx4 v63, s[24:27], s17 offen lds
    s_add_u32 m0, s58, 16384
    s_add_u32 s17, s57, 262144
    buffer_load_dwordx4 v62, s[28:31], s17 offen lds
    s_add_u32 m0, s58, 17408
    s_add_u32 s17, s57, 294912
    buffer_load_dwordx4 v62, s[28:31], s17 offen lds
    s_add_u32 m0, s58, 18432
    s_add_u32 s17, s57, 327680
    buffer_load_dwordx4 v63, s[28:31], s17 offen lds
    s_add_u32 m0, s58, 19456
    s_add_u32 s17, s57, 360448
    buffer_load_dwordx4 v63, s[28:31], s17 offen lds
    v_and_b32 v12, 15, v10
    v_lshrrev_b32 v13, 4, v10
    s_lshr_b32 s84, s15, 3
    s_bfe_u32 s85, s15, 0x20001
    s_and_b32 s86, s15, 1
    s_cmp_lt_u32 s14, 2
    s_cbranch_scc1 Lr_jab
    s_lshr_b32 s84, s15, 1
    s_and_b32 s84, s84, 3
Lr_jab:
    s_cmp_lt_u32 s15, 8
    s_cselect_b32 s62, 1, 0
    v_bfe_u32 v20, v12, 2, 1
    v_lshl_add_u32 v17, v20, 2, v13
    v_mul_u32_u24 v17, 12288, v17
    v_lshrrev_b32 v21, 3, v12
    v_lshlrev_b32 v21, 2, v21
    v_and_b32 v20, 3, v12
    v_add_u32 v21, v21, v20
    v_lshl_add_u32 v6, v21, 4, v17
    s_mul_i32 s17, s84, 2304
    s_lshl_b32 s18, s14, 10
    s_add_u32 s17, s17, s18
    s_lshl_b32 s18, s86, 7
    s_add_u32 s17, s17, s18
    s_lshl_b32 s18, s85, 8
    s_cmp_lt_u32 s14, 2
    s_cselect_b32 s18, s18, 0
    s_add_u32 s17, s17, s18
    v_add_u32 v6, s17, v6
    v_bfe_u32 v24, v12, 1, 2
    v_and_b32 v25, 1, v12
    v_lshrrev_b32 v26, 1, v13
    v_and_b32 v27, 1, v13
    s_cmp_lt_u32 s14, 2
    s_cbranch_scc0 Lr_jc
    s_lshl_b32 s17, s14, 2
    v_add_u32 v18, s17, v24
    v_lshlrev_b32 v7, 10, v18
    v_lshl_add_u32 v19, v27, 1, v25
    s_lshl_b32 s17, s84, 4
    s_lshl_b32 s18, s85, 2
    s_add_u32 s17, s17, s18
    v_add_u32 v19, s17, v19
    v_lshl_add_u32 v7, v19, 4, v7
    s_lshl_b32 s17, s86, 1
    v_add_u32 v19, s17, v26
    v_lshl_add_u32 v7, v19, 2, v7
    s_lshl_b32 s17, s85, 1
    v_add_u32 v19, s17, v25
    v_mul_u32_u24 v19, 576, v19
    v_lshl_add_u32 v19, v18, 4, v19
    v_lshl_add_u32 v19, v13, 1, v19
    s_mul_i32 s17, s84, 144
    s_lshl_b32 s18, s86, 3
    s_add_u32 s17, s17, s18
    v_add_u32 v19, s17, v19
    v_lshlrev_b32 v14, 1, v19
    v_add_u32 v15, 2, v14
    s_branch Lr_jd
Lr_jc:
    s_lshl_b32 s17, s86, 1
    v_add_u32 v18, s17, v26
    v_lshlrev_b32 v19, 2, v18
    v_lshl_add_u32 v19, v27, 1, v19
    v_add_u32 v19, v19, v25
    s_lshl_b32 s17, s84, 4
    v_add_u32 v19, s17, v19
    v_lshlrev_b32 v7, 4, v19
    v_lshl_add_u32 v7, v24, 2, v7
    v_add_u32 v7, 8192, v7
    v_lshl_add_u32 v19, v18, 1, v25
    v_mul_u32_u24 v19, 576, v19
    v_lshl_add_u32 v19, v27, 3, v19
    v_add_u32 v19, v19, v24
    s_mul_i32 s17, s84, 144
    s_add_u32 s17, s17, 128
    v_add_u32 v19, s17, v19
    v_lshlrev_b32 v14, 1, v19
    v_add_u32 v15, 8, v14
Lr_jd:
    s_mul_i32 s48, s32, 1048576
    s_add_u32 s48, s48, 4194304
    s_lshl_b32 s18, s14, 11
    s_lshl_b32 s19, s14, 8
    s_add_u32 s19, s19, 8192
    s_mul_i32 s17, s15, 12288
    s_add_u32 s17, s17, s48
    s_mul_i32 s38, s14, 2304
    s_add_u32 s38, s38, s17
    s_add_u32 s37, s48, 983040
    s_xor_b32 s36, s37, 16384
    s_add_u32 s34, s37, s18
    s_add_u32 s35, s37, s19
    s_mul_i32 s17, s32, 50331648
    s_lshl_b32 s19, s15, 13
    s_add_u32 s17, s17, s19
    s_add_u32 s40, s17, 61079552
    s_add_u32 s17, s17, s18
    s_add_u32 s41, s17, 60817408
    s_add_u32 s42, s17, 77594624
    s_mul_i32 s17, s32, 1048576
    s_lshl_b32 s19, s15, 12
    s_add_u32 s17, s17, s19
    s_lshl_b32 s19, s14, 9
    s_add_u32 s17, s17, s19
    s_add_u32 s45, s17, 27262976
    s_mov_b32 s43, s45
    s_mov_b32 s66, 0
    s_mov_b32 s67, 1464320
    s_mov_b32 s78, 0xff
    s_mov_b32 s79, 0
    s_mul_i32 s17, s32, 1441792
    s_lshl_b32 s19, s15, 9
    s_add_u32 s17, s17, s19
    s_add_u32 s44, s17, 185600
    s_mov_b32 s33, 0
    s_load_dwordx2 s[88:89], s[0:1], 32
    s_mov_b32 s90, 9216
    s_mov_b32 s91, 0x00020000
    s_waitcnt lgkmcnt(0)
    s_and_b32 s89, s89, 0xffff
    s_cmp_eq_u32 s14, 3
    s_cbranch_scc1 Lr_mem0_done
    s_cmp_lt_u32 s14, 2
    s_cselect_b32 s17, 1, s62
    s_cmp_eq_u32 s17, 0
    s_cbranch_scc1 Lr_mem0_done
    s_mov_b64 exec, s[50:51]
    buffer_load_ushort v20, v14, s[88:91], 0 offen
    buffer_load_ushort v21, v15, s[88:91], 0 offen
    s_waitcnt vmcnt(0)
    v_lshl_or_b32 v20, v21, 16, v20
    v_min_u32 v20, s54, v20
    buffer_store_dword v20, v7, s[8:11], s37 offen sc1
    v_mov_b32 v20, -1
    buffer_store_dword v20, v7, s[8:11], s36 offen sc1
    s_mov_b64 exec, -1
Lr_mem0_done:
    v_mov_b32 v20, 1
    v_mov_b32 v21, 1
    v_mov_b32 v22, 1
    v_mov_b32 v23, 1
    s_xor_b32 s17, s38, 524288
    buffer_store_dwordx4 v[20:23], v0, s[8:11], s38 offen offset:0 sc1
    buffer_store_dwordx4 v[20:23], v0, s[8:11], s38 offen offset:1024 sc1
    buffer_store_dword v20, v8, s[8:11], s38 offen offset:2048 sc1
    buffer_store_dwordx4 v[20:23], v0, s[8:11], s17 offen offset:0 sc1
    buffer_store_dwordx4 v[20:23], v0, s[8:11], s17 offen offset:1024 sc1
    buffer_store_dword v20, v8, s[8:11], s17 offen offset:2048 sc1
    v_lshrrev_b32 v17, 1, v0
    s_mov_b32 s17, s45
    buffer_store_dwordx2 v[20:21], v17, s[8:11], s17 offen offset:2048 sc1
    s_mov_b64 exec, s[52:53]
    buffer_store_dwordx4 v[20:23], v0, s[8:11], s17 offen sc1
    s_mov_b64 exec, -1
    s_add_u32 s17, s17, 131072
    buffer_store_dwordx2 v[20:21], v17, s[8:11], s17 offen offset:2048 sc1
    s_mov_b64 exec, s[52:53]
    buffer_store_dwordx4 v[20:23], v0, s[8:11], s17 offen sc1
    s_mov_b64 exec, -1
    s_add_u32 s17, s17, 131072
    buffer_store_dwordx2 v[20:21], v17, s[8:11], s17 offen offset:2048 sc1
    s_mov_b64 exec, s[52:53]
    buffer_store_dwordx4 v[20:23], v0, s[8:11], s17 offen sc1
    s_mov_b64 exec, -1
    s_add_u32 s17, s17, 131072
    buffer_store_dwordx2 v[20:21], v17, s[8:11], s17 offen offset:2048 sc1
    s_mov_b64 exec, s[52:53]
    buffer_store_dwordx4 v[20:23], v0, s[8:11], s17 offen sc1
    s_mov_b64 exec, -1
    s_add_u32 s17, s17, 131072
    buffer_store_dwordx2 v[20:21], v17, s[8:11], s17 offen offset:2048 sc1
    s_mov_b64 exec, s[52:53]
    buffer_store_dwordx4 v[20:23], v0, s[8:11], s17 offen sc1
    s_mov_b64 exec, -1
    s_add_u32 s17, s17, 131072
    buffer_store_dwordx2 v[20:21], v17, s[8:11], s17 offen offset:2048 sc1
    s_mov_b64 exec, s[52:53]
    buffer_store_dwordx4 v[20:23], v0, s[8:11], s17 offen sc1
    s_mov_b64 exec, -1
    s_add_u32 s17, s17, 131072
    buffer_store_dwordx2 v[20:21], v17, s[8:11], s17 offen offset:2048 sc1
    s_mov_b64 exec, s[52:53]
    buffer_store_dwordx4 v[20:23], v0, s[8:11], s17 offen sc1
    s_mov_b64 exec, -1
    s_add_u32 s17, s17, 131072
    buffer_store_dwordx2 v[20:21], v17, s[8:11], s17 offen offset:2048 sc1
    s_mov_b64 exec, s[52:53]
    buffer_store_dwordx4 v[20:23], v0, s[8:11], s17 offen sc1
    s_mov_b64 exec, -1
    s_add_u32 s17, s17, 131072
    s_cmp_lg_u32 s14, 3
    s_cbranch_scc1 Lr_not_w3
    v_and_b32 v7, 12, v8
    v_and_b32 v17, 4, v10
    v_lshl_add_u32 v7, v17, 5, v7
    s_add_u32 s17, s44, 4294877568
    s_cmp_eq_u32 s32, 0
    s_cselect_b32 s67, s67, s17
    s_add_u32 s17, s44, 22656
    s_min_u32 s18, s17, s67
    s_sub_u32 s17, s17, s18
    v_add_u32 v7, s17, v7
    s_sub_u32 s17, s67, s18
    v_mov_b32 v17, s17
    v_cmp_gt_u32 vcc, 8, v10
    s_nop 1
    v_cndmask_b32 v7, v17, v7, vcc
    s_mov_b32 s67, s18
Lr_not_w3:
    v_lshlrev_b32 v5, 3, v0
    s_add_u32 s56, s40, 16777216
    s_waitcnt vmcnt(32)
    s_barrier
    s_cmp_lg_u32 s14, 0
    s_cbranch_scc1 Lr_noadd
    s_lshl_b32 s17, s32, 2
    s_add_u32 s17, s17, 192
    v_mov_b32 v48, s17
    v_mov_b32 v49, 1
    s_mov_b64 exec, 1
    global_atomic_add v48, v49, s[12:13]
    s_mov_b64 exec, -1
Lr_noadd:
    s_add_u32 m0, s58, 32768
    s_add_u32 s17, s57, 393216
    buffer_load_dwordx4 v62, s[20:23], s17 offen lds
    s_add_u32 m0, s58, 33792
    s_add_u32 s17, s57, 425984
    buffer_load_dwordx4 v62, s[20:23], s17 offen lds
    s_add_u32 m0, s58, 34816
    s_add_u32 s17, s57, 458752
    buffer_load_dwordx4 v63, s[20:23], s17 offen lds
    s_add_u32 m0, s58, 35840
    s_add_u32 s17, s57, 491520
    buffer_load_dwordx4 v63, s[20:23], s17 offen lds
    v_add_u32 v68, 49152, v66
    v_add_u32 v69, 49152, v67
    ds_read_b64_tr_b16 v[72:73], v68 offset:0
    ds_read_b64_tr_b16 v[74:75], v68 offset:1024
    ds_read_b64_tr_b16 v[76:77], v68 offset:8192
    ds_read_b64_tr_b16 v[78:79], v68 offset:9216
    ds_read_b64_tr_b16 v[80:81], v69 offset:0
    ds_read_b64_tr_b16 v[82:83], v69 offset:1024
    ds_read_b64_tr_b16 v[84:85], v69 offset:8192
    ds_read_b64_tr_b16 v[86:87], v69 offset:9216
    s_waitcnt lgkmcnt(0)
    s_waitcnt vmcnt(32)
    s_barrier
    s_add_u32 m0, s58, 49152
    s_add_u32 s17, s57, 393216
    buffer_load_dwordx4 v62, s[24:27], s17 offen lds
    s_add_u32 m0, s58, 50176
    s_add_u32 s17, s57, 425984
    buffer_load_dwordx4 v62, s[24:27], s17 offen lds
    s_add_u32 m0, s58, 51200
    s_add_u32 s17, s57, 458752
    buffer_load_dwordx4 v63, s[24:27], s17 offen lds
    s_add_u32 m0, s58, 52224
    s_add_u32 s17, s57, 491520
    buffer_load_dwordx4 v63, s[24:27], s17 offen lds
    v_add_u32 v68, 65536, v66
    v_add_u32 v69, 65536, v67
    ds_read_b64_tr_b16 v[88:89], v68 offset:0
    ds_read_b64_tr_b16 v[90:91], v68 offset:1024
    ds_read_b64_tr_b16 v[92:93], v68 offset:8192
    ds_read_b64_tr_b16 v[94:95], v68 offset:9216
    ds_read_b64_tr_b16 a[176:177], v69 offset:0
    ds_read_b64_tr_b16 a[178:179], v69 offset:1024
    ds_read_b64_tr_b16 a[180:181], v69 offset:8192
    ds_read_b64_tr_b16 a[182:183], v69 offset:9216
    s_waitcnt lgkmcnt(0)
    s_waitcnt vmcnt(32)
    s_barrier
    s_add_u32 m0, s58, 65536
    s_add_u32 s17, s57, 393216
    buffer_load_dwordx4 v62, s[28:31], s17 offen lds
    s_add_u32 m0, s58, 66560
    s_add_u32 s17, s57, 425984
    buffer_load_dwordx4 v62, s[28:31], s17 offen lds
    s_add_u32 m0, s58, 67584
    s_add_u32 s17, s57, 458752
    buffer_load_dwordx4 v63, s[28:31], s17 offen lds
    s_add_u32 m0, s58, 68608
    s_add_u32 s17, s57, 491520
    buffer_load_dwordx4 v63, s[28:31], s17 offen lds
    v_add_u32 v68, 81920, v66
    v_add_u32 v69, 81920, v67
    ds_read_b64_tr_b16 v[96:97], v68 offset:0
    ds_read_b64_tr_b16 v[98:99], v68 offset:1024
    ds_read_b64_tr_b16 v[100:101], v68 offset:8192
    ds_read_b64_tr_b16 v[102:103], v68 offset:9216
    ds_read_b64_tr_b16 v[104:105], v69 offset:0
    ds_read_b64_tr_b16 v[106:107], v69 offset:1024
    ds_read_b64_tr_b16 v[108:109], v69 offset:8192
    ds_read_b64_tr_b16 v[110:111], v69 offset:9216
    s_waitcnt lgkmcnt(0)
    s_waitcnt vmcnt(32)
    s_barrier
    s_add_u32 m0, s58, 81920
    s_add_u32 s17, s57, 524288
    buffer_load_dwordx4 v62, s[20:23], s17 offen lds
    s_add_u32 m0, s58, 82944
    s_add_u32 s17, s57, 557056
    buffer_load_dwordx4 v62, s[20:23], s17 offen lds
    s_add_u32 m0, s58, 83968
    s_add_u32 s17, s57, 589824
    buffer_load_dwordx4 v63, s[20:23], s17 offen lds
    s_add_u32 m0, s58, 84992
    s_add_u32 s17, s57, 622592
    buffer_load_dwordx4 v63, s[20:23], s17 offen lds
    v_add_u32 v68, 98304, v66
    v_add_u32 v69, 98304, v67
    ds_read_b64_tr_b16 v[112:113], v68 offset:0
    ds_read_b64_tr_b16 v[114:115], v68 offset:1024
    ds_read_b64_tr_b16 v[116:117], v68 offset:8192
    ds_read_b64_tr_b16 v[118:119], v68 offset:9216
    ds_read_b64_tr_b16 v[120:121], v69 offset:0
    ds_read_b64_tr_b16 v[122:123], v69 offset:1024
    ds_read_b64_tr_b16 v[124:125], v69 offset:8192
    ds_read_b64_tr_b16 v[126:127], v69 offset:9216
    s_waitcnt lgkmcnt(0)
    s_waitcnt vmcnt(32)
    s_barrier
    s_add_u32 m0, s58, 98304
    s_add_u32 s17, s57, 524288
    buffer_load_dwordx4 v62, s[24:27], s17 offen lds
    s_add_u32 m0, s58, 99328
    s_add_u32 s17, s57, 557056
    buffer_load_dwordx4 v62, s[24:27], s17 offen lds
    s_add_u32 m0, s58, 100352
    s_add_u32 s17, s57, 589824
    buffer_load_dwordx4 v63, s[24:27], s17 offen lds
    s_add_u32 m0, s58, 101376
    s_add_u32 s17, s57, 622592
    buffer_load_dwordx4 v63, s[24:27], s17 offen lds
    v_add_u32 v68, 114688, v66
    v_add_u32 v69, 114688, v67
    ds_read_b64_tr_b16 v[128:129], v68 offset:0
    ds_read_b64_tr_b16 v[130:131], v68 offset:1024
    ds_read_b64_tr_b16 v[132:133], v68 offset:8192
    ds_read_b64_tr_b16 v[134:135], v68 offset:9216
    ds_read_b64_tr_b16 a[184:185], v69 offset:0
    ds_read_b64_tr_b16 a[186:187], v69 offset:1024
    ds_read_b64_tr_b16 a[188:189], v69 offset:8192
    ds_read_b64_tr_b16 a[190:191], v69 offset:9216
    s_waitcnt lgkmcnt(0)
    s_waitcnt vmcnt(32)
    s_barrier
    s_add_u32 m0, s58, 114688
    s_add_u32 s17, s57, 524288
    buffer_load_dwordx4 v62, s[28:31], s17 offen lds
    s_add_u32 m0, s58, 115712
    s_add_u32 s17, s57, 557056
    buffer_load_dwordx4 v62, s[28:31], s17 offen lds
    s_add_u32 m0, s58, 116736
    s_add_u32 s17, s57, 589824
    buffer_load_dwordx4 v63, s[28:31], s17 offen lds
    s_add_u32 m0, s58, 117760
    s_add_u32 s17, s57, 622592
    buffer_load_dwordx4 v63, s[28:31], s17 offen lds
    v_add_u32 v68, 131072, v66
    v_add_u32 v69, 131072, v67
    ds_read_b64_tr_b16 v[136:137], v68 offset:0
    ds_read_b64_tr_b16 v[138:139], v68 offset:1024
    ds_read_b64_tr_b16 v[140:141], v68 offset:8192
    ds_read_b64_tr_b16 v[142:143], v68 offset:9216
    ds_read_b64_tr_b16 v[144:145], v69 offset:0
    ds_read_b64_tr_b16 v[146:147], v69 offset:1024
    ds_read_b64_tr_b16 v[148:149], v69 offset:8192
    ds_read_b64_tr_b16 v[150:151], v69 offset:9216
    s_waitcnt lgkmcnt(0)
    s_waitcnt vmcnt(32)
    s_barrier
    s_add_u32 m0, s58, 131072
    s_add_u32 s17, s57, 655360
    buffer_load_dwordx4 v62, s[20:23], s17 offen lds
    s_add_u32 m0, s58, 132096
    s_add_u32 s17, s57, 688128
    buffer_load_dwordx4 v62, s[20:23], s17 offen lds
    s_add_u32 m0, s58, 133120
    s_add_u32 s17, s57, 720896
    buffer_load_dwordx4 v63, s[20:23], s17 offen lds
    s_add_u32 m0, s58, 134144
    s_add_u32 s17, s57, 753664
    buffer_load_dwordx4 v63, s[20:23], s17 offen lds
    v_add_u32 v68, 147456, v66
    v_add_u32 v69, 147456, v67
    ds_read_b64_tr_b16 v[152:153], v68 offset:0
    ds_read_b64_tr_b16 v[154:155], v68 offset:1024
    ds_read_b64_tr_b16 v[156:157], v68 offset:8192
    ds_read_b64_tr_b16 v[158:159], v68 offset:9216
    ds_read_b64_tr_b16 v[160:161], v69 offset:0
    ds_read_b64_tr_b16 v[162:163], v69 offset:1024
    ds_read_b64_tr_b16 v[164:165], v69 offset:8192
    ds_read_b64_tr_b16 v[166:167], v69 offset:9216
    s_waitcnt lgkmcnt(0)
    s_waitcnt vmcnt(32)
    s_barrier
    s_add_u32 m0, s58, 147456
    s_add_u32 s17, s57, 655360
    buffer_load_dwordx4 v62, s[24:27], s17 offen lds
    s_add_u32 m0, s58, 148480
    s_add_u32 s17, s57, 688128
    buffer_load_dwordx4 v62, s[24:27], s17 offen lds
    s_add_u32 m0, s58, 149504
    s_add_u32 s17, s57, 720896
    buffer_load_dwordx4 v63, s[24:27], s17 offen lds
    s_add_u32 m0, s58, 150528
    s_add_u32 s17, s57, 753664
    buffer_load_dwordx4 v63, s[24:27], s17 offen lds
    v_add_u32 v68, 0, v66
    v_add_u32 v69, 0, v67
    ds_read_b64_tr_b16 v[168:169], v68 offset:0
    ds_read_b64_tr_b16 v[170:171], v68 offset:1024
    ds_read_b64_tr_b16 v[172:173], v68 offset:8192
    ds_read_b64_tr_b16 v[174:175], v68 offset:9216
    ds_read_b64_tr_b16 a[192:193], v69 offset:0
    ds_read_b64_tr_b16 a[194:195], v69 offset:1024
    ds_read_b64_tr_b16 a[196:197], v69 offset:8192
    ds_read_b64_tr_b16 a[198:199], v69 offset:9216
    s_waitcnt lgkmcnt(0)
    s_waitcnt vmcnt(32)
    s_barrier
    s_add_u32 m0, s58, 0
    s_add_u32 s17, s57, 655360
    buffer_load_dwordx4 v62, s[28:31], s17 offen lds
    s_add_u32 m0, s58, 1024
    s_add_u32 s17, s57, 688128
    buffer_load_dwordx4 v62, s[28:31], s17 offen lds
    s_add_u32 m0, s58, 2048
    s_add_u32 s17, s57, 720896
    buffer_load_dwordx4 v63, s[28:31], s17 offen lds
    s_add_u32 m0, s58, 3072
    s_add_u32 s17, s57, 753664
    buffer_load_dwordx4 v63, s[28:31], s17 offen lds
    v_add_u32 v68, 16384, v66
    v_add_u32 v69, 16384, v67
    ds_read_b64_tr_b16 v[176:177], v68 offset:0
    ds_read_b64_tr_b16 v[178:179], v68 offset:1024
    ds_read_b64_tr_b16 v[180:181], v68 offset:8192
    ds_read_b64_tr_b16 v[182:183], v68 offset:9216
    ds_read_b64_tr_b16 v[184:185], v69 offset:0
    ds_read_b64_tr_b16 v[186:187], v69 offset:1024
    ds_read_b64_tr_b16 v[188:189], v69 offset:8192
    ds_read_b64_tr_b16 v[190:191], v69 offset:9216
    s_waitcnt lgkmcnt(0)
    s_waitcnt vmcnt(32)
    s_barrier
    s_add_u32 m0, s58, 16384
    s_add_u32 s17, s57, 786432
    buffer_load_dwordx4 v62, s[20:23], s17 offen lds
    s_add_u32 m0, s58, 17408
    s_add_u32 s17, s57, 819200
    buffer_load_dwordx4 v62, s[20:23], s17 offen lds
    s_add_u32 m0, s58, 18432
    s_add_u32 s17, s57, 851968
    buffer_load_dwordx4 v63, s[20:23], s17 offen lds
    s_add_u32 m0, s58, 19456
    s_add_u32 s17, s57, 884736
    buffer_load_dwordx4 v63, s[20:23], s17 offen lds
    v_add_u32 v68, 32768, v66
    v_add_u32 v69, 32768, v67
    ds_read_b64_tr_b16 v[192:193], v68 offset:0
    ds_read_b64_tr_b16 v[194:195], v68 offset:1024
    ds_read_b64_tr_b16 v[196:197], v68 offset:8192
    ds_read_b64_tr_b16 v[198:199], v68 offset:9216
    ds_read_b64_tr_b16 v[200:201], v69 offset:0
    ds_read_b64_tr_b16 v[202:203], v69 offset:1024
    ds_read_b64_tr_b16 v[204:205], v69 offset:8192
    ds_read_b64_tr_b16 v[206:207], v69 offset:9216
    s_waitcnt lgkmcnt(0)
    s_waitcnt vmcnt(32)
    s_barrier
    s_add_u32 m0, s58, 32768
    s_add_u32 s17, s57, 786432
    buffer_load_dwordx4 v62, s[24:27], s17 offen lds
    s_add_u32 m0, s58, 33792
    s_add_u32 s17, s57, 819200
    buffer_load_dwordx4 v62, s[24:27], s17 offen lds
    s_add_u32 m0, s58, 34816
    s_add_u32 s17, s57, 851968
    buffer_load_dwordx4 v63, s[24:27], s17 offen lds
    s_add_u32 m0, s58, 35840
    s_add_u32 s17, s57, 884736
    buffer_load_dwordx4 v63, s[24:27], s17 offen lds
    v_add_u32 v68, 49152, v66
    v_add_u32 v69, 49152, v67
    ds_read_b64_tr_b16 v[208:209], v68 offset:0
    ds_read_b64_tr_b16 v[210:211], v68 offset:1024
    ds_read_b64_tr_b16 v[212:213], v68 offset:8192
    ds_read_b64_tr_b16 v[214:215], v68 offset:9216
    ds_read_b64_tr_b16 a[200:201], v69 offset:0
    ds_read_b64_tr_b16 a[202:203], v69 offset:1024
    ds_read_b64_tr_b16 a[204:205], v69 offset:8192
    ds_read_b64_tr_b16 a[206:207], v69 offset:9216
    s_waitcnt lgkmcnt(0)
    s_waitcnt vmcnt(32)
    s_barrier
    s_add_u32 m0, s58, 49152
    s_add_u32 s17, s57, 786432
    buffer_load_dwordx4 v62, s[28:31], s17 offen lds
    s_add_u32 m0, s58, 50176
    s_add_u32 s17, s57, 819200
    buffer_load_dwordx4 v62, s[28:31], s17 offen lds
    s_add_u32 m0, s58, 51200
    s_add_u32 s17, s57, 851968
    buffer_load_dwordx4 v63, s[28:31], s17 offen lds
    s_add_u32 m0, s58, 52224
    s_add_u32 s17, s57, 884736
    buffer_load_dwordx4 v63, s[28:31], s17 offen lds
    v_add_u32 v68, 65536, v66
    v_add_u32 v69, 65536, v67
    ds_read_b64_tr_b16 v[216:217], v68 offset:0
    ds_read_b64_tr_b16 v[218:219], v68 offset:1024
    ds_read_b64_tr_b16 v[220:221], v68 offset:8192
    ds_read_b64_tr_b16 v[222:223], v68 offset:9216
    ds_read_b64_tr_b16 v[224:225], v69 offset:0
    ds_read_b64_tr_b16 v[226:227], v69 offset:1024
    ds_read_b64_tr_b16 v[228:229], v69 offset:8192
    ds_read_b64_tr_b16 v[230:231], v69 offset:9216
    s_waitcnt lgkmcnt(0)
    s_waitcnt vmcnt(32)
    s_barrier
    s_add_u32 m0, s58, 65536
    s_add_u32 s17, s57, 917504
    buffer_load_dwordx4 v62, s[20:23], s17 offen lds
    s_add_u32 m0, s58, 66560
    s_add_u32 s17, s57, 950272
    buffer_load_dwordx4 v62, s[20:23], s17 offen lds
    s_add_u32 m0, s58, 67584
    s_add_u32 s17, s57, 983040
    buffer_load_dwordx4 v63, s[20:23], s17 offen lds
    s_add_u32 m0, s58, 68608
    s_add_u32 s17, s57, 1015808
    buffer_load_dwordx4 v63, s[20:23], s17 offen lds
    v_add_u32 v68, 81920, v66
    v_add_u32 v69, 81920, v67
    ds_read_b64_tr_b16 v[232:233], v68 offset:0
    ds_read_b64_tr_b16 v[234:235], v68 offset:1024
    ds_read_b64_tr_b16 v[236:237], v68 offset:8192
    ds_read_b64_tr_b16 v[238:239], v68 offset:9216
    ds_read_b64_tr_b16 v[240:241], v69 offset:0
    ds_read_b64_tr_b16 v[242:243], v69 offset:1024
    ds_read_b64_tr_b16 v[244:245], v69 offset:8192
    ds_read_b64_tr_b16 v[246:247], v69 offset:9216
    s_waitcnt lgkmcnt(0)
    s_waitcnt vmcnt(32)
    s_barrier
    s_add_u32 m0, s58, 81920
    s_add_u32 s17, s57, 917504
    buffer_load_dwordx4 v62, s[24:27], s17 offen lds
    s_add_u32 m0, s58, 82944
    s_add_u32 s17, s57, 950272
    buffer_load_dwordx4 v62, s[24:27], s17 offen lds
    s_add_u32 m0, s58, 83968
    s_add_u32 s17, s57, 983040
    buffer_load_dwordx4 v63, s[24:27], s17 offen lds
    s_add_u32 m0, s58, 84992
    s_add_u32 s17, s57, 1015808
    buffer_load_dwordx4 v63, s[24:27], s17 offen lds
    v_add_u32 v68, 98304, v66
    v_add_u32 v69, 98304, v67
    ds_read_b64_tr_b16 v[248:249], v68 offset:0
    ds_read_b64_tr_b16 v[250:251], v68 offset:1024
    ds_read_b64_tr_b16 v[252:253], v68 offset:8192
    ds_read_b64_tr_b16 v[254:255], v68 offset:9216
    ds_read_b64_tr_b16 a[208:209], v69 offset:0
    ds_read_b64_tr_b16 a[210:211], v69 offset:1024
    ds_read_b64_tr_b16 a[212:213], v69 offset:8192
    ds_read_b64_tr_b16 a[214:215], v69 offset:9216
    s_waitcnt lgkmcnt(0)
    s_waitcnt vmcnt(32)
    s_barrier
    s_add_u32 m0, s58, 98304
    s_add_u32 s17, s57, 917504
    buffer_load_dwordx4 v62, s[28:31], s17 offen lds
    s_add_u32 m0, s58, 99328
    s_add_u32 s17, s57, 950272
    buffer_load_dwordx4 v62, s[28:31], s17 offen lds
    s_add_u32 m0, s58, 100352
    s_add_u32 s17, s57, 983040
    buffer_load_dwordx4 v63, s[28:31], s17 offen lds
    s_add_u32 m0, s58, 101376
    s_add_u32 s17, s57, 1015808
    buffer_load_dwordx4 v63, s[28:31], s17 offen lds
    v_add_u32 v68, 114688, v66
    v_add_u32 v69, 114688, v67
    ds_read_b64_tr_b16 a[0:1], v68 offset:0
    ds_read_b64_tr_b16 a[2:3], v68 offset:1024
    ds_read_b64_tr_b16 a[4:5], v68 offset:8192
    ds_read_b64_tr_b16 a[6:7], v68 offset:9216
    ds_read_b64_tr_b16 a[8:9], v69 offset:0
    ds_read_b64_tr_b16 a[10:11], v69 offset:1024
    ds_read_b64_tr_b16 a[12:13], v69 offset:8192
    ds_read_b64_tr_b16 a[14:15], v69 offset:9216
    s_waitcnt lgkmcnt(0)
    s_waitcnt vmcnt(32)
    s_barrier
    s_add_u32 m0, s58, 114688
    s_add_u32 s17, s57, 1048576
    buffer_load_dwordx4 v64, s[20:23], s17 offen lds
    s_add_u32 m0, s58, 115712
    s_add_u32 s17, s57, 1056768
    buffer_load_dwordx4 v64, s[20:23], s17 offen lds
    s_add_u32 m0, s58, 116736
    s_add_u32 s17, s57, 1064960
    buffer_load_dwordx4 v65, s[20:23], s17 offen lds
    s_add_u32 m0, s58, 117760
    s_add_u32 s17, s57, 1073152
    buffer_load_dwordx4 v65, s[20:23], s17 offen lds
    v_add_u32 v68, 131072, v66
    v_add_u32 v69, 131072, v67
    ds_read_b64_tr_b16 a[16:17], v68 offset:0
    ds_read_b64_tr_b16 a[18:19], v68 offset:1024
    ds_read_b64_tr_b16 a[20:21], v68 offset:8192
    ds_read_b64_tr_b16 a[22:23], v68 offset:9216
    ds_read_b64_tr_b16 a[24:25], v69 offset:0
    ds_read_b64_tr_b16 a[26:27], v69 offset:1024
    ds_read_b64_tr_b16 a[28:29], v69 offset:8192
    ds_read_b64_tr_b16 a[30:31], v69 offset:9216
    s_waitcnt lgkmcnt(0)
    s_waitcnt vmcnt(32)
    s_barrier
    s_add_u32 m0, s58, 131072
    s_add_u32 s17, s57, 1048576
    buffer_load_dwordx4 v64, s[24:27], s17 offen lds
    s_add_u32 m0, s58, 132096
    s_add_u32 s17, s57, 1056768
    buffer_load_dwordx4 v64, s[24:27], s17 offen lds
    s_add_u32 m0, s58, 133120
    s_add_u32 s17, s57, 1064960
    buffer_load_dwordx4 v65, s[24:27], s17 offen lds
    s_add_u32 m0, s58, 134144
    s_add_u32 s17, s57, 1073152
    buffer_load_dwordx4 v65, s[24:27], s17 offen lds
    v_add_u32 v68, 147456, v66
    v_add_u32 v69, 147456, v67
    ds_read_b64_tr_b16 a[32:33], v68 offset:0
    ds_read_b64_tr_b16 a[34:35], v68 offset:1024
    ds_read_b64_tr_b16 a[36:37], v68 offset:8192
    ds_read_b64_tr_b16 a[38:39], v68 offset:9216
    ds_read_b64_tr_b16 a[216:217], v69 offset:0
    ds_read_b64_tr_b16 a[218:219], v69 offset:1024
    ds_read_b64_tr_b16 a[220:221], v69 offset:8192
    ds_read_b64_tr_b16 a[222:223], v69 offset:9216
    s_waitcnt lgkmcnt(0)
    s_waitcnt vmcnt(32)
    s_barrier
    s_add_u32 m0, s58, 147456
    s_add_u32 s17, s57, 1048576
    buffer_load_dwordx4 v64, s[28:31], s17 offen lds
    s_add_u32 m0, s58, 148480
    s_add_u32 s17, s57, 1056768
    buffer_load_dwordx4 v64, s[28:31], s17 offen lds
    s_add_u32 m0, s58, 149504
    s_add_u32 s17, s57, 1064960
    buffer_load_dwordx4 v65, s[28:31], s17 offen lds
    s_add_u32 m0, s58, 150528
    s_add_u32 s17, s57, 1073152
    buffer_load_dwordx4 v65, s[28:31], s17 offen lds
    v_add_u32 v68, 0, v66
    v_add_u32 v69, 0, v67
    ds_read_b64_tr_b16 a[40:41], v68 offset:0
    ds_read_b64_tr_b16 a[42:43], v68 offset:1024
    ds_read_b64_tr_b16 a[44:45], v68 offset:8192
    ds_read_b64_tr_b16 a[46:47], v68 offset:9216
    ds_read_b64_tr_b16 a[48:49], v69 offset:0
    ds_read_b64_tr_b16 a[50:51], v69 offset:1024
    ds_read_b64_tr_b16 a[52:53], v69 offset:8192
    ds_read_b64_tr_b16 a[54:55], v69 offset:9216
    s_waitcnt lgkmcnt(0)
    s_waitcnt vmcnt(32)
    s_barrier
    v_add_u32 v68, 16384, v66
    v_add_u32 v69, 16384, v67
    ds_read_b64_tr_b16 a[56:57], v68 offset:0
    ds_read_b64_tr_b16 a[58:59], v68 offset:1024
    ds_read_b64_tr_b16 a[60:61], v68 offset:8192
    ds_read_b64_tr_b16 a[62:63], v68 offset:9216
    ds_read_b64_tr_b16 a[64:65], v69 offset:0
    ds_read_b64_tr_b16 a[66:67], v69 offset:1024
    ds_read_b64_tr_b16 a[68:69], v69 offset:8192
    ds_read_b64_tr_b16 a[70:71], v69 offset:9216
    s_waitcnt lgkmcnt(0)
    s_waitcnt vmcnt(28)
    s_barrier
    v_add_u32 v68, 32768, v66
    v_add_u32 v69, 32768, v67
    ds_read_b64_tr_b16 a[72:73], v68 offset:0
    ds_read_b64_tr_b16 a[74:75], v68 offset:1024
    ds_read_b64_tr_b16 a[76:77], v68 offset:8192
    ds_read_b64_tr_b16 a[78:79], v68 offset:9216
    ds_read_b64_tr_b16 a[224:225], v69 offset:0
    ds_read_b64_tr_b16 a[226:227], v69 offset:1024
    ds_read_b64_tr_b16 a[228:229], v69 offset:8192
    ds_read_b64_tr_b16 a[230:231], v69 offset:9216
    s_waitcnt lgkmcnt(0)
    s_waitcnt vmcnt(24)
    s_barrier
    v_add_u32 v68, 49152, v66
    v_add_u32 v69, 49152, v67
    ds_read_b64_tr_b16 a[80:81], v68 offset:0
    ds_read_b64_tr_b16 a[82:83], v68 offset:1024
    ds_read_b64_tr_b16 a[84:85], v68 offset:8192
    ds_read_b64_tr_b16 a[86:87], v68 offset:9216
    ds_read_b64_tr_b16 a[88:89], v69 offset:0
    ds_read_b64_tr_b16 a[90:91], v69 offset:1024
    ds_read_b64_tr_b16 a[92:93], v69 offset:8192
    ds_read_b64_tr_b16 a[94:95], v69 offset:9216
    s_waitcnt lgkmcnt(0)
    s_waitcnt vmcnt(20)
    s_barrier
    s_add_u32 s17, s59, 0
    s_add_u32 m0, s60, 0
    s_nop 0
    buffer_load_dwordx4 v50, s[80:83], s17 offen lds
    s_add_u32 m0, s60, 1024
    s_nop 0
    buffer_load_dwordx4 v51, s[80:83], s17 offen lds
    s_add_u32 m0, s60, 2048
    s_nop 0
    buffer_load_dwordx4 v52, s[80:83], s17 offen lds
    s_add_u32 m0, s60, 3072
    s_nop 0
    buffer_load_dwordx4 v53, s[80:83], s17 offen lds
    s_add_u32 m0, s60, 4096
    s_mov_b64 exec, s[52:53]
    buffer_load_dwordx4 v54, s[80:83], s17 offen lds
    s_mov_b64 exec, -1
    v_add_u32 v68, 65536, v66
    v_add_u32 v69, 65536, v67
    ds_read_b64_tr_b16 a[96:97], v68 offset:0
    ds_read_b64_tr_b16 a[98:99], v68 offset:1024
    ds_read_b64_tr_b16 a[100:101], v68 offset:8192
    ds_read_b64_tr_b16 a[102:103], v68 offset:9216
    ds_read_b64_tr_b16 a[104:105], v69 offset:0
    ds_read_b64_tr_b16 a[106:107], v69 offset:1024
    ds_read_b64_tr_b16 a[108:109], v69 offset:8192
    ds_read_b64_tr_b16 a[110:111], v69 offset:9216
    s_waitcnt lgkmcnt(0)
    s_waitcnt vmcnt(21)
    s_barrier
    s_add_u32 s17, s59, 1152
    s_add_u32 m0, s60, 18432
    s_nop 0
    buffer_load_dwordx4 v50, s[80:83], s17 offen lds
    s_add_u32 m0, s60, 19456
    s_nop 0
    buffer_load_dwordx4 v51, s[80:83], s17 offen lds
    s_add_u32 m0, s60, 20480
    s_nop 0
    buffer_load_dwordx4 v52, s[80:83], s17 offen lds
    s_add_u32 m0, s60, 21504
    s_nop 0
    buffer_load_dwordx4 v53, s[80:83], s17 offen lds
    s_add_u32 m0, s60, 22528
    s_mov_b64 exec, s[52:53]
    buffer_load_dwordx4 v54, s[80:83], s17 offen lds
    s_mov_b64 exec, -1
    v_add_u32 v68, 81920, v66
    v_add_u32 v69, 81920, v67
    ds_read_b64_tr_b16 a[112:113], v68 offset:0
    ds_read_b64_tr_b16 a[114:115], v68 offset:1024
    ds_read_b64_tr_b16 a[116:117], v68 offset:8192
    ds_read_b64_tr_b16 a[118:119], v68 offset:9216
    ds_read_b64_tr_b16 a[232:233], v69 offset:0
    ds_read_b64_tr_b16 a[234:235], v69 offset:1024
    ds_read_b64_tr_b16 a[236:237], v69 offset:8192
    ds_read_b64_tr_b16 a[238:239], v69 offset:9216
    s_waitcnt lgkmcnt(0)
    s_waitcnt vmcnt(22)
    s_barrier
    s_add_u32 s17, s59, 36864
    s_add_u32 m0, s60, 36864
    s_nop 0
    buffer_load_dwordx4 v50, s[80:83], s17 offen lds
    s_add_u32 m0, s60, 37888
    s_nop 0
    buffer_load_dwordx4 v51, s[80:83], s17 offen lds
    s_add_u32 m0, s60, 38912
    s_nop 0
    buffer_load_dwordx4 v52, s[80:83], s17 offen lds
    s_add_u32 m0, s60, 39936
    s_nop 0
    buffer_load_dwordx4 v53, s[80:83], s17 offen lds
    s_add_u32 m0, s60, 40960
    s_mov_b64 exec, s[52:53]
    buffer_load_dwordx4 v54, s[80:83], s17 offen lds
    s_mov_b64 exec, -1
    v_add_u32 v68, 98304, v66
    v_add_u32 v69, 98304, v67
    ds_read_b64_tr_b16 a[120:121], v68 offset:0
    ds_read_b64_tr_b16 a[122:123], v68 offset:1024
    ds_read_b64_tr_b16 a[124:125], v68 offset:8192
    ds_read_b64_tr_b16 a[126:127], v68 offset:9216
    ds_read_b64_tr_b16 a[128:129], v69 offset:0
    ds_read_b64_tr_b16 a[130:131], v69 offset:1024
    ds_read_b64_tr_b16 a[132:133], v69 offset:8192
    ds_read_b64_tr_b16 a[134:135], v69 offset:9216
    s_waitcnt lgkmcnt(0)
    s_waitcnt vmcnt(23)
    s_barrier
    v_add_u32 v68, 114688, v66
    v_add_u32 v69, 114688, v67
    ds_read_b64_tr_b16 a[136:137], v68 offset:0
    ds_read_b64_tr_b16 a[138:139], v68 offset:1024
    ds_read_b64_tr_b16 a[140:141], v68 offset:8192
    ds_read_b64_tr_b16 a[142:143], v68 offset:9216
    ds_read_b64_tr_b16 a[144:145], v69 offset:0
    ds_read_b64_tr_b16 a[146:147], v69 offset:1024
    ds_read_b64_tr_b16 a[148:149], v69 offset:8192
    ds_read_b64_tr_b16 a[150:151], v69 offset:9216
    s_waitcnt lgkmcnt(0)
    s_waitcnt vmcnt(19)
    s_barrier
    v_add_u32 v68, 131072, v66
    v_add_u32 v69, 131072, v67
    ds_read_b64_tr_b16 a[152:153], v68 offset:0
    ds_read_b64_tr_b16 a[154:155], v68 offset:1024
    ds_read_b64_tr_b16 a[156:157], v68 offset:8192
    ds_read_b64_tr_b16 a[158:159], v68 offset:9216
    ds_read_b64_tr_b16 a[240:241], v69 offset:0
    ds_read_b64_tr_b16 a[242:243], v69 offset:1024
    ds_read_b64_tr_b16 a[244:245], v69 offset:8192
    ds_read_b64_tr_b16 a[246:247], v69 offset:9216
    s_waitcnt lgkmcnt(0)
    s_waitcnt vmcnt(15)
    s_barrier
    v_add_u32 v68, 147456, v66
    v_add_u32 v69, 147456, v67
    ds_read_b64_tr_b16 a[160:161], v68 offset:0
    ds_read_b64_tr_b16 a[162:163], v68 offset:1024
    ds_read_b64_tr_b16 a[164:165], v68 offset:8192
    ds_read_b64_tr_b16 a[166:167], v68 offset:9216
    ds_read_b64_tr_b16 a[168:169], v69 offset:0
    ds_read_b64_tr_b16 a[170:171], v69 offset:1024
    ds_read_b64_tr_b16 a[172:173], v69 offset:8192
    ds_read_b64_tr_b16 a[174:175], v69 offset:9216
    s_waitcnt lgkmcnt(0)
    s_barrier
    ds_write_b128 v9, a[176:179] offset:0
    ds_write_b128 v9, a[180:183] offset:1024
    ds_write_b128 v9, a[184:187] offset:2048
    ds_write_b128 v9, a[188:191] offset:3072
    ds_write_b128 v9, a[192:195] offset:4096
    ds_write_b128 v9, a[196:199] offset:5120
    ds_write_b128 v9, a[200:203] offset:6144
    ds_write_b128 v9, a[204:207] offset:7168
    ds_write_b128 v9, a[208:211] offset:8192
    ds_write_b128 v9, a[212:215] offset:9216
    ds_write_b128 v9, a[216:219] offset:10240
    ds_write_b128 v9, a[220:223] offset:11264
    ds_write_b128 v9, a[224:227] offset:12288
    ds_write_b128 v9, a[228:231] offset:13312
    ds_write_b128 v9, a[232:235] offset:14336
    ds_write_b128 v9, a[236:239] offset:15360
    ds_write_b128 v9, a[240:243] offset:16384
    ds_write_b128 v9, a[244:247] offset:17408
    s_waitcnt lgkmcnt(0)
    s_waitcnt vmcnt(10)
    s_barrier
    ds_read_b64_tr_b16 a[176:177], v70 offset:0
    ds_read_b64_tr_b16 a[192:193], v70 offset:32
    ds_read_b64_tr_b16 v[12:13], v70 offset:64
    ds_read_b64_tr_b16 a[208:209], v70 offset:96
    ds_read_b64_tr_b16 v[20:21], v70 offset:128
    ds_read_b64_tr_b16 a[224:225], v70 offset:160
    ds_read_b64_tr_b16 a[240:241], v70 offset:192
    ds_read_b64_tr_b16 v[28:29], v70 offset:224
    ds_read_b64_tr_b16 v[36:37], v70 offset:256
    s_waitcnt lgkmcnt(0)
    s_waitcnt vmcnt(5)
    s_barrier
    s_add_u32 s17, s59, 38016
    s_add_u32 m0, s60, 0
    s_nop 0
    buffer_load_dwordx4 v50, s[80:83], s17 offen lds
    s_add_u32 m0, s60, 1024
    s_nop 0
    buffer_load_dwordx4 v51, s[80:83], s17 offen lds
    s_add_u32 m0, s60, 2048
    s_nop 0
    buffer_load_dwordx4 v52, s[80:83], s17 offen lds
    s_add_u32 m0, s60, 3072
    s_nop 0
    buffer_load_dwordx4 v53, s[80:83], s17 offen lds
    s_add_u32 m0, s60, 4096
    s_mov_b64 exec, s[52:53]
    buffer_load_dwordx4 v54, s[80:83], s17 offen lds
    s_mov_b64 exec, -1
    ds_read_b64_tr_b16 a[178:179], v70 offset:18432
    ds_read_b64_tr_b16 a[194:195], v70 offset:18464
    ds_read_b64_tr_b16 v[14:15], v70 offset:18496
    ds_read_b64_tr_b16 a[210:211], v70 offset:18528
    ds_read_b64_tr_b16 v[22:23], v70 offset:18560
    ds_read_b64_tr_b16 a[226:227], v70 offset:18592
    ds_read_b64_tr_b16 a[242:243], v70 offset:18624
    ds_read_b64_tr_b16 v[30:31], v70 offset:18656
    ds_read_b64_tr_b16 v[38:39], v70 offset:18688
    s_waitcnt lgkmcnt(0)
    s_waitcnt vmcnt(5)
    s_barrier
    s_add_u32 s17, s59, 73728
    s_add_u32 m0, s60, 18432
    s_nop 0
    buffer_load_dwordx4 v50, s[80:83], s17 offen lds
    s_add_u32 m0, s60, 19456
    s_nop 0
    buffer_load_dwordx4 v51, s[80:83], s17 offen lds
    s_add_u32 m0, s60, 20480
    s_nop 0
    buffer_load_dwordx4 v52, s[80:83], s17 offen lds
    s_add_u32 m0, s60, 21504
    s_nop 0
    buffer_load_dwordx4 v53, s[80:83], s17 offen lds
    s_add_u32 m0, s60, 22528
    s_mov_b64 exec, s[52:53]
    buffer_load_dwordx4 v54, s[80:83], s17 offen lds
    s_mov_b64 exec, -1
    ds_read_b64_tr_b16 a[180:181], v70 offset:36864
    ds_read_b64_tr_b16 a[196:197], v70 offset:36896
    ds_read_b64_tr_b16 v[16:17], v70 offset:36928
    ds_read_b64_tr_b16 a[212:213], v70 offset:36960
    ds_read_b64_tr_b16 v[24:25], v70 offset:36992
    ds_read_b64_tr_b16 a[228:229], v70 offset:37024
    ds_read_b64_tr_b16 a[244:245], v70 offset:37056
    ds_read_b64_tr_b16 v[32:33], v70 offset:37088
    ds_read_b64_tr_b16 v[40:41], v70 offset:37120
    s_waitcnt lgkmcnt(0)
    s_waitcnt vmcnt(5)
    s_barrier
    s_add_u32 s17, s59, 74880
    s_add_u32 m0, s60, 36864
    s_nop 0
    buffer_load_dwordx4 v50, s[80:83], s17 offen lds
    s_add_u32 m0, s60, 37888
    s_nop 0
    buffer_load_dwordx4 v51, s[80:83], s17 offen lds
    s_add_u32 m0, s60, 38912
    s_nop 0
    buffer_load_dwordx4 v52, s[80:83], s17 offen lds
    s_add_u32 m0, s60, 39936
    s_nop 0
    buffer_load_dwordx4 v53, s[80:83], s17 offen lds
    s_add_u32 m0, s60, 40960
    s_mov_b64 exec, s[52:53]
    buffer_load_dwordx4 v54, s[80:83], s17 offen lds
    s_mov_b64 exec, -1
    ds_read_b64_tr_b16 a[182:183], v70 offset:0
    ds_read_b64_tr_b16 a[198:199], v70 offset:32
    ds_read_b64_tr_b16 v[18:19], v70 offset:64
    ds_read_b64_tr_b16 a[214:215], v70 offset:96
    ds_read_b64_tr_b16 v[26:27], v70 offset:128
    ds_read_b64_tr_b16 a[230:231], v70 offset:160
    ds_read_b64_tr_b16 a[246:247], v70 offset:192
    ds_read_b64_tr_b16 v[34:35], v70 offset:224
    ds_read_b64_tr_b16 v[42:43], v70 offset:256
    s_waitcnt lgkmcnt(0)
    ds_write_b128 v9, v[12:15] offset:18432
    ds_write_b128 v9, v[16:19] offset:19456
    ds_write_b128 v9, v[20:23] offset:20480
    ds_write_b128 v9, v[24:27] offset:21504
    ds_write_b128 v9, v[28:31] offset:22528
    ds_write_b128 v9, v[32:35] offset:23552
    ds_write_b128 v9, v[36:39] offset:24576
    ds_write_b128 v9, v[40:43] offset:25600
    s_waitcnt lgkmcnt(0)
    s_waitcnt vmcnt(5)
    s_barrier
    s_add_u32 s17, s59, 110592
    s_add_u32 m0, s60, 0
    s_nop 0
    buffer_load_dwordx4 v50, s[80:83], s17 offen lds
    s_add_u32 m0, s60, 1024
    s_nop 0
    buffer_load_dwordx4 v51, s[80:83], s17 offen lds
    s_add_u32 m0, s60, 2048
    s_nop 0
    buffer_load_dwordx4 v52, s[80:83], s17 offen lds
    s_add_u32 m0, s60, 3072
    s_nop 0
    buffer_load_dwordx4 v53, s[80:83], s17 offen lds
    s_add_u32 m0, s60, 4096
    s_mov_b64 exec, s[52:53]
    buffer_load_dwordx4 v54, s[80:83], s17 offen lds
    s_mov_b64 exec, -1
    ds_read_b64_tr_b16 a[184:185], v70 offset:18432
    ds_read_b64_tr_b16 v[12:13], v70 offset:18464
    ds_read_b64_tr_b16 a[200:201], v70 offset:18496
    ds_read_b64_tr_b16 a[216:217], v70 offset:18528
    ds_read_b64_tr_b16 v[20:21], v70 offset:18560
    ds_read_b64_tr_b16 a[232:233], v70 offset:18592
    ds_read_b64_tr_b16 v[28:29], v70 offset:18624
    ds_read_b64_tr_b16 a[248:249], v70 offset:18656
    ds_read_b64_tr_b16 v[36:37], v70 offset:18688
    s_waitcnt lgkmcnt(0)
    s_waitcnt vmcnt(5)
    s_barrier
    s_add_u32 s17, s59, 111744
    s_add_u32 m0, s60, 18432
    s_nop 0
    buffer_load_dwordx4 v50, s[80:83], s17 offen lds
    s_add_u32 m0, s60, 19456
    s_nop 0
    buffer_load_dwordx4 v51, s[80:83], s17 offen lds
    s_add_u32 m0, s60, 20480
    s_nop 0
    buffer_load_dwordx4 v52, s[80:83], s17 offen lds
    s_add_u32 m0, s60, 21504
    s_nop 0
    buffer_load_dwordx4 v53, s[80:83], s17 offen lds
    s_add_u32 m0, s60, 22528
    s_mov_b64 exec, s[52:53]
    buffer_load_dwordx4 v54, s[80:83], s17 offen lds
    s_mov_b64 exec, -1
    ds_read_b64_tr_b16 a[186:187], v70 offset:36864
    ds_read_b64_tr_b16 v[14:15], v70 offset:36896
    ds_read_b64_tr_b16 a[202:203], v70 offset:36928
    ds_read_b64_tr_b16 a[218:219], v70 offset:36960
    ds_read_b64_tr_b16 v[22:23], v70 offset:36992
    ds_read_b64_tr_b16 a[234:235], v70 offset:37024
    ds_read_b64_tr_b16 v[30:31], v70 offset:37056
    ds_read_b64_tr_b16 a[250:251], v70 offset:37088
    ds_read_b64_tr_b16 v[38:39], v70 offset:37120
    s_waitcnt lgkmcnt(0)
    s_waitcnt vmcnt(5)
    s_barrier
    ds_read_b64_tr_b16 a[188:189], v70 offset:0
    ds_read_b64_tr_b16 v[16:17], v70 offset:32
    ds_read_b64_tr_b16 a[204:205], v70 offset:64
    ds_read_b64_tr_b16 a[220:221], v70 offset:96
    ds_read_b64_tr_b16 v[24:25], v70 offset:128
    ds_read_b64_tr_b16 a[236:237], v70 offset:160
    ds_read_b64_tr_b16 v[32:33], v70 offset:192
    ds_read_b64_tr_b16 a[252:253], v70 offset:224
    ds_read_b64_tr_b16 v[40:41], v70 offset:256
    s_waitcnt lgkmcnt(0)
    s_waitcnt vmcnt(0)
    s_barrier
    ds_read_b64_tr_b16 a[190:191], v70 offset:18432
    ds_read_b64_tr_b16 v[18:19], v70 offset:18464
    ds_read_b64_tr_b16 a[206:207], v70 offset:18496
    ds_read_b64_tr_b16 a[222:223], v70 offset:18528
    ds_read_b64_tr_b16 v[26:27], v70 offset:18560
    ds_read_b64_tr_b16 a[238:239], v70 offset:18592
    ds_read_b64_tr_b16 v[34:35], v70 offset:18624
    ds_read_b64_tr_b16 a[254:255], v70 offset:18656
    ds_read_b64_tr_b16 v[42:43], v70 offset:18688
    s_waitcnt lgkmcnt(0)
    s_barrier
    s_lshl_b32 s17, s14, 13
    v_add_u32 v71, s17, v0
    ds_write_b128 v71, v[12:15] offset:24576
    ds_write_b128 v71, v[16:19] offset:25600
    ds_write_b128 v71, v[20:23] offset:26624
    ds_write_b128 v71, v[24:27] offset:27648
    ds_write_b128 v71, v[28:31] offset:28672
    ds_write_b128 v71, v[32:35] offset:29696
    ds_write_b128 v71, v[36:39] offset:30720
    ds_write_b128 v71, v[40:43] offset:31744
    s_waitcnt vmcnt(0) lgkmcnt(0)
    s_barrier
    s_add_u32 s17, s32, s14
    s_cmp_lg_u32 s17, 0
    s_cbranch_scc1 Lr_nold
    v_mov_b32 v63, 48
    v_mov_b32 v64, 1
    s_mov_b64 exec, 1
    global_atomic_add v63, v64, s[12:13]
    s_mov_b64 exec, -1
Lr_nold:
    s_add_u32 s57, s48, 0
    s_add_u32 s58, s48, 98304
    s_add_u32 s59, s48, 196608
    s_add_u32 s60, s48, 294912
    s_mov_b64 exec, 0xff
    v_lshlrev_b32 v12, 5, v8
    v_and_b32 v12, 128, v12
    v_lshrrev_b32 v13, 1, v8
    v_and_or_b32 v12, v13, 12, v12
    s_mov_b32 s16, 0
L_pure:
    global_load_dword v13, v12, s[12:13] sc1
    s_add_u32 s16, s16, 1
    s_cmp_gt_u32 s16, 100000
    s_cbranch_scc1 Lr_abort
    s_mov_b32 s6, 0
    s_waitcnt vmcnt(0)
    v_readlane_b32 s7, v13, 0
    s_nop 0
    s_add_u32 s6, s6, s7
    v_readlane_b32 s7, v13, 1
    s_nop 0
    s_add_u32 s6, s6, s7
    v_readlane_b32 s7, v13, 2
    s_nop 0
    s_add_u32 s6, s6, s7
    v_readlane_b32 s7, v13, 3
    s_nop 0
    s_add_u32 s6, s6, s7
    v_readlane_b32 s7, v13, 4
    s_nop 0
    s_add_u32 s6, s6, s7
    v_readlane_b32 s7, v13, 5
    s_nop 0
    s_add_u32 s6, s6, s7
    v_readlane_b32 s7, v13, 6
    s_nop 0
    s_add_u32 s6, s6, s7
    v_readlane_b32 s7, v13, 7
    s_nop 0
    s_add_u32 s6, s6, s7
    v_readlane_b32 s7, v13, s32
    s_nop 0
    s_cmp_ge_u32 s7, 32
    s_cselect_b32 s55, 1, 0
    s_cselect_b32 s6, 256, s6
    s_cmp_lt_u32 s6, 256
    s_cbranch_scc1 L_pure
    s_mov_b64 exec, -1
    s_lshl_b32 s6, s32, 2
    s_add_u32 s6, s6, 192
    s_cmp_lg_u32 s14, 0
    s_cbranch_scc1 L_team_d
    v_mov_b32 v12, s6
    s_mov_b32 s16, 0
L_team:
    global_load_dword v13, v12, s[12:13] sc1
    s_add_u32 s16, s16, 1
    s_cmp_gt_u32 s16, 100000
    s_cbranch_scc1 Lr_abort
    s_waitcnt vmcnt(0)
    v_cmp_gt_u32 vcc, 32, v13
    s_nop 0
    s_cbranch_vccz L_team_d
    s_sleep 8
    s_branch L_team
L_team_d:
    s_barrier
    s_cmp_lg_u32 s14, 0
    s_cbranch_scc1 L_rpool_d
    v_mov_b32 v12, 160
    s_mov_b32 s16, 0
L_rpool:
    global_load_dword v13, v12, s[12:13] sc1
    s_add_u32 s16, s16, 1
    s_cmp_gt_u32 s16, 100000
    s_cbranch_scc1 Lr_abort
    s_waitcnt vmcnt(0)
    v_cmp_gt_u32 vcc, 123, v13
    s_nop 0
    s_cbranch_vccz L_rpool_d
    s_sleep 8
    s_branch L_rpool
L_rpool_d:
    s_barrier
    s_barrier
    s_cmp_eq_u32 s55, 0
    s_cbranch_scc1 L_slow
    s_cmp_lg_u32 s14, 0
    s_cbranch_scc1 L_w1_1
    s_barrier
    s_mov_b32 m0, 9216
    s_nop 0
    buffer_load_dwordx4 v0, s[8:11], s41 offen offset:0 lds
    buffer_load_dwordx4 v0, s[8:11], s41 offen offset:1024 lds
    s_add_u32 s41, s41, 262144
    s_waitcnt vmcnt(0)
    buffer_load_dwordx4 v[44:47], v0, s[8:11], s34 offen sc1
    buffer_load_dwordx4 v[48:51], v0, s[8:11], s34 offen offset:1024 sc1
    buffer_load_dword v10, v8, s[8:11], s35 offen sc1
    ds_read_b128 v[56:59], v9 offset:0
    ds_read_b128 v[60:63], v9 offset:1024
    ds_read_b128 v[64:67], v9 offset:2048
    ds_read_b128 v[68:71], v9 offset:3072
    v_mov_b64 v[12:13], 0
    v_mov_b64 v[14:15], 0
    v_mov_b64 v[16:17], 0
    v_mov_b64 v[18:19], 0
    v_mov_b64 v[20:21], 0
    v_mov_b64 v[22:23], 0
    v_mov_b64 v[24:25], 0
    v_mov_b64 v[26:27], 0
    v_mov_b64 v[28:29], 0
    v_mov_b64 v[30:31], 0
    v_mov_b64 v[32:33], 0
    v_mov_b64 v[34:35], 0
    s_waitcnt lgkmcnt(0)
Lr0f_step:
    s_mov_b32 s16, 0
    s_mov_b64 s[70:71], 0
    s_mov_b64 s[72:73], 0
    s_mov_b64 s[74:75], 0
Lr0f_p2:
    s_mov_b64 exec, s[70:71]
    buffer_load_dwordx4 v[44:47], v0, s[8:11], s34 offen sc1
    s_mov_b64 exec, s[72:73]
    buffer_load_dwordx4 v[48:51], v0, s[8:11], s34 offen offset:1024 sc1
    s_mov_b64 exec, s[74:75]
    buffer_load_dword v10, v8, s[8:11], s35 offen sc1
    s_mov_b64 exec, -1
    s_add_u32 s16, s16, 1
    s_cmp_gt_u32 s16, 100000
    s_cbranch_scc1 Lr_abort
    s_waitcnt vmcnt(5)
    v_max3_u32 v11, v44, v45, v46
    v_max_u32 v11, v11, v47
    v_cmp_eq_u32 s[70:71], -1, v11
    s_waitcnt vmcnt(4)
    v_max3_u32 v11, v48, v49, v50
    v_max_u32 v11, v11, v51
    v_cmp_eq_u32 s[72:73], -1, v11
    s_waitcnt vmcnt(3)
    v_cmp_eq_u32 s[74:75], -1, v10
    s_or_b64 vcc, s[70:71], s[72:73]
    s_or_b64 vcc, vcc, s[74:75]
    s_cbranch_scc1 Lr0f_p2
    v_smfmac_f32_16x16x64_bf16 v[12:15], v[44:47], v[72:79], v1
    ds_write_b128 v0, v[44:47] offset:0
    v_smfmac_f32_16x16x64_bf16 v[16:19], v[44:47], v[80:87], v1
    ds_write_b128 v0, v[48:51] offset:1024
    v_smfmac_f32_16x16x64_bf16 v[20:23], v[44:47], v[88:95], v1
    ds_write_b32 v8, v10 offset:8192
    v_smfmac_f32_16x16x64_bf16 v[24:27], v[44:47], v[56:63], v1
    s_waitcnt lgkmcnt(0)
    s_barrier
    ds_read_b128 v[52:55], v0 offset:2048
    v_smfmac_f32_16x16x64_bf16 v[12:15], v[48:51], v[112:119], v1
    ds_read_b128 v[36:39], v0 offset:3072
    v_smfmac_f32_16x16x64_bf16 v[16:19], v[48:51], v[120:127], v1
    ds_read_b128 v[56:59], v9 offset:4096
    v_smfmac_f32_16x16x64_bf16 v[20:23], v[48:51], v[128:135], v1
    ds_read_b128 v[60:63], v9 offset:5120
    v_smfmac_f32_16x16x64_bf16 v[24:27], v[48:51], v[64:71], v1
    ds_read_b128 v[40:43], v0 offset:4096
    s_waitcnt lgkmcnt(4)
    v_smfmac_f32_16x16x64_bf16 v[12:15], v[52:55], v[152:159], v1
    v_smfmac_f32_16x16x64_bf16 v[16:19], v[52:55], v[160:167], v1
    ds_read_b128 v[64:67], v9 offset:6144
    v_smfmac_f32_16x16x64_bf16 v[20:23], v[52:55], v[168:175], v1
    ds_read_b128 v[68:71], v9 offset:7168
    s_waitcnt lgkmcnt(3)
    v_smfmac_f32_16x16x64_bf16 v[24:27], v[52:55], v[56:63], v1
    v_smfmac_f32_16x16x64_bf16 v[12:15], v[36:39], v[192:199], v1
    ds_read_b128 v[52:55], v0 offset:5120
    v_smfmac_f32_16x16x64_bf16 v[16:19], v[36:39], v[200:207], v1
    ds_read_b128 v[56:59], v9 offset:8192
    v_smfmac_f32_16x16x64_bf16 v[20:23], v[36:39], v[208:215], v1
    ds_read_b128 v[60:63], v9 offset:9216
    s_waitcnt lgkmcnt(3)
    v_smfmac_f32_16x16x64_bf16 v[24:27], v[36:39], v[64:71], v1
    v_smfmac_f32_16x16x64_bf16 v[12:15], v[40:43], v[232:239], v1
    buffer_load_dwordx4 v[36:39], v0, s[8:11], s42 offen
    v_smfmac_f32_16x16x64_bf16 v[16:19], v[40:43], v[240:247], v1
    ds_read_b128 v[64:67], v9 offset:10240
    v_smfmac_f32_16x16x64_bf16 v[20:23], v[40:43], v[248:255], v1
    ds_read_b128 v[68:71], v9 offset:11264
    s_waitcnt lgkmcnt(2)
    v_smfmac_f32_16x16x64_bf16 v[24:27], v[40:43], v[56:63], v1
    s_waitcnt vmcnt(1)
    ds_read_b128 v[44:47], v0 offset:6144
    v_smfmac_f32_16x16x64_bf16 v[12:15], v[52:55], a[16:23], v1
    buffer_load_dwordx4 v[40:43], v0, s[8:11], s42 offen offset:1024
    v_smfmac_f32_16x16x64_bf16 v[16:19], v[52:55], a[24:31], v1
    ds_read_b128 v[56:59], v9 offset:12288
    v_smfmac_f32_16x16x64_bf16 v[20:23], v[52:55], a[32:39], v1
    ds_read_b128 v[60:63], v9 offset:13312
    s_waitcnt lgkmcnt(3)
    v_smfmac_f32_16x16x64_bf16 v[24:27], v[52:55], v[64:71], v1
    ds_read_b128 v[48:51], v0 offset:7168
    s_waitcnt lgkmcnt(3)
    v_smfmac_f32_16x16x64_bf16 v[12:15], v[44:47], a[56:63], v1
    ds_read_b128 v[52:55], v0 offset:8192
    v_smfmac_f32_16x16x64_bf16 v[16:19], v[44:47], a[64:71], v1
    ds_read_b128 v[64:67], v9 offset:14336
    v_smfmac_f32_16x16x64_bf16 v[20:23], v[44:47], a[72:79], v1
    ds_read_b128 v[68:71], v9 offset:15360
    s_waitcnt lgkmcnt(4)
    v_smfmac_f32_16x16x64_bf16 v[24:27], v[44:47], v[56:63], v1
    s_waitcnt lgkmcnt(3)
    v_smfmac_f32_16x16x64_bf16 v[12:15], v[48:51], a[96:103], v1
    v_smfmac_f32_16x16x64_bf16 v[16:19], v[48:51], a[104:111], v1
    ds_read_b128 v[56:59], v9 offset:16384
    s_waitcnt lgkmcnt(3)
    v_smfmac_f32_16x16x64_bf16 v[12:15], v[52:55], a[136:143], v1
    ds_read_b128 v[60:63], v9 offset:17408
    v_smfmac_f32_16x16x64_bf16 v[16:19], v[52:55], a[144:151], v1
    v_smfmac_f32_16x16x64_bf16 v[20:23], v[48:51], a[112:119], v1
    s_waitcnt lgkmcnt(2)
    v_smfmac_f32_16x16x64_bf16 v[24:27], v[48:51], v[64:71], v1
    ds_read_b128 v[64:67], v0 offset:9216
    s_nop 1
    v_add_f32 v12, v12, v14
    v_smfmac_f32_16x16x64_bf16 v[20:23], v[52:55], a[152:159], v1
    ds_read_b128 v[68:71], v0 offset:10240
    v_add_f32 v16, v16, v18
    s_waitcnt lgkmcnt(2)
    v_smfmac_f32_16x16x64_bf16 v[24:27], v[52:55], v[56:63], v1
    ds_read_b128 v[56:59], v0 offset:11264
    v_add_f32 v13, v13, v15
    v_add_f32 v17, v17, v19
    v_cvt_pk_bf16_f32 v14, v12, v16
    v_cvt_pk_bf16_f32 v15, v13, v17
    ds_write_b32 v2, v14 offset:17408
    ds_write_b32 v2, v15 offset:17696
    v_smfmac_f32_16x16x64_bf16 v[28:31], v[52:55], a[160:167], v1
    ds_read_b128 v[60:63], v0 offset:12288
    v_add_f32 v20, v20, v22
    v_add_f32 v24, v24, v26
    v_add_f32 v21, v21, v23
    v_add_f32 v25, v25, v27
    v_smfmac_f32_16x16x64_bf16 v[32:35], v[52:55], a[168:175], v1
    ds_read_b128 v[12:15], v0 offset:0
    v_cvt_pk_bf16_f32 v22, v20, v24
    v_cvt_pk_bf16_f32 v23, v21, v25
    ds_write_b32 v2, v22 offset:19712
    ds_write_b32 v2, v23 offset:20000
    v_smfmac_f32_16x16x64_bf16 v[28:31], v[48:51], a[120:127], v1
    ds_read_b128 v[16:19], v0 offset:1024
    v_smfmac_f32_16x16x64_bf16 v[32:35], v[48:51], a[128:135], v1
    ds_read_b128 v[20:23], v0 offset:2048
    v_smfmac_f32_16x16x64_bf16 v[28:31], v[44:47], a[80:87], v1
    ds_read_b128 v[24:27], v0 offset:3072
    v_smfmac_f32_16x16x64_bf16 v[32:35], v[44:47], a[88:95], v1
    s_waitcnt lgkmcnt(3)
    s_barrier
    ds_read_b128 v[44:47], v3 offset:17408
    v_smfmac_f32_16x16x64_bf16 v[28:31], v[12:15], v[96:103], v1
    ds_read_b128 v[52:55], v0 offset:4096
    v_smfmac_f32_16x16x64_bf16 v[32:35], v[12:15], v[104:111], v1
    ds_read_b128 v[12:15], v3 offset:19712
    s_waitcnt lgkmcnt(5)
    v_smfmac_f32_16x16x64_bf16 v[28:31], v[16:19], v[136:143], v1
    ds_read_b128 v[48:51], v0 offset:5120
    v_smfmac_f32_16x16x64_bf16 v[32:35], v[16:19], v[144:151], v1
    s_waitcnt lgkmcnt(5)
    v_smfmac_f32_16x16x64_bf16 v[28:31], v[20:23], v[176:183], v1
    v_smfmac_f32_16x16x64_bf16 v[32:35], v[20:23], v[184:191], v1
    ds_read_b128 v[20:23], v3 offset:17472
    s_waitcnt lgkmcnt(5)
    v_smfmac_f32_16x16x64_bf16 v[28:31], v[24:27], v[216:223], v1
    v_smfmac_f32_16x16x64_bf16 v[32:35], v[24:27], v[224:231], v1
    s_waitcnt lgkmcnt(3)
    v_smfmac_f32_16x16x64_bf16 v[28:31], v[52:55], a[0:7], v1
    v_smfmac_f32_16x16x64_bf16 v[32:35], v[52:55], a[8:15], v1
    ds_read_b128 v[52:55], v3 offset:19776
    s_waitcnt lgkmcnt(2)
    v_smfmac_f32_16x16x64_bf16 v[28:31], v[48:51], a[40:47], v1
    v_smfmac_f32_16x16x64_bf16 v[32:35], v[48:51], a[48:55], v1
    ds_read_b128 v[48:51], v3 offset:17536
    v_mfma_f32_16x16x32_bf16 v[24:27], v[12:15], v[44:47], 0
    v_mfma_f32_16x16x32_bf16 v[12:15], v[64:67], v[44:47], 0
    ds_read_b128 v[64:67], v0 offset:13312
    v_mfma_f32_16x16x32_bf16 v[16:19], v[68:71], v[44:47], 0
    ds_read_b128 v[68:71], v0 offset:14336
    s_waitcnt lgkmcnt(3)
    v_mfma_f32_16x16x32_bf16 v[24:27], v[52:55], v[20:23], v[24:27]
    ds_read_b128 v[44:47], v3 offset:19840
    v_add_f32 v28, v28, v30
    v_add_f32 v29, v29, v31
    v_mfma_f32_16x16x32_bf16 v[12:15], v[56:59], v[20:23], v[12:15]
    ds_read_b128 v[52:55], v3 offset:17600
    v_add_f32 v32, v32, v34
    v_add_f32 v33, v33, v35
    v_mfma_f32_16x16x32_bf16 v[16:19], v[60:63], v[20:23], v[16:19]
    ds_read_b128 v[56:59], v0 offset:15360
    v_cvt_pk_bf16_f32 v30, v28, v29
    v_cvt_pk_bf16_f32 v31, v32, v33
    s_waitcnt lgkmcnt(2)
    v_mfma_f32_16x16x32_bf16 v[24:27], v[44:47], v[48:51], v[24:27]
    ds_read_b128 v[20:23], v3 offset:19904
    v_lshrrev_b32 v10, 8, v0
    v_mul_u32_u24 v10, 288, v10
    v_mfma_f32_16x16x32_bf16 v[12:15], v[64:67], v[48:51], v[12:15]
    ds_read_b128 v[60:63], v0 offset:16384
    v_and_b32 v11, 0xf0, v0
    v_add_u32 v10, v10, v11
    v_mfma_f32_16x16x32_bf16 v[16:19], v[68:71], v[48:51], v[16:19]
    ds_read_b128 v[32:35], v10 offset:19712
    v_lshrrev_b32 v11, 1, v0
    v_bfi_b32 v30, 1, s66, v30
    s_waitcnt lgkmcnt(2)
    v_mfma_f32_16x16x32_bf16 v[24:27], v[20:23], v[52:55], v[24:27]
    buffer_store_dwordx2 v[30:31], v11, s[8:11], s43 offen offset:2048 sc1
    v_mov_b32 v49, 0
    v_mov_b32 v50, 0
    v_mfma_f32_16x16x32_bf16 v[12:15], v[56:59], v[52:55], v[12:15]
    v_mov_b64 v[64:65], s[68:69]
    v_mov_b64 v[66:67], s[68:69]
    s_waitcnt lgkmcnt(1)
    v_mfma_f32_16x16x32_bf16 v[16:19], v[60:63], v[52:55], v[16:19]
    s_waitcnt lgkmcnt(0)
    v_bfi_b32 v32, 1, s66, v32
    s_mov_b64 exec, s[52:53]
    buffer_store_dwordx4 v[32:35], v0, s[8:11], s43 offen sc1
    s_mov_b64 exec, -1
    v_max3_f32 v10, v24, v25, v12
    v_max3_f32 v10, v10, v13, v14
    s_nop 0
    v_max3_f32 v10, v10, v15, v16
    v_max3_f32 v10, v10, v17, v18
    v_max_f32 v10, v10, v19
    v_mov_b32 v11, v10
    s_nop 1
    v_permlane32_swap_b32 v10, v11
    v_max_f32 v10, v10, v11
    v_mov_b32 v11, v10
    s_nop 1
    v_permlane16_swap_b32 v10, v11
    v_max_f32 v10, v10, v11
    v_mul_f32 v20, s46, v10
    v_pk_fma_f32 v[24:25], v[24:25], s[46:47], v[20:21] op_sel_hi:[1,1,0] neg_lo:[0,0,1] neg_hi:[0,0,1]
    v_pk_fma_f32 v[12:13], v[12:13], s[46:47], v[20:21] op_sel_hi:[1,1,0] neg_lo:[0,0,1] neg_hi:[0,0,1]
    v_exp_f32 v24, v24
    v_exp_f32 v25, v25
    v_pk_fma_f32 v[14:15], v[14:15], s[46:47], v[20:21] op_sel_hi:[1,1,0] neg_lo:[0,0,1] neg_hi:[0,0,1]
    v_exp_f32 v12, v12
    v_exp_f32 v13, v13
    v_pk_fma_f32 v[16:17], v[16:17], s[46:47], v[20:21] op_sel_hi:[1,1,0] neg_lo:[0,0,1] neg_hi:[0,0,1]
    v_cvt_pk_bf16_f32 v48, v24, v25
    v_exp_f32 v14, v14
    v_pk_fma_f32 v[18:19], v[18:19], s[46:47], v[20:21] op_sel_hi:[1,1,0] neg_lo:[0,0,1] neg_hi:[0,0,1]
    v_cvt_pk_bf16_f32 v51, v24, v25
    v_exp_f32 v15, v15
    v_cvt_pk_bf16_f32 v44, v12, v13
    v_exp_f32 v16, v16
    v_exp_f32 v17, v17
    v_cvt_pk_bf16_f32 v45, v14, v15
    v_exp_f32 v18, v18
    v_exp_f32 v19, v19
    v_cvt_pk_bf16_f32 v46, v16, v17
    v_cvt_pk_bf16_f32 v47, v18, v19
    v_mfma_f32_16x16x16_bf16 v[68:71], v[64:65], v[48:49], 0
    v_mfma_f32_16x16x16_bf16 v[52:55], v[30:31], v[48:49], 0
    v_mfma_f32_16x16x16_bf16 v[56:59], v[30:31], v[50:51], 0
    v_mfma_f32_16x16x32_bf16 v[68:71], v[64:67], v[44:47], v[68:71]
    s_waitcnt vmcnt(3)
    v_mfma_f32_16x16x32_bf16 v[52:55], v[36:39], v[44:47], v[52:55]
    s_waitcnt vmcnt(2)
    v_mfma_f32_16x16x32_bf16 v[56:59], v[40:43], v[44:47], v[56:59]
    ds_read_b128 v[36:39], v0 offset:30720
    ds_read_b128 v[40:43], v0 offset:31744
    ds_read_b128 v[60:63], v9 offset:24576
    s_nop 0
    v_rcp_f32 v10, v68
    s_nop 0
    v_pk_mul_f32 v[52:53], v[52:53], v[10:11] op_sel_hi:[1,0]
    s_nop 0
    v_pk_mul_f32 v[56:57], v[56:57], v[10:11] op_sel_hi:[1,0]
    v_cvt_pk_bf16_f32 v16, v52, v56
    v_cvt_pk_bf16_f32 v17, v53, v57
    v_pk_mul_f32 v[54:55], v[54:55], v[10:11] op_sel_hi:[1,0]
    v_pk_mul_f32 v[58:59], v[58:59], v[10:11] op_sel_hi:[1,0]
    v_cvt_pk_bf16_f32 v18, v54, v58
    v_cvt_pk_bf16_f32 v19, v55, v59
    ds_write_b128 v3, v[16:19] offset:22016
    ds_read_b128 v[64:67], v9 offset:25600
    v_mov_b64 v[12:13], 0
    v_mov_b64 v[14:15], 0
    v_mov_b64 v[20:21], 0
    v_mov_b64 v[22:23], 0
    v_mov_b64 v[24:25], 0
    v_mov_b64 v[26:27], 0
    v_mov_b64 v[32:33], 0
    v_mov_b64 v[34:35], 0
    v_mov_b64 v[44:45], 0
    v_mov_b64 v[46:47], 0
    v_mov_b64 v[48:49], 0
    v_mov_b64 v[50:51], 0
    s_waitcnt lgkmcnt(1)
    s_barrier
    ds_read_b128 v[52:55], v4 offset:22016
    ds_read_b128 v[56:59], v4 offset:22144
    v_mov_b64 v[68:69], 0
    v_mov_b64 v[70:71], 0
    v_mov_b64 v[28:29], 0
    v_mov_b64 v[30:31], 0
    v_mov_b64 v[16:17], 0
    v_mov_b64 v[18:19], 0
    s_cmp_eq_u32 s33, 63
    s_cbranch_scc1 Lr0f_last
    s_waitcnt lgkmcnt(1)
    v_smfmac_f32_16x16x64_bf16 v[28:31], v[52:55], v[60:67], v1
    ds_read_b128 v[60:63], v0 offset:24576
    s_waitcnt lgkmcnt(1)
    v_smfmac_f32_16x16x64_bf16 v[28:31], v[56:59], v[36:43], v1
    ds_read_b128 v[64:67], v0 offset:25600
    ds_read_b128 v[36:39], v9 offset:18432
    v_smfmac_f32_16x16x64_bf16 v[12:15], v[52:55], a[176:183], v1
    ds_read_b128 v[40:43], v9 offset:19456
    v_smfmac_f32_16x16x64_bf16 v[12:15], v[56:59], a[184:191], v1
    buffer_load_dwordx4 v0, s[8:11], s41 offen offset:0 lds
    v_smfmac_f32_16x16x64_bf16 v[20:23], v[52:55], a[192:199], v1
    s_nop 0
    v_add_f32 v28, v28, v30
    v_add_f32 v29, v29, v31
    s_waitcnt lgkmcnt(2)
    v_smfmac_f32_16x16x64_bf16 v[20:23], v[56:59], v[60:67], v1
    ds_read_b128 v[60:63], v9 offset:20480
    v_cvt_pk_bf16_f32 v28, v28, v29
    v_bfi_b32 v28, 1, s39, v28
    buffer_store_dword v28, v8, s[8:11], s38 offen offset:2048
    s_waitcnt lgkmcnt(1)
    v_smfmac_f32_16x16x64_bf16 v[24:27], v[52:55], v[36:43], v1
    ds_read_b128 v[64:67], v9 offset:21504
    ds_read_b128 v[36:39], v0 offset:26624
    v_add_f32 v12, v12, v14
    v_add_f32 v13, v13, v15
    v_smfmac_f32_16x16x64_bf16 v[24:27], v[56:59], a[200:207], v1
    ds_read_b128 v[40:43], v0 offset:27648
    v_cvt_pk_bf16_f32 v12, v12, v13
    v_bfi_b32 v12, 1, s39, v12
    v_smfmac_f32_16x16x64_bf16 v[32:35], v[52:55], a[208:215], v1
    buffer_load_dwordx4 v0, s[8:11], s41 offen offset:1024 lds
    v_add_f32 v20, v20, v22
    v_add_f32 v21, v21, v23
    v_smfmac_f32_16x16x64_bf16 v[32:35], v[56:59], a[216:223], v1
    v_cvt_pk_bf16_f32 v13, v20, v21
    s_waitcnt lgkmcnt(2)
    v_smfmac_f32_16x16x64_bf16 v[44:47], v[52:55], v[60:67], v1
    ds_read_b128 v[60:63], v0 offset:28672
    v_add_f32 v24, v24, v26
    v_add_f32 v25, v25, v27
    s_waitcnt lgkmcnt(1)
    v_smfmac_f32_16x16x64_bf16 v[44:47], v[56:59], v[36:43], v1
    ds_read_b128 v[64:67], v0 offset:29696
    ds_read_b128 v[36:39], v9 offset:22528
    v_cvt_pk_bf16_f32 v14, v24, v25
    v_smfmac_f32_16x16x64_bf16 v[48:51], v[52:55], a[224:231], v1
    ds_read_b128 v[40:43], v9 offset:23552
    v_add_f32 v32, v32, v34
    v_add_f32 v33, v33, v35
    v_smfmac_f32_16x16x64_bf16 v[48:51], v[56:59], a[232:239], v1
    v_cvt_pk_bf16_f32 v15, v32, v33
    buffer_store_dwordx4 v[12:15], v0, s[8:11], s38 offen offset:0
    v_smfmac_f32_16x16x64_bf16 v[68:71], v[52:55], a[240:247], v1
    v_add_f32 v44, v44, v46
    v_add_f32 v45, v45, v47
    s_waitcnt lgkmcnt(2)
    v_smfmac_f32_16x16x64_bf16 v[68:71], v[56:59], v[60:67], v1
    v_cvt_pk_bf16_f32 v44, v44, v45
    v_bfi_b32 v44, 1, s39, v44
    s_waitcnt lgkmcnt(0)
    v_smfmac_f32_16x16x64_bf16 v[16:19], v[52:55], v[36:43], v1
    v_add_f32 v48, v48, v50
    v_add_f32 v49, v49, v51
    v_smfmac_f32_16x16x64_bf16 v[16:19], v[56:59], a[248:255], v1
    v_cvt_pk_bf16_f32 v45, v48, v49
    v_add_f32 v68, v68, v70
    v_add_f32 v69, v69, v71
    v_cvt_pk_bf16_f32 v46, v68, v69
    s_nop 3
    v_add_f32 v16, v16, v18
    v_add_f32 v17, v17, v19
    v_cvt_pk_bf16_f32 v47, v16, v17
    buffer_store_dwordx4 v[44:47], v0, s[8:11], s38 offen offset:1024
    v_bfe_u32 v10, v0, 4, 4
    v_mov_b32 v11, 0x3f80
    v_mov_b32 v40, 0x3f800000
    v_cmp_eq_u32 vcc, 0, v10
    v_cmp_eq_u32 s[48:49], 1, v10
    s_nop 0
    v_cndmask_b32 v36, 0, v11, vcc
    v_cndmask_b32 v36, v36, v40, s[48:49]
    v_cmp_eq_u32 vcc, 2, v10
    v_cmp_eq_u32 s[48:49], 3, v10
    s_nop 0
    v_cndmask_b32 v37, 0, v11, vcc
    v_cndmask_b32 v37, v37, v40, s[48:49]
    v_cmp_eq_u32 vcc, 4, v10
    v_cmp_eq_u32 s[48:49], 5, v10
    s_nop 0
    v_cndmask_b32 v38, 0, v11, vcc
    v_cndmask_b32 v38, v38, v40, s[48:49]
    v_cmp_eq_u32 vcc, 6, v10
    v_cmp_eq_u32 s[48:49], 7, v10
    s_nop 0
    v_cndmask_b32 v39, 0, v11, vcc
    v_cndmask_b32 v39, v39, v40, s[48:49]
    s_sleep 5
    buffer_load_dwordx4 v[52:55], v6, s[8:11], s57 offen sc1
    buffer_load_dwordx4 v[56:59], v6, s[8:11], s58 offen sc1
    buffer_load_dwordx4 v[60:63], v6, s[8:11], s59 offen sc1
    buffer_load_dwordx4 v[64:67], v6, s[8:11], s60 offen sc1
    s_mov_b32 s16, 0
    s_mov_b64 s[70:71], 0
    s_mov_b64 s[72:73], 0
    s_mov_b64 s[74:75], 0
    s_mov_b64 s[76:77], 0
Lr0f_p1:
    s_mov_b64 exec, s[70:71]
    buffer_load_dwordx4 v[52:55], v6, s[8:11], s57 offen sc1
    s_mov_b64 exec, s[72:73]
    buffer_load_dwordx4 v[56:59], v6, s[8:11], s58 offen sc1
    s_mov_b64 exec, s[74:75]
    buffer_load_dwordx4 v[60:63], v6, s[8:11], s59 offen sc1
    s_mov_b64 exec, s[76:77]
    buffer_load_dwordx4 v[64:67], v6, s[8:11], s60 offen sc1
    s_mov_b64 exec, -1
    s_add_u32 s16, s16, 1
    s_cmp_gt_u32 s16, 100000
    s_cbranch_scc1 Lr_abort
    s_waitcnt vmcnt(7)
    v_and_b32 v11, 1, v52
    v_cmp_ne_u32 s[70:71], s39, v11
    v_mfma_f32_16x16x32_bf16 v[40:43], v[52:55], v[36:39], 0
    s_waitcnt vmcnt(6)
    v_and_b32 v11, 1, v56
    v_cmp_ne_u32 s[72:73], s39, v11
    v_mfma_f32_16x16x32_bf16 v[40:43], v[56:59], v[36:39], v[40:43]
    s_waitcnt vmcnt(5)
    v_and_b32 v11, 1, v60
    v_cmp_ne_u32 s[74:75], s39, v11
    v_mfma_f32_16x16x32_bf16 v[40:43], v[60:63], v[36:39], v[40:43]
    s_or_b64 vcc, s[70:71], s[72:73]
    s_waitcnt vmcnt(4)
    v_and_b32 v11, 1, v64
    v_cmp_ne_u32 s[76:77], s39, v11
    v_mfma_f32_16x16x32_bf16 v[40:43], v[64:67], v[36:39], v[40:43]
    s_or_b64 vcc, vcc, s[74:75]
    s_or_b64 vcc, vcc, s[76:77]
    s_cbranch_scc1 Lr0f_p1
    s_nop 4
    v_permlane16_swap_b32 v40, v42
    v_permlane16_swap_b32 v41, v43
    s_mov_b64 exec, s[50:51]
    v_add_f32 v40, v40, v42
    v_add_f32 v41, v41, v43
    v_cvt_pk_bf16_f32 v40, v40, v41
    v_min_u32 v40, s54, v40
    buffer_store_dword v40, v7, s[8:11], s36 offen
    v_mov_b32 v41, -1
    buffer_store_dword v41, v7, s[8:11], s37 offen
    s_mov_b64 exec, -1
    s_xor_b32 s34, s34, 16384
    s_xor_b32 s35, s35, 16384
    s_barrier
    s_sleep 2
    buffer_load_dwordx4 v[44:47], v0, s[8:11], s34 offen sc1
    buffer_load_dwordx4 v[48:51], v0, s[8:11], s34 offen offset:1024 sc1
    buffer_load_dword v10, v8, s[8:11], s35 offen sc1
    s_add_u32 s33, s33, 1
    s_bfe_u32 s39, s33, 0x10001
    s_xor_b32 s38, s38, 524288
    s_xor_b32 s57, s57, 524288
    s_xor_b32 s58, s58, 524288
    s_xor_b32 s59, s59, 524288
    s_xor_b32 s60, s60, 524288
    s_xor_b32 s36, s36, 16384
    s_xor_b32 s37, s37, 16384
    s_and_b32 s17, s33, 7
    s_mul_i32 s17, s17, 131072
    s_add_u32 s43, s45, s17
    s_bfe_u32 s66, s33, 65539
    s_add_u32 s67, s67, 22528
    s_add_u32 s42, s42, 262144
    s_add_u32 s41, s41, 262144
    s_add_u32 s40, s40, 262144
    s_add_u32 s44, s44, 22528
    s_waitcnt vmcnt(5)
    ds_read_b128 v[56:59], v9 offset:0
    ds_read_b128 v[60:63], v9 offset:1024
    ds_read_b128 v[64:67], v9 offset:2048
    ds_read_b128 v[68:71], v9 offset:3072
    v_mov_b64 v[12:13], 0
    v_mov_b64 v[14:15], 0
    v_mov_b64 v[16:17], 0
    v_mov_b64 v[18:19], 0
    v_mov_b64 v[20:21], 0
    v_mov_b64 v[22:23], 0
    v_mov_b64 v[24:25], 0
    v_mov_b64 v[26:27], 0
    v_mov_b64 v[28:29], 0
    v_mov_b64 v[30:31], 0
    v_mov_b64 v[32:33], 0
    v_mov_b64 v[34:35], 0
    s_waitcnt lgkmcnt(0)
    s_branch Lr0f_step
Lr0f_last:
    s_waitcnt vmcnt(0) lgkmcnt(0)
    s_branch Lr_exit
L_w1_1:
    s_cmp_lg_u32 s14, 1
    s_cbranch_scc1 L_w2_1
    s_barrier
    s_mov_b32 m0, 11264
    s_nop 0
    buffer_load_dwordx4 v0, s[8:11], s41 offen offset:0 lds
    buffer_load_dwordx4 v0, s[8:11], s41 offen offset:1024 lds
    s_add_u32 s41, s41, 262144
    s_waitcnt vmcnt(0)
    buffer_load_dwordx4 v[44:47], v0, s[8:11], s34 offen sc1
    buffer_load_dwordx4 v[48:51], v0, s[8:11], s34 offen offset:1024 sc1
    buffer_load_dword v10, v8, s[8:11], s35 offen sc1
    ds_read_b128 v[56:59], v9 offset:4096
    ds_read_b128 v[60:63], v9 offset:5120
    ds_read_b128 v[64:67], v9 offset:6144
    ds_read_b128 v[68:71], v9 offset:7168
    v_mov_b64 v[12:13], 0
    v_mov_b64 v[14:15], 0
    v_mov_b64 v[16:17], 0
    v_mov_b64 v[18:19], 0
    v_mov_b64 v[20:21], 0
    v_mov_b64 v[22:23], 0
    v_mov_b64 v[24:25], 0
    v_mov_b64 v[26:27], 0
    v_mov_b64 v[28:29], 0
    v_mov_b64 v[30:31], 0
    v_mov_b64 v[32:33], 0
    v_mov_b64 v[34:35], 0
    s_waitcnt lgkmcnt(0)
Lr1f_step:
    s_mov_b32 s16, 0
    s_mov_b64 s[70:71], 0
    s_mov_b64 s[72:73], 0
    s_mov_b64 s[74:75], 0
Lr1f_p2:
    s_mov_b64 exec, s[70:71]
    buffer_load_dwordx4 v[44:47], v0, s[8:11], s34 offen sc1
    s_mov_b64 exec, s[72:73]
    buffer_load_dwordx4 v[48:51], v0, s[8:11], s34 offen offset:1024 sc1
    s_mov_b64 exec, s[74:75]
    buffer_load_dword v10, v8, s[8:11], s35 offen sc1
    s_mov_b64 exec, -1
    s_add_u32 s16, s16, 1
    s_cmp_gt_u32 s16, 100000
    s_cbranch_scc1 Lr_abort
    s_waitcnt vmcnt(5)
    v_max3_u32 v11, v44, v45, v46
    v_max_u32 v11, v11, v47
    v_cmp_eq_u32 s[70:71], -1, v11
    s_waitcnt vmcnt(4)
    v_max3_u32 v11, v48, v49, v50
    v_max_u32 v11, v11, v51
    v_cmp_eq_u32 s[72:73], -1, v11
    s_waitcnt vmcnt(3)
    v_cmp_eq_u32 s[74:75], -1, v10
    s_or_b64 vcc, s[70:71], s[72:73]
    s_or_b64 vcc, vcc, s[74:75]
    s_cbranch_scc1 Lr1f_p2
    v_smfmac_f32_16x16x64_bf16 v[12:15], v[44:47], v[152:159], v1
    ds_write_b128 v0, v[44:47] offset:2048
    v_smfmac_f32_16x16x64_bf16 v[16:19], v[44:47], v[160:167], v1
    ds_write_b128 v0, v[48:51] offset:3072
    v_smfmac_f32_16x16x64_bf16 v[20:23], v[44:47], v[168:175], v1
    ds_write_b32 v8, v10 offset:8448
    v_smfmac_f32_16x16x64_bf16 v[24:27], v[44:47], v[56:63], v1
    s_waitcnt lgkmcnt(0)
    s_barrier
    ds_read_b128 v[52:55], v0 offset:0
    v_smfmac_f32_16x16x64_bf16 v[12:15], v[48:51], v[192:199], v1
    ds_read_b128 v[36:39], v0 offset:1024
    v_smfmac_f32_16x16x64_bf16 v[16:19], v[48:51], v[200:207], v1
    ds_read_b128 v[56:59], v9 offset:0
    v_smfmac_f32_16x16x64_bf16 v[20:23], v[48:51], v[208:215], v1
    ds_read_b128 v[60:63], v9 offset:1024
    v_smfmac_f32_16x16x64_bf16 v[24:27], v[48:51], v[64:71], v1
    ds_read_b128 v[40:43], v0 offset:4096
    s_waitcnt lgkmcnt(4)
    v_smfmac_f32_16x16x64_bf16 v[12:15], v[52:55], v[72:79], v1
    v_smfmac_f32_16x16x64_bf16 v[16:19], v[52:55], v[80:87], v1
    ds_read_b128 v[64:67], v9 offset:2048
    v_smfmac_f32_16x16x64_bf16 v[20:23], v[52:55], v[88:95], v1
    ds_read_b128 v[68:71], v9 offset:3072
    s_waitcnt lgkmcnt(3)
    v_smfmac_f32_16x16x64_bf16 v[24:27], v[52:55], v[56:63], v1
    v_smfmac_f32_16x16x64_bf16 v[12:15], v[36:39], v[112:119], v1
    ds_read_b128 v[52:55], v0 offset:5120
    v_smfmac_f32_16x16x64_bf16 v[16:19], v[36:39], v[120:127], v1
    ds_read_b128 v[56:59], v9 offset:8192
    v_smfmac_f32_16x16x64_bf16 v[20:23], v[36:39], v[128:135], v1
    ds_read_b128 v[60:63], v9 offset:9216
    s_waitcnt lgkmcnt(3)
    v_smfmac_f32_16x16x64_bf16 v[24:27], v[36:39], v[64:71], v1
    v_smfmac_f32_16x16x64_bf16 v[12:15], v[40:43], v[232:239], v1
    buffer_load_dwordx4 v[36:39], v0, s[8:11], s42 offen
    v_smfmac_f32_16x16x64_bf16 v[16:19], v[40:43], v[240:247], v1
    ds_read_b128 v[64:67], v9 offset:10240
    v_smfmac_f32_16x16x64_bf16 v[20:23], v[40:43], v[248:255], v1
    ds_read_b128 v[68:71], v9 offset:11264
    s_waitcnt lgkmcnt(2)
    v_smfmac_f32_16x16x64_bf16 v[24:27], v[40:43], v[56:63], v1
    s_waitcnt vmcnt(1)
    ds_read_b128 v[44:47], v0 offset:6144
    v_smfmac_f32_16x16x64_bf16 v[12:15], v[52:55], a[16:23], v1
    buffer_load_dwordx4 v[40:43], v0, s[8:11], s42 offen offset:1024
    v_smfmac_f32_16x16x64_bf16 v[16:19], v[52:55], a[24:31], v1
    ds_read_b128 v[56:59], v9 offset:12288
    v_smfmac_f32_16x16x64_bf16 v[20:23], v[52:55], a[32:39], v1
    ds_read_b128 v[60:63], v9 offset:13312
    s_waitcnt lgkmcnt(3)
    v_smfmac_f32_16x16x64_bf16 v[24:27], v[52:55], v[64:71], v1
    ds_read_b128 v[48:51], v0 offset:7168
    s_waitcnt lgkmcnt(3)
    v_smfmac_f32_16x16x64_bf16 v[12:15], v[44:47], a[56:63], v1
    ds_read_b128 v[52:55], v0 offset:8192
    v_smfmac_f32_16x16x64_bf16 v[16:19], v[44:47], a[64:71], v1
    ds_read_b128 v[64:67], v9 offset:14336
    v_smfmac_f32_16x16x64_bf16 v[20:23], v[44:47], a[72:79], v1
    ds_read_b128 v[68:71], v9 offset:15360
    s_waitcnt lgkmcnt(4)
    v_smfmac_f32_16x16x64_bf16 v[24:27], v[44:47], v[56:63], v1
    s_waitcnt lgkmcnt(3)
    v_smfmac_f32_16x16x64_bf16 v[12:15], v[48:51], a[96:103], v1
    v_smfmac_f32_16x16x64_bf16 v[16:19], v[48:51], a[104:111], v1
    ds_read_b128 v[56:59], v9 offset:16384
    s_waitcnt lgkmcnt(3)
    v_smfmac_f32_16x16x64_bf16 v[12:15], v[52:55], a[136:143], v1
    ds_read_b128 v[60:63], v9 offset:17408
    v_smfmac_f32_16x16x64_bf16 v[16:19], v[52:55], a[144:151], v1
    v_smfmac_f32_16x16x64_bf16 v[20:23], v[48:51], a[112:119], v1
    s_waitcnt lgkmcnt(2)
    v_smfmac_f32_16x16x64_bf16 v[24:27], v[48:51], v[64:71], v1
    ds_read_b128 v[64:67], v0 offset:9216
    s_nop 1
    v_add_f32 v12, v12, v14
    v_smfmac_f32_16x16x64_bf16 v[20:23], v[52:55], a[152:159], v1
    ds_read_b128 v[68:71], v0 offset:10240
    v_add_f32 v16, v16, v18
    s_waitcnt lgkmcnt(2)
    v_smfmac_f32_16x16x64_bf16 v[24:27], v[52:55], v[56:63], v1
    ds_read_b128 v[56:59], v0 offset:11264
    v_add_f32 v13, v13, v15
    v_add_f32 v17, v17, v19
    v_cvt_pk_bf16_f32 v14, v12, v16
    v_cvt_pk_bf16_f32 v15, v13, v17
    ds_write_b32 v2, v14 offset:17408
    ds_write_b32 v2, v15 offset:17696
    v_smfmac_f32_16x16x64_bf16 v[28:31], v[52:55], a[160:167], v1
    ds_read_b128 v[60:63], v0 offset:12288
    v_add_f32 v20, v20, v22
    v_add_f32 v24, v24, v26
    v_add_f32 v21, v21, v23
    v_add_f32 v25, v25, v27
    v_smfmac_f32_16x16x64_bf16 v[32:35], v[52:55], a[168:175], v1
    ds_read_b128 v[12:15], v0 offset:2048
    v_cvt_pk_bf16_f32 v22, v20, v24
    v_cvt_pk_bf16_f32 v23, v21, v25
    ds_write_b32 v2, v22 offset:19712
    ds_write_b32 v2, v23 offset:20000
    v_smfmac_f32_16x16x64_bf16 v[28:31], v[48:51], a[120:127], v1
    ds_read_b128 v[16:19], v0 offset:3072
    v_smfmac_f32_16x16x64_bf16 v[32:35], v[48:51], a[128:135], v1
    ds_read_b128 v[20:23], v0 offset:0
    v_smfmac_f32_16x16x64_bf16 v[28:31], v[44:47], a[80:87], v1
    ds_read_b128 v[24:27], v0 offset:1024
    v_smfmac_f32_16x16x64_bf16 v[32:35], v[44:47], a[88:95], v1
    s_waitcnt lgkmcnt(3)
    s_barrier
    ds_read_b128 v[44:47], v3 offset:17408
    v_smfmac_f32_16x16x64_bf16 v[28:31], v[12:15], v[176:183], v1
    ds_read_b128 v[52:55], v0 offset:4096
    v_smfmac_f32_16x16x64_bf16 v[32:35], v[12:15], v[184:191], v1
    ds_read_b128 v[12:15], v3 offset:19712
    s_waitcnt lgkmcnt(5)
    v_smfmac_f32_16x16x64_bf16 v[28:31], v[16:19], v[216:223], v1
    ds_read_b128 v[48:51], v0 offset:5120
    v_smfmac_f32_16x16x64_bf16 v[32:35], v[16:19], v[224:231], v1
    s_waitcnt lgkmcnt(5)
    v_smfmac_f32_16x16x64_bf16 v[28:31], v[20:23], v[96:103], v1
    v_smfmac_f32_16x16x64_bf16 v[32:35], v[20:23], v[104:111], v1
    ds_read_b128 v[20:23], v3 offset:17472
    s_waitcnt lgkmcnt(5)
    v_smfmac_f32_16x16x64_bf16 v[28:31], v[24:27], v[136:143], v1
    v_smfmac_f32_16x16x64_bf16 v[32:35], v[24:27], v[144:151], v1
    s_waitcnt lgkmcnt(3)
    v_smfmac_f32_16x16x64_bf16 v[28:31], v[52:55], a[0:7], v1
    v_smfmac_f32_16x16x64_bf16 v[32:35], v[52:55], a[8:15], v1
    ds_read_b128 v[52:55], v3 offset:19776
    s_waitcnt lgkmcnt(2)
    v_smfmac_f32_16x16x64_bf16 v[28:31], v[48:51], a[40:47], v1
    v_smfmac_f32_16x16x64_bf16 v[32:35], v[48:51], a[48:55], v1
    ds_read_b128 v[48:51], v3 offset:17536
    v_mfma_f32_16x16x32_bf16 v[24:27], v[12:15], v[44:47], 0
    v_mfma_f32_16x16x32_bf16 v[12:15], v[64:67], v[44:47], 0
    ds_read_b128 v[64:67], v0 offset:13312
    v_mfma_f32_16x16x32_bf16 v[16:19], v[68:71], v[44:47], 0
    ds_read_b128 v[68:71], v0 offset:14336
    s_waitcnt lgkmcnt(3)
    v_mfma_f32_16x16x32_bf16 v[24:27], v[52:55], v[20:23], v[24:27]
    ds_read_b128 v[44:47], v3 offset:19840
    v_add_f32 v28, v28, v30
    v_add_f32 v29, v29, v31
    v_mfma_f32_16x16x32_bf16 v[12:15], v[56:59], v[20:23], v[12:15]
    ds_read_b128 v[52:55], v3 offset:17600
    v_add_f32 v32, v32, v34
    v_add_f32 v33, v33, v35
    v_mfma_f32_16x16x32_bf16 v[16:19], v[60:63], v[20:23], v[16:19]
    ds_read_b128 v[56:59], v0 offset:15360
    v_cvt_pk_bf16_f32 v30, v28, v29
    v_cvt_pk_bf16_f32 v31, v32, v33
    s_waitcnt lgkmcnt(2)
    v_mfma_f32_16x16x32_bf16 v[24:27], v[44:47], v[48:51], v[24:27]
    ds_read_b128 v[20:23], v3 offset:19904
    v_lshrrev_b32 v10, 8, v0
    v_mul_u32_u24 v10, 288, v10
    v_mfma_f32_16x16x32_bf16 v[12:15], v[64:67], v[48:51], v[12:15]
    ds_read_b128 v[60:63], v0 offset:16384
    v_and_b32 v11, 0xf0, v0
    v_add_u32 v10, v10, v11
    v_mfma_f32_16x16x32_bf16 v[16:19], v[68:71], v[48:51], v[16:19]
    ds_read_b128 v[32:35], v10 offset:20288
    v_lshrrev_b32 v11, 1, v0
    v_bfi_b32 v30, 1, s66, v30
    s_waitcnt lgkmcnt(2)
    v_mfma_f32_16x16x32_bf16 v[24:27], v[20:23], v[52:55], v[24:27]
    buffer_store_dwordx2 v[30:31], v11, s[8:11], s43 offen offset:2048 sc1
    v_mov_b32 v49, 0
    v_mov_b32 v50, 0
    v_mfma_f32_16x16x32_bf16 v[12:15], v[56:59], v[52:55], v[12:15]
    v_mov_b64 v[64:65], s[68:69]
    v_mov_b64 v[66:67], s[68:69]
    s_waitcnt lgkmcnt(1)
    v_mfma_f32_16x16x32_bf16 v[16:19], v[60:63], v[52:55], v[16:19]
    s_waitcnt lgkmcnt(0)
    v_bfi_b32 v32, 1, s66, v32
    s_mov_b64 exec, s[52:53]
    buffer_store_dwordx4 v[32:35], v0, s[8:11], s43 offen sc1
    s_mov_b64 exec, -1
    v_max3_f32 v10, v24, v25, v12
    v_max3_f32 v10, v10, v13, v14
    s_nop 0
    v_max3_f32 v10, v10, v15, v16
    v_max3_f32 v10, v10, v17, v18
    v_max_f32 v10, v10, v19
    v_mov_b32 v11, v10
    s_nop 1
    v_permlane32_swap_b32 v10, v11
    v_max_f32 v10, v10, v11
    v_mov_b32 v11, v10
    s_nop 1
    v_permlane16_swap_b32 v10, v11
    v_max_f32 v10, v10, v11
    v_mul_f32 v20, s46, v10
    v_pk_fma_f32 v[24:25], v[24:25], s[46:47], v[20:21] op_sel_hi:[1,1,0] neg_lo:[0,0,1] neg_hi:[0,0,1]
    v_pk_fma_f32 v[12:13], v[12:13], s[46:47], v[20:21] op_sel_hi:[1,1,0] neg_lo:[0,0,1] neg_hi:[0,0,1]
    v_exp_f32 v24, v24
    v_exp_f32 v25, v25
    v_pk_fma_f32 v[14:15], v[14:15], s[46:47], v[20:21] op_sel_hi:[1,1,0] neg_lo:[0,0,1] neg_hi:[0,0,1]
    v_exp_f32 v12, v12
    v_exp_f32 v13, v13
    v_pk_fma_f32 v[16:17], v[16:17], s[46:47], v[20:21] op_sel_hi:[1,1,0] neg_lo:[0,0,1] neg_hi:[0,0,1]
    v_cvt_pk_bf16_f32 v48, v24, v25
    v_exp_f32 v14, v14
    v_pk_fma_f32 v[18:19], v[18:19], s[46:47], v[20:21] op_sel_hi:[1,1,0] neg_lo:[0,0,1] neg_hi:[0,0,1]
    v_cvt_pk_bf16_f32 v51, v24, v25
    v_exp_f32 v15, v15
    v_cvt_pk_bf16_f32 v44, v12, v13
    v_exp_f32 v16, v16
    v_exp_f32 v17, v17
    v_cvt_pk_bf16_f32 v45, v14, v15
    v_exp_f32 v18, v18
    v_exp_f32 v19, v19
    v_cvt_pk_bf16_f32 v46, v16, v17
    v_cvt_pk_bf16_f32 v47, v18, v19
    v_mfma_f32_16x16x16_bf16 v[68:71], v[64:65], v[48:49], 0
    v_mfma_f32_16x16x16_bf16 v[52:55], v[30:31], v[48:49], 0
    v_mfma_f32_16x16x16_bf16 v[56:59], v[30:31], v[50:51], 0
    v_mfma_f32_16x16x32_bf16 v[68:71], v[64:67], v[44:47], v[68:71]
    s_waitcnt vmcnt(3)
    v_mfma_f32_16x16x32_bf16 v[52:55], v[36:39], v[44:47], v[52:55]
    s_waitcnt vmcnt(2)
    v_mfma_f32_16x16x32_bf16 v[56:59], v[40:43], v[44:47], v[56:59]
    ds_read_b128 v[36:39], v0 offset:38912
    ds_read_b128 v[40:43], v0 offset:39936
    ds_read_b128 v[60:63], v9 offset:24576
    s_nop 0
    v_rcp_f32 v10, v68
    s_nop 0
    v_pk_mul_f32 v[52:53], v[52:53], v[10:11] op_sel_hi:[1,0]
    s_nop 0
    v_pk_mul_f32 v[56:57], v[56:57], v[10:11] op_sel_hi:[1,0]
    v_cvt_pk_bf16_f32 v16, v52, v56
    v_cvt_pk_bf16_f32 v17, v53, v57
    v_pk_mul_f32 v[54:55], v[54:55], v[10:11] op_sel_hi:[1,0]
    v_pk_mul_f32 v[58:59], v[58:59], v[10:11] op_sel_hi:[1,0]
    v_cvt_pk_bf16_f32 v18, v54, v58
    v_cvt_pk_bf16_f32 v19, v55, v59
    ds_write_b128 v3, v[16:19] offset:22080
    ds_read_b128 v[64:67], v9 offset:25600
    v_mov_b64 v[12:13], 0
    v_mov_b64 v[14:15], 0
    v_mov_b64 v[20:21], 0
    v_mov_b64 v[22:23], 0
    v_mov_b64 v[24:25], 0
    v_mov_b64 v[26:27], 0
    v_mov_b64 v[32:33], 0
    v_mov_b64 v[34:35], 0
    v_mov_b64 v[44:45], 0
    v_mov_b64 v[46:47], 0
    v_mov_b64 v[48:49], 0
    v_mov_b64 v[50:51], 0
    s_waitcnt lgkmcnt(1)
    s_barrier
    ds_read_b128 v[52:55], v4 offset:22016
    ds_read_b128 v[56:59], v4 offset:22144
    v_mov_b64 v[68:69], 0
    v_mov_b64 v[70:71], 0
    v_mov_b64 v[28:29], 0
    v_mov_b64 v[30:31], 0
    v_mov_b64 v[16:17], 0
    v_mov_b64 v[18:19], 0
    s_cmp_eq_u32 s33, 63
    s_cbranch_scc1 Lr1f_last
    s_waitcnt lgkmcnt(1)
    v_smfmac_f32_16x16x64_bf16 v[28:31], v[52:55], v[60:67], v1
    ds_read_b128 v[60:63], v0 offset:32768
    s_waitcnt lgkmcnt(1)
    v_smfmac_f32_16x16x64_bf16 v[28:31], v[56:59], v[36:43], v1
    ds_read_b128 v[64:67], v0 offset:33792
    ds_read_b128 v[36:39], v9 offset:18432
    v_smfmac_f32_16x16x64_bf16 v[12:15], v[52:55], a[176:183], v1
    ds_read_b128 v[40:43], v9 offset:19456
    v_smfmac_f32_16x16x64_bf16 v[12:15], v[56:59], a[184:191], v1
    buffer_load_dwordx4 v0, s[8:11], s41 offen offset:0 lds
    v_smfmac_f32_16x16x64_bf16 v[20:23], v[52:55], a[192:199], v1
    s_nop 0
    v_add_f32 v28, v28, v30
    v_add_f32 v29, v29, v31
    s_waitcnt lgkmcnt(2)
    v_smfmac_f32_16x16x64_bf16 v[20:23], v[56:59], v[60:67], v1
    ds_read_b128 v[60:63], v9 offset:20480
    v_cvt_pk_bf16_f32 v28, v28, v29
    v_bfi_b32 v28, 1, s39, v28
    buffer_store_dword v28, v8, s[8:11], s38 offen offset:2048
    s_waitcnt lgkmcnt(1)
    v_smfmac_f32_16x16x64_bf16 v[24:27], v[52:55], v[36:43], v1
    ds_read_b128 v[64:67], v9 offset:21504
    ds_read_b128 v[36:39], v0 offset:34816
    v_add_f32 v12, v12, v14
    v_add_f32 v13, v13, v15
    v_smfmac_f32_16x16x64_bf16 v[24:27], v[56:59], a[200:207], v1
    ds_read_b128 v[40:43], v0 offset:35840
    v_cvt_pk_bf16_f32 v12, v12, v13
    v_bfi_b32 v12, 1, s39, v12
    v_smfmac_f32_16x16x64_bf16 v[32:35], v[52:55], a[208:215], v1
    buffer_load_dwordx4 v0, s[8:11], s41 offen offset:1024 lds
    v_add_f32 v20, v20, v22
    v_add_f32 v21, v21, v23
    v_smfmac_f32_16x16x64_bf16 v[32:35], v[56:59], a[216:223], v1
    v_cvt_pk_bf16_f32 v13, v20, v21
    s_waitcnt lgkmcnt(2)
    v_smfmac_f32_16x16x64_bf16 v[44:47], v[52:55], v[60:67], v1
    ds_read_b128 v[60:63], v0 offset:36864
    v_add_f32 v24, v24, v26
    v_add_f32 v25, v25, v27
    s_waitcnt lgkmcnt(1)
    v_smfmac_f32_16x16x64_bf16 v[44:47], v[56:59], v[36:43], v1
    ds_read_b128 v[64:67], v0 offset:37888
    ds_read_b128 v[36:39], v9 offset:22528
    v_cvt_pk_bf16_f32 v14, v24, v25
    v_smfmac_f32_16x16x64_bf16 v[48:51], v[52:55], a[224:231], v1
    ds_read_b128 v[40:43], v9 offset:23552
    v_add_f32 v32, v32, v34
    v_add_f32 v33, v33, v35
    v_smfmac_f32_16x16x64_bf16 v[48:51], v[56:59], a[232:239], v1
    v_cvt_pk_bf16_f32 v15, v32, v33
    buffer_store_dwordx4 v[12:15], v0, s[8:11], s38 offen offset:0
    v_smfmac_f32_16x16x64_bf16 v[68:71], v[52:55], a[240:247], v1
    v_add_f32 v44, v44, v46
    v_add_f32 v45, v45, v47
    s_waitcnt lgkmcnt(2)
    v_smfmac_f32_16x16x64_bf16 v[68:71], v[56:59], v[60:67], v1
    v_cvt_pk_bf16_f32 v44, v44, v45
    v_bfi_b32 v44, 1, s39, v44
    s_waitcnt lgkmcnt(0)
    v_smfmac_f32_16x16x64_bf16 v[16:19], v[52:55], v[36:43], v1
    v_add_f32 v48, v48, v50
    v_add_f32 v49, v49, v51
    v_smfmac_f32_16x16x64_bf16 v[16:19], v[56:59], a[248:255], v1
    v_cvt_pk_bf16_f32 v45, v48, v49
    v_add_f32 v68, v68, v70
    v_add_f32 v69, v69, v71
    v_cvt_pk_bf16_f32 v46, v68, v69
    s_nop 3
    v_add_f32 v16, v16, v18
    v_add_f32 v17, v17, v19
    v_cvt_pk_bf16_f32 v47, v16, v17
    buffer_store_dwordx4 v[44:47], v0, s[8:11], s38 offen offset:1024
    v_bfe_u32 v10, v0, 4, 4
    v_mov_b32 v11, 0x3f80
    v_mov_b32 v40, 0x3f800000
    v_cmp_eq_u32 vcc, 0, v10
    v_cmp_eq_u32 s[48:49], 1, v10
    s_nop 0
    v_cndmask_b32 v36, 0, v11, vcc
    v_cndmask_b32 v36, v36, v40, s[48:49]
    v_cmp_eq_u32 vcc, 2, v10
    v_cmp_eq_u32 s[48:49], 3, v10
    s_nop 0
    v_cndmask_b32 v37, 0, v11, vcc
    v_cndmask_b32 v37, v37, v40, s[48:49]
    v_cmp_eq_u32 vcc, 4, v10
    v_cmp_eq_u32 s[48:49], 5, v10
    s_nop 0
    v_cndmask_b32 v38, 0, v11, vcc
    v_cndmask_b32 v38, v38, v40, s[48:49]
    v_cmp_eq_u32 vcc, 6, v10
    v_cmp_eq_u32 s[48:49], 7, v10
    s_nop 0
    v_cndmask_b32 v39, 0, v11, vcc
    v_cndmask_b32 v39, v39, v40, s[48:49]
    s_sleep 5
    buffer_load_dwordx4 v[52:55], v6, s[8:11], s57 offen sc1
    buffer_load_dwordx4 v[56:59], v6, s[8:11], s58 offen sc1
    buffer_load_dwordx4 v[60:63], v6, s[8:11], s59 offen sc1
    buffer_load_dwordx4 v[64:67], v6, s[8:11], s60 offen sc1
    s_mov_b32 s16, 0
    s_mov_b64 s[70:71], 0
    s_mov_b64 s[72:73], 0
    s_mov_b64 s[74:75], 0
    s_mov_b64 s[76:77], 0
Lr1f_p1:
    s_mov_b64 exec, s[70:71]
    buffer_load_dwordx4 v[52:55], v6, s[8:11], s57 offen sc1
    s_mov_b64 exec, s[72:73]
    buffer_load_dwordx4 v[56:59], v6, s[8:11], s58 offen sc1
    s_mov_b64 exec, s[74:75]
    buffer_load_dwordx4 v[60:63], v6, s[8:11], s59 offen sc1
    s_mov_b64 exec, s[76:77]
    buffer_load_dwordx4 v[64:67], v6, s[8:11], s60 offen sc1
    s_mov_b64 exec, -1
    s_add_u32 s16, s16, 1
    s_cmp_gt_u32 s16, 100000
    s_cbranch_scc1 Lr_abort
    s_waitcnt vmcnt(7)
    v_and_b32 v11, 1, v52
    v_cmp_ne_u32 s[70:71], s39, v11
    v_mfma_f32_16x16x32_bf16 v[40:43], v[52:55], v[36:39], 0
    s_waitcnt vmcnt(6)
    v_and_b32 v11, 1, v56
    v_cmp_ne_u32 s[72:73], s39, v11
    v_mfma_f32_16x16x32_bf16 v[40:43], v[56:59], v[36:39], v[40:43]
    s_waitcnt vmcnt(5)
    v_and_b32 v11, 1, v60
    v_cmp_ne_u32 s[74:75], s39, v11
    v_mfma_f32_16x16x32_bf16 v[40:43], v[60:63], v[36:39], v[40:43]
    s_or_b64 vcc, s[70:71], s[72:73]
    s_waitcnt vmcnt(4)
    v_and_b32 v11, 1, v64
    v_cmp_ne_u32 s[76:77], s39, v11
    v_mfma_f32_16x16x32_bf16 v[40:43], v[64:67], v[36:39], v[40:43]
    s_or_b64 vcc, vcc, s[74:75]
    s_or_b64 vcc, vcc, s[76:77]
    s_cbranch_scc1 Lr1f_p1
    s_nop 4
    v_permlane16_swap_b32 v40, v42
    v_permlane16_swap_b32 v41, v43
    s_mov_b64 exec, s[50:51]
    v_add_f32 v40, v40, v42
    v_add_f32 v41, v41, v43
    v_cvt_pk_bf16_f32 v40, v40, v41
    v_min_u32 v40, s54, v40
    buffer_store_dword v40, v7, s[8:11], s36 offen
    v_mov_b32 v41, -1
    buffer_store_dword v41, v7, s[8:11], s37 offen
    s_mov_b64 exec, -1
    s_xor_b32 s34, s34, 16384
    s_xor_b32 s35, s35, 16384
    s_barrier
    s_sleep 2
    buffer_load_dwordx4 v[44:47], v0, s[8:11], s34 offen sc1
    buffer_load_dwordx4 v[48:51], v0, s[8:11], s34 offen offset:1024 sc1
    buffer_load_dword v10, v8, s[8:11], s35 offen sc1
    s_add_u32 s33, s33, 1
    s_bfe_u32 s39, s33, 0x10001
    s_xor_b32 s38, s38, 524288
    s_xor_b32 s57, s57, 524288
    s_xor_b32 s58, s58, 524288
    s_xor_b32 s59, s59, 524288
    s_xor_b32 s60, s60, 524288
    s_xor_b32 s36, s36, 16384
    s_xor_b32 s37, s37, 16384
    s_and_b32 s17, s33, 7
    s_mul_i32 s17, s17, 131072
    s_add_u32 s43, s45, s17
    s_bfe_u32 s66, s33, 65539
    s_add_u32 s67, s67, 22528
    s_add_u32 s42, s42, 262144
    s_add_u32 s41, s41, 262144
    s_add_u32 s40, s40, 262144
    s_add_u32 s44, s44, 22528
    s_waitcnt vmcnt(5)
    ds_read_b128 v[56:59], v9 offset:4096
    ds_read_b128 v[60:63], v9 offset:5120
    ds_read_b128 v[64:67], v9 offset:6144
    ds_read_b128 v[68:71], v9 offset:7168
    v_mov_b64 v[12:13], 0
    v_mov_b64 v[14:15], 0
    v_mov_b64 v[16:17], 0
    v_mov_b64 v[18:19], 0
    v_mov_b64 v[20:21], 0
    v_mov_b64 v[22:23], 0
    v_mov_b64 v[24:25], 0
    v_mov_b64 v[26:27], 0
    v_mov_b64 v[28:29], 0
    v_mov_b64 v[30:31], 0
    v_mov_b64 v[32:33], 0
    v_mov_b64 v[34:35], 0
    s_waitcnt lgkmcnt(0)
    s_branch Lr1f_step
Lr1f_last:
    s_waitcnt vmcnt(0) lgkmcnt(0)
    s_branch Lr_exit
L_w2_1:
    s_cmp_lg_u32 s14, 2
    s_cbranch_scc1 L_w3_1
    s_barrier
    s_mov_b32 m0, 13312
    s_nop 0
    buffer_load_dwordx4 v0, s[8:11], s41 offen offset:0 lds
    buffer_load_dwordx4 v0, s[8:11], s41 offen offset:1024 lds
    s_add_u32 s41, s41, 262144
    s_waitcnt vmcnt(0)
    buffer_load_dwordx4 v[44:47], v0, s[8:11], s34 offen sc1
    buffer_load_dwordx4 v[48:51], v0, s[8:11], s34 offen offset:1024 sc1
    buffer_load_dword v10, v8, s[8:11], s35 offen sc1
    ds_read_b128 v[56:59], v9 offset:8192
    ds_read_b128 v[60:63], v9 offset:9216
    ds_read_b128 v[64:67], v9 offset:10240
    ds_read_b128 v[68:71], v9 offset:11264
    v_mov_b64 v[12:13], 0
    v_mov_b64 v[14:15], 0
    v_mov_b64 v[16:17], 0
    v_mov_b64 v[18:19], 0
    v_mov_b64 v[20:21], 0
    v_mov_b64 v[22:23], 0
    v_mov_b64 v[24:25], 0
    v_mov_b64 v[26:27], 0
    v_mov_b64 v[28:29], 0
    v_mov_b64 v[30:31], 0
    v_mov_b64 v[32:33], 0
    v_mov_b64 v[34:35], 0
    s_waitcnt lgkmcnt(0)
Lr2f_step:
    s_mov_b32 s16, 0
    s_mov_b64 s[70:71], 0
    s_mov_b64 s[72:73], 0
    s_mov_b64 s[74:75], 0
Lr2f_p2:
    s_mov_b64 exec, s[70:71]
    buffer_load_dwordx4 v[44:47], v0, s[8:11], s34 offen sc1
    s_mov_b64 exec, s[72:73]
    buffer_load_dwordx4 v[48:51], v0, s[8:11], s34 offen offset:1024 sc1
    s_mov_b64 exec, s[74:75]
    buffer_load_dword v10, v8, s[8:11], s35 offen sc1
    s_mov_b64 exec, -1
    s_add_u32 s16, s16, 1
    s_cmp_gt_u32 s16, 100000
    s_cbranch_scc1 Lr_abort
    s_waitcnt vmcnt(5)
    v_max3_u32 v11, v44, v45, v46
    v_max_u32 v11, v11, v47
    v_cmp_eq_u32 s[70:71], -1, v11
    s_waitcnt vmcnt(4)
    v_max3_u32 v11, v48, v49, v50
    v_max_u32 v11, v11, v51
    v_cmp_eq_u32 s[72:73], -1, v11
    s_waitcnt vmcnt(3)
    v_cmp_eq_u32 s[74:75], -1, v10
    s_or_b64 vcc, s[70:71], s[72:73]
    s_or_b64 vcc, vcc, s[74:75]
    s_cbranch_scc1 Lr2f_p2
    v_smfmac_f32_16x16x64_bf16 v[12:15], v[44:47], v[232:239], v1
    ds_write_b128 v0, v[44:47] offset:4096
    v_smfmac_f32_16x16x64_bf16 v[16:19], v[44:47], v[240:247], v1
    ds_write_b128 v0, v[48:51] offset:5120
    v_smfmac_f32_16x16x64_bf16 v[20:23], v[44:47], v[248:255], v1
    ds_write_b32 v8, v10 offset:8704
    v_smfmac_f32_16x16x64_bf16 v[24:27], v[44:47], v[56:63], v1
    s_waitcnt lgkmcnt(0)
    s_barrier
    ds_read_b128 v[52:55], v0 offset:0
    v_smfmac_f32_16x16x64_bf16 v[12:15], v[48:51], a[16:23], v1
    ds_read_b128 v[36:39], v0 offset:1024
    v_smfmac_f32_16x16x64_bf16 v[16:19], v[48:51], a[24:31], v1
    ds_read_b128 v[56:59], v9 offset:0
    v_smfmac_f32_16x16x64_bf16 v[20:23], v[48:51], a[32:39], v1
    ds_read_b128 v[60:63], v9 offset:1024
    v_smfmac_f32_16x16x64_bf16 v[24:27], v[48:51], v[64:71], v1
    ds_read_b128 v[40:43], v0 offset:2048
    s_waitcnt lgkmcnt(4)
    v_smfmac_f32_16x16x64_bf16 v[12:15], v[52:55], v[72:79], v1
    v_smfmac_f32_16x16x64_bf16 v[16:19], v[52:55], v[80:87], v1
    ds_read_b128 v[64:67], v9 offset:2048
    v_smfmac_f32_16x16x64_bf16 v[20:23], v[52:55], v[88:95], v1
    ds_read_b128 v[68:71], v9 offset:3072
    s_waitcnt lgkmcnt(3)
    v_smfmac_f32_16x16x64_bf16 v[24:27], v[52:55], v[56:63], v1
    v_smfmac_f32_16x16x64_bf16 v[12:15], v[36:39], v[112:119], v1
    ds_read_b128 v[52:55], v0 offset:3072
    v_smfmac_f32_16x16x64_bf16 v[16:19], v[36:39], v[120:127], v1
    ds_read_b128 v[56:59], v9 offset:4096
    v_smfmac_f32_16x16x64_bf16 v[20:23], v[36:39], v[128:135], v1
    ds_read_b128 v[60:63], v9 offset:5120
    s_waitcnt lgkmcnt(3)
    v_smfmac_f32_16x16x64_bf16 v[24:27], v[36:39], v[64:71], v1
    v_smfmac_f32_16x16x64_bf16 v[12:15], v[40:43], v[152:159], v1
    buffer_load_dwordx4 v[36:39], v0, s[8:11], s42 offen
    v_smfmac_f32_16x16x64_bf16 v[16:19], v[40:43], v[160:167], v1
    ds_read_b128 v[64:67], v9 offset:6144
    v_smfmac_f32_16x16x64_bf16 v[20:23], v[40:43], v[168:175], v1
    ds_read_b128 v[68:71], v9 offset:7168
    s_waitcnt lgkmcnt(2)
    v_smfmac_f32_16x16x64_bf16 v[24:27], v[40:43], v[56:63], v1
    s_waitcnt vmcnt(1)
    ds_read_b128 v[44:47], v0 offset:6144
    v_smfmac_f32_16x16x64_bf16 v[12:15], v[52:55], v[192:199], v1
    buffer_load_dwordx4 v[40:43], v0, s[8:11], s42 offen offset:1024
    v_smfmac_f32_16x16x64_bf16 v[16:19], v[52:55], v[200:207], v1
    ds_read_b128 v[56:59], v9 offset:12288
    v_smfmac_f32_16x16x64_bf16 v[20:23], v[52:55], v[208:215], v1
    ds_read_b128 v[60:63], v9 offset:13312
    s_waitcnt lgkmcnt(3)
    v_smfmac_f32_16x16x64_bf16 v[24:27], v[52:55], v[64:71], v1
    ds_read_b128 v[48:51], v0 offset:7168
    s_waitcnt lgkmcnt(3)
    v_smfmac_f32_16x16x64_bf16 v[12:15], v[44:47], a[56:63], v1
    ds_read_b128 v[52:55], v0 offset:8192
    v_smfmac_f32_16x16x64_bf16 v[16:19], v[44:47], a[64:71], v1
    ds_read_b128 v[64:67], v9 offset:14336
    v_smfmac_f32_16x16x64_bf16 v[20:23], v[44:47], a[72:79], v1
    ds_read_b128 v[68:71], v9 offset:15360
    s_waitcnt lgkmcnt(4)
    v_smfmac_f32_16x16x64_bf16 v[24:27], v[44:47], v[56:63], v1
    s_waitcnt lgkmcnt(3)
    v_smfmac_f32_16x16x64_bf16 v[12:15], v[48:51], a[96:103], v1
    v_smfmac_f32_16x16x64_bf16 v[16:19], v[48:51], a[104:111], v1
    ds_read_b128 v[56:59], v9 offset:16384
    s_waitcnt lgkmcnt(3)
    v_smfmac_f32_16x16x64_bf16 v[12:15], v[52:55], a[136:143], v1
    ds_read_b128 v[60:63], v9 offset:17408
    v_smfmac_f32_16x16x64_bf16 v[16:19], v[52:55], a[144:151], v1
    v_smfmac_f32_16x16x64_bf16 v[20:23], v[48:51], a[112:119], v1
    s_waitcnt lgkmcnt(2)
    v_smfmac_f32_16x16x64_bf16 v[24:27], v[48:51], v[64:71], v1
    ds_read_b128 v[64:67], v0 offset:9216
    s_nop 1
    v_add_f32 v12, v12, v14
    v_smfmac_f32_16x16x64_bf16 v[20:23], v[52:55], a[152:159], v1
    ds_read_b128 v[68:71], v0 offset:10240
    v_add_f32 v16, v16, v18
    s_waitcnt lgkmcnt(2)
    v_smfmac_f32_16x16x64_bf16 v[24:27], v[52:55], v[56:63], v1
    ds_read_b128 v[56:59], v0 offset:11264
    v_add_f32 v13, v13, v15
    v_add_f32 v17, v17, v19
    v_cvt_pk_bf16_f32 v14, v12, v16
    v_cvt_pk_bf16_f32 v15, v13, v17
    ds_write_b32 v2, v14 offset:17408
    ds_write_b32 v2, v15 offset:17696
    v_smfmac_f32_16x16x64_bf16 v[28:31], v[52:55], a[160:167], v1
    ds_read_b128 v[60:63], v0 offset:12288
    v_add_f32 v20, v20, v22
    v_add_f32 v24, v24, v26
    v_add_f32 v21, v21, v23
    v_add_f32 v25, v25, v27
    v_smfmac_f32_16x16x64_bf16 v[32:35], v[52:55], a[168:175], v1
    ds_read_b128 v[12:15], v0 offset:4096
    v_cvt_pk_bf16_f32 v22, v20, v24
    v_cvt_pk_bf16_f32 v23, v21, v25
    ds_write_b32 v2, v22 offset:19712
    ds_write_b32 v2, v23 offset:20000
    v_smfmac_f32_16x16x64_bf16 v[28:31], v[48:51], a[120:127], v1
    ds_read_b128 v[16:19], v0 offset:5120
    v_smfmac_f32_16x16x64_bf16 v[32:35], v[48:51], a[128:135], v1
    ds_read_b128 v[20:23], v0 offset:0
    v_smfmac_f32_16x16x64_bf16 v[28:31], v[44:47], a[80:87], v1
    ds_read_b128 v[24:27], v0 offset:1024
    v_smfmac_f32_16x16x64_bf16 v[32:35], v[44:47], a[88:95], v1
    s_waitcnt lgkmcnt(3)
    s_barrier
    ds_read_b128 v[44:47], v3 offset:17408
    v_smfmac_f32_16x16x64_bf16 v[28:31], v[12:15], a[0:7], v1
    ds_read_b128 v[52:55], v0 offset:2048
    v_smfmac_f32_16x16x64_bf16 v[32:35], v[12:15], a[8:15], v1
    ds_read_b128 v[12:15], v3 offset:19712
    s_waitcnt lgkmcnt(5)
    v_smfmac_f32_16x16x64_bf16 v[28:31], v[16:19], a[40:47], v1
    ds_read_b128 v[48:51], v0 offset:3072
    v_smfmac_f32_16x16x64_bf16 v[32:35], v[16:19], a[48:55], v1
    s_waitcnt lgkmcnt(5)
    v_smfmac_f32_16x16x64_bf16 v[28:31], v[20:23], v[96:103], v1
    v_smfmac_f32_16x16x64_bf16 v[32:35], v[20:23], v[104:111], v1
    ds_read_b128 v[20:23], v3 offset:17472
    s_waitcnt lgkmcnt(5)
    v_smfmac_f32_16x16x64_bf16 v[28:31], v[24:27], v[136:143], v1
    v_smfmac_f32_16x16x64_bf16 v[32:35], v[24:27], v[144:151], v1
    s_waitcnt lgkmcnt(3)
    v_smfmac_f32_16x16x64_bf16 v[28:31], v[52:55], v[176:183], v1
    v_smfmac_f32_16x16x64_bf16 v[32:35], v[52:55], v[184:191], v1
    ds_read_b128 v[52:55], v3 offset:19776
    s_waitcnt lgkmcnt(2)
    v_smfmac_f32_16x16x64_bf16 v[28:31], v[48:51], v[216:223], v1
    v_smfmac_f32_16x16x64_bf16 v[32:35], v[48:51], v[224:231], v1
    ds_read_b128 v[48:51], v3 offset:17536
    v_mfma_f32_16x16x32_bf16 v[24:27], v[12:15], v[44:47], 0
    v_mfma_f32_16x16x32_bf16 v[12:15], v[64:67], v[44:47], 0
    ds_read_b128 v[64:67], v0 offset:13312
    v_mfma_f32_16x16x32_bf16 v[16:19], v[68:71], v[44:47], 0
    ds_read_b128 v[68:71], v0 offset:14336
    s_waitcnt lgkmcnt(3)
    v_mfma_f32_16x16x32_bf16 v[24:27], v[52:55], v[20:23], v[24:27]
    ds_read_b128 v[44:47], v3 offset:19840
    v_add_f32 v28, v28, v30
    v_add_f32 v29, v29, v31
    v_mfma_f32_16x16x32_bf16 v[12:15], v[56:59], v[20:23], v[12:15]
    ds_read_b128 v[52:55], v3 offset:17600
    v_add_f32 v32, v32, v34
    v_add_f32 v33, v33, v35
    v_mfma_f32_16x16x32_bf16 v[16:19], v[60:63], v[20:23], v[16:19]
    ds_read_b128 v[56:59], v0 offset:15360
    v_cvt_pk_bf16_f32 v30, v28, v29
    v_cvt_pk_bf16_f32 v31, v32, v33
    s_waitcnt lgkmcnt(2)
    v_mfma_f32_16x16x32_bf16 v[24:27], v[44:47], v[48:51], v[24:27]
    ds_read_b128 v[20:23], v3 offset:19904
    v_lshrrev_b32 v10, 8, v0
    v_mul_u32_u24 v10, 288, v10
    v_mfma_f32_16x16x32_bf16 v[12:15], v[64:67], v[48:51], v[12:15]
    ds_read_b128 v[60:63], v0 offset:16384
    v_and_b32 v11, 0xf0, v0
    v_add_u32 v10, v10, v11
    v_mfma_f32_16x16x32_bf16 v[16:19], v[68:71], v[48:51], v[16:19]
    ds_read_b128 v[32:35], v10 offset:20864
    v_lshrrev_b32 v11, 1, v0
    v_bfi_b32 v30, 1, s66, v30
    s_waitcnt lgkmcnt(2)
    v_mfma_f32_16x16x32_bf16 v[24:27], v[20:23], v[52:55], v[24:27]
    buffer_store_dwordx2 v[30:31], v11, s[8:11], s43 offen offset:2048 sc1
    v_mov_b32 v49, 0
    v_mov_b32 v50, 0
    v_mfma_f32_16x16x32_bf16 v[12:15], v[56:59], v[52:55], v[12:15]
    v_mov_b64 v[64:65], s[68:69]
    v_mov_b64 v[66:67], s[68:69]
    s_waitcnt lgkmcnt(1)
    v_mfma_f32_16x16x32_bf16 v[16:19], v[60:63], v[52:55], v[16:19]
    s_waitcnt lgkmcnt(0)
    v_bfi_b32 v32, 1, s66, v32
    s_mov_b64 exec, s[52:53]
    buffer_store_dwordx4 v[32:35], v0, s[8:11], s43 offen sc1
    s_mov_b64 exec, -1
    v_max3_f32 v10, v24, v25, v12
    v_max3_f32 v10, v10, v13, v14
    s_nop 0
    v_max3_f32 v10, v10, v15, v16
    v_max3_f32 v10, v10, v17, v18
    v_max_f32 v10, v10, v19
    v_mov_b32 v11, v10
    s_nop 1
    v_permlane32_swap_b32 v10, v11
    v_max_f32 v10, v10, v11
    v_mov_b32 v11, v10
    s_nop 1
    v_permlane16_swap_b32 v10, v11
    v_max_f32 v10, v10, v11
    v_mul_f32 v20, s46, v10
    v_pk_fma_f32 v[24:25], v[24:25], s[46:47], v[20:21] op_sel_hi:[1,1,0] neg_lo:[0,0,1] neg_hi:[0,0,1]
    v_pk_fma_f32 v[12:13], v[12:13], s[46:47], v[20:21] op_sel_hi:[1,1,0] neg_lo:[0,0,1] neg_hi:[0,0,1]
    v_exp_f32 v24, v24
    v_exp_f32 v25, v25
    v_pk_fma_f32 v[14:15], v[14:15], s[46:47], v[20:21] op_sel_hi:[1,1,0] neg_lo:[0,0,1] neg_hi:[0,0,1]
    v_exp_f32 v12, v12
    v_exp_f32 v13, v13
    v_pk_fma_f32 v[16:17], v[16:17], s[46:47], v[20:21] op_sel_hi:[1,1,0] neg_lo:[0,0,1] neg_hi:[0,0,1]
    v_cvt_pk_bf16_f32 v48, v24, v25
    v_exp_f32 v14, v14
    v_pk_fma_f32 v[18:19], v[18:19], s[46:47], v[20:21] op_sel_hi:[1,1,0] neg_lo:[0,0,1] neg_hi:[0,0,1]
    v_cvt_pk_bf16_f32 v51, v24, v25
    v_exp_f32 v15, v15
    v_cvt_pk_bf16_f32 v44, v12, v13
    v_exp_f32 v16, v16
    v_exp_f32 v17, v17
    v_cvt_pk_bf16_f32 v45, v14, v15
    v_exp_f32 v18, v18
    v_exp_f32 v19, v19
    v_cvt_pk_bf16_f32 v46, v16, v17
    v_cvt_pk_bf16_f32 v47, v18, v19
    v_mfma_f32_16x16x16_bf16 v[68:71], v[64:65], v[48:49], 0
    v_mfma_f32_16x16x16_bf16 v[52:55], v[30:31], v[48:49], 0
    v_mfma_f32_16x16x16_bf16 v[56:59], v[30:31], v[50:51], 0
    v_mfma_f32_16x16x32_bf16 v[68:71], v[64:67], v[44:47], v[68:71]
    s_waitcnt vmcnt(3)
    v_mfma_f32_16x16x32_bf16 v[52:55], v[36:39], v[44:47], v[52:55]
    s_waitcnt vmcnt(2)
    v_mfma_f32_16x16x32_bf16 v[56:59], v[40:43], v[44:47], v[56:59]
    ds_read_b128 v[36:39], v0 offset:47104
    ds_read_b128 v[40:43], v0 offset:48128
    ds_read_b128 v[60:63], v9 offset:24576
    s_nop 0
    v_rcp_f32 v10, v68
    s_nop 0
    v_pk_mul_f32 v[52:53], v[52:53], v[10:11] op_sel_hi:[1,0]
    s_nop 0
    v_pk_mul_f32 v[56:57], v[56:57], v[10:11] op_sel_hi:[1,0]
    v_cvt_pk_bf16_f32 v16, v52, v56
    v_cvt_pk_bf16_f32 v17, v53, v57
    v_pk_mul_f32 v[54:55], v[54:55], v[10:11] op_sel_hi:[1,0]
    v_pk_mul_f32 v[58:59], v[58:59], v[10:11] op_sel_hi:[1,0]
    v_cvt_pk_bf16_f32 v18, v54, v58
    v_cvt_pk_bf16_f32 v19, v55, v59
    ds_write_b128 v3, v[16:19] offset:22144
    ds_read_b128 v[64:67], v9 offset:25600
    v_mov_b64 v[12:13], 0
    v_mov_b64 v[14:15], 0
    v_mov_b64 v[20:21], 0
    v_mov_b64 v[22:23], 0
    v_mov_b64 v[24:25], 0
    v_mov_b64 v[26:27], 0
    v_mov_b64 v[32:33], 0
    v_mov_b64 v[34:35], 0
    v_mov_b64 v[44:45], 0
    v_mov_b64 v[46:47], 0
    v_mov_b64 v[48:49], 0
    v_mov_b64 v[50:51], 0
    s_waitcnt lgkmcnt(1)
    s_barrier
    ds_read_b128 v[52:55], v4 offset:22016
    ds_read_b128 v[56:59], v4 offset:22144
    v_mov_b64 v[68:69], 0
    v_mov_b64 v[70:71], 0
    v_mov_b64 v[28:29], 0
    v_mov_b64 v[30:31], 0
    v_mov_b64 v[16:17], 0
    v_mov_b64 v[18:19], 0
    s_cmp_eq_u32 s33, 63
    s_cbranch_scc1 Lr2f_last
    s_waitcnt lgkmcnt(1)
    v_smfmac_f32_16x16x64_bf16 v[28:31], v[52:55], v[60:67], v1
    ds_read_b128 v[60:63], v0 offset:40960
    s_waitcnt lgkmcnt(1)
    v_smfmac_f32_16x16x64_bf16 v[28:31], v[56:59], v[36:43], v1
    ds_read_b128 v[64:67], v0 offset:41984
    ds_read_b128 v[36:39], v9 offset:18432
    v_smfmac_f32_16x16x64_bf16 v[12:15], v[52:55], a[176:183], v1
    ds_read_b128 v[40:43], v9 offset:19456
    v_smfmac_f32_16x16x64_bf16 v[12:15], v[56:59], a[184:191], v1
    buffer_load_dwordx4 v0, s[8:11], s41 offen offset:0 lds
    v_smfmac_f32_16x16x64_bf16 v[20:23], v[52:55], a[192:199], v1
    s_nop 0
    v_add_f32 v28, v28, v30
    v_add_f32 v29, v29, v31
    s_waitcnt lgkmcnt(2)
    v_smfmac_f32_16x16x64_bf16 v[20:23], v[56:59], v[60:67], v1
    ds_read_b128 v[60:63], v9 offset:20480
    v_cvt_pk_bf16_f32 v28, v28, v29
    v_bfi_b32 v28, 1, s39, v28
    buffer_store_dword v28, v8, s[8:11], s38 offen offset:2048
    s_waitcnt lgkmcnt(1)
    v_smfmac_f32_16x16x64_bf16 v[24:27], v[52:55], v[36:43], v1
    ds_read_b128 v[64:67], v9 offset:21504
    ds_read_b128 v[36:39], v0 offset:43008
    v_add_f32 v12, v12, v14
    v_add_f32 v13, v13, v15
    v_smfmac_f32_16x16x64_bf16 v[24:27], v[56:59], a[200:207], v1
    ds_read_b128 v[40:43], v0 offset:44032
    v_cvt_pk_bf16_f32 v12, v12, v13
    v_bfi_b32 v12, 1, s39, v12
    v_smfmac_f32_16x16x64_bf16 v[32:35], v[52:55], a[208:215], v1
    buffer_load_dwordx4 v0, s[8:11], s41 offen offset:1024 lds
    v_add_f32 v20, v20, v22
    v_add_f32 v21, v21, v23
    v_smfmac_f32_16x16x64_bf16 v[32:35], v[56:59], a[216:223], v1
    v_cvt_pk_bf16_f32 v13, v20, v21
    s_waitcnt lgkmcnt(2)
    v_smfmac_f32_16x16x64_bf16 v[44:47], v[52:55], v[60:67], v1
    ds_read_b128 v[60:63], v0 offset:45056
    v_add_f32 v24, v24, v26
    v_add_f32 v25, v25, v27
    s_waitcnt lgkmcnt(1)
    v_smfmac_f32_16x16x64_bf16 v[44:47], v[56:59], v[36:43], v1
    ds_read_b128 v[64:67], v0 offset:46080
    ds_read_b128 v[36:39], v9 offset:22528
    v_cvt_pk_bf16_f32 v14, v24, v25
    v_smfmac_f32_16x16x64_bf16 v[48:51], v[52:55], a[224:231], v1
    ds_read_b128 v[40:43], v9 offset:23552
    v_add_f32 v32, v32, v34
    v_add_f32 v33, v33, v35
    v_smfmac_f32_16x16x64_bf16 v[48:51], v[56:59], a[232:239], v1
    v_cvt_pk_bf16_f32 v15, v32, v33
    buffer_store_dwordx4 v[12:15], v0, s[8:11], s38 offen offset:0
    v_smfmac_f32_16x16x64_bf16 v[68:71], v[52:55], a[240:247], v1
    v_add_f32 v44, v44, v46
    v_add_f32 v45, v45, v47
    s_waitcnt lgkmcnt(2)
    v_smfmac_f32_16x16x64_bf16 v[68:71], v[56:59], v[60:67], v1
    v_cvt_pk_bf16_f32 v44, v44, v45
    v_bfi_b32 v44, 1, s39, v44
    s_waitcnt lgkmcnt(0)
    v_smfmac_f32_16x16x64_bf16 v[16:19], v[52:55], v[36:43], v1
    v_add_f32 v48, v48, v50
    v_add_f32 v49, v49, v51
    v_smfmac_f32_16x16x64_bf16 v[16:19], v[56:59], a[248:255], v1
    v_cvt_pk_bf16_f32 v45, v48, v49
    v_add_f32 v68, v68, v70
    v_add_f32 v69, v69, v71
    v_cvt_pk_bf16_f32 v46, v68, v69
    s_nop 3
    v_add_f32 v16, v16, v18
    v_add_f32 v17, v17, v19
    v_cvt_pk_bf16_f32 v47, v16, v17
    buffer_store_dwordx4 v[44:47], v0, s[8:11], s38 offen offset:1024
    s_cmp_eq_u32 s62, 0
    s_cbranch_scc1 Lr2f_nojob
    v_bfe_u32 v10, v0, 4, 4
    v_mov_b32 v11, 0x3f80
    v_mov_b32 v40, 0x3f800000
    v_cmp_eq_u32 vcc, 0, v10
    v_cmp_eq_u32 s[48:49], 1, v10
    s_nop 0
    v_cndmask_b32 v36, 0, v11, vcc
    v_cndmask_b32 v36, v36, v40, s[48:49]
    v_cmp_eq_u32 vcc, 2, v10
    v_cmp_eq_u32 s[48:49], 3, v10
    s_nop 0
    v_cndmask_b32 v37, 0, v11, vcc
    v_cndmask_b32 v37, v37, v40, s[48:49]
    v_cmp_eq_u32 vcc, 4, v10
    v_cmp_eq_u32 s[48:49], 5, v10
    s_nop 0
    v_cndmask_b32 v38, 0, v11, vcc
    v_cndmask_b32 v38, v38, v40, s[48:49]
    v_cmp_eq_u32 vcc, 6, v10
    v_cmp_eq_u32 s[48:49], 7, v10
    s_nop 0
    v_cndmask_b32 v39, 0, v11, vcc
    v_cndmask_b32 v39, v39, v40, s[48:49]
    s_sleep 5
    buffer_load_dwordx4 v[52:55], v6, s[8:11], s57 offen sc1
    buffer_load_dwordx4 v[56:59], v6, s[8:11], s58 offen sc1
    buffer_load_dwordx4 v[60:63], v6, s[8:11], s59 offen sc1
    buffer_load_dwordx4 v[64:67], v6, s[8:11], s60 offen sc1
    s_mov_b32 s16, 0
    s_mov_b64 s[70:71], 0
    s_mov_b64 s[72:73], 0
    s_mov_b64 s[74:75], 0
    s_mov_b64 s[76:77], 0
Lr2f_p1:
    s_mov_b64 exec, s[70:71]
    buffer_load_dwordx4 v[52:55], v6, s[8:11], s57 offen sc1
    s_mov_b64 exec, s[72:73]
    buffer_load_dwordx4 v[56:59], v6, s[8:11], s58 offen sc1
    s_mov_b64 exec, s[74:75]
    buffer_load_dwordx4 v[60:63], v6, s[8:11], s59 offen sc1
    s_mov_b64 exec, s[76:77]
    buffer_load_dwordx4 v[64:67], v6, s[8:11], s60 offen sc1
    s_mov_b64 exec, -1
    s_add_u32 s16, s16, 1
    s_cmp_gt_u32 s16, 100000
    s_cbranch_scc1 Lr_abort
    s_waitcnt vmcnt(7)
    v_xor_b32 v10, v52, v53
    v_xor_b32 v11, v54, v55
    v_or_b32 v10, v10, v11
    v_xor_b32 v11, v52, v54
    v_or_b32 v10, v10, v11
    v_xor_b32 v11, s39, v52
    v_or_b32 v10, v10, v11
    v_and_b32 v10, 1, v10
    v_cmp_ne_u32 s[70:71], 0, v10
    v_mfma_f32_16x16x32_bf16 v[40:43], v[52:55], v[36:39], 0
    s_waitcnt vmcnt(6)
    v_xor_b32 v10, v56, v57
    v_xor_b32 v11, v58, v59
    v_or_b32 v10, v10, v11
    v_xor_b32 v11, v56, v58
    v_or_b32 v10, v10, v11
    v_xor_b32 v11, s39, v56
    v_or_b32 v10, v10, v11
    v_and_b32 v10, 1, v10
    v_cmp_ne_u32 s[72:73], 0, v10
    v_mfma_f32_16x16x32_bf16 v[40:43], v[56:59], v[36:39], v[40:43]
    s_waitcnt vmcnt(5)
    v_xor_b32 v10, v60, v61
    v_xor_b32 v11, v62, v63
    v_or_b32 v10, v10, v11
    v_xor_b32 v11, v60, v62
    v_or_b32 v10, v10, v11
    v_xor_b32 v11, s39, v60
    v_or_b32 v10, v10, v11
    v_and_b32 v10, 1, v10
    v_cmp_ne_u32 s[74:75], 0, v10
    v_mfma_f32_16x16x32_bf16 v[40:43], v[60:63], v[36:39], v[40:43]
    s_or_b64 vcc, s[70:71], s[72:73]
    s_waitcnt vmcnt(4)
    v_xor_b32 v10, v64, v65
    v_xor_b32 v11, v66, v67
    v_or_b32 v10, v10, v11
    v_xor_b32 v11, v64, v66
    v_or_b32 v10, v10, v11
    v_xor_b32 v11, s39, v64
    v_or_b32 v10, v10, v11
    v_and_b32 v10, 1, v10
    v_cmp_ne_u32 s[76:77], 0, v10
    v_mfma_f32_16x16x32_bf16 v[40:43], v[64:67], v[36:39], v[40:43]
    s_or_b64 vcc, vcc, s[74:75]
    s_or_b64 vcc, vcc, s[76:77]
    s_cbranch_scc1 Lr2f_p1
    s_nop 4
    v_permlane16_swap_b32 v40, v42
    v_permlane16_swap_b32 v41, v43
    s_mov_b64 exec, s[50:51]
    v_add_f32 v40, v40, v42
    v_add_f32 v41, v41, v43
    v_cvt_pk_bf16_f32 v40, v40, v41
    v_min_u32 v40, s54, v40
    buffer_store_dword v40, v7, s[8:11], s36 offen
    v_mov_b32 v41, -1
    buffer_store_dword v41, v7, s[8:11], s37 offen
    s_mov_b64 exec, -1
    s_branch Lr2f_jobdone
Lr2f_nojob:
Lr2f_jobdone:
    s_xor_b32 s34, s34, 16384
    s_xor_b32 s35, s35, 16384
    s_barrier
    s_sleep 2
    buffer_load_dwordx4 v[44:47], v0, s[8:11], s34 offen sc1
    buffer_load_dwordx4 v[48:51], v0, s[8:11], s34 offen offset:1024 sc1
    buffer_load_dword v10, v8, s[8:11], s35 offen sc1
    s_add_u32 s33, s33, 1
    s_bfe_u32 s39, s33, 0x10001
    s_xor_b32 s38, s38, 524288
    s_xor_b32 s57, s57, 524288
    s_xor_b32 s58, s58, 524288
    s_xor_b32 s59, s59, 524288
    s_xor_b32 s60, s60, 524288
    s_xor_b32 s36, s36, 16384
    s_xor_b32 s37, s37, 16384
    s_and_b32 s17, s33, 7
    s_mul_i32 s17, s17, 131072
    s_add_u32 s43, s45, s17
    s_bfe_u32 s66, s33, 65539
    s_add_u32 s67, s67, 22528
    s_add_u32 s42, s42, 262144
    s_add_u32 s41, s41, 262144
    s_add_u32 s40, s40, 262144
    s_add_u32 s44, s44, 22528
    s_waitcnt vmcnt(6)
    ds_read_b128 v[56:59], v9 offset:8192
    ds_read_b128 v[60:63], v9 offset:9216
    ds_read_b128 v[64:67], v9 offset:10240
    ds_read_b128 v[68:71], v9 offset:11264
    v_mov_b64 v[12:13], 0
    v_mov_b64 v[14:15], 0
    v_mov_b64 v[16:17], 0
    v_mov_b64 v[18:19], 0
    v_mov_b64 v[20:21], 0
    v_mov_b64 v[22:23], 0
    v_mov_b64 v[24:25], 0
    v_mov_b64 v[26:27], 0
    v_mov_b64 v[28:29], 0
    v_mov_b64 v[30:31], 0
    v_mov_b64 v[32:33], 0
    v_mov_b64 v[34:35], 0
    s_waitcnt lgkmcnt(0)
    s_branch Lr2f_step
Lr2f_last:
    s_waitcnt vmcnt(0) lgkmcnt(0)
    s_branch Lr_exit
L_w3_1:
    s_mov_b32 s16, 0
    s_add_u32 s17, s44, 128
    v_and_b32 v11, 16, v8
    v_lshlrev_b32 v11, 3, v11
    v_and_or_b32 v11, v8, 12, v11
Lr3f_fw_10:
    buffer_load_dword v10, v11, s[8:11], s17 offen sc1
    s_add_u32 s16, s16, 1
    s_cmp_gt_u32 s16, 100000
    s_cbranch_scc1 Lr_abort
    s_waitcnt vmcnt(0)
    v_cmp_eq_u32 vcc, 0, v10
    s_nop 0
    s_cbranch_vccz Lr3f_fw_10d
    s_sleep 4
    s_branch Lr3f_fw_10
Lr3f_fw_10d:
    s_barrier
    s_mov_b32 m0, 15360
    s_nop 0
    buffer_load_dwordx4 v0, s[8:11], s41 offen offset:0 lds
    buffer_load_dwordx4 v0, s[8:11], s41 offen offset:1024 lds
    s_add_u32 s41, s41, 262144
    s_waitcnt vmcnt(0)
    buffer_load_dwordx4 v[44:47], v0, s[8:11], s34 offen sc1
    buffer_load_dwordx4 v[48:51], v0, s[8:11], s34 offen offset:1024 sc1
    buffer_load_dword v10, v8, s[8:11], s35 offen sc1
    ds_read_b128 v[56:59], v9 offset:12288
    ds_read_b128 v[60:63], v9 offset:13312
    ds_read_b128 v[64:67], v9 offset:14336
    ds_read_b128 v[68:71], v9 offset:15360
    v_mov_b64 v[12:13], 0
    v_mov_b64 v[14:15], 0
    v_mov_b64 v[16:17], 0
    v_mov_b64 v[18:19], 0
    v_mov_b64 v[20:21], 0
    v_mov_b64 v[22:23], 0
    v_mov_b64 v[24:25], 0
    v_mov_b64 v[26:27], 0
    v_mov_b64 v[28:29], 0
    v_mov_b64 v[30:31], 0
    v_mov_b64 v[32:33], 0
    v_mov_b64 v[34:35], 0
    s_waitcnt lgkmcnt(0)
Lr3f_step:
    s_mov_b32 s16, 0
    s_mov_b64 s[70:71], 0
    s_mov_b64 s[72:73], 0
    s_mov_b64 s[74:75], 0
Lr3f_p2:
    s_mov_b64 exec, s[70:71]
    buffer_load_dwordx4 v[44:47], v0, s[8:11], s34 offen sc1
    s_mov_b64 exec, s[72:73]
    buffer_load_dwordx4 v[48:51], v0, s[8:11], s34 offen offset:1024 sc1
    s_mov_b64 exec, s[74:75]
    buffer_load_dword v10, v8, s[8:11], s35 offen sc1
    s_mov_b64 exec, -1
    s_add_u32 s16, s16, 1
    s_cmp_gt_u32 s16, 100000
    s_cbranch_scc1 Lr_abort
    s_waitcnt vmcnt(5)
    v_max3_u32 v11, v44, v45, v46
    v_max_u32 v11, v11, v47
    v_cmp_eq_u32 s[70:71], -1, v11
    s_waitcnt vmcnt(4)
    v_max3_u32 v11, v48, v49, v50
    v_max_u32 v11, v11, v51
    v_cmp_eq_u32 s[72:73], -1, v11
    s_waitcnt vmcnt(3)
    v_cmp_eq_u32 s[74:75], -1, v10
    s_or_b64 vcc, s[70:71], s[72:73]
    s_or_b64 vcc, vcc, s[74:75]
    s_cbranch_scc1 Lr3f_p2
    v_smfmac_f32_16x16x64_bf16 v[12:15], v[44:47], a[56:63], v1
    ds_write_b128 v0, v[44:47] offset:6144
    v_smfmac_f32_16x16x64_bf16 v[16:19], v[44:47], a[64:71], v1
    ds_write_b128 v0, v[48:51] offset:7168
    v_smfmac_f32_16x16x64_bf16 v[20:23], v[44:47], a[72:79], v1
    ds_write_b32 v8, v10 offset:8960
    v_smfmac_f32_16x16x64_bf16 v[24:27], v[44:47], v[56:63], v1
    s_waitcnt lgkmcnt(0)
    s_barrier
    ds_read_b128 v[52:55], v0 offset:0
    v_smfmac_f32_16x16x64_bf16 v[12:15], v[48:51], a[96:103], v1
    ds_read_b128 v[36:39], v0 offset:1024
    v_smfmac_f32_16x16x64_bf16 v[16:19], v[48:51], a[104:111], v1
    ds_read_b128 v[56:59], v9 offset:0
    v_smfmac_f32_16x16x64_bf16 v[20:23], v[48:51], a[112:119], v1
    ds_read_b128 v[60:63], v9 offset:1024
    v_smfmac_f32_16x16x64_bf16 v[24:27], v[48:51], v[64:71], v1
    ds_read_b128 v[40:43], v0 offset:2048
    s_waitcnt lgkmcnt(4)
    v_smfmac_f32_16x16x64_bf16 v[12:15], v[52:55], v[72:79], v1
    buffer_load_dword v6, v7, s[8:11], s67 offen sc1
    v_smfmac_f32_16x16x64_bf16 v[16:19], v[52:55], v[80:87], v1
    ds_read_b128 v[64:67], v9 offset:2048
    v_smfmac_f32_16x16x64_bf16 v[20:23], v[52:55], v[88:95], v1
    ds_read_b128 v[68:71], v9 offset:3072
    s_waitcnt lgkmcnt(3)
    v_smfmac_f32_16x16x64_bf16 v[24:27], v[52:55], v[56:63], v1
    v_smfmac_f32_16x16x64_bf16 v[12:15], v[36:39], v[112:119], v1
    ds_read_b128 v[52:55], v0 offset:3072
    v_smfmac_f32_16x16x64_bf16 v[16:19], v[36:39], v[120:127], v1
    ds_read_b128 v[56:59], v9 offset:4096
    v_smfmac_f32_16x16x64_bf16 v[20:23], v[36:39], v[128:135], v1
    ds_read_b128 v[60:63], v9 offset:5120
    s_waitcnt lgkmcnt(3)
    v_smfmac_f32_16x16x64_bf16 v[24:27], v[36:39], v[64:71], v1
    v_smfmac_f32_16x16x64_bf16 v[12:15], v[40:43], v[152:159], v1
    buffer_load_dwordx4 v[36:39], v0, s[8:11], s42 offen
    v_smfmac_f32_16x16x64_bf16 v[16:19], v[40:43], v[160:167], v1
    ds_read_b128 v[64:67], v9 offset:6144
    v_smfmac_f32_16x16x64_bf16 v[20:23], v[40:43], v[168:175], v1
    ds_read_b128 v[68:71], v9 offset:7168
    s_waitcnt lgkmcnt(2)
    v_smfmac_f32_16x16x64_bf16 v[24:27], v[40:43], v[56:63], v1
    s_waitcnt vmcnt(2)
    ds_read_b128 v[44:47], v0 offset:4096
    v_smfmac_f32_16x16x64_bf16 v[12:15], v[52:55], v[192:199], v1
    buffer_load_dwordx4 v[40:43], v0, s[8:11], s42 offen offset:1024
    v_smfmac_f32_16x16x64_bf16 v[16:19], v[52:55], v[200:207], v1
    ds_read_b128 v[56:59], v9 offset:8192
    v_smfmac_f32_16x16x64_bf16 v[20:23], v[52:55], v[208:215], v1
    ds_read_b128 v[60:63], v9 offset:9216
    s_waitcnt lgkmcnt(3)
    v_smfmac_f32_16x16x64_bf16 v[24:27], v[52:55], v[64:71], v1
    ds_read_b128 v[48:51], v0 offset:5120
    s_waitcnt lgkmcnt(3)
    v_smfmac_f32_16x16x64_bf16 v[12:15], v[44:47], v[232:239], v1
    ds_read_b128 v[52:55], v0 offset:8192
    v_smfmac_f32_16x16x64_bf16 v[16:19], v[44:47], v[240:247], v1
    ds_read_b128 v[64:67], v9 offset:10240
    v_smfmac_f32_16x16x64_bf16 v[20:23], v[44:47], v[248:255], v1
    ds_read_b128 v[68:71], v9 offset:11264
    s_waitcnt lgkmcnt(4)
    v_smfmac_f32_16x16x64_bf16 v[24:27], v[44:47], v[56:63], v1
    s_waitcnt lgkmcnt(3)
    v_smfmac_f32_16x16x64_bf16 v[12:15], v[48:51], a[16:23], v1
    v_smfmac_f32_16x16x64_bf16 v[16:19], v[48:51], a[24:31], v1
    ds_read_b128 v[56:59], v9 offset:16384
    s_waitcnt lgkmcnt(3)
    v_smfmac_f32_16x16x64_bf16 v[12:15], v[52:55], a[136:143], v1
    ds_read_b128 v[60:63], v9 offset:17408
    v_smfmac_f32_16x16x64_bf16 v[16:19], v[52:55], a[144:151], v1
    v_smfmac_f32_16x16x64_bf16 v[20:23], v[48:51], a[32:39], v1
    s_waitcnt lgkmcnt(2)
    v_smfmac_f32_16x16x64_bf16 v[24:27], v[48:51], v[64:71], v1
    ds_read_b128 v[64:67], v0 offset:9216
    s_nop 1
    v_add_f32 v12, v12, v14
    v_smfmac_f32_16x16x64_bf16 v[20:23], v[52:55], a[152:159], v1
    ds_read_b128 v[68:71], v0 offset:10240
    v_add_f32 v16, v16, v18
    s_waitcnt lgkmcnt(2)
    v_smfmac_f32_16x16x64_bf16 v[24:27], v[52:55], v[56:63], v1
    ds_read_b128 v[56:59], v0 offset:11264
    v_add_f32 v13, v13, v15
    v_add_f32 v17, v17, v19
    v_cvt_pk_bf16_f32 v14, v12, v16
    v_cvt_pk_bf16_f32 v15, v13, v17
    ds_write_b32 v2, v14 offset:17408
    ds_write_b32 v2, v15 offset:17696
    v_smfmac_f32_16x16x64_bf16 v[28:31], v[52:55], a[160:167], v1
    ds_read_b128 v[60:63], v0 offset:12288
    v_add_f32 v20, v20, v22
    v_add_f32 v24, v24, v26
    v_add_f32 v21, v21, v23
    v_add_f32 v25, v25, v27
    v_smfmac_f32_16x16x64_bf16 v[32:35], v[52:55], a[168:175], v1
    ds_read_b128 v[12:15], v0 offset:6144
    v_cvt_pk_bf16_f32 v22, v20, v24
    v_cvt_pk_bf16_f32 v23, v21, v25
    ds_write_b32 v2, v22 offset:19712
    ds_write_b32 v2, v23 offset:20000
    v_smfmac_f32_16x16x64_bf16 v[28:31], v[48:51], a[40:47], v1
    ds_read_b128 v[16:19], v0 offset:7168
    v_smfmac_f32_16x16x64_bf16 v[32:35], v[48:51], a[48:55], v1
    ds_read_b128 v[20:23], v0 offset:0
    v_smfmac_f32_16x16x64_bf16 v[28:31], v[44:47], a[0:7], v1
    ds_read_b128 v[24:27], v0 offset:1024
    v_smfmac_f32_16x16x64_bf16 v[32:35], v[44:47], a[8:15], v1
    s_waitcnt lgkmcnt(3)
    s_barrier
    ds_read_b128 v[44:47], v3 offset:17408
    v_smfmac_f32_16x16x64_bf16 v[28:31], v[12:15], a[80:87], v1
    ds_read_b128 v[52:55], v0 offset:2048
    v_smfmac_f32_16x16x64_bf16 v[32:35], v[12:15], a[88:95], v1
    ds_read_b128 v[12:15], v3 offset:19712
    s_waitcnt lgkmcnt(5)
    v_smfmac_f32_16x16x64_bf16 v[28:31], v[16:19], a[120:127], v1
    ds_read_b128 v[48:51], v0 offset:3072
    v_smfmac_f32_16x16x64_bf16 v[32:35], v[16:19], a[128:135], v1
    s_waitcnt lgkmcnt(5)
    v_smfmac_f32_16x16x64_bf16 v[28:31], v[20:23], v[96:103], v1
    v_smfmac_f32_16x16x64_bf16 v[32:35], v[20:23], v[104:111], v1
    ds_read_b128 v[20:23], v3 offset:17472
    s_waitcnt lgkmcnt(5)
    v_smfmac_f32_16x16x64_bf16 v[28:31], v[24:27], v[136:143], v1
    v_smfmac_f32_16x16x64_bf16 v[32:35], v[24:27], v[144:151], v1
    s_waitcnt lgkmcnt(3)
    v_smfmac_f32_16x16x64_bf16 v[28:31], v[52:55], v[176:183], v1
    v_smfmac_f32_16x16x64_bf16 v[32:35], v[52:55], v[184:191], v1
    ds_read_b128 v[52:55], v3 offset:19776
    s_waitcnt lgkmcnt(2)
    v_smfmac_f32_16x16x64_bf16 v[28:31], v[48:51], v[216:223], v1
    v_smfmac_f32_16x16x64_bf16 v[32:35], v[48:51], v[224:231], v1
    ds_read_b128 v[48:51], v3 offset:17536
    v_mfma_f32_16x16x32_bf16 v[24:27], v[12:15], v[44:47], 0
    s_waitcnt vmcnt(2)
    v_cmp_eq_u32 vcc, 0, v6
    s_nop 0
    s_and_b64 vcc, vcc, s[78:79]
    s_cbranch_scc1 Lr3f_flbad
Lr3f_flok:
    buffer_load_dword v6, v5, s[8:11], s40 offen
    buffer_load_dword v6, v5, s[8:11], s56 offen
    v_mfma_f32_16x16x32_bf16 v[12:15], v[64:67], v[44:47], 0
    ds_read_b128 v[64:67], v0 offset:13312
    v_mfma_f32_16x16x32_bf16 v[16:19], v[68:71], v[44:47], 0
    ds_read_b128 v[68:71], v0 offset:14336
    s_waitcnt lgkmcnt(3)
    v_mfma_f32_16x16x32_bf16 v[24:27], v[52:55], v[20:23], v[24:27]
    ds_read_b128 v[44:47], v3 offset:19840
    v_add_f32 v28, v28, v30
    v_add_f32 v29, v29, v31
    v_mfma_f32_16x16x32_bf16 v[12:15], v[56:59], v[20:23], v[12:15]
    ds_read_b128 v[52:55], v3 offset:17600
    v_add_f32 v32, v32, v34
    v_add_f32 v33, v33, v35
    v_mfma_f32_16x16x32_bf16 v[16:19], v[60:63], v[20:23], v[16:19]
    ds_read_b128 v[56:59], v0 offset:15360
    v_cvt_pk_bf16_f32 v30, v28, v29
    v_cvt_pk_bf16_f32 v31, v32, v33
    s_waitcnt lgkmcnt(2)
    v_mfma_f32_16x16x32_bf16 v[24:27], v[44:47], v[48:51], v[24:27]
    ds_read_b128 v[20:23], v3 offset:19904
    v_lshrrev_b32 v10, 8, v0
    v_mul_u32_u24 v10, 288, v10
    v_mfma_f32_16x16x32_bf16 v[12:15], v[64:67], v[48:51], v[12:15]
    ds_read_b128 v[60:63], v0 offset:16384
    v_and_b32 v11, 0xf0, v0
    v_add_u32 v10, v10, v11
    v_mfma_f32_16x16x32_bf16 v[16:19], v[68:71], v[48:51], v[16:19]
    ds_read_b128 v[32:35], v10 offset:21440
    v_lshrrev_b32 v11, 1, v0
    v_bfi_b32 v30, 1, s66, v30
    s_waitcnt lgkmcnt(2)
    v_mfma_f32_16x16x32_bf16 v[24:27], v[20:23], v[52:55], v[24:27]
    buffer_store_dwordx2 v[30:31], v11, s[8:11], s43 offen offset:2048 sc1
    v_mov_b32 v49, 0
    v_mov_b32 v50, 0
    v_mfma_f32_16x16x32_bf16 v[12:15], v[56:59], v[52:55], v[12:15]
    v_mov_b64 v[64:65], s[68:69]
    v_mov_b64 v[66:67], s[68:69]
    s_waitcnt lgkmcnt(1)
    v_mfma_f32_16x16x32_bf16 v[16:19], v[60:63], v[52:55], v[16:19]
    s_waitcnt lgkmcnt(0)
    v_bfi_b32 v32, 1, s66, v32
    s_mov_b64 exec, s[52:53]
    buffer_store_dwordx4 v[32:35], v0, s[8:11], s43 offen sc1
    s_mov_b64 exec, -1
    v_max3_f32 v10, v24, v25, v12
    v_max3_f32 v10, v10, v13, v14
    s_nop 0
    v_max3_f32 v10, v10, v15, v16
    v_max3_f32 v10, v10, v17, v18
    v_max_f32 v10, v10, v19
    v_mov_b32 v11, v10
    s_nop 1
    v_permlane32_swap_b32 v10, v11
    v_max_f32 v10, v10, v11
    v_mov_b32 v11, v10
    s_nop 1
    v_permlane16_swap_b32 v10, v11
    v_max_f32 v10, v10, v11
    v_mul_f32 v20, s46, v10
    v_pk_fma_f32 v[24:25], v[24:25], s[46:47], v[20:21] op_sel_hi:[1,1,0] neg_lo:[0,0,1] neg_hi:[0,0,1]
    v_pk_fma_f32 v[12:13], v[12:13], s[46:47], v[20:21] op_sel_hi:[1,1,0] neg_lo:[0,0,1] neg_hi:[0,0,1]
    v_exp_f32 v24, v24
    v_exp_f32 v25, v25
    v_pk_fma_f32 v[14:15], v[14:15], s[46:47], v[20:21] op_sel_hi:[1,1,0] neg_lo:[0,0,1] neg_hi:[0,0,1]
    v_exp_f32 v12, v12
    v_exp_f32 v13, v13
    v_pk_fma_f32 v[16:17], v[16:17], s[46:47], v[20:21] op_sel_hi:[1,1,0] neg_lo:[0,0,1] neg_hi:[0,0,1]
    v_cvt_pk_bf16_f32 v48, v24, v25
    v_exp_f32 v14, v14
    v_pk_fma_f32 v[18:19], v[18:19], s[46:47], v[20:21] op_sel_hi:[1,1,0] neg_lo:[0,0,1] neg_hi:[0,0,1]
    v_cvt_pk_bf16_f32 v51, v24, v25
    v_exp_f32 v15, v15
    v_cvt_pk_bf16_f32 v44, v12, v13
    v_exp_f32 v16, v16
    v_exp_f32 v17, v17
    v_cvt_pk_bf16_f32 v45, v14, v15
    v_exp_f32 v18, v18
    v_exp_f32 v19, v19
    v_cvt_pk_bf16_f32 v46, v16, v17
    v_cvt_pk_bf16_f32 v47, v18, v19
    v_mfma_f32_16x16x16_bf16 v[68:71], v[64:65], v[48:49], 0
    v_mfma_f32_16x16x16_bf16 v[52:55], v[30:31], v[48:49], 0
    v_mfma_f32_16x16x16_bf16 v[56:59], v[30:31], v[50:51], 0
    v_mfma_f32_16x16x32_bf16 v[68:71], v[64:67], v[44:47], v[68:71]
    s_waitcnt vmcnt(5)
    v_mfma_f32_16x16x32_bf16 v[52:55], v[36:39], v[44:47], v[52:55]
    s_waitcnt vmcnt(4)
    v_mfma_f32_16x16x32_bf16 v[56:59], v[40:43], v[44:47], v[56:59]
    ds_read_b128 v[36:39], v0 offset:55296
    ds_read_b128 v[40:43], v0 offset:56320
    ds_read_b128 v[60:63], v9 offset:24576
    s_nop 0
    v_rcp_f32 v10, v68
    s_nop 0
    v_pk_mul_f32 v[52:53], v[52:53], v[10:11] op_sel_hi:[1,0]
    s_nop 0
    v_pk_mul_f32 v[56:57], v[56:57], v[10:11] op_sel_hi:[1,0]
    v_cvt_pk_bf16_f32 v16, v52, v56
    v_cvt_pk_bf16_f32 v17, v53, v57
    v_pk_mul_f32 v[54:55], v[54:55], v[10:11] op_sel_hi:[1,0]
    v_pk_mul_f32 v[58:59], v[58:59], v[10:11] op_sel_hi:[1,0]
    v_cvt_pk_bf16_f32 v18, v54, v58
    v_cvt_pk_bf16_f32 v19, v55, v59
    ds_write_b128 v3, v[16:19] offset:22208
    ds_read_b128 v[64:67], v9 offset:25600
    v_mov_b64 v[12:13], 0
    v_mov_b64 v[14:15], 0
    v_mov_b64 v[20:21], 0
    v_mov_b64 v[22:23], 0
    v_mov_b64 v[24:25], 0
    v_mov_b64 v[26:27], 0
    v_mov_b64 v[32:33], 0
    v_mov_b64 v[34:35], 0
    v_mov_b64 v[44:45], 0
    v_mov_b64 v[46:47], 0
    v_mov_b64 v[48:49], 0
    v_mov_b64 v[50:51], 0
    s_waitcnt lgkmcnt(1)
    s_barrier
    ds_read_b128 v[52:55], v4 offset:22016
    ds_read_b128 v[56:59], v4 offset:22144
    v_mov_b64 v[68:69], 0
    v_mov_b64 v[70:71], 0
    v_mov_b64 v[28:29], 0
    v_mov_b64 v[30:31], 0
    v_mov_b64 v[16:17], 0
    v_mov_b64 v[18:19], 0
    s_cmp_eq_u32 s33, 63
    s_cbranch_scc1 Lr3f_last
    s_waitcnt lgkmcnt(1)
    v_smfmac_f32_16x16x64_bf16 v[28:31], v[52:55], v[60:67], v1
    ds_read_b128 v[60:63], v0 offset:49152
    s_waitcnt lgkmcnt(1)
    v_smfmac_f32_16x16x64_bf16 v[28:31], v[56:59], v[36:43], v1
    ds_read_b128 v[64:67], v0 offset:50176
    ds_read_b128 v[36:39], v9 offset:18432
    v_smfmac_f32_16x16x64_bf16 v[12:15], v[52:55], a[176:183], v1
    ds_read_b128 v[40:43], v9 offset:19456
    v_smfmac_f32_16x16x64_bf16 v[12:15], v[56:59], a[184:191], v1
    buffer_load_dwordx4 v0, s[8:11], s41 offen offset:0 lds
    v_smfmac_f32_16x16x64_bf16 v[20:23], v[52:55], a[192:199], v1
    s_nop 0
    v_add_f32 v28, v28, v30
    v_add_f32 v29, v29, v31
    s_waitcnt lgkmcnt(2)
    v_smfmac_f32_16x16x64_bf16 v[20:23], v[56:59], v[60:67], v1
    ds_read_b128 v[60:63], v9 offset:20480
    v_cvt_pk_bf16_f32 v28, v28, v29
    v_bfi_b32 v28, 1, s39, v28
    buffer_store_dword v28, v8, s[8:11], s38 offen offset:2048
    s_waitcnt lgkmcnt(1)
    v_smfmac_f32_16x16x64_bf16 v[24:27], v[52:55], v[36:43], v1
    ds_read_b128 v[64:67], v9 offset:21504
    ds_read_b128 v[36:39], v0 offset:51200
    v_add_f32 v12, v12, v14
    v_add_f32 v13, v13, v15
    v_smfmac_f32_16x16x64_bf16 v[24:27], v[56:59], a[200:207], v1
    ds_read_b128 v[40:43], v0 offset:52224
    v_cvt_pk_bf16_f32 v12, v12, v13
    v_bfi_b32 v12, 1, s39, v12
    v_smfmac_f32_16x16x64_bf16 v[32:35], v[52:55], a[208:215], v1
    buffer_load_dwordx4 v0, s[8:11], s41 offen offset:1024 lds
    v_add_f32 v20, v20, v22
    v_add_f32 v21, v21, v23
    v_smfmac_f32_16x16x64_bf16 v[32:35], v[56:59], a[216:223], v1
    v_cvt_pk_bf16_f32 v13, v20, v21
    s_waitcnt lgkmcnt(2)
    v_smfmac_f32_16x16x64_bf16 v[44:47], v[52:55], v[60:67], v1
    ds_read_b128 v[60:63], v0 offset:53248
    v_add_f32 v24, v24, v26
    v_add_f32 v25, v25, v27
    s_waitcnt lgkmcnt(1)
    v_smfmac_f32_16x16x64_bf16 v[44:47], v[56:59], v[36:43], v1
    ds_read_b128 v[64:67], v0 offset:54272
    ds_read_b128 v[36:39], v9 offset:22528
    v_cvt_pk_bf16_f32 v14, v24, v25
    v_smfmac_f32_16x16x64_bf16 v[48:51], v[52:55], a[224:231], v1
    ds_read_b128 v[40:43], v9 offset:23552
    v_add_f32 v32, v32, v34
    v_add_f32 v33, v33, v35
    v_smfmac_f32_16x16x64_bf16 v[48:51], v[56:59], a[232:239], v1
    v_cvt_pk_bf16_f32 v15, v32, v33
    buffer_store_dwordx4 v[12:15], v0, s[8:11], s38 offen offset:0
    v_smfmac_f32_16x16x64_bf16 v[68:71], v[52:55], a[240:247], v1
    v_add_f32 v44, v44, v46
    v_add_f32 v45, v45, v47
    s_waitcnt lgkmcnt(2)
    v_smfmac_f32_16x16x64_bf16 v[68:71], v[56:59], v[60:67], v1
    v_cvt_pk_bf16_f32 v44, v44, v45
    v_bfi_b32 v44, 1, s39, v44
    s_waitcnt lgkmcnt(0)
    v_smfmac_f32_16x16x64_bf16 v[16:19], v[52:55], v[36:43], v1
    v_add_f32 v48, v48, v50
    v_add_f32 v49, v49, v51
    v_smfmac_f32_16x16x64_bf16 v[16:19], v[56:59], a[248:255], v1
    v_cvt_pk_bf16_f32 v45, v48, v49
    v_add_f32 v68, v68, v70
    v_add_f32 v69, v69, v71
    v_cvt_pk_bf16_f32 v46, v68, v69
    s_nop 3
    v_add_f32 v16, v16, v18
    v_add_f32 v17, v17, v19
    v_cvt_pk_bf16_f32 v47, v16, v17
    buffer_store_dwordx4 v[44:47], v0, s[8:11], s38 offen offset:1024
    s_xor_b32 s34, s34, 16384
    s_xor_b32 s35, s35, 16384
    s_barrier
    s_sleep 2
    buffer_load_dwordx4 v[44:47], v0, s[8:11], s34 offen sc1
    buffer_load_dwordx4 v[48:51], v0, s[8:11], s34 offen offset:1024 sc1
    buffer_load_dword v10, v8, s[8:11], s35 offen sc1
    s_add_u32 s33, s33, 1
    s_bfe_u32 s39, s33, 0x10001
    s_xor_b32 s38, s38, 524288
    s_and_b32 s17, s33, 7
    s_mul_i32 s17, s17, 131072
    s_add_u32 s43, s45, s17
    s_bfe_u32 s66, s33, 65539
    s_add_u32 s67, s67, 22528
    s_and_b32 s17, s33, 3
    s_cmp_eq_u32 s17, 3
    s_cselect_b32 s17, 1, 0
    s_cmp_eq_u32 s32, 0
    s_cselect_b32 s17, 1, s17
    s_cmp_ge_u32 s33, 7
    s_cselect_b32 s17, s17, 0
    s_cmp_lg_u32 s17, 0
    s_cselect_b64 s[78:79], -1, 0xff
    s_add_u32 s56, s56, 262144
    s_add_u32 s42, s42, 262144
    s_add_u32 s41, s41, 262144
    s_add_u32 s40, s40, 262144
    s_add_u32 s44, s44, 22528
    ds_read_b128 v[56:59], v9 offset:12288
    ds_read_b128 v[60:63], v9 offset:13312
    ds_read_b128 v[64:67], v9 offset:14336
    ds_read_b128 v[68:71], v9 offset:15360
    v_mov_b64 v[12:13], 0
    v_mov_b64 v[14:15], 0
    v_mov_b64 v[16:17], 0
    v_mov_b64 v[18:19], 0
    v_mov_b64 v[20:21], 0
    v_mov_b64 v[22:23], 0
    v_mov_b64 v[24:25], 0
    v_mov_b64 v[26:27], 0
    v_mov_b64 v[28:29], 0
    v_mov_b64 v[30:31], 0
    v_mov_b64 v[32:33], 0
    v_mov_b64 v[34:35], 0
    s_waitcnt lgkmcnt(0)
    s_branch Lr3f_step
Lr3f_flbad:
    s_cmp_eq_u32 s33, 63
    s_cbranch_scc1 Lr3f_flok
    s_mov_b32 s16, 0
Lr3f_flp:
    buffer_load_dword v6, v7, s[8:11], s67 offen sc1
    s_add_u32 s16, s16, 1
    s_cmp_gt_u32 s16, 100000
    s_cbranch_scc1 Lr_abort
    s_waitcnt vmcnt(0)
    v_cmp_eq_u32 vcc, 0, v6
    s_nop 0
    s_and_b64 vcc, vcc, s[78:79]
    s_cbranch_scc1 Lr3f_flp
    s_branch Lr3f_flok
Lr3f_last:
    s_waitcnt vmcnt(0) lgkmcnt(0)
    s_branch Lr_exit
L_slow:
    s_cmp_lg_u32 s14, 0
    s_cbranch_scc1 L_w1_0
    s_barrier
    s_mov_b32 m0, 9216
    s_nop 0
    buffer_load_dwordx4 v0, s[8:11], s41 offen offset:0 lds
    buffer_load_dwordx4 v0, s[8:11], s41 offen offset:1024 lds
    s_add_u32 s41, s41, 262144
    s_waitcnt vmcnt(0)
    buffer_load_dwordx4 v[44:47], v0, s[8:11], s34 offen sc1
    buffer_load_dwordx4 v[48:51], v0, s[8:11], s34 offen offset:1024 sc1
    buffer_load_dword v10, v8, s[8:11], s35 offen sc1
    ds_read_b128 v[56:59], v9 offset:0
    ds_read_b128 v[60:63], v9 offset:1024
    ds_read_b128 v[64:67], v9 offset:2048
    ds_read_b128 v[68:71], v9 offset:3072
    v_mov_b64 v[12:13], 0
    v_mov_b64 v[14:15], 0
    v_mov_b64 v[16:17], 0
    v_mov_b64 v[18:19], 0
    v_mov_b64 v[20:21], 0
    v_mov_b64 v[22:23], 0
    v_mov_b64 v[24:25], 0
    v_mov_b64 v[26:27], 0
    v_mov_b64 v[28:29], 0
    v_mov_b64 v[30:31], 0
    v_mov_b64 v[32:33], 0
    v_mov_b64 v[34:35], 0
    s_waitcnt lgkmcnt(0)
Lr0s_step:
    s_mov_b32 s16, 0
    s_mov_b64 s[70:71], 0
    s_mov_b64 s[72:73], 0
    s_mov_b64 s[74:75], 0
Lr0s_p2:
    s_mov_b64 exec, s[70:71]
    buffer_load_dwordx4 v[44:47], v0, s[8:11], s34 offen sc1
    s_mov_b64 exec, s[72:73]
    buffer_load_dwordx4 v[48:51], v0, s[8:11], s34 offen offset:1024 sc1
    s_mov_b64 exec, s[74:75]
    buffer_load_dword v10, v8, s[8:11], s35 offen sc1
    s_mov_b64 exec, -1
    s_add_u32 s16, s16, 1
    s_cmp_gt_u32 s16, 100000
    s_cbranch_scc1 Lr_abort
    s_waitcnt vmcnt(5)
    v_max3_u32 v11, v44, v45, v46
    v_max_u32 v11, v11, v47
    v_cmp_eq_u32 s[70:71], -1, v11
    s_waitcnt vmcnt(4)
    v_max3_u32 v11, v48, v49, v50
    v_max_u32 v11, v11, v51
    v_cmp_eq_u32 s[72:73], -1, v11
    s_waitcnt vmcnt(3)
    v_cmp_eq_u32 s[74:75], -1, v10
    s_or_b64 vcc, s[70:71], s[72:73]
    s_or_b64 vcc, vcc, s[74:75]
    s_cbranch_scc1 Lr0s_p2
    v_smfmac_f32_16x16x64_bf16 v[12:15], v[44:47], v[72:79], v1
    ds_write_b128 v0, v[44:47] offset:0
    v_smfmac_f32_16x16x64_bf16 v[16:19], v[44:47], v[80:87], v1
    ds_write_b128 v0, v[48:51] offset:1024
    v_smfmac_f32_16x16x64_bf16 v[20:23], v[44:47], v[88:95], v1
    ds_write_b32 v8, v10 offset:8192
    v_smfmac_f32_16x16x64_bf16 v[24:27], v[44:47], v[56:63], v1
    s_waitcnt lgkmcnt(0)
    s_barrier
    ds_read_b128 v[52:55], v0 offset:2048
    v_smfmac_f32_16x16x64_bf16 v[12:15], v[48:51], v[112:119], v1
    ds_read_b128 v[36:39], v0 offset:3072
    v_smfmac_f32_16x16x64_bf16 v[16:19], v[48:51], v[120:127], v1
    ds_read_b128 v[56:59], v9 offset:4096
    v_smfmac_f32_16x16x64_bf16 v[20:23], v[48:51], v[128:135], v1
    ds_read_b128 v[60:63], v9 offset:5120
    v_smfmac_f32_16x16x64_bf16 v[24:27], v[48:51], v[64:71], v1
    ds_read_b128 v[40:43], v0 offset:4096
    s_waitcnt lgkmcnt(4)
    v_smfmac_f32_16x16x64_bf16 v[12:15], v[52:55], v[152:159], v1
    v_smfmac_f32_16x16x64_bf16 v[16:19], v[52:55], v[160:167], v1
    ds_read_b128 v[64:67], v9 offset:6144
    v_smfmac_f32_16x16x64_bf16 v[20:23], v[52:55], v[168:175], v1
    ds_read_b128 v[68:71], v9 offset:7168
    s_waitcnt lgkmcnt(3)
    v_smfmac_f32_16x16x64_bf16 v[24:27], v[52:55], v[56:63], v1
    v_smfmac_f32_16x16x64_bf16 v[12:15], v[36:39], v[192:199], v1
    ds_read_b128 v[52:55], v0 offset:5120
    v_smfmac_f32_16x16x64_bf16 v[16:19], v[36:39], v[200:207], v1
    ds_read_b128 v[56:59], v9 offset:8192
    v_smfmac_f32_16x16x64_bf16 v[20:23], v[36:39], v[208:215], v1
    ds_read_b128 v[60:63], v9 offset:9216
    s_waitcnt lgkmcnt(3)
    v_smfmac_f32_16x16x64_bf16 v[24:27], v[36:39], v[64:71], v1
    v_smfmac_f32_16x16x64_bf16 v[12:15], v[40:43], v[232:239], v1
    buffer_load_dwordx4 v[36:39], v0, s[8:11], s42 offen
    v_smfmac_f32_16x16x64_bf16 v[16:19], v[40:43], v[240:247], v1
    ds_read_b128 v[64:67], v9 offset:10240
    v_smfmac_f32_16x16x64_bf16 v[20:23], v[40:43], v[248:255], v1
    ds_read_b128 v[68:71], v9 offset:11264
    s_waitcnt lgkmcnt(2)
    v_smfmac_f32_16x16x64_bf16 v[24:27], v[40:43], v[56:63], v1
    s_waitcnt vmcnt(1)
    ds_read_b128 v[44:47], v0 offset:6144
    v_smfmac_f32_16x16x64_bf16 v[12:15], v[52:55], a[16:23], v1
    buffer_load_dwordx4 v[40:43], v0, s[8:11], s42 offen offset:1024
    v_smfmac_f32_16x16x64_bf16 v[16:19], v[52:55], a[24:31], v1
    ds_read_b128 v[56:59], v9 offset:12288
    v_smfmac_f32_16x16x64_bf16 v[20:23], v[52:55], a[32:39], v1
    ds_read_b128 v[60:63], v9 offset:13312
    s_waitcnt lgkmcnt(3)
    v_smfmac_f32_16x16x64_bf16 v[24:27], v[52:55], v[64:71], v1
    ds_read_b128 v[48:51], v0 offset:7168
    s_waitcnt lgkmcnt(3)
    v_smfmac_f32_16x16x64_bf16 v[12:15], v[44:47], a[56:63], v1
    ds_read_b128 v[52:55], v0 offset:8192
    v_smfmac_f32_16x16x64_bf16 v[16:19], v[44:47], a[64:71], v1
    ds_read_b128 v[64:67], v9 offset:14336
    v_smfmac_f32_16x16x64_bf16 v[20:23], v[44:47], a[72:79], v1
    ds_read_b128 v[68:71], v9 offset:15360
    s_waitcnt lgkmcnt(4)
    v_smfmac_f32_16x16x64_bf16 v[24:27], v[44:47], v[56:63], v1
    s_waitcnt lgkmcnt(3)
    v_smfmac_f32_16x16x64_bf16 v[12:15], v[48:51], a[96:103], v1
    v_smfmac_f32_16x16x64_bf16 v[16:19], v[48:51], a[104:111], v1
    ds_read_b128 v[56:59], v9 offset:16384
    s_waitcnt lgkmcnt(3)
    v_smfmac_f32_16x16x64_bf16 v[12:15], v[52:55], a[136:143], v1
    ds_read_b128 v[60:63], v9 offset:17408
    v_smfmac_f32_16x16x64_bf16 v[16:19], v[52:55], a[144:151], v1
    v_smfmac_f32_16x16x64_bf16 v[20:23], v[48:51], a[112:119], v1
    s_waitcnt lgkmcnt(2)
    v_smfmac_f32_16x16x64_bf16 v[24:27], v[48:51], v[64:71], v1
    ds_read_b128 v[64:67], v0 offset:9216
    s_nop 1
    v_add_f32 v12, v12, v14
    v_smfmac_f32_16x16x64_bf16 v[20:23], v[52:55], a[152:159], v1
    ds_read_b128 v[68:71], v0 offset:10240
    v_add_f32 v16, v16, v18
    s_waitcnt lgkmcnt(2)
    v_smfmac_f32_16x16x64_bf16 v[24:27], v[52:55], v[56:63], v1
    ds_read_b128 v[56:59], v0 offset:11264
    v_add_f32 v13, v13, v15
    v_add_f32 v17, v17, v19
    v_cvt_pk_bf16_f32 v14, v12, v16
    v_cvt_pk_bf16_f32 v15, v13, v17
    ds_write_b32 v2, v14 offset:17408
    ds_write_b32 v2, v15 offset:17696
    v_smfmac_f32_16x16x64_bf16 v[28:31], v[52:55], a[160:167], v1
    ds_read_b128 v[60:63], v0 offset:12288
    v_add_f32 v20, v20, v22
    v_add_f32 v24, v24, v26
    v_add_f32 v21, v21, v23
    v_add_f32 v25, v25, v27
    v_smfmac_f32_16x16x64_bf16 v[32:35], v[52:55], a[168:175], v1
    ds_read_b128 v[12:15], v0 offset:0
    v_cvt_pk_bf16_f32 v22, v20, v24
    v_cvt_pk_bf16_f32 v23, v21, v25
    ds_write_b32 v2, v22 offset:19712
    ds_write_b32 v2, v23 offset:20000
    v_smfmac_f32_16x16x64_bf16 v[28:31], v[48:51], a[120:127], v1
    ds_read_b128 v[16:19], v0 offset:1024
    v_smfmac_f32_16x16x64_bf16 v[32:35], v[48:51], a[128:135], v1
    ds_read_b128 v[20:23], v0 offset:2048
    v_smfmac_f32_16x16x64_bf16 v[28:31], v[44:47], a[80:87], v1
    ds_read_b128 v[24:27], v0 offset:3072
    v_smfmac_f32_16x16x64_bf16 v[32:35], v[44:47], a[88:95], v1
    s_waitcnt lgkmcnt(3)
    s_barrier
    ds_read_b128 v[44:47], v3 offset:17408
    v_smfmac_f32_16x16x64_bf16 v[28:31], v[12:15], v[96:103], v1
    ds_read_b128 v[52:55], v0 offset:4096
    v_smfmac_f32_16x16x64_bf16 v[32:35], v[12:15], v[104:111], v1
    ds_read_b128 v[12:15], v3 offset:19712
    s_waitcnt lgkmcnt(5)
    v_smfmac_f32_16x16x64_bf16 v[28:31], v[16:19], v[136:143], v1
    ds_read_b128 v[48:51], v0 offset:5120
    v_smfmac_f32_16x16x64_bf16 v[32:35], v[16:19], v[144:151], v1
    s_waitcnt lgkmcnt(5)
    v_smfmac_f32_16x16x64_bf16 v[28:31], v[20:23], v[176:183], v1
    v_smfmac_f32_16x16x64_bf16 v[32:35], v[20:23], v[184:191], v1
    ds_read_b128 v[20:23], v3 offset:17472
    s_waitcnt lgkmcnt(5)
    v_smfmac_f32_16x16x64_bf16 v[28:31], v[24:27], v[216:223], v1
    v_smfmac_f32_16x16x64_bf16 v[32:35], v[24:27], v[224:231], v1
    s_waitcnt lgkmcnt(3)
    v_smfmac_f32_16x16x64_bf16 v[28:31], v[52:55], a[0:7], v1
    v_smfmac_f32_16x16x64_bf16 v[32:35], v[52:55], a[8:15], v1
    ds_read_b128 v[52:55], v3 offset:19776
    s_waitcnt lgkmcnt(2)
    v_smfmac_f32_16x16x64_bf16 v[28:31], v[48:51], a[40:47], v1
    v_smfmac_f32_16x16x64_bf16 v[32:35], v[48:51], a[48:55], v1
    ds_read_b128 v[48:51], v3 offset:17536
    v_mfma_f32_16x16x32_bf16 v[24:27], v[12:15], v[44:47], 0
    v_mfma_f32_16x16x32_bf16 v[12:15], v[64:67], v[44:47], 0
    ds_read_b128 v[64:67], v0 offset:13312
    v_mfma_f32_16x16x32_bf16 v[16:19], v[68:71], v[44:47], 0
    ds_read_b128 v[68:71], v0 offset:14336
    s_waitcnt lgkmcnt(3)
    v_mfma_f32_16x16x32_bf16 v[24:27], v[52:55], v[20:23], v[24:27]
    ds_read_b128 v[44:47], v3 offset:19840
    v_add_f32 v28, v28, v30
    v_add_f32 v29, v29, v31
    v_mfma_f32_16x16x32_bf16 v[12:15], v[56:59], v[20:23], v[12:15]
    ds_read_b128 v[52:55], v3 offset:17600
    v_add_f32 v32, v32, v34
    v_add_f32 v33, v33, v35
    v_mfma_f32_16x16x32_bf16 v[16:19], v[60:63], v[20:23], v[16:19]
    ds_read_b128 v[56:59], v0 offset:15360
    v_cvt_pk_bf16_f32 v30, v28, v29
    v_cvt_pk_bf16_f32 v31, v32, v33
    s_waitcnt lgkmcnt(2)
    v_mfma_f32_16x16x32_bf16 v[24:27], v[44:47], v[48:51], v[24:27]
    ds_read_b128 v[20:23], v3 offset:19904
    v_lshrrev_b32 v10, 8, v0
    v_mul_u32_u24 v10, 288, v10
    v_mfma_f32_16x16x32_bf16 v[12:15], v[64:67], v[48:51], v[12:15]
    ds_read_b128 v[60:63], v0 offset:16384
    v_and_b32 v11, 0xf0, v0
    v_add_u32 v10, v10, v11
    v_mfma_f32_16x16x32_bf16 v[16:19], v[68:71], v[48:51], v[16:19]
    ds_read_b128 v[32:35], v10 offset:19712
    v_lshrrev_b32 v11, 1, v0
    v_bfi_b32 v30, 1, s66, v30
    s_waitcnt lgkmcnt(2)
    v_mfma_f32_16x16x32_bf16 v[24:27], v[20:23], v[52:55], v[24:27]
    buffer_store_dwordx2 v[30:31], v11, s[8:11], s43 offen offset:2048 sc1
    v_mov_b32 v49, 0
    v_mov_b32 v50, 0
    v_mfma_f32_16x16x32_bf16 v[12:15], v[56:59], v[52:55], v[12:15]
    v_mov_b64 v[64:65], s[68:69]
    v_mov_b64 v[66:67], s[68:69]
    s_waitcnt lgkmcnt(1)
    v_mfma_f32_16x16x32_bf16 v[16:19], v[60:63], v[52:55], v[16:19]
    s_waitcnt lgkmcnt(0)
    v_bfi_b32 v32, 1, s66, v32
    s_mov_b64 exec, s[52:53]
    buffer_store_dwordx4 v[32:35], v0, s[8:11], s43 offen sc1
    s_mov_b64 exec, -1
    v_max3_f32 v10, v24, v25, v12
    v_max3_f32 v10, v10, v13, v14
    s_nop 0
    v_max3_f32 v10, v10, v15, v16
    v_max3_f32 v10, v10, v17, v18
    v_max_f32 v10, v10, v19
    v_mov_b32 v11, v10
    s_nop 1
    v_permlane32_swap_b32 v10, v11
    v_max_f32 v10, v10, v11
    v_mov_b32 v11, v10
    s_nop 1
    v_permlane16_swap_b32 v10, v11
    v_max_f32 v10, v10, v11
    v_mul_f32 v20, s46, v10
    v_pk_fma_f32 v[24:25], v[24:25], s[46:47], v[20:21] op_sel_hi:[1,1,0] neg_lo:[0,0,1] neg_hi:[0,0,1]
    v_pk_fma_f32 v[12:13], v[12:13], s[46:47], v[20:21] op_sel_hi:[1,1,0] neg_lo:[0,0,1] neg_hi:[0,0,1]
    v_exp_f32 v24, v24
    v_exp_f32 v25, v25
    v_pk_fma_f32 v[14:15], v[14:15], s[46:47], v[20:21] op_sel_hi:[1,1,0] neg_lo:[0,0,1] neg_hi:[0,0,1]
    v_exp_f32 v12, v12
    v_exp_f32 v13, v13
    v_pk_fma_f32 v[16:17], v[16:17], s[46:47], v[20:21] op_sel_hi:[1,1,0] neg_lo:[0,0,1] neg_hi:[0,0,1]
    v_cvt_pk_bf16_f32 v48, v24, v25
    v_exp_f32 v14, v14
    v_pk_fma_f32 v[18:19], v[18:19], s[46:47], v[20:21] op_sel_hi:[1,1,0] neg_lo:[0,0,1] neg_hi:[0,0,1]
    v_cvt_pk_bf16_f32 v51, v24, v25
    v_exp_f32 v15, v15
    v_cvt_pk_bf16_f32 v44, v12, v13
    v_exp_f32 v16, v16
    v_exp_f32 v17, v17
    v_cvt_pk_bf16_f32 v45, v14, v15
    v_exp_f32 v18, v18
    v_exp_f32 v19, v19
    v_cvt_pk_bf16_f32 v46, v16, v17
    v_cvt_pk_bf16_f32 v47, v18, v19
    v_mfma_f32_16x16x16_bf16 v[68:71], v[64:65], v[48:49], 0
    v_mfma_f32_16x16x16_bf16 v[52:55], v[30:31], v[48:49], 0
    v_mfma_f32_16x16x16_bf16 v[56:59], v[30:31], v[50:51], 0
    v_mfma_f32_16x16x32_bf16 v[68:71], v[64:67], v[44:47], v[68:71]
    s_waitcnt vmcnt(3)
    v_mfma_f32_16x16x32_bf16 v[52:55], v[36:39], v[44:47], v[52:55]
    s_waitcnt vmcnt(2)
    v_mfma_f32_16x16x32_bf16 v[56:59], v[40:43], v[44:47], v[56:59]
    ds_read_b128 v[36:39], v0 offset:30720
    ds_read_b128 v[40:43], v0 offset:31744
    ds_read_b128 v[60:63], v9 offset:24576
    s_nop 0
    v_rcp_f32 v10, v68
    s_nop 0
    v_pk_mul_f32 v[52:53], v[52:53], v[10:11] op_sel_hi:[1,0]
    s_nop 0
    v_pk_mul_f32 v[56:57], v[56:57], v[10:11] op_sel_hi:[1,0]
    v_cvt_pk_bf16_f32 v16, v52, v56
    v_cvt_pk_bf16_f32 v17, v53, v57
    v_pk_mul_f32 v[54:55], v[54:55], v[10:11] op_sel_hi:[1,0]
    v_pk_mul_f32 v[58:59], v[58:59], v[10:11] op_sel_hi:[1,0]
    v_cvt_pk_bf16_f32 v18, v54, v58
    v_cvt_pk_bf16_f32 v19, v55, v59
    ds_write_b128 v3, v[16:19] offset:22016
    ds_read_b128 v[64:67], v9 offset:25600
    v_mov_b64 v[12:13], 0
    v_mov_b64 v[14:15], 0
    v_mov_b64 v[20:21], 0
    v_mov_b64 v[22:23], 0
    v_mov_b64 v[24:25], 0
    v_mov_b64 v[26:27], 0
    v_mov_b64 v[32:33], 0
    v_mov_b64 v[34:35], 0
    v_mov_b64 v[44:45], 0
    v_mov_b64 v[46:47], 0
    v_mov_b64 v[48:49], 0
    v_mov_b64 v[50:51], 0
    s_waitcnt lgkmcnt(1)
    s_barrier
    ds_read_b128 v[52:55], v4 offset:22016
    ds_read_b128 v[56:59], v4 offset:22144
    v_mov_b64 v[68:69], 0
    v_mov_b64 v[70:71], 0
    v_mov_b64 v[28:29], 0
    v_mov_b64 v[30:31], 0
    v_mov_b64 v[16:17], 0
    v_mov_b64 v[18:19], 0
    s_cmp_eq_u32 s33, 63
    s_cbranch_scc1 Lr0s_last
    s_waitcnt lgkmcnt(1)
    v_smfmac_f32_16x16x64_bf16 v[28:31], v[52:55], v[60:67], v1
    ds_read_b128 v[60:63], v0 offset:24576
    s_waitcnt lgkmcnt(1)
    v_smfmac_f32_16x16x64_bf16 v[28:31], v[56:59], v[36:43], v1
    ds_read_b128 v[64:67], v0 offset:25600
    ds_read_b128 v[36:39], v9 offset:18432
    v_smfmac_f32_16x16x64_bf16 v[12:15], v[52:55], a[176:183], v1
    ds_read_b128 v[40:43], v9 offset:19456
    v_smfmac_f32_16x16x64_bf16 v[12:15], v[56:59], a[184:191], v1
    buffer_load_dwordx4 v0, s[8:11], s41 offen offset:0 lds
    v_smfmac_f32_16x16x64_bf16 v[20:23], v[52:55], a[192:199], v1
    s_nop 0
    v_add_f32 v28, v28, v30
    v_add_f32 v29, v29, v31
    s_waitcnt lgkmcnt(2)
    v_smfmac_f32_16x16x64_bf16 v[20:23], v[56:59], v[60:67], v1
    ds_read_b128 v[60:63], v9 offset:20480
    v_cvt_pk_bf16_f32 v28, v28, v29
    v_bfi_b32 v28, 1, s39, v28
    buffer_store_dword v28, v8, s[8:11], s38 offen offset:2048 sc1
    s_waitcnt lgkmcnt(1)
    v_smfmac_f32_16x16x64_bf16 v[24:27], v[52:55], v[36:43], v1
    ds_read_b128 v[64:67], v9 offset:21504
    ds_read_b128 v[36:39], v0 offset:26624
    v_add_f32 v12, v12, v14
    v_add_f32 v13, v13, v15
    v_smfmac_f32_16x16x64_bf16 v[24:27], v[56:59], a[200:207], v1
    ds_read_b128 v[40:43], v0 offset:27648
    v_cvt_pk_bf16_f32 v12, v12, v13
    v_bfi_b32 v12, 1, s39, v12
    v_smfmac_f32_16x16x64_bf16 v[32:35], v[52:55], a[208:215], v1
    buffer_load_dwordx4 v0, s[8:11], s41 offen offset:1024 lds
    v_add_f32 v20, v20, v22
    v_add_f32 v21, v21, v23
    v_smfmac_f32_16x16x64_bf16 v[32:35], v[56:59], a[216:223], v1
    v_cvt_pk_bf16_f32 v13, v20, v21
    s_waitcnt lgkmcnt(2)
    v_smfmac_f32_16x16x64_bf16 v[44:47], v[52:55], v[60:67], v1
    ds_read_b128 v[60:63], v0 offset:28672
    v_add_f32 v24, v24, v26
    v_add_f32 v25, v25, v27
    s_waitcnt lgkmcnt(1)
    v_smfmac_f32_16x16x64_bf16 v[44:47], v[56:59], v[36:43], v1
    ds_read_b128 v[64:67], v0 offset:29696
    ds_read_b128 v[36:39], v9 offset:22528
    v_cvt_pk_bf16_f32 v14, v24, v25
    v_smfmac_f32_16x16x64_bf16 v[48:51], v[52:55], a[224:231], v1
    ds_read_b128 v[40:43], v9 offset:23552
    v_add_f32 v32, v32, v34
    v_add_f32 v33, v33, v35
    v_smfmac_f32_16x16x64_bf16 v[48:51], v[56:59], a[232:239], v1
    v_cvt_pk_bf16_f32 v15, v32, v33
    buffer_store_dwordx4 v[12:15], v0, s[8:11], s38 offen offset:0 sc1
    v_smfmac_f32_16x16x64_bf16 v[68:71], v[52:55], a[240:247], v1
    v_add_f32 v44, v44, v46
    v_add_f32 v45, v45, v47
    s_waitcnt lgkmcnt(2)
    v_smfmac_f32_16x16x64_bf16 v[68:71], v[56:59], v[60:67], v1
    v_cvt_pk_bf16_f32 v44, v44, v45
    v_bfi_b32 v44, 1, s39, v44
    s_waitcnt lgkmcnt(0)
    v_smfmac_f32_16x16x64_bf16 v[16:19], v[52:55], v[36:43], v1
    v_add_f32 v48, v48, v50
    v_add_f32 v49, v49, v51
    v_smfmac_f32_16x16x64_bf16 v[16:19], v[56:59], a[248:255], v1
    v_cvt_pk_bf16_f32 v45, v48, v49
    v_add_f32 v68, v68, v70
    v_add_f32 v69, v69, v71
    v_cvt_pk_bf16_f32 v46, v68, v69
    s_nop 3
    v_add_f32 v16, v16, v18
    v_add_f32 v17, v17, v19
    v_cvt_pk_bf16_f32 v47, v16, v17
    buffer_store_dwordx4 v[44:47], v0, s[8:11], s38 offen offset:1024 sc1
    v_bfe_u32 v10, v0, 4, 4
    v_mov_b32 v11, 0x3f80
    v_mov_b32 v40, 0x3f800000
    v_cmp_eq_u32 vcc, 0, v10
    v_cmp_eq_u32 s[48:49], 1, v10
    s_nop 0
    v_cndmask_b32 v36, 0, v11, vcc
    v_cndmask_b32 v36, v36, v40, s[48:49]
    v_cmp_eq_u32 vcc, 2, v10
    v_cmp_eq_u32 s[48:49], 3, v10
    s_nop 0
    v_cndmask_b32 v37, 0, v11, vcc
    v_cndmask_b32 v37, v37, v40, s[48:49]
    v_cmp_eq_u32 vcc, 4, v10
    v_cmp_eq_u32 s[48:49], 5, v10
    s_nop 0
    v_cndmask_b32 v38, 0, v11, vcc
    v_cndmask_b32 v38, v38, v40, s[48:49]
    v_cmp_eq_u32 vcc, 6, v10
    v_cmp_eq_u32 s[48:49], 7, v10
    s_nop 0
    v_cndmask_b32 v39, 0, v11, vcc
    v_cndmask_b32 v39, v39, v40, s[48:49]
    s_sleep 5
    buffer_load_dwordx4 v[52:55], v6, s[8:11], s57 offen sc1
    buffer_load_dwordx4 v[56:59], v6, s[8:11], s58 offen sc1
    buffer_load_dwordx4 v[60:63], v6, s[8:11], s59 offen sc1
    buffer_load_dwordx4 v[64:67], v6, s[8:11], s60 offen sc1
    s_mov_b32 s16, 0
    s_mov_b64 s[70:71], 0
    s_mov_b64 s[72:73], 0
    s_mov_b64 s[74:75], 0
    s_mov_b64 s[76:77], 0
Lr0s_p1:
    s_mov_b64 exec, s[70:71]
    buffer_load_dwordx4 v[52:55], v6, s[8:11], s57 offen sc1
    s_mov_b64 exec, s[72:73]
    buffer_load_dwordx4 v[56:59], v6, s[8:11], s58 offen sc1
    s_mov_b64 exec, s[74:75]
    buffer_load_dwordx4 v[60:63], v6, s[8:11], s59 offen sc1
    s_mov_b64 exec, s[76:77]
    buffer_load_dwordx4 v[64:67], v6, s[8:11], s60 offen sc1
    s_mov_b64 exec, -1
    s_add_u32 s16, s16, 1
    s_cmp_gt_u32 s16, 100000
    s_cbranch_scc1 Lr_abort
    s_waitcnt vmcnt(7)
    v_and_b32 v11, 1, v52
    v_cmp_ne_u32 s[70:71], s39, v11
    v_mfma_f32_16x16x32_bf16 v[40:43], v[52:55], v[36:39], 0
    s_waitcnt vmcnt(6)
    v_and_b32 v11, 1, v56
    v_cmp_ne_u32 s[72:73], s39, v11
    v_mfma_f32_16x16x32_bf16 v[40:43], v[56:59], v[36:39], v[40:43]
    s_waitcnt vmcnt(5)
    v_and_b32 v11, 1, v60
    v_cmp_ne_u32 s[74:75], s39, v11
    v_mfma_f32_16x16x32_bf16 v[40:43], v[60:63], v[36:39], v[40:43]
    s_or_b64 vcc, s[70:71], s[72:73]
    s_waitcnt vmcnt(4)
    v_and_b32 v11, 1, v64
    v_cmp_ne_u32 s[76:77], s39, v11
    v_mfma_f32_16x16x32_bf16 v[40:43], v[64:67], v[36:39], v[40:43]
    s_or_b64 vcc, vcc, s[74:75]
    s_or_b64 vcc, vcc, s[76:77]
    s_cbranch_scc1 Lr0s_p1
    s_nop 4
    v_permlane16_swap_b32 v40, v42
    v_permlane16_swap_b32 v41, v43
    s_mov_b64 exec, s[50:51]
    v_add_f32 v40, v40, v42
    v_add_f32 v41, v41, v43
    v_cvt_pk_bf16_f32 v40, v40, v41
    v_min_u32 v40, s54, v40
    buffer_store_dword v40, v7, s[8:11], s36 offen sc1
    v_mov_b32 v41, -1
    buffer_store_dword v41, v7, s[8:11], s37 offen sc1
    s_mov_b64 exec, -1
    s_xor_b32 s34, s34, 16384
    s_xor_b32 s35, s35, 16384
    s_barrier
    s_sleep 2
    buffer_load_dwordx4 v[44:47], v0, s[8:11], s34 offen sc1
    buffer_load_dwordx4 v[48:51], v0, s[8:11], s34 offen offset:1024 sc1
    buffer_load_dword v10, v8, s[8:11], s35 offen sc1
    s_add_u32 s33, s33, 1
    s_bfe_u32 s39, s33, 0x10001
    s_xor_b32 s38, s38, 524288
    s_xor_b32 s57, s57, 524288
    s_xor_b32 s58, s58, 524288
    s_xor_b32 s59, s59, 524288
    s_xor_b32 s60, s60, 524288
    s_xor_b32 s36, s36, 16384
    s_xor_b32 s37, s37, 16384
    s_and_b32 s17, s33, 7
    s_mul_i32 s17, s17, 131072
    s_add_u32 s43, s45, s17
    s_bfe_u32 s66, s33, 65539
    s_add_u32 s67, s67, 22528
    s_add_u32 s42, s42, 262144
    s_add_u32 s41, s41, 262144
    s_add_u32 s40, s40, 262144
    s_add_u32 s44, s44, 22528
    s_waitcnt vmcnt(5)
    ds_read_b128 v[56:59], v9 offset:0
    ds_read_b128 v[60:63], v9 offset:1024
    ds_read_b128 v[64:67], v9 offset:2048
    ds_read_b128 v[68:71], v9 offset:3072
    v_mov_b64 v[12:13], 0
    v_mov_b64 v[14:15], 0
    v_mov_b64 v[16:17], 0
    v_mov_b64 v[18:19], 0
    v_mov_b64 v[20:21], 0
    v_mov_b64 v[22:23], 0
    v_mov_b64 v[24:25], 0
    v_mov_b64 v[26:27], 0
    v_mov_b64 v[28:29], 0
    v_mov_b64 v[30:31], 0
    v_mov_b64 v[32:33], 0
    v_mov_b64 v[34:35], 0
    s_waitcnt lgkmcnt(0)
    s_branch Lr0s_step
Lr0s_last:
    s_waitcnt vmcnt(0) lgkmcnt(0)
    s_branch Lr_exit
L_w1_0:
    s_cmp_lg_u32 s14, 1
    s_cbranch_scc1 L_w2_0
    s_barrier
    s_mov_b32 m0, 11264
    s_nop 0
    buffer_load_dwordx4 v0, s[8:11], s41 offen offset:0 lds
    buffer_load_dwordx4 v0, s[8:11], s41 offen offset:1024 lds
    s_add_u32 s41, s41, 262144
    s_waitcnt vmcnt(0)
    buffer_load_dwordx4 v[44:47], v0, s[8:11], s34 offen sc1
    buffer_load_dwordx4 v[48:51], v0, s[8:11], s34 offen offset:1024 sc1
    buffer_load_dword v10, v8, s[8:11], s35 offen sc1
    ds_read_b128 v[56:59], v9 offset:4096
    ds_read_b128 v[60:63], v9 offset:5120
    ds_read_b128 v[64:67], v9 offset:6144
    ds_read_b128 v[68:71], v9 offset:7168
    v_mov_b64 v[12:13], 0
    v_mov_b64 v[14:15], 0
    v_mov_b64 v[16:17], 0
    v_mov_b64 v[18:19], 0
    v_mov_b64 v[20:21], 0
    v_mov_b64 v[22:23], 0
    v_mov_b64 v[24:25], 0
    v_mov_b64 v[26:27], 0
    v_mov_b64 v[28:29], 0
    v_mov_b64 v[30:31], 0
    v_mov_b64 v[32:33], 0
    v_mov_b64 v[34:35], 0
    s_waitcnt lgkmcnt(0)
Lr1s_step:
    s_mov_b32 s16, 0
    s_mov_b64 s[70:71], 0
    s_mov_b64 s[72:73], 0
    s_mov_b64 s[74:75], 0
Lr1s_p2:
    s_mov_b64 exec, s[70:71]
    buffer_load_dwordx4 v[44:47], v0, s[8:11], s34 offen sc1
    s_mov_b64 exec, s[72:73]
    buffer_load_dwordx4 v[48:51], v0, s[8:11], s34 offen offset:1024 sc1
    s_mov_b64 exec, s[74:75]
    buffer_load_dword v10, v8, s[8:11], s35 offen sc1
    s_mov_b64 exec, -1
    s_add_u32 s16, s16, 1
    s_cmp_gt_u32 s16, 100000
    s_cbranch_scc1 Lr_abort
    s_waitcnt vmcnt(5)
    v_max3_u32 v11, v44, v45, v46
    v_max_u32 v11, v11, v47
    v_cmp_eq_u32 s[70:71], -1, v11
    s_waitcnt vmcnt(4)
    v_max3_u32 v11, v48, v49, v50
    v_max_u32 v11, v11, v51
    v_cmp_eq_u32 s[72:73], -1, v11
    s_waitcnt vmcnt(3)
    v_cmp_eq_u32 s[74:75], -1, v10
    s_or_b64 vcc, s[70:71], s[72:73]
    s_or_b64 vcc, vcc, s[74:75]
    s_cbranch_scc1 Lr1s_p2
    v_smfmac_f32_16x16x64_bf16 v[12:15], v[44:47], v[152:159], v1
    ds_write_b128 v0, v[44:47] offset:2048
    v_smfmac_f32_16x16x64_bf16 v[16:19], v[44:47], v[160:167], v1
    ds_write_b128 v0, v[48:51] offset:3072
    v_smfmac_f32_16x16x64_bf16 v[20:23], v[44:47], v[168:175], v1
    ds_write_b32 v8, v10 offset:8448
    v_smfmac_f32_16x16x64_bf16 v[24:27], v[44:47], v[56:63], v1
    s_waitcnt lgkmcnt(0)
    s_barrier
    ds_read_b128 v[52:55], v0 offset:0
    v_smfmac_f32_16x16x64_bf16 v[12:15], v[48:51], v[192:199], v1
    ds_read_b128 v[36:39], v0 offset:1024
    v_smfmac_f32_16x16x64_bf16 v[16:19], v[48:51], v[200:207], v1
    ds_read_b128 v[56:59], v9 offset:0
    v_smfmac_f32_16x16x64_bf16 v[20:23], v[48:51], v[208:215], v1
    ds_read_b128 v[60:63], v9 offset:1024
    v_smfmac_f32_16x16x64_bf16 v[24:27], v[48:51], v[64:71], v1
    ds_read_b128 v[40:43], v0 offset:4096
    s_waitcnt lgkmcnt(4)
    v_smfmac_f32_16x16x64_bf16 v[12:15], v[52:55], v[72:79], v1
    v_smfmac_f32_16x16x64_bf16 v[16:19], v[52:55], v[80:87], v1
    ds_read_b128 v[64:67], v9 offset:2048
    v_smfmac_f32_16x16x64_bf16 v[20:23], v[52:55], v[88:95], v1
    ds_read_b128 v[68:71], v9 offset:3072
    s_waitcnt lgkmcnt(3)
    v_smfmac_f32_16x16x64_bf16 v[24:27], v[52:55], v[56:63], v1
    v_smfmac_f32_16x16x64_bf16 v[12:15], v[36:39], v[112:119], v1
    ds_read_b128 v[52:55], v0 offset:5120
    v_smfmac_f32_16x16x64_bf16 v[16:19], v[36:39], v[120:127], v1
    ds_read_b128 v[56:59], v9 offset:8192
    v_smfmac_f32_16x16x64_bf16 v[20:23], v[36:39], v[128:135], v1
    ds_read_b128 v[60:63], v9 offset:9216
    s_waitcnt lgkmcnt(3)
    v_smfmac_f32_16x16x64_bf16 v[24:27], v[36:39], v[64:71], v1
    v_smfmac_f32_16x16x64_bf16 v[12:15], v[40:43], v[232:239], v1
    buffer_load_dwordx4 v[36:39], v0, s[8:11], s42 offen
    v_smfmac_f32_16x16x64_bf16 v[16:19], v[40:43], v[240:247], v1
    ds_read_b128 v[64:67], v9 offset:10240
    v_smfmac_f32_16x16x64_bf16 v[20:23], v[40:43], v[248:255], v1
    ds_read_b128 v[68:71], v9 offset:11264
    s_waitcnt lgkmcnt(2)
    v_smfmac_f32_16x16x64_bf16 v[24:27], v[40:43], v[56:63], v1
    s_waitcnt vmcnt(1)
    ds_read_b128 v[44:47], v0 offset:6144
    v_smfmac_f32_16x16x64_bf16 v[12:15], v[52:55], a[16:23], v1
    buffer_load_dwordx4 v[40:43], v0, s[8:11], s42 offen offset:1024
    v_smfmac_f32_16x16x64_bf16 v[16:19], v[52:55], a[24:31], v1
    ds_read_b128 v[56:59], v9 offset:12288
    v_smfmac_f32_16x16x64_bf16 v[20:23], v[52:55], a[32:39], v1
    ds_read_b128 v[60:63], v9 offset:13312
    s_waitcnt lgkmcnt(3)
    v_smfmac_f32_16x16x64_bf16 v[24:27], v[52:55], v[64:71], v1
    ds_read_b128 v[48:51], v0 offset:7168
    s_waitcnt lgkmcnt(3)
    v_smfmac_f32_16x16x64_bf16 v[12:15], v[44:47], a[56:63], v1
    ds_read_b128 v[52:55], v0 offset:8192
    v_smfmac_f32_16x16x64_bf16 v[16:19], v[44:47], a[64:71], v1
    ds_read_b128 v[64:67], v9 offset:14336
    v_smfmac_f32_16x16x64_bf16 v[20:23], v[44:47], a[72:79], v1
    ds_read_b128 v[68:71], v9 offset:15360
    s_waitcnt lgkmcnt(4)
    v_smfmac_f32_16x16x64_bf16 v[24:27], v[44:47], v[56:63], v1
    s_waitcnt lgkmcnt(3)
    v_smfmac_f32_16x16x64_bf16 v[12:15], v[48:51], a[96:103], v1
    v_smfmac_f32_16x16x64_bf16 v[16:19], v[48:51], a[104:111], v1
    ds_read_b128 v[56:59], v9 offset:16384
    s_waitcnt lgkmcnt(3)
    v_smfmac_f32_16x16x64_bf16 v[12:15], v[52:55], a[136:143], v1
    ds_read_b128 v[60:63], v9 offset:17408
    v_smfmac_f32_16x16x64_bf16 v[16:19], v[52:55], a[144:151], v1
    v_smfmac_f32_16x16x64_bf16 v[20:23], v[48:51], a[112:119], v1
    s_waitcnt lgkmcnt(2)
    v_smfmac_f32_16x16x64_bf16 v[24:27], v[48:51], v[64:71], v1
    ds_read_b128 v[64:67], v0 offset:9216
    s_nop 1
    v_add_f32 v12, v12, v14
    v_smfmac_f32_16x16x64_bf16 v[20:23], v[52:55], a[152:159], v1
    ds_read_b128 v[68:71], v0 offset:10240
    v_add_f32 v16, v16, v18
    s_waitcnt lgkmcnt(2)
    v_smfmac_f32_16x16x64_bf16 v[24:27], v[52:55], v[56:63], v1
    ds_read_b128 v[56:59], v0 offset:11264
    v_add_f32 v13, v13, v15
    v_add_f32 v17, v17, v19
    v_cvt_pk_bf16_f32 v14, v12, v16
    v_cvt_pk_bf16_f32 v15, v13, v17
    ds_write_b32 v2, v14 offset:17408
    ds_write_b32 v2, v15 offset:17696
    v_smfmac_f32_16x16x64_bf16 v[28:31], v[52:55], a[160:167], v1
    ds_read_b128 v[60:63], v0 offset:12288
    v_add_f32 v20, v20, v22
    v_add_f32 v24, v24, v26
    v_add_f32 v21, v21, v23
    v_add_f32 v25, v25, v27
    v_smfmac_f32_16x16x64_bf16 v[32:35], v[52:55], a[168:175], v1
    ds_read_b128 v[12:15], v0 offset:2048
    v_cvt_pk_bf16_f32 v22, v20, v24
    v_cvt_pk_bf16_f32 v23, v21, v25
    ds_write_b32 v2, v22 offset:19712
    ds_write_b32 v2, v23 offset:20000
    v_smfmac_f32_16x16x64_bf16 v[28:31], v[48:51], a[120:127], v1
    ds_read_b128 v[16:19], v0 offset:3072
    v_smfmac_f32_16x16x64_bf16 v[32:35], v[48:51], a[128:135], v1
    ds_read_b128 v[20:23], v0 offset:0
    v_smfmac_f32_16x16x64_bf16 v[28:31], v[44:47], a[80:87], v1
    ds_read_b128 v[24:27], v0 offset:1024
    v_smfmac_f32_16x16x64_bf16 v[32:35], v[44:47], a[88:95], v1
    s_waitcnt lgkmcnt(3)
    s_barrier
    ds_read_b128 v[44:47], v3 offset:17408
    v_smfmac_f32_16x16x64_bf16 v[28:31], v[12:15], v[176:183], v1
    ds_read_b128 v[52:55], v0 offset:4096
    v_smfmac_f32_16x16x64_bf16 v[32:35], v[12:15], v[184:191], v1
    ds_read_b128 v[12:15], v3 offset:19712
    s_waitcnt lgkmcnt(5)
    v_smfmac_f32_16x16x64_bf16 v[28:31], v[16:19], v[216:223], v1
    ds_read_b128 v[48:51], v0 offset:5120
    v_smfmac_f32_16x16x64_bf16 v[32:35], v[16:19], v[224:231], v1
    s_waitcnt lgkmcnt(5)
    v_smfmac_f32_16x16x64_bf16 v[28:31], v[20:23], v[96:103], v1
    v_smfmac_f32_16x16x64_bf16 v[32:35], v[20:23], v[104:111], v1
    ds_read_b128 v[20:23], v3 offset:17472
    s_waitcnt lgkmcnt(5)
    v_smfmac_f32_16x16x64_bf16 v[28:31], v[24:27], v[136:143], v1
    v_smfmac_f32_16x16x64_bf16 v[32:35], v[24:27], v[144:151], v1
    s_waitcnt lgkmcnt(3)
    v_smfmac_f32_16x16x64_bf16 v[28:31], v[52:55], a[0:7], v1
    v_smfmac_f32_16x16x64_bf16 v[32:35], v[52:55], a[8:15], v1
    ds_read_b128 v[52:55], v3 offset:19776
    s_waitcnt lgkmcnt(2)
    v_smfmac_f32_16x16x64_bf16 v[28:31], v[48:51], a[40:47], v1
    v_smfmac_f32_16x16x64_bf16 v[32:35], v[48:51], a[48:55], v1
    ds_read_b128 v[48:51], v3 offset:17536
    v_mfma_f32_16x16x32_bf16 v[24:27], v[12:15], v[44:47], 0
    v_mfma_f32_16x16x32_bf16 v[12:15], v[64:67], v[44:47], 0
    ds_read_b128 v[64:67], v0 offset:13312
    v_mfma_f32_16x16x32_bf16 v[16:19], v[68:71], v[44:47], 0
    ds_read_b128 v[68:71], v0 offset:14336
    s_waitcnt lgkmcnt(3)
    v_mfma_f32_16x16x32_bf16 v[24:27], v[52:55], v[20:23], v[24:27]
    ds_read_b128 v[44:47], v3 offset:19840
    v_add_f32 v28, v28, v30
    v_add_f32 v29, v29, v31
    v_mfma_f32_16x16x32_bf16 v[12:15], v[56:59], v[20:23], v[12:15]
    ds_read_b128 v[52:55], v3 offset:17600
    v_add_f32 v32, v32, v34
    v_add_f32 v33, v33, v35
    v_mfma_f32_16x16x32_bf16 v[16:19], v[60:63], v[20:23], v[16:19]
    ds_read_b128 v[56:59], v0 offset:15360
    v_cvt_pk_bf16_f32 v30, v28, v29
    v_cvt_pk_bf16_f32 v31, v32, v33
    s_waitcnt lgkmcnt(2)
    v_mfma_f32_16x16x32_bf16 v[24:27], v[44:47], v[48:51], v[24:27]
    ds_read_b128 v[20:23], v3 offset:19904
    v_lshrrev_b32 v10, 8, v0
    v_mul_u32_u24 v10, 288, v10
    v_mfma_f32_16x16x32_bf16 v[12:15], v[64:67], v[48:51], v[12:15]
    ds_read_b128 v[60:63], v0 offset:16384
    v_and_b32 v11, 0xf0, v0
    v_add_u32 v10, v10, v11
    v_mfma_f32_16x16x32_bf16 v[16:19], v[68:71], v[48:51], v[16:19]
    ds_read_b128 v[32:35], v10 offset:20288
    v_lshrrev_b32 v11, 1, v0
    v_bfi_b32 v30, 1, s66, v30
    s_waitcnt lgkmcnt(2)
    v_mfma_f32_16x16x32_bf16 v[24:27], v[20:23], v[52:55], v[24:27]
    buffer_store_dwordx2 v[30:31], v11, s[8:11], s43 offen offset:2048 sc1
    v_mov_b32 v49, 0
    v_mov_b32 v50, 0
    v_mfma_f32_16x16x32_bf16 v[12:15], v[56:59], v[52:55], v[12:15]
    v_mov_b64 v[64:65], s[68:69]
    v_mov_b64 v[66:67], s[68:69]
    s_waitcnt lgkmcnt(1)
    v_mfma_f32_16x16x32_bf16 v[16:19], v[60:63], v[52:55], v[16:19]
    s_waitcnt lgkmcnt(0)
    v_bfi_b32 v32, 1, s66, v32
    s_mov_b64 exec, s[52:53]
    buffer_store_dwordx4 v[32:35], v0, s[8:11], s43 offen sc1
    s_mov_b64 exec, -1
    v_max3_f32 v10, v24, v25, v12
    v_max3_f32 v10, v10, v13, v14
    s_nop 0
    v_max3_f32 v10, v10, v15, v16
    v_max3_f32 v10, v10, v17, v18
    v_max_f32 v10, v10, v19
    v_mov_b32 v11, v10
    s_nop 1
    v_permlane32_swap_b32 v10, v11
    v_max_f32 v10, v10, v11
    v_mov_b32 v11, v10
    s_nop 1
    v_permlane16_swap_b32 v10, v11
    v_max_f32 v10, v10, v11
    v_mul_f32 v20, s46, v10
    v_pk_fma_f32 v[24:25], v[24:25], s[46:47], v[20:21] op_sel_hi:[1,1,0] neg_lo:[0,0,1] neg_hi:[0,0,1]
    v_pk_fma_f32 v[12:13], v[12:13], s[46:47], v[20:21] op_sel_hi:[1,1,0] neg_lo:[0,0,1] neg_hi:[0,0,1]
    v_exp_f32 v24, v24
    v_exp_f32 v25, v25
    v_pk_fma_f32 v[14:15], v[14:15], s[46:47], v[20:21] op_sel_hi:[1,1,0] neg_lo:[0,0,1] neg_hi:[0,0,1]
    v_exp_f32 v12, v12
    v_exp_f32 v13, v13
    v_pk_fma_f32 v[16:17], v[16:17], s[46:47], v[20:21] op_sel_hi:[1,1,0] neg_lo:[0,0,1] neg_hi:[0,0,1]
    v_cvt_pk_bf16_f32 v48, v24, v25
    v_exp_f32 v14, v14
    v_pk_fma_f32 v[18:19], v[18:19], s[46:47], v[20:21] op_sel_hi:[1,1,0] neg_lo:[0,0,1] neg_hi:[0,0,1]
    v_cvt_pk_bf16_f32 v51, v24, v25
    v_exp_f32 v15, v15
    v_cvt_pk_bf16_f32 v44, v12, v13
    v_exp_f32 v16, v16
    v_exp_f32 v17, v17
    v_cvt_pk_bf16_f32 v45, v14, v15
    v_exp_f32 v18, v18
    v_exp_f32 v19, v19
    v_cvt_pk_bf16_f32 v46, v16, v17
    v_cvt_pk_bf16_f32 v47, v18, v19
    v_mfma_f32_16x16x16_bf16 v[68:71], v[64:65], v[48:49], 0
    v_mfma_f32_16x16x16_bf16 v[52:55], v[30:31], v[48:49], 0
    v_mfma_f32_16x16x16_bf16 v[56:59], v[30:31], v[50:51], 0
    v_mfma_f32_16x16x32_bf16 v[68:71], v[64:67], v[44:47], v[68:71]
    s_waitcnt vmcnt(3)
    v_mfma_f32_16x16x32_bf16 v[52:55], v[36:39], v[44:47], v[52:55]
    s_waitcnt vmcnt(2)
    v_mfma_f32_16x16x32_bf16 v[56:59], v[40:43], v[44:47], v[56:59]
    ds_read_b128 v[36:39], v0 offset:38912
    ds_read_b128 v[40:43], v0 offset:39936
    ds_read_b128 v[60:63], v9 offset:24576
    s_nop 0
    v_rcp_f32 v10, v68
    s_nop 0
    v_pk_mul_f32 v[52:53], v[52:53], v[10:11] op_sel_hi:[1,0]
    s_nop 0
    v_pk_mul_f32 v[56:57], v[56:57], v[10:11] op_sel_hi:[1,0]
    v_cvt_pk_bf16_f32 v16, v52, v56
    v_cvt_pk_bf16_f32 v17, v53, v57
    v_pk_mul_f32 v[54:55], v[54:55], v[10:11] op_sel_hi:[1,0]
    v_pk_mul_f32 v[58:59], v[58:59], v[10:11] op_sel_hi:[1,0]
    v_cvt_pk_bf16_f32 v18, v54, v58
    v_cvt_pk_bf16_f32 v19, v55, v59
    ds_write_b128 v3, v[16:19] offset:22080
    ds_read_b128 v[64:67], v9 offset:25600
    v_mov_b64 v[12:13], 0
    v_mov_b64 v[14:15], 0
    v_mov_b64 v[20:21], 0
    v_mov_b64 v[22:23], 0
    v_mov_b64 v[24:25], 0
    v_mov_b64 v[26:27], 0
    v_mov_b64 v[32:33], 0
    v_mov_b64 v[34:35], 0
    v_mov_b64 v[44:45], 0
    v_mov_b64 v[46:47], 0
    v_mov_b64 v[48:49], 0
    v_mov_b64 v[50:51], 0
    s_waitcnt lgkmcnt(1)
    s_barrier
    ds_read_b128 v[52:55], v4 offset:22016
    ds_read_b128 v[56:59], v4 offset:22144
    v_mov_b64 v[68:69], 0
    v_mov_b64 v[70:71], 0
    v_mov_b64 v[28:29], 0
    v_mov_b64 v[30:31], 0
    v_mov_b64 v[16:17], 0
    v_mov_b64 v[18:19], 0
    s_cmp_eq_u32 s33, 63
    s_cbranch_scc1 Lr1s_last
    s_waitcnt lgkmcnt(1)
    v_smfmac_f32_16x16x64_bf16 v[28:31], v[52:55], v[60:67], v1
    ds_read_b128 v[60:63], v0 offset:32768
    s_waitcnt lgkmcnt(1)
    v_smfmac_f32_16x16x64_bf16 v[28:31], v[56:59], v[36:43], v1
    ds_read_b128 v[64:67], v0 offset:33792
    ds_read_b128 v[36:39], v9 offset:18432
    v_smfmac_f32_16x16x64_bf16 v[12:15], v[52:55], a[176:183], v1
    ds_read_b128 v[40:43], v9 offset:19456
    v_smfmac_f32_16x16x64_bf16 v[12:15], v[56:59], a[184:191], v1
    buffer_load_dwordx4 v0, s[8:11], s41 offen offset:0 lds
    v_smfmac_f32_16x16x64_bf16 v[20:23], v[52:55], a[192:199], v1
    s_nop 0
    v_add_f32 v28, v28, v30
    v_add_f32 v29, v29, v31
    s_waitcnt lgkmcnt(2)
    v_smfmac_f32_16x16x64_bf16 v[20:23], v[56:59], v[60:67], v1
    ds_read_b128 v[60:63], v9 offset:20480
    v_cvt_pk_bf16_f32 v28, v28, v29
    v_bfi_b32 v28, 1, s39, v28
    buffer_store_dword v28, v8, s[8:11], s38 offen offset:2048 sc1
    s_waitcnt lgkmcnt(1)
    v_smfmac_f32_16x16x64_bf16 v[24:27], v[52:55], v[36:43], v1
    ds_read_b128 v[64:67], v9 offset:21504
    ds_read_b128 v[36:39], v0 offset:34816
    v_add_f32 v12, v12, v14
    v_add_f32 v13, v13, v15
    v_smfmac_f32_16x16x64_bf16 v[24:27], v[56:59], a[200:207], v1
    ds_read_b128 v[40:43], v0 offset:35840
    v_cvt_pk_bf16_f32 v12, v12, v13
    v_bfi_b32 v12, 1, s39, v12
    v_smfmac_f32_16x16x64_bf16 v[32:35], v[52:55], a[208:215], v1
    buffer_load_dwordx4 v0, s[8:11], s41 offen offset:1024 lds
    v_add_f32 v20, v20, v22
    v_add_f32 v21, v21, v23
    v_smfmac_f32_16x16x64_bf16 v[32:35], v[56:59], a[216:223], v1
    v_cvt_pk_bf16_f32 v13, v20, v21
    s_waitcnt lgkmcnt(2)
    v_smfmac_f32_16x16x64_bf16 v[44:47], v[52:55], v[60:67], v1
    ds_read_b128 v[60:63], v0 offset:36864
    v_add_f32 v24, v24, v26
    v_add_f32 v25, v25, v27
    s_waitcnt lgkmcnt(1)
    v_smfmac_f32_16x16x64_bf16 v[44:47], v[56:59], v[36:43], v1
    ds_read_b128 v[64:67], v0 offset:37888
    ds_read_b128 v[36:39], v9 offset:22528
    v_cvt_pk_bf16_f32 v14, v24, v25
    v_smfmac_f32_16x16x64_bf16 v[48:51], v[52:55], a[224:231], v1
    ds_read_b128 v[40:43], v9 offset:23552
    v_add_f32 v32, v32, v34
    v_add_f32 v33, v33, v35
    v_smfmac_f32_16x16x64_bf16 v[48:51], v[56:59], a[232:239], v1
    v_cvt_pk_bf16_f32 v15, v32, v33
    buffer_store_dwordx4 v[12:15], v0, s[8:11], s38 offen offset:0 sc1
    v_smfmac_f32_16x16x64_bf16 v[68:71], v[52:55], a[240:247], v1
    v_add_f32 v44, v44, v46
    v_add_f32 v45, v45, v47
    s_waitcnt lgkmcnt(2)
    v_smfmac_f32_16x16x64_bf16 v[68:71], v[56:59], v[60:67], v1
    v_cvt_pk_bf16_f32 v44, v44, v45
    v_bfi_b32 v44, 1, s39, v44
    s_waitcnt lgkmcnt(0)
    v_smfmac_f32_16x16x64_bf16 v[16:19], v[52:55], v[36:43], v1
    v_add_f32 v48, v48, v50
    v_add_f32 v49, v49, v51
    v_smfmac_f32_16x16x64_bf16 v[16:19], v[56:59], a[248:255], v1
    v_cvt_pk_bf16_f32 v45, v48, v49
    v_add_f32 v68, v68, v70
    v_add_f32 v69, v69, v71
    v_cvt_pk_bf16_f32 v46, v68, v69
    s_nop 3
    v_add_f32 v16, v16, v18
    v_add_f32 v17, v17, v19
    v_cvt_pk_bf16_f32 v47, v16, v17
    buffer_store_dwordx4 v[44:47], v0, s[8:11], s38 offen offset:1024 sc1
    v_bfe_u32 v10, v0, 4, 4
    v_mov_b32 v11, 0x3f80
    v_mov_b32 v40, 0x3f800000
    v_cmp_eq_u32 vcc, 0, v10
    v_cmp_eq_u32 s[48:49], 1, v10
    s_nop 0
    v_cndmask_b32 v36, 0, v11, vcc
    v_cndmask_b32 v36, v36, v40, s[48:49]
    v_cmp_eq_u32 vcc, 2, v10
    v_cmp_eq_u32 s[48:49], 3, v10
    s_nop 0
    v_cndmask_b32 v37, 0, v11, vcc
    v_cndmask_b32 v37, v37, v40, s[48:49]
    v_cmp_eq_u32 vcc, 4, v10
    v_cmp_eq_u32 s[48:49], 5, v10
    s_nop 0
    v_cndmask_b32 v38, 0, v11, vcc
    v_cndmask_b32 v38, v38, v40, s[48:49]
    v_cmp_eq_u32 vcc, 6, v10
    v_cmp_eq_u32 s[48:49], 7, v10
    s_nop 0
    v_cndmask_b32 v39, 0, v11, vcc
    v_cndmask_b32 v39, v39, v40, s[48:49]
    s_sleep 5
    buffer_load_dwordx4 v[52:55], v6, s[8:11], s57 offen sc1
    buffer_load_dwordx4 v[56:59], v6, s[8:11], s58 offen sc1
    buffer_load_dwordx4 v[60:63], v6, s[8:11], s59 offen sc1
    buffer_load_dwordx4 v[64:67], v6, s[8:11], s60 offen sc1
    s_mov_b32 s16, 0
    s_mov_b64 s[70:71], 0
    s_mov_b64 s[72:73], 0
    s_mov_b64 s[74:75], 0
    s_mov_b64 s[76:77], 0
Lr1s_p1:
    s_mov_b64 exec, s[70:71]
    buffer_load_dwordx4 v[52:55], v6, s[8:11], s57 offen sc1
    s_mov_b64 exec, s[72:73]
    buffer_load_dwordx4 v[56:59], v6, s[8:11], s58 offen sc1
    s_mov_b64 exec, s[74:75]
    buffer_load_dwordx4 v[60:63], v6, s[8:11], s59 offen sc1
    s_mov_b64 exec, s[76:77]
    buffer_load_dwordx4 v[64:67], v6, s[8:11], s60 offen sc1
    s_mov_b64 exec, -1
    s_add_u32 s16, s16, 1
    s_cmp_gt_u32 s16, 100000
    s_cbranch_scc1 Lr_abort
    s_waitcnt vmcnt(7)
    v_and_b32 v11, 1, v52
    v_cmp_ne_u32 s[70:71], s39, v11
    v_mfma_f32_16x16x32_bf16 v[40:43], v[52:55], v[36:39], 0
    s_waitcnt vmcnt(6)
    v_and_b32 v11, 1, v56
    v_cmp_ne_u32 s[72:73], s39, v11
    v_mfma_f32_16x16x32_bf16 v[40:43], v[56:59], v[36:39], v[40:43]
    s_waitcnt vmcnt(5)
    v_and_b32 v11, 1, v60
    v_cmp_ne_u32 s[74:75], s39, v11
    v_mfma_f32_16x16x32_bf16 v[40:43], v[60:63], v[36:39], v[40:43]
    s_or_b64 vcc, s[70:71], s[72:73]
    s_waitcnt vmcnt(4)
    v_and_b32 v11, 1, v64
    v_cmp_ne_u32 s[76:77], s39, v11
    v_mfma_f32_16x16x32_bf16 v[40:43], v[64:67], v[36:39], v[40:43]
    s_or_b64 vcc, vcc, s[74:75]
    s_or_b64 vcc, vcc, s[76:77]
    s_cbranch_scc1 Lr1s_p1
    s_nop 4
    v_permlane16_swap_b32 v40, v42
    v_permlane16_swap_b32 v41, v43
    s_mov_b64 exec, s[50:51]
    v_add_f32 v40, v40, v42
    v_add_f32 v41, v41, v43
    v_cvt_pk_bf16_f32 v40, v40, v41
    v_min_u32 v40, s54, v40
    buffer_store_dword v40, v7, s[8:11], s36 offen sc1
    v_mov_b32 v41, -1
    buffer_store_dword v41, v7, s[8:11], s37 offen sc1
    s_mov_b64 exec, -1
    s_xor_b32 s34, s34, 16384
    s_xor_b32 s35, s35, 16384
    s_barrier
    s_sleep 2
    buffer_load_dwordx4 v[44:47], v0, s[8:11], s34 offen sc1
    buffer_load_dwordx4 v[48:51], v0, s[8:11], s34 offen offset:1024 sc1
    buffer_load_dword v10, v8, s[8:11], s35 offen sc1
    s_add_u32 s33, s33, 1
    s_bfe_u32 s39, s33, 0x10001
    s_xor_b32 s38, s38, 524288
    s_xor_b32 s57, s57, 524288
    s_xor_b32 s58, s58, 524288
    s_xor_b32 s59, s59, 524288
    s_xor_b32 s60, s60, 524288
    s_xor_b32 s36, s36, 16384
    s_xor_b32 s37, s37, 16384
    s_and_b32 s17, s33, 7
    s_mul_i32 s17, s17, 131072
    s_add_u32 s43, s45, s17
    s_bfe_u32 s66, s33, 65539
    s_add_u32 s67, s67, 22528
    s_add_u32 s42, s42, 262144
    s_add_u32 s41, s41, 262144
    s_add_u32 s40, s40, 262144
    s_add_u32 s44, s44, 22528
    s_waitcnt vmcnt(5)
    ds_read_b128 v[56:59], v9 offset:4096
    ds_read_b128 v[60:63], v9 offset:5120
    ds_read_b128 v[64:67], v9 offset:6144
    ds_read_b128 v[68:71], v9 offset:7168
    v_mov_b64 v[12:13], 0
    v_mov_b64 v[14:15], 0
    v_mov_b64 v[16:17], 0
    v_mov_b64 v[18:19], 0
    v_mov_b64 v[20:21], 0
    v_mov_b64 v[22:23], 0
    v_mov_b64 v[24:25], 0
    v_mov_b64 v[26:27], 0
    v_mov_b64 v[28:29], 0
    v_mov_b64 v[30:31], 0
    v_mov_b64 v[32:33], 0
    v_mov_b64 v[34:35], 0
    s_waitcnt lgkmcnt(0)
    s_branch Lr1s_step
Lr1s_last:
    s_waitcnt vmcnt(0) lgkmcnt(0)
    s_branch Lr_exit
L_w2_0:
    s_cmp_lg_u32 s14, 2
    s_cbranch_scc1 L_w3_0
    s_barrier
    s_mov_b32 m0, 13312
    s_nop 0
    buffer_load_dwordx4 v0, s[8:11], s41 offen offset:0 lds
    buffer_load_dwordx4 v0, s[8:11], s41 offen offset:1024 lds
    s_add_u32 s41, s41, 262144
    s_waitcnt vmcnt(0)
    buffer_load_dwordx4 v[44:47], v0, s[8:11], s34 offen sc1
    buffer_load_dwordx4 v[48:51], v0, s[8:11], s34 offen offset:1024 sc1
    buffer_load_dword v10, v8, s[8:11], s35 offen sc1
    ds_read_b128 v[56:59], v9 offset:8192
    ds_read_b128 v[60:63], v9 offset:9216
    ds_read_b128 v[64:67], v9 offset:10240
    ds_read_b128 v[68:71], v9 offset:11264
    v_mov_b64 v[12:13], 0
    v_mov_b64 v[14:15], 0
    v_mov_b64 v[16:17], 0
    v_mov_b64 v[18:19], 0
    v_mov_b64 v[20:21], 0
    v_mov_b64 v[22:23], 0
    v_mov_b64 v[24:25], 0
    v_mov_b64 v[26:27], 0
    v_mov_b64 v[28:29], 0
    v_mov_b64 v[30:31], 0
    v_mov_b64 v[32:33], 0
    v_mov_b64 v[34:35], 0
    s_waitcnt lgkmcnt(0)
Lr2s_step:
    s_mov_b32 s16, 0
    s_mov_b64 s[70:71], 0
    s_mov_b64 s[72:73], 0
    s_mov_b64 s[74:75], 0
Lr2s_p2:
    s_mov_b64 exec, s[70:71]
    buffer_load_dwordx4 v[44:47], v0, s[8:11], s34 offen sc1
    s_mov_b64 exec, s[72:73]
    buffer_load_dwordx4 v[48:51], v0, s[8:11], s34 offen offset:1024 sc1
    s_mov_b64 exec, s[74:75]
    buffer_load_dword v10, v8, s[8:11], s35 offen sc1
    s_mov_b64 exec, -1
    s_add_u32 s16, s16, 1
    s_cmp_gt_u32 s16, 100000
    s_cbranch_scc1 Lr_abort
    s_waitcnt vmcnt(5)
    v_max3_u32 v11, v44, v45, v46
    v_max_u32 v11, v11, v47
    v_cmp_eq_u32 s[70:71], -1, v11
    s_waitcnt vmcnt(4)
    v_max3_u32 v11, v48, v49, v50
    v_max_u32 v11, v11, v51
    v_cmp_eq_u32 s[72:73], -1, v11
    s_waitcnt vmcnt(3)
    v_cmp_eq_u32 s[74:75], -1, v10
    s_or_b64 vcc, s[70:71], s[72:73]
    s_or_b64 vcc, vcc, s[74:75]
    s_cbranch_scc1 Lr2s_p2
    v_smfmac_f32_16x16x64_bf16 v[12:15], v[44:47], v[232:239], v1
    ds_write_b128 v0, v[44:47] offset:4096
    v_smfmac_f32_16x16x64_bf16 v[16:19], v[44:47], v[240:247], v1
    ds_write_b128 v0, v[48:51] offset:5120
    v_smfmac_f32_16x16x64_bf16 v[20:23], v[44:47], v[248:255], v1
    ds_write_b32 v8, v10 offset:8704
    v_smfmac_f32_16x16x64_bf16 v[24:27], v[44:47], v[56:63], v1
    s_waitcnt lgkmcnt(0)
    s_barrier
    ds_read_b128 v[52:55], v0 offset:0
    v_smfmac_f32_16x16x64_bf16 v[12:15], v[48:51], a[16:23], v1
    ds_read_b128 v[36:39], v0 offset:1024
    v_smfmac_f32_16x16x64_bf16 v[16:19], v[48:51], a[24:31], v1
    ds_read_b128 v[56:59], v9 offset:0
    v_smfmac_f32_16x16x64_bf16 v[20:23], v[48:51], a[32:39], v1
    ds_read_b128 v[60:63], v9 offset:1024
    v_smfmac_f32_16x16x64_bf16 v[24:27], v[48:51], v[64:71], v1
    ds_read_b128 v[40:43], v0 offset:2048
    s_waitcnt lgkmcnt(4)
    v_smfmac_f32_16x16x64_bf16 v[12:15], v[52:55], v[72:79], v1
    v_smfmac_f32_16x16x64_bf16 v[16:19], v[52:55], v[80:87], v1
    ds_read_b128 v[64:67], v9 offset:2048
    v_smfmac_f32_16x16x64_bf16 v[20:23], v[52:55], v[88:95], v1
    ds_read_b128 v[68:71], v9 offset:3072
    s_waitcnt lgkmcnt(3)
    v_smfmac_f32_16x16x64_bf16 v[24:27], v[52:55], v[56:63], v1
    v_smfmac_f32_16x16x64_bf16 v[12:15], v[36:39], v[112:119], v1
    ds_read_b128 v[52:55], v0 offset:3072
    v_smfmac_f32_16x16x64_bf16 v[16:19], v[36:39], v[120:127], v1
    ds_read_b128 v[56:59], v9 offset:4096
    v_smfmac_f32_16x16x64_bf16 v[20:23], v[36:39], v[128:135], v1
    ds_read_b128 v[60:63], v9 offset:5120
    s_waitcnt lgkmcnt(3)
    v_smfmac_f32_16x16x64_bf16 v[24:27], v[36:39], v[64:71], v1
    v_smfmac_f32_16x16x64_bf16 v[12:15], v[40:43], v[152:159], v1
    buffer_load_dwordx4 v[36:39], v0, s[8:11], s42 offen
    v_smfmac_f32_16x16x64_bf16 v[16:19], v[40:43], v[160:167], v1
    ds_read_b128 v[64:67], v9 offset:6144
    v_smfmac_f32_16x16x64_bf16 v[20:23], v[40:43], v[168:175], v1
    ds_read_b128 v[68:71], v9 offset:7168
    s_waitcnt lgkmcnt(2)
    v_smfmac_f32_16x16x64_bf16 v[24:27], v[40:43], v[56:63], v1
    s_waitcnt vmcnt(1)
    ds_read_b128 v[44:47], v0 offset:6144
    v_smfmac_f32_16x16x64_bf16 v[12:15], v[52:55], v[192:199], v1
    buffer_load_dwordx4 v[40:43], v0, s[8:11], s42 offen offset:1024
    v_smfmac_f32_16x16x64_bf16 v[16:19], v[52:55], v[200:207], v1
    ds_read_b128 v[56:59], v9 offset:12288
    v_smfmac_f32_16x16x64_bf16 v[20:23], v[52:55], v[208:215], v1
    ds_read_b128 v[60:63], v9 offset:13312
    s_waitcnt lgkmcnt(3)
    v_smfmac_f32_16x16x64_bf16 v[24:27], v[52:55], v[64:71], v1
    ds_read_b128 v[48:51], v0 offset:7168
    s_waitcnt lgkmcnt(3)
    v_smfmac_f32_16x16x64_bf16 v[12:15], v[44:47], a[56:63], v1
    ds_read_b128 v[52:55], v0 offset:8192
    v_smfmac_f32_16x16x64_bf16 v[16:19], v[44:47], a[64:71], v1
    ds_read_b128 v[64:67], v9 offset:14336
    v_smfmac_f32_16x16x64_bf16 v[20:23], v[44:47], a[72:79], v1
    ds_read_b128 v[68:71], v9 offset:15360
    s_waitcnt lgkmcnt(4)
    v_smfmac_f32_16x16x64_bf16 v[24:27], v[44:47], v[56:63], v1
    s_waitcnt lgkmcnt(3)
    v_smfmac_f32_16x16x64_bf16 v[12:15], v[48:51], a[96:103], v1
    v_smfmac_f32_16x16x64_bf16 v[16:19], v[48:51], a[104:111], v1
    ds_read_b128 v[56:59], v9 offset:16384
    s_waitcnt lgkmcnt(3)
    v_smfmac_f32_16x16x64_bf16 v[12:15], v[52:55], a[136:143], v1
    ds_read_b128 v[60:63], v9 offset:17408
    v_smfmac_f32_16x16x64_bf16 v[16:19], v[52:55], a[144:151], v1
    v_smfmac_f32_16x16x64_bf16 v[20:23], v[48:51], a[112:119], v1
    s_waitcnt lgkmcnt(2)
    v_smfmac_f32_16x16x64_bf16 v[24:27], v[48:51], v[64:71], v1
    ds_read_b128 v[64:67], v0 offset:9216
    s_nop 1
    v_add_f32 v12, v12, v14
    v_smfmac_f32_16x16x64_bf16 v[20:23], v[52:55], a[152:159], v1
    ds_read_b128 v[68:71], v0 offset:10240
    v_add_f32 v16, v16, v18
    s_waitcnt lgkmcnt(2)
    v_smfmac_f32_16x16x64_bf16 v[24:27], v[52:55], v[56:63], v1
    ds_read_b128 v[56:59], v0 offset:11264
    v_add_f32 v13, v13, v15
    v_add_f32 v17, v17, v19
    v_cvt_pk_bf16_f32 v14, v12, v16
    v_cvt_pk_bf16_f32 v15, v13, v17
    ds_write_b32 v2, v14 offset:17408
    ds_write_b32 v2, v15 offset:17696
    v_smfmac_f32_16x16x64_bf16 v[28:31], v[52:55], a[160:167], v1
    ds_read_b128 v[60:63], v0 offset:12288
    v_add_f32 v20, v20, v22
    v_add_f32 v24, v24, v26
    v_add_f32 v21, v21, v23
    v_add_f32 v25, v25, v27
    v_smfmac_f32_16x16x64_bf16 v[32:35], v[52:55], a[168:175], v1
    ds_read_b128 v[12:15], v0 offset:4096
    v_cvt_pk_bf16_f32 v22, v20, v24
    v_cvt_pk_bf16_f32 v23, v21, v25
    ds_write_b32 v2, v22 offset:19712
    ds_write_b32 v2, v23 offset:20000
    v_smfmac_f32_16x16x64_bf16 v[28:31], v[48:51], a[120:127], v1
    ds_read_b128 v[16:19], v0 offset:5120
    v_smfmac_f32_16x16x64_bf16 v[32:35], v[48:51], a[128:135], v1
    ds_read_b128 v[20:23], v0 offset:0
    v_smfmac_f32_16x16x64_bf16 v[28:31], v[44:47], a[80:87], v1
    ds_read_b128 v[24:27], v0 offset:1024
    v_smfmac_f32_16x16x64_bf16 v[32:35], v[44:47], a[88:95], v1
    s_waitcnt lgkmcnt(3)
    s_barrier
    ds_read_b128 v[44:47], v3 offset:17408
    v_smfmac_f32_16x16x64_bf16 v[28:31], v[12:15], a[0:7], v1
    ds_read_b128 v[52:55], v0 offset:2048
    v_smfmac_f32_16x16x64_bf16 v[32:35], v[12:15], a[8:15], v1
    ds_read_b128 v[12:15], v3 offset:19712
    s_waitcnt lgkmcnt(5)
    v_smfmac_f32_16x16x64_bf16 v[28:31], v[16:19], a[40:47], v1
    ds_read_b128 v[48:51], v0 offset:3072
    v_smfmac_f32_16x16x64_bf16 v[32:35], v[16:19], a[48:55], v1
    s_waitcnt lgkmcnt(5)
    v_smfmac_f32_16x16x64_bf16 v[28:31], v[20:23], v[96:103], v1
    v_smfmac_f32_16x16x64_bf16 v[32:35], v[20:23], v[104:111], v1
    ds_read_b128 v[20:23], v3 offset:17472
    s_waitcnt lgkmcnt(5)
    v_smfmac_f32_16x16x64_bf16 v[28:31], v[24:27], v[136:143], v1
    v_smfmac_f32_16x16x64_bf16 v[32:35], v[24:27], v[144:151], v1
    s_waitcnt lgkmcnt(3)
    v_smfmac_f32_16x16x64_bf16 v[28:31], v[52:55], v[176:183], v1
    v_smfmac_f32_16x16x64_bf16 v[32:35], v[52:55], v[184:191], v1
    ds_read_b128 v[52:55], v3 offset:19776
    s_waitcnt lgkmcnt(2)
    v_smfmac_f32_16x16x64_bf16 v[28:31], v[48:51], v[216:223], v1
    v_smfmac_f32_16x16x64_bf16 v[32:35], v[48:51], v[224:231], v1
    ds_read_b128 v[48:51], v3 offset:17536
    v_mfma_f32_16x16x32_bf16 v[24:27], v[12:15], v[44:47], 0
    v_mfma_f32_16x16x32_bf16 v[12:15], v[64:67], v[44:47], 0
    ds_read_b128 v[64:67], v0 offset:13312
    v_mfma_f32_16x16x32_bf16 v[16:19], v[68:71], v[44:47], 0
    ds_read_b128 v[68:71], v0 offset:14336
    s_waitcnt lgkmcnt(3)
    v_mfma_f32_16x16x32_bf16 v[24:27], v[52:55], v[20:23], v[24:27]
    ds_read_b128 v[44:47], v3 offset:19840
    v_add_f32 v28, v28, v30
    v_add_f32 v29, v29, v31
    v_mfma_f32_16x16x32_bf16 v[12:15], v[56:59], v[20:23], v[12:15]
    ds_read_b128 v[52:55], v3 offset:17600
    v_add_f32 v32, v32, v34
    v_add_f32 v33, v33, v35
    v_mfma_f32_16x16x32_bf16 v[16:19], v[60:63], v[20:23], v[16:19]
    ds_read_b128 v[56:59], v0 offset:15360
    v_cvt_pk_bf16_f32 v30, v28, v29
    v_cvt_pk_bf16_f32 v31, v32, v33
    s_waitcnt lgkmcnt(2)
    v_mfma_f32_16x16x32_bf16 v[24:27], v[44:47], v[48:51], v[24:27]
    ds_read_b128 v[20:23], v3 offset:19904
    v_lshrrev_b32 v10, 8, v0
    v_mul_u32_u24 v10, 288, v10
    v_mfma_f32_16x16x32_bf16 v[12:15], v[64:67], v[48:51], v[12:15]
    ds_read_b128 v[60:63], v0 offset:16384
    v_and_b32 v11, 0xf0, v0
    v_add_u32 v10, v10, v11
    v_mfma_f32_16x16x32_bf16 v[16:19], v[68:71], v[48:51], v[16:19]
    ds_read_b128 v[32:35], v10 offset:20864
    v_lshrrev_b32 v11, 1, v0
    v_bfi_b32 v30, 1, s66, v30
    s_waitcnt lgkmcnt(2)
    v_mfma_f32_16x16x32_bf16 v[24:27], v[20:23], v[52:55], v[24:27]
    buffer_store_dwordx2 v[30:31], v11, s[8:11], s43 offen offset:2048 sc1
    v_mov_b32 v49, 0
    v_mov_b32 v50, 0
    v_mfma_f32_16x16x32_bf16 v[12:15], v[56:59], v[52:55], v[12:15]
    v_mov_b64 v[64:65], s[68:69]
    v_mov_b64 v[66:67], s[68:69]
    s_waitcnt lgkmcnt(1)
    v_mfma_f32_16x16x32_bf16 v[16:19], v[60:63], v[52:55], v[16:19]
    s_waitcnt lgkmcnt(0)
    v_bfi_b32 v32, 1, s66, v32
    s_mov_b64 exec, s[52:53]
    buffer_store_dwordx4 v[32:35], v0, s[8:11], s43 offen sc1
    s_mov_b64 exec, -1
    v_max3_f32 v10, v24, v25, v12
    v_max3_f32 v10, v10, v13, v14
    s_nop 0
    v_max3_f32 v10, v10, v15, v16
    v_max3_f32 v10, v10, v17, v18
    v_max_f32 v10, v10, v19
    v_mov_b32 v11, v10
    s_nop 1
    v_permlane32_swap_b32 v10, v11
    v_max_f32 v10, v10, v11
    v_mov_b32 v11, v10
    s_nop 1
    v_permlane16_swap_b32 v10, v11
    v_max_f32 v10, v10, v11
    v_mul_f32 v20, s46, v10
    v_pk_fma_f32 v[24:25], v[24:25], s[46:47], v[20:21] op_sel_hi:[1,1,0] neg_lo:[0,0,1] neg_hi:[0,0,1]
    v_pk_fma_f32 v[12:13], v[12:13], s[46:47], v[20:21] op_sel_hi:[1,1,0] neg_lo:[0,0,1] neg_hi:[0,0,1]
    v_exp_f32 v24, v24
    v_exp_f32 v25, v25
    v_pk_fma_f32 v[14:15], v[14:15], s[46:47], v[20:21] op_sel_hi:[1,1,0] neg_lo:[0,0,1] neg_hi:[0,0,1]
    v_exp_f32 v12, v12
    v_exp_f32 v13, v13
    v_pk_fma_f32 v[16:17], v[16:17], s[46:47], v[20:21] op_sel_hi:[1,1,0] neg_lo:[0,0,1] neg_hi:[0,0,1]
    v_cvt_pk_bf16_f32 v48, v24, v25
    v_exp_f32 v14, v14
    v_pk_fma_f32 v[18:19], v[18:19], s[46:47], v[20:21] op_sel_hi:[1,1,0] neg_lo:[0,0,1] neg_hi:[0,0,1]
    v_cvt_pk_bf16_f32 v51, v24, v25
    v_exp_f32 v15, v15
    v_cvt_pk_bf16_f32 v44, v12, v13
    v_exp_f32 v16, v16
    v_exp_f32 v17, v17
    v_cvt_pk_bf16_f32 v45, v14, v15
    v_exp_f32 v18, v18
    v_exp_f32 v19, v19
    v_cvt_pk_bf16_f32 v46, v16, v17
    v_cvt_pk_bf16_f32 v47, v18, v19
    v_mfma_f32_16x16x16_bf16 v[68:71], v[64:65], v[48:49], 0
    v_mfma_f32_16x16x16_bf16 v[52:55], v[30:31], v[48:49], 0
    v_mfma_f32_16x16x16_bf16 v[56:59], v[30:31], v[50:51], 0
    v_mfma_f32_16x16x32_bf16 v[68:71], v[64:67], v[44:47], v[68:71]
    s_waitcnt vmcnt(3)
    v_mfma_f32_16x16x32_bf16 v[52:55], v[36:39], v[44:47], v[52:55]
    s_waitcnt vmcnt(2)
    v_mfma_f32_16x16x32_bf16 v[56:59], v[40:43], v[44:47], v[56:59]
    ds_read_b128 v[36:39], v0 offset:47104
    ds_read_b128 v[40:43], v0 offset:48128
    ds_read_b128 v[60:63], v9 offset:24576
    s_nop 0
    v_rcp_f32 v10, v68
    s_nop 0
    v_pk_mul_f32 v[52:53], v[52:53], v[10:11] op_sel_hi:[1,0]
    s_nop 0
    v_pk_mul_f32 v[56:57], v[56:57], v[10:11] op_sel_hi:[1,0]
    v_cvt_pk_bf16_f32 v16, v52, v56
    v_cvt_pk_bf16_f32 v17, v53, v57
    v_pk_mul_f32 v[54:55], v[54:55], v[10:11] op_sel_hi:[1,0]
    v_pk_mul_f32 v[58:59], v[58:59], v[10:11] op_sel_hi:[1,0]
    v_cvt_pk_bf16_f32 v18, v54, v58
    v_cvt_pk_bf16_f32 v19, v55, v59
    ds_write_b128 v3, v[16:19] offset:22144
    ds_read_b128 v[64:67], v9 offset:25600
    v_mov_b64 v[12:13], 0
    v_mov_b64 v[14:15], 0
    v_mov_b64 v[20:21], 0
    v_mov_b64 v[22:23], 0
    v_mov_b64 v[24:25], 0
    v_mov_b64 v[26:27], 0
    v_mov_b64 v[32:33], 0
    v_mov_b64 v[34:35], 0
    v_mov_b64 v[44:45], 0
    v_mov_b64 v[46:47], 0
    v_mov_b64 v[48:49], 0
    v_mov_b64 v[50:51], 0
    s_waitcnt lgkmcnt(1)
    s_barrier
    ds_read_b128 v[52:55], v4 offset:22016
    ds_read_b128 v[56:59], v4 offset:22144
    v_mov_b64 v[68:69], 0
    v_mov_b64 v[70:71], 0
    v_mov_b64 v[28:29], 0
    v_mov_b64 v[30:31], 0
    v_mov_b64 v[16:17], 0
    v_mov_b64 v[18:19], 0
    s_cmp_eq_u32 s33, 63
    s_cbranch_scc1 Lr2s_last
    s_waitcnt lgkmcnt(1)
    v_smfmac_f32_16x16x64_bf16 v[28:31], v[52:55], v[60:67], v1
    ds_read_b128 v[60:63], v0 offset:40960
    s_waitcnt lgkmcnt(1)
    v_smfmac_f32_16x16x64_bf16 v[28:31], v[56:59], v[36:43], v1
    ds_read_b128 v[64:67], v0 offset:41984
    ds_read_b128 v[36:39], v9 offset:18432
    v_smfmac_f32_16x16x64_bf16 v[12:15], v[52:55], a[176:183], v1
    ds_read_b128 v[40:43], v9 offset:19456
    v_smfmac_f32_16x16x64_bf16 v[12:15], v[56:59], a[184:191], v1
    buffer_load_dwordx4 v0, s[8:11], s41 offen offset:0 lds
    v_smfmac_f32_16x16x64_bf16 v[20:23], v[52:55], a[192:199], v1
    s_nop 0
    v_add_f32 v28, v28, v30
    v_add_f32 v29, v29, v31
    s_waitcnt lgkmcnt(2)
    v_smfmac_f32_16x16x64_bf16 v[20:23], v[56:59], v[60:67], v1
    ds_read_b128 v[60:63], v9 offset:20480
    v_cvt_pk_bf16_f32 v28, v28, v29
    v_bfi_b32 v28, 1, s39, v28
    buffer_store_dword v28, v8, s[8:11], s38 offen offset:2048 sc1
    s_waitcnt lgkmcnt(1)
    v_smfmac_f32_16x16x64_bf16 v[24:27], v[52:55], v[36:43], v1
    ds_read_b128 v[64:67], v9 offset:21504
    ds_read_b128 v[36:39], v0 offset:43008
    v_add_f32 v12, v12, v14
    v_add_f32 v13, v13, v15
    v_smfmac_f32_16x16x64_bf16 v[24:27], v[56:59], a[200:207], v1
    ds_read_b128 v[40:43], v0 offset:44032
    v_cvt_pk_bf16_f32 v12, v12, v13
    v_bfi_b32 v12, 1, s39, v12
    v_smfmac_f32_16x16x64_bf16 v[32:35], v[52:55], a[208:215], v1
    buffer_load_dwordx4 v0, s[8:11], s41 offen offset:1024 lds
    v_add_f32 v20, v20, v22
    v_add_f32 v21, v21, v23
    v_smfmac_f32_16x16x64_bf16 v[32:35], v[56:59], a[216:223], v1
    v_cvt_pk_bf16_f32 v13, v20, v21
    s_waitcnt lgkmcnt(2)
    v_smfmac_f32_16x16x64_bf16 v[44:47], v[52:55], v[60:67], v1
    ds_read_b128 v[60:63], v0 offset:45056
    v_add_f32 v24, v24, v26
    v_add_f32 v25, v25, v27
    s_waitcnt lgkmcnt(1)
    v_smfmac_f32_16x16x64_bf16 v[44:47], v[56:59], v[36:43], v1
    ds_read_b128 v[64:67], v0 offset:46080
    ds_read_b128 v[36:39], v9 offset:22528
    v_cvt_pk_bf16_f32 v14, v24, v25
    v_smfmac_f32_16x16x64_bf16 v[48:51], v[52:55], a[224:231], v1
    ds_read_b128 v[40:43], v9 offset:23552
    v_add_f32 v32, v32, v34
    v_add_f32 v33, v33, v35
    v_smfmac_f32_16x16x64_bf16 v[48:51], v[56:59], a[232:239], v1
    v_cvt_pk_bf16_f32 v15, v32, v33
    buffer_store_dwordx4 v[12:15], v0, s[8:11], s38 offen offset:0 sc1
    v_smfmac_f32_16x16x64_bf16 v[68:71], v[52:55], a[240:247], v1
    v_add_f32 v44, v44, v46
    v_add_f32 v45, v45, v47
    s_waitcnt lgkmcnt(2)
    v_smfmac_f32_16x16x64_bf16 v[68:71], v[56:59], v[60:67], v1
    v_cvt_pk_bf16_f32 v44, v44, v45
    v_bfi_b32 v44, 1, s39, v44
    s_waitcnt lgkmcnt(0)
    v_smfmac_f32_16x16x64_bf16 v[16:19], v[52:55], v[36:43], v1
    v_add_f32 v48, v48, v50
    v_add_f32 v49, v49, v51
    v_smfmac_f32_16x16x64_bf16 v[16:19], v[56:59], a[248:255], v1
    v_cvt_pk_bf16_f32 v45, v48, v49
    v_add_f32 v68, v68, v70
    v_add_f32 v69, v69, v71
    v_cvt_pk_bf16_f32 v46, v68, v69
    s_nop 3
    v_add_f32 v16, v16, v18
    v_add_f32 v17, v17, v19
    v_cvt_pk_bf16_f32 v47, v16, v17
    buffer_store_dwordx4 v[44:47], v0, s[8:11], s38 offen offset:1024 sc1
    s_cmp_eq_u32 s62, 0
    s_cbranch_scc1 Lr2s_nojob
    v_bfe_u32 v10, v0, 4, 4
    v_mov_b32 v11, 0x3f80
    v_mov_b32 v40, 0x3f800000
    v_cmp_eq_u32 vcc, 0, v10
    v_cmp_eq_u32 s[48:49], 1, v10
    s_nop 0
    v_cndmask_b32 v36, 0, v11, vcc
    v_cndmask_b32 v36, v36, v40, s[48:49]
    v_cmp_eq_u32 vcc, 2, v10
    v_cmp_eq_u32 s[48:49], 3, v10
    s_nop 0
    v_cndmask_b32 v37, 0, v11, vcc
    v_cndmask_b32 v37, v37, v40, s[48:49]
    v_cmp_eq_u32 vcc, 4, v10
    v_cmp_eq_u32 s[48:49], 5, v10
    s_nop 0
    v_cndmask_b32 v38, 0, v11, vcc
    v_cndmask_b32 v38, v38, v40, s[48:49]
    v_cmp_eq_u32 vcc, 6, v10
    v_cmp_eq_u32 s[48:49], 7, v10
    s_nop 0
    v_cndmask_b32 v39, 0, v11, vcc
    v_cndmask_b32 v39, v39, v40, s[48:49]
    s_sleep 5
    buffer_load_dwordx4 v[52:55], v6, s[8:11], s57 offen sc1
    buffer_load_dwordx4 v[56:59], v6, s[8:11], s58 offen sc1
    buffer_load_dwordx4 v[60:63], v6, s[8:11], s59 offen sc1
    buffer_load_dwordx4 v[64:67], v6, s[8:11], s60 offen sc1
    s_mov_b32 s16, 0
    s_mov_b64 s[70:71], 0
    s_mov_b64 s[72:73], 0
    s_mov_b64 s[74:75], 0
    s_mov_b64 s[76:77], 0
Lr2s_p1:
    s_mov_b64 exec, s[70:71]
    buffer_load_dwordx4 v[52:55], v6, s[8:11], s57 offen sc1
    s_mov_b64 exec, s[72:73]
    buffer_load_dwordx4 v[56:59], v6, s[8:11], s58 offen sc1
    s_mov_b64 exec, s[74:75]
    buffer_load_dwordx4 v[60:63], v6, s[8:11], s59 offen sc1
    s_mov_b64 exec, s[76:77]
    buffer_load_dwordx4 v[64:67], v6, s[8:11], s60 offen sc1
    s_mov_b64 exec, -1
    s_add_u32 s16, s16, 1
    s_cmp_gt_u32 s16, 100000
    s_cbranch_scc1 Lr_abort
    s_waitcnt vmcnt(7)
    v_xor_b32 v10, v52, v53
    v_xor_b32 v11, v54, v55
    v_or_b32 v10, v10, v11
    v_xor_b32 v11, v52, v54
    v_or_b32 v10, v10, v11
    v_xor_b32 v11, s39, v52
    v_or_b32 v10, v10, v11
    v_and_b32 v10, 1, v10
    v_cmp_ne_u32 s[70:71], 0, v10
    v_mfma_f32_16x16x32_bf16 v[40:43], v[52:55], v[36:39], 0
    s_waitcnt vmcnt(6)
    v_xor_b32 v10, v56, v57
    v_xor_b32 v11, v58, v59
    v_or_b32 v10, v10, v11
    v_xor_b32 v11, v56, v58
    v_or_b32 v10, v10, v11
    v_xor_b32 v11, s39, v56
    v_or_b32 v10, v10, v11
    v_and_b32 v10, 1, v10
    v_cmp_ne_u32 s[72:73], 0, v10
    v_mfma_f32_16x16x32_bf16 v[40:43], v[56:59], v[36:39], v[40:43]
    s_waitcnt vmcnt(5)
    v_xor_b32 v10, v60, v61
    v_xor_b32 v11, v62, v63
    v_or_b32 v10, v10, v11
    v_xor_b32 v11, v60, v62
    v_or_b32 v10, v10, v11
    v_xor_b32 v11, s39, v60
    v_or_b32 v10, v10, v11
    v_and_b32 v10, 1, v10
    v_cmp_ne_u32 s[74:75], 0, v10
    v_mfma_f32_16x16x32_bf16 v[40:43], v[60:63], v[36:39], v[40:43]
    s_or_b64 vcc, s[70:71], s[72:73]
    s_waitcnt vmcnt(4)
    v_xor_b32 v10, v64, v65
    v_xor_b32 v11, v66, v67
    v_or_b32 v10, v10, v11
    v_xor_b32 v11, v64, v66
    v_or_b32 v10, v10, v11
    v_xor_b32 v11, s39, v64
    v_or_b32 v10, v10, v11
    v_and_b32 v10, 1, v10
    v_cmp_ne_u32 s[76:77], 0, v10
    v_mfma_f32_16x16x32_bf16 v[40:43], v[64:67], v[36:39], v[40:43]
    s_or_b64 vcc, vcc, s[74:75]
    s_or_b64 vcc, vcc, s[76:77]
    s_cbranch_scc1 Lr2s_p1
    s_nop 4
    v_permlane16_swap_b32 v40, v42
    v_permlane16_swap_b32 v41, v43
    s_mov_b64 exec, s[50:51]
    v_add_f32 v40, v40, v42
    v_add_f32 v41, v41, v43
    v_cvt_pk_bf16_f32 v40, v40, v41
    v_min_u32 v40, s54, v40
    buffer_store_dword v40, v7, s[8:11], s36 offen sc1
    v_mov_b32 v41, -1
    buffer_store_dword v41, v7, s[8:11], s37 offen sc1
    s_mov_b64 exec, -1
    s_branch Lr2s_jobdone
Lr2s_nojob:
Lr2s_jobdone:
    s_xor_b32 s34, s34, 16384
    s_xor_b32 s35, s35, 16384
    s_barrier
    s_sleep 2
    buffer_load_dwordx4 v[44:47], v0, s[8:11], s34 offen sc1
    buffer_load_dwordx4 v[48:51], v0, s[8:11], s34 offen offset:1024 sc1
    buffer_load_dword v10, v8, s[8:11], s35 offen sc1
    s_add_u32 s33, s33, 1
    s_bfe_u32 s39, s33, 0x10001
    s_xor_b32 s38, s38, 524288
    s_xor_b32 s57, s57, 524288
    s_xor_b32 s58, s58, 524288
    s_xor_b32 s59, s59, 524288
    s_xor_b32 s60, s60, 524288
    s_xor_b32 s36, s36, 16384
    s_xor_b32 s37, s37, 16384
    s_and_b32 s17, s33, 7
    s_mul_i32 s17, s17, 131072
    s_add_u32 s43, s45, s17
    s_bfe_u32 s66, s33, 65539
    s_add_u32 s67, s67, 22528
    s_add_u32 s42, s42, 262144
    s_add_u32 s41, s41, 262144
    s_add_u32 s40, s40, 262144
    s_add_u32 s44, s44, 22528
    s_waitcnt vmcnt(6)
    ds_read_b128 v[56:59], v9 offset:8192
    ds_read_b128 v[60:63], v9 offset:9216
    ds_read_b128 v[64:67], v9 offset:10240
    ds_read_b128 v[68:71], v9 offset:11264
    v_mov_b64 v[12:13], 0
    v_mov_b64 v[14:15], 0
    v_mov_b64 v[16:17], 0
    v_mov_b64 v[18:19], 0
    v_mov_b64 v[20:21], 0
    v_mov_b64 v[22:23], 0
    v_mov_b64 v[24:25], 0
    v_mov_b64 v[26:27], 0
    v_mov_b64 v[28:29], 0
    v_mov_b64 v[30:31], 0
    v_mov_b64 v[32:33], 0
    v_mov_b64 v[34:35], 0
    s_waitcnt lgkmcnt(0)
    s_branch Lr2s_step
Lr2s_last:
    s_waitcnt vmcnt(0) lgkmcnt(0)
    s_branch Lr_exit
L_w3_0:
    s_mov_b32 s16, 0
    s_add_u32 s17, s44, 128
    v_and_b32 v11, 16, v8
    v_lshlrev_b32 v11, 3, v11
    v_and_or_b32 v11, v8, 12, v11
Lr3s_fw_11:
    buffer_load_dword v10, v11, s[8:11], s17 offen sc1
    s_add_u32 s16, s16, 1
    s_cmp_gt_u32 s16, 100000
    s_cbranch_scc1 Lr_abort
    s_waitcnt vmcnt(0)
    v_cmp_eq_u32 vcc, 0, v10
    s_nop 0
    s_cbranch_vccz Lr3s_fw_11d
    s_sleep 4
    s_branch Lr3s_fw_11
Lr3s_fw_11d:
    s_barrier
    s_mov_b32 m0, 15360
    s_nop 0
    buffer_load_dwordx4 v0, s[8:11], s41 offen offset:0 lds
    buffer_load_dwordx4 v0, s[8:11], s41 offen offset:1024 lds
    s_add_u32 s41, s41, 262144
    s_waitcnt vmcnt(0)
    buffer_load_dwordx4 v[44:47], v0, s[8:11], s34 offen sc1
    buffer_load_dwordx4 v[48:51], v0, s[8:11], s34 offen offset:1024 sc1
    buffer_load_dword v10, v8, s[8:11], s35 offen sc1
    ds_read_b128 v[56:59], v9 offset:12288
    ds_read_b128 v[60:63], v9 offset:13312
    ds_read_b128 v[64:67], v9 offset:14336
    ds_read_b128 v[68:71], v9 offset:15360
    v_mov_b64 v[12:13], 0
    v_mov_b64 v[14:15], 0
    v_mov_b64 v[16:17], 0
    v_mov_b64 v[18:19], 0
    v_mov_b64 v[20:21], 0
    v_mov_b64 v[22:23], 0
    v_mov_b64 v[24:25], 0
    v_mov_b64 v[26:27], 0
    v_mov_b64 v[28:29], 0
    v_mov_b64 v[30:31], 0
    v_mov_b64 v[32:33], 0
    v_mov_b64 v[34:35], 0
    s_waitcnt lgkmcnt(0)
Lr3s_step:
    s_mov_b32 s16, 0
    s_mov_b64 s[70:71], 0
    s_mov_b64 s[72:73], 0
    s_mov_b64 s[74:75], 0
Lr3s_p2:
    s_mov_b64 exec, s[70:71]
    buffer_load_dwordx4 v[44:47], v0, s[8:11], s34 offen sc1
    s_mov_b64 exec, s[72:73]
    buffer_load_dwordx4 v[48:51], v0, s[8:11], s34 offen offset:1024 sc1
    s_mov_b64 exec, s[74:75]
    buffer_load_dword v10, v8, s[8:11], s35 offen sc1
    s_mov_b64 exec, -1
    s_add_u32 s16, s16, 1
    s_cmp_gt_u32 s16, 100000
    s_cbranch_scc1 Lr_abort
    s_waitcnt vmcnt(5)
    v_max3_u32 v11, v44, v45, v46
    v_max_u32 v11, v11, v47
    v_cmp_eq_u32 s[70:71], -1, v11
    s_waitcnt vmcnt(4)
    v_max3_u32 v11, v48, v49, v50
    v_max_u32 v11, v11, v51
    v_cmp_eq_u32 s[72:73], -1, v11
    s_waitcnt vmcnt(3)
    v_cmp_eq_u32 s[74:75], -1, v10
    s_or_b64 vcc, s[70:71], s[72:73]
    s_or_b64 vcc, vcc, s[74:75]
    s_cbranch_scc1 Lr3s_p2
    v_smfmac_f32_16x16x64_bf16 v[12:15], v[44:47], a[56:63], v1
    ds_write_b128 v0, v[44:47] offset:6144
    v_smfmac_f32_16x16x64_bf16 v[16:19], v[44:47], a[64:71], v1
    ds_write_b128 v0, v[48:51] offset:7168
    v_smfmac_f32_16x16x64_bf16 v[20:23], v[44:47], a[72:79], v1
    ds_write_b32 v8, v10 offset:8960
    v_smfmac_f32_16x16x64_bf16 v[24:27], v[44:47], v[56:63], v1
    s_waitcnt lgkmcnt(0)
    s_barrier
    ds_read_b128 v[52:55], v0 offset:0
    v_smfmac_f32_16x16x64_bf16 v[12:15], v[48:51], a[96:103], v1
    ds_read_b128 v[36:39], v0 offset:1024
    v_smfmac_f32_16x16x64_bf16 v[16:19], v[48:51], a[104:111], v1
    ds_read_b128 v[56:59], v9 offset:0
    v_smfmac_f32_16x16x64_bf16 v[20:23], v[48:51], a[112:119], v1
    ds_read_b128 v[60:63], v9 offset:1024
    v_smfmac_f32_16x16x64_bf16 v[24:27], v[48:51], v[64:71], v1
    ds_read_b128 v[40:43], v0 offset:2048
    s_waitcnt lgkmcnt(4)
    v_smfmac_f32_16x16x64_bf16 v[12:15], v[52:55], v[72:79], v1
    buffer_load_dword v6, v7, s[8:11], s67 offen sc1
    v_smfmac_f32_16x16x64_bf16 v[16:19], v[52:55], v[80:87], v1
    ds_read_b128 v[64:67], v9 offset:2048
    v_smfmac_f32_16x16x64_bf16 v[20:23], v[52:55], v[88:95], v1
    ds_read_b128 v[68:71], v9 offset:3072
    s_waitcnt lgkmcnt(3)
    v_smfmac_f32_16x16x64_bf16 v[24:27], v[52:55], v[56:63], v1
    v_smfmac_f32_16x16x64_bf16 v[12:15], v[36:39], v[112:119], v1
    ds_read_b128 v[52:55], v0 offset:3072
    v_smfmac_f32_16x16x64_bf16 v[16:19], v[36:39], v[120:127], v1
    ds_read_b128 v[56:59], v9 offset:4096
    v_smfmac_f32_16x16x64_bf16 v[20:23], v[36:39], v[128:135], v1
    ds_read_b128 v[60:63], v9 offset:5120
    s_waitcnt lgkmcnt(3)
    v_smfmac_f32_16x16x64_bf16 v[24:27], v[36:39], v[64:71], v1
    v_smfmac_f32_16x16x64_bf16 v[12:15], v[40:43], v[152:159], v1
    buffer_load_dwordx4 v[36:39], v0, s[8:11], s42 offen
    v_smfmac_f32_16x16x64_bf16 v[16:19], v[40:43], v[160:167], v1
    ds_read_b128 v[64:67], v9 offset:6144
    v_smfmac_f32_16x16x64_bf16 v[20:23], v[40:43], v[168:175], v1
    ds_read_b128 v[68:71], v9 offset:7168
    s_waitcnt lgkmcnt(2)
    v_smfmac_f32_16x16x64_bf16 v[24:27], v[40:43], v[56:63], v1
    s_waitcnt vmcnt(2)
    ds_read_b128 v[44:47], v0 offset:4096
    v_smfmac_f32_16x16x64_bf16 v[12:15], v[52:55], v[192:199], v1
    buffer_load_dwordx4 v[40:43], v0, s[8:11], s42 offen offset:1024
    v_smfmac_f32_16x16x64_bf16 v[16:19], v[52:55], v[200:207], v1
    ds_read_b128 v[56:59], v9 offset:8192
    v_smfmac_f32_16x16x64_bf16 v[20:23], v[52:55], v[208:215], v1
    ds_read_b128 v[60:63], v9 offset:9216
    s_waitcnt lgkmcnt(3)
    v_smfmac_f32_16x16x64_bf16 v[24:27], v[52:55], v[64:71], v1
    ds_read_b128 v[48:51], v0 offset:5120
    s_waitcnt lgkmcnt(3)
    v_smfmac_f32_16x16x64_bf16 v[12:15], v[44:47], v[232:239], v1
    ds_read_b128 v[52:55], v0 offset:8192
    v_smfmac_f32_16x16x64_bf16 v[16:19], v[44:47], v[240:247], v1
    ds_read_b128 v[64:67], v9 offset:10240
    v_smfmac_f32_16x16x64_bf16 v[20:23], v[44:47], v[248:255], v1
    ds_read_b128 v[68:71], v9 offset:11264
    s_waitcnt lgkmcnt(4)
    v_smfmac_f32_16x16x64_bf16 v[24:27], v[44:47], v[56:63], v1
    s_waitcnt lgkmcnt(3)
    v_smfmac_f32_16x16x64_bf16 v[12:15], v[48:51], a[16:23], v1
    v_smfmac_f32_16x16x64_bf16 v[16:19], v[48:51], a[24:31], v1
    ds_read_b128 v[56:59], v9 offset:16384
    s_waitcnt lgkmcnt(3)
    v_smfmac_f32_16x16x64_bf16 v[12:15], v[52:55], a[136:143], v1
    ds_read_b128 v[60:63], v9 offset:17408
    v_smfmac_f32_16x16x64_bf16 v[16:19], v[52:55], a[144:151], v1
    v_smfmac_f32_16x16x64_bf16 v[20:23], v[48:51], a[32:39], v1
    s_waitcnt lgkmcnt(2)
    v_smfmac_f32_16x16x64_bf16 v[24:27], v[48:51], v[64:71], v1
    ds_read_b128 v[64:67], v0 offset:9216
    s_nop 1
    v_add_f32 v12, v12, v14
    v_smfmac_f32_16x16x64_bf16 v[20:23], v[52:55], a[152:159], v1
    ds_read_b128 v[68:71], v0 offset:10240
    v_add_f32 v16, v16, v18
    s_waitcnt lgkmcnt(2)
    v_smfmac_f32_16x16x64_bf16 v[24:27], v[52:55], v[56:63], v1
    ds_read_b128 v[56:59], v0 offset:11264
    v_add_f32 v13, v13, v15
    v_add_f32 v17, v17, v19
    v_cvt_pk_bf16_f32 v14, v12, v16
    v_cvt_pk_bf16_f32 v15, v13, v17
    ds_write_b32 v2, v14 offset:17408
    ds_write_b32 v2, v15 offset:17696
    v_smfmac_f32_16x16x64_bf16 v[28:31], v[52:55], a[160:167], v1
    ds_read_b128 v[60:63], v0 offset:12288
    v_add_f32 v20, v20, v22
    v_add_f32 v24, v24, v26
    v_add_f32 v21, v21, v23
    v_add_f32 v25, v25, v27
    v_smfmac_f32_16x16x64_bf16 v[32:35], v[52:55], a[168:175], v1
    ds_read_b128 v[12:15], v0 offset:6144
    v_cvt_pk_bf16_f32 v22, v20, v24
    v_cvt_pk_bf16_f32 v23, v21, v25
    ds_write_b32 v2, v22 offset:19712
    ds_write_b32 v2, v23 offset:20000
    v_smfmac_f32_16x16x64_bf16 v[28:31], v[48:51], a[40:47], v1
    ds_read_b128 v[16:19], v0 offset:7168
    v_smfmac_f32_16x16x64_bf16 v[32:35], v[48:51], a[48:55], v1
    ds_read_b128 v[20:23], v0 offset:0
    v_smfmac_f32_16x16x64_bf16 v[28:31], v[44:47], a[0:7], v1
    ds_read_b128 v[24:27], v0 offset:1024
    v_smfmac_f32_16x16x64_bf16 v[32:35], v[44:47], a[8:15], v1
    s_waitcnt lgkmcnt(3)
    s_barrier
    ds_read_b128 v[44:47], v3 offset:17408
    v_smfmac_f32_16x16x64_bf16 v[28:31], v[12:15], a[80:87], v1
    ds_read_b128 v[52:55], v0 offset:2048
    v_smfmac_f32_16x16x64_bf16 v[32:35], v[12:15], a[88:95], v1
    ds_read_b128 v[12:15], v3 offset:19712
    s_waitcnt lgkmcnt(5)
    v_smfmac_f32_16x16x64_bf16 v[28:31], v[16:19], a[120:127], v1
    ds_read_b128 v[48:51], v0 offset:3072
    v_smfmac_f32_16x16x64_bf16 v[32:35], v[16:19], a[128:135], v1
    s_waitcnt lgkmcnt(5)
    v_smfmac_f32_16x16x64_bf16 v[28:31], v[20:23], v[96:103], v1
    v_smfmac_f32_16x16x64_bf16 v[32:35], v[20:23], v[104:111], v1
    ds_read_b128 v[20:23], v3 offset:17472
    s_waitcnt lgkmcnt(5)
    v_smfmac_f32_16x16x64_bf16 v[28:31], v[24:27], v[136:143], v1
    v_smfmac_f32_16x16x64_bf16 v[32:35], v[24:27], v[144:151], v1
    s_waitcnt lgkmcnt(3)
    v_smfmac_f32_16x16x64_bf16 v[28:31], v[52:55], v[176:183], v1
    v_smfmac_f32_16x16x64_bf16 v[32:35], v[52:55], v[184:191], v1
    ds_read_b128 v[52:55], v3 offset:19776
    s_waitcnt lgkmcnt(2)
    v_smfmac_f32_16x16x64_bf16 v[28:31], v[48:51], v[216:223], v1
    v_smfmac_f32_16x16x64_bf16 v[32:35], v[48:51], v[224:231], v1
    ds_read_b128 v[48:51], v3 offset:17536
    v_mfma_f32_16x16x32_bf16 v[24:27], v[12:15], v[44:47], 0
    s_waitcnt vmcnt(2)
    v_cmp_eq_u32 vcc, 0, v6
    s_nop 0
    s_and_b64 vcc, vcc, s[78:79]
    s_cbranch_scc1 Lr3s_flbad
Lr3s_flok:
    buffer_load_dword v6, v5, s[8:11], s40 offen
    buffer_load_dword v6, v5, s[8:11], s56 offen
    v_mfma_f32_16x16x32_bf16 v[12:15], v[64:67], v[44:47], 0
    ds_read_b128 v[64:67], v0 offset:13312
    v_mfma_f32_16x16x32_bf16 v[16:19], v[68:71], v[44:47], 0
    ds_read_b128 v[68:71], v0 offset:14336
    s_waitcnt lgkmcnt(3)
    v_mfma_f32_16x16x32_bf16 v[24:27], v[52:55], v[20:23], v[24:27]
    ds_read_b128 v[44:47], v3 offset:19840
    v_add_f32 v28, v28, v30
    v_add_f32 v29, v29, v31
    v_mfma_f32_16x16x32_bf16 v[12:15], v[56:59], v[20:23], v[12:15]
    ds_read_b128 v[52:55], v3 offset:17600
    v_add_f32 v32, v32, v34
    v_add_f32 v33, v33, v35
    v_mfma_f32_16x16x32_bf16 v[16:19], v[60:63], v[20:23], v[16:19]
    ds_read_b128 v[56:59], v0 offset:15360
    v_cvt_pk_bf16_f32 v30, v28, v29
    v_cvt_pk_bf16_f32 v31, v32, v33
    s_waitcnt lgkmcnt(2)
    v_mfma_f32_16x16x32_bf16 v[24:27], v[44:47], v[48:51], v[24:27]
    ds_read_b128 v[20:23], v3 offset:19904
    v_lshrrev_b32 v10, 8, v0
    v_mul_u32_u24 v10, 288, v10
    v_mfma_f32_16x16x32_bf16 v[12:15], v[64:67], v[48:51], v[12:15]
    ds_read_b128 v[60:63], v0 offset:16384
    v_and_b32 v11, 0xf0, v0
    v_add_u32 v10, v10, v11
    v_mfma_f32_16x16x32_bf16 v[16:19], v[68:71], v[48:51], v[16:19]
    ds_read_b128 v[32:35], v10 offset:21440
    v_lshrrev_b32 v11, 1, v0
    v_bfi_b32 v30, 1, s66, v30
    s_waitcnt lgkmcnt(2)
    v_mfma_f32_16x16x32_bf16 v[24:27], v[20:23], v[52:55], v[24:27]
    buffer_store_dwordx2 v[30:31], v11, s[8:11], s43 offen offset:2048 sc1
    v_mov_b32 v49, 0
    v_mov_b32 v50, 0
    v_mfma_f32_16x16x32_bf16 v[12:15], v[56:59], v[52:55], v[12:15]
    v_mov_b64 v[64:65], s[68:69]
    v_mov_b64 v[66:67], s[68:69]
    s_waitcnt lgkmcnt(1)
    v_mfma_f32_16x16x32_bf16 v[16:19], v[60:63], v[52:55], v[16:19]
    s_waitcnt lgkmcnt(0)
    v_bfi_b32 v32, 1, s66, v32
    s_mov_b64 exec, s[52:53]
    buffer_store_dwordx4 v[32:35], v0, s[8:11], s43 offen sc1
    s_mov_b64 exec, -1
    v_max3_f32 v10, v24, v25, v12
    v_max3_f32 v10, v10, v13, v14
    s_nop 0
    v_max3_f32 v10, v10, v15, v16
    v_max3_f32 v10, v10, v17, v18
    v_max_f32 v10, v10, v19
    v_mov_b32 v11, v10
    s_nop 1
    v_permlane32_swap_b32 v10, v11
    v_max_f32 v10, v10, v11
    v_mov_b32 v11, v10
    s_nop 1
    v_permlane16_swap_b32 v10, v11
    v_max_f32 v10, v10, v11
    v_mul_f32 v20, s46, v10
    v_pk_fma_f32 v[24:25], v[24:25], s[46:47], v[20:21] op_sel_hi:[1,1,0] neg_lo:[0,0,1] neg_hi:[0,0,1]
    v_pk_fma_f32 v[12:13], v[12:13], s[46:47], v[20:21] op_sel_hi:[1,1,0] neg_lo:[0,0,1] neg_hi:[0,0,1]
    v_exp_f32 v24, v24
    v_exp_f32 v25, v25
    v_pk_fma_f32 v[14:15], v[14:15], s[46:47], v[20:21] op_sel_hi:[1,1,0] neg_lo:[0,0,1] neg_hi:[0,0,1]
    v_exp_f32 v12, v12
    v_exp_f32 v13, v13
    v_pk_fma_f32 v[16:17], v[16:17], s[46:47], v[20:21] op_sel_hi:[1,1,0] neg_lo:[0,0,1] neg_hi:[0,0,1]
    v_cvt_pk_bf16_f32 v48, v24, v25
    v_exp_f32 v14, v14
    v_pk_fma_f32 v[18:19], v[18:19], s[46:47], v[20:21] op_sel_hi:[1,1,0] neg_lo:[0,0,1] neg_hi:[0,0,1]
    v_cvt_pk_bf16_f32 v51, v24, v25
    v_exp_f32 v15, v15
    v_cvt_pk_bf16_f32 v44, v12, v13
    v_exp_f32 v16, v16
    v_exp_f32 v17, v17
    v_cvt_pk_bf16_f32 v45, v14, v15
    v_exp_f32 v18, v18
    v_exp_f32 v19, v19
    v_cvt_pk_bf16_f32 v46, v16, v17
    v_cvt_pk_bf16_f32 v47, v18, v19
    v_mfma_f32_16x16x16_bf16 v[68:71], v[64:65], v[48:49], 0
    v_mfma_f32_16x16x16_bf16 v[52:55], v[30:31], v[48:49], 0
    v_mfma_f32_16x16x16_bf16 v[56:59], v[30:31], v[50:51], 0
    v_mfma_f32_16x16x32_bf16 v[68:71], v[64:67], v[44:47], v[68:71]
    s_waitcnt vmcnt(5)
    v_mfma_f32_16x16x32_bf16 v[52:55], v[36:39], v[44:47], v[52:55]
    s_waitcnt vmcnt(4)
    v_mfma_f32_16x16x32_bf16 v[56:59], v[40:43], v[44:47], v[56:59]
    ds_read_b128 v[36:39], v0 offset:55296
    ds_read_b128 v[40:43], v0 offset:56320
    ds_read_b128 v[60:63], v9 offset:24576
    s_nop 0
    v_rcp_f32 v10, v68
    s_nop 0
    v_pk_mul_f32 v[52:53], v[52:53], v[10:11] op_sel_hi:[1,0]
    s_nop 0
    v_pk_mul_f32 v[56:57], v[56:57], v[10:11] op_sel_hi:[1,0]
    v_cvt_pk_bf16_f32 v16, v52, v56
    v_cvt_pk_bf16_f32 v17, v53, v57
    v_pk_mul_f32 v[54:55], v[54:55], v[10:11] op_sel_hi:[1,0]
    v_pk_mul_f32 v[58:59], v[58:59], v[10:11] op_sel_hi:[1,0]
    v_cvt_pk_bf16_f32 v18, v54, v58
    v_cvt_pk_bf16_f32 v19, v55, v59
    ds_write_b128 v3, v[16:19] offset:22208
    ds_read_b128 v[64:67], v9 offset:25600
    v_mov_b64 v[12:13], 0
    v_mov_b64 v[14:15], 0
    v_mov_b64 v[20:21], 0
    v_mov_b64 v[22:23], 0
    v_mov_b64 v[24:25], 0
    v_mov_b64 v[26:27], 0
    v_mov_b64 v[32:33], 0
    v_mov_b64 v[34:35], 0
    v_mov_b64 v[44:45], 0
    v_mov_b64 v[46:47], 0
    v_mov_b64 v[48:49], 0
    v_mov_b64 v[50:51], 0
    s_waitcnt lgkmcnt(1)
    s_barrier
    ds_read_b128 v[52:55], v4 offset:22016
    ds_read_b128 v[56:59], v4 offset:22144
    v_mov_b64 v[68:69], 0
    v_mov_b64 v[70:71], 0
    v_mov_b64 v[28:29], 0
    v_mov_b64 v[30:31], 0
    v_mov_b64 v[16:17], 0
    v_mov_b64 v[18:19], 0
    s_cmp_eq_u32 s33, 63
    s_cbranch_scc1 Lr3s_last
    s_waitcnt lgkmcnt(1)
    v_smfmac_f32_16x16x64_bf16 v[28:31], v[52:55], v[60:67], v1
    ds_read_b128 v[60:63], v0 offset:49152
    s_waitcnt lgkmcnt(1)
    v_smfmac_f32_16x16x64_bf16 v[28:31], v[56:59], v[36:43], v1
    ds_read_b128 v[64:67], v0 offset:50176
    ds_read_b128 v[36:39], v9 offset:18432
    v_smfmac_f32_16x16x64_bf16 v[12:15], v[52:55], a[176:183], v1
    ds_read_b128 v[40:43], v9 offset:19456
    v_smfmac_f32_16x16x64_bf16 v[12:15], v[56:59], a[184:191], v1
    buffer_load_dwordx4 v0, s[8:11], s41 offen offset:0 lds
    v_smfmac_f32_16x16x64_bf16 v[20:23], v[52:55], a[192:199], v1
    s_nop 0
    v_add_f32 v28, v28, v30
    v_add_f32 v29, v29, v31
    s_waitcnt lgkmcnt(2)
    v_smfmac_f32_16x16x64_bf16 v[20:23], v[56:59], v[60:67], v1
    ds_read_b128 v[60:63], v9 offset:20480
    v_cvt_pk_bf16_f32 v28, v28, v29
    v_bfi_b32 v28, 1, s39, v28
    buffer_store_dword v28, v8, s[8:11], s38 offen offset:2048 sc1
    s_waitcnt lgkmcnt(1)
    v_smfmac_f32_16x16x64_bf16 v[24:27], v[52:55], v[36:43], v1
    ds_read_b128 v[64:67], v9 offset:21504
    ds_read_b128 v[36:39], v0 offset:51200
    v_add_f32 v12, v12, v14
    v_add_f32 v13, v13, v15
    v_smfmac_f32_16x16x64_bf16 v[24:27], v[56:59], a[200:207], v1
    ds_read_b128 v[40:43], v0 offset:52224
    v_cvt_pk_bf16_f32 v12, v12, v13
    v_bfi_b32 v12, 1, s39, v12
    v_smfmac_f32_16x16x64_bf16 v[32:35], v[52:55], a[208:215], v1
    buffer_load_dwordx4 v0, s[8:11], s41 offen offset:1024 lds
    v_add_f32 v20, v20, v22
    v_add_f32 v21, v21, v23
    v_smfmac_f32_16x16x64_bf16 v[32:35], v[56:59], a[216:223], v1
    v_cvt_pk_bf16_f32 v13, v20, v21
    s_waitcnt lgkmcnt(2)
    v_smfmac_f32_16x16x64_bf16 v[44:47], v[52:55], v[60:67], v1
    ds_read_b128 v[60:63], v0 offset:53248
    v_add_f32 v24, v24, v26
    v_add_f32 v25, v25, v27
    s_waitcnt lgkmcnt(1)
    v_smfmac_f32_16x16x64_bf16 v[44:47], v[56:59], v[36:43], v1
    ds_read_b128 v[64:67], v0 offset:54272
    ds_read_b128 v[36:39], v9 offset:22528
    v_cvt_pk_bf16_f32 v14, v24, v25
    v_smfmac_f32_16x16x64_bf16 v[48:51], v[52:55], a[224:231], v1
    ds_read_b128 v[40:43], v9 offset:23552
    v_add_f32 v32, v32, v34
    v_add_f32 v33, v33, v35
    v_smfmac_f32_16x16x64_bf16 v[48:51], v[56:59], a[232:239], v1
    v_cvt_pk_bf16_f32 v15, v32, v33
    buffer_store_dwordx4 v[12:15], v0, s[8:11], s38 offen offset:0 sc1
    v_smfmac_f32_16x16x64_bf16 v[68:71], v[52:55], a[240:247], v1
    v_add_f32 v44, v44, v46
    v_add_f32 v45, v45, v47
    s_waitcnt lgkmcnt(2)
    v_smfmac_f32_16x16x64_bf16 v[68:71], v[56:59], v[60:67], v1
    v_cvt_pk_bf16_f32 v44, v44, v45
    v_bfi_b32 v44, 1, s39, v44
    s_waitcnt lgkmcnt(0)
    v_smfmac_f32_16x16x64_bf16 v[16:19], v[52:55], v[36:43], v1
    v_add_f32 v48, v48, v50
    v_add_f32 v49, v49, v51
    v_smfmac_f32_16x16x64_bf16 v[16:19], v[56:59], a[248:255], v1
    v_cvt_pk_bf16_f32 v45, v48, v49
    v_add_f32 v68, v68, v70
    v_add_f32 v69, v69, v71
    v_cvt_pk_bf16_f32 v46, v68, v69
    s_nop 3
    v_add_f32 v16, v16, v18
    v_add_f32 v17, v17, v19
    v_cvt_pk_bf16_f32 v47, v16, v17
    buffer_store_dwordx4 v[44:47], v0, s[8:11], s38 offen offset:1024 sc1
    s_xor_b32 s34, s34, 16384
    s_xor_b32 s35, s35, 16384
    s_barrier
    s_sleep 2
    buffer_load_dwordx4 v[44:47], v0, s[8:11], s34 offen sc1
    buffer_load_dwordx4 v[48:51], v0, s[8:11], s34 offen offset:1024 sc1
    buffer_load_dword v10, v8, s[8:11], s35 offen sc1
    s_add_u32 s33, s33, 1
    s_bfe_u32 s39, s33, 0x10001
    s_xor_b32 s38, s38, 524288
    s_and_b32 s17, s33, 7
    s_mul_i32 s17, s17, 131072
    s_add_u32 s43, s45, s17
    s_bfe_u32 s66, s33, 65539
    s_add_u32 s67, s67, 22528
    s_and_b32 s17, s33, 3
    s_cmp_eq_u32 s17, 3
    s_cselect_b32 s17, 1, 0
    s_cmp_eq_u32 s32, 0
    s_cselect_b32 s17, 1, s17
    s_cmp_ge_u32 s33, 7
    s_cselect_b32 s17, s17, 0
    s_cmp_lg_u32 s17, 0
    s_cselect_b64 s[78:79], -1, 0xff
    s_add_u32 s56, s56, 262144
    s_add_u32 s42, s42, 262144
    s_add_u32 s41, s41, 262144
    s_add_u32 s40, s40, 262144
    s_add_u32 s44, s44, 22528
    ds_read_b128 v[56:59], v9 offset:12288
    ds_read_b128 v[60:63], v9 offset:13312
    ds_read_b128 v[64:67], v9 offset:14336
    ds_read_b128 v[68:71], v9 offset:15360
    v_mov_b64 v[12:13], 0
    v_mov_b64 v[14:15], 0
    v_mov_b64 v[16:17], 0
    v_mov_b64 v[18:19], 0
    v_mov_b64 v[20:21], 0
    v_mov_b64 v[22:23], 0
    v_mov_b64 v[24:25], 0
    v_mov_b64 v[26:27], 0
    v_mov_b64 v[28:29], 0
    v_mov_b64 v[30:31], 0
    v_mov_b64 v[32:33], 0
    v_mov_b64 v[34:35], 0
    s_waitcnt lgkmcnt(0)
    s_branch Lr3s_step
Lr3s_flbad:
    s_cmp_eq_u32 s33, 63
    s_cbranch_scc1 Lr3s_flok
    s_mov_b32 s16, 0
Lr3s_flp:
    buffer_load_dword v6, v7, s[8:11], s67 offen sc1
    s_add_u32 s16, s16, 1
    s_cmp_gt_u32 s16, 100000
    s_cbranch_scc1 Lr_abort
    s_waitcnt vmcnt(0)
    v_cmp_eq_u32 vcc, 0, v6
    s_nop 0
    s_and_b64 vcc, vcc, s[78:79]
    s_cbranch_scc1 Lr3s_flp
    s_branch Lr3s_flok
Lr3s_last:
    s_waitcnt vmcnt(0) lgkmcnt(0)
    s_branch Lr_exit
Lr_abort:
    s_waitcnt lgkmcnt(0)
    s_mov_b64 exec, -1
    v_mov_b32 v0, 60
    s_lshl_b32 s5, s3, 8
    s_or_b32 s5, s5, s4
    s_or_b32 s5, s5, 0x10000
    v_mov_b32 v1, s5
    global_store_dword v0, v1, s[12:13]
    s_endpgm
Lr_exit:
    s_add_u32 s6, s15, s14
    s_cmp_lg_u32 s6, 0
    s_cbranch_scc1 Lr_nowb
    s_waitcnt vmcnt(0)
    buffer_wbl2 sc1
    s_waitcnt vmcnt(0)
Lr_nowb:
    s_endpgm
.section .rodata,"a"
.p2align 6
.amdhsa_kernel interleave_layers__sliding_local_dilated__memory_aug_recurrent_mem_tr__prompt_kernel
  .amdhsa_next_free_vgpr 512
  .amdhsa_next_free_sgpr 102
  .amdhsa_accum_offset 256
  .amdhsa_group_segment_fixed_size 0
  .amdhsa_kernarg_size 104
  .amdhsa_user_sgpr_count 2
  .amdhsa_user_sgpr_kernarg_segment_ptr 1
  .amdhsa_system_sgpr_workgroup_id_x 1
.end_amdhsa_kernel
```

```asm
; @launch grid=(256,1,1) block=(256,1,1) lds=163840
.amdgcn_target "amdgcn-amd-amdhsa--gfx950"
.text
.globl interleave_layers__sliding_local_dilated__memory_aug_recurrent_mem_tr__prompt_kernel
.p2align 8
.type interleave_layers__sliding_local_dilated__memory_aug_recurrent_mem_tr__prompt_kernel,@function
interleave_layers__sliding_local_dilated__memory_aug_recurrent_mem_tr__prompt_kernel:
    s_cmp_ge_u32 s2, 256
    s_cbranch_scc1 L_exit
    s_load_dwordx2 s[8:9], s[0:1], 96
    s_mov_b32 s10, 268435456
    s_mov_b32 s11, 0x00020000
    s_waitcnt lgkmcnt(0)
    s_and_b32 s9, s9, 0xffff
    s_load_dwordx2 s[12:13], s[0:1], 88
    v_lshrrev_b32 v1, 6, v0
    s_getreg_b32 s3, hwreg(HW_REG_XCC_ID)
    v_readfirstlane_b32 s14, v1
    s_and_b32 s3, s3, 7
    s_and_b32 s17, s3, 1
    s_lshl_b32 s17, s17, 7
    s_lshl_b32 s18, s3, 1
    s_and_b32 s18, s18, 12
    s_add_u32 s17, s17, s18
    v_mov_b32 v2, 0
    v_mov_b32 v3, 1
    v_mov_b32 v4, s17
    s_mov_b32 s33, 0
    s_waitcnt lgkmcnt(0)
    s_cmp_lg_u32 s14, 0
    s_cbranch_scc1 L_tk_wait
    s_mov_b64 exec, 1
    global_atomic_add v3, v4, v3, s[12:13] sc0
    s_waitcnt vmcnt(0)
    v_readfirstlane_b32 s4, v3
    s_nop 0
    s_cmp_lt_u32 s4, 32
    s_cbranch_scc1 L_tk_have
    v_mov_b32 v3, 1
    v_mov_b32 v4, 32
    global_atomic_add v3, v4, v3, s[12:13] sc0
    s_waitcnt vmcnt(0)
    v_readfirstlane_b32 s5, v3
    s_mov_b64 exec, 0xff
    v_and_b32 v4, 1, v0
    v_lshlrev_b32 v4, 7, v4
    v_lshlrev_b32 v5, 1, v0
    v_and_or_b32 v4, v5, 12, v4
    s_mov_b32 s16, 0
L_hl_poll:
    global_load_dword v5, v4, s[12:13] sc1
    s_add_u32 s16, s16, 1
    s_cmp_gt_u32 s16, 100000
    s_cbranch_scc1 L_abort
    s_mov_b32 s6, 0
    s_waitcnt vmcnt(0)
    v_readlane_b32 s40, v5, 0
    s_nop 0
    s_add_u32 s6, s6, s40
    v_readlane_b32 s41, v5, 1
    s_nop 0
    s_add_u32 s6, s6, s41
    v_readlane_b32 s42, v5, 2
    s_nop 0
    s_add_u32 s6, s6, s42
    v_readlane_b32 s43, v5, 3
    s_nop 0
    s_add_u32 s6, s6, s43
    v_readlane_b32 s44, v5, 4
    s_nop 0
    s_add_u32 s6, s6, s44
    v_readlane_b32 s45, v5, 5
    s_nop 0
    s_add_u32 s6, s6, s45
    v_readlane_b32 s46, v5, 6
    s_nop 0
    s_add_u32 s6, s6, s46
    v_readlane_b32 s47, v5, 7
    s_nop 0
    s_add_u32 s6, s6, s47
    s_cmp_lt_u32 s6, 256
    s_cbranch_scc1 L_hl_poll
    s_mov_b32 s3, 0
    s_mov_b32 s4, 0
    s_min_u32 s6, s47, 32
    s_sub_u32 s7, 32, s6
    s_cmp_lt_u32 s5, s7
    s_cselect_b32 s3, 7, s3
    s_add_u32 s6, s6, s5
    s_cmp_lt_u32 s5, s7
    s_cselect_b32 s4, s6, s4
    s_sub_u32 s5, s5, s7
    s_min_u32 s6, s46, 32
    s_sub_u32 s7, 32, s6
    s_cmp_lt_u32 s5, s7
    s_cselect_b32 s3, 6, s3
    s_add_u32 s6, s6, s5
    s_cmp_lt_u32 s5, s7
    s_cselect_b32 s4, s6, s4
    s_sub_u32 s5, s5, s7
    s_min_u32 s6, s45, 32
    s_sub_u32 s7, 32, s6
    s_cmp_lt_u32 s5, s7
    s_cselect_b32 s3, 5, s3
    s_add_u32 s6, s6, s5
    s_cmp_lt_u32 s5, s7
    s_cselect_b32 s4, s6, s4
    s_sub_u32 s5, s5, s7
    s_min_u32 s6, s44, 32
    s_sub_u32 s7, 32, s6
    s_cmp_lt_u32 s5, s7
    s_cselect_b32 s3, 4, s3
    s_add_u32 s6, s6, s5
    s_cmp_lt_u32 s5, s7
    s_cselect_b32 s4, s6, s4
    s_sub_u32 s5, s5, s7
    s_min_u32 s6, s43, 32
    s_sub_u32 s7, 32, s6
    s_cmp_lt_u32 s5, s7
    s_cselect_b32 s3, 3, s3
    s_add_u32 s6, s6, s5
    s_cmp_lt_u32 s5, s7
    s_cselect_b32 s4, s6, s4
    s_sub_u32 s5, s5, s7
    s_min_u32 s6, s42, 32
    s_sub_u32 s7, 32, s6
    s_cmp_lt_u32 s5, s7
    s_cselect_b32 s3, 2, s3
    s_add_u32 s6, s6, s5
    s_cmp_lt_u32 s5, s7
    s_cselect_b32 s4, s6, s4
    s_sub_u32 s5, s5, s7
    s_min_u32 s6, s41, 32
    s_sub_u32 s7, 32, s6
    s_cmp_lt_u32 s5, s7
    s_cselect_b32 s3, 1, s3
    s_add_u32 s6, s6, s5
    s_cmp_lt_u32 s5, s7
    s_cselect_b32 s4, s6, s4
    s_sub_u32 s5, s5, s7
    s_min_u32 s6, s40, 32
    s_sub_u32 s7, 32, s6
    s_cmp_lt_u32 s5, s7
    s_cselect_b32 s3, 0, s3
    s_add_u32 s6, s6, s5
    s_cmp_lt_u32 s5, s7
    s_cselect_b32 s4, s6, s4
    s_sub_u32 s5, s5, s7
L_tk_have:
    s_lshl_b32 s5, s3, 8
    s_or_b32 s5, s5, s4
    v_mov_b32 v3, s5
    s_mov_b64 exec, 1
    ds_write_b32 v2, v3
    s_mov_b64 exec, -1
L_tk_wait:
    s_waitcnt vmcnt(0) lgkmcnt(0)
    s_barrier
    ds_read_b32 v3, v2
    s_waitcnt lgkmcnt(0)
    v_readfirstlane_b32 s5, v3
    s_nop 0
    s_lshr_b32 s3, s5, 8
    s_and_b32 s4, s5, 255
    s_barrier
    s_cmp_lt_u32 s3, 2
    s_cbranch_scc1 L_role_r
    s_cmp_lg_u32 s3, 2
    s_cbranch_scc1 L_ii2_no
    s_cmp_lt_u32 s4, 32
    s_cbranch_scc1 L_noinit
L_ii2_no:
    s_cmp_lg_u32 s3, 3
    s_cbranch_scc1 L_ii3_no
    s_cmp_lt_u32 s4, 16
    s_cbranch_scc1 L_noinit
    s_cmp_lt_u32 s4, 32
    s_add_u32 s6, s4, 4294967280
    s_cmp_lt_u32 s4, 32
    s_cbranch_scc1 L_doinit
L_ii3_no:
    s_cmp_lg_u32 s3, 4
    s_cbranch_scc1 L_ii4_no
    s_cmp_lt_u32 s4, 21
    s_cbranch_scc1 L_noinit
    s_cmp_lt_u32 s4, 32
    s_add_u32 s6, s4, 4294967291
    s_cmp_lt_u32 s4, 32
    s_cbranch_scc1 L_doinit
L_ii4_no:
    s_cmp_lg_u32 s3, 5
    s_cbranch_scc1 L_ii5_no
    s_cmp_lt_u32 s4, 32
    s_add_u32 s6, s4, 27
    s_cmp_lt_u32 s4, 32
    s_cbranch_scc1 L_doinit
L_ii5_no:
    s_cmp_lg_u32 s3, 6
    s_cbranch_scc1 L_ii6_no
    s_cmp_lt_u32 s4, 32
    s_add_u32 s6, s4, 59
    s_cmp_lt_u32 s4, 32
    s_cbranch_scc1 L_doinit
L_ii6_no:
    s_cmp_lg_u32 s3, 7
    s_cbranch_scc1 L_ii7_no
    s_cmp_lt_u32 s4, 32
    s_add_u32 s6, s4, 91
    s_cmp_lt_u32 s4, 32
    s_cbranch_scc1 L_doinit
L_ii7_no:
    s_endpgm
L_doinit:
    s_load_dwordx2 s[20:21], s[0:1], 0
    s_mov_b32 s22, 2359296
    s_mov_b32 s23, 0x00020000
    s_waitcnt lgkmcnt(0)
    s_and_b32 s21, s21, 0xffff
    v_lshlrev_b32 v7, 4, v0
    v_mov_b32 v12, 0
    v_mov_b32 v13, 0
    v_mov_b32 v14, 0
    v_mov_b32 v15, 0
    s_mov_b32 s46, s6
Li_loop:
    s_cmp_ge_u32 s46, 136
    s_cbranch_scc1 Li_nofl
    s_mul_i32 s41, s46, 22528
    s_add_u32 s41, s41, 180224
    s_sub_u32 s42, s46, 128
    s_lshl_b32 s42, s42, 12
    s_add_u32 s42, s42, 3080192
    s_cmp_ge_u32 s46, 128
    s_cselect_b32 s41, s42, s41
    buffer_store_dwordx4 v[12:15], v7, s[8:11], s41 offen sc1
    s_cbranch_scc1 Li_nofl
    s_add_u32 s41, s41, 4096
    buffer_store_dwordx4 v[12:15], v7, s[8:11], s41 offen sc1
    s_add_u32 s41, s41, 4096
    buffer_store_dwordx4 v[12:15], v7, s[8:11], s41 offen sc1
    s_add_u32 s41, s41, 4096
    buffer_store_dwordx4 v[12:15], v7, s[8:11], s41 offen sc1
    s_add_u32 s41, s41, 4096
    buffer_store_dwordx4 v[12:15], v7, s[8:11], s41 offen sc1
    s_add_u32 s41, s41, 4096
    v_cmp_gt_u32 vcc, 128, v0
    s_nop 0
    s_and_saveexec_b64 s[42:43], vcc
    s_cbranch_execz Li_fl5
    buffer_store_dwordx4 v[12:15], v7, s[8:11], s41 offen sc1
Li_fl5:
    s_mov_b64 exec, s[42:43]
Li_nofl:
    s_cmp_ge_u32 s46, 64
    s_cbranch_scc1 Li_rest
    s_mul_i32 s42, s46, 6144
    s_add_u32 s42, s42, 15728640
    s_add_u32 s43, s42, 2048
    buffer_store_dwordx4 v[12:15], v7, s[8:11], s43 offen sc1
    s_branch Li_done
Li_rest:
    s_cmp_ge_u32 s46, 192
    s_cbranch_scc1 Li_done
    s_sub_u32 s41, s46, 64
    s_lshr_b32 s42, s41, 6
    s_and_b32 s41, s41, 63
    s_mul_i32 s42, s42, 786432
    s_mul_i32 s41, s41, 6144
    s_add_u32 s41, s41, s42
    s_add_u32 s41, s41, 16126464
    v_cmp_gt_u32 vcc, 96, v0
    s_nop 0
    s_and_saveexec_b64 s[44:45], vcc
    s_cbranch_execz Li_rest2
    buffer_store_dwordx4 v[12:15], v7, s[8:11], s41 offen sc1
Li_rest2:
    s_mov_b64 exec, s[44:45]
Li_done:
    s_add_u32 s46, s46, 123
    s_cmp_lt_u32 s46, 192
    s_cbranch_scc1 Li_loop
    v_and_b32 v1, 31, v0
    v_lshrrev_b32 v2, 5, v0
    v_mul_u32_u24 v3, 1152, v1
    v_mul_u32_u24 v5, 144, v2
    v_add_u32 v3, v3, v5
    s_sub_u32 s47, s6, 59
    s_mul_i32 s41, s47, 36864
    s_cmp_lt_u32 s6, 59
    s_cselect_b32 s41, 0x7f000000, s41
    buffer_load_dwordx4 v[64:67], v3, s[20:23], s41 offen offset:0
    buffer_load_dwordx4 v[68:71], v3, s[20:23], s41 offen offset:16
    buffer_load_dwordx4 v[72:75], v3, s[20:23], s41 offen offset:32
    buffer_load_dwordx4 v[76:79], v3, s[20:23], s41 offen offset:48
    buffer_load_dwordx4 v[80:83], v3, s[20:23], s41 offen offset:64
    buffer_load_dwordx4 v[84:87], v3, s[20:23], s41 offen offset:80
    buffer_load_dwordx4 v[88:91], v3, s[20:23], s41 offen offset:96
    buffer_load_dwordx4 v[92:95], v3, s[20:23], s41 offen offset:112
    buffer_load_dwordx4 v[96:99], v3, s[20:23], s41 offen offset:128
    s_waitcnt vmcnt(9)
    s_barrier
    s_cmp_lg_u32 s14, 0
    s_cbranch_scc1 Li_mid
    v_mov_b32 v2, 160
    v_mov_b32 v3, 1
    s_mov_b64 exec, 1
    global_atomic_add v2, v3, s[12:13]
    s_mov_b64 exec, -1
Li_mid:
    s_cmp_lt_u32 s6, 59
    s_cbranch_scc1 Li_end
    s_waitcnt vmcnt(0)
    v_and_b32 v1, 31, v0
    v_lshrrev_b32 v2, 5, v0
    v_mul_u32_u24 v4, 4608, v2
    v_lshl_add_u32 v4, v1, 4, v4
    s_mul_i32 s41, s47, 36864
    s_add_u32 s41, s41, 6291456
    s_mul_i32 s42, s47, 6144
    s_add_u32 s42, s42, 15728640
    v_mov_b32 v60, 0
    v_mov_b32 v61, 0
    buffer_store_dwordx4 v[64:67], v4, s[8:11], s41 offen offset:0 sc1
    buffer_store_dwordx4 v[68:71], v4, s[8:11], s41 offen offset:512 sc1
    buffer_store_dwordx4 v[72:75], v4, s[8:11], s41 offen offset:1024 sc1
    buffer_store_dwordx4 v[76:79], v4, s[8:11], s41 offen offset:1536 sc1
    buffer_store_dwordx4 v[80:83], v4, s[8:11], s41 offen offset:2048 sc1
    buffer_store_dwordx4 v[84:87], v4, s[8:11], s41 offen offset:2560 sc1
    buffer_store_dwordx4 v[88:91], v4, s[8:11], s41 offen offset:3072 sc1
    buffer_store_dwordx4 v[92:95], v4, s[8:11], s41 offen offset:3584 sc1
    v_add_u32 v4, 4096, v4
    buffer_store_dwordx4 v[96:99], v4, s[8:11], s41 offen offset:0 sc1
    v_mov_b32 v62, 0x3f803f80
    v_dot2c_f32_bf16 v60, v64, v62
    v_dot2c_f32_bf16 v61, v64, v64
    v_dot2c_f32_bf16 v60, v65, v62
    v_dot2c_f32_bf16 v61, v65, v65
    v_dot2c_f32_bf16 v60, v66, v62
    v_dot2c_f32_bf16 v61, v66, v66
    v_dot2c_f32_bf16 v60, v67, v62
    v_dot2c_f32_bf16 v61, v67, v67
    v_dot2c_f32_bf16 v60, v68, v62
    v_dot2c_f32_bf16 v61, v68, v68
    v_dot2c_f32_bf16 v60, v69, v62
    v_dot2c_f32_bf16 v61, v69, v69
    v_dot2c_f32_bf16 v60, v70, v62
    v_dot2c_f32_bf16 v61, v70, v70
    v_dot2c_f32_bf16 v60, v71, v62
    v_dot2c_f32_bf16 v61, v71, v71
    v_dot2c_f32_bf16 v60, v72, v62
    v_dot2c_f32_bf16 v61, v72, v72
    v_dot2c_f32_bf16 v60, v73, v62
    v_dot2c_f32_bf16 v61, v73, v73
    v_dot2c_f32_bf16 v60, v74, v62
    v_dot2c_f32_bf16 v61, v74, v74
    v_dot2c_f32_bf16 v60, v75, v62
    v_dot2c_f32_bf16 v61, v75, v75
    v_dot2c_f32_bf16 v60, v76, v62
    v_dot2c_f32_bf16 v61, v76, v76
    v_dot2c_f32_bf16 v60, v77, v62
    v_dot2c_f32_bf16 v61, v77, v77
    v_dot2c_f32_bf16 v60, v78, v62
    v_dot2c_f32_bf16 v61, v78, v78
    v_dot2c_f32_bf16 v60, v79, v62
    v_dot2c_f32_bf16 v61, v79, v79
    v_dot2c_f32_bf16 v60, v80, v62
    v_dot2c_f32_bf16 v61, v80, v80
    v_dot2c_f32_bf16 v60, v81, v62
    v_dot2c_f32_bf16 v61, v81, v81
    v_dot2c_f32_bf16 v60, v82, v62
    v_dot2c_f32_bf16 v61, v82, v82
    v_dot2c_f32_bf16 v60, v83, v62
    v_dot2c_f32_bf16 v61, v83, v83
    v_dot2c_f32_bf16 v60, v84, v62
    v_dot2c_f32_bf16 v61, v84, v84
    v_dot2c_f32_bf16 v60, v85, v62
    v_dot2c_f32_bf16 v61, v85, v85
    v_dot2c_f32_bf16 v60, v86, v62
    v_dot2c_f32_bf16 v61, v86, v86
    v_dot2c_f32_bf16 v60, v87, v62
    v_dot2c_f32_bf16 v61, v87, v87
    v_dot2c_f32_bf16 v60, v88, v62
    v_dot2c_f32_bf16 v61, v88, v88
    v_dot2c_f32_bf16 v60, v89, v62
    v_dot2c_f32_bf16 v61, v89, v89
    v_dot2c_f32_bf16 v60, v90, v62
    v_dot2c_f32_bf16 v61, v90, v90
    v_dot2c_f32_bf16 v60, v91, v62
    v_dot2c_f32_bf16 v61, v91, v91
    v_dot2c_f32_bf16 v60, v92, v62
    v_dot2c_f32_bf16 v61, v92, v92
    v_dot2c_f32_bf16 v60, v93, v62
    v_dot2c_f32_bf16 v61, v93, v93
    v_dot2c_f32_bf16 v60, v94, v62
    v_dot2c_f32_bf16 v61, v94, v94
    v_dot2c_f32_bf16 v60, v95, v62
    v_dot2c_f32_bf16 v61, v95, v95
    v_dot2c_f32_bf16 v60, v96, v62
    v_dot2c_f32_bf16 v61, v96, v96
    v_dot2c_f32_bf16 v60, v97, v62
    v_dot2c_f32_bf16 v61, v97, v97
    v_dot2c_f32_bf16 v60, v98, v62
    v_dot2c_f32_bf16 v61, v98, v98
    v_dot2c_f32_bf16 v60, v99, v62
    v_dot2c_f32_bf16 v61, v99, v99
    s_nop 3
    v_lshrrev_b32 v5, 1, v2
    v_lshlrev_b32 v5, 9, v5
    v_lshl_add_u32 v5, v1, 4, v5
    v_and_b32 v6, 1, v2
    v_lshl_add_u32 v5, v6, 3, v5
    buffer_store_dwordx2 v[60:61], v5, s[8:11], s42 offen sc1
    s_waitcnt vmcnt(0)
    s_cmp_lg_u32 s14, 0
    s_cbranch_scc1 Li_pw_d
    v_mov_b32 v5, 160
    s_mov_b32 s16, 0
Li_pw:
    global_load_dword v6, v5, s[12:13] sc1
    s_add_u32 s16, s16, 1
    s_cmp_gt_u32 s16, 100000
    s_cbranch_scc1 L_abort
    s_waitcnt vmcnt(0)
    v_cmp_gt_u32 vcc, 123, v6
    s_nop 0
    s_cbranch_vccz Li_pw_d
    s_sleep 2
    s_branch Li_pw
Li_pw_d:
    s_barrier
    s_cmp_lg_u32 s14, 0
    s_cbranch_scc1 Li_end
    v_lshrrev_b32 v5, 2, v0
    v_lshlrev_b32 v5, 7, v5
    v_and_b32 v6, 3, v0
    v_lshl_add_u32 v5, v6, 2, v5
    v_mov_b32 v6, 1
    s_mul_i32 s41, s47, 22528
    s_mov_b32 exec_lo, -1
    s_mov_b32 exec_hi, 0xffff
    s_add_u32 s41, s41, 180224
    buffer_store_dword v6, v5, s[8:11], s41 offen offset:0 sc1
    s_mov_b64 exec, -1
Li_end:
L_noinit:
    s_cmp_lg_u32 s3, 2
    s_cbranch_scc1 L_cls2_no
    s_add_u32 s15, s4, 0
    s_cmp_lt_u32 s4, 32
    s_cbranch_scc1 L_role_p
    s_endpgm
L_cls2_no:
    s_cmp_lg_u32 s3, 3
    s_cbranch_scc1 L_cls3_no
    s_add_u32 s15, s4, 32
    s_cmp_lt_u32 s4, 32
    s_cbranch_scc1 L_role_p
    s_endpgm
L_cls3_no:
    s_cmp_lg_u32 s3, 4
    s_cbranch_scc1 L_cls4_no
    s_add_u32 s15, s4, 0
    s_cmp_lt_u32 s4, 16
    s_cbranch_scc1 L_role_aq
    s_add_u32 s15, s4, 4294967280
    s_cmp_lt_u32 s4, 21
    s_cbranch_scc1 L_role_awo
    s_add_u32 s15, s4, 43
    s_cmp_lt_u32 s4, 32
    s_cbranch_scc1 L_role_p
    s_endpgm
L_cls4_no:
    s_cmp_lg_u32 s3, 5
    s_cbranch_scc1 L_cls5_no
    s_add_u32 s15, s4, 16
    s_cmp_lt_u32 s4, 16
    s_cbranch_scc1 L_role_aq
    s_add_u32 s15, s4, 4294967285
    s_cmp_lt_u32 s4, 21
    s_cbranch_scc1 L_role_awo
    s_add_u32 s15, s4, 54
    s_cmp_lt_u32 s4, 32
    s_cbranch_scc1 L_role_p
    s_endpgm
L_cls5_no:
    s_cmp_lg_u32 s3, 6
    s_cbranch_scc1 L_cls6_no
    s_add_u32 s15, s4, 0
    s_cmp_lt_u32 s4, 8
    s_cbranch_scc1 L_role_ta
    s_add_u32 s15, s4, 4294967288
    s_cmp_lt_u32 s4, 32
    s_cbranch_scc1 L_role_tw
    s_endpgm
L_cls6_no:
    s_cmp_lg_u32 s3, 7
    s_cbranch_scc1 L_cls7_no
    s_add_u32 s15, s4, 8
    s_cmp_lt_u32 s4, 8
    s_cbranch_scc1 L_role_ta
    s_add_u32 s15, s4, 16
    s_cmp_lt_u32 s4, 20
    s_cbranch_scc1 L_role_tw
    s_add_u32 s15, s4, 66
    s_cmp_lt_u32 s4, 30
    s_cbranch_scc1 L_role_p
    s_endpgm
L_cls7_no:
L_exit:
    s_endpgm
L_abort:
    s_waitcnt lgkmcnt(0)
    s_mov_b64 exec, -1
    v_mov_b32 v0, 60
    s_lshl_b32 s5, s3, 8
    s_or_b32 s5, s5, s4
    s_or_b32 s5, s5, 0x10000
    v_mov_b32 v1, s5
    global_store_dword v0, v1, s[12:13]
    s_endpgm
.p2align 6
L_role_p:
    v_and_b32 v5, 63, v0
    v_lshlrev_b32 v0, 4, v5
    v_and_b32 v7, 15, v5
    v_lshrrev_b32 v8, 4, v5
    v_min_u32 v1, 17, v5
    v_lshrrev_b32 v6, 2, v1
    v_and_b32 v1, 3, v1
    v_lshlrev_b32 v1, 2, v1
    v_lshl_add_u32 v1, v6, 7, v1
    v_mov_b32 v3, 1
    v_mov_b32 v4, 0
    s_mov_b32 s44, 0x05040100
    s_mov_b32 s45, 0x07060302
    s_cmp_ge_u32 s15, 48
    s_cselect_b32 s63, 1, 0
    s_cselect_b32 s17, 48, 0
    s_sub_u32 s15, s15, s17
    s_lshr_b32 s50, s15, 4
    s_and_b32 s51, s15, 15
    s_lshl_b32 s51, s51, 1
    s_lshr_b32 s17, s14, 1
    s_add_u32 s51, s51, s17
    s_and_b32 s47, s14, 1
    s_lshl_b32 s17, s50, 3
    s_add_u32 s17, s17, 40
    s_load_dwordx2 s[20:21], s[0:1], s17
    s_mov_b32 s22, 4718592
    s_mov_b32 s23, 0x00020000
    s_lshl_b32 s49, s51, 8
    s_lshl_b32 s17, s47, 7
    s_add_u32 s49, s49, s17
    s_cmp_eq_u32 s63, 0
    s_cbranch_scc1 Lp_noord
    s_cmp_lg_u32 s14, 0
    s_cbranch_scc1 Lp_ord_d
    v_mov_b32 v5, 48
    s_mov_b32 s16, 0
Lp_ord:
    global_load_dword v6, v5, s[12:13] sc1
    s_add_u32 s16, s16, 1
    s_cmp_gt_u32 s16, 100000
    s_cbranch_scc1 L_role_p_abort
    s_waitcnt vmcnt(0)
    v_cmp_gt_u32 vcc, 1, v6
    s_nop 0
    s_cbranch_vccz Lp_ord_d
    s_sleep 64
    s_branch Lp_ord
Lp_ord_d:
    s_barrier
Lp_noord:
    v_lshrrev_b32 v5, 4, v0
    v_lshrrev_b32 v211, 3, v5
    v_lshlrev_b32 v211, 13, v211
    v_and_b32 v6, 7, v5
    v_lshl_add_u32 v211, v6, 4, v211
    v_lshrrev_b32 v210, 1, v8
    v_lshlrev_b32 v210, 3, v210
    v_lshrrev_b32 v6, 2, v7
    v_add_u32 v210, v210, v6
    v_lshlrev_b32 v210, 7, v210
    s_lshl_b32 s17, s14, 15
    v_add_u32 v210, s17, v210
    v_and_b32 v13, 1, v8
    v_and_b32 v6, 1, v7
    v_lshlrev_b32 v6, 3, v6
    v_lshl_add_u32 v6, v13, 4, v6
    v_bfe_u32 v9, v7, 1, 1
    v_lshl_add_u32 v6, v9, 5, v6
    v_and_b32 v9, 3, v7
    v_lshlrev_b32 v9, 3, v9
    v_lshl_add_u32 v13, v13, 5, v9
    s_cmp_eq_u32 s50, 2
    s_cselect_b64 vcc, -1, 0
    v_cndmask_b32 v6, v6, v13, vcc
    v_add_u32 v210, v210, v6
    s_waitcnt lgkmcnt(0)
    s_and_b32 s21, s21, 0xffff
    s_lshl_b32 s46, s14, 15
    s_add_u32 m0, s46, 0
    s_add_u32 s17, s49, 0
    buffer_load_dwordx4 v211, s[20:23], s17 offen lds
    s_add_u32 m0, s46, 1024
    s_add_u32 s17, s49, 65536
    buffer_load_dwordx4 v211, s[20:23], s17 offen lds
    s_add_u32 m0, s46, 2048
    s_add_u32 s17, s49, 131072
    buffer_load_dwordx4 v211, s[20:23], s17 offen lds
    s_add_u32 m0, s46, 3072
    s_add_u32 s17, s49, 196608
    buffer_load_dwordx4 v211, s[20:23], s17 offen lds
    s_add_u32 m0, s46, 4096
    s_add_u32 s17, s49, 262144
    buffer_load_dwordx4 v211, s[20:23], s17 offen lds
    s_add_u32 m0, s46, 5120
    s_add_u32 s17, s49, 327680
    buffer_load_dwordx4 v211, s[20:23], s17 offen lds
    s_add_u32 m0, s46, 6144
    s_add_u32 s17, s49, 393216
    buffer_load_dwordx4 v211, s[20:23], s17 offen lds
    s_add_u32 m0, s46, 7168
    s_add_u32 s17, s49, 458752
    buffer_load_dwordx4 v211, s[20:23], s17 offen lds
    s_add_u32 m0, s46, 8192
    s_add_u32 s17, s49, 524288
    buffer_load_dwordx4 v211, s[20:23], s17 offen lds
    s_add_u32 m0, s46, 9216
    s_add_u32 s17, s49, 589824
    buffer_load_dwordx4 v211, s[20:23], s17 offen lds
    s_add_u32 m0, s46, 10240
    s_add_u32 s17, s49, 655360
    buffer_load_dwordx4 v211, s[20:23], s17 offen lds
    s_add_u32 m0, s46, 11264
    s_add_u32 s17, s49, 720896
    buffer_load_dwordx4 v211, s[20:23], s17 offen lds
    s_add_u32 m0, s46, 12288
    s_add_u32 s17, s49, 786432
    buffer_load_dwordx4 v211, s[20:23], s17 offen lds
    s_add_u32 m0, s46, 13312
    s_add_u32 s17, s49, 851968
    buffer_load_dwordx4 v211, s[20:23], s17 offen lds
    s_add_u32 m0, s46, 14336
    s_add_u32 s17, s49, 917504
    buffer_load_dwordx4 v211, s[20:23], s17 offen lds
    s_add_u32 m0, s46, 15360
    s_add_u32 s17, s49, 983040
    buffer_load_dwordx4 v211, s[20:23], s17 offen lds
    s_add_u32 m0, s46, 16384
    s_add_u32 s17, s49, 1048576
    buffer_load_dwordx4 v211, s[20:23], s17 offen lds
    s_add_u32 m0, s46, 17408
    s_add_u32 s17, s49, 1114112
    buffer_load_dwordx4 v211, s[20:23], s17 offen lds
    s_add_u32 m0, s46, 18432
    s_add_u32 s17, s49, 1179648
    buffer_load_dwordx4 v211, s[20:23], s17 offen lds
    s_add_u32 m0, s46, 19456
    s_add_u32 s17, s49, 1245184
    buffer_load_dwordx4 v211, s[20:23], s17 offen lds
    s_add_u32 m0, s46, 20480
    s_add_u32 s17, s49, 1310720
    buffer_load_dwordx4 v211, s[20:23], s17 offen lds
    s_add_u32 m0, s46, 21504
    s_add_u32 s17, s49, 1376256
    buffer_load_dwordx4 v211, s[20:23], s17 offen lds
    s_add_u32 m0, s46, 22528
    s_add_u32 s17, s49, 1441792
    buffer_load_dwordx4 v211, s[20:23], s17 offen lds
    s_add_u32 m0, s46, 23552
    s_add_u32 s17, s49, 1507328
    buffer_load_dwordx4 v211, s[20:23], s17 offen lds
    s_add_u32 m0, s46, 24576
    s_add_u32 s17, s49, 1572864
    buffer_load_dwordx4 v211, s[20:23], s17 offen lds
    s_add_u32 m0, s46, 25600
    s_add_u32 s17, s49, 1638400
    buffer_load_dwordx4 v211, s[20:23], s17 offen lds
    s_add_u32 m0, s46, 26624
    s_add_u32 s17, s49, 1703936
    buffer_load_dwordx4 v211, s[20:23], s17 offen lds
    s_add_u32 m0, s46, 27648
    s_add_u32 s17, s49, 1769472
    buffer_load_dwordx4 v211, s[20:23], s17 offen lds
    s_add_u32 m0, s46, 28672
    s_add_u32 s17, s49, 1835008
    buffer_load_dwordx4 v211, s[20:23], s17 offen lds
    s_add_u32 m0, s46, 29696
    s_add_u32 s17, s49, 1900544
    buffer_load_dwordx4 v211, s[20:23], s17 offen lds
    s_add_u32 m0, s46, 30720
    s_add_u32 s17, s49, 1966080
    buffer_load_dwordx4 v211, s[20:23], s17 offen lds
    s_add_u32 m0, s46, 31744
    s_add_u32 s17, s49, 2031616
    buffer_load_dwordx4 v211, s[20:23], s17 offen lds
    s_waitcnt vmcnt(30)
    ds_read_b64_tr_b16 a[0:1], v210 offset:0
    ds_read_b64_tr_b16 a[2:3], v210 offset:512
    ds_read_b64_tr_b16 a[144:145], v210 offset:64
    ds_read_b64_tr_b16 a[146:147], v210 offset:576
    s_waitcnt lgkmcnt(0)
    s_add_u32 m0, s46, 0
    s_add_u32 s17, s49, 2097152
    buffer_load_dwordx4 v211, s[20:23], s17 offen lds
    s_add_u32 m0, s46, 1024
    s_add_u32 s17, s49, 2162688
    buffer_load_dwordx4 v211, s[20:23], s17 offen lds
    s_waitcnt vmcnt(30)
    ds_read_b64_tr_b16 a[4:5], v210 offset:2048
    ds_read_b64_tr_b16 a[6:7], v210 offset:2560
    ds_read_b64_tr_b16 a[148:149], v210 offset:2112
    ds_read_b64_tr_b16 a[150:151], v210 offset:2624
    s_waitcnt lgkmcnt(0)
    s_add_u32 m0, s46, 2048
    s_add_u32 s17, s49, 2228224
    buffer_load_dwordx4 v211, s[20:23], s17 offen lds
    s_add_u32 m0, s46, 3072
    s_add_u32 s17, s49, 2293760
    buffer_load_dwordx4 v211, s[20:23], s17 offen lds
    s_waitcnt vmcnt(30)
    ds_read_b64_tr_b16 a[8:9], v210 offset:4096
    ds_read_b64_tr_b16 a[10:11], v210 offset:4608
    ds_read_b64_tr_b16 a[152:153], v210 offset:4160
    ds_read_b64_tr_b16 a[154:155], v210 offset:4672
    s_waitcnt lgkmcnt(0)
    s_add_u32 m0, s46, 4096
    s_add_u32 s17, s49, 2359296
    buffer_load_dwordx4 v211, s[20:23], s17 offen lds
    s_add_u32 m0, s46, 5120
    s_add_u32 s17, s49, 2424832
    buffer_load_dwordx4 v211, s[20:23], s17 offen lds
    s_waitcnt vmcnt(30)
    ds_read_b64_tr_b16 a[12:13], v210 offset:6144
    ds_read_b64_tr_b16 a[14:15], v210 offset:6656
    ds_read_b64_tr_b16 a[156:157], v210 offset:6208
    ds_read_b64_tr_b16 a[158:159], v210 offset:6720
    s_waitcnt lgkmcnt(0)
    s_add_u32 m0, s46, 6144
    s_add_u32 s17, s49, 2490368
    buffer_load_dwordx4 v211, s[20:23], s17 offen lds
    s_add_u32 m0, s46, 7168
    s_add_u32 s17, s49, 2555904
    buffer_load_dwordx4 v211, s[20:23], s17 offen lds
    s_waitcnt vmcnt(30)
    ds_read_b64_tr_b16 a[16:17], v210 offset:8192
    ds_read_b64_tr_b16 a[18:19], v210 offset:8704
    ds_read_b64_tr_b16 a[160:161], v210 offset:8256
    ds_read_b64_tr_b16 a[162:163], v210 offset:8768
    s_waitcnt lgkmcnt(0)
    s_add_u32 m0, s46, 8192
    s_add_u32 s17, s49, 2621440
    buffer_load_dwordx4 v211, s[20:23], s17 offen lds
    s_add_u32 m0, s46, 9216
    s_add_u32 s17, s49, 2686976
    buffer_load_dwordx4 v211, s[20:23], s17 offen lds
    s_waitcnt vmcnt(30)
    ds_read_b64_tr_b16 a[20:21], v210 offset:10240
    ds_read_b64_tr_b16 a[22:23], v210 offset:10752
    ds_read_b64_tr_b16 a[164:165], v210 offset:10304
    ds_read_b64_tr_b16 a[166:167], v210 offset:10816
    s_waitcnt lgkmcnt(0)
    s_add_u32 m0, s46, 10240
    s_add_u32 s17, s49, 2752512
    buffer_load_dwordx4 v211, s[20:23], s17 offen lds
    s_add_u32 m0, s46, 11264
    s_add_u32 s17, s49, 2818048
    buffer_load_dwordx4 v211, s[20:23], s17 offen lds
    s_waitcnt vmcnt(30)
    ds_read_b64_tr_b16 a[24:25], v210 offset:12288
    ds_read_b64_tr_b16 a[26:27], v210 offset:12800
    ds_read_b64_tr_b16 a[168:169], v210 offset:12352
    ds_read_b64_tr_b16 a[170:171], v210 offset:12864
    s_waitcnt lgkmcnt(0)
    s_add_u32 m0, s46, 12288
    s_add_u32 s17, s49, 2883584
    buffer_load_dwordx4 v211, s[20:23], s17 offen lds
    s_add_u32 m0, s46, 13312
    s_add_u32 s17, s49, 2949120
    buffer_load_dwordx4 v211, s[20:23], s17 offen lds
    s_waitcnt vmcnt(30)
    ds_read_b64_tr_b16 a[28:29], v210 offset:14336
    ds_read_b64_tr_b16 a[30:31], v210 offset:14848
    ds_read_b64_tr_b16 a[172:173], v210 offset:14400
    ds_read_b64_tr_b16 a[174:175], v210 offset:14912
    s_waitcnt lgkmcnt(0)
    s_add_u32 m0, s46, 14336
    s_add_u32 s17, s49, 3014656
    buffer_load_dwordx4 v211, s[20:23], s17 offen lds
    s_add_u32 m0, s46, 15360
    s_add_u32 s17, s49, 3080192
    buffer_load_dwordx4 v211, s[20:23], s17 offen lds
    s_waitcnt vmcnt(30)
    ds_read_b64_tr_b16 a[32:33], v210 offset:16384
    ds_read_b64_tr_b16 a[34:35], v210 offset:16896
    ds_read_b64_tr_b16 a[176:177], v210 offset:16448
    ds_read_b64_tr_b16 a[178:179], v210 offset:16960
    s_waitcnt lgkmcnt(0)
    s_add_u32 m0, s46, 16384
    s_add_u32 s17, s49, 3145728
    buffer_load_dwordx4 v211, s[20:23], s17 offen lds
    s_add_u32 m0, s46, 17408
    s_add_u32 s17, s49, 3211264
    buffer_load_dwordx4 v211, s[20:23], s17 offen lds
    s_waitcnt vmcnt(30)
    ds_read_b64_tr_b16 a[36:37], v210 offset:18432
    ds_read_b64_tr_b16 a[38:39], v210 offset:18944
    ds_read_b64_tr_b16 a[180:181], v210 offset:18496
    ds_read_b64_tr_b16 a[182:183], v210 offset:19008
    s_waitcnt lgkmcnt(0)
    s_add_u32 m0, s46, 18432
    s_add_u32 s17, s49, 3276800
    buffer_load_dwordx4 v211, s[20:23], s17 offen lds
    s_add_u32 m0, s46, 19456
    s_add_u32 s17, s49, 3342336
    buffer_load_dwordx4 v211, s[20:23], s17 offen lds
    s_waitcnt vmcnt(30)
    ds_read_b64_tr_b16 a[40:41], v210 offset:20480
    ds_read_b64_tr_b16 a[42:43], v210 offset:20992
    ds_read_b64_tr_b16 a[184:185], v210 offset:20544
    ds_read_b64_tr_b16 a[186:187], v210 offset:21056
    s_waitcnt lgkmcnt(0)
    s_add_u32 m0, s46, 20480
    s_add_u32 s17, s49, 3407872
    buffer_load_dwordx4 v211, s[20:23], s17 offen lds
    s_add_u32 m0, s46, 21504
    s_add_u32 s17, s49, 3473408
    buffer_load_dwordx4 v211, s[20:23], s17 offen lds
    s_waitcnt vmcnt(30)
    ds_read_b64_tr_b16 a[44:45], v210 offset:22528
    ds_read_b64_tr_b16 a[46:47], v210 offset:23040
    ds_read_b64_tr_b16 a[188:189], v210 offset:22592
    ds_read_b64_tr_b16 a[190:191], v210 offset:23104
    s_waitcnt lgkmcnt(0)
    s_add_u32 m0, s46, 22528
    s_add_u32 s17, s49, 3538944
    buffer_load_dwordx4 v211, s[20:23], s17 offen lds
    s_add_u32 m0, s46, 23552
    s_add_u32 s17, s49, 3604480
    buffer_load_dwordx4 v211, s[20:23], s17 offen lds
    s_waitcnt vmcnt(30)
    ds_read_b64_tr_b16 a[48:49], v210 offset:24576
    ds_read_b64_tr_b16 a[50:51], v210 offset:25088
    ds_read_b64_tr_b16 a[192:193], v210 offset:24640
    ds_read_b64_tr_b16 a[194:195], v210 offset:25152
    s_waitcnt lgkmcnt(0)
    s_add_u32 m0, s46, 24576
    s_add_u32 s17, s49, 3670016
    buffer_load_dwordx4 v211, s[20:23], s17 offen lds
    s_add_u32 m0, s46, 25600
    s_add_u32 s17, s49, 3735552
    buffer_load_dwordx4 v211, s[20:23], s17 offen lds
    s_waitcnt vmcnt(30)
    ds_read_b64_tr_b16 a[52:53], v210 offset:26624
    ds_read_b64_tr_b16 a[54:55], v210 offset:27136
    ds_read_b64_tr_b16 a[196:197], v210 offset:26688
    ds_read_b64_tr_b16 a[198:199], v210 offset:27200
    s_waitcnt lgkmcnt(0)
    s_add_u32 m0, s46, 26624
    s_add_u32 s17, s49, 3801088
    buffer_load_dwordx4 v211, s[20:23], s17 offen lds
    s_add_u32 m0, s46, 27648
    s_add_u32 s17, s49, 3866624
    buffer_load_dwordx4 v211, s[20:23], s17 offen lds
    s_waitcnt vmcnt(30)
    ds_read_b64_tr_b16 a[56:57], v210 offset:28672
    ds_read_b64_tr_b16 a[58:59], v210 offset:29184
    ds_read_b64_tr_b16 a[200:201], v210 offset:28736
    ds_read_b64_tr_b16 a[202:203], v210 offset:29248
    s_waitcnt lgkmcnt(0)
    s_add_u32 m0, s46, 28672
    s_add_u32 s17, s49, 3932160
    buffer_load_dwordx4 v211, s[20:23], s17 offen lds
    s_add_u32 m0, s46, 29696
    s_add_u32 s17, s49, 3997696
    buffer_load_dwordx4 v211, s[20:23], s17 offen lds
    s_waitcnt vmcnt(30)
    ds_read_b64_tr_b16 a[60:61], v210 offset:30720
    ds_read_b64_tr_b16 a[62:63], v210 offset:31232
    ds_read_b64_tr_b16 a[204:205], v210 offset:30784
    ds_read_b64_tr_b16 a[206:207], v210 offset:31296
    s_waitcnt lgkmcnt(0)
    s_add_u32 m0, s46, 30720
    s_add_u32 s17, s49, 4063232
    buffer_load_dwordx4 v211, s[20:23], s17 offen lds
    s_add_u32 m0, s46, 31744
    s_add_u32 s17, s49, 4128768
    buffer_load_dwordx4 v211, s[20:23], s17 offen lds
    s_waitcnt vmcnt(30)
    ds_read_b64_tr_b16 a[64:65], v210 offset:0
    ds_read_b64_tr_b16 a[66:67], v210 offset:512
    ds_read_b64_tr_b16 a[208:209], v210 offset:64
    ds_read_b64_tr_b16 a[210:211], v210 offset:576
    s_waitcnt lgkmcnt(0)
    s_add_u32 m0, s46, 0
    s_add_u32 s17, s49, 4194304
    buffer_load_dwordx4 v211, s[20:23], s17 offen lds
    s_add_u32 m0, s46, 1024
    s_add_u32 s17, s49, 4259840
    buffer_load_dwordx4 v211, s[20:23], s17 offen lds
    s_waitcnt vmcnt(30)
    ds_read_b64_tr_b16 a[68:69], v210 offset:2048
    ds_read_b64_tr_b16 a[70:71], v210 offset:2560
    ds_read_b64_tr_b16 a[212:213], v210 offset:2112
    ds_read_b64_tr_b16 a[214:215], v210 offset:2624
    s_waitcnt lgkmcnt(0)
    s_add_u32 m0, s46, 2048
    s_add_u32 s17, s49, 4325376
    buffer_load_dwordx4 v211, s[20:23], s17 offen lds
    s_add_u32 m0, s46, 3072
    s_add_u32 s17, s49, 4390912
    buffer_load_dwordx4 v211, s[20:23], s17 offen lds
    s_waitcnt vmcnt(30)
    ds_read_b64_tr_b16 a[72:73], v210 offset:4096
    ds_read_b64_tr_b16 a[74:75], v210 offset:4608
    ds_read_b64_tr_b16 a[216:217], v210 offset:4160
    ds_read_b64_tr_b16 a[218:219], v210 offset:4672
    s_waitcnt lgkmcnt(0)
    s_add_u32 m0, s46, 4096
    s_add_u32 s17, s49, 4456448
    buffer_load_dwordx4 v211, s[20:23], s17 offen lds
    s_add_u32 m0, s46, 5120
    s_add_u32 s17, s49, 4521984
    buffer_load_dwordx4 v211, s[20:23], s17 offen lds
    s_waitcnt vmcnt(30)
    ds_read_b64_tr_b16 a[76:77], v210 offset:6144
    ds_read_b64_tr_b16 a[78:79], v210 offset:6656
    ds_read_b64_tr_b16 a[220:221], v210 offset:6208
    ds_read_b64_tr_b16 a[222:223], v210 offset:6720
    s_waitcnt lgkmcnt(0)
    s_add_u32 m0, s46, 6144
    s_add_u32 s17, s49, 4587520
    buffer_load_dwordx4 v211, s[20:23], s17 offen lds
    s_add_u32 m0, s46, 7168
    s_add_u32 s17, s49, 4653056
    buffer_load_dwordx4 v211, s[20:23], s17 offen lds
    s_waitcnt vmcnt(30)
    ds_read_b64_tr_b16 a[80:81], v210 offset:8192
    ds_read_b64_tr_b16 a[82:83], v210 offset:8704
    ds_read_b64_tr_b16 a[224:225], v210 offset:8256
    ds_read_b64_tr_b16 a[226:227], v210 offset:8768
    s_waitcnt vmcnt(28)
    ds_read_b64_tr_b16 a[84:85], v210 offset:10240
    ds_read_b64_tr_b16 a[86:87], v210 offset:10752
    ds_read_b64_tr_b16 a[228:229], v210 offset:10304
    ds_read_b64_tr_b16 a[230:231], v210 offset:10816
    s_waitcnt vmcnt(26)
    ds_read_b64_tr_b16 a[88:89], v210 offset:12288
    ds_read_b64_tr_b16 a[90:91], v210 offset:12800
    ds_read_b64_tr_b16 a[232:233], v210 offset:12352
    ds_read_b64_tr_b16 a[234:235], v210 offset:12864
    s_waitcnt vmcnt(24)
    ds_read_b64_tr_b16 a[92:93], v210 offset:14336
    ds_read_b64_tr_b16 a[94:95], v210 offset:14848
    ds_read_b64_tr_b16 a[236:237], v210 offset:14400
    ds_read_b64_tr_b16 a[238:239], v210 offset:14912
    s_waitcnt vmcnt(22)
    ds_read_b64_tr_b16 a[96:97], v210 offset:16384
    ds_read_b64_tr_b16 a[98:99], v210 offset:16896
    ds_read_b64_tr_b16 a[240:241], v210 offset:16448
    ds_read_b64_tr_b16 a[242:243], v210 offset:16960
    s_waitcnt vmcnt(20)
    ds_read_b64_tr_b16 a[100:101], v210 offset:18432
    ds_read_b64_tr_b16 a[102:103], v210 offset:18944
    ds_read_b64_tr_b16 a[244:245], v210 offset:18496
    ds_read_b64_tr_b16 a[246:247], v210 offset:19008
    s_waitcnt vmcnt(18)
    ds_read_b64_tr_b16 a[104:105], v210 offset:20480
    ds_read_b64_tr_b16 a[106:107], v210 offset:20992
    ds_read_b64_tr_b16 a[248:249], v210 offset:20544
    ds_read_b64_tr_b16 a[250:251], v210 offset:21056
    s_waitcnt vmcnt(16)
    ds_read_b64_tr_b16 a[108:109], v210 offset:22528
    ds_read_b64_tr_b16 a[110:111], v210 offset:23040
    ds_read_b64_tr_b16 a[252:253], v210 offset:22592
    ds_read_b64_tr_b16 a[254:255], v210 offset:23104
    s_waitcnt vmcnt(14)
    ds_read_b64_tr_b16 a[112:113], v210 offset:24576
    ds_read_b64_tr_b16 a[114:115], v210 offset:25088
    ds_read_b64_tr_b16 v[224:225], v210 offset:24640
    ds_read_b64_tr_b16 v[226:227], v210 offset:25152
    s_waitcnt vmcnt(12)
    ds_read_b64_tr_b16 a[116:117], v210 offset:26624
    ds_read_b64_tr_b16 a[118:119], v210 offset:27136
    ds_read_b64_tr_b16 v[228:229], v210 offset:26688
    ds_read_b64_tr_b16 v[230:231], v210 offset:27200
    s_waitcnt vmcnt(10)
    ds_read_b64_tr_b16 a[120:121], v210 offset:28672
    ds_read_b64_tr_b16 a[122:123], v210 offset:29184
    ds_read_b64_tr_b16 v[232:233], v210 offset:28736
    ds_read_b64_tr_b16 v[234:235], v210 offset:29248
    s_waitcnt vmcnt(8)
    ds_read_b64_tr_b16 a[124:125], v210 offset:30720
    ds_read_b64_tr_b16 a[126:127], v210 offset:31232
    ds_read_b64_tr_b16 v[236:237], v210 offset:30784
    ds_read_b64_tr_b16 v[238:239], v210 offset:31296
    s_waitcnt vmcnt(6)
    ds_read_b64_tr_b16 a[128:129], v210 offset:0
    ds_read_b64_tr_b16 a[130:131], v210 offset:512
    ds_read_b64_tr_b16 v[240:241], v210 offset:64
    ds_read_b64_tr_b16 v[242:243], v210 offset:576
    s_waitcnt vmcnt(4)
    ds_read_b64_tr_b16 a[132:133], v210 offset:2048
    ds_read_b64_tr_b16 a[134:135], v210 offset:2560
    ds_read_b64_tr_b16 v[244:245], v210 offset:2112
    ds_read_b64_tr_b16 v[246:247], v210 offset:2624
    s_waitcnt vmcnt(2)
    ds_read_b64_tr_b16 a[136:137], v210 offset:4096
    ds_read_b64_tr_b16 a[138:139], v210 offset:4608
    ds_read_b64_tr_b16 v[248:249], v210 offset:4160
    ds_read_b64_tr_b16 v[250:251], v210 offset:4672
    s_waitcnt vmcnt(0)
    ds_read_b64_tr_b16 a[140:141], v210 offset:6144
    ds_read_b64_tr_b16 a[142:143], v210 offset:6656
    ds_read_b64_tr_b16 v[252:253], v210 offset:6208
    ds_read_b64_tr_b16 v[254:255], v210 offset:6720
    s_waitcnt vmcnt(0) lgkmcnt(0)
    v_bfe_u32 v10, v0, 4, 5
    v_lshrrev_b32 v5, 9, v0
    v_lshlrev_b32 v10, 4, v10
    v_mul_u32_u24 v6, 2560, v5
    v_add_u32 v10, v10, v6
    v_add_u32 v10, 114688, v10
    s_lshl_b32 s67, s14, 10
    v_bfe_u32 v6, v0, 8, 1
    v_lshlrev_b32 v13, 10, v6
    v_lshl_add_u32 v13, v7, 4, v13
    v_lshl_add_u32 v13, v5, 8, v13
    v_mov_b32 v212, 1
    v_mov_b32 v213, 1
    s_mul_i32 s52, s50, 16777216
    s_lshl_b32 s17, s51, 13
    s_add_u32 s52, s52, s17
    s_lshl_b32 s17, s47, 12
    s_add_u32 s52, s52, s17
    s_add_u32 s52, s52, 44040192
    s_lshl_b32 s49, s51, 9
    s_lshl_b32 s17, s50, 7
    s_add_u32 s49, s49, s17
    s_lshl_b32 s17, s47, 3
    s_add_u32 s49, s49, s17
    s_add_u32 s49, s49, 185600
    v_mov_b32 v48, 0x3f803f80
    v_mov_b32 v49, 0x3f803f80
    v_mov_b32 v50, 0x3f803f80
    v_mov_b32 v51, 0x3f803f80
    s_lshl_b32 s17, s14, 8
    s_add_u32 s17, s17, 110592
    v_bfe_u32 v5, v0, 4, 5
    v_lshl_add_u32 v14, v5, 2, s17
    v_lshrrev_b32 v5, 9, v0
    v_lshl_add_u32 v214, v5, 4, s17
    s_cmp_eq_u32 s50, 2
    s_cbranch_scc1 Lp_v
    v_mfma_f32_32x32x16_bf16 v[148:163], a[0:3], v[48:51], 0
    v_mfma_f32_32x32x16_bf16 v[148:163], a[4:7], v[48:51], v[148:163]
    v_mfma_f32_32x32x16_bf16 v[148:163], a[8:11], v[48:51], v[148:163]
    v_mfma_f32_32x32x16_bf16 v[148:163], a[12:15], v[48:51], v[148:163]
    v_mfma_f32_32x32x16_bf16 v[148:163], a[16:19], v[48:51], v[148:163]
    v_mfma_f32_32x32x16_bf16 v[148:163], a[20:23], v[48:51], v[148:163]
    v_mfma_f32_32x32x16_bf16 v[148:163], a[24:27], v[48:51], v[148:163]
    v_mfma_f32_32x32x16_bf16 v[148:163], a[28:31], v[48:51], v[148:163]
    v_mfma_f32_32x32x16_bf16 v[148:163], a[32:35], v[48:51], v[148:163]
    v_mfma_f32_32x32x16_bf16 v[148:163], a[36:39], v[48:51], v[148:163]
    v_mfma_f32_32x32x16_bf16 v[148:163], a[40:43], v[48:51], v[148:163]
    v_mfma_f32_32x32x16_bf16 v[148:163], a[44:47], v[48:51], v[148:163]
    v_mfma_f32_32x32x16_bf16 v[148:163], a[48:51], v[48:51], v[148:163]
    v_mfma_f32_32x32x16_bf16 v[148:163], a[52:55], v[48:51], v[148:163]
    v_mfma_f32_32x32x16_bf16 v[148:163], a[56:59], v[48:51], v[148:163]
    v_mfma_f32_32x32x16_bf16 v[148:163], a[60:63], v[48:51], v[148:163]
    v_mfma_f32_32x32x16_bf16 v[148:163], a[64:67], v[48:51], v[148:163]
    v_mfma_f32_32x32x16_bf16 v[148:163], a[68:71], v[48:51], v[148:163]
    v_mfma_f32_32x32x16_bf16 v[148:163], a[72:75], v[48:51], v[148:163]
    v_mfma_f32_32x32x16_bf16 v[148:163], a[76:79], v[48:51], v[148:163]
    v_mfma_f32_32x32x16_bf16 v[148:163], a[80:83], v[48:51], v[148:163]
    v_mfma_f32_32x32x16_bf16 v[148:163], a[84:87], v[48:51], v[148:163]
    v_mfma_f32_32x32x16_bf16 v[148:163], a[88:91], v[48:51], v[148:163]
    v_mfma_f32_32x32x16_bf16 v[148:163], a[92:95], v[48:51], v[148:163]
    v_mfma_f32_32x32x16_bf16 v[148:163], a[96:99], v[48:51], v[148:163]
    v_mfma_f32_32x32x16_bf16 v[148:163], a[100:103], v[48:51], v[148:163]
    v_mfma_f32_32x32x16_bf16 v[148:163], a[104:107], v[48:51], v[148:163]
    v_mfma_f32_32x32x16_bf16 v[148:163], a[108:111], v[48:51], v[148:163]
    v_mfma_f32_32x32x16_bf16 v[148:163], a[112:115], v[48:51], v[148:163]
    v_mfma_f32_32x32x16_bf16 v[148:163], a[116:119], v[48:51], v[148:163]
    v_mfma_f32_32x32x16_bf16 v[148:163], a[120:123], v[48:51], v[148:163]
    v_mfma_f32_32x32x16_bf16 v[148:163], a[124:127], v[48:51], v[148:163]
    v_mfma_f32_32x32x16_bf16 v[148:163], a[128:131], v[48:51], v[148:163]
    v_mfma_f32_32x32x16_bf16 v[148:163], a[132:135], v[48:51], v[148:163]
    v_mfma_f32_32x32x16_bf16 v[148:163], a[136:139], v[48:51], v[148:163]
    v_mfma_f32_32x32x16_bf16 v[148:163], a[140:143], v[48:51], v[148:163]
    v_mfma_f32_32x32x16_bf16 v[164:179], a[144:147], v[48:51], 0
    v_mfma_f32_32x32x16_bf16 v[164:179], a[148:151], v[48:51], v[164:179]
    v_mfma_f32_32x32x16_bf16 v[164:179], a[152:155], v[48:51], v[164:179]
    v_mfma_f32_32x32x16_bf16 v[164:179], a[156:159], v[48:51], v[164:179]
    v_mfma_f32_32x32x16_bf16 v[164:179], a[160:163], v[48:51], v[164:179]
    v_mfma_f32_32x32x16_bf16 v[164:179], a[164:167], v[48:51], v[164:179]
    v_mfma_f32_32x32x16_bf16 v[164:179], a[168:171], v[48:51], v[164:179]
    v_mfma_f32_32x32x16_bf16 v[164:179], a[172:175], v[48:51], v[164:179]
    v_mfma_f32_32x32x16_bf16 v[164:179], a[176:179], v[48:51], v[164:179]
    v_mfma_f32_32x32x16_bf16 v[164:179], a[180:183], v[48:51], v[164:179]
    v_mfma_f32_32x32x16_bf16 v[164:179], a[184:187], v[48:51], v[164:179]
    v_mfma_f32_32x32x16_bf16 v[164:179], a[188:191], v[48:51], v[164:179]
    v_mfma_f32_32x32x16_bf16 v[164:179], a[192:195], v[48:51], v[164:179]
    v_mfma_f32_32x32x16_bf16 v[164:179], a[196:199], v[48:51], v[164:179]
    v_mfma_f32_32x32x16_bf16 v[164:179], a[200:203], v[48:51], v[164:179]
    v_mfma_f32_32x32x16_bf16 v[164:179], a[204:207], v[48:51], v[164:179]
    v_mfma_f32_32x32x16_bf16 v[164:179], a[208:211], v[48:51], v[164:179]
    v_mfma_f32_32x32x16_bf16 v[164:179], a[212:215], v[48:51], v[164:179]
    v_mfma_f32_32x32x16_bf16 v[164:179], a[216:219], v[48:51], v[164:179]
    v_mfma_f32_32x32x16_bf16 v[164:179], a[220:223], v[48:51], v[164:179]
    v_mfma_f32_32x32x16_bf16 v[164:179], a[224:227], v[48:51], v[164:179]
    v_mfma_f32_32x32x16_bf16 v[164:179], a[228:231], v[48:51], v[164:179]
    v_mfma_f32_32x32x16_bf16 v[164:179], a[232:235], v[48:51], v[164:179]
    v_mfma_f32_32x32x16_bf16 v[164:179], a[236:239], v[48:51], v[164:179]
    v_mfma_f32_32x32x16_bf16 v[164:179], a[240:243], v[48:51], v[164:179]
    v_mfma_f32_32x32x16_bf16 v[164:179], a[244:247], v[48:51], v[164:179]
    v_mfma_f32_32x32x16_bf16 v[164:179], a[248:251], v[48:51], v[164:179]
    v_mfma_f32_32x32x16_bf16 v[164:179], a[252:255], v[48:51], v[164:179]
    v_mfma_f32_32x32x16_bf16 v[164:179], v[224:227], v[48:51], v[164:179]
    v_mfma_f32_32x32x16_bf16 v[164:179], v[228:231], v[48:51], v[164:179]
    v_mfma_f32_32x32x16_bf16 v[164:179], v[232:235], v[48:51], v[164:179]
    v_mfma_f32_32x32x16_bf16 v[164:179], v[236:239], v[48:51], v[164:179]
    v_mfma_f32_32x32x16_bf16 v[164:179], v[240:243], v[48:51], v[164:179]
    v_mfma_f32_32x32x16_bf16 v[164:179], v[244:247], v[48:51], v[164:179]
    v_mfma_f32_32x32x16_bf16 v[164:179], v[248:251], v[48:51], v[164:179]
    v_mfma_f32_32x32x16_bf16 v[164:179], v[252:255], v[48:51], v[164:179]
    s_mov_b32 s66, 114688
    s_mov_b32 s71, 0x2000
    s_mov_b32 s36, s63
    s_mov_b32 s34, s63
    s_mov_b32 s37, 0
    s_lshl_b32 s56, s63, 6
    s_mul_i32 s58, s14, 9216
    s_mov_b32 s40, 36864
    s_mov_b32 s59, s58
    s_mov_b32 s43, 0
    s_mov_b32 s28, s8
    s_mov_b32 s29, s9
    s_mov_b32 s30, 0
    s_mov_b32 s31, 0x00020000
    s_mul_i32 s41, s63, 4718592
    s_add_u32 s41, s41, s58
    s_add_u32 s41, s41, 8650752
    s_mul_i32 s42, s56, 22528
    s_add_u32 s42, s42, 183808
    s_cmp_lg_u32 s14, 0
    s_cbranch_scc1 LpQ_ini_d
    v_mov_b32 v5, 160
    s_mov_b32 s16, 0
LpQ_ini:
    global_load_dword v6, v5, s[12:13] sc1
    s_add_u32 s16, s16, 1
    s_cmp_gt_u32 s16, 100000
    s_cbranch_scc1 L_role_p_abort
    s_waitcnt vmcnt(0)
    v_cmp_gt_u32 vcc, 123, v6
    s_nop 0
    s_cbranch_vccz LpQ_ini_d
    s_sleep 8
    s_branch LpQ_ini
LpQ_ini_d:
    s_barrier
    s_branch LpQ_poll
LpQ_item:
    s_waitcnt vmcnt(4)
LpQ_go:
    s_barrier
    s_xor_b32 s40, s40, 36864
    s_xor_b32 s59, s59, 36864
    s_xor_b32 s66, s66, 0x2000
    s_xor_b32 s71, s71, 0x2000
    s_mov_b32 s35, s37
    s_mov_b32 s57, s56
    s_add_u32 s37, s37, 1
    s_add_u32 s56, s56, 1
    s_add_u32 s41, s41, 36864
    s_add_u32 s42, s42, 22528
    s_mov_b32 s62, 0
    v_add_u32 v9, s40, v0
    v_add_u32 v5, s71, v10
    ds_read_b128 v[48:51], v9 offset:0
    ds_read_b128 v[52:55], v9 offset:1024
    ds_read_b128 v[56:59], v9 offset:2048
    s_waitcnt lgkmcnt(2)
    v_mfma_f32_32x32x16_bf16 v[16:31], a[0:3], v[48:51], 0
    ds_read_b128 v[60:63], v9 offset:3072
    ds_read_b128 v[96:99], v5 offset:0
    ds_read_b128 v[100:103], v5 offset:512
    s_waitcnt lgkmcnt(4)
    v_mfma_f32_32x32x16_bf16 v[16:31], a[4:7], v[52:55], v[16:31]
    ds_read_b128 v[64:67], v9 offset:4096
    ds_read_b128 v[104:107], v5 offset:1024
    ds_read_b128 v[108:111], v5 offset:1536
    s_waitcnt lgkmcnt(6)
    v_mfma_f32_32x32x16_bf16 v[16:31], a[8:11], v[56:59], v[16:31]
    ds_read_b128 v[68:71], v9 offset:5120
    ds_read_b128 v[112:115], v5 offset:2048
    s_waitcnt lgkmcnt(7)
    v_mfma_f32_32x32x16_bf16 v[16:31], a[12:15], v[60:63], v[16:31]
    ds_read_b128 v[72:75], v9 offset:6144
    s_waitcnt lgkmcnt(6)
    v_add_f32 v96, v96, v100
    s_waitcnt lgkmcnt(5)
    v_mfma_f32_32x32x16_bf16 v[16:31], a[16:19], v[64:67], v[16:31]
    ds_read_b128 v[76:79], v9 offset:7168
    v_add_f32 v97, v97, v101
    v_add_f32 v98, v98, v102
    s_waitcnt lgkmcnt(3)
    v_mfma_f32_32x32x16_bf16 v[16:31], a[20:23], v[68:71], v[16:31]
    ds_read_b128 v[80:83], v9 offset:8192
    v_add_f32 v99, v99, v103
    v_add_f32 v96, v96, v104
    s_waitcnt lgkmcnt(2)
    v_mfma_f32_32x32x16_bf16 v[16:31], a[24:27], v[72:75], v[16:31]
    ds_read_b128 v[84:87], v9 offset:9216
    v_add_f32 v97, v97, v105
    v_add_f32 v98, v98, v106
    s_waitcnt lgkmcnt(2)
    v_mfma_f32_32x32x16_bf16 v[16:31], a[28:31], v[76:79], v[16:31]
    ds_read_b128 v[88:91], v9 offset:10240
    v_add_f32 v99, v99, v107
    v_add_f32 v96, v96, v108
    s_waitcnt lgkmcnt(2)
    v_mfma_f32_32x32x16_bf16 v[16:31], a[32:35], v[80:83], v[16:31]
    ds_read_b128 v[92:95], v9 offset:11264
    v_add_f32 v97, v97, v109
    v_add_f32 v98, v98, v110
    v_mfma_f32_32x32x16_bf16 v[32:47], a[144:147], v[48:51], 0
    v_add_f32 v99, v99, v111
    v_add_f32 v96, v96, v112
    s_waitcnt lgkmcnt(2)
    v_mfma_f32_32x32x16_bf16 v[16:31], a[36:39], v[84:87], v[16:31]
    ds_read_b128 v[48:51], v9 offset:12288
    v_add_f32 v97, v97, v113
    v_add_f32 v98, v98, v114
    v_mfma_f32_32x32x16_bf16 v[32:47], a[148:151], v[52:55], v[32:47]
    v_add_f32 v99, v99, v115
    v_add_f32 v96, v96, v98
    s_waitcnt lgkmcnt(2)
    v_mfma_f32_32x32x16_bf16 v[16:31], a[40:43], v[88:91], v[16:31]
    ds_read_b128 v[52:55], v9 offset:13312
    v_add_f32 v97, v97, v99
    v_mov_b32 v98, v96
    v_mfma_f32_32x32x16_bf16 v[32:47], a[152:155], v[56:59], v[32:47]
    v_mov_b32 v99, v97
    v_permlane32_swap_b32 v96, v98
    s_waitcnt lgkmcnt(2)
    v_mfma_f32_32x32x16_bf16 v[16:31], a[44:47], v[92:95], v[16:31]
    ds_read_b128 v[56:59], v9 offset:14336
    v_permlane32_swap_b32 v97, v99
    v_add_f32 v96, v96, v98
    v_mfma_f32_32x32x16_bf16 v[32:47], a[156:159], v[60:63], v[32:47]
    v_add_f32 v97, v97, v99
    v_mul_f32 v96, 0x3ae38e39, v96
    s_waitcnt lgkmcnt(2)
    v_mfma_f32_32x32x16_bf16 v[16:31], a[48:51], v[48:51], v[16:31]
    ds_read_b128 v[60:63], v9 offset:15360
    v_mul_f32 v97, 0x3ae38e39, v97
    v_fma_f32 v97, -v96, v96, v97
    v_mfma_f32_32x32x16_bf16 v[32:47], a[160:163], v[64:67], v[32:47]
    v_max_f32 v97, 0, v97
    v_add_f32 v97, 0x3727c5ac, v97
    s_waitcnt lgkmcnt(2)
    v_mfma_f32_32x32x16_bf16 v[16:31], a[52:55], v[52:55], v[16:31]
    ds_read_b128 v[64:67], v9 offset:16384
    v_rsq_f32 v116, v97
    s_nop 0
    v_mul_f32 v117, v96, v116
    v_mfma_f32_32x32x16_bf16 v[32:47], a[164:167], v[68:71], v[32:47]
    s_mul_i32 s46, s34, 50331648
    s_lshl_b32 s19, s35, 18
    s_waitcnt lgkmcnt(2)
    v_mfma_f32_32x32x16_bf16 v[16:31], a[56:59], v[56:59], v[16:31]
    ds_read_b128 v[68:71], v9 offset:17408
    s_waitcnt vmcnt(0)
    buffer_load_dword v2, v1, s[8:11], s42 offen sc1
    s_cmp_lg_u32 s43, 0
    s_cselect_b64 exec, 1, 0
    buffer_store_dwordx2 v[212:213], v4, s[8:11], s43 offen sc1
    s_mov_b64 exec, -1
    s_mov_b32 s43, 0
    v_mfma_f32_32x32x16_bf16 v[32:47], a[168:171], v[72:75], v[32:47]
    s_add_u32 s46, s46, s19
    s_add_u32 s46, s46, s52
    s_waitcnt lgkmcnt(2)
    v_mfma_f32_32x32x16_bf16 v[16:31], a[60:63], v[60:63], v[16:31]
    ds_read_b128 v[72:75], v9 offset:18432
    v_mfma_f32_32x32x16_bf16 v[32:47], a[172:175], v[76:79], v[32:47]
    s_waitcnt lgkmcnt(2)
    v_mfma_f32_32x32x16_bf16 v[16:31], a[64:67], v[64:67], v[16:31]
    ds_read_b128 v[76:79], v9 offset:19456
    v_mfma_f32_32x32x16_bf16 v[32:47], a[176:179], v[80:83], v[32:47]
    s_waitcnt lgkmcnt(2)
    v_mfma_f32_32x32x16_bf16 v[16:31], a[68:71], v[68:71], v[16:31]
    ds_read_b128 v[80:83], v9 offset:20480
    v_mfma_f32_32x32x16_bf16 v[32:47], a[180:183], v[84:87], v[32:47]
    s_waitcnt lgkmcnt(2)
    v_mfma_f32_32x32x16_bf16 v[16:31], a[72:75], v[72:75], v[16:31]
    ds_read_b128 v[84:87], v9 offset:21504
    v_mfma_f32_32x32x16_bf16 v[32:47], a[184:187], v[88:91], v[32:47]
    s_waitcnt lgkmcnt(2)
    v_mfma_f32_32x32x16_bf16 v[16:31], a[76:79], v[76:79], v[16:31]
    ds_read_b128 v[88:91], v9 offset:22528
    v_mfma_f32_32x32x16_bf16 v[32:47], a[188:191], v[92:95], v[32:47]
    s_waitcnt lgkmcnt(2)
    v_mfma_f32_32x32x16_bf16 v[16:31], a[80:83], v[80:83], v[16:31]
    ds_read_b128 v[92:95], v9 offset:23552
    v_mfma_f32_32x32x16_bf16 v[32:47], a[192:195], v[48:51], v[32:47]
    s_waitcnt lgkmcnt(2)
    v_mfma_f32_32x32x16_bf16 v[16:31], a[84:87], v[84:87], v[16:31]
    ds_read_b128 v[48:51], v9 offset:24576
    v_mfma_f32_32x32x16_bf16 v[32:47], a[196:199], v[52:55], v[32:47]
    s_waitcnt lgkmcnt(2)
    v_mfma_f32_32x32x16_bf16 v[16:31], a[88:91], v[88:91], v[16:31]
    ds_read_b128 v[52:55], v9 offset:25600
    v_mfma_f32_32x32x16_bf16 v[32:47], a[200:203], v[56:59], v[32:47]
    s_waitcnt lgkmcnt(2)
    v_mfma_f32_32x32x16_bf16 v[16:31], a[92:95], v[92:95], v[16:31]
    ds_read_b128 v[56:59], v9 offset:26624
    v_mfma_f32_32x32x16_bf16 v[32:47], a[204:207], v[60:63], v[32:47]
    s_waitcnt lgkmcnt(2)
    v_mfma_f32_32x32x16_bf16 v[16:31], a[96:99], v[48:51], v[16:31]
    ds_read_b128 v[60:63], v9 offset:27648
    v_mfma_f32_32x32x16_bf16 v[32:47], a[208:211], v[64:67], v[32:47]
    s_waitcnt lgkmcnt(2)
    v_mfma_f32_32x32x16_bf16 v[16:31], a[100:103], v[52:55], v[16:31]
    ds_read_b128 v[64:67], v9 offset:28672
    s_waitcnt vmcnt(1)
    v_cmp_eq_u32 vcc, 0, v2
    s_nop 0
    s_cmp_eq_u64 vcc, 0
    s_cselect_b32 s62, 1, 0
    s_cmp_lt_u32 s37, 64
    s_cselect_b32 s62, s62, 0
    s_cmp_lg_u32 s62, 0
    s_cselect_b32 s30, 268435456, 0
    v_mfma_f32_32x32x16_bf16 v[32:47], a[212:215], v[68:71], v[32:47]
    s_waitcnt lgkmcnt(2)
    v_mfma_f32_32x32x16_bf16 v[16:31], a[104:107], v[56:59], v[16:31]
    ds_read_b128 v[68:71], v9 offset:29696
    s_add_u32 m0, s59, 0
    s_add_u32 s47, s41, 0
    buffer_load_dwordx4 v0, s[28:31], s47 offen offset:0 lds
    v_mfma_f32_32x32x16_bf16 v[32:47], a[216:219], v[72:75], v[32:47]
    s_waitcnt lgkmcnt(2)
    v_mfma_f32_32x32x16_bf16 v[16:31], a[108:111], v[60:63], v[16:31]
    ds_read_b128 v[72:75], v9 offset:30720
    buffer_load_dwordx4 v0, s[28:31], s47 offen offset:1024 lds
    v_mfma_f32_32x32x16_bf16 v[32:47], a[220:223], v[76:79], v[32:47]
    s_waitcnt lgkmcnt(2)
    v_mfma_f32_32x32x16_bf16 v[16:31], a[112:115], v[64:67], v[16:31]
    ds_read_b128 v[76:79], v9 offset:31744
    buffer_load_dwordx4 v0, s[28:31], s47 offen offset:2048 lds
    v_mfma_f32_32x32x16_bf16 v[32:47], a[224:227], v[80:83], v[32:47]
    s_waitcnt lgkmcnt(2)
    v_mfma_f32_32x32x16_bf16 v[16:31], a[116:119], v[68:71], v[16:31]
    ds_read_b128 v[80:83], v9 offset:32768
    buffer_load_dwordx4 v0, s[28:31], s47 offen offset:3072 lds
    v_mfma_f32_32x32x16_bf16 v[32:47], a[228:231], v[84:87], v[32:47]
    s_waitcnt lgkmcnt(2)
    v_mfma_f32_32x32x16_bf16 v[16:31], a[120:123], v[72:75], v[16:31]
    ds_read_b128 v[84:87], v9 offset:33792
    s_add_u32 m0, s59, 4096
    s_add_u32 s47, s41, 4096
    buffer_load_dwordx4 v0, s[28:31], s47 offen offset:0 lds
    v_mfma_f32_32x32x16_bf16 v[32:47], a[232:235], v[88:91], v[32:47]
    s_waitcnt lgkmcnt(2)
    v_mfma_f32_32x32x16_bf16 v[16:31], a[124:127], v[76:79], v[16:31]
    ds_read_b128 v[88:91], v9 offset:34816
    buffer_load_dwordx4 v0, s[28:31], s47 offen offset:1024 lds
    v_mfma_f32_32x32x16_bf16 v[32:47], a[236:239], v[92:95], v[32:47]
    s_waitcnt lgkmcnt(2)
    v_mfma_f32_32x32x16_bf16 v[16:31], a[128:131], v[80:83], v[16:31]
    ds_read_b128 v[92:95], v9 offset:35840
    buffer_load_dwordx4 v0, s[28:31], s47 offen offset:2048 lds
    v_mfma_f32_32x32x16_bf16 v[32:47], a[240:243], v[48:51], v[32:47]
    s_waitcnt lgkmcnt(2)
    v_mfma_f32_32x32x16_bf16 v[16:31], a[132:135], v[84:87], v[16:31]
    buffer_load_dwordx4 v0, s[28:31], s47 offen offset:3072 lds
    v_mfma_f32_32x32x16_bf16 v[32:47], a[244:247], v[52:55], v[32:47]
    s_waitcnt lgkmcnt(1)
    v_mfma_f32_32x32x16_bf16 v[16:31], a[136:139], v[88:91], v[16:31]
    s_add_u32 m0, s59, 8192
    s_add_u32 s47, s41, 8192
    buffer_load_dwordx4 v0, s[28:31], s47 offen offset:0 lds
    v_mfma_f32_32x32x16_bf16 v[32:47], a[248:251], v[56:59], v[32:47]
    s_waitcnt lgkmcnt(0)
    v_mfma_f32_32x32x16_bf16 v[16:31], a[140:143], v[92:95], v[16:31]
    s_mul_i32 s48, s36, 786432
    s_mul_i32 s18, s37, 6144
    s_add_u32 s48, s48, s18
    s_add_u32 s48, s48, 16125952
    s_add_u32 m0, s66, 4096
    s_nop 0
    buffer_load_dwordx4 v0, s[28:31], s48 offen lds
    v_mfma_f32_32x32x16_bf16 v[32:47], a[252:255], v[60:63], v[32:47]
    v_mfma_f32_32x32x16_bf16 v[32:47], v[224:227], v[64:67], v[32:47]
    s_add_u32 m0, s66, s67
    s_sub_u32 s48, s48, 4096
    s_add_u32 s48, s48, s67
    buffer_load_dwordx4 v0, s[28:31], s48 offen lds
    v_mfma_f32_32x32x16_bf16 v[32:47], v[228:231], v[68:71], v[32:47]
    v_mul_f32 v180, v117, v148
    v_fma_f32 v16, v16, v116, -v180
    v_mul_f32 v184, v117, v152
    v_fma_f32 v20, v20, v116, -v184
    v_cvt_pk_bf16_f32 v196, v16, v20
    v_mfma_f32_32x32x16_bf16 v[32:47], v[232:235], v[72:75], v[32:47]
    v_mul_f32 v181, v117, v149
    v_fma_f32 v17, v17, v116, -v181
    v_mul_f32 v185, v117, v153
    v_fma_f32 v21, v21, v116, -v185
    v_cvt_pk_bf16_f32 v197, v17, v21
    v_mfma_f32_32x32x16_bf16 v[32:47], v[236:239], v[76:79], v[32:47]
    v_mul_f32 v182, v117, v150
    v_fma_f32 v18, v18, v116, -v182
    v_mul_f32 v186, v117, v154
    v_fma_f32 v22, v22, v116, -v186
    v_cvt_pk_bf16_f32 v198, v18, v22
    v_mfma_f32_32x32x16_bf16 v[32:47], v[240:243], v[80:83], v[32:47]
    v_mul_f32 v183, v117, v151
    v_fma_f32 v19, v19, v116, -v183
    v_mul_f32 v187, v117, v155
    v_fma_f32 v23, v23, v116, -v187
    v_cvt_pk_bf16_f32 v199, v19, v23
    v_mfma_f32_32x32x16_bf16 v[32:47], v[244:247], v[84:87], v[32:47]
    buffer_store_dwordx4 v[196:199], v13, s[8:11], s46 offen offset:0 sc1
    v_mul_f32 v188, v117, v156
    v_fma_f32 v24, v24, v116, -v188
    v_mul_f32 v192, v117, v160
    v_fma_f32 v28, v28, v116, -v192
    v_mfma_f32_32x32x16_bf16 v[32:47], v[248:251], v[88:91], v[32:47]
    v_cvt_pk_bf16_f32 v200, v24, v28
    v_mul_f32 v189, v117, v157
    v_fma_f32 v25, v25, v116, -v189
    v_mul_f32 v193, v117, v161
    v_fma_f32 v29, v29, v116, -v193
    v_mfma_f32_32x32x16_bf16 v[32:47], v[252:255], v[92:95], v[32:47]
    v_cvt_pk_bf16_f32 v201, v25, v29
    v_mul_f32 v190, v117, v158
    v_fma_f32 v26, v26, v116, -v190
    v_mul_f32 v194, v117, v162
    v_fma_f32 v30, v30, v116, -v194
    v_cvt_pk_bf16_f32 v202, v26, v30
    v_mul_f32 v191, v117, v159
    v_fma_f32 v27, v27, v116, -v191
    v_mul_f32 v195, v117, v163
    v_fma_f32 v31, v31, v116, -v195
    v_cvt_pk_bf16_f32 v203, v27, v31
    buffer_store_dwordx4 v[200:203], v13, s[8:11], s46 offen offset:512 sc1
    v_mul_f32 v180, v117, v164
    v_fma_f32 v32, v32, v116, -v180
    v_mul_f32 v184, v117, v168
    v_fma_f32 v36, v36, v116, -v184
    v_cvt_pk_bf16_f32 v196, v32, v36
    v_mul_f32 v181, v117, v165
    v_fma_f32 v33, v33, v116, -v181
    v_mul_f32 v185, v117, v169
    v_fma_f32 v37, v37, v116, -v185
    v_cvt_pk_bf16_f32 v197, v33, v37
    v_mul_f32 v182, v117, v166
    v_fma_f32 v34, v34, v116, -v182
    v_mul_f32 v186, v117, v170
    v_fma_f32 v38, v38, v116, -v186
    v_cvt_pk_bf16_f32 v198, v34, v38
    v_mul_f32 v183, v117, v167
    v_fma_f32 v35, v35, v116, -v183
    v_mul_f32 v187, v117, v171
    v_fma_f32 v39, v39, v116, -v187
    v_cvt_pk_bf16_f32 v199, v35, v39
    buffer_store_dwordx4 v[196:199], v13, s[8:11], s46 offen offset:2048 sc1
    v_mul_f32 v188, v117, v172
    v_fma_f32 v40, v40, v116, -v188
    v_mul_f32 v192, v117, v176
    v_fma_f32 v44, v44, v116, -v192
    v_cvt_pk_bf16_f32 v200, v40, v44
    v_mul_f32 v189, v117, v173
    v_fma_f32 v41, v41, v116, -v189
    v_mul_f32 v193, v117, v177
    v_fma_f32 v45, v45, v116, -v193
    v_cvt_pk_bf16_f32 v201, v41, v45
    v_mul_f32 v190, v117, v174
    v_fma_f32 v42, v42, v116, -v190
    v_mul_f32 v194, v117, v178
    v_fma_f32 v46, v46, v116, -v194
    v_cvt_pk_bf16_f32 v202, v42, v46
    v_mul_f32 v191, v117, v175
    v_fma_f32 v43, v43, v116, -v191
    v_mul_f32 v195, v117, v179
    v_fma_f32 v47, v47, v116, -v195
    v_cvt_pk_bf16_f32 v203, v43, v47
    buffer_store_dwordx4 v[200:203], v13, s[8:11], s46 offen offset:2560 sc1
    s_mul_i32 s43, s57, 22528
    s_add_u32 s43, s43, s49
    s_cmp_lg_u32 s62, 0
    s_cbranch_scc1 LpQ_item
    buffer_load_dword v2, v1, s[8:11], s42 offen sc1
    s_waitcnt vmcnt(0)
    s_cmp_ge_u32 s37, 64
    s_cbranch_scc1 LpQ_fin
    v_cmp_eq_u32 vcc, 0, v2
    s_nop 0
    s_cbranch_vccnz LpQ_pub
    s_add_u32 m0, s59, 0
    s_add_u32 s47, s41, 0
    buffer_load_dwordx4 v0, s[8:11], s47 offen offset:0 lds
    buffer_load_dwordx4 v0, s[8:11], s47 offen offset:1024 lds
    buffer_load_dwordx4 v0, s[8:11], s47 offen offset:2048 lds
    buffer_load_dwordx4 v0, s[8:11], s47 offen offset:3072 lds
    s_add_u32 m0, s59, 4096
    s_add_u32 s47, s41, 4096
    buffer_load_dwordx4 v0, s[8:11], s47 offen offset:0 lds
    buffer_load_dwordx4 v0, s[8:11], s47 offen offset:1024 lds
    buffer_load_dwordx4 v0, s[8:11], s47 offen offset:2048 lds
    buffer_load_dwordx4 v0, s[8:11], s47 offen offset:3072 lds
    s_add_u32 m0, s59, 8192
    s_add_u32 s47, s41, 8192
    buffer_load_dwordx4 v0, s[8:11], s47 offen offset:0 lds
    s_mul_i32 s48, s36, 786432
    s_mul_i32 s18, s37, 6144
    s_add_u32 s48, s48, s18
    s_add_u32 s48, s48, 16125952
    s_add_u32 m0, s66, 4096
    s_nop 0
    buffer_load_dwordx4 v0, s[8:11], s48 offen lds
    s_add_u32 m0, s66, s67
    s_sub_u32 s48, s48, 4096
    s_add_u32 s48, s48, s67
    buffer_load_dwordx4 v0, s[8:11], s48 offen lds
    s_cmp_lg_u32 s43, 0
    s_cselect_b64 exec, 1, 0
    buffer_store_dwordx2 v[212:213], v4, s[8:11], s43 offen sc1
    s_mov_b64 exec, -1
    s_mov_b32 s43, 0
    s_waitcnt vmcnt(1)
    s_branch LpQ_go
LpQ_fin:
    s_cmp_lg_u32 s43, 0
    s_cselect_b64 exec, 1, 0
    buffer_store_dwordx2 v[212:213], v4, s[8:11], s43 offen sc1
    s_mov_b64 exec, -1
    s_mov_b32 s43, 0
    s_branch L_role_p_exit
LpQ_pub:
    s_cmp_lg_u32 s43, 0
    s_cselect_b64 exec, 1, 0
    buffer_store_dwordx2 v[212:213], v4, s[8:11], s43 offen sc1
    s_mov_b64 exec, -1
    s_mov_b32 s43, 0
LpQ_poll:
    s_mov_b32 s16, 0
LpQ_pl:
    buffer_load_dword v2, v1, s[8:11], s42 offen sc1
    s_add_u32 s16, s16, 1
    s_cmp_gt_u32 s16, 100000
    s_cbranch_scc1 L_role_p_abort
    s_waitcnt vmcnt(0)
    v_cmp_eq_u32 vcc, 0, v2
    s_nop 0
    s_cbranch_vccz LpQ_pld
    s_sleep 4
    s_branch LpQ_pl
LpQ_pld:
    s_add_u32 m0, s59, 0
    s_add_u32 s47, s41, 0
    buffer_load_dwordx4 v0, s[8:11], s47 offen offset:0 lds
    buffer_load_dwordx4 v0, s[8:11], s47 offen offset:1024 lds
    buffer_load_dwordx4 v0, s[8:11], s47 offen offset:2048 lds
    buffer_load_dwordx4 v0, s[8:11], s47 offen offset:3072 lds
    s_add_u32 m0, s59, 4096
    s_add_u32 s47, s41, 4096
    buffer_load_dwordx4 v0, s[8:11], s47 offen offset:0 lds
    buffer_load_dwordx4 v0, s[8:11], s47 offen offset:1024 lds
    buffer_load_dwordx4 v0, s[8:11], s47 offen offset:2048 lds
    buffer_load_dwordx4 v0, s[8:11], s47 offen offset:3072 lds
    s_add_u32 m0, s59, 8192
    s_add_u32 s47, s41, 8192
    buffer_load_dwordx4 v0, s[8:11], s47 offen offset:0 lds
    s_mul_i32 s48, s36, 786432
    s_mul_i32 s18, s37, 6144
    s_add_u32 s48, s48, s18
    s_add_u32 s48, s48, 16125952
    s_add_u32 m0, s66, 4096
    s_nop 0
    buffer_load_dwordx4 v0, s[8:11], s48 offen lds
    s_add_u32 m0, s66, s67
    s_sub_u32 s48, s48, 4096
    s_add_u32 s48, s48, s67
    buffer_load_dwordx4 v0, s[8:11], s48 offen lds
    s_waitcnt vmcnt(0)
    s_branch LpQ_go
Lp_v:
    v_mfma_f32_32x32x16_bf16 v[16:31], v[48:51], a[0:3], 0
    v_mfma_f32_32x32x16_bf16 v[16:31], v[48:51], a[4:7], v[16:31]
    v_mfma_f32_32x32x16_bf16 v[16:31], v[48:51], a[8:11], v[16:31]
    v_mfma_f32_32x32x16_bf16 v[16:31], v[48:51], a[12:15], v[16:31]
    v_mfma_f32_32x32x16_bf16 v[16:31], v[48:51], a[16:19], v[16:31]
    v_mfma_f32_32x32x16_bf16 v[16:31], v[48:51], a[20:23], v[16:31]
    v_mfma_f32_32x32x16_bf16 v[16:31], v[48:51], a[24:27], v[16:31]
    v_mfma_f32_32x32x16_bf16 v[16:31], v[48:51], a[28:31], v[16:31]
    v_mfma_f32_32x32x16_bf16 v[16:31], v[48:51], a[32:35], v[16:31]
    v_mfma_f32_32x32x16_bf16 v[16:31], v[48:51], a[36:39], v[16:31]
    v_mfma_f32_32x32x16_bf16 v[16:31], v[48:51], a[40:43], v[16:31]
    v_mfma_f32_32x32x16_bf16 v[16:31], v[48:51], a[44:47], v[16:31]
    v_mfma_f32_32x32x16_bf16 v[16:31], v[48:51], a[48:51], v[16:31]
    v_mfma_f32_32x32x16_bf16 v[16:31], v[48:51], a[52:55], v[16:31]
    v_mfma_f32_32x32x16_bf16 v[16:31], v[48:51], a[56:59], v[16:31]
    v_mfma_f32_32x32x16_bf16 v[16:31], v[48:51], a[60:63], v[16:31]
    v_mfma_f32_32x32x16_bf16 v[16:31], v[48:51], a[64:67], v[16:31]
    v_mfma_f32_32x32x16_bf16 v[16:31], v[48:51], a[68:71], v[16:31]
    v_mfma_f32_32x32x16_bf16 v[16:31], v[48:51], a[72:75], v[16:31]
    v_mfma_f32_32x32x16_bf16 v[16:31], v[48:51], a[76:79], v[16:31]
    v_mfma_f32_32x32x16_bf16 v[16:31], v[48:51], a[80:83], v[16:31]
    v_mfma_f32_32x32x16_bf16 v[16:31], v[48:51], a[84:87], v[16:31]
    v_mfma_f32_32x32x16_bf16 v[16:31], v[48:51], a[88:91], v[16:31]
    v_mfma_f32_32x32x16_bf16 v[16:31], v[48:51], a[92:95], v[16:31]
    v_mfma_f32_32x32x16_bf16 v[16:31], v[48:51], a[96:99], v[16:31]
    v_mfma_f32_32x32x16_bf16 v[16:31], v[48:51], a[100:103], v[16:31]
    v_mfma_f32_32x32x16_bf16 v[16:31], v[48:51], a[104:107], v[16:31]
    v_mfma_f32_32x32x16_bf16 v[16:31], v[48:51], a[108:111], v[16:31]
    v_mfma_f32_32x32x16_bf16 v[16:31], v[48:51], a[112:115], v[16:31]
    v_mfma_f32_32x32x16_bf16 v[16:31], v[48:51], a[116:119], v[16:31]
    v_mfma_f32_32x32x16_bf16 v[16:31], v[48:51], a[120:123], v[16:31]
    v_mfma_f32_32x32x16_bf16 v[16:31], v[48:51], a[124:127], v[16:31]
    v_mfma_f32_32x32x16_bf16 v[16:31], v[48:51], a[128:131], v[16:31]
    v_mfma_f32_32x32x16_bf16 v[16:31], v[48:51], a[132:135], v[16:31]
    v_mfma_f32_32x32x16_bf16 v[16:31], v[48:51], a[136:139], v[16:31]
    v_mfma_f32_32x32x16_bf16 v[16:31], v[48:51], a[140:143], v[16:31]
    v_mfma_f32_32x32x16_bf16 v[32:47], v[48:51], a[144:147], 0
    v_mfma_f32_32x32x16_bf16 v[32:47], v[48:51], a[148:151], v[32:47]
    v_mfma_f32_32x32x16_bf16 v[32:47], v[48:51], a[152:155], v[32:47]
    v_mfma_f32_32x32x16_bf16 v[32:47], v[48:51], a[156:159], v[32:47]
    v_mfma_f32_32x32x16_bf16 v[32:47], v[48:51], a[160:163], v[32:47]
    v_mfma_f32_32x32x16_bf16 v[32:47], v[48:51], a[164:167], v[32:47]
    v_mfma_f32_32x32x16_bf16 v[32:47], v[48:51], a[168:171], v[32:47]
    v_mfma_f32_32x32x16_bf16 v[32:47], v[48:51], a[172:175], v[32:47]
    v_mfma_f32_32x32x16_bf16 v[32:47], v[48:51], a[176:179], v[32:47]
    v_mfma_f32_32x32x16_bf16 v[32:47], v[48:51], a[180:183], v[32:47]
    v_mfma_f32_32x32x16_bf16 v[32:47], v[48:51], a[184:187], v[32:47]
    v_mfma_f32_32x32x16_bf16 v[32:47], v[48:51], a[188:191], v[32:47]
    v_mfma_f32_32x32x16_bf16 v[32:47], v[48:51], a[192:195], v[32:47]
    v_mfma_f32_32x32x16_bf16 v[32:47], v[48:51], a[196:199], v[32:47]
    v_mfma_f32_32x32x16_bf16 v[32:47], v[48:51], a[200:203], v[32:47]
    v_mfma_f32_32x32x16_bf16 v[32:47], v[48:51], a[204:207], v[32:47]
    v_mfma_f32_32x32x16_bf16 v[32:47], v[48:51], a[208:211], v[32:47]
    v_mfma_f32_32x32x16_bf16 v[32:47], v[48:51], a[212:215], v[32:47]
    v_mfma_f32_32x32x16_bf16 v[32:47], v[48:51], a[216:219], v[32:47]
    v_mfma_f32_32x32x16_bf16 v[32:47], v[48:51], a[220:223], v[32:47]
    v_mfma_f32_32x32x16_bf16 v[32:47], v[48:51], a[224:227], v[32:47]
    v_mfma_f32_32x32x16_bf16 v[32:47], v[48:51], a[228:231], v[32:47]
    v_mfma_f32_32x32x16_bf16 v[32:47], v[48:51], a[232:235], v[32:47]
    v_mfma_f32_32x32x16_bf16 v[32:47], v[48:51], a[236:239], v[32:47]
    v_mfma_f32_32x32x16_bf16 v[32:47], v[48:51], a[240:243], v[32:47]
    v_mfma_f32_32x32x16_bf16 v[32:47], v[48:51], a[244:247], v[32:47]
    v_mfma_f32_32x32x16_bf16 v[32:47], v[48:51], a[248:251], v[32:47]
    v_mfma_f32_32x32x16_bf16 v[32:47], v[48:51], a[252:255], v[32:47]
    v_mfma_f32_32x32x16_bf16 v[32:47], v[48:51], v[224:227], v[32:47]
    v_mfma_f32_32x32x16_bf16 v[32:47], v[48:51], v[228:231], v[32:47]
    v_mfma_f32_32x32x16_bf16 v[32:47], v[48:51], v[232:235], v[32:47]
    v_mfma_f32_32x32x16_bf16 v[32:47], v[48:51], v[236:239], v[32:47]
    v_mfma_f32_32x32x16_bf16 v[32:47], v[48:51], v[240:243], v[32:47]
    v_mfma_f32_32x32x16_bf16 v[32:47], v[48:51], v[244:247], v[32:47]
    v_mfma_f32_32x32x16_bf16 v[32:47], v[48:51], v[248:251], v[32:47]
    v_mfma_f32_32x32x16_bf16 v[32:47], v[48:51], v[252:255], v[32:47]
    v_mov_b32 v11, v16
    s_nop 10
    v_mov_b32 v12, v32
    s_mov_b32 s66, 114688
    s_mov_b32 s71, 0x2000
    s_mov_b32 s36, s63
    s_mov_b32 s34, s63
    s_mov_b32 s37, 0
    s_lshl_b32 s56, s63, 6
    s_mul_i32 s58, s14, 9216
    s_mov_b32 s40, 36864
    s_mov_b32 s59, s58
    s_mov_b32 s43, 0
    s_mov_b32 s28, s8
    s_mov_b32 s29, s9
    s_mov_b32 s30, 0
    s_mov_b32 s31, 0x00020000
    s_mul_i32 s41, s63, 4718592
    s_add_u32 s41, s41, s58
    s_add_u32 s41, s41, 8650752
    s_mul_i32 s42, s56, 22528
    s_add_u32 s42, s42, 183808
    s_cmp_lg_u32 s14, 0
    s_cbranch_scc1 LpV_ini_d
    v_mov_b32 v5, 160
    s_mov_b32 s16, 0
LpV_ini:
    global_load_dword v6, v5, s[12:13] sc1
    s_add_u32 s16, s16, 1
    s_cmp_gt_u32 s16, 100000
    s_cbranch_scc1 L_role_p_abort
    s_waitcnt vmcnt(0)
    v_cmp_gt_u32 vcc, 123, v6
    s_nop 0
    s_cbranch_vccz LpV_ini_d
    s_sleep 8
    s_branch LpV_ini
LpV_ini_d:
    s_barrier
    s_branch LpV_poll
LpV_item:
    s_waitcnt vmcnt(4)
LpV_go:
    s_barrier
    s_xor_b32 s40, s40, 36864
    s_xor_b32 s59, s59, 36864
    s_xor_b32 s66, s66, 0x2000
    s_xor_b32 s71, s71, 0x2000
    s_mov_b32 s35, s37
    s_mov_b32 s57, s56
    s_add_u32 s37, s37, 1
    s_add_u32 s56, s56, 1
    s_add_u32 s41, s41, 36864
    s_add_u32 s42, s42, 22528
    s_mov_b32 s62, 0
    v_add_u32 v9, s40, v0
    v_add_u32 v5, s71, v10
    ds_read_b128 v[48:51], v9 offset:0
    ds_read_b128 v[52:55], v9 offset:1024
    ds_read_b128 v[56:59], v9 offset:2048
    s_waitcnt lgkmcnt(2)
    v_mfma_f32_32x32x16_bf16 v[16:31], v[48:51], a[0:3], 0
    ds_read_b128 v[60:63], v9 offset:3072
    ds_read_b128 v[96:99], v5 offset:0
    ds_read_b128 v[100:103], v5 offset:512
    s_waitcnt lgkmcnt(4)
    v_mfma_f32_32x32x16_bf16 v[16:31], v[52:55], a[4:7], v[16:31]
    ds_read_b128 v[64:67], v9 offset:4096
    ds_read_b128 v[104:107], v5 offset:1024
    ds_read_b128 v[108:111], v5 offset:1536
    s_waitcnt lgkmcnt(6)
    v_mfma_f32_32x32x16_bf16 v[16:31], v[56:59], a[8:11], v[16:31]
    ds_read_b128 v[68:71], v9 offset:5120
    ds_read_b128 v[112:115], v5 offset:2048
    s_waitcnt lgkmcnt(7)
    v_mfma_f32_32x32x16_bf16 v[16:31], v[60:63], a[12:15], v[16:31]
    ds_read_b128 v[72:75], v9 offset:6144
    s_waitcnt lgkmcnt(6)
    v_add_f32 v96, v96, v100
    s_waitcnt lgkmcnt(5)
    v_mfma_f32_32x32x16_bf16 v[16:31], v[64:67], a[16:19], v[16:31]
    ds_read_b128 v[76:79], v9 offset:7168
    v_add_f32 v97, v97, v101
    v_add_f32 v98, v98, v102
    s_waitcnt lgkmcnt(3)
    v_mfma_f32_32x32x16_bf16 v[16:31], v[68:71], a[20:23], v[16:31]
    ds_read_b128 v[80:83], v9 offset:8192
    v_add_f32 v99, v99, v103
    v_add_f32 v96, v96, v104
    s_waitcnt lgkmcnt(2)
    v_mfma_f32_32x32x16_bf16 v[16:31], v[72:75], a[24:27], v[16:31]
    ds_read_b128 v[84:87], v9 offset:9216
    v_add_f32 v97, v97, v105
    v_add_f32 v98, v98, v106
    s_waitcnt lgkmcnt(2)
    v_mfma_f32_32x32x16_bf16 v[16:31], v[76:79], a[28:31], v[16:31]
    ds_read_b128 v[88:91], v9 offset:10240
    v_add_f32 v99, v99, v107
    v_add_f32 v96, v96, v108
    s_waitcnt lgkmcnt(2)
    v_mfma_f32_32x32x16_bf16 v[16:31], v[80:83], a[32:35], v[16:31]
    ds_read_b128 v[92:95], v9 offset:11264
    v_add_f32 v97, v97, v109
    v_add_f32 v98, v98, v110
    v_mfma_f32_32x32x16_bf16 v[32:47], v[48:51], a[144:147], 0
    v_add_f32 v99, v99, v111
    v_add_f32 v96, v96, v112
    s_waitcnt lgkmcnt(2)
    v_mfma_f32_32x32x16_bf16 v[16:31], v[84:87], a[36:39], v[16:31]
    ds_read_b128 v[48:51], v9 offset:12288
    v_add_f32 v97, v97, v113
    v_add_f32 v98, v98, v114
    v_mfma_f32_32x32x16_bf16 v[32:47], v[52:55], a[148:151], v[32:47]
    v_add_f32 v99, v99, v115
    v_add_f32 v96, v96, v98
    s_waitcnt lgkmcnt(2)
    v_mfma_f32_32x32x16_bf16 v[16:31], v[88:91], a[40:43], v[16:31]
    ds_read_b128 v[52:55], v9 offset:13312
    v_add_f32 v97, v97, v99
    v_mov_b32 v98, v96
    v_mfma_f32_32x32x16_bf16 v[32:47], v[56:59], a[152:155], v[32:47]
    v_mov_b32 v99, v97
    v_permlane32_swap_b32 v96, v98
    s_waitcnt lgkmcnt(2)
    v_mfma_f32_32x32x16_bf16 v[16:31], v[92:95], a[44:47], v[16:31]
    ds_read_b128 v[56:59], v9 offset:14336
    v_permlane32_swap_b32 v97, v99
    v_add_f32 v96, v96, v98
    v_mfma_f32_32x32x16_bf16 v[32:47], v[60:63], a[156:159], v[32:47]
    v_add_f32 v97, v97, v99
    v_mul_f32 v96, 0x3ae38e39, v96
    s_waitcnt lgkmcnt(2)
    v_mfma_f32_32x32x16_bf16 v[16:31], v[48:51], a[48:51], v[16:31]
    ds_read_b128 v[60:63], v9 offset:15360
    v_mul_f32 v97, 0x3ae38e39, v97
    v_fma_f32 v97, -v96, v96, v97
    v_mfma_f32_32x32x16_bf16 v[32:47], v[64:67], a[160:163], v[32:47]
    v_max_f32 v97, 0, v97
    v_add_f32 v97, 0x3727c5ac, v97
    s_waitcnt lgkmcnt(2)
    v_mfma_f32_32x32x16_bf16 v[16:31], v[52:55], a[52:55], v[16:31]
    ds_read_b128 v[64:67], v9 offset:16384
    v_rsq_f32 v116, v97
    s_nop 0
    v_mul_f32 v117, v96, v116
    v_mfma_f32_32x32x16_bf16 v[32:47], v[68:71], a[164:167], v[32:47]
    ds_write2_b32 v14, v116, v117 offset0:0 offset1:32
    ds_read_b128 v[116:119], v214 offset:0
    s_waitcnt lgkmcnt(4)
    v_mfma_f32_32x32x16_bf16 v[16:31], v[56:59], a[56:59], v[16:31]
    ds_read_b128 v[68:71], v9 offset:17408
    s_waitcnt vmcnt(0)
    buffer_load_dword v2, v1, s[8:11], s42 offen sc1
    s_cmp_lg_u32 s43, 0
    s_cselect_b64 exec, 1, 0
    buffer_store_dwordx2 v[212:213], v4, s[8:11], s43 offen sc1
    s_mov_b64 exec, -1
    s_mov_b32 s43, 0
    v_mfma_f32_32x32x16_bf16 v[32:47], v[72:75], a[168:171], v[32:47]
    ds_read_b128 v[120:123], v214 offset:32
    ds_read_b128 v[124:127], v214 offset:64
    s_waitcnt lgkmcnt(6)
    v_mfma_f32_32x32x16_bf16 v[16:31], v[60:63], a[60:63], v[16:31]
    ds_read_b128 v[72:75], v9 offset:18432
    ds_read_b128 v[128:131], v214 offset:96
    ds_read_b128 v[132:135], v214 offset:128
    v_mfma_f32_32x32x16_bf16 v[32:47], v[76:79], a[172:175], v[32:47]
    ds_read_b128 v[136:139], v214 offset:160
    ds_read_b128 v[140:143], v214 offset:192
    s_waitcnt lgkmcnt(10)
    v_mfma_f32_32x32x16_bf16 v[16:31], v[64:67], a[64:67], v[16:31]
    ds_read_b128 v[76:79], v9 offset:19456
    ds_read_b128 v[144:147], v214 offset:224
    s_mul_i32 s46, s34, 50331648
    v_mfma_f32_32x32x16_bf16 v[32:47], v[80:83], a[176:179], v[32:47]
    s_lshl_b32 s19, s35, 18
    s_add_u32 s46, s46, s19
    s_waitcnt lgkmcnt(9)
    v_mfma_f32_32x32x16_bf16 v[16:31], v[68:71], a[68:71], v[16:31]
    ds_read_b128 v[80:83], v9 offset:20480
    s_add_u32 s46, s46, s52
    v_mfma_f32_32x32x16_bf16 v[32:47], v[84:87], a[180:183], v[32:47]
    s_waitcnt lgkmcnt(7)
    v_mfma_f32_32x32x16_bf16 v[16:31], v[72:75], a[72:75], v[16:31]
    ds_read_b128 v[84:87], v9 offset:21504
    v_mfma_f32_32x32x16_bf16 v[32:47], v[88:91], a[184:187], v[32:47]
    s_waitcnt lgkmcnt(3)
    v_mfma_f32_32x32x16_bf16 v[16:31], v[76:79], a[76:79], v[16:31]
    ds_read_b128 v[88:91], v9 offset:22528
    v_mfma_f32_32x32x16_bf16 v[32:47], v[92:95], a[188:191], v[32:47]
    s_waitcnt lgkmcnt(2)
    v_mfma_f32_32x32x16_bf16 v[16:31], v[80:83], a[80:83], v[16:31]
    ds_read_b128 v[92:95], v9 offset:23552
    v_mfma_f32_32x32x16_bf16 v[32:47], v[48:51], a[192:195], v[32:47]
    s_waitcnt lgkmcnt(2)
    v_mfma_f32_32x32x16_bf16 v[16:31], v[84:87], a[84:87], v[16:31]
    ds_read_b128 v[48:51], v9 offset:24576
    v_mfma_f32_32x32x16_bf16 v[32:47], v[52:55], a[196:199], v[32:47]
    s_waitcnt lgkmcnt(2)
    v_mfma_f32_32x32x16_bf16 v[16:31], v[88:91], a[88:91], v[16:31]
    ds_read_b128 v[52:55], v9 offset:25600
    v_mfma_f32_32x32x16_bf16 v[32:47], v[56:59], a[200:203], v[32:47]
    s_waitcnt lgkmcnt(2)
    v_mfma_f32_32x32x16_bf16 v[16:31], v[92:95], a[92:95], v[16:31]
    ds_read_b128 v[56:59], v9 offset:26624
    v_mfma_f32_32x32x16_bf16 v[32:47], v[60:63], a[204:207], v[32:47]
    s_waitcnt lgkmcnt(2)
    v_mfma_f32_32x32x16_bf16 v[16:31], v[48:51], a[96:99], v[16:31]
    ds_read_b128 v[60:63], v9 offset:27648
    v_mfma_f32_32x32x16_bf16 v[32:47], v[64:67], a[208:211], v[32:47]
    s_waitcnt lgkmcnt(2)
    v_mfma_f32_32x32x16_bf16 v[16:31], v[52:55], a[100:103], v[16:31]
    ds_read_b128 v[64:67], v9 offset:28672
    s_waitcnt vmcnt(1)
    v_cmp_eq_u32 vcc, 0, v2
    s_nop 0
    s_cmp_eq_u64 vcc, 0
    s_cselect_b32 s62, 1, 0
    s_cmp_lt_u32 s37, 64
    s_cselect_b32 s62, s62, 0
    s_cmp_lg_u32 s62, 0
    s_cselect_b32 s30, 268435456, 0
    v_mfma_f32_32x32x16_bf16 v[32:47], v[68:71], a[212:215], v[32:47]
    s_waitcnt lgkmcnt(2)
    v_mfma_f32_32x32x16_bf16 v[16:31], v[56:59], a[104:107], v[16:31]
    ds_read_b128 v[68:71], v9 offset:29696
    s_add_u32 m0, s59, 0
    s_add_u32 s47, s41, 0
    buffer_load_dwordx4 v0, s[28:31], s47 offen offset:0 lds
    v_mfma_f32_32x32x16_bf16 v[32:47], v[72:75], a[216:219], v[32:47]
    s_waitcnt lgkmcnt(2)
    v_mfma_f32_32x32x16_bf16 v[16:31], v[60:63], a[108:111], v[16:31]
    ds_read_b128 v[72:75], v9 offset:30720
    buffer_load_dwordx4 v0, s[28:31], s47 offen offset:1024 lds
    v_mfma_f32_32x32x16_bf16 v[32:47], v[76:79], a[220:223], v[32:47]
    s_waitcnt lgkmcnt(2)
    v_mfma_f32_32x32x16_bf16 v[16:31], v[64:67], a[112:115], v[16:31]
    ds_read_b128 v[76:79], v9 offset:31744
    buffer_load_dwordx4 v0, s[28:31], s47 offen offset:2048 lds
    v_mfma_f32_32x32x16_bf16 v[32:47], v[80:83], a[224:227], v[32:47]
    s_waitcnt lgkmcnt(2)
    v_mfma_f32_32x32x16_bf16 v[16:31], v[68:71], a[116:119], v[16:31]
    ds_read_b128 v[80:83], v9 offset:32768
    buffer_load_dwordx4 v0, s[28:31], s47 offen offset:3072 lds
    v_mfma_f32_32x32x16_bf16 v[32:47], v[84:87], a[228:231], v[32:47]
    s_waitcnt lgkmcnt(2)
    v_mfma_f32_32x32x16_bf16 v[16:31], v[72:75], a[120:123], v[16:31]
    ds_read_b128 v[84:87], v9 offset:33792
    s_add_u32 m0, s59, 4096
    s_add_u32 s47, s41, 4096
    buffer_load_dwordx4 v0, s[28:31], s47 offen offset:0 lds
    v_mfma_f32_32x32x16_bf16 v[32:47], v[88:91], a[232:235], v[32:47]
    s_waitcnt lgkmcnt(2)
    v_mfma_f32_32x32x16_bf16 v[16:31], v[76:79], a[124:127], v[16:31]
    ds_read_b128 v[88:91], v9 offset:34816
    buffer_load_dwordx4 v0, s[28:31], s47 offen offset:1024 lds
    v_mfma_f32_32x32x16_bf16 v[32:47], v[92:95], a[236:239], v[32:47]
    s_waitcnt lgkmcnt(2)
    v_mfma_f32_32x32x16_bf16 v[16:31], v[80:83], a[128:131], v[16:31]
    ds_read_b128 v[92:95], v9 offset:35840
    buffer_load_dwordx4 v0, s[28:31], s47 offen offset:2048 lds
    v_mfma_f32_32x32x16_bf16 v[32:47], v[48:51], a[240:243], v[32:47]
    s_waitcnt lgkmcnt(2)
    v_mfma_f32_32x32x16_bf16 v[16:31], v[84:87], a[132:135], v[16:31]
    buffer_load_dwordx4 v0, s[28:31], s47 offen offset:3072 lds
    v_mfma_f32_32x32x16_bf16 v[32:47], v[52:55], a[244:247], v[32:47]
    s_waitcnt lgkmcnt(1)
    v_mfma_f32_32x32x16_bf16 v[16:31], v[88:91], a[136:139], v[16:31]
    s_add_u32 m0, s59, 8192
    s_add_u32 s47, s41, 8192
    buffer_load_dwordx4 v0, s[28:31], s47 offen offset:0 lds
    v_mfma_f32_32x32x16_bf16 v[32:47], v[56:59], a[248:251], v[32:47]
    s_waitcnt lgkmcnt(0)
    v_mfma_f32_32x32x16_bf16 v[16:31], v[92:95], a[140:143], v[16:31]
    s_mul_i32 s48, s36, 786432
    s_mul_i32 s18, s37, 6144
    s_add_u32 s48, s48, s18
    s_add_u32 s48, s48, 16125952
    s_add_u32 m0, s66, 4096
    s_nop 0
    buffer_load_dwordx4 v0, s[28:31], s48 offen lds
    v_mfma_f32_32x32x16_bf16 v[32:47], v[60:63], a[252:255], v[32:47]
    v_mfma_f32_32x32x16_bf16 v[32:47], v[64:67], v[224:227], v[32:47]
    s_add_u32 m0, s66, s67
    s_sub_u32 s48, s48, 4096
    s_add_u32 s48, s48, s67
    buffer_load_dwordx4 v0, s[28:31], s48 offen lds
    v_mfma_f32_32x32x16_bf16 v[32:47], v[68:71], v[228:231], v[32:47]
    v_mul_f32 v180, v11, v132
    v_fma_f32 v16, v16, v116, -v180
    v_mul_f32 v181, v11, v133
    v_fma_f32 v17, v17, v117, -v181
    v_cvt_pk_bf16_f32 v196, v16, v17
    v_mfma_f32_32x32x16_bf16 v[32:47], v[72:75], v[232:235], v[32:47]
    v_mul_f32 v182, v11, v134
    v_fma_f32 v18, v18, v118, -v182
    v_mul_f32 v183, v11, v135
    v_fma_f32 v19, v19, v119, -v183
    v_cvt_pk_bf16_f32 v197, v18, v19
    v_mfma_f32_32x32x16_bf16 v[32:47], v[76:79], v[236:239], v[32:47]
    v_mul_f32 v188, v11, v140
    v_fma_f32 v24, v24, v124, -v188
    v_mul_f32 v189, v11, v141
    v_fma_f32 v25, v25, v125, -v189
    v_cvt_pk_bf16_f32 v198, v24, v25
    v_mfma_f32_32x32x16_bf16 v[32:47], v[80:83], v[240:243], v[32:47]
    v_mul_f32 v190, v11, v142
    v_fma_f32 v26, v26, v126, -v190
    v_mul_f32 v191, v11, v143
    v_fma_f32 v27, v27, v127, -v191
    v_cvt_pk_bf16_f32 v199, v26, v27
    v_mfma_f32_32x32x16_bf16 v[32:47], v[84:87], v[244:247], v[32:47]
    buffer_store_dwordx4 v[196:199], v13, s[8:11], s46 offen offset:0 sc1
    v_mul_f32 v184, v11, v136
    v_fma_f32 v20, v20, v120, -v184
    v_mul_f32 v185, v11, v137
    v_fma_f32 v21, v21, v121, -v185
    v_mfma_f32_32x32x16_bf16 v[32:47], v[88:91], v[248:251], v[32:47]
    v_cvt_pk_bf16_f32 v200, v20, v21
    v_mul_f32 v186, v11, v138
    v_fma_f32 v22, v22, v122, -v186
    v_mul_f32 v187, v11, v139
    v_fma_f32 v23, v23, v123, -v187
    v_mfma_f32_32x32x16_bf16 v[32:47], v[92:95], v[252:255], v[32:47]
    v_cvt_pk_bf16_f32 v201, v22, v23
    v_mul_f32 v192, v11, v144
    v_fma_f32 v28, v28, v128, -v192
    v_mul_f32 v193, v11, v145
    v_fma_f32 v29, v29, v129, -v193
    v_cvt_pk_bf16_f32 v202, v28, v29
    v_mul_f32 v194, v11, v146
    v_fma_f32 v30, v30, v130, -v194
    v_mul_f32 v195, v11, v147
    v_fma_f32 v31, v31, v131, -v195
    v_cvt_pk_bf16_f32 v203, v30, v31
    buffer_store_dwordx4 v[200:203], v13, s[8:11], s46 offen offset:512 sc1
    v_mul_f32 v180, v12, v132
    v_fma_f32 v32, v32, v116, -v180
    v_mul_f32 v181, v12, v133
    v_fma_f32 v33, v33, v117, -v181
    v_cvt_pk_bf16_f32 v196, v32, v33
    v_mul_f32 v182, v12, v134
    v_fma_f32 v34, v34, v118, -v182
    v_mul_f32 v183, v12, v135
    v_fma_f32 v35, v35, v119, -v183
    v_cvt_pk_bf16_f32 v197, v34, v35
    v_mul_f32 v188, v12, v140
    v_fma_f32 v40, v40, v124, -v188
    v_mul_f32 v189, v12, v141
    v_fma_f32 v41, v41, v125, -v189
    v_cvt_pk_bf16_f32 v198, v40, v41
    v_mul_f32 v190, v12, v142
    v_fma_f32 v42, v42, v126, -v190
    v_mul_f32 v191, v12, v143
    v_fma_f32 v43, v43, v127, -v191
    v_cvt_pk_bf16_f32 v199, v42, v43
    buffer_store_dwordx4 v[196:199], v13, s[8:11], s46 offen offset:2048 sc1
    v_mul_f32 v184, v12, v136
    v_fma_f32 v36, v36, v120, -v184
    v_mul_f32 v185, v12, v137
    v_fma_f32 v37, v37, v121, -v185
    v_cvt_pk_bf16_f32 v200, v36, v37
    v_mul_f32 v186, v12, v138
    v_fma_f32 v38, v38, v122, -v186
    v_mul_f32 v187, v12, v139
    v_fma_f32 v39, v39, v123, -v187
    v_cvt_pk_bf16_f32 v201, v38, v39
    v_mul_f32 v192, v12, v144
    v_fma_f32 v44, v44, v128, -v192
    v_mul_f32 v193, v12, v145
    v_fma_f32 v45, v45, v129, -v193
    v_cvt_pk_bf16_f32 v202, v44, v45
    v_mul_f32 v194, v12, v146
    v_fma_f32 v46, v46, v130, -v194
    v_mul_f32 v195, v12, v147
    v_fma_f32 v47, v47, v131, -v195
    v_cvt_pk_bf16_f32 v203, v46, v47
    buffer_store_dwordx4 v[200:203], v13, s[8:11], s46 offen offset:2560 sc1
    s_mul_i32 s43, s57, 22528
    s_add_u32 s43, s43, s49
    s_cmp_lg_u32 s62, 0
    s_cbranch_scc1 LpV_item
    buffer_load_dword v2, v1, s[8:11], s42 offen sc1
    s_waitcnt vmcnt(0)
    s_cmp_ge_u32 s37, 64
    s_cbranch_scc1 LpV_fin
    v_cmp_eq_u32 vcc, 0, v2
    s_nop 0
    s_cbranch_vccnz LpV_pub
    s_add_u32 m0, s59, 0
    s_add_u32 s47, s41, 0
    buffer_load_dwordx4 v0, s[8:11], s47 offen offset:0 lds
    buffer_load_dwordx4 v0, s[8:11], s47 offen offset:1024 lds
    buffer_load_dwordx4 v0, s[8:11], s47 offen offset:2048 lds
    buffer_load_dwordx4 v0, s[8:11], s47 offen offset:3072 lds
    s_add_u32 m0, s59, 4096
    s_add_u32 s47, s41, 4096
    buffer_load_dwordx4 v0, s[8:11], s47 offen offset:0 lds
    buffer_load_dwordx4 v0, s[8:11], s47 offen offset:1024 lds
    buffer_load_dwordx4 v0, s[8:11], s47 offen offset:2048 lds
    buffer_load_dwordx4 v0, s[8:11], s47 offen offset:3072 lds
    s_add_u32 m0, s59, 8192
    s_add_u32 s47, s41, 8192
    buffer_load_dwordx4 v0, s[8:11], s47 offen offset:0 lds
    s_mul_i32 s48, s36, 786432
    s_mul_i32 s18, s37, 6144
    s_add_u32 s48, s48, s18
    s_add_u32 s48, s48, 16125952
    s_add_u32 m0, s66, 4096
    s_nop 0
    buffer_load_dwordx4 v0, s[8:11], s48 offen lds
    s_add_u32 m0, s66, s67
    s_sub_u32 s48, s48, 4096
    s_add_u32 s48, s48, s67
    buffer_load_dwordx4 v0, s[8:11], s48 offen lds
    s_cmp_lg_u32 s43, 0
    s_cselect_b64 exec, 1, 0
    buffer_store_dwordx2 v[212:213], v4, s[8:11], s43 offen sc1
    s_mov_b64 exec, -1
    s_mov_b32 s43, 0
    s_waitcnt vmcnt(1)
    s_branch LpV_go
LpV_fin:
    s_cmp_lg_u32 s43, 0
    s_cselect_b64 exec, 1, 0
    buffer_store_dwordx2 v[212:213], v4, s[8:11], s43 offen sc1
    s_mov_b64 exec, -1
    s_mov_b32 s43, 0
    s_branch L_role_p_exit
LpV_pub:
    s_cmp_lg_u32 s43, 0
    s_cselect_b64 exec, 1, 0
    buffer_store_dwordx2 v[212:213], v4, s[8:11], s43 offen sc1
    s_mov_b64 exec, -1
    s_mov_b32 s43, 0
LpV_poll:
    s_mov_b32 s16, 0
LpV_pl:
    buffer_load_dword v2, v1, s[8:11], s42 offen sc1
    s_add_u32 s16, s16, 1
    s_cmp_gt_u32 s16, 100000
    s_cbranch_scc1 L_role_p_abort
    s_waitcnt vmcnt(0)
    v_cmp_eq_u32 vcc, 0, v2
    s_nop 0
    s_cbranch_vccz LpV_pld
    s_sleep 4
    s_branch LpV_pl
LpV_pld:
    s_add_u32 m0, s59, 0
    s_add_u32 s47, s41, 0
    buffer_load_dwordx4 v0, s[8:11], s47 offen offset:0 lds
    buffer_load_dwordx4 v0, s[8:11], s47 offen offset:1024 lds
    buffer_load_dwordx4 v0, s[8:11], s47 offen offset:2048 lds
    buffer_load_dwordx4 v0, s[8:11], s47 offen offset:3072 lds
    s_add_u32 m0, s59, 4096
    s_add_u32 s47, s41, 4096
    buffer_load_dwordx4 v0, s[8:11], s47 offen offset:0 lds
    buffer_load_dwordx4 v0, s[8:11], s47 offen offset:1024 lds
    buffer_load_dwordx4 v0, s[8:11], s47 offen offset:2048 lds
    buffer_load_dwordx4 v0, s[8:11], s47 offen offset:3072 lds
    s_add_u32 m0, s59, 8192
    s_add_u32 s47, s41, 8192
    buffer_load_dwordx4 v0, s[8:11], s47 offen offset:0 lds
    s_mul_i32 s48, s36, 786432
    s_mul_i32 s18, s37, 6144
    s_add_u32 s48, s48, s18
    s_add_u32 s48, s48, 16125952
    s_add_u32 m0, s66, 4096
    s_nop 0
    buffer_load_dwordx4 v0, s[8:11], s48 offen lds
    s_add_u32 m0, s66, s67
    s_sub_u32 s48, s48, 4096
    s_add_u32 s48, s48, s67
    buffer_load_dwordx4 v0, s[8:11], s48 offen lds
    s_waitcnt vmcnt(0)
    s_branch LpV_go
L_role_p_abort:
    s_waitcnt lgkmcnt(0)
    s_mov_b64 exec, -1
    v_mov_b32 v0, 60
    s_lshl_b32 s5, s3, 8
    s_or_b32 s5, s5, s4
    s_or_b32 s5, s5, 0x10000
    v_mov_b32 v1, s5
    global_store_dword v0, v1, s[12:13]
    s_endpgm
L_role_p_exit:
    s_cmp_lg_u32 s63, 0
    s_cbranch_scc1 L_p_end
    s_cmp_ge_u32 s15, 24
    s_cbranch_scc1 L_p_end
    s_add_u32 s15, s15, 36
    v_lshrrev_b32 v0, 4, v0
    s_waitcnt vmcnt(0) lgkmcnt(0)
    s_barrier
    s_branch L_role_tw
L_p_end:
    s_endpgm
.p2align 6
L_role_tw:
    v_and_b32 v5, 63, v0
    v_lshlrev_b32 v0, 4, v5
    v_and_b32 v7, 15, v5
    v_lshrrev_b32 v8, 4, v5
    v_min_u32 v1, 31, v5
    v_lshrrev_b32 v6, 2, v1
    v_and_b32 v1, 3, v1
    v_lshlrev_b32 v1, 2, v1
    v_lshl_add_u32 v1, v6, 7, v1
    v_mov_b32 v3, 1
    v_mov_b32 v4, 0
    s_mov_b32 s44, 0x05040100
    s_mov_b32 s45, 0x07060302
    s_cmp_lt_u32 s15, 24
    s_cbranch_scc1 Ltw_noord
    s_cmp_lg_u32 s14, 0
    s_cbranch_scc1 Ltw_ord_d
    v_mov_b32 v5, 48
    s_mov_b32 s16, 0
Ltw_ord:
    global_load_dword v6, v5, s[12:13] sc1
    s_add_u32 s16, s16, 1
    s_cmp_gt_u32 s16, 100000
    s_cbranch_scc1 L_role_tw_abort
    s_waitcnt vmcnt(0)
    v_cmp_gt_u32 vcc, 1, v6
    s_nop 0
    s_cbranch_vccz Ltw_ord_d
    s_sleep 64
    s_branch Ltw_ord
Ltw_ord_d:
    s_barrier
Ltw_noord:
    s_load_dwordx2 s[20:21], s[0:1], 64
    s_mov_b32 s22, 4718592
    s_mov_b32 s23, 0x00020000
    s_waitcnt lgkmcnt(0)
    s_and_b32 s21, s21, 0xffff
    s_load_dwordx2 s[24:25], s[0:1], 80
    s_mov_b32 s26, 2359296
    s_mov_b32 s27, 0x00020000
    s_waitcnt lgkmcnt(0)
    s_and_b32 s25, s25, 0xffff
    s_mul_i32 s17, s15, 43
    s_lshr_b32 s32, s17, 9
    s_mul_i32 s17, s32, 12
    s_sub_u32 s50, s15, s17
    s_add_u32 s33, s32, 31
    s_cmp_eq_u32 s32, 2
    s_cselect_b32 s33, 0, s33
    s_cmp_lt_u32 s32, 2
    s_cselect_b32 s33, 64, s33
    s_cselect_b32 s32, s32, 64
    s_mul_i32 s49, s50, 96
    s_mul_i32 s17, s14, 1179648
    s_add_u32 s49, s49, s17
    v_mul_u32_u24 v5, 4608, v8
    v_lshl_add_u32 v9, v7, 2, v5
    v_add_u32 v10, 18432, v9
    v_and_b32 v6, 14, v7
    v_lshl_add_u32 v12, v6, 1, v5
    v_add_u32 v12, 64, v12
    v_add_u32 v13, 18432, v12
    v_and_b32 v5, 1, v7
    v_mov_b32 v11, s44
    v_mov_b32 v6, s45
    v_cmp_eq_u32 vcc, 1, v5
    s_nop 1
    v_cndmask_b32 v11, v11, v6, vcc
    s_add_u32 s17, s49, 0
    buffer_load_dword v16, v9, s[20:23], s17 offen
    buffer_load_dword v17, v10, s[20:23], s17 offen
    buffer_load_dword v18, v12, s[20:23], s17 offen
    buffer_load_dword v19, v13, s[20:23], s17 offen
    s_add_u32 s17, s49, 1152
    buffer_load_dword v20, v9, s[20:23], s17 offen
    buffer_load_dword v21, v10, s[20:23], s17 offen
    buffer_load_dword v22, v12, s[20:23], s17 offen
    buffer_load_dword v23, v13, s[20:23], s17 offen
    s_add_u32 s17, s49, 2304
    buffer_load_dword v24, v9, s[20:23], s17 offen
    buffer_load_dword v25, v10, s[20:23], s17 offen
    buffer_load_dword v26, v12, s[20:23], s17 offen
    buffer_load_dword v27, v13, s[20:23], s17 offen
    s_add_u32 s17, s49, 3456
    buffer_load_dword v28, v9, s[20:23], s17 offen
    buffer_load_dword v29, v10, s[20:23], s17 offen
    buffer_load_dword v30, v12, s[20:23], s17 offen
    buffer_load_dword v31, v13, s[20:23], s17 offen
    s_add_u32 s17, s49, 36864
    buffer_load_dword v32, v9, s[20:23], s17 offen
    buffer_load_dword v33, v10, s[20:23], s17 offen
    buffer_load_dword v34, v12, s[20:23], s17 offen
    buffer_load_dword v35, v13, s[20:23], s17 offen
    s_add_u32 s17, s49, 38016
    buffer_load_dword v36, v9, s[20:23], s17 offen
    buffer_load_dword v37, v10, s[20:23], s17 offen
    buffer_load_dword v38, v12, s[20:23], s17 offen
    buffer_load_dword v39, v13, s[20:23], s17 offen
    s_add_u32 s17, s49, 39168
    buffer_load_dword v40, v9, s[20:23], s17 offen
    buffer_load_dword v41, v10, s[20:23], s17 offen
    buffer_load_dword v42, v12, s[20:23], s17 offen
    buffer_load_dword v43, v13, s[20:23], s17 offen
    s_add_u32 s17, s49, 40320
    buffer_load_dword v44, v9, s[20:23], s17 offen
    buffer_load_dword v45, v10, s[20:23], s17 offen
    buffer_load_dword v46, v12, s[20:23], s17 offen
    buffer_load_dword v47, v13, s[20:23], s17 offen
    s_add_u32 s17, s49, 73728
    buffer_load_dword v48, v9, s[20:23], s17 offen
    buffer_load_dword v49, v10, s[20:23], s17 offen
    buffer_load_dword v50, v12, s[20:23], s17 offen
    buffer_load_dword v51, v13, s[20:23], s17 offen
    s_add_u32 s17, s49, 74880
    buffer_load_dword v52, v9, s[20:23], s17 offen
    buffer_load_dword v53, v10, s[20:23], s17 offen
    buffer_load_dword v54, v12, s[20:23], s17 offen
    buffer_load_dword v55, v13, s[20:23], s17 offen
    s_add_u32 s17, s49, 76032
    buffer_load_dword v56, v9, s[20:23], s17 offen
    buffer_load_dword v57, v10, s[20:23], s17 offen
    buffer_load_dword v58, v12, s[20:23], s17 offen
    buffer_load_dword v59, v13, s[20:23], s17 offen
    s_add_u32 s17, s49, 77184
    buffer_load_dword v60, v9, s[20:23], s17 offen
    buffer_load_dword v61, v10, s[20:23], s17 offen
    buffer_load_dword v62, v12, s[20:23], s17 offen
    buffer_load_dword v63, v13, s[20:23], s17 offen
    s_add_u32 s17, s49, 110592
    buffer_load_dword v64, v9, s[20:23], s17 offen
    buffer_load_dword v65, v10, s[20:23], s17 offen
    buffer_load_dword v66, v12, s[20:23], s17 offen
    buffer_load_dword v67, v13, s[20:23], s17 offen
    s_add_u32 s17, s49, 111744
    buffer_load_dword v68, v9, s[20:23], s17 offen
    buffer_load_dword v69, v10, s[20:23], s17 offen
    buffer_load_dword v70, v12, s[20:23], s17 offen
    buffer_load_dword v71, v13, s[20:23], s17 offen
    s_add_u32 s17, s49, 112896
    buffer_load_dword v72, v9, s[20:23], s17 offen
    buffer_load_dword v73, v10, s[20:23], s17 offen
    buffer_load_dword v74, v12, s[20:23], s17 offen
    buffer_load_dword v75, v13, s[20:23], s17 offen
    s_waitcnt vmcnt(58)
    v_perm_b32 v5, v17, v16, s44
    v_perm_b32 v6, v17, v16, s45
    s_waitcnt vmcnt(56)
    v_perm_b32 v128, v19, v18, v11
    v_accvgpr_write_b32 a0, v5
    v_accvgpr_write_b32 a4, v6
    s_add_u32 s17, s49, 114048
    buffer_load_dword v76, v9, s[20:23], s17 offen
    buffer_load_dword v77, v10, s[20:23], s17 offen
    buffer_load_dword v78, v12, s[20:23], s17 offen
    buffer_load_dword v79, v13, s[20:23], s17 offen
    s_waitcnt vmcnt(58)
    v_perm_b32 v5, v21, v20, s44
    v_perm_b32 v6, v21, v20, s45
    s_waitcnt vmcnt(56)
    v_perm_b32 v129, v23, v22, v11
    v_accvgpr_write_b32 a1, v5
    v_accvgpr_write_b32 a5, v6
    s_add_u32 s17, s49, 147456
    buffer_load_dword v80, v9, s[20:23], s17 offen
    buffer_load_dword v81, v10, s[20:23], s17 offen
    buffer_load_dword v82, v12, s[20:23], s17 offen
    buffer_load_dword v83, v13, s[20:23], s17 offen
    s_waitcnt vmcnt(58)
    v_perm_b32 v5, v25, v24, s44
    v_perm_b32 v6, v25, v24, s45
    s_waitcnt vmcnt(56)
    v_perm_b32 v130, v27, v26, v11
    v_accvgpr_write_b32 a2, v5
    v_accvgpr_write_b32 a6, v6
    s_add_u32 s17, s49, 148608
    buffer_load_dword v84, v9, s[20:23], s17 offen
    buffer_load_dword v85, v10, s[20:23], s17 offen
    buffer_load_dword v86, v12, s[20:23], s17 offen
    buffer_load_dword v87, v13, s[20:23], s17 offen
    s_waitcnt vmcnt(58)
    v_perm_b32 v5, v29, v28, s44
    v_perm_b32 v6, v29, v28, s45
    s_waitcnt vmcnt(56)
    v_perm_b32 v131, v31, v30, v11
    v_accvgpr_write_b32 a3, v5
    v_accvgpr_write_b32 a7, v6
    s_add_u32 s17, s49, 149760
    buffer_load_dword v88, v9, s[20:23], s17 offen
    buffer_load_dword v89, v10, s[20:23], s17 offen
    buffer_load_dword v90, v12, s[20:23], s17 offen
    buffer_load_dword v91, v13, s[20:23], s17 offen
    s_waitcnt vmcnt(58)
    v_perm_b32 v5, v33, v32, s44
    v_perm_b32 v6, v33, v32, s45
    s_waitcnt vmcnt(56)
    v_perm_b32 v132, v35, v34, v11
    v_accvgpr_write_b32 a8, v5
    v_accvgpr_write_b32 a12, v6
    s_add_u32 s17, s49, 150912
    buffer_load_dword v92, v9, s[20:23], s17 offen
    buffer_load_dword v93, v10, s[20:23], s17 offen
    buffer_load_dword v94, v12, s[20:23], s17 offen
    buffer_load_dword v95, v13, s[20:23], s17 offen
    s_waitcnt vmcnt(58)
    v_perm_b32 v5, v37, v36, s44
    v_perm_b32 v6, v37, v36, s45
    s_waitcnt vmcnt(56)
    v_perm_b32 v133, v39, v38, v11
    v_accvgpr_write_b32 a9, v5
    v_accvgpr_write_b32 a13, v6
    s_add_u32 s17, s49, 184320
    buffer_load_dword v96, v9, s[20:23], s17 offen
    buffer_load_dword v97, v10, s[20:23], s17 offen
    buffer_load_dword v98, v12, s[20:23], s17 offen
    buffer_load_dword v99, v13, s[20:23], s17 offen
    s_waitcnt vmcnt(58)
    v_perm_b32 v5, v41, v40, s44
    v_perm_b32 v6, v41, v40, s45
    s_waitcnt vmcnt(56)
    v_perm_b32 v134, v43, v42, v11
    v_accvgpr_write_b32 a10, v5
    v_accvgpr_write_b32 a14, v6
    s_add_u32 s17, s49, 185472
    buffer_load_dword v100, v9, s[20:23], s17 offen
    buffer_load_dword v101, v10, s[20:23], s17 offen
    buffer_load_dword v102, v12, s[20:23], s17 offen
    buffer_load_dword v103, v13, s[20:23], s17 offen
    s_waitcnt vmcnt(58)
    v_perm_b32 v5, v45, v44, s44
    v_perm_b32 v6, v45, v44, s45
    s_waitcnt vmcnt(56)
    v_perm_b32 v135, v47, v46, v11
    v_accvgpr_write_b32 a11, v5
    v_accvgpr_write_b32 a15, v6
    s_add_u32 s17, s49, 186624
    buffer_load_dword v104, v9, s[20:23], s17 offen
    buffer_load_dword v105, v10, s[20:23], s17 offen
    buffer_load_dword v106, v12, s[20:23], s17 offen
    buffer_load_dword v107, v13, s[20:23], s17 offen
    s_waitcnt vmcnt(58)
    v_perm_b32 v5, v49, v48, s44
    v_perm_b32 v6, v49, v48, s45
    s_waitcnt vmcnt(56)
    v_perm_b32 v136, v51, v50, v11
    v_accvgpr_write_b32 a16, v5
    v_accvgpr_write_b32 a20, v6
    s_add_u32 s17, s49, 187776
    buffer_load_dword v108, v9, s[20:23], s17 offen
    buffer_load_dword v109, v10, s[20:23], s17 offen
    buffer_load_dword v110, v12, s[20:23], s17 offen
    buffer_load_dword v111, v13, s[20:23], s17 offen
    s_waitcnt vmcnt(58)
    v_perm_b32 v5, v53, v52, s44
    v_perm_b32 v6, v53, v52, s45
    s_waitcnt vmcnt(56)
    v_perm_b32 v137, v55, v54, v11
    v_accvgpr_write_b32 a17, v5
    v_accvgpr_write_b32 a21, v6
    s_add_u32 s17, s49, 221184
    buffer_load_dword v112, v9, s[20:23], s17 offen
    buffer_load_dword v113, v10, s[20:23], s17 offen
    buffer_load_dword v114, v12, s[20:23], s17 offen
    buffer_load_dword v115, v13, s[20:23], s17 offen
    s_waitcnt vmcnt(58)
    v_perm_b32 v5, v57, v56, s44
    v_perm_b32 v6, v57, v56, s45
    s_waitcnt vmcnt(56)
    v_perm_b32 v138, v59, v58, v11
    v_accvgpr_write_b32 a18, v5
    v_accvgpr_write_b32 a22, v6
    s_add_u32 s17, s49, 222336
    buffer_load_dword v116, v9, s[20:23], s17 offen
    buffer_load_dword v117, v10, s[20:23], s17 offen
    buffer_load_dword v118, v12, s[20:23], s17 offen
    buffer_load_dword v119, v13, s[20:23], s17 offen
    s_waitcnt vmcnt(58)
    v_perm_b32 v5, v61, v60, s44
    v_perm_b32 v6, v61, v60, s45
    s_waitcnt vmcnt(56)
    v_perm_b32 v139, v63, v62, v11
    v_accvgpr_write_b32 a19, v5
    v_accvgpr_write_b32 a23, v6
    s_add_u32 s17, s49, 223488
    buffer_load_dword v120, v9, s[20:23], s17 offen
    buffer_load_dword v121, v10, s[20:23], s17 offen
    buffer_load_dword v122, v12, s[20:23], s17 offen
    buffer_load_dword v123, v13, s[20:23], s17 offen
    s_waitcnt vmcnt(58)
    v_perm_b32 v5, v65, v64, s44
    v_perm_b32 v6, v65, v64, s45
    s_waitcnt vmcnt(56)
    v_perm_b32 v140, v67, v66, v11
    v_accvgpr_write_b32 a24, v5
    v_accvgpr_write_b32 a28, v6
    s_add_u32 s17, s49, 224640
    buffer_load_dword v124, v9, s[20:23], s17 offen
    buffer_load_dword v125, v10, s[20:23], s17 offen
    buffer_load_dword v126, v12, s[20:23], s17 offen
    buffer_load_dword v127, v13, s[20:23], s17 offen
    s_waitcnt vmcnt(58)
    v_perm_b32 v5, v69, v68, s44
    v_perm_b32 v6, v69, v68, s45
    s_waitcnt vmcnt(56)
    v_perm_b32 v141, v71, v70, v11
    v_accvgpr_write_b32 a25, v5
    v_accvgpr_write_b32 a29, v6
    s_add_u32 s17, s49, 258048
    buffer_load_dword v16, v9, s[20:23], s17 offen
    buffer_load_dword v17, v10, s[20:23], s17 offen
    buffer_load_dword v18, v12, s[20:23], s17 offen
    buffer_load_dword v19, v13, s[20:23], s17 offen
    s_waitcnt vmcnt(58)
    v_perm_b32 v5, v73, v72, s44
    v_perm_b32 v6, v73, v72, s45
    s_waitcnt vmcnt(56)
    v_perm_b32 v142, v75, v74, v11
    v_accvgpr_write_b32 a26, v5
    v_accvgpr_write_b32 a30, v6
    s_add_u32 s17, s49, 259200
    buffer_load_dword v20, v9, s[20:23], s17 offen
    buffer_load_dword v21, v10, s[20:23], s17 offen
    buffer_load_dword v22, v12, s[20:23], s17 offen
    buffer_load_dword v23, v13, s[20:23], s17 offen
    s_waitcnt vmcnt(58)
    v_perm_b32 v5, v77, v76, s44
    v_perm_b32 v6, v77, v76, s45
    s_waitcnt vmcnt(56)
    v_perm_b32 v143, v79, v78, v11
    v_accvgpr_write_b32 a27, v5
    v_accvgpr_write_b32 a31, v6
    s_add_u32 s17, s49, 260352
    buffer_load_dword v24, v9, s[20:23], s17 offen
    buffer_load_dword v25, v10, s[20:23], s17 offen
    buffer_load_dword v26, v12, s[20:23], s17 offen
    buffer_load_dword v27, v13, s[20:23], s17 offen
    s_waitcnt vmcnt(58)
    v_perm_b32 v5, v81, v80, s44
    v_perm_b32 v6, v81, v80, s45
    s_waitcnt vmcnt(56)
    v_perm_b32 v144, v83, v82, v11
    v_accvgpr_write_b32 a32, v5
    v_accvgpr_write_b32 a36, v6
    s_add_u32 s17, s49, 261504
    buffer_load_dword v28, v9, s[20:23], s17 offen
    buffer_load_dword v29, v10, s[20:23], s17 offen
    buffer_load_dword v30, v12, s[20:23], s17 offen
    buffer_load_dword v31, v13, s[20:23], s17 offen
    s_waitcnt vmcnt(58)
    v_perm_b32 v5, v85, v84, s44
    v_perm_b32 v6, v85, v84, s45
    s_waitcnt vmcnt(56)
    v_perm_b32 v145, v87, v86, v11
    v_accvgpr_write_b32 a33, v5
    v_accvgpr_write_b32 a37, v6
    s_add_u32 s17, s49, 294912
    buffer_load_dword v32, v9, s[20:23], s17 offen
    buffer_load_dword v33, v10, s[20:23], s17 offen
    buffer_load_dword v34, v12, s[20:23], s17 offen
    buffer_load_dword v35, v13, s[20:23], s17 offen
    s_waitcnt vmcnt(58)
    v_perm_b32 v5, v89, v88, s44
    v_perm_b32 v6, v89, v88, s45
    s_waitcnt vmcnt(56)
    v_perm_b32 v146, v91, v90, v11
    v_accvgpr_write_b32 a34, v5
    v_accvgpr_write_b32 a38, v6
    s_add_u32 s17, s49, 296064
    buffer_load_dword v36, v9, s[20:23], s17 offen
    buffer_load_dword v37, v10, s[20:23], s17 offen
    buffer_load_dword v38, v12, s[20:23], s17 offen
    buffer_load_dword v39, v13, s[20:23], s17 offen
    s_waitcnt vmcnt(58)
    v_perm_b32 v5, v93, v92, s44
    v_perm_b32 v6, v93, v92, s45
    s_waitcnt vmcnt(56)
    v_perm_b32 v147, v95, v94, v11
    v_accvgpr_write_b32 a35, v5
    v_accvgpr_write_b32 a39, v6
    s_add_u32 s17, s49, 297216
    buffer_load_dword v40, v9, s[20:23], s17 offen
    buffer_load_dword v41, v10, s[20:23], s17 offen
    buffer_load_dword v42, v12, s[20:23], s17 offen
    buffer_load_dword v43, v13, s[20:23], s17 offen
    s_waitcnt vmcnt(58)
    v_perm_b32 v5, v97, v96, s44
    v_perm_b32 v6, v97, v96, s45
    s_waitcnt vmcnt(56)
    v_perm_b32 v148, v99, v98, v11
    v_accvgpr_write_b32 a40, v5
    v_accvgpr_write_b32 a44, v6
    s_add_u32 s17, s49, 298368
    buffer_load_dword v44, v9, s[20:23], s17 offen
    buffer_load_dword v45, v10, s[20:23], s17 offen
    buffer_load_dword v46, v12, s[20:23], s17 offen
    buffer_load_dword v47, v13, s[20:23], s17 offen
    s_waitcnt vmcnt(58)
    v_perm_b32 v5, v101, v100, s44
    v_perm_b32 v6, v101, v100, s45
    s_waitcnt vmcnt(56)
    v_perm_b32 v149, v103, v102, v11
    v_accvgpr_write_b32 a41, v5
    v_accvgpr_write_b32 a45, v6
    s_add_u32 s17, s49, 331776
    buffer_load_dword v48, v9, s[20:23], s17 offen
    buffer_load_dword v49, v10, s[20:23], s17 offen
    buffer_load_dword v50, v12, s[20:23], s17 offen
    buffer_load_dword v51, v13, s[20:23], s17 offen
    s_waitcnt vmcnt(58)
    v_perm_b32 v5, v105, v104, s44
    v_perm_b32 v6, v105, v104, s45
    s_waitcnt vmcnt(56)
    v_perm_b32 v150, v107, v106, v11
    v_accvgpr_write_b32 a42, v5
    v_accvgpr_write_b32 a46, v6
    s_add_u32 s17, s49, 332928
    buffer_load_dword v52, v9, s[20:23], s17 offen
    buffer_load_dword v53, v10, s[20:23], s17 offen
    buffer_load_dword v54, v12, s[20:23], s17 offen
    buffer_load_dword v55, v13, s[20:23], s17 offen
    s_waitcnt vmcnt(58)
    v_perm_b32 v5, v109, v108, s44
    v_perm_b32 v6, v109, v108, s45
    s_waitcnt vmcnt(56)
    v_perm_b32 v151, v111, v110, v11
    v_accvgpr_write_b32 a43, v5
    v_accvgpr_write_b32 a47, v6
    s_add_u32 s17, s49, 334080
    buffer_load_dword v56, v9, s[20:23], s17 offen
    buffer_load_dword v57, v10, s[20:23], s17 offen
    buffer_load_dword v58, v12, s[20:23], s17 offen
    buffer_load_dword v59, v13, s[20:23], s17 offen
    s_waitcnt vmcnt(58)
    v_perm_b32 v5, v113, v112, s44
    v_perm_b32 v6, v113, v112, s45
    s_waitcnt vmcnt(56)
    v_perm_b32 v152, v115, v114, v11
    v_accvgpr_write_b32 a48, v5
    v_accvgpr_write_b32 a52, v6
    s_add_u32 s17, s49, 335232
    buffer_load_dword v60, v9, s[20:23], s17 offen
    buffer_load_dword v61, v10, s[20:23], s17 offen
    buffer_load_dword v62, v12, s[20:23], s17 offen
    buffer_load_dword v63, v13, s[20:23], s17 offen
    s_waitcnt vmcnt(58)
    v_perm_b32 v5, v117, v116, s44
    v_perm_b32 v6, v117, v116, s45
    s_waitcnt vmcnt(56)
    v_perm_b32 v153, v119, v118, v11
    v_accvgpr_write_b32 a49, v5
    v_accvgpr_write_b32 a53, v6
    s_add_u32 s17, s49, 368640
    buffer_load_dword v64, v9, s[20:23], s17 offen
    buffer_load_dword v65, v10, s[20:23], s17 offen
    buffer_load_dword v66, v12, s[20:23], s17 offen
    buffer_load_dword v67, v13, s[20:23], s17 offen
    s_waitcnt vmcnt(58)
    v_perm_b32 v5, v121, v120, s44
    v_perm_b32 v6, v121, v120, s45
    s_waitcnt vmcnt(56)
    v_perm_b32 v154, v123, v122, v11
    v_accvgpr_write_b32 a50, v5
    v_accvgpr_write_b32 a54, v6
    s_add_u32 s17, s49, 369792
    buffer_load_dword v68, v9, s[20:23], s17 offen
    buffer_load_dword v69, v10, s[20:23], s17 offen
    buffer_load_dword v70, v12, s[20:23], s17 offen
    buffer_load_dword v71, v13, s[20:23], s17 offen
    s_waitcnt vmcnt(58)
    v_perm_b32 v5, v125, v124, s44
    v_perm_b32 v6, v125, v124, s45
    s_waitcnt vmcnt(56)
    v_perm_b32 v155, v127, v126, v11
    v_accvgpr_write_b32 a51, v5
    v_accvgpr_write_b32 a55, v6
    s_add_u32 s17, s49, 370944
    buffer_load_dword v72, v9, s[20:23], s17 offen
    buffer_load_dword v73, v10, s[20:23], s17 offen
    buffer_load_dword v74, v12, s[20:23], s17 offen
    buffer_load_dword v75, v13, s[20:23], s17 offen
    s_waitcnt vmcnt(58)
    v_perm_b32 v5, v17, v16, s44
    v_perm_b32 v6, v17, v16, s45
    s_waitcnt vmcnt(56)
    v_perm_b32 v156, v19, v18, v11
    v_accvgpr_write_b32 a56, v5
    v_accvgpr_write_b32 a60, v6
    s_add_u32 s17, s49, 372096
    buffer_load_dword v76, v9, s[20:23], s17 offen
    buffer_load_dword v77, v10, s[20:23], s17 offen
    buffer_load_dword v78, v12, s[20:23], s17 offen
    buffer_load_dword v79, v13, s[20:23], s17 offen
    s_waitcnt vmcnt(58)
    v_perm_b32 v5, v21, v20, s44
    v_perm_b32 v6, v21, v20, s45
    s_waitcnt vmcnt(56)
    v_perm_b32 v157, v23, v22, v11
    v_accvgpr_write_b32 a57, v5
    v_accvgpr_write_b32 a61, v6
    s_add_u32 s17, s49, 405504
    buffer_load_dword v80, v9, s[20:23], s17 offen
    buffer_load_dword v81, v10, s[20:23], s17 offen
    buffer_load_dword v82, v12, s[20:23], s17 offen
    buffer_load_dword v83, v13, s[20:23], s17 offen
    s_waitcnt vmcnt(58)
    v_perm_b32 v5, v25, v24, s44
    v_perm_b32 v6, v25, v24, s45
    s_waitcnt vmcnt(56)
    v_perm_b32 v158, v27, v26, v11
    v_accvgpr_write_b32 a58, v5
    v_accvgpr_write_b32 a62, v6
    s_add_u32 s17, s49, 406656
    buffer_load_dword v84, v9, s[20:23], s17 offen
    buffer_load_dword v85, v10, s[20:23], s17 offen
    buffer_load_dword v86, v12, s[20:23], s17 offen
    buffer_load_dword v87, v13, s[20:23], s17 offen
    s_waitcnt vmcnt(58)
    v_perm_b32 v5, v29, v28, s44
    v_perm_b32 v6, v29, v28, s45
    s_waitcnt vmcnt(56)
    v_perm_b32 v159, v31, v30, v11
    v_accvgpr_write_b32 a59, v5
    v_accvgpr_write_b32 a63, v6
    s_add_u32 s17, s49, 407808
    buffer_load_dword v88, v9, s[20:23], s17 offen
    buffer_load_dword v89, v10, s[20:23], s17 offen
    buffer_load_dword v90, v12, s[20:23], s17 offen
    buffer_load_dword v91, v13, s[20:23], s17 offen
    s_waitcnt vmcnt(58)
    v_perm_b32 v5, v33, v32, s44
    v_perm_b32 v6, v33, v32, s45
    s_waitcnt vmcnt(56)
    v_perm_b32 v160, v35, v34, v11
    v_accvgpr_write_b32 a64, v5
    v_accvgpr_write_b32 a68, v6
    s_add_u32 s17, s49, 408960
    buffer_load_dword v92, v9, s[20:23], s17 offen
    buffer_load_dword v93, v10, s[20:23], s17 offen
    buffer_load_dword v94, v12, s[20:23], s17 offen
    buffer_load_dword v95, v13, s[20:23], s17 offen
    s_waitcnt vmcnt(58)
    v_perm_b32 v5, v37, v36, s44
    v_perm_b32 v6, v37, v36, s45
    s_waitcnt vmcnt(56)
    v_perm_b32 v161, v39, v38, v11
    v_accvgpr_write_b32 a65, v5
    v_accvgpr_write_b32 a69, v6
    s_add_u32 s17, s49, 442368
    buffer_load_dword v96, v9, s[20:23], s17 offen
    buffer_load_dword v97, v10, s[20:23], s17 offen
    buffer_load_dword v98, v12, s[20:23], s17 offen
    buffer_load_dword v99, v13, s[20:23], s17 offen
    s_waitcnt vmcnt(58)
    v_perm_b32 v5, v41, v40, s44
    v_perm_b32 v6, v41, v40, s45
    s_waitcnt vmcnt(56)
    v_perm_b32 v162, v43, v42, v11
    v_accvgpr_write_b32 a66, v5
    v_accvgpr_write_b32 a70, v6
    s_add_u32 s17, s49, 443520
    buffer_load_dword v100, v9, s[20:23], s17 offen
    buffer_load_dword v101, v10, s[20:23], s17 offen
    buffer_load_dword v102, v12, s[20:23], s17 offen
    buffer_load_dword v103, v13, s[20:23], s17 offen
    s_waitcnt vmcnt(58)
    v_perm_b32 v5, v45, v44, s44
    v_perm_b32 v6, v45, v44, s45
    s_waitcnt vmcnt(56)
    v_perm_b32 v163, v47, v46, v11
    v_accvgpr_write_b32 a67, v5
    v_accvgpr_write_b32 a71, v6
    s_add_u32 s17, s49, 444672
    buffer_load_dword v104, v9, s[20:23], s17 offen
    buffer_load_dword v105, v10, s[20:23], s17 offen
    buffer_load_dword v106, v12, s[20:23], s17 offen
    buffer_load_dword v107, v13, s[20:23], s17 offen
    s_waitcnt vmcnt(58)
    v_perm_b32 v5, v49, v48, s44
    v_perm_b32 v6, v49, v48, s45
    s_waitcnt vmcnt(56)
    v_perm_b32 v164, v51, v50, v11
    v_accvgpr_write_b32 a72, v5
    v_accvgpr_write_b32 a76, v6
    s_add_u32 s17, s49, 445824
    buffer_load_dword v108, v9, s[20:23], s17 offen
    buffer_load_dword v109, v10, s[20:23], s17 offen
    buffer_load_dword v110, v12, s[20:23], s17 offen
    buffer_load_dword v111, v13, s[20:23], s17 offen
    s_waitcnt vmcnt(58)
    v_perm_b32 v5, v53, v52, s44
    v_perm_b32 v6, v53, v52, s45
    s_waitcnt vmcnt(56)
    v_perm_b32 v165, v55, v54, v11
    v_accvgpr_write_b32 a73, v5
    v_accvgpr_write_b32 a77, v6
    s_add_u32 s17, s49, 479232
    buffer_load_dword v112, v9, s[20:23], s17 offen
    buffer_load_dword v113, v10, s[20:23], s17 offen
    buffer_load_dword v114, v12, s[20:23], s17 offen
    buffer_load_dword v115, v13, s[20:23], s17 offen
    s_waitcnt vmcnt(58)
    v_perm_b32 v5, v57, v56, s44
    v_perm_b32 v6, v57, v56, s45
    s_waitcnt vmcnt(56)
    v_perm_b32 v166, v59, v58, v11
    v_accvgpr_write_b32 a74, v5
    v_accvgpr_write_b32 a78, v6
    s_add_u32 s17, s49, 480384
    buffer_load_dword v116, v9, s[20:23], s17 offen
    buffer_load_dword v117, v10, s[20:23], s17 offen
    buffer_load_dword v118, v12, s[20:23], s17 offen
    buffer_load_dword v119, v13, s[20:23], s17 offen
    s_waitcnt vmcnt(58)
    v_perm_b32 v5, v61, v60, s44
    v_perm_b32 v6, v61, v60, s45
    s_waitcnt vmcnt(56)
    v_perm_b32 v167, v63, v62, v11
    v_accvgpr_write_b32 a75, v5
    v_accvgpr_write_b32 a79, v6
    s_add_u32 s17, s49, 481536
    buffer_load_dword v120, v9, s[20:23], s17 offen
    buffer_load_dword v121, v10, s[20:23], s17 offen
    buffer_load_dword v122, v12, s[20:23], s17 offen
    buffer_load_dword v123, v13, s[20:23], s17 offen
    s_waitcnt vmcnt(58)
    v_perm_b32 v5, v65, v64, s44
    v_perm_b32 v6, v65, v64, s45
    s_waitcnt vmcnt(56)
    v_perm_b32 v168, v67, v66, v11
    v_accvgpr_write_b32 a80, v5
    v_accvgpr_write_b32 a84, v6
    s_add_u32 s17, s49, 482688
    buffer_load_dword v124, v9, s[20:23], s17 offen
    buffer_load_dword v125, v10, s[20:23], s17 offen
    buffer_load_dword v126, v12, s[20:23], s17 offen
    buffer_load_dword v127, v13, s[20:23], s17 offen
    s_waitcnt vmcnt(58)
    v_perm_b32 v5, v69, v68, s44
    v_perm_b32 v6, v69, v68, s45
    s_waitcnt vmcnt(56)
    v_perm_b32 v169, v71, v70, v11
    v_accvgpr_write_b32 a81, v5
    v_accvgpr_write_b32 a85, v6
    s_add_u32 s17, s49, 516096
    buffer_load_dword v16, v9, s[20:23], s17 offen
    buffer_load_dword v17, v10, s[20:23], s17 offen
    buffer_load_dword v18, v12, s[20:23], s17 offen
    buffer_load_dword v19, v13, s[20:23], s17 offen
    s_waitcnt vmcnt(58)
    v_perm_b32 v5, v73, v72, s44
    v_perm_b32 v6, v73, v72, s45
    s_waitcnt vmcnt(56)
    v_perm_b32 v170, v75, v74, v11
    v_accvgpr_write_b32 a82, v5
    v_accvgpr_write_b32 a86, v6
    s_add_u32 s17, s49, 517248
    buffer_load_dword v20, v9, s[20:23], s17 offen
    buffer_load_dword v21, v10, s[20:23], s17 offen
    buffer_load_dword v22, v12, s[20:23], s17 offen
    buffer_load_dword v23, v13, s[20:23], s17 offen
    s_waitcnt vmcnt(58)
    v_perm_b32 v5, v77, v76, s44
    v_perm_b32 v6, v77, v76, s45
    s_waitcnt vmcnt(56)
    v_perm_b32 v171, v79, v78, v11
    v_accvgpr_write_b32 a83, v5
    v_accvgpr_write_b32 a87, v6
    s_add_u32 s17, s49, 518400
    buffer_load_dword v24, v9, s[20:23], s17 offen
    buffer_load_dword v25, v10, s[20:23], s17 offen
    buffer_load_dword v26, v12, s[20:23], s17 offen
    buffer_load_dword v27, v13, s[20:23], s17 offen
    s_waitcnt vmcnt(58)
    v_perm_b32 v5, v81, v80, s44
    v_perm_b32 v6, v81, v80, s45
    s_waitcnt vmcnt(56)
    v_perm_b32 v172, v83, v82, v11
    v_accvgpr_write_b32 a88, v5
    v_accvgpr_write_b32 a92, v6
    s_add_u32 s17, s49, 519552
    buffer_load_dword v28, v9, s[20:23], s17 offen
    buffer_load_dword v29, v10, s[20:23], s17 offen
    buffer_load_dword v30, v12, s[20:23], s17 offen
    buffer_load_dword v31, v13, s[20:23], s17 offen
    s_waitcnt vmcnt(58)
    v_perm_b32 v5, v85, v84, s44
    v_perm_b32 v6, v85, v84, s45
    s_waitcnt vmcnt(56)
    v_perm_b32 v173, v87, v86, v11
    v_accvgpr_write_b32 a89, v5
    v_accvgpr_write_b32 a93, v6
    s_add_u32 s17, s49, 552960
    buffer_load_dword v32, v9, s[20:23], s17 offen
    buffer_load_dword v33, v10, s[20:23], s17 offen
    buffer_load_dword v34, v12, s[20:23], s17 offen
    buffer_load_dword v35, v13, s[20:23], s17 offen
    s_waitcnt vmcnt(58)
    v_perm_b32 v5, v89, v88, s44
    v_perm_b32 v6, v89, v88, s45
    s_waitcnt vmcnt(56)
    v_perm_b32 v174, v91, v90, v11
    v_accvgpr_write_b32 a90, v5
    v_accvgpr_write_b32 a94, v6
    s_add_u32 s17, s49, 554112
    buffer_load_dword v36, v9, s[20:23], s17 offen
    buffer_load_dword v37, v10, s[20:23], s17 offen
    buffer_load_dword v38, v12, s[20:23], s17 offen
    buffer_load_dword v39, v13, s[20:23], s17 offen
    s_waitcnt vmcnt(58)
    v_perm_b32 v5, v93, v92, s44
    v_perm_b32 v6, v93, v92, s45
    s_waitcnt vmcnt(56)
    v_perm_b32 v175, v95, v94, v11
    v_accvgpr_write_b32 a91, v5
    v_accvgpr_write_b32 a95, v6
    s_add_u32 s17, s49, 555264
    buffer_load_dword v40, v9, s[20:23], s17 offen
    buffer_load_dword v41, v10, s[20:23], s17 offen
    buffer_load_dword v42, v12, s[20:23], s17 offen
    buffer_load_dword v43, v13, s[20:23], s17 offen
    s_waitcnt vmcnt(58)
    v_perm_b32 v5, v97, v96, s44
    v_perm_b32 v6, v97, v96, s45
    s_waitcnt vmcnt(56)
    v_perm_b32 v176, v99, v98, v11
    v_accvgpr_write_b32 a96, v5
    v_accvgpr_write_b32 a100, v6
    s_add_u32 s17, s49, 556416
    buffer_load_dword v44, v9, s[20:23], s17 offen
    buffer_load_dword v45, v10, s[20:23], s17 offen
    buffer_load_dword v46, v12, s[20:23], s17 offen
    buffer_load_dword v47, v13, s[20:23], s17 offen
    s_waitcnt vmcnt(58)
    v_perm_b32 v5, v101, v100, s44
    v_perm_b32 v6, v101, v100, s45
    s_waitcnt vmcnt(56)
    v_perm_b32 v177, v103, v102, v11
    v_accvgpr_write_b32 a97, v5
    v_accvgpr_write_b32 a101, v6
    s_add_u32 s17, s49, 589824
    buffer_load_dword v48, v9, s[20:23], s17 offen
    buffer_load_dword v49, v10, s[20:23], s17 offen
    buffer_load_dword v50, v12, s[20:23], s17 offen
    buffer_load_dword v51, v13, s[20:23], s17 offen
    s_waitcnt vmcnt(58)
    v_perm_b32 v5, v105, v104, s44
    v_perm_b32 v6, v105, v104, s45
    s_waitcnt vmcnt(56)
    v_perm_b32 v178, v107, v106, v11
    v_accvgpr_write_b32 a98, v5
    v_accvgpr_write_b32 a102, v6
    s_add_u32 s17, s49, 590976
    buffer_load_dword v52, v9, s[20:23], s17 offen
    buffer_load_dword v53, v10, s[20:23], s17 offen
    buffer_load_dword v54, v12, s[20:23], s17 offen
    buffer_load_dword v55, v13, s[20:23], s17 offen
    s_waitcnt vmcnt(58)
    v_perm_b32 v5, v109, v108, s44
    v_perm_b32 v6, v109, v108, s45
    s_waitcnt vmcnt(56)
    v_perm_b32 v179, v111, v110, v11
    v_accvgpr_write_b32 a99, v5
    v_accvgpr_write_b32 a103, v6
    s_add_u32 s17, s49, 592128
    buffer_load_dword v56, v9, s[20:23], s17 offen
    buffer_load_dword v57, v10, s[20:23], s17 offen
    buffer_load_dword v58, v12, s[20:23], s17 offen
    buffer_load_dword v59, v13, s[20:23], s17 offen
    s_waitcnt vmcnt(58)
    v_perm_b32 v5, v113, v112, s44
    v_perm_b32 v6, v113, v112, s45
    s_waitcnt vmcnt(56)
    v_perm_b32 v180, v115, v114, v11
    v_accvgpr_write_b32 a104, v5
    v_accvgpr_write_b32 a108, v6
    s_add_u32 s17, s49, 593280
    buffer_load_dword v60, v9, s[20:23], s17 offen
    buffer_load_dword v61, v10, s[20:23], s17 offen
    buffer_load_dword v62, v12, s[20:23], s17 offen
    buffer_load_dword v63, v13, s[20:23], s17 offen
    s_waitcnt vmcnt(58)
    v_perm_b32 v5, v117, v116, s44
    v_perm_b32 v6, v117, v116, s45
    s_waitcnt vmcnt(56)
    v_perm_b32 v181, v119, v118, v11
    v_accvgpr_write_b32 a105, v5
    v_accvgpr_write_b32 a109, v6
    s_add_u32 s17, s49, 626688
    buffer_load_dword v64, v9, s[20:23], s17 offen
    buffer_load_dword v65, v10, s[20:23], s17 offen
    buffer_load_dword v66, v12, s[20:23], s17 offen
    buffer_load_dword v67, v13, s[20:23], s17 offen
    s_waitcnt vmcnt(58)
    v_perm_b32 v5, v121, v120, s44
    v_perm_b32 v6, v121, v120, s45
    s_waitcnt vmcnt(56)
    v_perm_b32 v182, v123, v122, v11
    v_accvgpr_write_b32 a106, v5
    v_accvgpr_write_b32 a110, v6
    s_add_u32 s17, s49, 627840
    buffer_load_dword v68, v9, s[20:23], s17 offen
    buffer_load_dword v69, v10, s[20:23], s17 offen
    buffer_load_dword v70, v12, s[20:23], s17 offen
    buffer_load_dword v71, v13, s[20:23], s17 offen
    s_waitcnt vmcnt(58)
    v_perm_b32 v5, v125, v124, s44
    v_perm_b32 v6, v125, v124, s45
    s_waitcnt vmcnt(56)
    v_perm_b32 v183, v127, v126, v11
    v_accvgpr_write_b32 a107, v5
    v_accvgpr_write_b32 a111, v6
    s_add_u32 s17, s49, 628992
    buffer_load_dword v72, v9, s[20:23], s17 offen
    buffer_load_dword v73, v10, s[20:23], s17 offen
    buffer_load_dword v74, v12, s[20:23], s17 offen
    buffer_load_dword v75, v13, s[20:23], s17 offen
    s_waitcnt vmcnt(58)
    v_perm_b32 v5, v17, v16, s44
    v_perm_b32 v6, v17, v16, s45
    s_waitcnt vmcnt(56)
    v_perm_b32 v184, v19, v18, v11
    v_accvgpr_write_b32 a112, v5
    v_accvgpr_write_b32 a116, v6
    s_add_u32 s17, s49, 630144
    buffer_load_dword v76, v9, s[20:23], s17 offen
    buffer_load_dword v77, v10, s[20:23], s17 offen
    buffer_load_dword v78, v12, s[20:23], s17 offen
    buffer_load_dword v79, v13, s[20:23], s17 offen
    s_waitcnt vmcnt(58)
    v_perm_b32 v5, v21, v20, s44
    v_perm_b32 v6, v21, v20, s45
    s_waitcnt vmcnt(56)
    v_perm_b32 v185, v23, v22, v11
    v_accvgpr_write_b32 a113, v5
    v_accvgpr_write_b32 a117, v6
    s_add_u32 s17, s49, 663552
    buffer_load_dword v80, v9, s[20:23], s17 offen
    buffer_load_dword v81, v10, s[20:23], s17 offen
    buffer_load_dword v82, v12, s[20:23], s17 offen
    buffer_load_dword v83, v13, s[20:23], s17 offen
    s_waitcnt vmcnt(58)
    v_perm_b32 v5, v25, v24, s44
    v_perm_b32 v6, v25, v24, s45
    s_waitcnt vmcnt(56)
    v_perm_b32 v186, v27, v26, v11
    v_accvgpr_write_b32 a114, v5
    v_accvgpr_write_b32 a118, v6
    s_add_u32 s17, s49, 664704
    buffer_load_dword v84, v9, s[20:23], s17 offen
    buffer_load_dword v85, v10, s[20:23], s17 offen
    buffer_load_dword v86, v12, s[20:23], s17 offen
    buffer_load_dword v87, v13, s[20:23], s17 offen
    s_waitcnt vmcnt(58)
    v_perm_b32 v5, v29, v28, s44
    v_perm_b32 v6, v29, v28, s45
    s_waitcnt vmcnt(56)
    v_perm_b32 v187, v31, v30, v11
    v_accvgpr_write_b32 a115, v5
    v_accvgpr_write_b32 a119, v6
    s_add_u32 s17, s49, 665856
    buffer_load_dword v88, v9, s[20:23], s17 offen
    buffer_load_dword v89, v10, s[20:23], s17 offen
    buffer_load_dword v90, v12, s[20:23], s17 offen
    buffer_load_dword v91, v13, s[20:23], s17 offen
    s_waitcnt vmcnt(58)
    v_perm_b32 v5, v33, v32, s44
    v_perm_b32 v6, v33, v32, s45
    s_waitcnt vmcnt(56)
    v_perm_b32 v188, v35, v34, v11
    v_accvgpr_write_b32 a120, v5
    v_accvgpr_write_b32 a124, v6
    s_add_u32 s17, s49, 667008
    buffer_load_dword v92, v9, s[20:23], s17 offen
    buffer_load_dword v93, v10, s[20:23], s17 offen
    buffer_load_dword v94, v12, s[20:23], s17 offen
    buffer_load_dword v95, v13, s[20:23], s17 offen
    s_waitcnt vmcnt(58)
    v_perm_b32 v5, v37, v36, s44
    v_perm_b32 v6, v37, v36, s45
    s_waitcnt vmcnt(56)
    v_perm_b32 v189, v39, v38, v11
    v_accvgpr_write_b32 a121, v5
    v_accvgpr_write_b32 a125, v6
    s_add_u32 s17, s49, 700416
    buffer_load_dword v96, v9, s[20:23], s17 offen
    buffer_load_dword v97, v10, s[20:23], s17 offen
    buffer_load_dword v98, v12, s[20:23], s17 offen
    buffer_load_dword v99, v13, s[20:23], s17 offen
    s_waitcnt vmcnt(58)
    v_perm_b32 v5, v41, v40, s44
    v_perm_b32 v6, v41, v40, s45
    s_waitcnt vmcnt(56)
    v_perm_b32 v190, v43, v42, v11
    v_accvgpr_write_b32 a122, v5
    v_accvgpr_write_b32 a126, v6
    s_add_u32 s17, s49, 701568
    buffer_load_dword v100, v9, s[20:23], s17 offen
    buffer_load_dword v101, v10, s[20:23], s17 offen
    buffer_load_dword v102, v12, s[20:23], s17 offen
    buffer_load_dword v103, v13, s[20:23], s17 offen
    s_waitcnt vmcnt(58)
    v_perm_b32 v5, v45, v44, s44
    v_perm_b32 v6, v45, v44, s45
    s_waitcnt vmcnt(56)
    v_perm_b32 v191, v47, v46, v11
    v_accvgpr_write_b32 a123, v5
    v_accvgpr_write_b32 a127, v6
    s_add_u32 s17, s49, 702720
    buffer_load_dword v104, v9, s[20:23], s17 offen
    buffer_load_dword v105, v10, s[20:23], s17 offen
    buffer_load_dword v106, v12, s[20:23], s17 offen
    buffer_load_dword v107, v13, s[20:23], s17 offen
    s_waitcnt vmcnt(58)
    v_perm_b32 v5, v49, v48, s44
    v_perm_b32 v6, v49, v48, s45
    s_waitcnt vmcnt(56)
    v_perm_b32 v192, v51, v50, v11
    v_accvgpr_write_b32 a128, v5
    v_accvgpr_write_b32 a132, v6
    s_add_u32 s17, s49, 703872
    buffer_load_dword v108, v9, s[20:23], s17 offen
    buffer_load_dword v109, v10, s[20:23], s17 offen
    buffer_load_dword v110, v12, s[20:23], s17 offen
    buffer_load_dword v111, v13, s[20:23], s17 offen
    s_waitcnt vmcnt(58)
    v_perm_b32 v5, v53, v52, s44
    v_perm_b32 v6, v53, v52, s45
    s_waitcnt vmcnt(56)
    v_perm_b32 v193, v55, v54, v11
    v_accvgpr_write_b32 a129, v5
    v_accvgpr_write_b32 a133, v6
    s_add_u32 s17, s49, 737280
    buffer_load_dword v112, v9, s[20:23], s17 offen
    buffer_load_dword v113, v10, s[20:23], s17 offen
    buffer_load_dword v114, v12, s[20:23], s17 offen
    buffer_load_dword v115, v13, s[20:23], s17 offen
    s_waitcnt vmcnt(58)
    v_perm_b32 v5, v57, v56, s44
    v_perm_b32 v6, v57, v56, s45
    s_waitcnt vmcnt(56)
    v_perm_b32 v194, v59, v58, v11
    v_accvgpr_write_b32 a130, v5
    v_accvgpr_write_b32 a134, v6
    s_add_u32 s17, s49, 738432
    buffer_load_dword v116, v9, s[20:23], s17 offen
    buffer_load_dword v117, v10, s[20:23], s17 offen
    buffer_load_dword v118, v12, s[20:23], s17 offen
    buffer_load_dword v119, v13, s[20:23], s17 offen
    s_waitcnt vmcnt(58)
    v_perm_b32 v5, v61, v60, s44
    v_perm_b32 v6, v61, v60, s45
    s_waitcnt vmcnt(56)
    v_perm_b32 v195, v63, v62, v11
    v_accvgpr_write_b32 a131, v5
    v_accvgpr_write_b32 a135, v6
    s_add_u32 s17, s49, 739584
    buffer_load_dword v120, v9, s[20:23], s17 offen
    buffer_load_dword v121, v10, s[20:23], s17 offen
    buffer_load_dword v122, v12, s[20:23], s17 offen
    buffer_load_dword v123, v13, s[20:23], s17 offen
    s_waitcnt vmcnt(58)
    v_perm_b32 v5, v65, v64, s44
    v_perm_b32 v6, v65, v64, s45
    s_waitcnt vmcnt(56)
    v_perm_b32 v196, v67, v66, v11
    v_accvgpr_write_b32 a136, v5
    v_accvgpr_write_b32 a140, v6
    s_add_u32 s17, s49, 740736
    buffer_load_dword v124, v9, s[20:23], s17 offen
    buffer_load_dword v125, v10, s[20:23], s17 offen
    buffer_load_dword v126, v12, s[20:23], s17 offen
    buffer_load_dword v127, v13, s[20:23], s17 offen
    s_waitcnt vmcnt(58)
    v_perm_b32 v5, v69, v68, s44
    v_perm_b32 v6, v69, v68, s45
    s_waitcnt vmcnt(56)
    v_perm_b32 v197, v71, v70, v11
    v_accvgpr_write_b32 a137, v5
    v_accvgpr_write_b32 a141, v6
    s_add_u32 s17, s49, 774144
    buffer_load_dword v16, v9, s[20:23], s17 offen
    buffer_load_dword v17, v10, s[20:23], s17 offen
    buffer_load_dword v18, v12, s[20:23], s17 offen
    buffer_load_dword v19, v13, s[20:23], s17 offen
    s_waitcnt vmcnt(58)
    v_perm_b32 v5, v73, v72, s44
    v_perm_b32 v6, v73, v72, s45
    s_waitcnt vmcnt(56)
    v_perm_b32 v198, v75, v74, v11
    v_accvgpr_write_b32 a138, v5
    v_accvgpr_write_b32 a142, v6
    s_add_u32 s17, s49, 775296
    buffer_load_dword v20, v9, s[20:23], s17 offen
    buffer_load_dword v21, v10, s[20:23], s17 offen
    buffer_load_dword v22, v12, s[20:23], s17 offen
    buffer_load_dword v23, v13, s[20:23], s17 offen
    s_waitcnt vmcnt(58)
    v_perm_b32 v5, v77, v76, s44
    v_perm_b32 v6, v77, v76, s45
    s_waitcnt vmcnt(56)
    v_perm_b32 v199, v79, v78, v11
    v_accvgpr_write_b32 a139, v5
    v_accvgpr_write_b32 a143, v6
    s_add_u32 s17, s49, 776448
    buffer_load_dword v24, v9, s[20:23], s17 offen
    buffer_load_dword v25, v10, s[20:23], s17 offen
    buffer_load_dword v26, v12, s[20:23], s17 offen
    buffer_load_dword v27, v13, s[20:23], s17 offen
    s_waitcnt vmcnt(58)
    v_perm_b32 v5, v81, v80, s44
    v_perm_b32 v6, v81, v80, s45
    s_waitcnt vmcnt(56)
    v_perm_b32 v200, v83, v82, v11
    v_accvgpr_write_b32 a144, v5
    v_accvgpr_write_b32 a148, v6
    s_add_u32 s17, s49, 777600
    buffer_load_dword v28, v9, s[20:23], s17 offen
    buffer_load_dword v29, v10, s[20:23], s17 offen
    buffer_load_dword v30, v12, s[20:23], s17 offen
    buffer_load_dword v31, v13, s[20:23], s17 offen
    s_waitcnt vmcnt(58)
    v_perm_b32 v5, v85, v84, s44
    v_perm_b32 v6, v85, v84, s45
    s_waitcnt vmcnt(56)
    v_perm_b32 v201, v87, v86, v11
    v_accvgpr_write_b32 a145, v5
    v_accvgpr_write_b32 a149, v6
    s_add_u32 s17, s49, 811008
    buffer_load_dword v32, v9, s[20:23], s17 offen
    buffer_load_dword v33, v10, s[20:23], s17 offen
    buffer_load_dword v34, v12, s[20:23], s17 offen
    buffer_load_dword v35, v13, s[20:23], s17 offen
    s_waitcnt vmcnt(58)
    v_perm_b32 v5, v89, v88, s44
    v_perm_b32 v6, v89, v88, s45
    s_waitcnt vmcnt(56)
    v_perm_b32 v202, v91, v90, v11
    v_accvgpr_write_b32 a146, v5
    v_accvgpr_write_b32 a150, v6
    s_add_u32 s17, s49, 812160
    buffer_load_dword v36, v9, s[20:23], s17 offen
    buffer_load_dword v37, v10, s[20:23], s17 offen
    buffer_load_dword v38, v12, s[20:23], s17 offen
    buffer_load_dword v39, v13, s[20:23], s17 offen
    s_waitcnt vmcnt(58)
    v_perm_b32 v5, v93, v92, s44
    v_perm_b32 v6, v93, v92, s45
    s_waitcnt vmcnt(56)
    v_perm_b32 v203, v95, v94, v11
    v_accvgpr_write_b32 a147, v5
    v_accvgpr_write_b32 a151, v6
    s_add_u32 s17, s49, 813312
    buffer_load_dword v40, v9, s[20:23], s17 offen
    buffer_load_dword v41, v10, s[20:23], s17 offen
    buffer_load_dword v42, v12, s[20:23], s17 offen
    buffer_load_dword v43, v13, s[20:23], s17 offen
    s_waitcnt vmcnt(58)
    v_perm_b32 v5, v97, v96, s44
    v_perm_b32 v6, v97, v96, s45
    s_waitcnt vmcnt(56)
    v_perm_b32 v204, v99, v98, v11
    v_accvgpr_write_b32 a152, v5
    v_accvgpr_write_b32 a156, v6
    s_add_u32 s17, s49, 814464
    buffer_load_dword v44, v9, s[20:23], s17 offen
    buffer_load_dword v45, v10, s[20:23], s17 offen
    buffer_load_dword v46, v12, s[20:23], s17 offen
    buffer_load_dword v47, v13, s[20:23], s17 offen
    s_waitcnt vmcnt(58)
    v_perm_b32 v5, v101, v100, s44
    v_perm_b32 v6, v101, v100, s45
    s_waitcnt vmcnt(56)
    v_perm_b32 v205, v103, v102, v11
    v_accvgpr_write_b32 a153, v5
    v_accvgpr_write_b32 a157, v6
    s_add_u32 s17, s49, 847872
    buffer_load_dword v48, v9, s[20:23], s17 offen
    buffer_load_dword v49, v10, s[20:23], s17 offen
    buffer_load_dword v50, v12, s[20:23], s17 offen
    buffer_load_dword v51, v13, s[20:23], s17 offen
    s_waitcnt vmcnt(58)
    v_perm_b32 v5, v105, v104, s44
    v_perm_b32 v6, v105, v104, s45
    s_waitcnt vmcnt(56)
    v_perm_b32 v206, v107, v106, v11
    v_accvgpr_write_b32 a154, v5
    v_accvgpr_write_b32 a158, v6
    s_add_u32 s17, s49, 849024
    buffer_load_dword v52, v9, s[20:23], s17 offen
    buffer_load_dword v53, v10, s[20:23], s17 offen
    buffer_load_dword v54, v12, s[20:23], s17 offen
    buffer_load_dword v55, v13, s[20:23], s17 offen
    s_waitcnt vmcnt(58)
    v_perm_b32 v5, v109, v108, s44
    v_perm_b32 v6, v109, v108, s45
    s_waitcnt vmcnt(56)
    v_perm_b32 v207, v111, v110, v11
    v_accvgpr_write_b32 a155, v5
    v_accvgpr_write_b32 a159, v6
    s_add_u32 s17, s49, 850176
    buffer_load_dword v56, v9, s[20:23], s17 offen
    buffer_load_dword v57, v10, s[20:23], s17 offen
    buffer_load_dword v58, v12, s[20:23], s17 offen
    buffer_load_dword v59, v13, s[20:23], s17 offen
    s_waitcnt vmcnt(58)
    v_perm_b32 v5, v113, v112, s44
    v_perm_b32 v6, v113, v112, s45
    s_waitcnt vmcnt(56)
    v_perm_b32 v208, v115, v114, v11
    v_accvgpr_write_b32 a160, v5
    v_accvgpr_write_b32 a164, v6
    s_add_u32 s17, s49, 851328
    buffer_load_dword v60, v9, s[20:23], s17 offen
    buffer_load_dword v61, v10, s[20:23], s17 offen
    buffer_load_dword v62, v12, s[20:23], s17 offen
    buffer_load_dword v63, v13, s[20:23], s17 offen
    s_waitcnt vmcnt(58)
    v_perm_b32 v5, v117, v116, s44
    v_perm_b32 v6, v117, v116, s45
    s_waitcnt vmcnt(56)
    v_perm_b32 v209, v119, v118, v11
    v_accvgpr_write_b32 a161, v5
    v_accvgpr_write_b32 a165, v6
    s_add_u32 s17, s49, 884736
    buffer_load_dword v64, v9, s[20:23], s17 offen
    buffer_load_dword v65, v10, s[20:23], s17 offen
    buffer_load_dword v66, v12, s[20:23], s17 offen
    buffer_load_dword v67, v13, s[20:23], s17 offen
    s_waitcnt vmcnt(58)
    v_perm_b32 v5, v121, v120, s44
    v_perm_b32 v6, v121, v120, s45
    s_waitcnt vmcnt(56)
    v_perm_b32 v210, v123, v122, v11
    v_accvgpr_write_b32 a162, v5
    v_accvgpr_write_b32 a166, v6
    s_add_u32 s17, s49, 885888
    buffer_load_dword v68, v9, s[20:23], s17 offen
    buffer_load_dword v69, v10, s[20:23], s17 offen
    buffer_load_dword v70, v12, s[20:23], s17 offen
    buffer_load_dword v71, v13, s[20:23], s17 offen
    s_waitcnt vmcnt(58)
    v_perm_b32 v5, v125, v124, s44
    v_perm_b32 v6, v125, v124, s45
    s_waitcnt vmcnt(56)
    v_perm_b32 v211, v127, v126, v11
    v_accvgpr_write_b32 a163, v5
    v_accvgpr_write_b32 a167, v6
    s_add_u32 s17, s49, 887040
    buffer_load_dword v72, v9, s[20:23], s17 offen
    buffer_load_dword v73, v10, s[20:23], s17 offen
    buffer_load_dword v74, v12, s[20:23], s17 offen
    buffer_load_dword v75, v13, s[20:23], s17 offen
    s_waitcnt vmcnt(58)
    v_perm_b32 v5, v17, v16, s44
    v_perm_b32 v6, v17, v16, s45
    s_waitcnt vmcnt(56)
    v_perm_b32 v212, v19, v18, v11
    v_accvgpr_write_b32 a168, v5
    v_accvgpr_write_b32 a172, v6
    s_add_u32 s17, s49, 888192
    buffer_load_dword v76, v9, s[20:23], s17 offen
    buffer_load_dword v77, v10, s[20:23], s17 offen
    buffer_load_dword v78, v12, s[20:23], s17 offen
    buffer_load_dword v79, v13, s[20:23], s17 offen
    s_waitcnt vmcnt(58)
    v_perm_b32 v5, v21, v20, s44
    v_perm_b32 v6, v21, v20, s45
    s_waitcnt vmcnt(56)
    v_perm_b32 v213, v23, v22, v11
    v_accvgpr_write_b32 a169, v5
    v_accvgpr_write_b32 a173, v6
    s_add_u32 s17, s49, 921600
    buffer_load_dword v80, v9, s[20:23], s17 offen
    buffer_load_dword v81, v10, s[20:23], s17 offen
    buffer_load_dword v82, v12, s[20:23], s17 offen
    buffer_load_dword v83, v13, s[20:23], s17 offen
    s_waitcnt vmcnt(58)
    v_perm_b32 v5, v25, v24, s44
    v_perm_b32 v6, v25, v24, s45
    s_waitcnt vmcnt(56)
    v_perm_b32 v214, v27, v26, v11
    v_accvgpr_write_b32 a170, v5
    v_accvgpr_write_b32 a174, v6
    s_add_u32 s17, s49, 922752
    buffer_load_dword v84, v9, s[20:23], s17 offen
    buffer_load_dword v85, v10, s[20:23], s17 offen
    buffer_load_dword v86, v12, s[20:23], s17 offen
    buffer_load_dword v87, v13, s[20:23], s17 offen
    s_waitcnt vmcnt(58)
    v_perm_b32 v5, v29, v28, s44
    v_perm_b32 v6, v29, v28, s45
    s_waitcnt vmcnt(56)
    v_perm_b32 v215, v31, v30, v11
    v_accvgpr_write_b32 a171, v5
    v_accvgpr_write_b32 a175, v6
    s_add_u32 s17, s49, 923904
    buffer_load_dword v88, v9, s[20:23], s17 offen
    buffer_load_dword v89, v10, s[20:23], s17 offen
    buffer_load_dword v90, v12, s[20:23], s17 offen
    buffer_load_dword v91, v13, s[20:23], s17 offen
    s_waitcnt vmcnt(58)
    v_perm_b32 v5, v33, v32, s44
    v_perm_b32 v6, v33, v32, s45
    s_waitcnt vmcnt(56)
    v_perm_b32 v216, v35, v34, v11
    v_accvgpr_write_b32 a176, v5
    v_accvgpr_write_b32 a180, v6
    s_add_u32 s17, s49, 925056
    buffer_load_dword v92, v9, s[20:23], s17 offen
    buffer_load_dword v93, v10, s[20:23], s17 offen
    buffer_load_dword v94, v12, s[20:23], s17 offen
    buffer_load_dword v95, v13, s[20:23], s17 offen
    s_waitcnt vmcnt(58)
    v_perm_b32 v5, v37, v36, s44
    v_perm_b32 v6, v37, v36, s45
    s_waitcnt vmcnt(56)
    v_perm_b32 v217, v39, v38, v11
    v_accvgpr_write_b32 a177, v5
    v_accvgpr_write_b32 a181, v6
    s_add_u32 s17, s49, 958464
    buffer_load_dword v96, v9, s[20:23], s17 offen
    buffer_load_dword v97, v10, s[20:23], s17 offen
    buffer_load_dword v98, v12, s[20:23], s17 offen
    buffer_load_dword v99, v13, s[20:23], s17 offen
    s_waitcnt vmcnt(58)
    v_perm_b32 v5, v41, v40, s44
    v_perm_b32 v6, v41, v40, s45
    s_waitcnt vmcnt(56)
    v_perm_b32 v218, v43, v42, v11
    v_accvgpr_write_b32 a178, v5
    v_accvgpr_write_b32 a182, v6
    s_add_u32 s17, s49, 959616
    buffer_load_dword v100, v9, s[20:23], s17 offen
    buffer_load_dword v101, v10, s[20:23], s17 offen
    buffer_load_dword v102, v12, s[20:23], s17 offen
    buffer_load_dword v103, v13, s[20:23], s17 offen
    s_waitcnt vmcnt(58)
    v_perm_b32 v5, v45, v44, s44
    v_perm_b32 v6, v45, v44, s45
    s_waitcnt vmcnt(56)
    v_perm_b32 v219, v47, v46, v11
    v_accvgpr_write_b32 a179, v5
    v_accvgpr_write_b32 a183, v6
    s_add_u32 s17, s49, 960768
    buffer_load_dword v104, v9, s[20:23], s17 offen
    buffer_load_dword v105, v10, s[20:23], s17 offen
    buffer_load_dword v106, v12, s[20:23], s17 offen
    buffer_load_dword v107, v13, s[20:23], s17 offen
    s_waitcnt vmcnt(58)
    v_perm_b32 v5, v49, v48, s44
    v_perm_b32 v6, v49, v48, s45
    s_waitcnt vmcnt(56)
    v_perm_b32 v220, v51, v50, v11
    v_accvgpr_write_b32 a184, v5
    v_accvgpr_write_b32 a188, v6
    s_add_u32 s17, s49, 961920
    buffer_load_dword v108, v9, s[20:23], s17 offen
    buffer_load_dword v109, v10, s[20:23], s17 offen
    buffer_load_dword v110, v12, s[20:23], s17 offen
    buffer_load_dword v111, v13, s[20:23], s17 offen
    s_waitcnt vmcnt(58)
    v_perm_b32 v5, v53, v52, s44
    v_perm_b32 v6, v53, v52, s45
    s_waitcnt vmcnt(56)
    v_perm_b32 v221, v55, v54, v11
    v_accvgpr_write_b32 a185, v5
    v_accvgpr_write_b32 a189, v6
    s_add_u32 s17, s49, 995328
    buffer_load_dword v112, v9, s[20:23], s17 offen
    buffer_load_dword v113, v10, s[20:23], s17 offen
    buffer_load_dword v114, v12, s[20:23], s17 offen
    buffer_load_dword v115, v13, s[20:23], s17 offen
    s_waitcnt vmcnt(58)
    v_perm_b32 v5, v57, v56, s44
    v_perm_b32 v6, v57, v56, s45
    s_waitcnt vmcnt(56)
    v_perm_b32 v222, v59, v58, v11
    v_accvgpr_write_b32 a186, v5
    v_accvgpr_write_b32 a190, v6
    s_add_u32 s17, s49, 996480
    buffer_load_dword v116, v9, s[20:23], s17 offen
    buffer_load_dword v117, v10, s[20:23], s17 offen
    buffer_load_dword v118, v12, s[20:23], s17 offen
    buffer_load_dword v119, v13, s[20:23], s17 offen
    s_waitcnt vmcnt(58)
    v_perm_b32 v5, v61, v60, s44
    v_perm_b32 v6, v61, v60, s45
    s_waitcnt vmcnt(56)
    v_perm_b32 v223, v63, v62, v11
    v_accvgpr_write_b32 a187, v5
    v_accvgpr_write_b32 a191, v6
    s_add_u32 s17, s49, 997632
    buffer_load_dword v120, v9, s[20:23], s17 offen
    buffer_load_dword v121, v10, s[20:23], s17 offen
    buffer_load_dword v122, v12, s[20:23], s17 offen
    buffer_load_dword v123, v13, s[20:23], s17 offen
    s_waitcnt vmcnt(58)
    v_perm_b32 v5, v65, v64, s44
    v_perm_b32 v6, v65, v64, s45
    s_waitcnt vmcnt(56)
    v_perm_b32 v224, v67, v66, v11
    v_accvgpr_write_b32 a192, v5
    v_accvgpr_write_b32 a196, v6
    s_add_u32 s17, s49, 998784
    buffer_load_dword v124, v9, s[20:23], s17 offen
    buffer_load_dword v125, v10, s[20:23], s17 offen
    buffer_load_dword v126, v12, s[20:23], s17 offen
    buffer_load_dword v127, v13, s[20:23], s17 offen
    s_waitcnt vmcnt(58)
    v_perm_b32 v5, v69, v68, s44
    v_perm_b32 v6, v69, v68, s45
    s_waitcnt vmcnt(56)
    v_perm_b32 v225, v71, v70, v11
    v_accvgpr_write_b32 a193, v5
    v_accvgpr_write_b32 a197, v6
    s_add_u32 s17, s49, 1032192
    buffer_load_dword v16, v9, s[20:23], s17 offen
    buffer_load_dword v17, v10, s[20:23], s17 offen
    buffer_load_dword v18, v12, s[20:23], s17 offen
    buffer_load_dword v19, v13, s[20:23], s17 offen
    s_waitcnt vmcnt(58)
    v_perm_b32 v5, v73, v72, s44
    v_perm_b32 v6, v73, v72, s45
    s_waitcnt vmcnt(56)
    v_perm_b32 v226, v75, v74, v11
    v_accvgpr_write_b32 a194, v5
    v_accvgpr_write_b32 a198, v6
    s_add_u32 s17, s49, 1033344
    buffer_load_dword v20, v9, s[20:23], s17 offen
    buffer_load_dword v21, v10, s[20:23], s17 offen
    buffer_load_dword v22, v12, s[20:23], s17 offen
    buffer_load_dword v23, v13, s[20:23], s17 offen
    s_waitcnt vmcnt(58)
    v_perm_b32 v5, v77, v76, s44
    v_perm_b32 v6, v77, v76, s45
    s_waitcnt vmcnt(56)
    v_perm_b32 v227, v79, v78, v11
    v_accvgpr_write_b32 a195, v5
    v_accvgpr_write_b32 a199, v6
    s_add_u32 s17, s49, 1034496
    buffer_load_dword v24, v9, s[20:23], s17 offen
    buffer_load_dword v25, v10, s[20:23], s17 offen
    buffer_load_dword v26, v12, s[20:23], s17 offen
    buffer_load_dword v27, v13, s[20:23], s17 offen
    s_waitcnt vmcnt(58)
    v_perm_b32 v5, v81, v80, s44
    v_perm_b32 v6, v81, v80, s45
    s_waitcnt vmcnt(56)
    v_perm_b32 v228, v83, v82, v11
    v_accvgpr_write_b32 a200, v5
    v_accvgpr_write_b32 a204, v6
    s_add_u32 s17, s49, 1035648
    buffer_load_dword v28, v9, s[20:23], s17 offen
    buffer_load_dword v29, v10, s[20:23], s17 offen
    buffer_load_dword v30, v12, s[20:23], s17 offen
    buffer_load_dword v31, v13, s[20:23], s17 offen
    s_waitcnt vmcnt(58)
    v_perm_b32 v5, v85, v84, s44
    v_perm_b32 v6, v85, v84, s45
    s_waitcnt vmcnt(56)
    v_perm_b32 v229, v87, v86, v11
    v_accvgpr_write_b32 a201, v5
    v_accvgpr_write_b32 a205, v6
    s_add_u32 s17, s49, 1069056
    buffer_load_dword v32, v9, s[20:23], s17 offen
    buffer_load_dword v33, v10, s[20:23], s17 offen
    buffer_load_dword v34, v12, s[20:23], s17 offen
    buffer_load_dword v35, v13, s[20:23], s17 offen
    s_waitcnt vmcnt(58)
    v_perm_b32 v5, v89, v88, s44
    v_perm_b32 v6, v89, v88, s45
    s_waitcnt vmcnt(56)
    v_perm_b32 v230, v91, v90, v11
    v_accvgpr_write_b32 a202, v5
    v_accvgpr_write_b32 a206, v6
    s_add_u32 s17, s49, 1070208
    buffer_load_dword v36, v9, s[20:23], s17 offen
    buffer_load_dword v37, v10, s[20:23], s17 offen
    buffer_load_dword v38, v12, s[20:23], s17 offen
    buffer_load_dword v39, v13, s[20:23], s17 offen
    s_waitcnt vmcnt(58)
    v_perm_b32 v5, v93, v92, s44
    v_perm_b32 v6, v93, v92, s45
    s_waitcnt vmcnt(56)
    v_perm_b32 v231, v95, v94, v11
    v_accvgpr_write_b32 a203, v5
    v_accvgpr_write_b32 a207, v6
    s_add_u32 s17, s49, 1071360
    buffer_load_dword v40, v9, s[20:23], s17 offen
    buffer_load_dword v41, v10, s[20:23], s17 offen
    buffer_load_dword v42, v12, s[20:23], s17 offen
    buffer_load_dword v43, v13, s[20:23], s17 offen
    s_waitcnt vmcnt(58)
    v_perm_b32 v5, v97, v96, s44
    v_perm_b32 v6, v97, v96, s45
    s_waitcnt vmcnt(56)
    v_perm_b32 v232, v99, v98, v11
    v_accvgpr_write_b32 a208, v5
    v_accvgpr_write_b32 a212, v6
    s_add_u32 s17, s49, 1072512
    buffer_load_dword v44, v9, s[20:23], s17 offen
    buffer_load_dword v45, v10, s[20:23], s17 offen
    buffer_load_dword v46, v12, s[20:23], s17 offen
    buffer_load_dword v47, v13, s[20:23], s17 offen
    s_waitcnt vmcnt(58)
    v_perm_b32 v5, v101, v100, s44
    v_perm_b32 v6, v101, v100, s45
    s_waitcnt vmcnt(56)
    v_perm_b32 v233, v103, v102, v11
    v_accvgpr_write_b32 a209, v5
    v_accvgpr_write_b32 a213, v6
    s_add_u32 s17, s49, 1105920
    buffer_load_dword v48, v9, s[20:23], s17 offen
    buffer_load_dword v49, v10, s[20:23], s17 offen
    buffer_load_dword v50, v12, s[20:23], s17 offen
    buffer_load_dword v51, v13, s[20:23], s17 offen
    s_waitcnt vmcnt(58)
    v_perm_b32 v5, v105, v104, s44
    v_perm_b32 v6, v105, v104, s45
    s_waitcnt vmcnt(56)
    v_perm_b32 v234, v107, v106, v11
    v_accvgpr_write_b32 a210, v5
    v_accvgpr_write_b32 a214, v6
    s_add_u32 s17, s49, 1107072
    buffer_load_dword v52, v9, s[20:23], s17 offen
    buffer_load_dword v53, v10, s[20:23], s17 offen
    buffer_load_dword v54, v12, s[20:23], s17 offen
    buffer_load_dword v55, v13, s[20:23], s17 offen
    s_waitcnt vmcnt(58)
    v_perm_b32 v5, v109, v108, s44
    v_perm_b32 v6, v109, v108, s45
    s_waitcnt vmcnt(56)
    v_perm_b32 v235, v111, v110, v11
    v_accvgpr_write_b32 a211, v5
    v_accvgpr_write_b32 a215, v6
    s_add_u32 s17, s49, 1108224
    buffer_load_dword v56, v9, s[20:23], s17 offen
    buffer_load_dword v57, v10, s[20:23], s17 offen
    buffer_load_dword v58, v12, s[20:23], s17 offen
    buffer_load_dword v59, v13, s[20:23], s17 offen
    s_waitcnt vmcnt(58)
    v_perm_b32 v5, v113, v112, s44
    v_perm_b32 v6, v113, v112, s45
    s_waitcnt vmcnt(56)
    v_perm_b32 v236, v115, v114, v11
    v_accvgpr_write_b32 a216, v5
    v_accvgpr_write_b32 a220, v6
    s_add_u32 s17, s49, 1109376
    buffer_load_dword v60, v9, s[20:23], s17 offen
    buffer_load_dword v61, v10, s[20:23], s17 offen
    buffer_load_dword v62, v12, s[20:23], s17 offen
    buffer_load_dword v63, v13, s[20:23], s17 offen
    s_waitcnt vmcnt(58)
    v_perm_b32 v5, v117, v116, s44
    v_perm_b32 v6, v117, v116, s45
    s_waitcnt vmcnt(56)
    v_perm_b32 v237, v119, v118, v11
    v_accvgpr_write_b32 a217, v5
    v_accvgpr_write_b32 a221, v6
    s_add_u32 s17, s49, 1142784
    buffer_load_dword v64, v9, s[20:23], s17 offen
    buffer_load_dword v65, v10, s[20:23], s17 offen
    buffer_load_dword v66, v12, s[20:23], s17 offen
    buffer_load_dword v67, v13, s[20:23], s17 offen
    s_waitcnt vmcnt(58)
    v_perm_b32 v5, v121, v120, s44
    v_perm_b32 v6, v121, v120, s45
    s_waitcnt vmcnt(56)
    v_perm_b32 v238, v123, v122, v11
    v_accvgpr_write_b32 a218, v5
    v_accvgpr_write_b32 a222, v6
    s_add_u32 s17, s49, 1143936
    buffer_load_dword v68, v9, s[20:23], s17 offen
    buffer_load_dword v69, v10, s[20:23], s17 offen
    buffer_load_dword v70, v12, s[20:23], s17 offen
    buffer_load_dword v71, v13, s[20:23], s17 offen
    s_waitcnt vmcnt(58)
    v_perm_b32 v5, v125, v124, s44
    v_perm_b32 v6, v125, v124, s45
    s_waitcnt vmcnt(56)
    v_perm_b32 v239, v127, v126, v11
    v_accvgpr_write_b32 a219, v5
    v_accvgpr_write_b32 a223, v6
    s_add_u32 s17, s49, 1145088
    buffer_load_dword v72, v9, s[20:23], s17 offen
    buffer_load_dword v73, v10, s[20:23], s17 offen
    buffer_load_dword v74, v12, s[20:23], s17 offen
    buffer_load_dword v75, v13, s[20:23], s17 offen
    s_waitcnt vmcnt(58)
    v_perm_b32 v5, v17, v16, s44
    v_perm_b32 v6, v17, v16, s45
    s_waitcnt vmcnt(56)
    v_perm_b32 v240, v19, v18, v11
    v_accvgpr_write_b32 a224, v5
    v_accvgpr_write_b32 a228, v6
    s_add_u32 s17, s49, 1146240
    buffer_load_dword v76, v9, s[20:23], s17 offen
    buffer_load_dword v77, v10, s[20:23], s17 offen
    buffer_load_dword v78, v12, s[20:23], s17 offen
    buffer_load_dword v79, v13, s[20:23], s17 offen
    s_waitcnt vmcnt(58)
    v_perm_b32 v5, v21, v20, s44
    v_perm_b32 v6, v21, v20, s45
    s_waitcnt vmcnt(56)
    v_perm_b32 v241, v23, v22, v11
    v_accvgpr_write_b32 a225, v5
    v_accvgpr_write_b32 a229, v6
    s_waitcnt vmcnt(54)
    v_perm_b32 v5, v25, v24, s44
    v_perm_b32 v6, v25, v24, s45
    s_waitcnt vmcnt(52)
    v_perm_b32 v242, v27, v26, v11
    v_accvgpr_write_b32 a226, v5
    v_accvgpr_write_b32 a230, v6
    s_waitcnt vmcnt(50)
    v_perm_b32 v5, v29, v28, s44
    v_perm_b32 v6, v29, v28, s45
    s_waitcnt vmcnt(48)
    v_perm_b32 v243, v31, v30, v11
    v_accvgpr_write_b32 a227, v5
    v_accvgpr_write_b32 a231, v6
    s_waitcnt vmcnt(46)
    v_perm_b32 v5, v33, v32, s44
    v_perm_b32 v6, v33, v32, s45
    s_waitcnt vmcnt(44)
    v_perm_b32 v244, v35, v34, v11
    v_accvgpr_write_b32 a232, v5
    v_accvgpr_write_b32 a236, v6
    s_waitcnt vmcnt(42)
    v_perm_b32 v5, v37, v36, s44
    v_perm_b32 v6, v37, v36, s45
    s_waitcnt vmcnt(40)
    v_perm_b32 v245, v39, v38, v11
    v_accvgpr_write_b32 a233, v5
    v_accvgpr_write_b32 a237, v6
    s_waitcnt vmcnt(38)
    v_perm_b32 v5, v41, v40, s44
    v_perm_b32 v6, v41, v40, s45
    s_waitcnt vmcnt(36)
    v_perm_b32 v246, v43, v42, v11
    v_accvgpr_write_b32 a234, v5
    v_accvgpr_write_b32 a238, v6
    s_waitcnt vmcnt(34)
    v_perm_b32 v5, v45, v44, s44
    v_perm_b32 v6, v45, v44, s45
    s_waitcnt vmcnt(32)
    v_perm_b32 v247, v47, v46, v11
    v_accvgpr_write_b32 a235, v5
    v_accvgpr_write_b32 a239, v6
    s_waitcnt vmcnt(30)
    v_perm_b32 v5, v49, v48, s44
    v_perm_b32 v6, v49, v48, s45
    s_waitcnt vmcnt(28)
    v_perm_b32 v248, v51, v50, v11
    v_accvgpr_write_b32 a240, v5
    v_accvgpr_write_b32 a244, v6
    s_waitcnt vmcnt(26)
    v_perm_b32 v5, v53, v52, s44
    v_perm_b32 v6, v53, v52, s45
    s_waitcnt vmcnt(24)
    v_perm_b32 v249, v55, v54, v11
    v_accvgpr_write_b32 a241, v5
    v_accvgpr_write_b32 a245, v6
    s_waitcnt vmcnt(22)
    v_perm_b32 v5, v57, v56, s44
    v_perm_b32 v6, v57, v56, s45
    s_waitcnt vmcnt(20)
    v_perm_b32 v250, v59, v58, v11
    v_accvgpr_write_b32 a242, v5
    v_accvgpr_write_b32 a246, v6
    s_waitcnt vmcnt(18)
    v_perm_b32 v5, v61, v60, s44
    v_perm_b32 v6, v61, v60, s45
    s_waitcnt vmcnt(16)
    v_perm_b32 v251, v63, v62, v11
    v_accvgpr_write_b32 a243, v5
    v_accvgpr_write_b32 a247, v6
    s_waitcnt vmcnt(14)
    v_perm_b32 v5, v65, v64, s44
    v_perm_b32 v6, v65, v64, s45
    s_waitcnt vmcnt(12)
    v_perm_b32 v252, v67, v66, v11
    v_accvgpr_write_b32 a248, v5
    v_accvgpr_write_b32 a252, v6
    s_waitcnt vmcnt(10)
    v_perm_b32 v5, v69, v68, s44
    v_perm_b32 v6, v69, v68, s45
    s_waitcnt vmcnt(8)
    v_perm_b32 v253, v71, v70, v11
    v_accvgpr_write_b32 a249, v5
    v_accvgpr_write_b32 a253, v6
    s_waitcnt vmcnt(6)
    v_perm_b32 v5, v73, v72, s44
    v_perm_b32 v6, v73, v72, s45
    s_waitcnt vmcnt(4)
    v_perm_b32 v254, v75, v74, v11
    v_accvgpr_write_b32 a250, v5
    v_accvgpr_write_b32 a254, v6
    s_waitcnt vmcnt(2)
    v_perm_b32 v5, v77, v76, s44
    v_perm_b32 v6, v77, v76, s45
    s_waitcnt vmcnt(0)
    v_perm_b32 v255, v79, v78, v11
    v_accvgpr_write_b32 a251, v5
    v_accvgpr_write_b32 a255, v6
    s_and_b32 s51, s14, 1
    s_lshl_b32 s17, s51, 4
    v_add_u32 v5, s17, v7
    v_lshlrev_b32 v14, 4, v5
    v_mul_u32_u24 v13, 1152, v5
    s_mul_i32 s17, s50, 96
    v_add_u32 v13, s17, v13
    s_mul_i32 s17, s50, 3072
    v_add_u32 v12, s17, v14
    s_lshl_b32 s17, s50, 9
    v_add_u32 v14, s17, v14
    s_lshl_b32 s49, s50, 7
    s_lshl_b32 s17, s14, 2
    s_add_u32 s49, s49, s17
    s_add_u32 s49, s49, 1622016
    s_mul_i32 s17, s14, 6144
    v_add_u32 v48, s17, v0
    v_mov_b32 v49, 0x10000
    v_lshrrev_b32 v51, 4, v0
    v_min_u32 v51, 42, v51
    s_mul_i32 s17, s50, 43
    v_add_u32 v51, s17, v51
    v_lshlrev_b32 v51, 7, v51
    s_cmp_gt_u32 s14, 1
    s_cbranch_scc1 Ltw_z
    v_lshl_add_u32 v12, v8, 9, v12
    v_lshl_add_u32 v13, v8, 4, v13
    s_lshl_b32 s58, s14, 16
    s_add_u32 s58, s58, 144703488
    s_mov_b32 s43, 0
    s_mov_b32 s28, s8
    s_mov_b32 s29, s9
    s_mov_b32 s30, 0
    s_mov_b32 s31, 0x00020000
    s_mul_i32 s17, s51, 3072
    v_add_u32 v50, s17, v0
    ds_write2_b32 v49, v4, v4 offset0:0 offset1:1
    s_waitcnt lgkmcnt(0)
    s_cmp_lg_u32 s14, 0
    s_cbranch_scc1 LtwX_ini_d
    v_mov_b32 v5, 160
    s_mov_b32 s16, 0
LtwX_ini:
    global_load_dword v6, v5, s[12:13] sc1
    s_add_u32 s16, s16, 1
    s_cmp_gt_u32 s16, 100000
    s_cbranch_scc1 L_role_tw_abort
    s_waitcnt vmcnt(0)
    v_cmp_gt_u32 vcc, 123, v6
    s_nop 0
    s_cbranch_vccz LtwX_ini_d
    s_sleep 8
    s_branch LtwX_ini
LtwX_ini_d:
    s_barrier
LtwX_idle:
    s_cmp_lg_u32 s14, 0
    s_cbranch_scc1 LtwX_nw0
    s_mul_i32 s60, s32, 22528
    s_add_u32 s60, s60, 184448
    s_cmp_lt_u32 s32, 64
    s_cselect_b32 s60, s60, 3080192
    s_mul_i32 s61, s33, 22528
    s_add_u32 s61, s61, 1626240
    s_cmp_lt_u32 s33, 64
    s_cselect_b32 s61, s61, 3080192
    s_mov_b32 s16, 0
LtwX_p_1:
    buffer_load_dword v2, v1, s[8:11], s60 offen sc1
    buffer_load_dword v15, v1, s[8:11], s61 offen sc1
    s_add_u32 s16, s16, 1
    s_cmp_gt_u32 s16, 100000
    s_cbranch_scc1 L_role_tw_abort
    s_waitcnt vmcnt(1)
    v_cmp_eq_u32 vcc, 0, v2
    s_waitcnt vmcnt(0)
    v_cmp_eq_u32 s[54:55], 0, v15
    s_nop 0
    s_cmp_eq_u64 s[54:55], 0
    s_cselect_b32 s62, 2, 0
    s_cmp_eq_u64 vcc, 0
    s_cselect_b32 s62, 1, s62
    s_cmp_lg_u32 s62, 0
    s_cbranch_scc1 LtwX_p_1d
    s_sleep 4
    s_branch LtwX_p_1
LtwX_p_1d:
    v_mov_b32 v5, s62
    ds_write_b32 v49, v5
    s_waitcnt lgkmcnt(0)
LtwX_nw0:
    s_barrier
    ds_read_b32 v6, v49
    v_xor_b32 v49, 4, v49
    s_waitcnt lgkmcnt(0)
    v_readfirstlane_b32 s62, v6
    s_nop 0
    s_cmp_eq_u32 s62, 0
    s_cbranch_scc1 L_role_tw_abort
    s_cmp_lt_u32 s33, 33
    s_cselect_b32 s38, 1, 3
    s_cmp_eq_u32 s62, 2
    s_cselect_b32 s36, 1, 0
    s_cselect_b32 s37, s33, s32
    s_cselect_b32 s17, s38, 0
    s_add_u32 s33, s33, s17
    s_cmp_eq_u32 s62, 1
    s_cselect_b32 s17, 2, 0
    s_add_u32 s32, s32, s17
    s_lshl_b32 s56, s36, 6
    s_add_u32 s56, s56, s37
    s_lshl_b32 s46, s56, 18
    s_add_u32 s46, s46, s58
    s_mul_i32 s41, s36, 4718592
    s_mul_i32 s17, s37, 36864
    s_add_u32 s41, s41, s17
    s_add_u32 s41, s41, 8650752
    s_cmp_ge_u32 s37, 64
    s_cbranch_scc1 L_role_tw_abort
    buffer_load_dword v10, v51, s[8:11], s46 offen
    s_add_u32 s48, s46, 0
    buffer_load_dwordx4 v[64:67], v0, s[8:11], s48 offen offset:0
    buffer_load_dwordx4 v[68:71], v0, s[8:11], s48 offen offset:1024
    buffer_load_dwordx4 v[72:75], v0, s[8:11], s48 offen offset:2048
    buffer_load_dwordx4 v[76:79], v0, s[8:11], s48 offen offset:3072
    s_add_u32 s48, s46, 4096
    buffer_load_dwordx4 v[80:83], v0, s[8:11], s48 offen offset:0
    buffer_load_dwordx4 v[84:87], v0, s[8:11], s48 offen offset:1024
    buffer_load_dwordx4 v[88:91], v0, s[8:11], s48 offen offset:2048
    buffer_load_dwordx4 v[92:95], v0, s[8:11], s48 offen offset:3072
    s_add_u32 s48, s46, 8192
    buffer_load_dwordx4 v[96:99], v0, s[8:11], s48 offen offset:0
    buffer_load_dwordx4 v[100:103], v0, s[8:11], s48 offen offset:1024
    buffer_load_dwordx4 v[104:107], v0, s[8:11], s48 offen offset:2048
    buffer_load_dwordx4 v[108:111], v0, s[8:11], s48 offen offset:3072
    s_add_u32 s48, s46, 12288
    buffer_load_dwordx4 v[112:115], v0, s[8:11], s48 offen offset:0
    buffer_load_dwordx4 v[116:119], v0, s[8:11], s48 offen offset:1024
    buffer_load_dwordx4 v[120:123], v0, s[8:11], s48 offen offset:2048
    buffer_load_dwordx4 v[40:43], v12, s[8:11], s41 offen
LtwX_item:
    s_mov_b32 s34, s36
    s_mov_b32 s35, s37
    s_mov_b32 s47, s41
    buffer_load_dwordx4 v[124:127], v0, s[8:11], s48 offen offset:3072
    s_waitcnt vmcnt(16)
    v_mfma_f32_16x16x32_bf16 v[16:19], a[0:3], v[64:67], 0
    v_mfma_f32_16x16x32_bf16 v[20:23], a[4:7], v[64:67], 0
    v_mfma_f32_16x16x32_bf16 v[24:27], v[128:131], v[64:67], 0
    s_add_u32 s48, s46, 16384
    buffer_load_dwordx4 v[64:67], v0, s[8:11], s48 offen offset:0
    s_waitcnt vmcnt(16)
    v_mfma_f32_16x16x32_bf16 v[28:31], a[0:3], v[68:71], 0
    v_mfma_f32_16x16x32_bf16 v[32:35], a[4:7], v[68:71], 0
    v_mfma_f32_16x16x32_bf16 v[36:39], v[128:131], v[68:71], 0
    buffer_load_dwordx4 v[68:71], v0, s[8:11], s48 offen offset:1024
    s_waitcnt vmcnt(16)
    v_mfma_f32_16x16x32_bf16 v[16:19], a[8:11], v[72:75], v[16:19]
    v_mfma_f32_16x16x32_bf16 v[20:23], a[12:15], v[72:75], v[20:23]
    v_mfma_f32_16x16x32_bf16 v[24:27], v[132:135], v[72:75], v[24:27]
    buffer_load_dwordx4 v[72:75], v0, s[8:11], s48 offen offset:2048
    s_waitcnt vmcnt(16)
    v_mfma_f32_16x16x32_bf16 v[28:31], a[8:11], v[76:79], v[28:31]
    v_mfma_f32_16x16x32_bf16 v[32:35], a[12:15], v[76:79], v[32:35]
    v_mfma_f32_16x16x32_bf16 v[36:39], v[132:135], v[76:79], v[36:39]
    buffer_load_dwordx4 v[76:79], v0, s[8:11], s48 offen offset:3072
    s_waitcnt vmcnt(16)
    v_mfma_f32_16x16x32_bf16 v[16:19], a[16:19], v[80:83], v[16:19]
    v_mfma_f32_16x16x32_bf16 v[20:23], a[20:23], v[80:83], v[20:23]
    v_mfma_f32_16x16x32_bf16 v[24:27], v[136:139], v[80:83], v[24:27]
    s_add_u32 s48, s46, 20480
    buffer_load_dwordx4 v[80:83], v0, s[8:11], s48 offen offset:0
    s_waitcnt vmcnt(16)
    v_mfma_f32_16x16x32_bf16 v[28:31], a[16:19], v[84:87], v[28:31]
    v_mfma_f32_16x16x32_bf16 v[32:35], a[20:23], v[84:87], v[32:35]
    v_mfma_f32_16x16x32_bf16 v[36:39], v[136:139], v[84:87], v[36:39]
    buffer_load_dwordx4 v[84:87], v0, s[8:11], s48 offen offset:1024
    s_waitcnt vmcnt(16)
    v_mfma_f32_16x16x32_bf16 v[16:19], a[24:27], v[88:91], v[16:19]
    v_mfma_f32_16x16x32_bf16 v[20:23], a[28:31], v[88:91], v[20:23]
    v_mfma_f32_16x16x32_bf16 v[24:27], v[140:143], v[88:91], v[24:27]
    buffer_load_dwordx4 v[88:91], v0, s[8:11], s48 offen offset:2048
    s_waitcnt vmcnt(16)
    v_mfma_f32_16x16x32_bf16 v[28:31], a[24:27], v[92:95], v[28:31]
    v_mfma_f32_16x16x32_bf16 v[32:35], a[28:31], v[92:95], v[32:35]
    v_mfma_f32_16x16x32_bf16 v[36:39], v[140:143], v[92:95], v[36:39]
    buffer_load_dwordx4 v[92:95], v0, s[8:11], s48 offen offset:3072
    s_waitcnt vmcnt(16)
    v_mfma_f32_16x16x32_bf16 v[16:19], a[32:35], v[96:99], v[16:19]
    v_mfma_f32_16x16x32_bf16 v[20:23], a[36:39], v[96:99], v[20:23]
    v_mfma_f32_16x16x32_bf16 v[24:27], v[144:147], v[96:99], v[24:27]
    s_add_u32 s48, s46, 24576
    buffer_load_dwordx4 v[96:99], v0, s[8:11], s48 offen offset:0
    s_waitcnt vmcnt(16)
    v_mfma_f32_16x16x32_bf16 v[28:31], a[32:35], v[100:103], v[28:31]
    v_mfma_f32_16x16x32_bf16 v[32:35], a[36:39], v[100:103], v[32:35]
    v_mfma_f32_16x16x32_bf16 v[36:39], v[144:147], v[100:103], v[36:39]
    buffer_load_dwordx4 v[100:103], v0, s[8:11], s48 offen offset:1024
    s_waitcnt vmcnt(16)
    v_mfma_f32_16x16x32_bf16 v[16:19], a[40:43], v[104:107], v[16:19]
    v_mfma_f32_16x16x32_bf16 v[20:23], a[44:47], v[104:107], v[20:23]
    v_mfma_f32_16x16x32_bf16 v[24:27], v[148:151], v[104:107], v[24:27]
    buffer_load_dwordx4 v[104:107], v0, s[8:11], s48 offen offset:2048
    s_waitcnt vmcnt(16)
    v_mfma_f32_16x16x32_bf16 v[28:31], a[40:43], v[108:111], v[28:31]
    v_mfma_f32_16x16x32_bf16 v[32:35], a[44:47], v[108:111], v[32:35]
    v_mfma_f32_16x16x32_bf16 v[36:39], v[148:151], v[108:111], v[36:39]
    buffer_load_dwordx4 v[108:111], v0, s[8:11], s48 offen offset:3072
    s_waitcnt vmcnt(16)
    v_mfma_f32_16x16x32_bf16 v[16:19], a[48:51], v[112:115], v[16:19]
    v_mfma_f32_16x16x32_bf16 v[20:23], a[52:55], v[112:115], v[20:23]
    v_mfma_f32_16x16x32_bf16 v[24:27], v[152:155], v[112:115], v[24:27]
    s_add_u32 s48, s46, 28672
    buffer_load_dwordx4 v[112:115], v0, s[8:11], s48 offen offset:0
    s_waitcnt vmcnt(16)
    v_mfma_f32_16x16x32_bf16 v[28:31], a[48:51], v[116:119], v[28:31]
    v_mfma_f32_16x16x32_bf16 v[32:35], a[52:55], v[116:119], v[32:35]
    v_mfma_f32_16x16x32_bf16 v[36:39], v[152:155], v[116:119], v[36:39]
    buffer_load_dwordx4 v[116:119], v0, s[8:11], s48 offen offset:1024
    s_waitcnt vmcnt(16)
    v_mfma_f32_16x16x32_bf16 v[16:19], a[56:59], v[120:123], v[16:19]
    v_mfma_f32_16x16x32_bf16 v[20:23], a[60:63], v[120:123], v[20:23]
    v_mfma_f32_16x16x32_bf16 v[24:27], v[156:159], v[120:123], v[24:27]
    buffer_load_dwordx4 v[120:123], v0, s[8:11], s48 offen offset:2048
    s_waitcnt vmcnt(15)
    v_mfma_f32_16x16x32_bf16 v[28:31], a[56:59], v[124:127], v[28:31]
    v_mfma_f32_16x16x32_bf16 v[32:35], a[60:63], v[124:127], v[32:35]
    v_mfma_f32_16x16x32_bf16 v[36:39], v[156:159], v[124:127], v[36:39]
    buffer_load_dwordx4 v[124:127], v0, s[8:11], s48 offen offset:3072
    s_waitcnt vmcnt(15)
    v_mfma_f32_16x16x32_bf16 v[16:19], a[64:67], v[64:67], v[16:19]
    v_mfma_f32_16x16x32_bf16 v[20:23], a[68:71], v[64:67], v[20:23]
    v_mfma_f32_16x16x32_bf16 v[24:27], v[160:163], v[64:67], v[24:27]
    s_add_u32 s48, s46, 32768
    buffer_load_dwordx4 v[64:67], v0, s[8:11], s48 offen offset:0
    s_waitcnt vmcnt(15)
    v_mfma_f32_16x16x32_bf16 v[28:31], a[64:67], v[68:71], v[28:31]
    v_mfma_f32_16x16x32_bf16 v[32:35], a[68:71], v[68:71], v[32:35]
    v_mfma_f32_16x16x32_bf16 v[36:39], v[160:163], v[68:71], v[36:39]
    s_cmp_lg_u32 s43, 0
    s_cselect_b64 exec, 1, 0
    buffer_store_dword v3, v4, s[8:11], s43 offen sc1
    s_mov_b64 exec, -1
    s_mov_b32 s43, 0
    buffer_load_dwordx4 v[68:71], v0, s[8:11], s48 offen offset:1024
    s_waitcnt vmcnt(16)
    v_mfma_f32_16x16x32_bf16 v[16:19], a[72:75], v[72:75], v[16:19]
    v_mfma_f32_16x16x32_bf16 v[20:23], a[76:79], v[72:75], v[20:23]
    v_mfma_f32_16x16x32_bf16 v[24:27], v[164:167], v[72:75], v[24:27]
    buffer_load_dwordx4 v[72:75], v0, s[8:11], s48 offen offset:2048
    s_waitcnt vmcnt(16)
    v_mfma_f32_16x16x32_bf16 v[28:31], a[72:75], v[76:79], v[28:31]
    v_mfma_f32_16x16x32_bf16 v[32:35], a[76:79], v[76:79], v[32:35]
    v_mfma_f32_16x16x32_bf16 v[36:39], v[164:167], v[76:79], v[36:39]
    buffer_load_dwordx4 v[76:79], v0, s[8:11], s48 offen offset:3072
    s_waitcnt vmcnt(16)
    v_mfma_f32_16x16x32_bf16 v[16:19], a[80:83], v[80:83], v[16:19]
    v_mfma_f32_16x16x32_bf16 v[20:23], a[84:87], v[80:83], v[20:23]
    v_mfma_f32_16x16x32_bf16 v[24:27], v[168:171], v[80:83], v[24:27]
    s_add_u32 s48, s46, 36864
    buffer_load_dwordx4 v[80:83], v0, s[8:11], s48 offen offset:0
    s_waitcnt vmcnt(16)
    v_mfma_f32_16x16x32_bf16 v[28:31], a[80:83], v[84:87], v[28:31]
    v_mfma_f32_16x16x32_bf16 v[32:35], a[84:87], v[84:87], v[32:35]
    v_mfma_f32_16x16x32_bf16 v[36:39], v[168:171], v[84:87], v[36:39]
    buffer_load_dwordx4 v[84:87], v0, s[8:11], s48 offen offset:1024
    s_waitcnt vmcnt(16)
    v_mfma_f32_16x16x32_bf16 v[16:19], a[88:91], v[88:91], v[16:19]
    v_mfma_f32_16x16x32_bf16 v[20:23], a[92:95], v[88:91], v[20:23]
    v_mfma_f32_16x16x32_bf16 v[24:27], v[172:175], v[88:91], v[24:27]
    buffer_load_dwordx4 v[88:91], v0, s[8:11], s48 offen offset:2048
    s_waitcnt vmcnt(16)
    v_mfma_f32_16x16x32_bf16 v[28:31], a[88:91], v[92:95], v[28:31]
    v_mfma_f32_16x16x32_bf16 v[32:35], a[92:95], v[92:95], v[32:35]
    v_mfma_f32_16x16x32_bf16 v[36:39], v[172:175], v[92:95], v[36:39]
    buffer_load_dwordx4 v[92:95], v0, s[8:11], s48 offen offset:3072
    s_waitcnt vmcnt(16)
    v_mfma_f32_16x16x32_bf16 v[16:19], a[96:99], v[96:99], v[16:19]
    v_mfma_f32_16x16x32_bf16 v[20:23], a[100:103], v[96:99], v[20:23]
    v_mfma_f32_16x16x32_bf16 v[24:27], v[176:179], v[96:99], v[24:27]
    s_add_u32 s48, s46, 40960
    buffer_load_dwordx4 v[96:99], v0, s[8:11], s48 offen offset:0
    s_waitcnt vmcnt(16)
    v_mfma_f32_16x16x32_bf16 v[28:31], a[96:99], v[100:103], v[28:31]
    v_mfma_f32_16x16x32_bf16 v[32:35], a[100:103], v[100:103], v[32:35]
    v_mfma_f32_16x16x32_bf16 v[36:39], v[176:179], v[100:103], v[36:39]
    buffer_load_dwordx4 v[100:103], v0, s[8:11], s48 offen offset:1024
    s_waitcnt vmcnt(16)
    v_mfma_f32_16x16x32_bf16 v[16:19], a[104:107], v[104:107], v[16:19]
    v_mfma_f32_16x16x32_bf16 v[20:23], a[108:111], v[104:107], v[20:23]
    v_mfma_f32_16x16x32_bf16 v[24:27], v[180:183], v[104:107], v[24:27]
    s_cmp_lg_u32 s14, 0
    s_cbranch_scc1 LtwX_nw1
    s_mul_i32 s60, s32, 22528
    s_add_u32 s60, s60, 184448
    s_cmp_lt_u32 s32, 64
    s_cselect_b32 s60, s60, 3080192
    s_mul_i32 s61, s33, 22528
    s_add_u32 s61, s61, 1626240
    s_cmp_lt_u32 s33, 64
    s_cselect_b32 s61, s61, 3080192
    buffer_load_dword v2, v1, s[8:11], s60 offen sc1
    buffer_load_dword v15, v1, s[8:11], s61 offen sc1
LtwX_nw1:
    buffer_load_dwordx4 v[104:107], v0, s[8:11], s48 offen offset:2048
    s_waitcnt vmcnt(16)
    v_mfma_f32_16x16x32_bf16 v[28:31], a[104:107], v[108:111], v[28:31]
    v_mfma_f32_16x16x32_bf16 v[32:35], a[108:111], v[108:111], v[32:35]
    v_mfma_f32_16x16x32_bf16 v[36:39], v[180:183], v[108:111], v[36:39]
    buffer_load_dwordx4 v[108:111], v0, s[8:11], s48 offen offset:3072
    s_waitcnt vmcnt(16)
    v_mfma_f32_16x16x32_bf16 v[16:19], a[112:115], v[112:115], v[16:19]
    v_mfma_f32_16x16x32_bf16 v[20:23], a[116:119], v[112:115], v[20:23]
    v_mfma_f32_16x16x32_bf16 v[24:27], v[184:187], v[112:115], v[24:27]
    s_add_u32 s48, s46, 45056
    buffer_load_dwordx4 v[112:115], v0, s[8:11], s48 offen offset:0
    s_waitcnt vmcnt(16)
    v_mfma_f32_16x16x32_bf16 v[28:31], a[112:115], v[116:119], v[28:31]
    v_mfma_f32_16x16x32_bf16 v[32:35], a[116:119], v[116:119], v[32:35]
    v_mfma_f32_16x16x32_bf16 v[36:39], v[184:187], v[116:119], v[36:39]
    buffer_load_dwordx4 v[116:119], v0, s[8:11], s48 offen offset:1024
    s_waitcnt vmcnt(16)
    v_mfma_f32_16x16x32_bf16 v[16:19], a[120:123], v[120:123], v[16:19]
    v_mfma_f32_16x16x32_bf16 v[20:23], a[124:127], v[120:123], v[20:23]
    v_mfma_f32_16x16x32_bf16 v[24:27], v[188:191], v[120:123], v[24:27]
    buffer_load_dwordx4 v[120:123], v0, s[8:11], s48 offen offset:2048
    s_waitcnt vmcnt(16)
    v_mfma_f32_16x16x32_bf16 v[28:31], a[120:123], v[124:127], v[28:31]
    v_mfma_f32_16x16x32_bf16 v[32:35], a[124:127], v[124:127], v[32:35]
    v_mfma_f32_16x16x32_bf16 v[36:39], v[188:191], v[124:127], v[36:39]
    buffer_load_dwordx4 v[124:127], v0, s[8:11], s48 offen offset:3072
    s_waitcnt vmcnt(16)
    v_mfma_f32_16x16x32_bf16 v[16:19], a[128:131], v[64:67], v[16:19]
    v_mfma_f32_16x16x32_bf16 v[20:23], a[132:135], v[64:67], v[20:23]
    v_mfma_f32_16x16x32_bf16 v[24:27], v[192:195], v[64:67], v[24:27]
    s_add_u32 s48, s46, 49152
    buffer_load_dwordx4 v[64:67], v0, s[8:11], s48 offen offset:0
    s_waitcnt vmcnt(15)
    v_mfma_f32_16x16x32_bf16 v[28:31], a[128:131], v[68:71], v[28:31]
    v_mfma_f32_16x16x32_bf16 v[32:35], a[132:135], v[68:71], v[32:35]
    v_mfma_f32_16x16x32_bf16 v[36:39], v[192:195], v[68:71], v[36:39]
    buffer_load_dwordx4 v[68:71], v0, s[8:11], s48 offen offset:1024
    s_waitcnt vmcnt(15)
    v_mfma_f32_16x16x32_bf16 v[16:19], a[136:139], v[72:75], v[16:19]
    v_mfma_f32_16x16x32_bf16 v[20:23], a[140:143], v[72:75], v[20:23]
    v_mfma_f32_16x16x32_bf16 v[24:27], v[196:199], v[72:75], v[24:27]
    buffer_load_dwordx4 v[72:75], v0, s[8:11], s48 offen offset:2048
    s_waitcnt vmcnt(15)
    v_mfma_f32_16x16x32_bf16 v[28:31], a[136:139], v[76:79], v[28:31]
    v_mfma_f32_16x16x32_bf16 v[32:35], a[140:143], v[76:79], v[32:35]
    v_mfma_f32_16x16x32_bf16 v[36:39], v[196:199], v[76:79], v[36:39]
    buffer_load_dwordx4 v[76:79], v0, s[8:11], s48 offen offset:3072
    s_waitcnt vmcnt(15)
    v_mfma_f32_16x16x32_bf16 v[16:19], a[144:147], v[80:83], v[16:19]
    v_mfma_f32_16x16x32_bf16 v[20:23], a[148:151], v[80:83], v[20:23]
    v_mfma_f32_16x16x32_bf16 v[24:27], v[200:203], v[80:83], v[24:27]
    s_add_u32 s48, s46, 53248
    buffer_load_dwordx4 v[80:83], v0, s[8:11], s48 offen offset:0
    s_waitcnt vmcnt(15)
    v_mfma_f32_16x16x32_bf16 v[28:31], a[144:147], v[84:87], v[28:31]
    v_mfma_f32_16x16x32_bf16 v[32:35], a[148:151], v[84:87], v[32:35]
    v_mfma_f32_16x16x32_bf16 v[36:39], v[200:203], v[84:87], v[36:39]
    buffer_load_dwordx4 v[84:87], v0, s[8:11], s48 offen offset:1024
    s_waitcnt vmcnt(15)
    v_mfma_f32_16x16x32_bf16 v[16:19], a[152:155], v[88:91], v[16:19]
    v_mfma_f32_16x16x32_bf16 v[20:23], a[156:159], v[88:91], v[20:23]
    v_mfma_f32_16x16x32_bf16 v[24:27], v[204:207], v[88:91], v[24:27]
    buffer_load_dwordx4 v[88:91], v0, s[8:11], s48 offen offset:2048
    s_waitcnt vmcnt(15)
    v_mfma_f32_16x16x32_bf16 v[28:31], a[152:155], v[92:95], v[28:31]
    v_mfma_f32_16x16x32_bf16 v[32:35], a[156:159], v[92:95], v[32:35]
    v_mfma_f32_16x16x32_bf16 v[36:39], v[204:207], v[92:95], v[36:39]
    buffer_load_dwordx4 v[92:95], v0, s[8:11], s48 offen offset:3072
    s_waitcnt vmcnt(15)
    v_mfma_f32_16x16x32_bf16 v[16:19], a[160:163], v[96:99], v[16:19]
    v_mfma_f32_16x16x32_bf16 v[20:23], a[164:167], v[96:99], v[20:23]
    v_mfma_f32_16x16x32_bf16 v[24:27], v[208:211], v[96:99], v[24:27]
    s_add_u32 s48, s46, 57344
    buffer_load_dwordx4 v[96:99], v0, s[8:11], s48 offen offset:0
    s_waitcnt vmcnt(15)
    v_mfma_f32_16x16x32_bf16 v[28:31], a[160:163], v[100:103], v[28:31]
    v_mfma_f32_16x16x32_bf16 v[32:35], a[164:167], v[100:103], v[32:35]
    v_mfma_f32_16x16x32_bf16 v[36:39], v[208:211], v[100:103], v[36:39]
    buffer_load_dwordx4 v[100:103], v0, s[8:11], s48 offen offset:1024
    s_waitcnt vmcnt(15)
    v_mfma_f32_16x16x32_bf16 v[16:19], a[168:171], v[104:107], v[16:19]
    v_mfma_f32_16x16x32_bf16 v[20:23], a[172:175], v[104:107], v[20:23]
    v_mfma_f32_16x16x32_bf16 v[24:27], v[212:215], v[104:107], v[24:27]
    buffer_load_dwordx4 v[104:107], v0, s[8:11], s48 offen offset:2048
    s_waitcnt vmcnt(15)
    v_mfma_f32_16x16x32_bf16 v[28:31], a[168:171], v[108:111], v[28:31]
    v_mfma_f32_16x16x32_bf16 v[32:35], a[172:175], v[108:111], v[32:35]
    v_mfma_f32_16x16x32_bf16 v[36:39], v[212:215], v[108:111], v[36:39]
    buffer_load_dwordx4 v[108:111], v0, s[8:11], s48 offen offset:3072
    s_waitcnt vmcnt(15)
    v_mfma_f32_16x16x32_bf16 v[16:19], a[176:179], v[112:115], v[16:19]
    v_mfma_f32_16x16x32_bf16 v[20:23], a[180:183], v[112:115], v[20:23]
    v_mfma_f32_16x16x32_bf16 v[24:27], v[216:219], v[112:115], v[24:27]
    s_cmp_lg_u32 s14, 0
    s_cbranch_scc1 LtwX_nw2
    v_cmp_eq_u32 vcc, 0, v2
    v_cmp_eq_u32 s[54:55], 0, v15
    s_nop 0
    s_cmp_eq_u64 s[54:55], 0
    s_cselect_b32 s62, 2, 0
    s_cmp_eq_u64 vcc, 0
    s_cselect_b32 s62, 1, s62
    v_mov_b32 v5, s62
    ds_write_b32 v49, v5
    s_waitcnt lgkmcnt(0)
LtwX_nw2:
    s_barrier
    ds_read_b32 v6, v49
    v_xor_b32 v49, 4, v49
    s_add_u32 s48, s46, 61440
    buffer_load_dwordx4 v[112:115], v0, s[8:11], s48 offen offset:0
    s_waitcnt vmcnt(15)
    v_mfma_f32_16x16x32_bf16 v[28:31], a[176:179], v[116:119], v[28:31]
    v_mfma_f32_16x16x32_bf16 v[32:35], a[180:183], v[116:119], v[32:35]
    v_mfma_f32_16x16x32_bf16 v[36:39], v[216:219], v[116:119], v[36:39]
    buffer_load_dwordx4 v[116:119], v0, s[8:11], s48 offen offset:1024
    s_waitcnt vmcnt(15)
    v_mfma_f32_16x16x32_bf16 v[16:19], a[184:187], v[120:123], v[16:19]
    v_mfma_f32_16x16x32_bf16 v[20:23], a[188:191], v[120:123], v[20:23]
    v_mfma_f32_16x16x32_bf16 v[24:27], v[220:223], v[120:123], v[24:27]
    buffer_load_dwordx4 v[120:123], v0, s[8:11], s48 offen offset:2048
    s_waitcnt vmcnt(15)
    v_mfma_f32_16x16x32_bf16 v[28:31], a[184:187], v[124:127], v[28:31]
    v_mfma_f32_16x16x32_bf16 v[32:35], a[188:191], v[124:127], v[32:35]
    v_mfma_f32_16x16x32_bf16 v[36:39], v[220:223], v[124:127], v[36:39]
    s_waitcnt lgkmcnt(0)
    v_readfirstlane_b32 s62, v6
    s_cmp_lt_u32 s33, 33
    s_cselect_b32 s38, 1, 3
    s_cmp_eq_u32 s62, 2
    s_cselect_b32 s36, 1, 0
    s_cselect_b32 s37, s33, s32
    s_cselect_b32 s17, s38, 0
    s_add_u32 s33, s33, s17
    s_cmp_eq_u32 s62, 1
    s_cselect_b32 s17, 2, 0
    s_add_u32 s32, s32, s17
    s_lshl_b32 s56, s36, 6
    s_add_u32 s56, s56, s37
    buffer_load_dwordx4 v[124:127], v0, s[8:11], s48 offen offset:3072
    s_waitcnt vmcnt(15)
    v_mfma_f32_16x16x32_bf16 v[16:19], a[192:195], v[64:67], v[16:19]
    v_mfma_f32_16x16x32_bf16 v[20:23], a[196:199], v[64:67], v[20:23]
    v_mfma_f32_16x16x32_bf16 v[24:27], v[224:227], v[64:67], v[24:27]
    s_cmp_lt_u32 s37, 64
    s_cselect_b32 s62, s62, 0
    s_lshl_b32 s46, s56, 18
    s_add_u32 s46, s46, s58
    s_mul_i32 s41, s36, 4718592
    s_mul_i32 s17, s37, 36864
    s_add_u32 s41, s41, s17
    s_add_u32 s41, s41, 8650752
    s_cmp_lg_u32 s62, 0
    s_cselect_b32 s30, 268435456, 0
    buffer_load_dword v10, v51, s[28:31], s46 offen
    s_add_u32 s48, s46, 0
    buffer_load_dwordx4 v[64:67], v0, s[28:31], s48 offen offset:0
    s_waitcnt vmcnt(15)
    v_mfma_f32_16x16x32_bf16 v[28:31], a[192:195], v[68:71], v[28:31]
    v_mfma_f32_16x16x32_bf16 v[32:35], a[196:199], v[68:71], v[32:35]
    v_mfma_f32_16x16x32_bf16 v[36:39], v[224:227], v[68:71], v[36:39]
    buffer_load_dwordx4 v[68:71], v0, s[28:31], s48 offen offset:1024
    s_waitcnt vmcnt(15)
    v_mfma_f32_16x16x32_bf16 v[16:19], a[200:203], v[72:75], v[16:19]
    v_mfma_f32_16x16x32_bf16 v[20:23], a[204:207], v[72:75], v[20:23]
    v_mfma_f32_16x16x32_bf16 v[24:27], v[228:231], v[72:75], v[24:27]
    buffer_load_dwordx4 v[72:75], v0, s[28:31], s48 offen offset:2048
    s_waitcnt vmcnt(15)
    v_mfma_f32_16x16x32_bf16 v[28:31], a[200:203], v[76:79], v[28:31]
    v_mfma_f32_16x16x32_bf16 v[32:35], a[204:207], v[76:79], v[32:35]
    v_mfma_f32_16x16x32_bf16 v[36:39], v[228:231], v[76:79], v[36:39]
    buffer_load_dwordx4 v[76:79], v0, s[28:31], s48 offen offset:3072
    s_waitcnt vmcnt(15)
    v_mfma_f32_16x16x32_bf16 v[16:19], a[208:211], v[80:83], v[16:19]
    v_mfma_f32_16x16x32_bf16 v[20:23], a[212:215], v[80:83], v[20:23]
    v_mfma_f32_16x16x32_bf16 v[24:27], v[232:235], v[80:83], v[24:27]
    s_add_u32 s48, s46, 4096
    buffer_load_dwordx4 v[80:83], v0, s[28:31], s48 offen offset:0
    s_waitcnt vmcnt(15)
    v_mfma_f32_16x16x32_bf16 v[28:31], a[208:211], v[84:87], v[28:31]
    v_mfma_f32_16x16x32_bf16 v[32:35], a[212:215], v[84:87], v[32:35]
    v_mfma_f32_16x16x32_bf16 v[36:39], v[232:235], v[84:87], v[36:39]
    buffer_load_dwordx4 v[84:87], v0, s[28:31], s48 offen offset:1024
    s_waitcnt vmcnt(15)
    v_mfma_f32_16x16x32_bf16 v[16:19], a[216:219], v[88:91], v[16:19]
    v_mfma_f32_16x16x32_bf16 v[20:23], a[220:223], v[88:91], v[20:23]
    v_mfma_f32_16x16x32_bf16 v[24:27], v[236:239], v[88:91], v[24:27]
    buffer_load_dwordx4 v[88:91], v0, s[28:31], s48 offen offset:2048
    s_waitcnt vmcnt(15)
    v_mfma_f32_16x16x32_bf16 v[28:31], a[216:219], v[92:95], v[28:31]
    v_mfma_f32_16x16x32_bf16 v[32:35], a[220:223], v[92:95], v[32:35]
    v_mfma_f32_16x16x32_bf16 v[36:39], v[236:239], v[92:95], v[36:39]
    buffer_load_dwordx4 v[92:95], v0, s[28:31], s48 offen offset:3072
    s_waitcnt vmcnt(15)
    v_mfma_f32_16x16x32_bf16 v[16:19], a[224:227], v[96:99], v[16:19]
    v_mfma_f32_16x16x32_bf16 v[20:23], a[228:231], v[96:99], v[20:23]
    v_mfma_f32_16x16x32_bf16 v[24:27], v[240:243], v[96:99], v[24:27]
    s_add_u32 s48, s46, 8192
    buffer_load_dwordx4 v[96:99], v0, s[28:31], s48 offen offset:0
    s_waitcnt vmcnt(15)
    v_mfma_f32_16x16x32_bf16 v[28:31], a[224:227], v[100:103], v[28:31]
    v_mfma_f32_16x16x32_bf16 v[32:35], a[228:231], v[100:103], v[32:35]
    v_mfma_f32_16x16x32_bf16 v[36:39], v[240:243], v[100:103], v[36:39]
    buffer_load_dwordx4 v[100:103], v0, s[28:31], s48 offen offset:1024
    s_waitcnt vmcnt(15)
    v_mfma_f32_16x16x32_bf16 v[16:19], a[232:235], v[104:107], v[16:19]
    v_mfma_f32_16x16x32_bf16 v[20:23], a[236:239], v[104:107], v[20:23]
    v_mfma_f32_16x16x32_bf16 v[24:27], v[244:247], v[104:107], v[24:27]
    buffer_load_dwordx4 v[104:107], v0, s[28:31], s48 offen offset:2048
    s_waitcnt vmcnt(15)
    v_mfma_f32_16x16x32_bf16 v[28:31], a[232:235], v[108:111], v[28:31]
    v_mfma_f32_16x16x32_bf16 v[32:35], a[236:239], v[108:111], v[32:35]
    v_mfma_f32_16x16x32_bf16 v[36:39], v[244:247], v[108:111], v[36:39]
    buffer_load_dwordx4 v[108:111], v0, s[28:31], s48 offen offset:3072
    s_waitcnt vmcnt(15)
    v_mfma_f32_16x16x32_bf16 v[16:19], a[240:243], v[112:115], v[16:19]
    v_mfma_f32_16x16x32_bf16 v[20:23], a[244:247], v[112:115], v[20:23]
    v_mfma_f32_16x16x32_bf16 v[24:27], v[248:251], v[112:115], v[24:27]
    s_add_u32 s48, s46, 12288
    buffer_load_dwordx4 v[112:115], v0, s[28:31], s48 offen offset:0
    s_waitcnt vmcnt(15)
    v_mfma_f32_16x16x32_bf16 v[28:31], a[240:243], v[116:119], v[28:31]
    v_mfma_f32_16x16x32_bf16 v[32:35], a[244:247], v[116:119], v[32:35]
    v_mfma_f32_16x16x32_bf16 v[36:39], v[248:251], v[116:119], v[36:39]
    buffer_load_dwordx4 v[116:119], v0, s[28:31], s48 offen offset:1024
    s_waitcnt vmcnt(15)
    v_mfma_f32_16x16x32_bf16 v[16:19], a[248:251], v[120:123], v[16:19]
    v_mfma_f32_16x16x32_bf16 v[20:23], a[252:255], v[120:123], v[20:23]
    v_mfma_f32_16x16x32_bf16 v[24:27], v[252:255], v[120:123], v[24:27]
    buffer_load_dwordx4 v[120:123], v0, s[28:31], s48 offen offset:2048
    s_waitcnt vmcnt(15)
    v_mfma_f32_16x16x32_bf16 v[28:31], a[248:251], v[124:127], v[28:31]
    v_mfma_f32_16x16x32_bf16 v[32:35], a[252:255], v[124:127], v[32:35]
    v_mfma_f32_16x16x32_bf16 v[36:39], v[252:255], v[124:127], v[36:39]
    s_nop 5
    ds_write_b128 v48, v[16:19] offset:0
    ds_write_b128 v48, v[20:23] offset:1024
    ds_write_b128 v48, v[24:27] offset:2048
    ds_write_b128 v48, v[28:31] offset:3072
    ds_write_b128 v48, v[32:35] offset:4096
    ds_write_b128 v48, v[36:39] offset:5120
    s_waitcnt lgkmcnt(0)
    s_barrier
    ds_read_b128 v[24:27], v50 offset:0
    ds_read_b128 v[28:31], v50 offset:1024
    ds_read_b128 v[32:35], v50 offset:6144
    ds_read_b128 v[36:39], v50 offset:7168
    ds_read_b128 v[56:59], v50 offset:12288
    ds_read_b128 v[60:63], v50 offset:13312
    ds_read_b128 v[124:127], v50 offset:18432
    ds_read_b128 v[52:55], v50 offset:19456
    v_xor_b32 v48, 0x8000, v48
    v_xor_b32 v50, 0x8000, v50
    v_lshlrev_b32 v16, 16, v40
    v_and_b32 v20, 0xffff0000, v40
    v_lshlrev_b32 v17, 16, v41
    v_and_b32 v21, 0xffff0000, v41
    v_lshlrev_b32 v18, 16, v42
    v_and_b32 v22, 0xffff0000, v42
    v_lshlrev_b32 v19, 16, v43
    v_and_b32 v23, 0xffff0000, v43
    buffer_load_dwordx4 v[40:43], v12, s[28:31], s41 offen
    s_waitcnt lgkmcnt(7)
    v_add_f32 v16, v16, v24
    v_add_f32 v17, v17, v25
    v_add_f32 v18, v18, v26
    v_add_f32 v19, v19, v27
    s_waitcnt lgkmcnt(6)
    v_add_f32 v20, v20, v28
    v_add_f32 v21, v21, v29
    v_add_f32 v22, v22, v30
    v_add_f32 v23, v23, v31
    s_waitcnt lgkmcnt(5)
    v_add_f32 v16, v16, v32
    v_add_f32 v17, v17, v33
    v_add_f32 v18, v18, v34
    v_add_f32 v19, v19, v35
    s_waitcnt lgkmcnt(4)
    v_add_f32 v20, v20, v36
    v_add_f32 v21, v21, v37
    v_add_f32 v22, v22, v38
    v_add_f32 v23, v23, v39
    s_waitcnt lgkmcnt(3)
    v_add_f32 v16, v16, v56
    v_add_f32 v17, v17, v57
    v_add_f32 v18, v18, v58
    v_add_f32 v19, v19, v59
    s_waitcnt lgkmcnt(2)
    v_add_f32 v20, v20, v60
    v_add_f32 v21, v21, v61
    v_add_f32 v22, v22, v62
    v_add_f32 v23, v23, v63
    s_waitcnt lgkmcnt(1)
    v_add_f32 v16, v16, v124
    v_add_f32 v17, v17, v125
    v_add_f32 v18, v18, v126
    v_add_f32 v19, v19, v127
    s_waitcnt lgkmcnt(0)
    v_add_f32 v20, v20, v52
    v_add_f32 v21, v21, v53
    v_add_f32 v22, v22, v54
    v_add_f32 v23, v23, v55
    v_cvt_pk_bf16_f32 v52, v16, v20
    v_cvt_pk_bf16_f32 v53, v17, v21
    v_cvt_pk_bf16_f32 v54, v18, v22
    v_cvt_pk_bf16_f32 v55, v19, v23
    s_cmp_eq_u32 s34, 0
    s_cbranch_scc1 LtwX_l0
    s_mul_i32 s17, s35, 36864
    buffer_store_dwordx4 v[52:55], v13, s[24:27], s17 offen
    s_cmp_lg_u32 s62, 0
    s_cbranch_scc1 LtwX_item
LtwX_chk:
    s_min_u32 s17, s32, s33
    s_cmp_lt_u32 s17, 64
    s_cbranch_scc1 LtwX_idle
    s_branch L_role_tw_exit
LtwX_l0:
    s_add_u32 s47, s47, 2359296
    buffer_store_dwordx4 v[52:55], v12, s[8:11], s47 offen sc1
    v_add_f32 v44, v16, v17
    v_mul_f32 v45, v16, v16
    v_fmac_f32 v45, v17, v17
    v_add_f32 v44, v44, v18
    v_fmac_f32 v45, v18, v18
    v_add_f32 v44, v44, v19
    v_fmac_f32 v45, v19, v19
    v_add_f32 v44, v44, v20
    v_fmac_f32 v45, v20, v20
    v_add_f32 v44, v44, v21
    v_fmac_f32 v45, v21, v21
    v_add_f32 v44, v44, v22
    v_fmac_f32 v45, v22, v22
    v_add_f32 v44, v44, v23
    v_fmac_f32 v45, v23, v23
    v_mov_b32 v46, v44
    v_mov_b32 v47, v45
    s_nop 0
    v_permlane32_swap_b32 v44, v46
    v_permlane32_swap_b32 v45, v47
    v_add_f32 v44, v44, v46
    v_add_f32 v45, v45, v47
    v_mov_b32 v46, v44
    v_mov_b32 v47, v45
    s_nop 0
    v_permlane16_swap_b32 v44, v46
    v_permlane16_swap_b32 v45, v47
    v_add_f32 v44, v44, v46
    v_add_f32 v45, v45, v47
    s_mul_i32 s17, s35, 6144
    s_add_u32 s17, s17, 16515072
    s_mov_b64 exec, 0xffff
    buffer_store_dwordx2 v[44:45], v14, s[8:11], s17 offen sc1
    s_mov_b64 exec, -1
    s_mul_i32 s43, s35, 22528
    s_add_u32 s43, s43, s49
    s_cmp_lg_u32 s62, 0
    s_cbranch_scc1 LtwX_item
    s_cmp_lg_u32 s14, 0
    s_cbranch_scc1 LtwX_nw3
    s_mul_i32 s60, s32, 22528
    s_add_u32 s60, s60, 184448
    s_cmp_lt_u32 s32, 64
    s_cselect_b32 s60, s60, 3080192
    s_mul_i32 s61, s33, 22528
    s_add_u32 s61, s61, 1626240
    s_cmp_lt_u32 s33, 64
    s_cselect_b32 s61, s61, 3080192
    buffer_load_dword v2, v1, s[8:11], s60 offen sc1
    buffer_load_dword v15, v1, s[8:11], s61 offen sc1
LtwX_nw3:
    s_waitcnt vmcnt(0)
    s_mov_b64 exec, 1
    buffer_store_dword v3, v4, s[8:11], s43 offen sc1
    s_mov_b64 exec, -1
    s_mov_b32 s43, 0
    s_min_u32 s17, s32, s33
    s_cmp_lt_u32 s17, 64
    s_cbranch_scc0 LtwX_chk
    s_cmp_lg_u32 s14, 0
    s_cbranch_scc1 LtwX_nw0
    v_cmp_eq_u32 vcc, 0, v2
    v_cmp_eq_u32 s[54:55], 0, v15
    s_nop 0
    s_cmp_eq_u64 s[54:55], 0
    s_cselect_b32 s62, 2, 0
    s_cmp_eq_u64 vcc, 0
    s_cselect_b32 s62, 1, s62
    s_cmp_eq_u32 s62, 0
    s_cbranch_scc1 LtwX_idle
    v_mov_b32 v5, s62
    ds_write_b32 v49, v5
    s_waitcnt lgkmcnt(0)
    s_branch LtwX_nw0
Ltw_z:
    v_lshrrev_b32 v5, 1, v8
    v_lshl_add_u32 v12, v5, 9, v12
    v_and_b32 v5, 1, v8
    v_lshl_add_u32 v12, v5, 3, v12
    v_add_u32 v12, 2048, v12
    v_lshl_add_u32 v13, v8, 3, v13
    v_add_u32 v13, 64, v13
    v_add_u32 v14, 8, v14
    s_lshl_b32 s58, s14, 16
    s_add_u32 s58, s58, 144703488
    s_mov_b32 s43, 0
    s_mov_b32 s28, s8
    s_mov_b32 s29, s9
    s_mov_b32 s30, 0
    s_mov_b32 s31, 0x00020000
    s_mul_i32 s17, s51, 3072
    v_add_u32 v50, s17, v0
    ds_write2_b32 v49, v4, v4 offset0:0 offset1:1
    s_waitcnt lgkmcnt(0)
    s_cmp_lg_u32 s14, 0
    s_cbranch_scc1 LtwZ_ini_d
    v_mov_b32 v5, 160
    s_mov_b32 s16, 0
LtwZ_ini:
    global_load_dword v6, v5, s[12:13] sc1
    s_add_u32 s16, s16, 1
    s_cmp_gt_u32 s16, 100000
    s_cbranch_scc1 L_role_tw_abort
    s_waitcnt vmcnt(0)
    v_cmp_gt_u32 vcc, 123, v6
    s_nop 0
    s_cbranch_vccz LtwZ_ini_d
    s_sleep 8
    s_branch LtwZ_ini
LtwZ_ini_d:
    s_barrier
LtwZ_idle:
    s_barrier
    ds_read_b32 v6, v49
    v_xor_b32 v49, 4, v49
    s_waitcnt lgkmcnt(0)
    v_readfirstlane_b32 s62, v6
    s_nop 0
    s_cmp_eq_u32 s62, 0
    s_cbranch_scc1 L_role_tw_abort
    s_cmp_lt_u32 s33, 33
    s_cselect_b32 s38, 1, 3
    s_cmp_eq_u32 s62, 2
    s_cselect_b32 s36, 1, 0
    s_cselect_b32 s37, s33, s32
    s_cselect_b32 s17, s38, 0
    s_add_u32 s33, s33, s17
    s_cmp_eq_u32 s62, 1
    s_cselect_b32 s17, 2, 0
    s_add_u32 s32, s32, s17
    s_lshl_b32 s56, s36, 6
    s_add_u32 s56, s56, s37
    s_lshl_b32 s46, s56, 18
    s_add_u32 s46, s46, s58
    s_mul_i32 s41, s36, 4718592
    s_mul_i32 s17, s37, 36864
    s_add_u32 s41, s41, s17
    s_add_u32 s41, s41, 8650752
    s_cmp_ge_u32 s37, 64
    s_cbranch_scc1 L_role_tw_abort
    buffer_load_dword v10, v51, s[8:11], s46 offen
    s_add_u32 s48, s46, 0
    buffer_load_dwordx4 v[64:67], v0, s[8:11], s48 offen offset:0
    buffer_load_dwordx4 v[68:71], v0, s[8:11], s48 offen offset:1024
    buffer_load_dwordx4 v[72:75], v0, s[8:11], s48 offen offset:2048
    buffer_load_dwordx4 v[76:79], v0, s[8:11], s48 offen offset:3072
    s_add_u32 s48, s46, 4096
    buffer_load_dwordx4 v[80:83], v0, s[8:11], s48 offen offset:0
    buffer_load_dwordx4 v[84:87], v0, s[8:11], s48 offen offset:1024
    buffer_load_dwordx4 v[88:91], v0, s[8:11], s48 offen offset:2048
    buffer_load_dwordx4 v[92:95], v0, s[8:11], s48 offen offset:3072
    s_add_u32 s48, s46, 8192
    buffer_load_dwordx4 v[96:99], v0, s[8:11], s48 offen offset:0
    buffer_load_dwordx4 v[100:103], v0, s[8:11], s48 offen offset:1024
    buffer_load_dwordx4 v[104:107], v0, s[8:11], s48 offen offset:2048
    buffer_load_dwordx4 v[108:111], v0, s[8:11], s48 offen offset:3072
    s_add_u32 s48, s46, 12288
    buffer_load_dwordx4 v[112:115], v0, s[8:11], s48 offen offset:0
    buffer_load_dwordx4 v[116:119], v0, s[8:11], s48 offen offset:1024
    buffer_load_dwordx4 v[120:123], v0, s[8:11], s48 offen offset:2048
    buffer_load_dwordx2 v[40:41], v12, s[8:11], s41 offen
LtwZ_item:
    s_mov_b32 s34, s36
    s_mov_b32 s35, s37
    s_mov_b32 s47, s41
    buffer_load_dwordx4 v[124:127], v0, s[8:11], s48 offen offset:3072
    s_waitcnt vmcnt(16)
    v_mfma_f32_16x16x32_bf16 v[16:19], a[0:3], v[64:67], 0
    v_mfma_f32_16x16x32_bf16 v[20:23], a[4:7], v[64:67], 0
    v_mfma_f32_16x16x32_bf16 v[24:27], v[128:131], v[64:67], 0
    s_add_u32 s48, s46, 16384
    buffer_load_dwordx4 v[64:67], v0, s[8:11], s48 offen offset:0
    s_waitcnt vmcnt(16)
    v_mfma_f32_16x16x32_bf16 v[28:31], a[0:3], v[68:71], 0
    v_mfma_f32_16x16x32_bf16 v[32:35], a[4:7], v[68:71], 0
    v_mfma_f32_16x16x32_bf16 v[36:39], v[128:131], v[68:71], 0
    buffer_load_dwordx4 v[68:71], v0, s[8:11], s48 offen offset:1024
    s_waitcnt vmcnt(16)
    v_mfma_f32_16x16x32_bf16 v[16:19], a[8:11], v[72:75], v[16:19]
    v_mfma_f32_16x16x32_bf16 v[20:23], a[12:15], v[72:75], v[20:23]
    v_mfma_f32_16x16x32_bf16 v[24:27], v[132:135], v[72:75], v[24:27]
    buffer_load_dwordx4 v[72:75], v0, s[8:11], s48 offen offset:2048
    s_waitcnt vmcnt(16)
    v_mfma_f32_16x16x32_bf16 v[28:31], a[8:11], v[76:79], v[28:31]
    v_mfma_f32_16x16x32_bf16 v[32:35], a[12:15], v[76:79], v[32:35]
    v_mfma_f32_16x16x32_bf16 v[36:39], v[132:135], v[76:79], v[36:39]
    buffer_load_dwordx4 v[76:79], v0, s[8:11], s48 offen offset:3072
    s_waitcnt vmcnt(16)
    v_mfma_f32_16x16x32_bf16 v[16:19], a[16:19], v[80:83], v[16:19]
    v_mfma_f32_16x16x32_bf16 v[20:23], a[20:23], v[80:83], v[20:23]
    v_mfma_f32_16x16x32_bf16 v[24:27], v[136:139], v[80:83], v[24:27]
    s_add_u32 s48, s46, 20480
    buffer_load_dwordx4 v[80:83], v0, s[8:11], s48 offen offset:0
    s_waitcnt vmcnt(16)
    v_mfma_f32_16x16x32_bf16 v[28:31], a[16:19], v[84:87], v[28:31]
    v_mfma_f32_16x16x32_bf16 v[32:35], a[20:23], v[84:87], v[32:35]
    v_mfma_f32_16x16x32_bf16 v[36:39], v[136:139], v[84:87], v[36:39]
    buffer_load_dwordx4 v[84:87], v0, s[8:11], s48 offen offset:1024
    s_waitcnt vmcnt(16)
    v_mfma_f32_16x16x32_bf16 v[16:19], a[24:27], v[88:91], v[16:19]
    v_mfma_f32_16x16x32_bf16 v[20:23], a[28:31], v[88:91], v[20:23]
    v_mfma_f32_16x16x32_bf16 v[24:27], v[140:143], v[88:91], v[24:27]
    buffer_load_dwordx4 v[88:91], v0, s[8:11], s48 offen offset:2048
    s_waitcnt vmcnt(16)
    v_mfma_f32_16x16x32_bf16 v[28:31], a[24:27], v[92:95], v[28:31]
    v_mfma_f32_16x16x32_bf16 v[32:35], a[28:31], v[92:95], v[32:35]
    v_mfma_f32_16x16x32_bf16 v[36:39], v[140:143], v[92:95], v[36:39]
    buffer_load_dwordx4 v[92:95], v0, s[8:11], s48 offen offset:3072
    s_waitcnt vmcnt(16)
    v_mfma_f32_16x16x32_bf16 v[16:19], a[32:35], v[96:99], v[16:19]
    v_mfma_f32_16x16x32_bf16 v[20:23], a[36:39], v[96:99], v[20:23]
    v_mfma_f32_16x16x32_bf16 v[24:27], v[144:147], v[96:99], v[24:27]
    s_add_u32 s48, s46, 24576
    buffer_load_dwordx4 v[96:99], v0, s[8:11], s48 offen offset:0
    s_waitcnt vmcnt(16)
    v_mfma_f32_16x16x32_bf16 v[28:31], a[32:35], v[100:103], v[28:31]
    v_mfma_f32_16x16x32_bf16 v[32:35], a[36:39], v[100:103], v[32:35]
    v_mfma_f32_16x16x32_bf16 v[36:39], v[144:147], v[100:103], v[36:39]
    buffer_load_dwordx4 v[100:103], v0, s[8:11], s48 offen offset:1024
    s_waitcnt vmcnt(16)
    v_mfma_f32_16x16x32_bf16 v[16:19], a[40:43], v[104:107], v[16:19]
    v_mfma_f32_16x16x32_bf16 v[20:23], a[44:47], v[104:107], v[20:23]
    v_mfma_f32_16x16x32_bf16 v[24:27], v[148:151], v[104:107], v[24:27]
    buffer_load_dwordx4 v[104:107], v0, s[8:11], s48 offen offset:2048
    s_waitcnt vmcnt(16)
    v_mfma_f32_16x16x32_bf16 v[28:31], a[40:43], v[108:111], v[28:31]
    v_mfma_f32_16x16x32_bf16 v[32:35], a[44:47], v[108:111], v[32:35]
    v_mfma_f32_16x16x32_bf16 v[36:39], v[148:151], v[108:111], v[36:39]
    buffer_load_dwordx4 v[108:111], v0, s[8:11], s48 offen offset:3072
    s_waitcnt vmcnt(16)
    v_mfma_f32_16x16x32_bf16 v[16:19], a[48:51], v[112:115], v[16:19]
    v_mfma_f32_16x16x32_bf16 v[20:23], a[52:55], v[112:115], v[20:23]
    v_mfma_f32_16x16x32_bf16 v[24:27], v[152:155], v[112:115], v[24:27]
    s_add_u32 s48, s46, 28672
    buffer_load_dwordx4 v[112:115], v0, s[8:11], s48 offen offset:0
    s_waitcnt vmcnt(16)
    v_mfma_f32_16x16x32_bf16 v[28:31], a[48:51], v[116:119], v[28:31]
    v_mfma_f32_16x16x32_bf16 v[32:35], a[52:55], v[116:119], v[32:35]
    v_mfma_f32_16x16x32_bf16 v[36:39], v[152:155], v[116:119], v[36:39]
    buffer_load_dwordx4 v[116:119], v0, s[8:11], s48 offen offset:1024
    s_waitcnt vmcnt(16)
    v_mfma_f32_16x16x32_bf16 v[16:19], a[56:59], v[120:123], v[16:19]
    v_mfma_f32_16x16x32_bf16 v[20:23], a[60:63], v[120:123], v[20:23]
    v_mfma_f32_16x16x32_bf16 v[24:27], v[156:159], v[120:123], v[24:27]
    buffer_load_dwordx4 v[120:123], v0, s[8:11], s48 offen offset:2048
    s_waitcnt vmcnt(15)
    v_mfma_f32_16x16x32_bf16 v[28:31], a[56:59], v[124:127], v[28:31]
    v_mfma_f32_16x16x32_bf16 v[32:35], a[60:63], v[124:127], v[32:35]
    v_mfma_f32_16x16x32_bf16 v[36:39], v[156:159], v[124:127], v[36:39]
    buffer_load_dwordx4 v[124:127], v0, s[8:11], s48 offen offset:3072
    s_waitcnt vmcnt(15)
    v_mfma_f32_16x16x32_bf16 v[16:19], a[64:67], v[64:67], v[16:19]
    v_mfma_f32_16x16x32_bf16 v[20:23], a[68:71], v[64:67], v[20:23]
    v_mfma_f32_16x16x32_bf16 v[24:27], v[160:163], v[64:67], v[24:27]
    s_add_u32 s48, s46, 32768
    buffer_load_dwordx4 v[64:67], v0, s[8:11], s48 offen offset:0
    s_waitcnt vmcnt(15)
    v_mfma_f32_16x16x32_bf16 v[28:31], a[64:67], v[68:71], v[28:31]
    v_mfma_f32_16x16x32_bf16 v[32:35], a[68:71], v[68:71], v[32:35]
    v_mfma_f32_16x16x32_bf16 v[36:39], v[160:163], v[68:71], v[36:39]
    s_cmp_lg_u32 s43, 0
    s_cselect_b64 exec, 1, 0
    buffer_store_dword v3, v4, s[8:11], s43 offen sc1
    s_mov_b64 exec, -1
    s_mov_b32 s43, 0
    buffer_load_dwordx4 v[68:71], v0, s[8:11], s48 offen offset:1024
    s_waitcnt vmcnt(16)
    v_mfma_f32_16x16x32_bf16 v[16:19], a[72:75], v[72:75], v[16:19]
    v_mfma_f32_16x16x32_bf16 v[20:23], a[76:79], v[72:75], v[20:23]
    v_mfma_f32_16x16x32_bf16 v[24:27], v[164:167], v[72:75], v[24:27]
    buffer_load_dwordx4 v[72:75], v0, s[8:11], s48 offen offset:2048
    s_waitcnt vmcnt(16)
    v_mfma_f32_16x16x32_bf16 v[28:31], a[72:75], v[76:79], v[28:31]
    v_mfma_f32_16x16x32_bf16 v[32:35], a[76:79], v[76:79], v[32:35]
    v_mfma_f32_16x16x32_bf16 v[36:39], v[164:167], v[76:79], v[36:39]
    buffer_load_dwordx4 v[76:79], v0, s[8:11], s48 offen offset:3072
    s_waitcnt vmcnt(16)
    v_mfma_f32_16x16x32_bf16 v[16:19], a[80:83], v[80:83], v[16:19]
    v_mfma_f32_16x16x32_bf16 v[20:23], a[84:87], v[80:83], v[20:23]
    v_mfma_f32_16x16x32_bf16 v[24:27], v[168:171], v[80:83], v[24:27]
    s_add_u32 s48, s46, 36864
    buffer_load_dwordx4 v[80:83], v0, s[8:11], s48 offen offset:0
    s_waitcnt vmcnt(16)
    v_mfma_f32_16x16x32_bf16 v[28:31], a[80:83], v[84:87], v[28:31]
    v_mfma_f32_16x16x32_bf16 v[32:35], a[84:87], v[84:87], v[32:35]
    v_mfma_f32_16x16x32_bf16 v[36:39], v[168:171], v[84:87], v[36:39]
    buffer_load_dwordx4 v[84:87], v0, s[8:11], s48 offen offset:1024
    s_waitcnt vmcnt(16)
    v_mfma_f32_16x16x32_bf16 v[16:19], a[88:91], v[88:91], v[16:19]
    v_mfma_f32_16x16x32_bf16 v[20:23], a[92:95], v[88:91], v[20:23]
    v_mfma_f32_16x16x32_bf16 v[24:27], v[172:175], v[88:91], v[24:27]
    buffer_load_dwordx4 v[88:91], v0, s[8:11], s48 offen offset:2048
    s_waitcnt vmcnt(16)
    v_mfma_f32_16x16x32_bf16 v[28:31], a[88:91], v[92:95], v[28:31]
    v_mfma_f32_16x16x32_bf16 v[32:35], a[92:95], v[92:95], v[32:35]
    v_mfma_f32_16x16x32_bf16 v[36:39], v[172:175], v[92:95], v[36:39]
    buffer_load_dwordx4 v[92:95], v0, s[8:11], s48 offen offset:3072
    s_waitcnt vmcnt(16)
    v_mfma_f32_16x16x32_bf16 v[16:19], a[96:99], v[96:99], v[16:19]
    v_mfma_f32_16x16x32_bf16 v[20:23], a[100:103], v[96:99], v[20:23]
    v_mfma_f32_16x16x32_bf16 v[24:27], v[176:179], v[96:99], v[24:27]
    s_add_u32 s48, s46, 40960
    buffer_load_dwordx4 v[96:99], v0, s[8:11], s48 offen offset:0
    s_waitcnt vmcnt(16)
    v_mfma_f32_16x16x32_bf16 v[28:31], a[96:99], v[100:103], v[28:31]
    v_mfma_f32_16x16x32_bf16 v[32:35], a[100:103], v[100:103], v[32:35]
    v_mfma_f32_16x16x32_bf16 v[36:39], v[176:179], v[100:103], v[36:39]
    buffer_load_dwordx4 v[100:103], v0, s[8:11], s48 offen offset:1024
    s_waitcnt vmcnt(16)
    v_mfma_f32_16x16x32_bf16 v[16:19], a[104:107], v[104:107], v[16:19]
    v_mfma_f32_16x16x32_bf16 v[20:23], a[108:111], v[104:107], v[20:23]
    v_mfma_f32_16x16x32_bf16 v[24:27], v[180:183], v[104:107], v[24:27]
    buffer_load_dwordx4 v[104:107], v0, s[8:11], s48 offen offset:2048
    s_waitcnt vmcnt(16)
    v_mfma_f32_16x16x32_bf16 v[28:31], a[104:107], v[108:111], v[28:31]
    v_mfma_f32_16x16x32_bf16 v[32:35], a[108:111], v[108:111], v[32:35]
    v_mfma_f32_16x16x32_bf16 v[36:39], v[180:183], v[108:111], v[36:39]
    buffer_load_dwordx4 v[108:111], v0, s[8:11], s48 offen offset:3072
    s_waitcnt vmcnt(16)
    v_mfma_f32_16x16x32_bf16 v[16:19], a[112:115], v[112:115], v[16:19]
    v_mfma_f32_16x16x32_bf16 v[20:23], a[116:119], v[112:115], v[20:23]
    v_mfma_f32_16x16x32_bf16 v[24:27], v[184:187], v[112:115], v[24:27]
    s_add_u32 s48, s46, 45056
    buffer_load_dwordx4 v[112:115], v0, s[8:11], s48 offen offset:0
    s_waitcnt vmcnt(16)
    v_mfma_f32_16x16x32_bf16 v[28:31], a[112:115], v[116:119], v[28:31]
    v_mfma_f32_16x16x32_bf16 v[32:35], a[116:119], v[116:119], v[32:35]
    v_mfma_f32_16x16x32_bf16 v[36:39], v[184:187], v[116:119], v[36:39]
    buffer_load_dwordx4 v[116:119], v0, s[8:11], s48 offen offset:1024
    s_waitcnt vmcnt(16)
    v_mfma_f32_16x16x32_bf16 v[16:19], a[120:123], v[120:123], v[16:19]
    v_mfma_f32_16x16x32_bf16 v[20:23], a[124:127], v[120:123], v[20:23]
    v_mfma_f32_16x16x32_bf16 v[24:27], v[188:191], v[120:123], v[24:27]
    buffer_load_dwordx4 v[120:123], v0, s[8:11], s48 offen offset:2048
    s_waitcnt vmcnt(16)
    v_mfma_f32_16x16x32_bf16 v[28:31], a[120:123], v[124:127], v[28:31]
    v_mfma_f32_16x16x32_bf16 v[32:35], a[124:127], v[124:127], v[32:35]
    v_mfma_f32_16x16x32_bf16 v[36:39], v[188:191], v[124:127], v[36:39]
    buffer_load_dwordx4 v[124:127], v0, s[8:11], s48 offen offset:3072
    s_waitcnt vmcnt(16)
    v_mfma_f32_16x16x32_bf16 v[16:19], a[128:131], v[64:67], v[16:19]
    v_mfma_f32_16x16x32_bf16 v[20:23], a[132:135], v[64:67], v[20:23]
    v_mfma_f32_16x16x32_bf16 v[24:27], v[192:195], v[64:67], v[24:27]
    s_add_u32 s48, s46, 49152
    buffer_load_dwordx4 v[64:67], v0, s[8:11], s48 offen offset:0
    s_waitcnt vmcnt(15)
    v_mfma_f32_16x16x32_bf16 v[28:31], a[128:131], v[68:71], v[28:31]
    v_mfma_f32_16x16x32_bf16 v[32:35], a[132:135], v[68:71], v[32:35]
    v_mfma_f32_16x16x32_bf16 v[36:39], v[192:195], v[68:71], v[36:39]
    buffer_load_dwordx4 v[68:71], v0, s[8:11], s48 offen offset:1024
    s_waitcnt vmcnt(15)
    v_mfma_f32_16x16x32_bf16 v[16:19], a[136:139], v[72:75], v[16:19]
    v_mfma_f32_16x16x32_bf16 v[20:23], a[140:143], v[72:75], v[20:23]
    v_mfma_f32_16x16x32_bf16 v[24:27], v[196:199], v[72:75], v[24:27]
    buffer_load_dwordx4 v[72:75], v0, s[8:11], s48 offen offset:2048
    s_waitcnt vmcnt(15)
    v_mfma_f32_16x16x32_bf16 v[28:31], a[136:139], v[76:79], v[28:31]
    v_mfma_f32_16x16x32_bf16 v[32:35], a[140:143], v[76:79], v[32:35]
    v_mfma_f32_16x16x32_bf16 v[36:39], v[196:199], v[76:79], v[36:39]
    buffer_load_dwordx4 v[76:79], v0, s[8:11], s48 offen offset:3072
    s_waitcnt vmcnt(15)
    v_mfma_f32_16x16x32_bf16 v[16:19], a[144:147], v[80:83], v[16:19]
    v_mfma_f32_16x16x32_bf16 v[20:23], a[148:151], v[80:83], v[20:23]
    v_mfma_f32_16x16x32_bf16 v[24:27], v[200:203], v[80:83], v[24:27]
    s_add_u32 s48, s46, 53248
    buffer_load_dwordx4 v[80:83], v0, s[8:11], s48 offen offset:0
    s_waitcnt vmcnt(15)
    v_mfma_f32_16x16x32_bf16 v[28:31], a[144:147], v[84:87], v[28:31]
    v_mfma_f32_16x16x32_bf16 v[32:35], a[148:151], v[84:87], v[32:35]
    v_mfma_f32_16x16x32_bf16 v[36:39], v[200:203], v[84:87], v[36:39]
    buffer_load_dwordx4 v[84:87], v0, s[8:11], s48 offen offset:1024
    s_waitcnt vmcnt(15)
    v_mfma_f32_16x16x32_bf16 v[16:19], a[152:155], v[88:91], v[16:19]
    v_mfma_f32_16x16x32_bf16 v[20:23], a[156:159], v[88:91], v[20:23]
    v_mfma_f32_16x16x32_bf16 v[24:27], v[204:207], v[88:91], v[24:27]
    buffer_load_dwordx4 v[88:91], v0, s[8:11], s48 offen offset:2048
    s_waitcnt vmcnt(15)
    v_mfma_f32_16x16x32_bf16 v[28:31], a[152:155], v[92:95], v[28:31]
    v_mfma_f32_16x16x32_bf16 v[32:35], a[156:159], v[92:95], v[32:35]
    v_mfma_f32_16x16x32_bf16 v[36:39], v[204:207], v[92:95], v[36:39]
    buffer_load_dwordx4 v[92:95], v0, s[8:11], s48 offen offset:3072
    s_waitcnt vmcnt(15)
    v_mfma_f32_16x16x32_bf16 v[16:19], a[160:163], v[96:99], v[16:19]
    v_mfma_f32_16x16x32_bf16 v[20:23], a[164:167], v[96:99], v[20:23]
    v_mfma_f32_16x16x32_bf16 v[24:27], v[208:211], v[96:99], v[24:27]
    s_add_u32 s48, s46, 57344
    buffer_load_dwordx4 v[96:99], v0, s[8:11], s48 offen offset:0
    s_waitcnt vmcnt(15)
    v_mfma_f32_16x16x32_bf16 v[28:31], a[160:163], v[100:103], v[28:31]
    v_mfma_f32_16x16x32_bf16 v[32:35], a[164:167], v[100:103], v[32:35]
    v_mfma_f32_16x16x32_bf16 v[36:39], v[208:211], v[100:103], v[36:39]
    buffer_load_dwordx4 v[100:103], v0, s[8:11], s48 offen offset:1024
    s_waitcnt vmcnt(15)
    v_mfma_f32_16x16x32_bf16 v[16:19], a[168:171], v[104:107], v[16:19]
    v_mfma_f32_16x16x32_bf16 v[20:23], a[172:175], v[104:107], v[20:23]
    v_mfma_f32_16x16x32_bf16 v[24:27], v[212:215], v[104:107], v[24:27]
    buffer_load_dwordx4 v[104:107], v0, s[8:11], s48 offen offset:2048
    s_waitcnt vmcnt(15)
    v_mfma_f32_16x16x32_bf16 v[28:31], a[168:171], v[108:111], v[28:31]
    v_mfma_f32_16x16x32_bf16 v[32:35], a[172:175], v[108:111], v[32:35]
    v_mfma_f32_16x16x32_bf16 v[36:39], v[212:215], v[108:111], v[36:39]
    buffer_load_dwordx4 v[108:111], v0, s[8:11], s48 offen offset:3072
    s_waitcnt vmcnt(15)
    v_mfma_f32_16x16x32_bf16 v[16:19], a[176:179], v[112:115], v[16:19]
    v_mfma_f32_16x16x32_bf16 v[20:23], a[180:183], v[112:115], v[20:23]
    v_mfma_f32_16x16x32_bf16 v[24:27], v[216:219], v[112:115], v[24:27]
    s_barrier
    ds_read_b32 v6, v49
    v_xor_b32 v49, 4, v49
    s_add_u32 s48, s46, 61440
    buffer_load_dwordx4 v[112:115], v0, s[8:11], s48 offen offset:0
    s_waitcnt vmcnt(15)
    v_mfma_f32_16x16x32_bf16 v[28:31], a[176:179], v[116:119], v[28:31]
    v_mfma_f32_16x16x32_bf16 v[32:35], a[180:183], v[116:119], v[32:35]
    v_mfma_f32_16x16x32_bf16 v[36:39], v[216:219], v[116:119], v[36:39]
    buffer_load_dwordx4 v[116:119], v0, s[8:11], s48 offen offset:1024
    s_waitcnt vmcnt(15)
    v_mfma_f32_16x16x32_bf16 v[16:19], a[184:187], v[120:123], v[16:19]
    v_mfma_f32_16x16x32_bf16 v[20:23], a[188:191], v[120:123], v[20:23]
    v_mfma_f32_16x16x32_bf16 v[24:27], v[220:223], v[120:123], v[24:27]
    buffer_load_dwordx4 v[120:123], v0, s[8:11], s48 offen offset:2048
    s_waitcnt vmcnt(15)
    v_mfma_f32_16x16x32_bf16 v[28:31], a[184:187], v[124:127], v[28:31]
    v_mfma_f32_16x16x32_bf16 v[32:35], a[188:191], v[124:127], v[32:35]
    v_mfma_f32_16x16x32_bf16 v[36:39], v[220:223], v[124:127], v[36:39]
    s_waitcnt lgkmcnt(0)
    v_readfirstlane_b32 s62, v6
    s_cmp_lt_u32 s33, 33
    s_cselect_b32 s38, 1, 3
    s_cmp_eq_u32 s62, 2
    s_cselect_b32 s36, 1, 0
    s_cselect_b32 s37, s33, s32
    s_cselect_b32 s17, s38, 0
    s_add_u32 s33, s33, s17
    s_cmp_eq_u32 s62, 1
    s_cselect_b32 s17, 2, 0
    s_add_u32 s32, s32, s17
    s_lshl_b32 s56, s36, 6
    s_add_u32 s56, s56, s37
    buffer_load_dwordx4 v[124:127], v0, s[8:11], s48 offen offset:3072
    s_waitcnt vmcnt(15)
    v_mfma_f32_16x16x32_bf16 v[16:19], a[192:195], v[64:67], v[16:19]
    v_mfma_f32_16x16x32_bf16 v[20:23], a[196:199], v[64:67], v[20:23]
    v_mfma_f32_16x16x32_bf16 v[24:27], v[224:227], v[64:67], v[24:27]
    s_cmp_lt_u32 s37, 64
    s_cselect_b32 s62, s62, 0
    s_lshl_b32 s46, s56, 18
    s_add_u32 s46, s46, s58
    s_mul_i32 s41, s36, 4718592
    s_mul_i32 s17, s37, 36864
    s_add_u32 s41, s41, s17
    s_add_u32 s41, s41, 8650752
    s_cmp_lg_u32 s62, 0
    s_cselect_b32 s30, 268435456, 0
    buffer_load_dword v10, v51, s[28:31], s46 offen
    s_add_u32 s48, s46, 0
    buffer_load_dwordx4 v[64:67], v0, s[28:31], s48 offen offset:0
    s_waitcnt vmcnt(15)
    v_mfma_f32_16x16x32_bf16 v[28:31], a[192:195], v[68:71], v[28:31]
    v_mfma_f32_16x16x32_bf16 v[32:35], a[196:199], v[68:71], v[32:35]
    v_mfma_f32_16x16x32_bf16 v[36:39], v[224:227], v[68:71], v[36:39]
    buffer_load_dwordx4 v[68:71], v0, s[28:31], s48 offen offset:1024
    s_waitcnt vmcnt(15)
    v_mfma_f32_16x16x32_bf16 v[16:19], a[200:203], v[72:75], v[16:19]
    v_mfma_f32_16x16x32_bf16 v[20:23], a[204:207], v[72:75], v[20:23]
    v_mfma_f32_16x16x32_bf16 v[24:27], v[228:231], v[72:75], v[24:27]
    buffer_load_dwordx4 v[72:75], v0, s[28:31], s48 offen offset:2048
    s_waitcnt vmcnt(15)
    v_mfma_f32_16x16x32_bf16 v[28:31], a[200:203], v[76:79], v[28:31]
    v_mfma_f32_16x16x32_bf16 v[32:35], a[204:207], v[76:79], v[32:35]
    v_mfma_f32_16x16x32_bf16 v[36:39], v[228:231], v[76:79], v[36:39]
    buffer_load_dwordx4 v[76:79], v0, s[28:31], s48 offen offset:3072
    s_waitcnt vmcnt(15)
    v_mfma_f32_16x16x32_bf16 v[16:19], a[208:211], v[80:83], v[16:19]
    v_mfma_f32_16x16x32_bf16 v[20:23], a[212:215], v[80:83], v[20:23]
    v_mfma_f32_16x16x32_bf16 v[24:27], v[232:235], v[80:83], v[24:27]
    s_add_u32 s48, s46, 4096
    buffer_load_dwordx4 v[80:83], v0, s[28:31], s48 offen offset:0
    s_waitcnt vmcnt(15)
    v_mfma_f32_16x16x32_bf16 v[28:31], a[208:211], v[84:87], v[28:31]
    v_mfma_f32_16x16x32_bf16 v[32:35], a[212:215], v[84:87], v[32:35]
    v_mfma_f32_16x16x32_bf16 v[36:39], v[232:235], v[84:87], v[36:39]
    buffer_load_dwordx4 v[84:87], v0, s[28:31], s48 offen offset:1024
    s_waitcnt vmcnt(15)
    v_mfma_f32_16x16x32_bf16 v[16:19], a[216:219], v[88:91], v[16:19]
    v_mfma_f32_16x16x32_bf16 v[20:23], a[220:223], v[88:91], v[20:23]
    v_mfma_f32_16x16x32_bf16 v[24:27], v[236:239], v[88:91], v[24:27]
    buffer_load_dwordx4 v[88:91], v0, s[28:31], s48 offen offset:2048
    s_waitcnt vmcnt(15)
    v_mfma_f32_16x16x32_bf16 v[28:31], a[216:219], v[92:95], v[28:31]
    v_mfma_f32_16x16x32_bf16 v[32:35], a[220:223], v[92:95], v[32:35]
    v_mfma_f32_16x16x32_bf16 v[36:39], v[236:239], v[92:95], v[36:39]
    buffer_load_dwordx4 v[92:95], v0, s[28:31], s48 offen offset:3072
    s_waitcnt vmcnt(15)
    v_mfma_f32_16x16x32_bf16 v[16:19], a[224:227], v[96:99], v[16:19]
    v_mfma_f32_16x16x32_bf16 v[20:23], a[228:231], v[96:99], v[20:23]
    v_mfma_f32_16x16x32_bf16 v[24:27], v[240:243], v[96:99], v[24:27]
    s_add_u32 s48, s46, 8192
    buffer_load_dwordx4 v[96:99], v0, s[28:31], s48 offen offset:0
    s_waitcnt vmcnt(15)
    v_mfma_f32_16x16x32_bf16 v[28:31], a[224:227], v[100:103], v[28:31]
    v_mfma_f32_16x16x32_bf16 v[32:35], a[228:231], v[100:103], v[32:35]
    v_mfma_f32_16x16x32_bf16 v[36:39], v[240:243], v[100:103], v[36:39]
    buffer_load_dwordx4 v[100:103], v0, s[28:31], s48 offen offset:1024
    s_waitcnt vmcnt(15)
    v_mfma_f32_16x16x32_bf16 v[16:19], a[232:235], v[104:107], v[16:19]
    v_mfma_f32_16x16x32_bf16 v[20:23], a[236:239], v[104:107], v[20:23]
    v_mfma_f32_16x16x32_bf16 v[24:27], v[244:247], v[104:107], v[24:27]
    buffer_load_dwordx4 v[104:107], v0, s[28:31], s48 offen offset:2048
    s_waitcnt vmcnt(15)
    v_mfma_f32_16x16x32_bf16 v[28:31], a[232:235], v[108:111], v[28:31]
    v_mfma_f32_16x16x32_bf16 v[32:35], a[236:239], v[108:111], v[32:35]
    v_mfma_f32_16x16x32_bf16 v[36:39], v[244:247], v[108:111], v[36:39]
    buffer_load_dwordx4 v[108:111], v0, s[28:31], s48 offen offset:3072
    s_waitcnt vmcnt(15)
    v_mfma_f32_16x16x32_bf16 v[16:19], a[240:243], v[112:115], v[16:19]
    v_mfma_f32_16x16x32_bf16 v[20:23], a[244:247], v[112:115], v[20:23]
    v_mfma_f32_16x16x32_bf16 v[24:27], v[248:251], v[112:115], v[24:27]
    s_add_u32 s48, s46, 12288
    buffer_load_dwordx4 v[112:115], v0, s[28:31], s48 offen offset:0
    s_waitcnt vmcnt(15)
    v_mfma_f32_16x16x32_bf16 v[28:31], a[240:243], v[116:119], v[28:31]
    v_mfma_f32_16x16x32_bf16 v[32:35], a[244:247], v[116:119], v[32:35]
    v_mfma_f32_16x16x32_bf16 v[36:39], v[248:251], v[116:119], v[36:39]
    buffer_load_dwordx4 v[116:119], v0, s[28:31], s48 offen offset:1024
    s_waitcnt vmcnt(15)
    v_mfma_f32_16x16x32_bf16 v[16:19], a[248:251], v[120:123], v[16:19]
    v_mfma_f32_16x16x32_bf16 v[20:23], a[252:255], v[120:123], v[20:23]
    v_mfma_f32_16x16x32_bf16 v[24:27], v[252:255], v[120:123], v[24:27]
    buffer_load_dwordx4 v[120:123], v0, s[28:31], s48 offen offset:2048
    s_waitcnt vmcnt(15)
    v_mfma_f32_16x16x32_bf16 v[28:31], a[248:251], v[124:127], v[28:31]
    v_mfma_f32_16x16x32_bf16 v[32:35], a[252:255], v[124:127], v[32:35]
    v_mfma_f32_16x16x32_bf16 v[36:39], v[252:255], v[124:127], v[36:39]
    s_nop 5
    ds_write_b128 v48, v[16:19] offset:0
    ds_write_b128 v48, v[20:23] offset:1024
    ds_write_b128 v48, v[24:27] offset:2048
    ds_write_b128 v48, v[28:31] offset:3072
    ds_write_b128 v48, v[32:35] offset:4096
    ds_write_b128 v48, v[36:39] offset:5120
    s_waitcnt lgkmcnt(0)
    s_barrier
    ds_read_b128 v[24:27], v50 offset:2048
    ds_read_b128 v[28:31], v50 offset:8192
    ds_read_b128 v[32:35], v50 offset:14336
    ds_read_b128 v[36:39], v50 offset:20480
    v_xor_b32 v48, 0x8000, v48
    v_xor_b32 v50, 0x8000, v50
    v_lshlrev_b32 v16, 16, v40
    v_and_b32 v17, 0xffff0000, v40
    v_lshlrev_b32 v18, 16, v41
    v_and_b32 v19, 0xffff0000, v41
    buffer_load_dwordx2 v[40:41], v12, s[28:31], s41 offen
    s_waitcnt lgkmcnt(3)
    v_add_f32 v16, v16, v24
    v_add_f32 v17, v17, v25
    v_add_f32 v18, v18, v26
    v_add_f32 v19, v19, v27
    s_waitcnt lgkmcnt(2)
    v_add_f32 v16, v16, v28
    v_add_f32 v17, v17, v29
    v_add_f32 v18, v18, v30
    v_add_f32 v19, v19, v31
    s_waitcnt lgkmcnt(1)
    v_add_f32 v16, v16, v32
    v_add_f32 v17, v17, v33
    v_add_f32 v18, v18, v34
    v_add_f32 v19, v19, v35
    s_waitcnt lgkmcnt(0)
    v_add_f32 v16, v16, v36
    v_add_f32 v17, v17, v37
    v_add_f32 v18, v18, v38
    v_add_f32 v19, v19, v39
    v_cvt_pk_bf16_f32 v52, v16, v17
    v_cvt_pk_bf16_f32 v53, v18, v19
    s_cmp_eq_u32 s34, 0
    s_cbranch_scc1 LtwZ_l0
    s_mul_i32 s17, s35, 36864
    buffer_store_dwordx2 v[52:53], v13, s[24:27], s17 offen
    s_cmp_lg_u32 s62, 0
    s_cbranch_scc1 LtwZ_item
LtwZ_chk:
    s_min_u32 s17, s32, s33
    s_cmp_lt_u32 s17, 64
    s_cbranch_scc1 LtwZ_idle
    s_branch L_role_tw_exit
LtwZ_l0:
    s_add_u32 s47, s47, 2359296
    buffer_store_dwordx2 v[52:53], v12, s[8:11], s47 offen sc1
    v_add_f32 v44, v16, v17
    v_mul_f32 v45, v16, v16
    v_fmac_f32 v45, v17, v17
    v_add_f32 v44, v44, v18
    v_fmac_f32 v45, v18, v18
    v_add_f32 v44, v44, v19
    v_fmac_f32 v45, v19, v19
    v_mov_b32 v46, v44
    v_mov_b32 v47, v45
    s_nop 0
    v_permlane32_swap_b32 v44, v46
    v_permlane32_swap_b32 v45, v47
    v_add_f32 v44, v44, v46
    v_add_f32 v45, v45, v47
    v_mov_b32 v46, v44
    v_mov_b32 v47, v45
    s_nop 0
    v_permlane16_swap_b32 v44, v46
    v_permlane16_swap_b32 v45, v47
    v_add_f32 v44, v44, v46
    v_add_f32 v45, v45, v47
    s_mul_i32 s17, s35, 6144
    s_add_u32 s17, s17, 16515072
    s_mov_b64 exec, 0xffff
    buffer_store_dwordx2 v[44:45], v14, s[8:11], s17 offen sc1
    s_mov_b64 exec, -1
    s_mul_i32 s43, s35, 22528
    s_add_u32 s43, s43, s49
    s_cmp_lg_u32 s62, 0
    s_cbranch_scc1 LtwZ_item
    s_waitcnt vmcnt(0)
    s_mov_b64 exec, 1
    buffer_store_dword v3, v4, s[8:11], s43 offen sc1
    s_mov_b64 exec, -1
    s_mov_b32 s43, 0
    s_min_u32 s17, s32, s33
    s_cmp_lt_u32 s17, 64
    s_cbranch_scc0 LtwZ_chk
    s_branch LtwZ_idle
L_role_tw_abort:
    s_waitcnt lgkmcnt(0)
    s_mov_b64 exec, -1
    v_mov_b32 v0, 60
    s_lshl_b32 s5, s3, 8
    s_or_b32 s5, s5, s4
    s_or_b32 s5, s5, 0x10000
    v_mov_b32 v1, s5
    global_store_dword v0, v1, s[12:13]
    s_endpgm
L_role_tw_exit:
    s_endpgm
.p2align 6
L_role_awo:
    v_and_b32 v5, 63, v0
    v_lshlrev_b32 v0, 4, v5
    v_and_b32 v7, 15, v5
    v_lshrrev_b32 v8, 4, v5
    v_min_u32 v1, 63, v5
    v_lshrrev_b32 v6, 2, v1
    v_and_b32 v1, 3, v1
    v_lshlrev_b32 v1, 2, v1
    v_lshl_add_u32 v1, v6, 7, v1
    v_mov_b32 v3, 1
    v_mov_b32 v4, 0
    s_mov_b32 s44, 0x05040100
    s_mov_b32 s45, 0x07060302
    s_cmp_lt_u32 s15, 5
    s_cbranch_scc1 Lawo_noord
    s_cmp_lg_u32 s14, 0
    s_cbranch_scc1 Lawo_ord_d
    v_mov_b32 v5, 48
    s_mov_b32 s16, 0
Lawo_ord:
    global_load_dword v6, v5, s[12:13] sc1
    s_add_u32 s16, s16, 1
    s_cmp_gt_u32 s16, 100000
    s_cbranch_scc1 L_role_awo_abort
    s_waitcnt vmcnt(0)
    v_cmp_gt_u32 vcc, 1, v6
    s_nop 0
    s_cbranch_vccz Lawo_ord_d
    s_sleep 64
    s_branch Lawo_ord
Lawo_ord_d:
    s_barrier
Lawo_noord:
    s_load_dwordx2 s[20:21], s[0:1], 16
    s_mov_b32 s22, 663552
    s_mov_b32 s23, 0x00020000
    s_waitcnt lgkmcnt(0)
    s_and_b32 s21, s21, 0xffff
    s_cmp_ge_u32 s15, 5
    s_cselect_b32 s63, 1, 0
    s_cselect_b32 s17, 5, 0
    s_sub_u32 s15, s15, s17
    s_lshl_b32 s50, s15, 2
    s_add_u32 s50, s50, s14
    s_min_u32 s50, s50, 17
    s_lshl_b32 s49, s50, 6
    v_bfe_u32 v10, v0, 4, 5
    v_and_b32 v14, 19, v10
    v_bfe_u32 v5, v10, 2, 1
    v_lshl_add_u32 v14, v5, 3, v14
    v_bfe_u32 v5, v10, 3, 1
    v_lshl_add_u32 v14, v5, 2, v14
    v_and_b32 v5, 1, v14
    v_mov_b32 v11, s44
    v_mov_b32 v6, s45
    v_cmp_eq_u32 vcc, 1, v5
    s_nop 1
    v_cndmask_b32 v11, v11, v6, vcc
    v_and_b32 v14, 30, v14
    v_lshlrev_b32 v14, 1, v14
    v_lshrrev_b32 v9, 9, v0
    v_mul_u32_u24 v5, 9216, v9
    v_add_u32 v12, v5, v14
    v_add_u32 v13, 1152, v12
    s_add_u32 s17, s49, 0
    buffer_load_dword v16, v12, s[20:23], s17 offen
    buffer_load_dword v17, v13, s[20:23], s17 offen
    s_add_u32 s17, s49, 2304
    buffer_load_dword v18, v12, s[20:23], s17 offen
    buffer_load_dword v19, v13, s[20:23], s17 offen
    s_add_u32 s17, s49, 4608
    buffer_load_dword v20, v12, s[20:23], s17 offen
    buffer_load_dword v21, v13, s[20:23], s17 offen
    s_add_u32 s17, s49, 6912
    buffer_load_dword v22, v12, s[20:23], s17 offen
    buffer_load_dword v23, v13, s[20:23], s17 offen
    s_add_u32 s17, s49, 23040
    buffer_load_dword v24, v12, s[20:23], s17 offen
    buffer_load_dword v25, v13, s[20:23], s17 offen
    s_add_u32 s17, s49, 25344
    buffer_load_dword v26, v12, s[20:23], s17 offen
    buffer_load_dword v27, v13, s[20:23], s17 offen
    s_add_u32 s17, s49, 27648
    buffer_load_dword v28, v12, s[20:23], s17 offen
    buffer_load_dword v29, v13, s[20:23], s17 offen
    s_add_u32 s17, s49, 29952
    buffer_load_dword v30, v12, s[20:23], s17 offen
    buffer_load_dword v31, v13, s[20:23], s17 offen
    s_add_u32 s17, s49, 41472
    buffer_load_dword v32, v12, s[20:23], s17 offen
    buffer_load_dword v33, v13, s[20:23], s17 offen
    s_add_u32 s17, s49, 43776
    buffer_load_dword v34, v12, s[20:23], s17 offen
    buffer_load_dword v35, v13, s[20:23], s17 offen
    s_add_u32 s17, s49, 46080
    buffer_load_dword v36, v12, s[20:23], s17 offen
    buffer_load_dword v37, v13, s[20:23], s17 offen
    s_add_u32 s17, s49, 48384
    buffer_load_dword v38, v12, s[20:23], s17 offen
    buffer_load_dword v39, v13, s[20:23], s17 offen
    s_add_u32 s17, s49, 64512
    buffer_load_dword v40, v12, s[20:23], s17 offen
    buffer_load_dword v41, v13, s[20:23], s17 offen
    s_add_u32 s17, s49, 66816
    buffer_load_dword v42, v12, s[20:23], s17 offen
    buffer_load_dword v43, v13, s[20:23], s17 offen
    s_add_u32 s17, s49, 69120
    buffer_load_dword v44, v12, s[20:23], s17 offen
    buffer_load_dword v45, v13, s[20:23], s17 offen
    s_add_u32 s17, s49, 71424
    buffer_load_dword v46, v12, s[20:23], s17 offen
    buffer_load_dword v47, v13, s[20:23], s17 offen
    s_add_u32 s17, s49, 82944
    buffer_load_dword v48, v12, s[20:23], s17 offen
    buffer_load_dword v49, v13, s[20:23], s17 offen
    s_add_u32 s17, s49, 85248
    buffer_load_dword v50, v12, s[20:23], s17 offen
    buffer_load_dword v51, v13, s[20:23], s17 offen
    s_add_u32 s17, s49, 87552
    buffer_load_dword v52, v12, s[20:23], s17 offen
    buffer_load_dword v53, v13, s[20:23], s17 offen
    s_add_u32 s17, s49, 89856
    buffer_load_dword v54, v12, s[20:23], s17 offen
    buffer_load_dword v55, v13, s[20:23], s17 offen
    s_add_u32 s17, s49, 105984
    buffer_load_dword v56, v12, s[20:23], s17 offen
    buffer_load_dword v57, v13, s[20:23], s17 offen
    s_add_u32 s17, s49, 108288
    buffer_load_dword v58, v12, s[20:23], s17 offen
    buffer_load_dword v59, v13, s[20:23], s17 offen
    s_add_u32 s17, s49, 110592
    buffer_load_dword v60, v12, s[20:23], s17 offen
    buffer_load_dword v61, v13, s[20:23], s17 offen
    s_add_u32 s17, s49, 112896
    buffer_load_dword v62, v12, s[20:23], s17 offen
    buffer_load_dword v63, v13, s[20:23], s17 offen
    s_add_u32 s17, s49, 124416
    buffer_load_dword v64, v12, s[20:23], s17 offen
    buffer_load_dword v65, v13, s[20:23], s17 offen
    s_add_u32 s17, s49, 126720
    buffer_load_dword v66, v12, s[20:23], s17 offen
    buffer_load_dword v67, v13, s[20:23], s17 offen
    s_add_u32 s17, s49, 129024
    buffer_load_dword v68, v12, s[20:23], s17 offen
    buffer_load_dword v69, v13, s[20:23], s17 offen
    s_add_u32 s17, s49, 131328
    buffer_load_dword v70, v12, s[20:23], s17 offen
    buffer_load_dword v71, v13, s[20:23], s17 offen
    s_add_u32 s17, s49, 147456
    buffer_load_dword v72, v12, s[20:23], s17 offen
    buffer_load_dword v73, v13, s[20:23], s17 offen
    s_waitcnt vmcnt(56)
    v_perm_b32 v112, v17, v16, v11
    s_add_u32 s17, s49, 149760
    buffer_load_dword v74, v12, s[20:23], s17 offen
    buffer_load_dword v75, v13, s[20:23], s17 offen
    s_waitcnt vmcnt(56)
    v_perm_b32 v113, v19, v18, v11
    s_add_u32 s17, s49, 152064
    buffer_load_dword v76, v12, s[20:23], s17 offen
    buffer_load_dword v77, v13, s[20:23], s17 offen
    s_waitcnt vmcnt(56)
    v_perm_b32 v114, v21, v20, v11
    s_add_u32 s17, s49, 154368
    buffer_load_dword v78, v12, s[20:23], s17 offen
    buffer_load_dword v79, v13, s[20:23], s17 offen
    s_waitcnt vmcnt(56)
    v_perm_b32 v115, v23, v22, v11
    s_add_u32 s17, s49, 165888
    buffer_load_dword v80, v12, s[20:23], s17 offen
    buffer_load_dword v81, v13, s[20:23], s17 offen
    s_waitcnt vmcnt(56)
    v_perm_b32 v116, v25, v24, v11
    s_add_u32 s17, s49, 168192
    buffer_load_dword v82, v12, s[20:23], s17 offen
    buffer_load_dword v83, v13, s[20:23], s17 offen
    s_waitcnt vmcnt(56)
    v_perm_b32 v117, v27, v26, v11
    s_add_u32 s17, s49, 170496
    buffer_load_dword v84, v12, s[20:23], s17 offen
    buffer_load_dword v85, v13, s[20:23], s17 offen
    s_waitcnt vmcnt(56)
    v_perm_b32 v118, v29, v28, v11
    s_add_u32 s17, s49, 172800
    buffer_load_dword v86, v12, s[20:23], s17 offen
    buffer_load_dword v87, v13, s[20:23], s17 offen
    s_waitcnt vmcnt(56)
    v_perm_b32 v119, v31, v30, v11
    s_add_u32 s17, s49, 188928
    buffer_load_dword v88, v12, s[20:23], s17 offen
    buffer_load_dword v89, v13, s[20:23], s17 offen
    s_waitcnt vmcnt(56)
    v_perm_b32 v120, v33, v32, v11
    s_add_u32 s17, s49, 191232
    buffer_load_dword v90, v12, s[20:23], s17 offen
    buffer_load_dword v91, v13, s[20:23], s17 offen
    s_waitcnt vmcnt(56)
    v_perm_b32 v121, v35, v34, v11
    s_add_u32 s17, s49, 193536
    buffer_load_dword v92, v12, s[20:23], s17 offen
    buffer_load_dword v93, v13, s[20:23], s17 offen
    s_waitcnt vmcnt(56)
    v_perm_b32 v122, v37, v36, v11
    s_add_u32 s17, s49, 195840
    buffer_load_dword v94, v12, s[20:23], s17 offen
    buffer_load_dword v95, v13, s[20:23], s17 offen
    s_waitcnt vmcnt(56)
    v_perm_b32 v123, v39, v38, v11
    s_add_u32 s17, s49, 207360
    buffer_load_dword v96, v12, s[20:23], s17 offen
    buffer_load_dword v97, v13, s[20:23], s17 offen
    s_waitcnt vmcnt(56)
    v_perm_b32 v124, v41, v40, v11
    s_add_u32 s17, s49, 209664
    buffer_load_dword v98, v12, s[20:23], s17 offen
    buffer_load_dword v99, v13, s[20:23], s17 offen
    s_waitcnt vmcnt(56)
    v_perm_b32 v125, v43, v42, v11
    s_add_u32 s17, s49, 211968
    buffer_load_dword v100, v12, s[20:23], s17 offen
    buffer_load_dword v101, v13, s[20:23], s17 offen
    s_waitcnt vmcnt(56)
    v_perm_b32 v126, v45, v44, v11
    s_add_u32 s17, s49, 214272
    buffer_load_dword v102, v12, s[20:23], s17 offen
    buffer_load_dword v103, v13, s[20:23], s17 offen
    s_waitcnt vmcnt(56)
    v_perm_b32 v127, v47, v46, v11
    s_add_u32 s17, s49, 230400
    buffer_load_dword v104, v12, s[20:23], s17 offen
    buffer_load_dword v105, v13, s[20:23], s17 offen
    s_waitcnt vmcnt(56)
    v_perm_b32 v128, v49, v48, v11
    s_add_u32 s17, s49, 232704
    buffer_load_dword v106, v12, s[20:23], s17 offen
    buffer_load_dword v107, v13, s[20:23], s17 offen
    s_waitcnt vmcnt(56)
    v_perm_b32 v129, v51, v50, v11
    s_add_u32 s17, s49, 235008
    buffer_load_dword v108, v12, s[20:23], s17 offen
    buffer_load_dword v109, v13, s[20:23], s17 offen
    s_waitcnt vmcnt(56)
    v_perm_b32 v130, v53, v52, v11
    s_add_u32 s17, s49, 237312
    buffer_load_dword v110, v12, s[20:23], s17 offen
    buffer_load_dword v111, v13, s[20:23], s17 offen
    s_waitcnt vmcnt(56)
    v_perm_b32 v131, v55, v54, v11
    s_add_u32 s17, s49, 248832
    buffer_load_dword v16, v12, s[20:23], s17 offen
    buffer_load_dword v17, v13, s[20:23], s17 offen
    s_waitcnt vmcnt(56)
    v_perm_b32 v132, v57, v56, v11
    s_add_u32 s17, s49, 251136
    buffer_load_dword v18, v12, s[20:23], s17 offen
    buffer_load_dword v19, v13, s[20:23], s17 offen
    s_waitcnt vmcnt(56)
    v_perm_b32 v133, v59, v58, v11
    s_add_u32 s17, s49, 253440
    buffer_load_dword v20, v12, s[20:23], s17 offen
    buffer_load_dword v21, v13, s[20:23], s17 offen
    s_waitcnt vmcnt(56)
    v_perm_b32 v134, v61, v60, v11
    s_add_u32 s17, s49, 255744
    buffer_load_dword v22, v12, s[20:23], s17 offen
    buffer_load_dword v23, v13, s[20:23], s17 offen
    s_waitcnt vmcnt(56)
    v_perm_b32 v135, v63, v62, v11
    s_add_u32 s17, s49, 271872
    buffer_load_dword v24, v12, s[20:23], s17 offen
    buffer_load_dword v25, v13, s[20:23], s17 offen
    s_waitcnt vmcnt(56)
    v_perm_b32 v136, v65, v64, v11
    s_add_u32 s17, s49, 274176
    buffer_load_dword v26, v12, s[20:23], s17 offen
    buffer_load_dword v27, v13, s[20:23], s17 offen
    s_waitcnt vmcnt(56)
    v_perm_b32 v137, v67, v66, v11
    s_add_u32 s17, s49, 276480
    buffer_load_dword v28, v12, s[20:23], s17 offen
    buffer_load_dword v29, v13, s[20:23], s17 offen
    s_waitcnt vmcnt(56)
    v_perm_b32 v138, v69, v68, v11
    s_add_u32 s17, s49, 278784
    buffer_load_dword v30, v12, s[20:23], s17 offen
    buffer_load_dword v31, v13, s[20:23], s17 offen
    s_waitcnt vmcnt(56)
    v_perm_b32 v139, v71, v70, v11
    s_add_u32 s17, s49, 290304
    buffer_load_dword v32, v12, s[20:23], s17 offen
    buffer_load_dword v33, v13, s[20:23], s17 offen
    s_waitcnt vmcnt(56)
    v_perm_b32 v140, v73, v72, v11
    s_add_u32 s17, s49, 292608
    buffer_load_dword v34, v12, s[20:23], s17 offen
    buffer_load_dword v35, v13, s[20:23], s17 offen
    s_waitcnt vmcnt(56)
    v_perm_b32 v141, v75, v74, v11
    s_add_u32 s17, s49, 294912
    buffer_load_dword v36, v12, s[20:23], s17 offen
    buffer_load_dword v37, v13, s[20:23], s17 offen
    s_waitcnt vmcnt(56)
    v_perm_b32 v142, v77, v76, v11
    s_add_u32 s17, s49, 297216
    buffer_load_dword v38, v12, s[20:23], s17 offen
    buffer_load_dword v39, v13, s[20:23], s17 offen
    s_waitcnt vmcnt(56)
    v_perm_b32 v143, v79, v78, v11
    s_add_u32 s17, s49, 313344
    buffer_load_dword v40, v12, s[20:23], s17 offen
    buffer_load_dword v41, v13, s[20:23], s17 offen
    s_waitcnt vmcnt(56)
    v_perm_b32 v144, v81, v80, v11
    s_add_u32 s17, s49, 315648
    buffer_load_dword v42, v12, s[20:23], s17 offen
    buffer_load_dword v43, v13, s[20:23], s17 offen
    s_waitcnt vmcnt(56)
    v_perm_b32 v145, v83, v82, v11
    s_add_u32 s17, s49, 317952
    buffer_load_dword v44, v12, s[20:23], s17 offen
    buffer_load_dword v45, v13, s[20:23], s17 offen
    s_waitcnt vmcnt(56)
    v_perm_b32 v146, v85, v84, v11
    s_add_u32 s17, s49, 320256
    buffer_load_dword v46, v12, s[20:23], s17 offen
    buffer_load_dword v47, v13, s[20:23], s17 offen
    s_waitcnt vmcnt(56)
    v_perm_b32 v147, v87, v86, v11
    s_add_u32 s17, s49, 331776
    buffer_load_dword v48, v12, s[20:23], s17 offen
    buffer_load_dword v49, v13, s[20:23], s17 offen
    s_waitcnt vmcnt(56)
    v_perm_b32 v148, v89, v88, v11
    s_add_u32 s17, s49, 334080
    buffer_load_dword v50, v12, s[20:23], s17 offen
    buffer_load_dword v51, v13, s[20:23], s17 offen
    s_waitcnt vmcnt(56)
    v_perm_b32 v149, v91, v90, v11
    s_add_u32 s17, s49, 336384
    buffer_load_dword v52, v12, s[20:23], s17 offen
    buffer_load_dword v53, v13, s[20:23], s17 offen
    s_waitcnt vmcnt(56)
    v_perm_b32 v150, v93, v92, v11
    s_add_u32 s17, s49, 338688
    buffer_load_dword v54, v12, s[20:23], s17 offen
    buffer_load_dword v55, v13, s[20:23], s17 offen
    s_waitcnt vmcnt(56)
    v_perm_b32 v151, v95, v94, v11
    s_add_u32 s17, s49, 354816
    buffer_load_dword v56, v12, s[20:23], s17 offen
    buffer_load_dword v57, v13, s[20:23], s17 offen
    s_waitcnt vmcnt(56)
    v_perm_b32 v152, v97, v96, v11
    s_add_u32 s17, s49, 357120
    buffer_load_dword v58, v12, s[20:23], s17 offen
    buffer_load_dword v59, v13, s[20:23], s17 offen
    s_waitcnt vmcnt(56)
    v_perm_b32 v153, v99, v98, v11
    s_add_u32 s17, s49, 359424
    buffer_load_dword v60, v12, s[20:23], s17 offen
    buffer_load_dword v61, v13, s[20:23], s17 offen
    s_waitcnt vmcnt(56)
    v_perm_b32 v154, v101, v100, v11
    s_add_u32 s17, s49, 361728
    buffer_load_dword v62, v12, s[20:23], s17 offen
    buffer_load_dword v63, v13, s[20:23], s17 offen
    s_waitcnt vmcnt(56)
    v_perm_b32 v155, v103, v102, v11
    s_add_u32 s17, s49, 373248
    buffer_load_dword v64, v12, s[20:23], s17 offen
    buffer_load_dword v65, v13, s[20:23], s17 offen
    s_waitcnt vmcnt(56)
    v_perm_b32 v156, v105, v104, v11
    s_add_u32 s17, s49, 375552
    buffer_load_dword v66, v12, s[20:23], s17 offen
    buffer_load_dword v67, v13, s[20:23], s17 offen
    s_waitcnt vmcnt(56)
    v_perm_b32 v157, v107, v106, v11
    s_add_u32 s17, s49, 377856
    buffer_load_dword v68, v12, s[20:23], s17 offen
    buffer_load_dword v69, v13, s[20:23], s17 offen
    s_waitcnt vmcnt(56)
    v_perm_b32 v158, v109, v108, v11
    s_add_u32 s17, s49, 380160
    buffer_load_dword v70, v12, s[20:23], s17 offen
    buffer_load_dword v71, v13, s[20:23], s17 offen
    s_waitcnt vmcnt(56)
    v_perm_b32 v159, v111, v110, v11
    s_add_u32 s17, s49, 396288
    buffer_load_dword v72, v12, s[20:23], s17 offen
    buffer_load_dword v73, v13, s[20:23], s17 offen
    s_waitcnt vmcnt(56)
    v_perm_b32 v160, v17, v16, v11
    s_add_u32 s17, s49, 398592
    buffer_load_dword v74, v12, s[20:23], s17 offen
    buffer_load_dword v75, v13, s[20:23], s17 offen
    s_waitcnt vmcnt(56)
    v_perm_b32 v161, v19, v18, v11
    s_add_u32 s17, s49, 400896
    buffer_load_dword v76, v12, s[20:23], s17 offen
    buffer_load_dword v77, v13, s[20:23], s17 offen
    s_waitcnt vmcnt(56)
    v_perm_b32 v162, v21, v20, v11
    s_add_u32 s17, s49, 403200
    buffer_load_dword v78, v12, s[20:23], s17 offen
    buffer_load_dword v79, v13, s[20:23], s17 offen
    s_waitcnt vmcnt(56)
    v_perm_b32 v163, v23, v22, v11
    s_add_u32 s17, s49, 414720
    buffer_load_dword v80, v12, s[20:23], s17 offen
    buffer_load_dword v81, v13, s[20:23], s17 offen
    s_waitcnt vmcnt(56)
    v_perm_b32 v164, v25, v24, v11
    s_add_u32 s17, s49, 417024
    buffer_load_dword v82, v12, s[20:23], s17 offen
    buffer_load_dword v83, v13, s[20:23], s17 offen
    s_waitcnt vmcnt(56)
    v_perm_b32 v165, v27, v26, v11
    s_add_u32 s17, s49, 419328
    buffer_load_dword v84, v12, s[20:23], s17 offen
    buffer_load_dword v85, v13, s[20:23], s17 offen
    s_waitcnt vmcnt(56)
    v_perm_b32 v166, v29, v28, v11
    s_add_u32 s17, s49, 421632
    buffer_load_dword v86, v12, s[20:23], s17 offen
    buffer_load_dword v87, v13, s[20:23], s17 offen
    s_waitcnt vmcnt(56)
    v_perm_b32 v167, v31, v30, v11
    s_add_u32 s17, s49, 437760
    buffer_load_dword v88, v12, s[20:23], s17 offen
    buffer_load_dword v89, v13, s[20:23], s17 offen
    s_waitcnt vmcnt(56)
    v_perm_b32 v168, v33, v32, v11
    s_add_u32 s17, s49, 440064
    buffer_load_dword v90, v12, s[20:23], s17 offen
    buffer_load_dword v91, v13, s[20:23], s17 offen
    s_waitcnt vmcnt(56)
    v_perm_b32 v169, v35, v34, v11
    s_add_u32 s17, s49, 442368
    buffer_load_dword v92, v12, s[20:23], s17 offen
    buffer_load_dword v93, v13, s[20:23], s17 offen
    s_waitcnt vmcnt(56)
    v_perm_b32 v170, v37, v36, v11
    s_add_u32 s17, s49, 444672
    buffer_load_dword v94, v12, s[20:23], s17 offen
    buffer_load_dword v95, v13, s[20:23], s17 offen
    s_waitcnt vmcnt(56)
    v_perm_b32 v171, v39, v38, v11
    s_add_u32 s17, s49, 456192
    buffer_load_dword v96, v12, s[20:23], s17 offen
    buffer_load_dword v97, v13, s[20:23], s17 offen
    s_waitcnt vmcnt(56)
    v_perm_b32 v172, v41, v40, v11
    s_add_u32 s17, s49, 458496
    buffer_load_dword v98, v12, s[20:23], s17 offen
    buffer_load_dword v99, v13, s[20:23], s17 offen
    s_waitcnt vmcnt(56)
    v_perm_b32 v173, v43, v42, v11
    s_add_u32 s17, s49, 460800
    buffer_load_dword v100, v12, s[20:23], s17 offen
    buffer_load_dword v101, v13, s[20:23], s17 offen
    s_waitcnt vmcnt(56)
    v_perm_b32 v174, v45, v44, v11
    s_add_u32 s17, s49, 463104
    buffer_load_dword v102, v12, s[20:23], s17 offen
    buffer_load_dword v103, v13, s[20:23], s17 offen
    s_waitcnt vmcnt(56)
    v_perm_b32 v175, v47, v46, v11
    s_add_u32 s17, s49, 479232
    buffer_load_dword v104, v12, s[20:23], s17 offen
    buffer_load_dword v105, v13, s[20:23], s17 offen
    s_waitcnt vmcnt(56)
    v_perm_b32 v176, v49, v48, v11
    s_add_u32 s17, s49, 481536
    buffer_load_dword v106, v12, s[20:23], s17 offen
    buffer_load_dword v107, v13, s[20:23], s17 offen
    s_waitcnt vmcnt(56)
    v_perm_b32 v177, v51, v50, v11
    s_add_u32 s17, s49, 483840
    buffer_load_dword v108, v12, s[20:23], s17 offen
    buffer_load_dword v109, v13, s[20:23], s17 offen
    s_waitcnt vmcnt(56)
    v_perm_b32 v178, v53, v52, v11
    s_add_u32 s17, s49, 486144
    buffer_load_dword v110, v12, s[20:23], s17 offen
    buffer_load_dword v111, v13, s[20:23], s17 offen
    s_waitcnt vmcnt(56)
    v_perm_b32 v179, v55, v54, v11
    s_add_u32 s17, s49, 497664
    buffer_load_dword v16, v12, s[20:23], s17 offen
    buffer_load_dword v17, v13, s[20:23], s17 offen
    s_waitcnt vmcnt(56)
    v_perm_b32 v180, v57, v56, v11
    s_add_u32 s17, s49, 499968
    buffer_load_dword v18, v12, s[20:23], s17 offen
    buffer_load_dword v19, v13, s[20:23], s17 offen
    s_waitcnt vmcnt(56)
    v_perm_b32 v181, v59, v58, v11
    s_add_u32 s17, s49, 502272
    buffer_load_dword v20, v12, s[20:23], s17 offen
    buffer_load_dword v21, v13, s[20:23], s17 offen
    s_waitcnt vmcnt(56)
    v_perm_b32 v182, v61, v60, v11
    s_add_u32 s17, s49, 504576
    buffer_load_dword v22, v12, s[20:23], s17 offen
    buffer_load_dword v23, v13, s[20:23], s17 offen
    s_waitcnt vmcnt(56)
    v_perm_b32 v183, v63, v62, v11
    s_add_u32 s17, s49, 520704
    buffer_load_dword v24, v12, s[20:23], s17 offen
    buffer_load_dword v25, v13, s[20:23], s17 offen
    s_waitcnt vmcnt(56)
    v_perm_b32 v184, v65, v64, v11
    s_add_u32 s17, s49, 523008
    buffer_load_dword v26, v12, s[20:23], s17 offen
    buffer_load_dword v27, v13, s[20:23], s17 offen
    s_waitcnt vmcnt(56)
    v_perm_b32 v185, v67, v66, v11
    s_add_u32 s17, s49, 525312
    buffer_load_dword v28, v12, s[20:23], s17 offen
    buffer_load_dword v29, v13, s[20:23], s17 offen
    s_waitcnt vmcnt(56)
    v_perm_b32 v186, v69, v68, v11
    s_add_u32 s17, s49, 527616
    buffer_load_dword v30, v12, s[20:23], s17 offen
    buffer_load_dword v31, v13, s[20:23], s17 offen
    s_waitcnt vmcnt(56)
    v_perm_b32 v187, v71, v70, v11
    s_add_u32 s17, s49, 539136
    buffer_load_dword v32, v12, s[20:23], s17 offen
    buffer_load_dword v33, v13, s[20:23], s17 offen
    s_waitcnt vmcnt(56)
    v_perm_b32 v188, v73, v72, v11
    s_add_u32 s17, s49, 541440
    buffer_load_dword v34, v12, s[20:23], s17 offen
    buffer_load_dword v35, v13, s[20:23], s17 offen
    s_waitcnt vmcnt(56)
    v_perm_b32 v189, v75, v74, v11
    s_add_u32 s17, s49, 543744
    buffer_load_dword v36, v12, s[20:23], s17 offen
    buffer_load_dword v37, v13, s[20:23], s17 offen
    s_waitcnt vmcnt(56)
    v_perm_b32 v190, v77, v76, v11
    s_add_u32 s17, s49, 546048
    buffer_load_dword v38, v12, s[20:23], s17 offen
    buffer_load_dword v39, v13, s[20:23], s17 offen
    s_waitcnt vmcnt(56)
    v_perm_b32 v191, v79, v78, v11
    s_add_u32 s17, s49, 562176
    buffer_load_dword v40, v12, s[20:23], s17 offen
    buffer_load_dword v41, v13, s[20:23], s17 offen
    s_waitcnt vmcnt(56)
    v_perm_b32 v192, v81, v80, v11
    s_add_u32 s17, s49, 564480
    buffer_load_dword v42, v12, s[20:23], s17 offen
    buffer_load_dword v43, v13, s[20:23], s17 offen
    s_waitcnt vmcnt(56)
    v_perm_b32 v193, v83, v82, v11
    s_add_u32 s17, s49, 566784
    buffer_load_dword v44, v12, s[20:23], s17 offen
    buffer_load_dword v45, v13, s[20:23], s17 offen
    s_waitcnt vmcnt(56)
    v_perm_b32 v194, v85, v84, v11
    s_add_u32 s17, s49, 569088
    buffer_load_dword v46, v12, s[20:23], s17 offen
    buffer_load_dword v47, v13, s[20:23], s17 offen
    s_waitcnt vmcnt(56)
    v_perm_b32 v195, v87, v86, v11
    s_add_u32 s17, s49, 580608
    buffer_load_dword v48, v12, s[20:23], s17 offen
    buffer_load_dword v49, v13, s[20:23], s17 offen
    s_waitcnt vmcnt(56)
    v_perm_b32 v196, v89, v88, v11
    s_add_u32 s17, s49, 582912
    buffer_load_dword v50, v12, s[20:23], s17 offen
    buffer_load_dword v51, v13, s[20:23], s17 offen
    s_waitcnt vmcnt(56)
    v_perm_b32 v197, v91, v90, v11
    s_add_u32 s17, s49, 585216
    buffer_load_dword v52, v12, s[20:23], s17 offen
    buffer_load_dword v53, v13, s[20:23], s17 offen
    s_waitcnt vmcnt(56)
    v_perm_b32 v198, v93, v92, v11
    s_add_u32 s17, s49, 587520
    buffer_load_dword v54, v12, s[20:23], s17 offen
    buffer_load_dword v55, v13, s[20:23], s17 offen
    s_waitcnt vmcnt(56)
    v_perm_b32 v199, v95, v94, v11
    s_add_u32 s17, s49, 603648
    buffer_load_dword v56, v12, s[20:23], s17 offen
    buffer_load_dword v57, v13, s[20:23], s17 offen
    s_waitcnt vmcnt(56)
    v_perm_b32 v200, v97, v96, v11
    s_add_u32 s17, s49, 605952
    buffer_load_dword v58, v12, s[20:23], s17 offen
    buffer_load_dword v59, v13, s[20:23], s17 offen
    s_waitcnt vmcnt(56)
    v_perm_b32 v201, v99, v98, v11
    s_add_u32 s17, s49, 608256
    buffer_load_dword v60, v12, s[20:23], s17 offen
    buffer_load_dword v61, v13, s[20:23], s17 offen
    s_waitcnt vmcnt(56)
    v_perm_b32 v202, v101, v100, v11
    s_add_u32 s17, s49, 610560
    buffer_load_dword v62, v12, s[20:23], s17 offen
    buffer_load_dword v63, v13, s[20:23], s17 offen
    s_waitcnt vmcnt(56)
    v_perm_b32 v203, v103, v102, v11
    s_add_u32 s17, s49, 622080
    buffer_load_dword v64, v12, s[20:23], s17 offen
    buffer_load_dword v65, v13, s[20:23], s17 offen
    s_waitcnt vmcnt(56)
    v_perm_b32 v204, v105, v104, v11
    s_add_u32 s17, s49, 624384
    buffer_load_dword v66, v12, s[20:23], s17 offen
    buffer_load_dword v67, v13, s[20:23], s17 offen
    s_waitcnt vmcnt(56)
    v_perm_b32 v205, v107, v106, v11
    s_add_u32 s17, s49, 626688
    buffer_load_dword v68, v12, s[20:23], s17 offen
    buffer_load_dword v69, v13, s[20:23], s17 offen
    s_waitcnt vmcnt(56)
    v_perm_b32 v206, v109, v108, v11
    s_add_u32 s17, s49, 628992
    buffer_load_dword v70, v12, s[20:23], s17 offen
    buffer_load_dword v71, v13, s[20:23], s17 offen
    s_waitcnt vmcnt(56)
    v_perm_b32 v207, v111, v110, v11
    s_add_u32 s17, s49, 645120
    buffer_load_dword v72, v12, s[20:23], s17 offen
    buffer_load_dword v73, v13, s[20:23], s17 offen
    s_waitcnt vmcnt(56)
    v_perm_b32 v208, v17, v16, v11
    s_add_u32 s17, s49, 647424
    buffer_load_dword v74, v12, s[20:23], s17 offen
    buffer_load_dword v75, v13, s[20:23], s17 offen
    s_waitcnt vmcnt(56)
    v_perm_b32 v209, v19, v18, v11
    s_add_u32 s17, s49, 649728
    buffer_load_dword v76, v12, s[20:23], s17 offen
    buffer_load_dword v77, v13, s[20:23], s17 offen
    s_waitcnt vmcnt(56)
    v_perm_b32 v210, v21, v20, v11
    s_add_u32 s17, s49, 652032
    buffer_load_dword v78, v12, s[20:23], s17 offen
    buffer_load_dword v79, v13, s[20:23], s17 offen
    s_waitcnt vmcnt(56)
    v_perm_b32 v211, v23, v22, v11
    s_waitcnt vmcnt(54)
    v_perm_b32 v212, v25, v24, v11
    s_waitcnt vmcnt(52)
    v_perm_b32 v213, v27, v26, v11
    s_waitcnt vmcnt(50)
    v_perm_b32 v214, v29, v28, v11
    s_waitcnt vmcnt(48)
    v_perm_b32 v215, v31, v30, v11
    s_waitcnt vmcnt(46)
    v_perm_b32 v216, v33, v32, v11
    s_waitcnt vmcnt(44)
    v_perm_b32 v217, v35, v34, v11
    s_waitcnt vmcnt(42)
    v_perm_b32 v218, v37, v36, v11
    s_waitcnt vmcnt(40)
    v_perm_b32 v219, v39, v38, v11
    s_waitcnt vmcnt(38)
    v_perm_b32 v220, v41, v40, v11
    s_waitcnt vmcnt(36)
    v_perm_b32 v221, v43, v42, v11
    s_waitcnt vmcnt(34)
    v_perm_b32 v222, v45, v44, v11
    s_waitcnt vmcnt(32)
    v_perm_b32 v223, v47, v46, v11
    s_waitcnt vmcnt(30)
    v_perm_b32 v224, v49, v48, v11
    s_waitcnt vmcnt(28)
    v_perm_b32 v225, v51, v50, v11
    s_waitcnt vmcnt(26)
    v_perm_b32 v226, v53, v52, v11
    s_waitcnt vmcnt(24)
    v_perm_b32 v227, v55, v54, v11
    s_waitcnt vmcnt(22)
    v_perm_b32 v228, v57, v56, v11
    s_waitcnt vmcnt(20)
    v_perm_b32 v229, v59, v58, v11
    s_waitcnt vmcnt(18)
    v_perm_b32 v230, v61, v60, v11
    s_waitcnt vmcnt(16)
    v_perm_b32 v231, v63, v62, v11
    s_waitcnt vmcnt(14)
    v_perm_b32 v232, v65, v64, v11
    s_waitcnt vmcnt(12)
    v_perm_b32 v233, v67, v66, v11
    s_waitcnt vmcnt(10)
    v_perm_b32 v234, v69, v68, v11
    s_waitcnt vmcnt(8)
    v_perm_b32 v235, v71, v70, v11
    s_waitcnt vmcnt(6)
    v_perm_b32 v236, v73, v72, v11
    s_waitcnt vmcnt(4)
    v_perm_b32 v237, v75, v74, v11
    s_waitcnt vmcnt(2)
    v_perm_b32 v238, v77, v76, v11
    s_waitcnt vmcnt(0)
    v_perm_b32 v239, v79, v78, v11
    v_mul_u32_u24 v5, 82944, v9
    v_add_u32 v12, v5, v14
    v_add_u32 v13, 1152, v12
    s_add_u32 s17, s49, 18432
    buffer_load_dword v16, v12, s[20:23], s17 offen
    buffer_load_dword v17, v13, s[20:23], s17 offen
    s_add_u32 s17, s49, 20736
    buffer_load_dword v18, v12, s[20:23], s17 offen
    buffer_load_dword v19, v13, s[20:23], s17 offen
    s_add_u32 s17, s49, 59904
    buffer_load_dword v20, v12, s[20:23], s17 offen
    buffer_load_dword v21, v13, s[20:23], s17 offen
    s_add_u32 s17, s49, 62208
    buffer_load_dword v22, v12, s[20:23], s17 offen
    buffer_load_dword v23, v13, s[20:23], s17 offen
    s_add_u32 s17, s49, 184320
    buffer_load_dword v24, v12, s[20:23], s17 offen
    buffer_load_dword v25, v13, s[20:23], s17 offen
    s_add_u32 s17, s49, 186624
    buffer_load_dword v26, v12, s[20:23], s17 offen
    buffer_load_dword v27, v13, s[20:23], s17 offen
    s_add_u32 s17, s49, 225792
    buffer_load_dword v28, v12, s[20:23], s17 offen
    buffer_load_dword v29, v13, s[20:23], s17 offen
    s_add_u32 s17, s49, 228096
    buffer_load_dword v30, v12, s[20:23], s17 offen
    buffer_load_dword v31, v13, s[20:23], s17 offen
    s_add_u32 s17, s49, 350208
    buffer_load_dword v32, v12, s[20:23], s17 offen
    buffer_load_dword v33, v13, s[20:23], s17 offen
    s_add_u32 s17, s49, 352512
    buffer_load_dword v34, v12, s[20:23], s17 offen
    buffer_load_dword v35, v13, s[20:23], s17 offen
    s_add_u32 s17, s49, 391680
    buffer_load_dword v36, v12, s[20:23], s17 offen
    buffer_load_dword v37, v13, s[20:23], s17 offen
    s_add_u32 s17, s49, 393984
    buffer_load_dword v38, v12, s[20:23], s17 offen
    buffer_load_dword v39, v13, s[20:23], s17 offen
    s_add_u32 s17, s49, 516096
    buffer_load_dword v40, v12, s[20:23], s17 offen
    buffer_load_dword v41, v13, s[20:23], s17 offen
    s_add_u32 s17, s49, 518400
    buffer_load_dword v42, v12, s[20:23], s17 offen
    buffer_load_dword v43, v13, s[20:23], s17 offen
    s_add_u32 s17, s49, 557568
    buffer_load_dword v44, v12, s[20:23], s17 offen
    buffer_load_dword v45, v13, s[20:23], s17 offen
    s_add_u32 s17, s49, 559872
    buffer_load_dword v46, v12, s[20:23], s17 offen
    buffer_load_dword v47, v13, s[20:23], s17 offen
    s_waitcnt vmcnt(30)
    v_perm_b32 v240, v17, v16, v11
    s_waitcnt vmcnt(28)
    v_perm_b32 v241, v19, v18, v11
    s_waitcnt vmcnt(26)
    v_perm_b32 v242, v21, v20, v11
    s_waitcnt vmcnt(24)
    v_perm_b32 v243, v23, v22, v11
    s_waitcnt vmcnt(22)
    v_perm_b32 v244, v25, v24, v11
    s_waitcnt vmcnt(20)
    v_perm_b32 v245, v27, v26, v11
    s_waitcnt vmcnt(18)
    v_perm_b32 v246, v29, v28, v11
    s_waitcnt vmcnt(16)
    v_perm_b32 v247, v31, v30, v11
    s_waitcnt vmcnt(14)
    v_perm_b32 v248, v33, v32, v11
    s_waitcnt vmcnt(12)
    v_perm_b32 v249, v35, v34, v11
    s_waitcnt vmcnt(10)
    v_perm_b32 v250, v37, v36, v11
    s_waitcnt vmcnt(8)
    v_perm_b32 v251, v39, v38, v11
    s_waitcnt vmcnt(6)
    v_perm_b32 v252, v41, v40, v11
    s_waitcnt vmcnt(4)
    v_perm_b32 v253, v43, v42, v11
    s_waitcnt vmcnt(2)
    v_perm_b32 v254, v45, v44, v11
    s_waitcnt vmcnt(0)
    v_perm_b32 v255, v47, v46, v11
    v_lshlrev_b32 v10, 4, v10
    v_lshl_add_u32 v14, v9, 9, v10
    s_lshl_b32 s17, s50, 11
    v_add_u32 v14, s17, v14
    s_lshr_b32 s17, s50, 1
    s_lshl_b32 s17, s17, 9
    s_and_b32 s18, s50, 1
    s_lshl_b32 s18, s18, 3
    s_add_u32 s17, s17, s18
    v_add_u32 v10, s17, v10
    s_lshr_b32 s49, s50, 2
    s_lshl_b32 s49, s49, 7
    s_and_b32 s17, s50, 3
    s_lshl_b32 s17, s17, 2
    s_add_u32 s49, s49, s17
    s_add_u32 s49, s49, 183808
    s_mov_b32 s36, s63
    s_mov_b32 s34, s63
    s_mov_b32 s37, 0
    s_lshl_b32 s56, s63, 6
    s_mul_i32 s58, s14, 9216
    s_mov_b32 s40, 36864
    s_mov_b32 s59, s58
    s_mov_b32 s43, 0
    s_mov_b32 s28, s8
    s_mov_b32 s29, s9
    s_mov_b32 s30, 0
    s_mov_b32 s31, 0x00020000
    s_mul_i32 s41, s63, 2359296
    s_add_u32 s41, s41, s58
    s_add_u32 s41, s41, 17301504
    s_mul_i32 s42, s56, 22528
    s_add_u32 s42, s42, 181760
    s_cmp_lg_u32 s14, 0
    s_cbranch_scc1 Lawo_ini_d
    v_mov_b32 v5, 160
    s_mov_b32 s16, 0
Lawo_ini:
    global_load_dword v6, v5, s[12:13] sc1
    s_add_u32 s16, s16, 1
    s_cmp_gt_u32 s16, 100000
    s_cbranch_scc1 L_role_awo_abort
    s_waitcnt vmcnt(0)
    v_cmp_gt_u32 vcc, 123, v6
    s_nop 0
    s_cbranch_vccz Lawo_ini_d
    s_sleep 8
    s_branch Lawo_ini
Lawo_ini_d:
    s_barrier
    s_branch Lawo_poll
Lawo_item:
    s_waitcnt vmcnt(3)
Lawo_go:
    s_barrier
    s_xor_b32 s40, s40, 36864
    s_xor_b32 s59, s59, 36864
    s_xor_b32 s66, s66, 0x2000
    s_xor_b32 s71, s71, 0x2000
    s_mov_b32 s35, s37
    s_mov_b32 s57, s56
    s_add_u32 s37, s37, 1
    s_add_u32 s56, s56, 1
    s_add_u32 s41, s41, 36864
    s_add_u32 s42, s42, 22528
    s_mov_b32 s62, 0
    v_add_u32 v9, s40, v0
    ds_read_b128 v[32:35], v9 offset:0
    ds_read_b128 v[36:39], v9 offset:1024
    ds_read_b128 v[40:43], v9 offset:2048
    ds_read_b128 v[44:47], v9 offset:3072
    ds_read_b128 v[48:51], v9 offset:4096
    ds_read_b128 v[52:55], v9 offset:5120
    ds_read_b128 v[56:59], v9 offset:6144
    v_lshlrev_b32 v16, 16, v64
    v_and_b32 v17, 0xffff0000, v64
    v_lshlrev_b32 v18, 16, v65
    v_and_b32 v19, 0xffff0000, v65
    v_lshlrev_b32 v20, 16, v66
    v_and_b32 v21, 0xffff0000, v66
    v_lshlrev_b32 v22, 16, v67
    v_and_b32 v23, 0xffff0000, v67
    v_lshlrev_b32 v24, 16, v68
    v_and_b32 v25, 0xffff0000, v68
    v_lshlrev_b32 v26, 16, v69
    v_and_b32 v27, 0xffff0000, v69
    v_lshlrev_b32 v28, 16, v70
    v_and_b32 v29, 0xffff0000, v70
    v_lshlrev_b32 v30, 16, v71
    v_and_b32 v31, 0xffff0000, v71
    s_waitcnt lgkmcnt(6)
    s_nop 0
    v_mfma_f32_32x32x16_bf16 v[16:31], v[112:115], v[32:35], v[16:31]
    ds_read_b128 v[60:63], v9 offset:7168
    s_mul_i32 s46, s34, 4718592
    s_waitcnt lgkmcnt(6)
    v_mfma_f32_32x32x16_bf16 v[16:31], v[116:119], v[36:39], v[16:31]
    ds_read_b128 v[32:35], v9 offset:8192
    s_mul_i32 s51, s35, 36864
    s_waitcnt lgkmcnt(6)
    v_mfma_f32_32x32x16_bf16 v[16:31], v[120:123], v[40:43], v[16:31]
    ds_read_b128 v[36:39], v9 offset:9216
    s_add_u32 s46, s46, s51
    s_waitcnt lgkmcnt(6)
    v_mfma_f32_32x32x16_bf16 v[16:31], v[124:127], v[44:47], v[16:31]
    ds_read_b128 v[40:43], v9 offset:10240
    s_add_u32 s46, s46, 8650752
    s_waitcnt lgkmcnt(6)
    v_mfma_f32_32x32x16_bf16 v[16:31], v[128:131], v[48:51], v[16:31]
    ds_read_b128 v[44:47], v9 offset:11264
    s_mul_i32 s52, s34, 786432
    s_waitcnt lgkmcnt(6)
    v_mfma_f32_32x32x16_bf16 v[16:31], v[132:135], v[52:55], v[16:31]
    ds_read_b128 v[48:51], v9 offset:12288
    s_mul_i32 s51, s35, 6144
    s_waitcnt lgkmcnt(6)
    v_mfma_f32_32x32x16_bf16 v[16:31], v[136:139], v[56:59], v[16:31]
    ds_read_b128 v[52:55], v9 offset:13312
    s_add_u32 s52, s52, s51
    s_waitcnt lgkmcnt(6)
    v_mfma_f32_32x32x16_bf16 v[16:31], v[140:143], v[60:63], v[16:31]
    ds_read_b128 v[56:59], v9 offset:14336
    s_add_u32 s52, s52, 16121856
    s_waitcnt lgkmcnt(6)
    v_mfma_f32_32x32x16_bf16 v[16:31], v[144:147], v[32:35], v[16:31]
    ds_read_b128 v[60:63], v9 offset:15360
    s_waitcnt lgkmcnt(6)
    v_mfma_f32_32x32x16_bf16 v[16:31], v[148:151], v[36:39], v[16:31]
    ds_read_b128 v[32:35], v9 offset:16384
    s_waitcnt lgkmcnt(6)
    v_mfma_f32_32x32x16_bf16 v[16:31], v[152:155], v[40:43], v[16:31]
    ds_read_b128 v[36:39], v9 offset:17408
    s_waitcnt lgkmcnt(6)
    v_mfma_f32_32x32x16_bf16 v[16:31], v[156:159], v[44:47], v[16:31]
    ds_read_b128 v[40:43], v9 offset:18432
    s_waitcnt lgkmcnt(6)
    v_mfma_f32_32x32x16_bf16 v[16:31], v[160:163], v[48:51], v[16:31]
    ds_read_b128 v[44:47], v9 offset:19456
    s_waitcnt lgkmcnt(6)
    v_mfma_f32_32x32x16_bf16 v[16:31], v[164:167], v[52:55], v[16:31]
    ds_read_b128 v[48:51], v9 offset:20480
    s_waitcnt lgkmcnt(6)
    v_mfma_f32_32x32x16_bf16 v[16:31], v[168:171], v[56:59], v[16:31]
    ds_read_b128 v[52:55], v9 offset:21504
    s_waitcnt vmcnt(0)
    buffer_load_dword v2, v1, s[8:11], s42 offen sc1
    s_cmp_lg_u32 s43, 0
    s_cselect_b64 exec, 1, 0
    buffer_store_dword v3, v4, s[8:11], s43 offen sc1
    s_mov_b64 exec, -1
    s_mov_b32 s43, 0
    s_waitcnt lgkmcnt(6)
    v_mfma_f32_32x32x16_bf16 v[16:31], v[172:175], v[60:63], v[16:31]
    ds_read_b128 v[56:59], v9 offset:22528
    s_waitcnt lgkmcnt(6)
    v_mfma_f32_32x32x16_bf16 v[16:31], v[176:179], v[32:35], v[16:31]
    ds_read_b128 v[60:63], v9 offset:23552
    s_waitcnt lgkmcnt(6)
    v_mfma_f32_32x32x16_bf16 v[16:31], v[180:183], v[36:39], v[16:31]
    ds_read_b128 v[32:35], v9 offset:24576
    s_waitcnt lgkmcnt(6)
    v_mfma_f32_32x32x16_bf16 v[16:31], v[184:187], v[40:43], v[16:31]
    ds_read_b128 v[36:39], v9 offset:25600
    s_waitcnt lgkmcnt(6)
    v_mfma_f32_32x32x16_bf16 v[16:31], v[188:191], v[44:47], v[16:31]
    ds_read_b128 v[40:43], v9 offset:26624
    s_waitcnt lgkmcnt(6)
    v_mfma_f32_32x32x16_bf16 v[16:31], v[192:195], v[48:51], v[16:31]
    ds_read_b128 v[44:47], v9 offset:27648
    s_waitcnt lgkmcnt(6)
    v_mfma_f32_32x32x16_bf16 v[16:31], v[196:199], v[52:55], v[16:31]
    ds_read_b128 v[48:51], v9 offset:28672
    s_waitcnt lgkmcnt(6)
    v_mfma_f32_32x32x16_bf16 v[16:31], v[200:203], v[56:59], v[16:31]
    ds_read_b128 v[52:55], v9 offset:29696
    s_waitcnt lgkmcnt(6)
    v_mfma_f32_32x32x16_bf16 v[16:31], v[204:207], v[60:63], v[16:31]
    ds_read_b128 v[56:59], v9 offset:30720
    s_waitcnt lgkmcnt(6)
    v_mfma_f32_32x32x16_bf16 v[16:31], v[208:211], v[32:35], v[16:31]
    ds_read_b128 v[60:63], v9 offset:31744
    s_waitcnt lgkmcnt(6)
    v_mfma_f32_32x32x16_bf16 v[16:31], v[212:215], v[36:39], v[16:31]
    ds_read_b128 v[32:35], v9 offset:32768
    s_waitcnt lgkmcnt(6)
    v_mfma_f32_32x32x16_bf16 v[16:31], v[216:219], v[40:43], v[16:31]
    ds_read_b128 v[36:39], v9 offset:33792
    s_waitcnt lgkmcnt(6)
    v_mfma_f32_32x32x16_bf16 v[16:31], v[220:223], v[44:47], v[16:31]
    ds_read_b128 v[40:43], v9 offset:34816
    s_waitcnt lgkmcnt(6)
    v_mfma_f32_32x32x16_bf16 v[16:31], v[224:227], v[48:51], v[16:31]
    ds_read_b128 v[44:47], v9 offset:35840
    s_waitcnt lgkmcnt(6)
    v_mfma_f32_32x32x16_bf16 v[16:31], v[228:231], v[52:55], v[16:31]
    s_waitcnt lgkmcnt(5)
    v_mfma_f32_32x32x16_bf16 v[16:31], v[232:235], v[56:59], v[16:31]
    s_waitcnt lgkmcnt(4)
    v_mfma_f32_32x32x16_bf16 v[16:31], v[236:239], v[60:63], v[16:31]
    s_waitcnt lgkmcnt(3)
    v_mfma_f32_32x32x16_bf16 v[16:31], v[240:243], v[32:35], v[16:31]
    s_waitcnt vmcnt(1)
    v_cmp_eq_u32 vcc, 0, v2
    s_nop 0
    s_cmp_eq_u64 vcc, 0
    s_cselect_b32 s62, 1, 0
    s_cmp_lt_u32 s37, 64
    s_cselect_b32 s62, s62, 0
    s_cmp_lg_u32 s62, 0
    s_cselect_b32 s30, 268435456, 0
    s_waitcnt lgkmcnt(2)
    v_mfma_f32_32x32x16_bf16 v[16:31], v[244:247], v[36:39], v[16:31]
    s_add_u32 m0, s59, 0
    s_add_u32 s47, s41, 0
    buffer_load_dwordx4 v0, s[28:31], s47 offen offset:0 lds
    buffer_load_dwordx4 v0, s[28:31], s47 offen offset:1024 lds
    s_waitcnt lgkmcnt(1)
    v_mfma_f32_32x32x16_bf16 v[16:31], v[248:251], v[40:43], v[16:31]
    buffer_load_dwordx4 v0, s[28:31], s47 offen offset:2048 lds
    buffer_load_dwordx4 v0, s[28:31], s47 offen offset:3072 lds
    s_waitcnt lgkmcnt(0)
    v_mfma_f32_32x32x16_bf16 v[16:31], v[252:255], v[44:47], v[16:31]
    s_add_u32 m0, s59, 4096
    s_add_u32 s47, s41, 4096
    buffer_load_dwordx4 v0, s[28:31], s47 offen offset:0 lds
    buffer_load_dwordx4 v0, s[28:31], s47 offen offset:1024 lds
    buffer_load_dwordx4 v0, s[28:31], s47 offen offset:2048 lds
    buffer_load_dwordx4 v0, s[28:31], s47 offen offset:3072 lds
    s_add_u32 m0, s59, 8192
    s_add_u32 s47, s41, 8192
    buffer_load_dwordx4 v0, s[28:31], s47 offen offset:0 lds
    s_mul_i32 s48, s36, 4718592
    s_mul_i32 s18, s37, 36864
    s_add_u32 s48, s48, s18
    s_add_u32 s48, s48, 6291456
    buffer_load_dwordx4 v[64:67], v14, s[28:31], s48 offen offset:0
    buffer_load_dwordx4 v[68:71], v14, s[28:31], s48 offen offset:1024
    v_cvt_pk_bf16_f32 v32, v16, v17
    v_cvt_pk_bf16_f32 v33, v18, v19
    v_cvt_pk_bf16_f32 v34, v20, v21
    v_cvt_pk_bf16_f32 v35, v22, v23
    buffer_store_dwordx4 v[32:35], v14, s[8:11], s46 offen offset:0 sc1
    v_cvt_pk_bf16_f32 v36, v24, v25
    v_cvt_pk_bf16_f32 v37, v26, v27
    v_cvt_pk_bf16_f32 v38, v28, v29
    v_cvt_pk_bf16_f32 v39, v30, v31
    buffer_store_dwordx4 v[36:39], v14, s[8:11], s46 offen offset:1024 sc1
    v_add_f32 v72, v16, v17
    v_mul_f32 v73, v16, v16
    v_fmac_f32 v73, v17, v17
    v_add_f32 v72, v72, v18
    v_fmac_f32 v73, v18, v18
    v_add_f32 v72, v72, v19
    v_fmac_f32 v73, v19, v19
    v_add_f32 v72, v72, v20
    v_fmac_f32 v73, v20, v20
    v_add_f32 v72, v72, v21
    v_fmac_f32 v73, v21, v21
    v_add_f32 v72, v72, v22
    v_fmac_f32 v73, v22, v22
    v_add_f32 v72, v72, v23
    v_fmac_f32 v73, v23, v23
    v_add_f32 v72, v72, v24
    v_fmac_f32 v73, v24, v24
    v_add_f32 v72, v72, v25
    v_fmac_f32 v73, v25, v25
    v_add_f32 v72, v72, v26
    v_fmac_f32 v73, v26, v26
    v_add_f32 v72, v72, v27
    v_fmac_f32 v73, v27, v27
    v_add_f32 v72, v72, v28
    v_fmac_f32 v73, v28, v28
    v_add_f32 v72, v72, v29
    v_fmac_f32 v73, v29, v29
    v_add_f32 v72, v72, v30
    v_fmac_f32 v73, v30, v30
    v_add_f32 v72, v72, v31
    v_fmac_f32 v73, v31, v31
    v_mov_b32 v74, v72
    v_mov_b32 v75, v73
    s_nop 0
    v_permlane32_swap_b32 v72, v74
    v_permlane32_swap_b32 v73, v75
    v_add_f32 v72, v72, v74
    v_add_f32 v73, v73, v75
    buffer_store_dwordx2 v[72:73], v10, s[8:11], s52 offen sc1
    s_mul_i32 s43, s57, 22528
    s_add_u32 s43, s43, s49
    s_cmp_lg_u32 s62, 0
    s_cbranch_scc1 Lawo_item
    buffer_load_dword v2, v1, s[8:11], s42 offen sc1
    s_waitcnt vmcnt(0)
    s_cmp_ge_u32 s37, 64
    s_cbranch_scc1 Lawo_fin
    v_cmp_eq_u32 vcc, 0, v2
    s_nop 0
    s_cbranch_vccnz Lawo_pub
    s_add_u32 m0, s59, 0
    s_add_u32 s47, s41, 0
    buffer_load_dwordx4 v0, s[8:11], s47 offen offset:0 lds
    buffer_load_dwordx4 v0, s[8:11], s47 offen offset:1024 lds
    buffer_load_dwordx4 v0, s[8:11], s47 offen offset:2048 lds
    buffer_load_dwordx4 v0, s[8:11], s47 offen offset:3072 lds
    s_add_u32 m0, s59, 4096
    s_add_u32 s47, s41, 4096
    buffer_load_dwordx4 v0, s[8:11], s47 offen offset:0 lds
    buffer_load_dwordx4 v0, s[8:11], s47 offen offset:1024 lds
    buffer_load_dwordx4 v0, s[8:11], s47 offen offset:2048 lds
    buffer_load_dwordx4 v0, s[8:11], s47 offen offset:3072 lds
    s_add_u32 m0, s59, 8192
    s_add_u32 s47, s41, 8192
    buffer_load_dwordx4 v0, s[8:11], s47 offen offset:0 lds
    s_mul_i32 s48, s36, 4718592
    s_mul_i32 s18, s37, 36864
    s_add_u32 s48, s48, s18
    s_add_u32 s48, s48, 6291456
    buffer_load_dwordx4 v[64:67], v14, s[8:11], s48 offen offset:0
    buffer_load_dwordx4 v[68:71], v14, s[8:11], s48 offen offset:1024
    s_cmp_lg_u32 s43, 0
    s_cselect_b64 exec, 1, 0
    buffer_store_dword v3, v4, s[8:11], s43 offen sc1
    s_mov_b64 exec, -1
    s_mov_b32 s43, 0
    s_waitcnt vmcnt(1)
    s_branch Lawo_go
Lawo_fin:
    s_cmp_lg_u32 s43, 0
    s_cselect_b64 exec, 1, 0
    buffer_store_dword v3, v4, s[8:11], s43 offen sc1
    s_mov_b64 exec, -1
    s_mov_b32 s43, 0
    s_branch L_role_awo_exit
Lawo_pub:
    s_cmp_lg_u32 s43, 0
    s_cselect_b64 exec, 1, 0
    buffer_store_dword v3, v4, s[8:11], s43 offen sc1
    s_mov_b64 exec, -1
    s_mov_b32 s43, 0
Lawo_poll:
    s_mov_b32 s16, 0
Lawo_pl:
    buffer_load_dword v2, v1, s[8:11], s42 offen sc1
    s_add_u32 s16, s16, 1
    s_cmp_gt_u32 s16, 100000
    s_cbranch_scc1 L_role_awo_abort
    s_waitcnt vmcnt(0)
    v_cmp_eq_u32 vcc, 0, v2
    s_nop 0
    s_cbranch_vccz Lawo_pld
    s_sleep 2
    s_branch Lawo_pl
Lawo_pld:
    s_add_u32 m0, s59, 0
    s_add_u32 s47, s41, 0
    buffer_load_dwordx4 v0, s[8:11], s47 offen offset:0 lds
    buffer_load_dwordx4 v0, s[8:11], s47 offen offset:1024 lds
    buffer_load_dwordx4 v0, s[8:11], s47 offen offset:2048 lds
    buffer_load_dwordx4 v0, s[8:11], s47 offen offset:3072 lds
    s_add_u32 m0, s59, 4096
    s_add_u32 s47, s41, 4096
    buffer_load_dwordx4 v0, s[8:11], s47 offen offset:0 lds
    buffer_load_dwordx4 v0, s[8:11], s47 offen offset:1024 lds
    buffer_load_dwordx4 v0, s[8:11], s47 offen offset:2048 lds
    buffer_load_dwordx4 v0, s[8:11], s47 offen offset:3072 lds
    s_add_u32 m0, s59, 8192
    s_add_u32 s47, s41, 8192
    buffer_load_dwordx4 v0, s[8:11], s47 offen offset:0 lds
    s_mul_i32 s48, s36, 4718592
    s_mul_i32 s18, s37, 36864
    s_add_u32 s48, s48, s18
    s_add_u32 s48, s48, 6291456
    buffer_load_dwordx4 v[64:67], v14, s[8:11], s48 offen offset:0
    buffer_load_dwordx4 v[68:71], v14, s[8:11], s48 offen offset:1024
    s_waitcnt vmcnt(0)
    s_branch Lawo_go
L_role_awo_abort:
    s_waitcnt lgkmcnt(0)
    s_mov_b64 exec, -1
    v_mov_b32 v0, 60
    s_lshl_b32 s5, s3, 8
    s_or_b32 s5, s5, s4
    s_or_b32 s5, s5, 0x10000
    v_mov_b32 v1, s5
    global_store_dword v0, v1, s[12:13]
    s_endpgm
L_role_awo_exit:
    s_endpgm
.p2align 6
L_role_aq:
    v_and_b32 v5, 63, v0
    v_lshlrev_b32 v0, 4, v5
    v_and_b32 v7, 15, v5
    v_lshrrev_b32 v8, 4, v5
    v_min_u32 v1, 47, v5
    v_lshrrev_b32 v6, 2, v1
    v_and_b32 v1, 3, v1
    v_lshlrev_b32 v1, 2, v1
    v_lshl_add_u32 v1, v6, 7, v1
    v_mov_b32 v3, 1
    v_mov_b32 v4, 0
    s_mov_b32 s44, 0x05040100
    s_mov_b32 s45, 0x07060302
    s_lshr_b32 s63, s15, 4
    s_and_b32 s15, s15, 15
    s_lshl_b32 s50, s15, 1
    s_lshr_b32 s17, s14, 1
    s_add_u32 s50, s50, s17
    s_and_b32 s51, s14, 1
    s_mul_i32 s49, s50, 36
    s_cmp_eq_u32 s63, 0
    s_cbranch_scc1 Laq_noord
    s_cmp_lg_u32 s14, 0
    s_cbranch_scc1 Laq_ord_d
    v_mov_b32 v5, 48
    s_mov_b32 s16, 0
Laq_ord:
    global_load_dword v6, v5, s[12:13] sc1
    s_add_u32 s16, s16, 1
    s_cmp_gt_u32 s16, 100000
    s_cbranch_scc1 L_role_aq_abort
    s_waitcnt vmcnt(0)
    v_cmp_gt_u32 vcc, 1, v6
    s_nop 0
    s_cbranch_vccz Laq_ord_d
    s_sleep 64
    s_branch Laq_ord
Laq_ord_d:
    s_barrier
Laq_noord:
    s_load_dwordx2 s[20:21], s[0:1], 8
    s_mov_b32 s22, 1990656
    s_mov_b32 s23, 0x00020000
    s_waitcnt lgkmcnt(0)
    s_and_b32 s21, s21, 0xffff
    v_lshrrev_b32 v24, 4, v0
    v_add_u32 v24, 0, v24
    v_mul_u32_u24 v25, 4370, v24
    v_lshrrev_b32 v25, 16, v25
    v_mul_u32_u24 v26, 15, v25
    v_sub_u32 v24, v24, v26
    v_mul_u32_u24 v16, 3456, v25
    v_mul_u32_u24 v25, 13108, v24
    v_lshrrev_b32 v25, 16, v25
    v_mul_u32_u24 v26, 5, v25
    v_sub_u32 v24, v24, v26
    v_mul_u32_u24 v25, 1152, v25
    v_lshlrev_b32 v24, 4, v24
    v_add3_u32 v16, v16, v24, v25
    v_lshrrev_b32 v24, 4, v0
    v_add_u32 v24, 64, v24
    v_mul_u32_u24 v25, 4370, v24
    v_lshrrev_b32 v25, 16, v25
    v_mul_u32_u24 v26, 15, v25
    v_sub_u32 v24, v24, v26
    v_mul_u32_u24 v17, 3456, v25
    v_mul_u32_u24 v25, 13108, v24
    v_lshrrev_b32 v25, 16, v25
    v_mul_u32_u24 v26, 5, v25
    v_sub_u32 v24, v24, v26
    v_mul_u32_u24 v25, 1152, v25
    v_lshlrev_b32 v24, 4, v24
    v_add3_u32 v17, v17, v24, v25
    s_mul_i32 s49, s15, 72
    s_and_b32 s48, s49, 15
    s_and_b32 s49, s49, -16
    s_mul_i32 s17, s14, 27648
    s_add_u32 s49, s49, s17
    s_mul_i32 s46, s14, 1920
    s_mov_b32 s54, -1
    s_mov_b32 s55, 0x00ffffff
    s_add_u32 s17, s49, 0
    s_add_u32 m0, s46, 0
    s_nop 0
    buffer_load_dwordx4 v16, s[20:23], s17 offen lds
    s_add_u32 m0, s46, 1024
    s_mov_b64 exec, s[54:55]
    buffer_load_dwordx4 v17, s[20:23], s17 offen lds
    s_mov_b64 exec, -1
    s_add_u32 s17, s49, 110592
    s_add_u32 m0, s46, 7680
    s_nop 0
    buffer_load_dwordx4 v16, s[20:23], s17 offen lds
    s_add_u32 m0, s46, 8704
    s_mov_b64 exec, s[54:55]
    buffer_load_dwordx4 v17, s[20:23], s17 offen lds
    s_mov_b64 exec, -1
    s_add_u32 s17, s49, 221184
    s_add_u32 m0, s46, 15360
    s_nop 0
    buffer_load_dwordx4 v16, s[20:23], s17 offen lds
    s_add_u32 m0, s46, 16384
    s_mov_b64 exec, s[54:55]
    buffer_load_dwordx4 v17, s[20:23], s17 offen lds
    s_mov_b64 exec, -1
    s_add_u32 s17, s49, 331776
    s_add_u32 m0, s46, 23040
    s_nop 0
    buffer_load_dwordx4 v16, s[20:23], s17 offen lds
    s_add_u32 m0, s46, 24064
    s_mov_b64 exec, s[54:55]
    buffer_load_dwordx4 v17, s[20:23], s17 offen lds
    s_mov_b64 exec, -1
    s_add_u32 s17, s49, 442368
    s_add_u32 m0, s46, 30720
    s_nop 0
    buffer_load_dwordx4 v16, s[20:23], s17 offen lds
    s_add_u32 m0, s46, 31744
    s_mov_b64 exec, s[54:55]
    buffer_load_dwordx4 v17, s[20:23], s17 offen lds
    s_mov_b64 exec, -1
    s_add_u32 s17, s49, 552960
    s_add_u32 m0, s46, 38400
    s_nop 0
    buffer_load_dwordx4 v16, s[20:23], s17 offen lds
    s_add_u32 m0, s46, 39424
    s_mov_b64 exec, s[54:55]
    buffer_load_dwordx4 v17, s[20:23], s17 offen lds
    s_mov_b64 exec, -1
    s_add_u32 s17, s49, 663552
    s_add_u32 m0, s46, 46080
    s_nop 0
    buffer_load_dwordx4 v16, s[20:23], s17 offen lds
    s_add_u32 m0, s46, 47104
    s_mov_b64 exec, s[54:55]
    buffer_load_dwordx4 v17, s[20:23], s17 offen lds
    s_mov_b64 exec, -1
    s_add_u32 s17, s49, 774144
    s_add_u32 m0, s46, 53760
    s_nop 0
    buffer_load_dwordx4 v16, s[20:23], s17 offen lds
    s_add_u32 m0, s46, 54784
    s_mov_b64 exec, s[54:55]
    buffer_load_dwordx4 v17, s[20:23], s17 offen lds
    s_mov_b64 exec, -1
    s_add_u32 s17, s49, 884736
    s_add_u32 m0, s46, 61440
    s_nop 0
    buffer_load_dwordx4 v16, s[20:23], s17 offen lds
    s_add_u32 m0, s46, 62464
    s_mov_b64 exec, s[54:55]
    buffer_load_dwordx4 v17, s[20:23], s17 offen lds
    s_mov_b64 exec, -1
    s_add_u32 s17, s49, 995328
    s_add_u32 m0, s46, 69120
    s_nop 0
    buffer_load_dwordx4 v16, s[20:23], s17 offen lds
    s_add_u32 m0, s46, 70144
    s_mov_b64 exec, s[54:55]
    buffer_load_dwordx4 v17, s[20:23], s17 offen lds
    s_mov_b64 exec, -1
    s_add_u32 s17, s49, 1105920
    s_add_u32 m0, s46, 76800
    s_nop 0
    buffer_load_dwordx4 v16, s[20:23], s17 offen lds
    s_add_u32 m0, s46, 77824
    s_mov_b64 exec, s[54:55]
    buffer_load_dwordx4 v17, s[20:23], s17 offen lds
    s_mov_b64 exec, -1
    s_add_u32 s17, s49, 1216512
    s_add_u32 m0, s46, 84480
    s_nop 0
    buffer_load_dwordx4 v16, s[20:23], s17 offen lds
    s_add_u32 m0, s46, 85504
    s_mov_b64 exec, s[54:55]
    buffer_load_dwordx4 v17, s[20:23], s17 offen lds
    s_mov_b64 exec, -1
    s_lshr_b32 s47, s14, 1
    s_mul_i32 s17, s47, 40
    s_add_u32 s17, s17, s48
    s_mul_i32 s18, s47, 4
    s_add_u32 s18, s18, s48
    s_add_u32 s18, s18, 32
    s_lshl_b32 s19, s47, 4
    s_add_u32 s19, s19, 138240
    v_lshrrev_b32 v5, 2, v7
    v_lshl_add_u32 v5, v8, 3, v5
    v_and_b32 v6, 3, v7
    v_mul_u32_u24 v19, 240, v5
    v_add_u32 v19, s17, v19
    v_lshl_add_u32 v19, v6, 3, v19
    v_lshlrev_b32 v20, 5, v5
    v_add_u32 v20, s19, v20
    v_mov_b32 v22, 156672
    v_cmp_eq_u32 vcc, 0, v6
    s_nop 1
    v_cndmask_b32 v20, v22, v20, vcc
    v_cndmask_b32 v21, 0, -1, vcc
    v_bfe_u32 v5, v0, 4, 5
    v_mul_u32_u24 v23, 240, v5
    v_add_u32 v23, s18, v23
    v_lshlrev_b32 v28, 5, v5
    v_add_u32 v28, s19, v28
    v_mov_b32 v24, 0
    v_mov_b32 v25, 0
    v_mov_b32 v26, 0
    v_mov_b32 v27, 0
    v_lshlrev_b32 v22, 4, v7
    v_add_u32 v22, 156672, v22
    ds_write_b128 v22, v[24:27]
    v_mov_b32 v104, 0x3f803f80
    v_mov_b32 v105, 0x3f803f80
    v_mov_b32 v106, 0x3f803f80
    v_mov_b32 v107, 0x3f803f80
    s_waitcnt vmcnt(12) lgkmcnt(0)
    s_barrier
    v_add_u32 v60, 0, v23
    v_mov_b32 v59, 0
    ds_read_b32 v56, v60
    ds_read_b32 v57, v60 offset:80
    ds_read_b32 v58, v60 offset:160
    v_add_u32 v68, 7680, v23
    v_mov_b32 v67, 0
    ds_read_b32 v64, v68
    ds_read_b32 v65, v68 offset:80
    ds_read_b32 v66, v68 offset:160
    v_add_u32 v76, 15360, v23
    v_mov_b32 v75, 0
    ds_read_b32 v72, v76
    ds_read_b32 v73, v76 offset:80
    ds_read_b32 v74, v76 offset:160
    v_add_u32 v84, 23040, v23
    v_mov_b32 v83, 0
    ds_read_b32 v80, v84
    ds_read_b32 v81, v84 offset:80
    ds_read_b32 v82, v84 offset:160
    v_add_u32 v92, 30720, v23
    v_mov_b32 v91, 0
    ds_read_b32 v88, v92
    ds_read_b32 v89, v92 offset:80
    ds_read_b32 v90, v92 offset:160
    v_add_u32 v100, 38400, v23
    v_mov_b32 v99, 0
    ds_read_b32 v96, v100
    ds_read_b32 v97, v100 offset:80
    ds_read_b32 v98, v100 offset:160
    v_add_u32 v61, 0, v19
    ds_read_b64_tr_b16 v[152:153], v61 offset:0
    ds_read_b64_tr_b16 v[224:225], v61 offset:80
    ds_read_b64_tr_b16 a[112:113], v61 offset:160
    ds_read_b64_tr_b16 v[154:155], v61 offset:960
    ds_read_b64_tr_b16 v[226:227], v61 offset:1040
    ds_read_b64_tr_b16 a[114:115], v61 offset:1120
    v_add_u32 v69, 7680, v19
    ds_read_b64_tr_b16 v[156:157], v69 offset:0
    ds_read_b64_tr_b16 v[228:229], v69 offset:80
    ds_read_b64_tr_b16 a[116:117], v69 offset:160
    ds_read_b64_tr_b16 v[158:159], v69 offset:960
    ds_read_b64_tr_b16 v[230:231], v69 offset:1040
    ds_read_b64_tr_b16 a[118:119], v69 offset:1120
    v_add_u32 v77, 15360, v19
    ds_read_b64_tr_b16 v[160:161], v77 offset:0
    ds_read_b64_tr_b16 v[232:233], v77 offset:80
    ds_read_b64_tr_b16 a[120:121], v77 offset:160
    ds_read_b64_tr_b16 v[162:163], v77 offset:960
    ds_read_b64_tr_b16 v[234:235], v77 offset:1040
    ds_read_b64_tr_b16 a[122:123], v77 offset:1120
    v_add_u32 v85, 23040, v19
    ds_read_b64_tr_b16 v[164:165], v85 offset:0
    ds_read_b64_tr_b16 v[236:237], v85 offset:80
    ds_read_b64_tr_b16 a[124:125], v85 offset:160
    ds_read_b64_tr_b16 v[166:167], v85 offset:960
    ds_read_b64_tr_b16 v[238:239], v85 offset:1040
    ds_read_b64_tr_b16 a[126:127], v85 offset:1120
    v_add_u32 v93, 30720, v19
    ds_read_b64_tr_b16 v[168:169], v93 offset:0
    ds_read_b64_tr_b16 v[240:241], v93 offset:80
    ds_read_b64_tr_b16 a[128:129], v93 offset:160
    ds_read_b64_tr_b16 v[170:171], v93 offset:960
    ds_read_b64_tr_b16 v[242:243], v93 offset:1040
    ds_read_b64_tr_b16 a[130:131], v93 offset:1120
    v_add_u32 v101, 38400, v19
    ds_read_b64_tr_b16 v[172:173], v101 offset:0
    ds_read_b64_tr_b16 v[244:245], v101 offset:80
    ds_read_b64_tr_b16 a[132:133], v101 offset:160
    ds_read_b64_tr_b16 v[174:175], v101 offset:960
    ds_read_b64_tr_b16 v[246:247], v101 offset:1040
    ds_read_b64_tr_b16 a[134:135], v101 offset:1120
    s_waitcnt lgkmcnt(15)
    ds_write_b64 v28, v[56:57] offset:0
    ds_write_b64 v28, v[58:59] offset:8
    ds_write_b64 v28, v[64:65] offset:1024
    ds_write_b64 v28, v[66:67] offset:1032
    ds_write_b64 v28, v[72:73] offset:2048
    ds_write_b64 v28, v[74:75] offset:2056
    ds_write_b64 v28, v[80:81] offset:3072
    ds_write_b64 v28, v[82:83] offset:3080
    ds_write_b64 v28, v[88:89] offset:4096
    ds_write_b64 v28, v[90:91] offset:4104
    ds_write_b64 v28, v[96:97] offset:5120
    ds_write_b64 v28, v[98:99] offset:5128
    s_waitcnt lgkmcnt(0)
    v_and_b32 v56, 0, v21
    v_add_u32 v56, v56, v20
    ds_read_b64_tr_b16 a[40:41], v56 offset:0
    ds_read_b64_tr_b16 a[42:43], v56 offset:128
    v_and_b32 v57, 8, v21
    v_add_u32 v57, v57, v20
    ds_read_b64_tr_b16 a[184:185], v57 offset:0
    ds_read_b64_tr_b16 a[186:187], v57 offset:128
    v_and_b32 v64, 1024, v21
    v_add_u32 v64, v64, v20
    ds_read_b64_tr_b16 a[44:45], v64 offset:0
    ds_read_b64_tr_b16 a[46:47], v64 offset:128
    v_and_b32 v65, 1032, v21
    v_add_u32 v65, v65, v20
    ds_read_b64_tr_b16 a[188:189], v65 offset:0
    ds_read_b64_tr_b16 a[190:191], v65 offset:128
    v_and_b32 v72, 2048, v21
    v_add_u32 v72, v72, v20
    ds_read_b64_tr_b16 a[48:49], v72 offset:0
    ds_read_b64_tr_b16 a[50:51], v72 offset:128
    v_and_b32 v73, 2056, v21
    v_add_u32 v73, v73, v20
    ds_read_b64_tr_b16 a[192:193], v73 offset:0
    ds_read_b64_tr_b16 a[194:195], v73 offset:128
    v_and_b32 v80, 3072, v21
    v_add_u32 v80, v80, v20
    ds_read_b64_tr_b16 a[52:53], v80 offset:0
    ds_read_b64_tr_b16 a[54:55], v80 offset:128
    v_and_b32 v81, 3080, v21
    v_add_u32 v81, v81, v20
    ds_read_b64_tr_b16 a[196:197], v81 offset:0
    ds_read_b64_tr_b16 a[198:199], v81 offset:128
    v_and_b32 v88, 4096, v21
    v_add_u32 v88, v88, v20
    ds_read_b64_tr_b16 a[56:57], v88 offset:0
    ds_read_b64_tr_b16 a[58:59], v88 offset:128
    v_and_b32 v89, 4104, v21
    v_add_u32 v89, v89, v20
    ds_read_b64_tr_b16 a[200:201], v89 offset:0
    ds_read_b64_tr_b16 a[202:203], v89 offset:128
    v_and_b32 v96, 5120, v21
    v_add_u32 v96, v96, v20
    ds_read_b64_tr_b16 a[60:61], v96 offset:0
    ds_read_b64_tr_b16 a[62:63], v96 offset:128
    v_and_b32 v97, 5128, v21
    v_add_u32 v97, v97, v20
    ds_read_b64_tr_b16 a[204:205], v97 offset:0
    ds_read_b64_tr_b16 a[206:207], v97 offset:128
    s_waitcnt lgkmcnt(0)
    s_add_u32 s17, s49, 1327104
    s_add_u32 m0, s46, 92160
    s_nop 0
    buffer_load_dwordx4 v16, s[20:23], s17 offen lds
    s_add_u32 m0, s46, 93184
    s_mov_b64 exec, s[54:55]
    buffer_load_dwordx4 v17, s[20:23], s17 offen lds
    s_mov_b64 exec, -1
    s_add_u32 s17, s49, 1437696
    s_add_u32 m0, s46, 99840
    s_nop 0
    buffer_load_dwordx4 v16, s[20:23], s17 offen lds
    s_add_u32 m0, s46, 100864
    s_mov_b64 exec, s[54:55]
    buffer_load_dwordx4 v17, s[20:23], s17 offen lds
    s_mov_b64 exec, -1
    s_add_u32 s17, s49, 1548288
    s_add_u32 m0, s46, 107520
    s_nop 0
    buffer_load_dwordx4 v16, s[20:23], s17 offen lds
    s_add_u32 m0, s46, 108544
    s_mov_b64 exec, s[54:55]
    buffer_load_dwordx4 v17, s[20:23], s17 offen lds
    s_mov_b64 exec, -1
    s_add_u32 s17, s49, 1658880
    s_add_u32 m0, s46, 115200
    s_nop 0
    buffer_load_dwordx4 v16, s[20:23], s17 offen lds
    s_add_u32 m0, s46, 116224
    s_mov_b64 exec, s[54:55]
    buffer_load_dwordx4 v17, s[20:23], s17 offen lds
    s_mov_b64 exec, -1
    s_add_u32 s17, s49, 1769472
    s_add_u32 m0, s46, 122880
    s_nop 0
    buffer_load_dwordx4 v16, s[20:23], s17 offen lds
    s_add_u32 m0, s46, 123904
    s_mov_b64 exec, s[54:55]
    buffer_load_dwordx4 v17, s[20:23], s17 offen lds
    s_mov_b64 exec, -1
    s_add_u32 s17, s49, 1880064
    s_add_u32 m0, s46, 130560
    s_nop 0
    buffer_load_dwordx4 v16, s[20:23], s17 offen lds
    s_add_u32 m0, s46, 131584
    s_mov_b64 exec, s[54:55]
    buffer_load_dwordx4 v17, s[20:23], s17 offen lds
    s_mov_b64 exec, -1
    v_mfma_f32_16x16x32_bf16 v[36:39], v[152:155], v[104:107], 0
    v_mfma_f32_16x16x32_bf16 v[40:43], v[224:227], v[104:107], 0
    v_mfma_f32_16x16x32_bf16 v[44:47], a[40:43], v[104:107], 0
    v_mfma_f32_16x16x32_bf16 v[48:51], v[104:107], a[112:115], 0
    v_mfma_f32_16x16x32_bf16 v[52:55], v[104:107], a[184:187], 0
    v_mfma_f32_16x16x32_bf16 v[36:39], v[156:159], v[104:107], v[36:39]
    v_mfma_f32_16x16x32_bf16 v[40:43], v[228:231], v[104:107], v[40:43]
    v_mfma_f32_16x16x32_bf16 v[44:47], a[44:47], v[104:107], v[44:47]
    v_mfma_f32_16x16x32_bf16 v[48:51], v[104:107], a[116:119], v[48:51]
    v_mfma_f32_16x16x32_bf16 v[52:55], v[104:107], a[188:191], v[52:55]
    v_mfma_f32_16x16x32_bf16 v[36:39], v[160:163], v[104:107], v[36:39]
    v_mfma_f32_16x16x32_bf16 v[40:43], v[232:235], v[104:107], v[40:43]
    v_mfma_f32_16x16x32_bf16 v[44:47], a[48:51], v[104:107], v[44:47]
    v_mfma_f32_16x16x32_bf16 v[48:51], v[104:107], a[120:123], v[48:51]
    v_mfma_f32_16x16x32_bf16 v[52:55], v[104:107], a[192:195], v[52:55]
    v_mfma_f32_16x16x32_bf16 v[36:39], v[164:167], v[104:107], v[36:39]
    v_mfma_f32_16x16x32_bf16 v[40:43], v[236:239], v[104:107], v[40:43]
    v_mfma_f32_16x16x32_bf16 v[44:47], a[52:55], v[104:107], v[44:47]
    v_mfma_f32_16x16x32_bf16 v[48:51], v[104:107], a[124:127], v[48:51]
    v_mfma_f32_16x16x32_bf16 v[52:55], v[104:107], a[196:199], v[52:55]
    v_mfma_f32_16x16x32_bf16 v[36:39], v[168:171], v[104:107], v[36:39]
    v_mfma_f32_16x16x32_bf16 v[40:43], v[240:243], v[104:107], v[40:43]
    v_mfma_f32_16x16x32_bf16 v[44:47], a[56:59], v[104:107], v[44:47]
    v_mfma_f32_16x16x32_bf16 v[48:51], v[104:107], a[128:131], v[48:51]
    v_mfma_f32_16x16x32_bf16 v[52:55], v[104:107], a[200:203], v[52:55]
    v_mfma_f32_16x16x32_bf16 v[36:39], v[172:175], v[104:107], v[36:39]
    v_mfma_f32_16x16x32_bf16 v[40:43], v[244:247], v[104:107], v[40:43]
    v_mfma_f32_16x16x32_bf16 v[44:47], a[60:63], v[104:107], v[44:47]
    v_mfma_f32_16x16x32_bf16 v[48:51], v[104:107], a[132:135], v[48:51]
    v_mfma_f32_16x16x32_bf16 v[52:55], v[104:107], a[204:207], v[52:55]
    s_waitcnt vmcnt(12)
    s_barrier
    v_add_u32 v60, 46080, v23
    v_mov_b32 v59, 0
    ds_read_b32 v56, v60
    ds_read_b32 v57, v60 offset:80
    ds_read_b32 v58, v60 offset:160
    v_add_u32 v68, 53760, v23
    v_mov_b32 v67, 0
    ds_read_b32 v64, v68
    ds_read_b32 v65, v68 offset:80
    ds_read_b32 v66, v68 offset:160
    v_add_u32 v76, 61440, v23
    v_mov_b32 v75, 0
    ds_read_b32 v72, v76
    ds_read_b32 v73, v76 offset:80
    ds_read_b32 v74, v76 offset:160
    v_add_u32 v84, 69120, v23
    v_mov_b32 v83, 0
    ds_read_b32 v80, v84
    ds_read_b32 v81, v84 offset:80
    ds_read_b32 v82, v84 offset:160
    v_add_u32 v92, 76800, v23
    v_mov_b32 v91, 0
    ds_read_b32 v88, v92
    ds_read_b32 v89, v92 offset:80
    ds_read_b32 v90, v92 offset:160
    v_add_u32 v100, 84480, v23
    v_mov_b32 v99, 0
    ds_read_b32 v96, v100
    ds_read_b32 v97, v100 offset:80
    ds_read_b32 v98, v100 offset:160
    v_add_u32 v61, 46080, v19
    ds_read_b64_tr_b16 v[176:177], v61 offset:0
    ds_read_b64_tr_b16 v[248:249], v61 offset:80
    ds_read_b64_tr_b16 a[136:137], v61 offset:160
    ds_read_b64_tr_b16 v[178:179], v61 offset:960
    ds_read_b64_tr_b16 v[250:251], v61 offset:1040
    ds_read_b64_tr_b16 a[138:139], v61 offset:1120
    v_add_u32 v69, 53760, v19
    ds_read_b64_tr_b16 v[180:181], v69 offset:0
    ds_read_b64_tr_b16 v[252:253], v69 offset:80
    ds_read_b64_tr_b16 a[140:141], v69 offset:160
    ds_read_b64_tr_b16 v[182:183], v69 offset:960
    ds_read_b64_tr_b16 v[254:255], v69 offset:1040
    ds_read_b64_tr_b16 a[142:143], v69 offset:1120
    v_add_u32 v77, 61440, v19
    ds_read_b64_tr_b16 v[184:185], v77 offset:0
    ds_read_b64_tr_b16 a[0:1], v77 offset:80
    ds_read_b64_tr_b16 a[144:145], v77 offset:160
    ds_read_b64_tr_b16 v[186:187], v77 offset:960
    ds_read_b64_tr_b16 a[2:3], v77 offset:1040
    ds_read_b64_tr_b16 a[146:147], v77 offset:1120
    v_add_u32 v85, 69120, v19
    ds_read_b64_tr_b16 v[188:189], v85 offset:0
    ds_read_b64_tr_b16 a[4:5], v85 offset:80
    ds_read_b64_tr_b16 a[148:149], v85 offset:160
    ds_read_b64_tr_b16 v[190:191], v85 offset:960
    ds_read_b64_tr_b16 a[6:7], v85 offset:1040
    ds_read_b64_tr_b16 a[150:151], v85 offset:1120
    v_add_u32 v93, 76800, v19
    ds_read_b64_tr_b16 v[192:193], v93 offset:0
    ds_read_b64_tr_b16 a[8:9], v93 offset:80
    ds_read_b64_tr_b16 a[152:153], v93 offset:160
    ds_read_b64_tr_b16 v[194:195], v93 offset:960
    ds_read_b64_tr_b16 a[10:11], v93 offset:1040
    ds_read_b64_tr_b16 a[154:155], v93 offset:1120
    v_add_u32 v101, 84480, v19
    ds_read_b64_tr_b16 v[196:197], v101 offset:0
    ds_read_b64_tr_b16 a[12:13], v101 offset:80
    ds_read_b64_tr_b16 a[156:157], v101 offset:160
    ds_read_b64_tr_b16 v[198:199], v101 offset:960
    ds_read_b64_tr_b16 a[14:15], v101 offset:1040
    ds_read_b64_tr_b16 a[158:159], v101 offset:1120
    s_waitcnt lgkmcnt(15)
    ds_write_b64 v28, v[56:57] offset:6144
    ds_write_b64 v28, v[58:59] offset:6152
    ds_write_b64 v28, v[64:65] offset:7168
    ds_write_b64 v28, v[66:67] offset:7176
    ds_write_b64 v28, v[72:73] offset:8192
    ds_write_b64 v28, v[74:75] offset:8200
    ds_write_b64 v28, v[80:81] offset:9216
    ds_write_b64 v28, v[82:83] offset:9224
    ds_write_b64 v28, v[88:89] offset:10240
    ds_write_b64 v28, v[90:91] offset:10248
    ds_write_b64 v28, v[96:97] offset:11264
    ds_write_b64 v28, v[98:99] offset:11272
    s_waitcnt lgkmcnt(0)
    v_and_b32 v56, 6144, v21
    v_add_u32 v56, v56, v20
    ds_read_b64_tr_b16 a[64:65], v56 offset:0
    ds_read_b64_tr_b16 a[66:67], v56 offset:128
    v_and_b32 v57, 6152, v21
    v_add_u32 v57, v57, v20
    ds_read_b64_tr_b16 a[208:209], v57 offset:0
    ds_read_b64_tr_b16 a[210:211], v57 offset:128
    v_and_b32 v64, 7168, v21
    v_add_u32 v64, v64, v20
    ds_read_b64_tr_b16 a[68:69], v64 offset:0
    ds_read_b64_tr_b16 a[70:71], v64 offset:128
    v_and_b32 v65, 7176, v21
    v_add_u32 v65, v65, v20
    ds_read_b64_tr_b16 a[212:213], v65 offset:0
    ds_read_b64_tr_b16 a[214:215], v65 offset:128
    v_and_b32 v72, 8192, v21
    v_add_u32 v72, v72, v20
    ds_read_b64_tr_b16 a[72:73], v72 offset:0
    ds_read_b64_tr_b16 a[74:75], v72 offset:128
    v_and_b32 v73, 8200, v21
    v_add_u32 v73, v73, v20
    ds_read_b64_tr_b16 a[216:217], v73 offset:0
    ds_read_b64_tr_b16 a[218:219], v73 offset:128
    v_and_b32 v80, 9216, v21
    v_add_u32 v80, v80, v20
    ds_read_b64_tr_b16 a[76:77], v80 offset:0
    ds_read_b64_tr_b16 a[78:79], v80 offset:128
    v_and_b32 v81, 9224, v21
    v_add_u32 v81, v81, v20
    ds_read_b64_tr_b16 a[220:221], v81 offset:0
    ds_read_b64_tr_b16 a[222:223], v81 offset:128
    v_and_b32 v88, 10240, v21
    v_add_u32 v88, v88, v20
    ds_read_b64_tr_b16 a[80:81], v88 offset:0
    ds_read_b64_tr_b16 a[82:83], v88 offset:128
    v_and_b32 v89, 10248, v21
    v_add_u32 v89, v89, v20
    ds_read_b64_tr_b16 a[224:225], v89 offset:0
    ds_read_b64_tr_b16 a[226:227], v89 offset:128
    v_and_b32 v96, 11264, v21
    v_add_u32 v96, v96, v20
    ds_read_b64_tr_b16 a[84:85], v96 offset:0
    ds_read_b64_tr_b16 a[86:87], v96 offset:128
    v_and_b32 v97, 11272, v21
    v_add_u32 v97, v97, v20
    ds_read_b64_tr_b16 a[228:229], v97 offset:0
    ds_read_b64_tr_b16 a[230:231], v97 offset:128
    s_waitcnt lgkmcnt(0)
    v_mfma_f32_16x16x32_bf16 v[36:39], v[176:179], v[104:107], v[36:39]
    v_mfma_f32_16x16x32_bf16 v[40:43], v[248:251], v[104:107], v[40:43]
    v_mfma_f32_16x16x32_bf16 v[44:47], a[64:67], v[104:107], v[44:47]
    v_mfma_f32_16x16x32_bf16 v[48:51], v[104:107], a[136:139], v[48:51]
    v_mfma_f32_16x16x32_bf16 v[52:55], v[104:107], a[208:211], v[52:55]
    v_mfma_f32_16x16x32_bf16 v[36:39], v[180:183], v[104:107], v[36:39]
    v_mfma_f32_16x16x32_bf16 v[40:43], v[252:255], v[104:107], v[40:43]
    v_mfma_f32_16x16x32_bf16 v[44:47], a[68:71], v[104:107], v[44:47]
    v_mfma_f32_16x16x32_bf16 v[48:51], v[104:107], a[140:143], v[48:51]
    v_mfma_f32_16x16x32_bf16 v[52:55], v[104:107], a[212:215], v[52:55]
    v_mfma_f32_16x16x32_bf16 v[36:39], v[184:187], v[104:107], v[36:39]
    v_mfma_f32_16x16x32_bf16 v[40:43], a[0:3], v[104:107], v[40:43]
    v_mfma_f32_16x16x32_bf16 v[44:47], a[72:75], v[104:107], v[44:47]
    v_mfma_f32_16x16x32_bf16 v[48:51], v[104:107], a[144:147], v[48:51]
    v_mfma_f32_16x16x32_bf16 v[52:55], v[104:107], a[216:219], v[52:55]
    v_mfma_f32_16x16x32_bf16 v[36:39], v[188:191], v[104:107], v[36:39]
    v_mfma_f32_16x16x32_bf16 v[40:43], a[4:7], v[104:107], v[40:43]
    v_mfma_f32_16x16x32_bf16 v[44:47], a[76:79], v[104:107], v[44:47]
    v_mfma_f32_16x16x32_bf16 v[48:51], v[104:107], a[148:151], v[48:51]
    v_mfma_f32_16x16x32_bf16 v[52:55], v[104:107], a[220:223], v[52:55]
    v_mfma_f32_16x16x32_bf16 v[36:39], v[192:195], v[104:107], v[36:39]
    v_mfma_f32_16x16x32_bf16 v[40:43], a[8:11], v[104:107], v[40:43]
    v_mfma_f32_16x16x32_bf16 v[44:47], a[80:83], v[104:107], v[44:47]
    v_mfma_f32_16x16x32_bf16 v[48:51], v[104:107], a[152:155], v[48:51]
    v_mfma_f32_16x16x32_bf16 v[52:55], v[104:107], a[224:227], v[52:55]
    v_mfma_f32_16x16x32_bf16 v[36:39], v[196:199], v[104:107], v[36:39]
    v_mfma_f32_16x16x32_bf16 v[40:43], a[12:15], v[104:107], v[40:43]
    v_mfma_f32_16x16x32_bf16 v[44:47], a[84:87], v[104:107], v[44:47]
    v_mfma_f32_16x16x32_bf16 v[48:51], v[104:107], a[156:159], v[48:51]
    v_mfma_f32_16x16x32_bf16 v[52:55], v[104:107], a[228:231], v[52:55]
    s_waitcnt vmcnt(0)
    s_barrier
    v_add_u32 v60, 92160, v23
    v_mov_b32 v59, 0
    ds_read_b32 v56, v60
    ds_read_b32 v57, v60 offset:80
    ds_read_b32 v58, v60 offset:160
    v_add_u32 v68, 99840, v23
    v_mov_b32 v67, 0
    ds_read_b32 v64, v68
    ds_read_b32 v65, v68 offset:80
    ds_read_b32 v66, v68 offset:160
    v_add_u32 v76, 107520, v23
    v_mov_b32 v75, 0
    ds_read_b32 v72, v76
    ds_read_b32 v73, v76 offset:80
    ds_read_b32 v74, v76 offset:160
    v_add_u32 v84, 115200, v23
    v_mov_b32 v83, 0
    ds_read_b32 v80, v84
    ds_read_b32 v81, v84 offset:80
    ds_read_b32 v82, v84 offset:160
    v_add_u32 v92, 122880, v23
    v_mov_b32 v91, 0
    ds_read_b32 v88, v92
    ds_read_b32 v89, v92 offset:80
    ds_read_b32 v90, v92 offset:160
    v_add_u32 v100, 130560, v23
    v_mov_b32 v99, 0
    ds_read_b32 v96, v100
    ds_read_b32 v97, v100 offset:80
    ds_read_b32 v98, v100 offset:160
    v_add_u32 v61, 92160, v19
    ds_read_b64_tr_b16 v[200:201], v61 offset:0
    ds_read_b64_tr_b16 a[16:17], v61 offset:80
    ds_read_b64_tr_b16 a[160:161], v61 offset:160
    ds_read_b64_tr_b16 v[202:203], v61 offset:960
    ds_read_b64_tr_b16 a[18:19], v61 offset:1040
    ds_read_b64_tr_b16 a[162:163], v61 offset:1120
    v_add_u32 v69, 99840, v19
    ds_read_b64_tr_b16 v[204:205], v69 offset:0
    ds_read_b64_tr_b16 a[20:21], v69 offset:80
    ds_read_b64_tr_b16 a[164:165], v69 offset:160
    ds_read_b64_tr_b16 v[206:207], v69 offset:960
    ds_read_b64_tr_b16 a[22:23], v69 offset:1040
    ds_read_b64_tr_b16 a[166:167], v69 offset:1120
    v_add_u32 v77, 107520, v19
    ds_read_b64_tr_b16 v[208:209], v77 offset:0
    ds_read_b64_tr_b16 a[24:25], v77 offset:80
    ds_read_b64_tr_b16 a[168:169], v77 offset:160
    ds_read_b64_tr_b16 v[210:211], v77 offset:960
    ds_read_b64_tr_b16 a[26:27], v77 offset:1040
    ds_read_b64_tr_b16 a[170:171], v77 offset:1120
    v_add_u32 v85, 115200, v19
    ds_read_b64_tr_b16 v[212:213], v85 offset:0
    ds_read_b64_tr_b16 a[28:29], v85 offset:80
    ds_read_b64_tr_b16 a[172:173], v85 offset:160
    ds_read_b64_tr_b16 v[214:215], v85 offset:960
    ds_read_b64_tr_b16 a[30:31], v85 offset:1040
    ds_read_b64_tr_b16 a[174:175], v85 offset:1120
    v_add_u32 v93, 122880, v19
    ds_read_b64_tr_b16 v[216:217], v93 offset:0
    ds_read_b64_tr_b16 a[32:33], v93 offset:80
    ds_read_b64_tr_b16 a[176:177], v93 offset:160
    ds_read_b64_tr_b16 v[218:219], v93 offset:960
    ds_read_b64_tr_b16 a[34:35], v93 offset:1040
    ds_read_b64_tr_b16 a[178:179], v93 offset:1120
    v_add_u32 v101, 130560, v19
    ds_read_b64_tr_b16 v[220:221], v101 offset:0
    ds_read_b64_tr_b16 a[36:37], v101 offset:80
    ds_read_b64_tr_b16 a[180:181], v101 offset:160
    ds_read_b64_tr_b16 v[222:223], v101 offset:960
    ds_read_b64_tr_b16 a[38:39], v101 offset:1040
    ds_read_b64_tr_b16 a[182:183], v101 offset:1120
    s_waitcnt lgkmcnt(15)
    ds_write_b64 v28, v[56:57] offset:12288
    ds_write_b64 v28, v[58:59] offset:12296
    ds_write_b64 v28, v[64:65] offset:13312
    ds_write_b64 v28, v[66:67] offset:13320
    ds_write_b64 v28, v[72:73] offset:14336
    ds_write_b64 v28, v[74:75] offset:14344
    ds_write_b64 v28, v[80:81] offset:15360
    ds_write_b64 v28, v[82:83] offset:15368
    ds_write_b64 v28, v[88:89] offset:16384
    ds_write_b64 v28, v[90:91] offset:16392
    ds_write_b64 v28, v[96:97] offset:17408
    ds_write_b64 v28, v[98:99] offset:17416
    s_waitcnt lgkmcnt(0)
    v_and_b32 v56, 12288, v21
    v_add_u32 v56, v56, v20
    ds_read_b64_tr_b16 a[88:89], v56 offset:0
    ds_read_b64_tr_b16 a[90:91], v56 offset:128
    v_and_b32 v57, 12296, v21
    v_add_u32 v57, v57, v20
    ds_read_b64_tr_b16 a[232:233], v57 offset:0
    ds_read_b64_tr_b16 a[234:235], v57 offset:128
    v_and_b32 v64, 13312, v21
    v_add_u32 v64, v64, v20
    ds_read_b64_tr_b16 a[92:93], v64 offset:0
    ds_read_b64_tr_b16 a[94:95], v64 offset:128
    v_and_b32 v65, 13320, v21
    v_add_u32 v65, v65, v20
    ds_read_b64_tr_b16 a[236:237], v65 offset:0
    ds_read_b64_tr_b16 a[238:239], v65 offset:128
    v_and_b32 v72, 14336, v21
    v_add_u32 v72, v72, v20
    ds_read_b64_tr_b16 a[96:97], v72 offset:0
    ds_read_b64_tr_b16 a[98:99], v72 offset:128
    v_and_b32 v73, 14344, v21
    v_add_u32 v73, v73, v20
    ds_read_b64_tr_b16 a[240:241], v73 offset:0
    ds_read_b64_tr_b16 a[242:243], v73 offset:128
    v_and_b32 v80, 15360, v21
    v_add_u32 v80, v80, v20
    ds_read_b64_tr_b16 a[100:101], v80 offset:0
    ds_read_b64_tr_b16 a[102:103], v80 offset:128
    v_and_b32 v81, 15368, v21
    v_add_u32 v81, v81, v20
    ds_read_b64_tr_b16 a[244:245], v81 offset:0
    ds_read_b64_tr_b16 a[246:247], v81 offset:128
    v_and_b32 v88, 16384, v21
    v_add_u32 v88, v88, v20
    ds_read_b64_tr_b16 a[104:105], v88 offset:0
    ds_read_b64_tr_b16 a[106:107], v88 offset:128
    v_and_b32 v89, 16392, v21
    v_add_u32 v89, v89, v20
    ds_read_b64_tr_b16 a[248:249], v89 offset:0
    ds_read_b64_tr_b16 a[250:251], v89 offset:128
    v_and_b32 v96, 17408, v21
    v_add_u32 v96, v96, v20
    ds_read_b64_tr_b16 a[108:109], v96 offset:0
    ds_read_b64_tr_b16 a[110:111], v96 offset:128
    v_and_b32 v97, 17416, v21
    v_add_u32 v97, v97, v20
    ds_read_b64_tr_b16 a[252:253], v97 offset:0
    ds_read_b64_tr_b16 a[254:255], v97 offset:128
    s_waitcnt lgkmcnt(0)
    v_mfma_f32_16x16x32_bf16 v[36:39], v[200:203], v[104:107], v[36:39]
    v_mfma_f32_16x16x32_bf16 v[40:43], a[16:19], v[104:107], v[40:43]
    v_mfma_f32_16x16x32_bf16 v[44:47], a[88:91], v[104:107], v[44:47]
    v_mfma_f32_16x16x32_bf16 v[48:51], v[104:107], a[160:163], v[48:51]
    v_mfma_f32_16x16x32_bf16 v[52:55], v[104:107], a[232:235], v[52:55]
    v_mfma_f32_16x16x32_bf16 v[36:39], v[204:207], v[104:107], v[36:39]
    v_mfma_f32_16x16x32_bf16 v[40:43], a[20:23], v[104:107], v[40:43]
    v_mfma_f32_16x16x32_bf16 v[44:47], a[92:95], v[104:107], v[44:47]
    v_mfma_f32_16x16x32_bf16 v[48:51], v[104:107], a[164:167], v[48:51]
    v_mfma_f32_16x16x32_bf16 v[52:55], v[104:107], a[236:239], v[52:55]
    v_mfma_f32_16x16x32_bf16 v[36:39], v[208:211], v[104:107], v[36:39]
    v_mfma_f32_16x16x32_bf16 v[40:43], a[24:27], v[104:107], v[40:43]
    v_mfma_f32_16x16x32_bf16 v[44:47], a[96:99], v[104:107], v[44:47]
    v_mfma_f32_16x16x32_bf16 v[48:51], v[104:107], a[168:171], v[48:51]
    v_mfma_f32_16x16x32_bf16 v[52:55], v[104:107], a[240:243], v[52:55]
    v_mfma_f32_16x16x32_bf16 v[36:39], v[212:215], v[104:107], v[36:39]
    v_mfma_f32_16x16x32_bf16 v[40:43], a[28:31], v[104:107], v[40:43]
    v_mfma_f32_16x16x32_bf16 v[44:47], a[100:103], v[104:107], v[44:47]
    v_mfma_f32_16x16x32_bf16 v[48:51], v[104:107], a[172:175], v[48:51]
    v_mfma_f32_16x16x32_bf16 v[52:55], v[104:107], a[244:247], v[52:55]
    v_mfma_f32_16x16x32_bf16 v[36:39], v[216:219], v[104:107], v[36:39]
    v_mfma_f32_16x16x32_bf16 v[40:43], a[32:35], v[104:107], v[40:43]
    v_mfma_f32_16x16x32_bf16 v[44:47], a[104:107], v[104:107], v[44:47]
    v_mfma_f32_16x16x32_bf16 v[48:51], v[104:107], a[176:179], v[48:51]
    v_mfma_f32_16x16x32_bf16 v[52:55], v[104:107], a[248:251], v[52:55]
    v_mfma_f32_16x16x32_bf16 v[36:39], v[220:223], v[104:107], v[36:39]
    v_mfma_f32_16x16x32_bf16 v[40:43], a[36:39], v[104:107], v[40:43]
    v_mfma_f32_16x16x32_bf16 v[44:47], a[108:111], v[104:107], v[44:47]
    v_mfma_f32_16x16x32_bf16 v[48:51], v[104:107], a[180:183], v[48:51]
    v_mfma_f32_16x16x32_bf16 v[52:55], v[104:107], a[252:255], v[52:55]
    s_barrier
    v_lshlrev_b32 v10, 5, v7
    s_lshl_b32 s17, s51, 4
    v_add_u32 v10, s17, v10
    v_mul_u32_u24 v6, 1536, v8
    v_add_u32 v10, v10, v6
    s_lshl_b32 s17, s14, 7
    s_add_u32 s17, s17, 73728
    v_lshl_add_u32 v11, v7, 3, s17
    v_lshl_add_u32 v12, v8, 5, s17
    v_lshlrev_b32 v13, 5, v7
    s_lshl_b32 s17, s51, 4
    v_add_u32 v13, s17, v13
    s_lshr_b32 s17, s50, 2
    s_add_u32 s17, s17, 64
    s_lshl_b32 s17, s17, 9
    s_and_b32 s18, s50, 3
    s_lshl_b32 s18, s18, 2
    s_add_u32 s17, s17, s18
    v_add_u32 v14, s17, v13
    v_lshrrev_b32 v5, 1, v8
    v_lshl_add_u32 v13, v5, 9, v13
    v_and_b32 v5, 1, v8
    v_lshl_add_u32 v13, v5, 3, v13
    s_lshl_b32 s17, s50, 10
    v_add_u32 v13, s17, v13
    s_lshl_b32 s49, s15, 7
    s_lshl_b32 s17, s14, 2
    s_add_u32 s49, s49, s17
    s_add_u32 s49, s49, 181760
    s_mov_b32 s52, 0x3eae1a93
    v_mov_b32 v6, 0xf149f2ca
    v_lshl_add_u32 v5, v8, 2, 0
    v_sub_u32 v5, v5, v7
    v_cmp_le_i32 vcc, 9, v5
    s_nop 1
    v_cndmask_b32 v72, v6, v4, vcc
    v_add_u32 v5, 7, v5
    v_cmp_ge_u32 vcc, 7, v5
    s_nop 1
    v_cndmask_b32 v76, v6, v4, vcc
    v_lshl_add_u32 v5, v8, 2, 1
    v_sub_u32 v5, v5, v7
    v_cmp_le_i32 vcc, 9, v5
    s_nop 1
    v_cndmask_b32 v73, v6, v4, vcc
    v_add_u32 v5, 7, v5
    v_cmp_ge_u32 vcc, 7, v5
    s_nop 1
    v_cndmask_b32 v77, v6, v4, vcc
    v_lshl_add_u32 v5, v8, 2, 2
    v_sub_u32 v5, v5, v7
    v_cmp_le_i32 vcc, 9, v5
    s_nop 1
    v_cndmask_b32 v74, v6, v4, vcc
    v_add_u32 v5, 7, v5
    v_cmp_ge_u32 vcc, 7, v5
    s_nop 1
    v_cndmask_b32 v78, v6, v4, vcc
    v_lshl_add_u32 v5, v8, 2, 3
    v_sub_u32 v5, v5, v7
    v_cmp_le_i32 vcc, 9, v5
    s_nop 1
    v_cndmask_b32 v75, v6, v4, vcc
    v_add_u32 v5, 7, v5
    v_cmp_ge_u32 vcc, 7, v5
    s_nop 1
    v_cndmask_b32 v79, v6, v4, vcc
    v_and_b32 v111, 0x200, v0
    v_lshl_add_u32 v111, v7, 5, v111
    v_and_b32 v5, 1, v8
    v_lshl_add_u32 v111, v5, 4, v111
    v_mov_b32 v112, 0
    v_mov_b32 v113, 0
    v_mov_b32 v114, 0
    v_mov_b32 v115, 0
    v_mov_b32 v136, 0
    v_mov_b32 v137, 0
    v_mov_b32 v138, 0
    v_mov_b32 v139, 0
    v_mov_b32 v140, 0
    v_mov_b32 v141, 0
    v_mov_b32 v142, 0
    v_mov_b32 v143, 0
    v_mov_b32 v116, 0x3f803f80
    v_mov_b32 v117, 0x3f803f80
    v_mov_b32 v118, 0x3f803f80
    v_mov_b32 v119, 0x3f803f80
    v_mov_b32 v131, 0
    v_mov_b32 v135, 0
    v_mbcnt_lo_u32_b32 v24, -1, 0
    v_mbcnt_hi_u32_b32 v24, -1, v24
    v_and_b32 v25, 1, v24
    v_lshlrev_b32 v25, 7, v25
    v_lshlrev_b32 v24, 1, v24
    v_and_or_b32 v24, v24, 12, v25
    s_mov_b32 s16, 0
Laq_pure:
    global_load_dword v25, v24, s[12:13] sc1
    s_add_u32 s16, s16, 1
    s_cmp_gt_u32 s16, 100000
    s_cbranch_scc1 L_role_aq_abort
    s_mov_b32 s6, 0
    s_waitcnt vmcnt(0)
    v_readlane_b32 s7, v25, 0
    s_nop 0
    s_add_u32 s6, s6, s7
    v_readlane_b32 s7, v25, 1
    s_nop 0
    s_add_u32 s6, s6, s7
    v_readlane_b32 s7, v25, 2
    s_nop 0
    s_add_u32 s6, s6, s7
    v_readlane_b32 s7, v25, 3
    s_nop 0
    s_add_u32 s6, s6, s7
    v_readlane_b32 s7, v25, 4
    s_nop 0
    s_add_u32 s6, s6, s7
    v_readlane_b32 s7, v25, 5
    s_nop 0
    s_add_u32 s6, s6, s7
    v_readlane_b32 s7, v25, 6
    s_nop 0
    s_add_u32 s6, s6, s7
    v_readlane_b32 s7, v25, 7
    s_nop 0
    s_add_u32 s6, s6, s7
    v_readlane_b32 s7, v25, s3
    s_nop 0
    s_cmp_ge_u32 s7, 32
    s_cselect_b32 s61, 1, 0
    s_cselect_b32 s6, 256, s6
    s_cmp_lt_u32 s6, 256
    s_cbranch_scc1 Laq_pure
    s_cmp_eq_u32 s61, 0
    s_cbranch_scc1 Laq_slow
    s_mov_b32 s36, s63
    s_mov_b32 s34, s63
    s_mov_b32 s37, 0
    s_lshl_b32 s56, s63, 6
    s_mul_i32 s58, s14, 9216
    s_mov_b32 s40, 36864
    s_mov_b32 s59, s58
    s_mov_b32 s43, 0
    s_mov_b32 s28, s8
    s_mov_b32 s29, s9
    s_mov_b32 s30, 0
    s_mov_b32 s31, 0x00020000
    s_mul_i32 s41, s63, 4718592
    s_add_u32 s41, s41, s58
    s_add_u32 s41, s41, 6291456
    s_mul_i32 s42, s56, 22528
    s_add_u32 s42, s42, 180224
    s_cmp_lg_u32 s14, 0
    s_cbranch_scc1 Laqf_ini_d
    v_mov_b32 v5, 160
    s_mov_b32 s16, 0
Laqf_ini:
    global_load_dword v6, v5, s[12:13] sc1
    s_add_u32 s16, s16, 1
    s_cmp_gt_u32 s16, 100000
    s_cbranch_scc1 L_role_aq_abort
    s_waitcnt vmcnt(0)
    v_cmp_gt_u32 vcc, 123, v6
    s_nop 0
    s_cbranch_vccz Laqf_ini_d
    s_sleep 8
    s_branch Laqf_ini
Laqf_ini_d:
    s_barrier
    s_branch Laqf_poll
Laqf_item:
    s_waitcnt vmcnt(2)
Laqf_go:
    s_barrier
    s_xor_b32 s40, s40, 36864
    s_xor_b32 s59, s59, 36864
    s_xor_b32 s66, s66, 0x2000
    s_xor_b32 s71, s71, 0x2000
    s_mov_b32 s35, s37
    s_mov_b32 s57, s56
    s_add_u32 s37, s37, 1
    s_add_u32 s56, s56, 1
    s_add_u32 s41, s41, 36864
    s_add_u32 s42, s42, 22528
    s_mov_b32 s62, 0
    v_lshlrev_b32 v9, 9, v8
    v_lshl_add_u32 v9, v7, 4, v9
    s_lshl_b32 s17, s51, 8
    s_add_u32 s17, s17, s40
    v_add_u32 v9, s17, v9
    ds_read_b128 v[56:59], v9 offset:0
    ds_read_b128 v[60:63], v9 offset:2048
    ds_read_b128 v[64:67], v9 offset:4096
    ds_read_b128 v[104:107], v9 offset:6144
    s_waitcnt lgkmcnt(3)
    v_mfma_f32_16x16x32_bf16 v[16:19], v[152:155], v[56:59], 0
    v_add_f32 v80, v80, v84
    v_mfma_f32_16x16x32_bf16 v[20:23], v[224:227], v[56:59], 0
    v_add_f32 v81, v81, v85
    v_mfma_f32_16x16x32_bf16 v[24:27], a[40:43], v[56:59], 0
    v_add_f32 v82, v82, v86
    ds_read_b128 v[56:59], v9 offset:8192
    s_waitcnt lgkmcnt(3)
    v_mfma_f32_16x16x32_bf16 v[16:19], v[156:159], v[60:63], v[16:19]
    v_add_f32 v83, v83, v87
    v_mfma_f32_16x16x32_bf16 v[20:23], v[228:231], v[60:63], v[20:23]
    v_add_f32 v80, v80, v88
    v_mfma_f32_16x16x32_bf16 v[24:27], a[44:47], v[60:63], v[24:27]
    v_add_f32 v81, v81, v89
    ds_read_b128 v[60:63], v9 offset:10240
    s_waitcnt lgkmcnt(3)
    v_mfma_f32_16x16x32_bf16 v[16:19], v[160:163], v[64:67], v[16:19]
    v_add_f32 v82, v82, v90
    v_mfma_f32_16x16x32_bf16 v[20:23], v[232:235], v[64:67], v[20:23]
    v_add_f32 v83, v83, v91
    v_mfma_f32_16x16x32_bf16 v[24:27], a[48:51], v[64:67], v[24:27]
    v_add_f32 v80, v80, v82
    ds_read_b128 v[64:67], v9 offset:12288
    s_waitcnt lgkmcnt(3)
    v_mfma_f32_16x16x32_bf16 v[16:19], v[164:167], v[104:107], v[16:19]
    v_add_f32 v81, v81, v83
    v_mfma_f32_16x16x32_bf16 v[20:23], v[236:239], v[104:107], v[20:23]
    v_mov_b32 v82, v80
    v_mfma_f32_16x16x32_bf16 v[24:27], a[52:55], v[104:107], v[24:27]
    v_mov_b32 v83, v81
    ds_read_b128 v[104:107], v9 offset:14336
    s_waitcnt lgkmcnt(3)
    v_mfma_f32_16x16x32_bf16 v[16:19], v[168:171], v[56:59], v[16:19]
    v_permlane32_swap_b32 v80, v82
    v_mfma_f32_16x16x32_bf16 v[20:23], v[240:243], v[56:59], v[20:23]
    v_permlane32_swap_b32 v81, v83
    v_mfma_f32_16x16x32_bf16 v[24:27], a[56:59], v[56:59], v[24:27]
    v_add_f32 v80, v80, v82
    ds_read_b128 v[56:59], v9 offset:16384
    s_waitcnt lgkmcnt(3)
    v_mfma_f32_16x16x32_bf16 v[16:19], v[172:175], v[60:63], v[16:19]
    v_add_f32 v81, v81, v83
    v_mfma_f32_16x16x32_bf16 v[20:23], v[244:247], v[60:63], v[20:23]
    v_mov_b32 v82, v80
    v_mfma_f32_16x16x32_bf16 v[24:27], a[60:63], v[60:63], v[24:27]
    v_mov_b32 v83, v81
    ds_read_b128 v[60:63], v9 offset:18432
    s_waitcnt lgkmcnt(3)
    v_mfma_f32_16x16x32_bf16 v[16:19], v[176:179], v[64:67], v[16:19]
    v_permlane16_swap_b32 v80, v82
    v_mfma_f32_16x16x32_bf16 v[20:23], v[248:251], v[64:67], v[20:23]
    v_permlane16_swap_b32 v81, v83
    v_mfma_f32_16x16x32_bf16 v[24:27], a[64:67], v[64:67], v[24:27]
    v_add_f32 v80, v80, v82
    ds_read_b128 v[64:67], v9 offset:20480
    s_waitcnt lgkmcnt(3)
    v_mfma_f32_16x16x32_bf16 v[16:19], v[180:183], v[104:107], v[16:19]
    v_add_f32 v81, v81, v83
    v_mfma_f32_16x16x32_bf16 v[20:23], v[252:255], v[104:107], v[20:23]
    v_mul_f32 v80, 0x3ae38e39, v80
    v_mfma_f32_16x16x32_bf16 v[24:27], a[68:71], v[104:107], v[24:27]
    v_mul_f32 v81, 0x3ae38e39, v81
    ds_read_b128 v[104:107], v9 offset:22528
    s_waitcnt lgkmcnt(3)
    v_mfma_f32_16x16x32_bf16 v[16:19], v[184:187], v[56:59], v[16:19]
    v_fma_f32 v81, -v80, v80, v81
    v_mfma_f32_16x16x32_bf16 v[20:23], a[0:3], v[56:59], v[20:23]
    v_max_f32 v81, 0, v81
    v_mfma_f32_16x16x32_bf16 v[24:27], a[72:75], v[56:59], v[24:27]
    v_add_f32 v81, 0x3727c5ac, v81
    ds_read_b128 v[56:59], v9 offset:24576
    s_waitcnt lgkmcnt(3)
    v_mfma_f32_16x16x32_bf16 v[16:19], v[188:191], v[60:63], v[16:19]
    v_rsq_f32 v92, v81
    v_mfma_f32_16x16x32_bf16 v[20:23], a[4:7], v[60:63], v[20:23]
    v_mul_f32 v93, v80, v92
    v_mfma_f32_16x16x32_bf16 v[24:27], a[76:79], v[60:63], v[24:27]
    ds_write_b64 v11, v[92:93]
    ds_read_b128 v[60:63], v9 offset:26624
    s_waitcnt lgkmcnt(4)
    v_mfma_f32_16x16x32_bf16 v[16:19], v[192:195], v[64:67], v[16:19]
    ds_read_b128 v[96:99], v12
    v_mfma_f32_16x16x32_bf16 v[20:23], a[8:11], v[64:67], v[20:23]
    ds_read_b128 v[100:103], v12 offset:16
    v_mfma_f32_16x16x32_bf16 v[24:27], a[80:83], v[64:67], v[24:27]
    s_waitcnt vmcnt(0)
    buffer_load_dword v2, v1, s[8:11], s42 offen sc1
    s_cmp_lg_u32 s43, 0
    s_cselect_b64 exec, 1, 0
    buffer_store_dword v3, v4, s[8:11], s43 offen
    s_mov_b64 exec, -1
    s_mov_b32 s43, 0
    ds_read_b128 v[64:67], v9 offset:28672
    s_waitcnt lgkmcnt(6)
    v_mfma_f32_16x16x32_bf16 v[16:19], v[196:199], v[104:107], v[16:19]
    v_mfma_f32_16x16x32_bf16 v[20:23], a[12:15], v[104:107], v[20:23]
    v_mfma_f32_16x16x32_bf16 v[24:27], a[84:87], v[104:107], v[24:27]
    ds_read_b128 v[104:107], v9 offset:30720
    s_waitcnt lgkmcnt(6)
    v_mfma_f32_16x16x32_bf16 v[16:19], v[200:203], v[56:59], v[16:19]
    v_mfma_f32_16x16x32_bf16 v[20:23], a[16:19], v[56:59], v[20:23]
    v_mfma_f32_16x16x32_bf16 v[24:27], a[88:91], v[56:59], v[24:27]
    ds_read_b128 v[56:59], v9 offset:32768
    s_waitcnt lgkmcnt(5)
    v_mfma_f32_16x16x32_bf16 v[16:19], v[204:207], v[60:63], v[16:19]
    v_mfma_f32_16x16x32_bf16 v[20:23], a[20:23], v[60:63], v[20:23]
    v_mfma_f32_16x16x32_bf16 v[24:27], a[92:95], v[60:63], v[24:27]
    ds_read_b128 v[60:63], v9 offset:34816
    s_waitcnt lgkmcnt(3)
    v_mfma_f32_16x16x32_bf16 v[16:19], v[208:211], v[64:67], v[16:19]
    v_mfma_f32_16x16x32_bf16 v[20:23], a[24:27], v[64:67], v[20:23]
    v_mfma_f32_16x16x32_bf16 v[24:27], a[96:99], v[64:67], v[24:27]
    ds_read_b128 v[64:67], v9 offset:0
    s_waitcnt lgkmcnt(3)
    v_mfma_f32_16x16x32_bf16 v[16:19], v[212:215], v[104:107], v[16:19]
    v_mfma_f32_16x16x32_bf16 v[20:23], a[28:31], v[104:107], v[20:23]
    v_mfma_f32_16x16x32_bf16 v[24:27], a[100:103], v[104:107], v[24:27]
    ds_read_b128 v[104:107], v9 offset:2048
    s_waitcnt lgkmcnt(3)
    v_mfma_f32_16x16x32_bf16 v[16:19], v[216:219], v[56:59], v[16:19]
    v_mfma_f32_16x16x32_bf16 v[20:23], a[32:35], v[56:59], v[20:23]
    v_mfma_f32_16x16x32_bf16 v[24:27], a[104:107], v[56:59], v[24:27]
    ds_read_b128 v[56:59], v9 offset:4096
    s_waitcnt lgkmcnt(3)
    v_mfma_f32_16x16x32_bf16 v[16:19], v[220:223], v[60:63], v[16:19]
    v_mfma_f32_16x16x32_bf16 v[20:23], a[36:39], v[60:63], v[20:23]
    v_mfma_f32_16x16x32_bf16 v[24:27], a[108:111], v[60:63], v[24:27]
    ds_read_b128 v[60:63], v9 offset:6144
    s_waitcnt lgkmcnt(3)
    v_mfma_f32_16x16x32_bf16 v[28:31], v[64:67], a[112:115], 0
    v_mfma_f32_16x16x32_bf16 v[32:35], v[64:67], a[184:187], 0
    ds_read_b128 v[64:67], v9 offset:8192
    s_waitcnt lgkmcnt(3)
    v_mfma_f32_16x16x32_bf16 v[28:31], v[104:107], a[116:119], v[28:31]
    v_mul_f32 v94, v93, v36
    v_fma_f32 v16, v16, v92, -v94
    v_mfma_f32_16x16x32_bf16 v[32:35], v[104:107], a[188:191], v[32:35]
    v_mul_f32 v94, v93, v37
    v_fma_f32 v17, v17, v92, -v94
    ds_read_b128 v[104:107], v9 offset:10240
    s_waitcnt lgkmcnt(3)
    v_mfma_f32_16x16x32_bf16 v[28:31], v[56:59], a[120:123], v[28:31]
    v_mul_f32 v94, v93, v38
    v_fma_f32 v18, v18, v92, -v94
    v_mfma_f32_16x16x32_bf16 v[32:35], v[56:59], a[192:195], v[32:35]
    v_mul_f32 v94, v93, v39
    v_fma_f32 v19, v19, v92, -v94
    ds_read_b128 v[56:59], v9 offset:12288
    s_waitcnt lgkmcnt(3)
    v_mfma_f32_16x16x32_bf16 v[28:31], v[60:63], a[124:127], v[28:31]
    v_mul_f32 v94, v93, v44
    v_fma_f32 v24, v24, v92, -v94
    v_mfma_f32_16x16x32_bf16 v[32:35], v[60:63], a[196:199], v[32:35]
    v_mul_f32 v94, v93, v45
    v_fma_f32 v25, v25, v92, -v94
    ds_read_b128 v[60:63], v9 offset:14336
    s_waitcnt lgkmcnt(3)
    v_mfma_f32_16x16x32_bf16 v[28:31], v[64:67], a[128:131], v[28:31]
    v_mul_f32 v94, v93, v46
    v_fma_f32 v26, v26, v92, -v94
    v_mfma_f32_16x16x32_bf16 v[32:35], v[64:67], a[200:203], v[32:35]
    v_mul_f32 v94, v93, v47
    v_fma_f32 v27, v27, v92, -v94
    s_waitcnt vmcnt(1)
    v_cmp_eq_u32 vcc, 0, v2
    s_nop 0
    s_cmp_eq_u64 vcc, 0
    s_cselect_b32 s62, 1, 0
    s_cmp_lt_u32 s37, 64
    s_cselect_b32 s62, s62, 0
    s_cmp_lg_u32 s62, 0
    s_cselect_b32 s30, 268435456, 0
    ds_read_b128 v[64:67], v9 offset:16384
    s_waitcnt lgkmcnt(3)
    v_mfma_f32_16x16x32_bf16 v[28:31], v[104:107], a[132:135], v[28:31]
    v_mul_f32 v94, v93, v40
    v_fma_f32 v20, v20, v92, -v94
    v_mfma_f32_16x16x32_bf16 v[32:35], v[104:107], a[204:207], v[32:35]
    v_mul_f32 v94, v93, v41
    v_fma_f32 v21, v21, v92, -v94
    s_add_u32 m0, s59, 0
    s_add_u32 s47, s41, 0
    buffer_load_dwordx4 v111, s[28:31], s47 offen offset:0 lds
    ds_read_b128 v[104:107], v9 offset:18432
    s_waitcnt lgkmcnt(3)
    v_mfma_f32_16x16x32_bf16 v[28:31], v[56:59], a[136:139], v[28:31]
    v_mul_f32 v94, v93, v42
    v_fma_f32 v22, v22, v92, -v94
    v_mfma_f32_16x16x32_bf16 v[32:35], v[56:59], a[208:211], v[32:35]
    v_mul_f32 v94, v93, v43
    v_fma_f32 v23, v23, v92, -v94
    buffer_load_dwordx4 v111, s[28:31], s47 offen offset:1024 lds
    ds_read_b128 v[56:59], v9 offset:20480
    s_waitcnt lgkmcnt(3)
    v_mfma_f32_16x16x32_bf16 v[28:31], v[60:63], a[140:143], v[28:31]
    v_cvt_pk_bf16_f32 v128, v16, v17
    v_cvt_pk_bf16_f32 v129, v18, v19
    v_mfma_f32_16x16x32_bf16 v[32:35], v[60:63], a[212:215], v[32:35]
    v_cvt_pk_bf16_f32 v130, v24, v25
    v_cvt_pk_bf16_f32 v132, v20, v21
    buffer_load_dwordx4 v111, s[28:31], s47 offen offset:2048 lds
    ds_read_b128 v[60:63], v9 offset:22528
    s_waitcnt lgkmcnt(3)
    v_mfma_f32_16x16x32_bf16 v[28:31], v[64:67], a[144:147], v[28:31]
    v_cvt_pk_bf16_f32 v133, v22, v23
    v_cvt_pk_bf16_f32 v134, v26, v27
    v_mfma_f32_16x16x32_bf16 v[32:35], v[64:67], a[216:219], v[32:35]
    s_cmp_eq_u32 s35, 0
    s_cselect_b32 s46, 0xf149f2ca, 0
    buffer_load_dwordx4 v111, s[28:31], s47 offen offset:3072 lds
    ds_read_b128 v[64:67], v9 offset:24576
    s_waitcnt lgkmcnt(3)
    v_mfma_f32_16x16x32_bf16 v[28:31], v[104:107], a[148:151], v[28:31]
    v_mfma_f32_16x16x32_bf16 v[144:147], v[112:115], v[128:131], 0
    v_mfma_f32_16x16x32_bf16 v[32:35], v[104:107], a[220:223], v[32:35]
    v_mfma_f32_16x16x32_bf16 v[148:151], v[132:135], v[128:131], 0
    s_add_u32 m0, s59, 4096
    s_add_u32 s47, s41, 4096
    buffer_load_dwordx4 v111, s[28:31], s47 offen offset:0 lds
    ds_read_b128 v[104:107], v9 offset:26624
    s_waitcnt lgkmcnt(3)
    v_mfma_f32_16x16x32_bf16 v[28:31], v[56:59], a[152:155], v[28:31]
    v_mov_b32 v112, v132
    v_mfma_f32_16x16x32_bf16 v[32:35], v[56:59], a[224:227], v[32:35]
    v_mov_b32 v113, v133
    v_mov_b32 v114, v134
    buffer_load_dwordx4 v111, s[28:31], s47 offen offset:1024 lds
    ds_read_b128 v[56:59], v9 offset:28672
    s_waitcnt lgkmcnt(3)
    v_mfma_f32_16x16x32_bf16 v[28:31], v[60:63], a[156:159], v[28:31]
    v_mfma_f32_16x16x32_bf16 v[32:35], v[60:63], a[228:231], v[32:35]
    v_fma_f32 v144, v144, s52, v72
    buffer_load_dwordx4 v111, s[28:31], s47 offen offset:2048 lds
    ds_read_b128 v[60:63], v9 offset:30720
    s_waitcnt lgkmcnt(3)
    v_mfma_f32_16x16x32_bf16 v[28:31], v[64:67], a[160:163], v[28:31]
    v_fma_f32 v145, v145, s52, v73
    v_fma_f32 v146, v146, s52, v74
    v_fma_f32 v147, v147, s52, v75
    v_mfma_f32_16x16x32_bf16 v[32:35], v[64:67], a[232:235], v[32:35]
    v_fma_f32 v148, v148, s52, v76
    v_fma_f32 v149, v149, s52, v77
    v_fma_f32 v150, v150, s52, v78
    buffer_load_dwordx4 v111, s[28:31], s47 offen offset:3072 lds
    ds_read_b128 v[64:67], v9 offset:32768
    s_waitcnt lgkmcnt(3)
    v_mfma_f32_16x16x32_bf16 v[28:31], v[104:107], a[164:167], v[28:31]
    v_fma_f32 v151, v151, s52, v79
    v_add_f32 v144, s46, v144
    v_add_f32 v145, s46, v145
    v_mfma_f32_16x16x32_bf16 v[32:35], v[104:107], a[236:239], v[32:35]
    v_add_f32 v146, s46, v146
    v_add_f32 v147, s46, v147
    v_max3_f32 v5, v144, v145, v146
    s_add_u32 m0, s59, 8192
    s_add_u32 s47, s41, 8192
    buffer_load_dwordx4 v111, s[28:31], s47 offen offset:0 lds
    ds_read_b128 v[104:107], v9 offset:34816
    s_waitcnt lgkmcnt(3)
    v_mfma_f32_16x16x32_bf16 v[28:31], v[56:59], a[168:171], v[28:31]
    v_max3_f32 v5, v5, v147, v148
    v_max3_f32 v5, v5, v149, v150
    v_max_f32 v5, v5, v151
    v_mfma_f32_16x16x32_bf16 v[32:35], v[56:59], a[240:243], v[32:35]
    v_mov_b32 v6, v5
    s_nop 1
    v_permlane32_swap_b32 v5, v6
    s_mul_i32 s48, s36, 786432
    s_mul_i32 s18, s37, 6144
    s_add_u32 s48, s48, s18
    s_add_u32 s48, s48, 15728640
    buffer_load_dwordx4 v[80:83], v10, s[28:31], s48 offen offset:0
    s_waitcnt lgkmcnt(2)
    v_mfma_f32_16x16x32_bf16 v[28:31], v[60:63], a[172:175], v[28:31]
    v_max_f32 v5, v5, v6
    v_mov_b32 v6, v5
    v_mfma_f32_16x16x32_bf16 v[32:35], v[60:63], a[244:247], v[32:35]
    s_nop 0
    v_permlane16_swap_b32 v5, v6
    v_max_f32 v5, v5, v6
    v_sub_f32 v144, v144, v5
    buffer_load_dwordx4 v[84:87], v10, s[28:31], s48 offen offset:512
    s_waitcnt lgkmcnt(1)
    v_mfma_f32_16x16x32_bf16 v[28:31], v[64:67], a[176:179], v[28:31]
    v_sub_f32 v145, v145, v5
    v_sub_f32 v146, v146, v5
    v_sub_f32 v147, v147, v5
    v_mfma_f32_16x16x32_bf16 v[32:35], v[64:67], a[248:251], v[32:35]
    v_sub_f32 v148, v148, v5
    v_sub_f32 v149, v149, v5
    v_sub_f32 v150, v150, v5
    buffer_load_dwordx4 v[88:91], v10, s[28:31], s48 offen offset:1024
    s_waitcnt lgkmcnt(0)
    v_mfma_f32_16x16x32_bf16 v[28:31], v[104:107], a[180:183], v[28:31]
    v_sub_f32 v151, v151, v5
    v_exp_f32 v144, v144
    v_exp_f32 v145, v145
    v_mfma_f32_16x16x32_bf16 v[32:35], v[104:107], a[252:255], v[32:35]
    v_exp_f32 v146, v146
    v_exp_f32 v147, v147
    v_exp_f32 v148, v148
    v_exp_f32 v149, v149
    v_exp_f32 v150, v150
    v_exp_f32 v151, v151
    v_cvt_pk_bf16_f32 v68, v144, v145
    v_cvt_pk_bf16_f32 v69, v146, v147
    v_cvt_pk_bf16_f32 v70, v148, v149
    v_cvt_pk_bf16_f32 v71, v150, v151
    s_nop 1
    v_mfma_f32_16x16x32_bf16 v[16:19], v[116:119], v[68:71], 0
    s_mul_i32 s46, s57, 36864
    s_add_u32 s46, s46, 17301504
    s_nop 5
    v_rcp_f32 v6, v16
    v_mul_f32 v94, v97, v48
    v_fma_f32 v28, v28, v96, -v94
    v_mul_f32 v94, v99, v49
    v_fma_f32 v29, v29, v98, -v94
    v_mul_f32 v94, v101, v50
    v_fma_f32 v30, v30, v100, -v94
    v_mul_f32 v94, v103, v51
    v_fma_f32 v31, v31, v102, -v94
    v_cvt_pk_bf16_f32 v138, v28, v29
    v_cvt_pk_bf16_f32 v139, v30, v31
    v_mul_f32 v94, v97, v52
    v_fma_f32 v32, v32, v96, -v94
    v_mfma_f32_16x16x32_bf16 v[20:23], v[136:139], v[68:71], 0
    v_mul_f32 v94, v99, v53
    v_fma_f32 v33, v33, v98, -v94
    v_mul_f32 v94, v101, v54
    v_fma_f32 v34, v34, v100, -v94
    v_mul_f32 v94, v103, v55
    v_fma_f32 v35, v35, v102, -v94
    v_cvt_pk_bf16_f32 v142, v32, v33
    v_cvt_pk_bf16_f32 v143, v34, v35
    v_mov_b32 v136, v138
    v_mov_b32 v137, v139
    v_mfma_f32_16x16x32_bf16 v[24:27], v[140:143], v[68:71], 0
    v_mul_f32 v20, v6, v20
    v_mul_f32 v21, v6, v21
    v_mul_f32 v22, v6, v22
    v_mul_f32 v23, v6, v23
    v_cvt_pk_bf16_f32 v20, v20, v21
    v_cvt_pk_bf16_f32 v21, v22, v23
    buffer_store_dwordx2 v[20:21], v13, s[8:11], s46 offen
    v_mov_b32 v140, v142
    v_mov_b32 v141, v143
    v_mul_f32 v24, v6, v24
    v_mul_f32 v25, v6, v25
    v_cvt_pk_bf16_f32 v24, v24, v25
    s_mov_b64 exec, 0xffff
    buffer_store_dword v24, v14, s[8:11], s46 offen
    s_mov_b64 exec, -1
    s_mul_i32 s43, s57, 22528
    s_add_u32 s43, s43, s49
    s_cmp_lg_u32 s62, 0
    s_cbranch_scc1 Laqf_item
    buffer_load_dword v2, v1, s[8:11], s42 offen sc1
    s_waitcnt vmcnt(0)
    s_cmp_ge_u32 s37, 64
    s_cbranch_scc1 Laqf_fin
    v_cmp_eq_u32 vcc, 0, v2
    s_nop 0
    s_cbranch_vccnz Laqf_pub
    s_add_u32 m0, s59, 0
    s_add_u32 s47, s41, 0
    buffer_load_dwordx4 v111, s[8:11], s47 offen offset:0 lds
    buffer_load_dwordx4 v111, s[8:11], s47 offen offset:1024 lds
    buffer_load_dwordx4 v111, s[8:11], s47 offen offset:2048 lds
    buffer_load_dwordx4 v111, s[8:11], s47 offen offset:3072 lds
    s_add_u32 m0, s59, 4096
    s_add_u32 s47, s41, 4096
    buffer_load_dwordx4 v111, s[8:11], s47 offen offset:0 lds
    buffer_load_dwordx4 v111, s[8:11], s47 offen offset:1024 lds
    buffer_load_dwordx4 v111, s[8:11], s47 offen offset:2048 lds
    buffer_load_dwordx4 v111, s[8:11], s47 offen offset:3072 lds
    s_add_u32 m0, s59, 8192
    s_add_u32 s47, s41, 8192
    buffer_load_dwordx4 v111, s[8:11], s47 offen offset:0 lds
    s_mul_i32 s48, s36, 786432
    s_mul_i32 s18, s37, 6144
    s_add_u32 s48, s48, s18
    s_add_u32 s48, s48, 15728640
    buffer_load_dwordx4 v[80:83], v10, s[8:11], s48 offen offset:0
    buffer_load_dwordx4 v[84:87], v10, s[8:11], s48 offen offset:512
    buffer_load_dwordx4 v[88:91], v10, s[8:11], s48 offen offset:1024
    s_cmp_lg_u32 s43, 0
    s_cselect_b64 exec, 1, 0
    buffer_store_dword v3, v4, s[8:11], s43 offen
    s_mov_b64 exec, -1
    s_mov_b32 s43, 0
    s_waitcnt vmcnt(1)
    s_branch Laqf_go
Laqf_fin:
    s_cmp_lg_u32 s43, 0
    s_cselect_b64 exec, 1, 0
    buffer_store_dword v3, v4, s[8:11], s43 offen
    s_mov_b64 exec, -1
    s_mov_b32 s43, 0
    s_branch L_role_aq_exit
Laqf_pub:
    s_cmp_lg_u32 s43, 0
    s_cselect_b64 exec, 1, 0
    buffer_store_dword v3, v4, s[8:11], s43 offen
    s_mov_b64 exec, -1
    s_mov_b32 s43, 0
Laqf_poll:
    s_mov_b32 s16, 0
Laqf_pl:
    buffer_load_dword v2, v1, s[8:11], s42 offen sc1
    s_add_u32 s16, s16, 1
    s_cmp_gt_u32 s16, 100000
    s_cbranch_scc1 L_role_aq_abort
    s_waitcnt vmcnt(0)
    v_cmp_eq_u32 vcc, 0, v2
    s_nop 0
    s_cbranch_vccz Laqf_pld
    s_sleep 4
    s_branch Laqf_pl
Laqf_pld:
    s_add_u32 m0, s59, 0
    s_add_u32 s47, s41, 0
    buffer_load_dwordx4 v111, s[8:11], s47 offen offset:0 lds
    buffer_load_dwordx4 v111, s[8:11], s47 offen offset:1024 lds
    buffer_load_dwordx4 v111, s[8:11], s47 offen offset:2048 lds
    buffer_load_dwordx4 v111, s[8:11], s47 offen offset:3072 lds
    s_add_u32 m0, s59, 4096
    s_add_u32 s47, s41, 4096
    buffer_load_dwordx4 v111, s[8:11], s47 offen offset:0 lds
    buffer_load_dwordx4 v111, s[8:11], s47 offen offset:1024 lds
    buffer_load_dwordx4 v111, s[8:11], s47 offen offset:2048 lds
    buffer_load_dwordx4 v111, s[8:11], s47 offen offset:3072 lds
    s_add_u32 m0, s59, 8192
    s_add_u32 s47, s41, 8192
    buffer_load_dwordx4 v111, s[8:11], s47 offen offset:0 lds
    s_mul_i32 s48, s36, 786432
    s_mul_i32 s18, s37, 6144
    s_add_u32 s48, s48, s18
    s_add_u32 s48, s48, 15728640
    buffer_load_dwordx4 v[80:83], v10, s[8:11], s48 offen offset:0
    buffer_load_dwordx4 v[84:87], v10, s[8:11], s48 offen offset:512
    buffer_load_dwordx4 v[88:91], v10, s[8:11], s48 offen offset:1024
    s_waitcnt vmcnt(0)
    s_branch Laqf_go
Laq_slow:
    s_mov_b32 s36, s63
    s_mov_b32 s34, s63
    s_mov_b32 s37, 0
    s_lshl_b32 s56, s63, 6
    s_mul_i32 s58, s14, 9216
    s_mov_b32 s40, 36864
    s_mov_b32 s59, s58
    s_mov_b32 s43, 0
    s_mov_b32 s28, s8
    s_mov_b32 s29, s9
    s_mov_b32 s30, 0
    s_mov_b32 s31, 0x00020000
    s_mul_i32 s41, s63, 4718592
    s_add_u32 s41, s41, s58
    s_add_u32 s41, s41, 6291456
    s_mul_i32 s42, s56, 22528
    s_add_u32 s42, s42, 180224
    s_cmp_lg_u32 s14, 0
    s_cbranch_scc1 Laq_ini_d
    v_mov_b32 v5, 160
    s_mov_b32 s16, 0
Laq_ini:
    global_load_dword v6, v5, s[12:13] sc1
    s_add_u32 s16, s16, 1
    s_cmp_gt_u32 s16, 100000
    s_cbranch_scc1 L_role_aq_abort
    s_waitcnt vmcnt(0)
    v_cmp_gt_u32 vcc, 123, v6
    s_nop 0
    s_cbranch_vccz Laq_ini_d
    s_sleep 8
    s_branch Laq_ini
Laq_ini_d:
    s_barrier
    s_branch Laq_poll
Laq_item:
    s_waitcnt vmcnt(2)
Laq_go:
    s_barrier
    s_xor_b32 s40, s40, 36864
    s_xor_b32 s59, s59, 36864
    s_xor_b32 s66, s66, 0x2000
    s_xor_b32 s71, s71, 0x2000
    s_mov_b32 s35, s37
    s_mov_b32 s57, s56
    s_add_u32 s37, s37, 1
    s_add_u32 s56, s56, 1
    s_add_u32 s41, s41, 36864
    s_add_u32 s42, s42, 22528
    s_mov_b32 s62, 0
    v_lshlrev_b32 v9, 9, v8
    v_lshl_add_u32 v9, v7, 4, v9
    s_lshl_b32 s17, s51, 8
    s_add_u32 s17, s17, s40
    v_add_u32 v9, s17, v9
    ds_read_b128 v[56:59], v9 offset:0
    ds_read_b128 v[60:63], v9 offset:2048
    ds_read_b128 v[64:67], v9 offset:4096
    ds_read_b128 v[104:107], v9 offset:6144
    s_waitcnt lgkmcnt(3)
    v_mfma_f32_16x16x32_bf16 v[16:19], v[152:155], v[56:59], 0
    v_add_f32 v80, v80, v84
    v_mfma_f32_16x16x32_bf16 v[20:23], v[224:227], v[56:59], 0
    v_add_f32 v81, v81, v85
    v_mfma_f32_16x16x32_bf16 v[24:27], a[40:43], v[56:59], 0
    v_add_f32 v82, v82, v86
    ds_read_b128 v[56:59], v9 offset:8192
    s_waitcnt lgkmcnt(3)
    v_mfma_f32_16x16x32_bf16 v[16:19], v[156:159], v[60:63], v[16:19]
    v_add_f32 v83, v83, v87
    v_mfma_f32_16x16x32_bf16 v[20:23], v[228:231], v[60:63], v[20:23]
    v_add_f32 v80, v80, v88
    v_mfma_f32_16x16x32_bf16 v[24:27], a[44:47], v[60:63], v[24:27]
    v_add_f32 v81, v81, v89
    ds_read_b128 v[60:63], v9 offset:10240
    s_waitcnt lgkmcnt(3)
    v_mfma_f32_16x16x32_bf16 v[16:19], v[160:163], v[64:67], v[16:19]
    v_add_f32 v82, v82, v90
    v_mfma_f32_16x16x32_bf16 v[20:23], v[232:235], v[64:67], v[20:23]
    v_add_f32 v83, v83, v91
    v_mfma_f32_16x16x32_bf16 v[24:27], a[48:51], v[64:67], v[24:27]
    v_add_f32 v80, v80, v82
    ds_read_b128 v[64:67], v9 offset:12288
    s_waitcnt lgkmcnt(3)
    v_mfma_f32_16x16x32_bf16 v[16:19], v[164:167], v[104:107], v[16:19]
    v_add_f32 v81, v81, v83
    v_mfma_f32_16x16x32_bf16 v[20:23], v[236:239], v[104:107], v[20:23]
    v_mov_b32 v82, v80
    v_mfma_f32_16x16x32_bf16 v[24:27], a[52:55], v[104:107], v[24:27]
    v_mov_b32 v83, v81
    ds_read_b128 v[104:107], v9 offset:14336
    s_waitcnt lgkmcnt(3)
    v_mfma_f32_16x16x32_bf16 v[16:19], v[168:171], v[56:59], v[16:19]
    v_permlane32_swap_b32 v80, v82
    v_mfma_f32_16x16x32_bf16 v[20:23], v[240:243], v[56:59], v[20:23]
    v_permlane32_swap_b32 v81, v83
    v_mfma_f32_16x16x32_bf16 v[24:27], a[56:59], v[56:59], v[24:27]
    v_add_f32 v80, v80, v82
    ds_read_b128 v[56:59], v9 offset:16384
    s_waitcnt lgkmcnt(3)
    v_mfma_f32_16x16x32_bf16 v[16:19], v[172:175], v[60:63], v[16:19]
    v_add_f32 v81, v81, v83
    v_mfma_f32_16x16x32_bf16 v[20:23], v[244:247], v[60:63], v[20:23]
    v_mov_b32 v82, v80
    v_mfma_f32_16x16x32_bf16 v[24:27], a[60:63], v[60:63], v[24:27]
    v_mov_b32 v83, v81
    ds_read_b128 v[60:63], v9 offset:18432
    s_waitcnt lgkmcnt(3)
    v_mfma_f32_16x16x32_bf16 v[16:19], v[176:179], v[64:67], v[16:19]
    v_permlane16_swap_b32 v80, v82
    v_mfma_f32_16x16x32_bf16 v[20:23], v[248:251], v[64:67], v[20:23]
    v_permlane16_swap_b32 v81, v83
    v_mfma_f32_16x16x32_bf16 v[24:27], a[64:67], v[64:67], v[24:27]
    v_add_f32 v80, v80, v82
    ds_read_b128 v[64:67], v9 offset:20480
    s_waitcnt lgkmcnt(3)
    v_mfma_f32_16x16x32_bf16 v[16:19], v[180:183], v[104:107], v[16:19]
    v_add_f32 v81, v81, v83
    v_mfma_f32_16x16x32_bf16 v[20:23], v[252:255], v[104:107], v[20:23]
    v_mul_f32 v80, 0x3ae38e39, v80
    v_mfma_f32_16x16x32_bf16 v[24:27], a[68:71], v[104:107], v[24:27]
    v_mul_f32 v81, 0x3ae38e39, v81
    ds_read_b128 v[104:107], v9 offset:22528
    s_waitcnt lgkmcnt(3)
    v_mfma_f32_16x16x32_bf16 v[16:19], v[184:187], v[56:59], v[16:19]
    v_fma_f32 v81, -v80, v80, v81
    v_mfma_f32_16x16x32_bf16 v[20:23], a[0:3], v[56:59], v[20:23]
    v_max_f32 v81, 0, v81
    v_mfma_f32_16x16x32_bf16 v[24:27], a[72:75], v[56:59], v[24:27]
    v_add_f32 v81, 0x3727c5ac, v81
    ds_read_b128 v[56:59], v9 offset:24576
    s_waitcnt lgkmcnt(3)
    v_mfma_f32_16x16x32_bf16 v[16:19], v[188:191], v[60:63], v[16:19]
    v_rsq_f32 v92, v81
    v_mfma_f32_16x16x32_bf16 v[20:23], a[4:7], v[60:63], v[20:23]
    v_mul_f32 v93, v80, v92
    v_mfma_f32_16x16x32_bf16 v[24:27], a[76:79], v[60:63], v[24:27]
    ds_write_b64 v11, v[92:93]
    ds_read_b128 v[60:63], v9 offset:26624
    s_waitcnt lgkmcnt(4)
    v_mfma_f32_16x16x32_bf16 v[16:19], v[192:195], v[64:67], v[16:19]
    ds_read_b128 v[96:99], v12
    v_mfma_f32_16x16x32_bf16 v[20:23], a[8:11], v[64:67], v[20:23]
    ds_read_b128 v[100:103], v12 offset:16
    v_mfma_f32_16x16x32_bf16 v[24:27], a[80:83], v[64:67], v[24:27]
    s_waitcnt vmcnt(0)
    buffer_load_dword v2, v1, s[8:11], s42 offen sc1
    s_cmp_lg_u32 s43, 0
    s_cselect_b64 exec, 1, 0
    buffer_store_dword v3, v4, s[8:11], s43 offen sc1
    s_mov_b64 exec, -1
    s_mov_b32 s43, 0
    ds_read_b128 v[64:67], v9 offset:28672
    s_waitcnt lgkmcnt(6)
    v_mfma_f32_16x16x32_bf16 v[16:19], v[196:199], v[104:107], v[16:19]
    v_mfma_f32_16x16x32_bf16 v[20:23], a[12:15], v[104:107], v[20:23]
    v_mfma_f32_16x16x32_bf16 v[24:27], a[84:87], v[104:107], v[24:27]
    ds_read_b128 v[104:107], v9 offset:30720
    s_waitcnt lgkmcnt(6)
    v_mfma_f32_16x16x32_bf16 v[16:19], v[200:203], v[56:59], v[16:19]
    v_mfma_f32_16x16x32_bf16 v[20:23], a[16:19], v[56:59], v[20:23]
    v_mfma_f32_16x16x32_bf16 v[24:27], a[88:91], v[56:59], v[24:27]
    ds_read_b128 v[56:59], v9 offset:32768
    s_waitcnt lgkmcnt(5)
    v_mfma_f32_16x16x32_bf16 v[16:19], v[204:207], v[60:63], v[16:19]
    v_mfma_f32_16x16x32_bf16 v[20:23], a[20:23], v[60:63], v[20:23]
    v_mfma_f32_16x16x32_bf16 v[24:27], a[92:95], v[60:63], v[24:27]
    ds_read_b128 v[60:63], v9 offset:34816
    s_waitcnt lgkmcnt(3)
    v_mfma_f32_16x16x32_bf16 v[16:19], v[208:211], v[64:67], v[16:19]
    v_mfma_f32_16x16x32_bf16 v[20:23], a[24:27], v[64:67], v[20:23]
    v_mfma_f32_16x16x32_bf16 v[24:27], a[96:99], v[64:67], v[24:27]
    ds_read_b128 v[64:67], v9 offset:0
    s_waitcnt lgkmcnt(3)
    v_mfma_f32_16x16x32_bf16 v[16:19], v[212:215], v[104:107], v[16:19]
    v_mfma_f32_16x16x32_bf16 v[20:23], a[28:31], v[104:107], v[20:23]
    v_mfma_f32_16x16x32_bf16 v[24:27], a[100:103], v[104:107], v[24:27]
    ds_read_b128 v[104:107], v9 offset:2048
    s_waitcnt lgkmcnt(3)
    v_mfma_f32_16x16x32_bf16 v[16:19], v[216:219], v[56:59], v[16:19]
    v_mfma_f32_16x16x32_bf16 v[20:23], a[32:35], v[56:59], v[20:23]
    v_mfma_f32_16x16x32_bf16 v[24:27], a[104:107], v[56:59], v[24:27]
    ds_read_b128 v[56:59], v9 offset:4096
    s_waitcnt lgkmcnt(3)
    v_mfma_f32_16x16x32_bf16 v[16:19], v[220:223], v[60:63], v[16:19]
    v_mfma_f32_16x16x32_bf16 v[20:23], a[36:39], v[60:63], v[20:23]
    v_mfma_f32_16x16x32_bf16 v[24:27], a[108:111], v[60:63], v[24:27]
    ds_read_b128 v[60:63], v9 offset:6144
    s_waitcnt lgkmcnt(3)
    v_mfma_f32_16x16x32_bf16 v[28:31], v[64:67], a[112:115], 0
    v_mfma_f32_16x16x32_bf16 v[32:35], v[64:67], a[184:187], 0
    ds_read_b128 v[64:67], v9 offset:8192
    s_waitcnt lgkmcnt(3)
    v_mfma_f32_16x16x32_bf16 v[28:31], v[104:107], a[116:119], v[28:31]
    v_mul_f32 v94, v93, v36
    v_fma_f32 v16, v16, v92, -v94
    v_mfma_f32_16x16x32_bf16 v[32:35], v[104:107], a[188:191], v[32:35]
    v_mul_f32 v94, v93, v37
    v_fma_f32 v17, v17, v92, -v94
    ds_read_b128 v[104:107], v9 offset:10240
    s_waitcnt lgkmcnt(3)
    v_mfma_f32_16x16x32_bf16 v[28:31], v[56:59], a[120:123], v[28:31]
    v_mul_f32 v94, v93, v38
    v_fma_f32 v18, v18, v92, -v94
    v_mfma_f32_16x16x32_bf16 v[32:35], v[56:59], a[192:195], v[32:35]
    v_mul_f32 v94, v93, v39
    v_fma_f32 v19, v19, v92, -v94
    ds_read_b128 v[56:59], v9 offset:12288
    s_waitcnt lgkmcnt(3)
    v_mfma_f32_16x16x32_bf16 v[28:31], v[60:63], a[124:127], v[28:31]
    v_mul_f32 v94, v93, v44
    v_fma_f32 v24, v24, v92, -v94
    v_mfma_f32_16x16x32_bf16 v[32:35], v[60:63], a[196:199], v[32:35]
    v_mul_f32 v94, v93, v45
    v_fma_f32 v25, v25, v92, -v94
    ds_read_b128 v[60:63], v9 offset:14336
    s_waitcnt lgkmcnt(3)
    v_mfma_f32_16x16x32_bf16 v[28:31], v[64:67], a[128:131], v[28:31]
    v_mul_f32 v94, v93, v46
    v_fma_f32 v26, v26, v92, -v94
    v_mfma_f32_16x16x32_bf16 v[32:35], v[64:67], a[200:203], v[32:35]
    v_mul_f32 v94, v93, v47
    v_fma_f32 v27, v27, v92, -v94
    s_waitcnt vmcnt(1)
    v_cmp_eq_u32 vcc, 0, v2
    s_nop 0
    s_cmp_eq_u64 vcc, 0
    s_cselect_b32 s62, 1, 0
    s_cmp_lt_u32 s37, 64
    s_cselect_b32 s62, s62, 0
    s_cmp_lg_u32 s62, 0
    s_cselect_b32 s30, 268435456, 0
    ds_read_b128 v[64:67], v9 offset:16384
    s_waitcnt lgkmcnt(3)
    v_mfma_f32_16x16x32_bf16 v[28:31], v[104:107], a[132:135], v[28:31]
    v_mul_f32 v94, v93, v40
    v_fma_f32 v20, v20, v92, -v94
    v_mfma_f32_16x16x32_bf16 v[32:35], v[104:107], a[204:207], v[32:35]
    v_mul_f32 v94, v93, v41
    v_fma_f32 v21, v21, v92, -v94
    s_add_u32 m0, s59, 0
    s_add_u32 s47, s41, 0
    buffer_load_dwordx4 v111, s[28:31], s47 offen offset:0 lds
    ds_read_b128 v[104:107], v9 offset:18432
    s_waitcnt lgkmcnt(3)
    v_mfma_f32_16x16x32_bf16 v[28:31], v[56:59], a[136:139], v[28:31]
    v_mul_f32 v94, v93, v42
    v_fma_f32 v22, v22, v92, -v94
    v_mfma_f32_16x16x32_bf16 v[32:35], v[56:59], a[208:211], v[32:35]
    v_mul_f32 v94, v93, v43
    v_fma_f32 v23, v23, v92, -v94
    buffer_load_dwordx4 v111, s[28:31], s47 offen offset:1024 lds
    ds_read_b128 v[56:59], v9 offset:20480
    s_waitcnt lgkmcnt(3)
    v_mfma_f32_16x16x32_bf16 v[28:31], v[60:63], a[140:143], v[28:31]
    v_cvt_pk_bf16_f32 v128, v16, v17
    v_cvt_pk_bf16_f32 v129, v18, v19
    v_mfma_f32_16x16x32_bf16 v[32:35], v[60:63], a[212:215], v[32:35]
    v_cvt_pk_bf16_f32 v130, v24, v25
    v_cvt_pk_bf16_f32 v132, v20, v21
    buffer_load_dwordx4 v111, s[28:31], s47 offen offset:2048 lds
    ds_read_b128 v[60:63], v9 offset:22528
    s_waitcnt lgkmcnt(3)
    v_mfma_f32_16x16x32_bf16 v[28:31], v[64:67], a[144:147], v[28:31]
    v_cvt_pk_bf16_f32 v133, v22, v23
    v_cvt_pk_bf16_f32 v134, v26, v27
    v_mfma_f32_16x16x32_bf16 v[32:35], v[64:67], a[216:219], v[32:35]
    s_cmp_eq_u32 s35, 0
    s_cselect_b32 s46, 0xf149f2ca, 0
    buffer_load_dwordx4 v111, s[28:31], s47 offen offset:3072 lds
    ds_read_b128 v[64:67], v9 offset:24576
    s_waitcnt lgkmcnt(3)
    v_mfma_f32_16x16x32_bf16 v[28:31], v[104:107], a[148:151], v[28:31]
    v_mfma_f32_16x16x32_bf16 v[144:147], v[112:115], v[128:131], 0
    v_mfma_f32_16x16x32_bf16 v[32:35], v[104:107], a[220:223], v[32:35]
    v_mfma_f32_16x16x32_bf16 v[148:151], v[132:135], v[128:131], 0
    s_add_u32 m0, s59, 4096
    s_add_u32 s47, s41, 4096
    buffer_load_dwordx4 v111, s[28:31], s47 offen offset:0 lds
    ds_read_b128 v[104:107], v9 offset:26624
    s_waitcnt lgkmcnt(3)
    v_mfma_f32_16x16x32_bf16 v[28:31], v[56:59], a[152:155], v[28:31]
    v_mov_b32 v112, v132
    v_mfma_f32_16x16x32_bf16 v[32:35], v[56:59], a[224:227], v[32:35]
    v_mov_b32 v113, v133
    v_mov_b32 v114, v134
    buffer_load_dwordx4 v111, s[28:31], s47 offen offset:1024 lds
    ds_read_b128 v[56:59], v9 offset:28672
    s_waitcnt lgkmcnt(3)
    v_mfma_f32_16x16x32_bf16 v[28:31], v[60:63], a[156:159], v[28:31]
    v_mfma_f32_16x16x32_bf16 v[32:35], v[60:63], a[228:231], v[32:35]
    v_fma_f32 v144, v144, s52, v72
    buffer_load_dwordx4 v111, s[28:31], s47 offen offset:2048 lds
    ds_read_b128 v[60:63], v9 offset:30720
    s_waitcnt lgkmcnt(3)
    v_mfma_f32_16x16x32_bf16 v[28:31], v[64:67], a[160:163], v[28:31]
    v_fma_f32 v145, v145, s52, v73
    v_fma_f32 v146, v146, s52, v74
    v_fma_f32 v147, v147, s52, v75
    v_mfma_f32_16x16x32_bf16 v[32:35], v[64:67], a[232:235], v[32:35]
    v_fma_f32 v148, v148, s52, v76
    v_fma_f32 v149, v149, s52, v77
    v_fma_f32 v150, v150, s52, v78
    buffer_load_dwordx4 v111, s[28:31], s47 offen offset:3072 lds
    ds_read_b128 v[64:67], v9 offset:32768
    s_waitcnt lgkmcnt(3)
    v_mfma_f32_16x16x32_bf16 v[28:31], v[104:107], a[164:167], v[28:31]
    v_fma_f32 v151, v151, s52, v79
    v_add_f32 v144, s46, v144
    v_add_f32 v145, s46, v145
    v_mfma_f32_16x16x32_bf16 v[32:35], v[104:107], a[236:239], v[32:35]
    v_add_f32 v146, s46, v146
    v_add_f32 v147, s46, v147
    v_max3_f32 v5, v144, v145, v146
    s_add_u32 m0, s59, 8192
    s_add_u32 s47, s41, 8192
    buffer_load_dwordx4 v111, s[28:31], s47 offen offset:0 lds
    ds_read_b128 v[104:107], v9 offset:34816
    s_waitcnt lgkmcnt(3)
    v_mfma_f32_16x16x32_bf16 v[28:31], v[56:59], a[168:171], v[28:31]
    v_max3_f32 v5, v5, v147, v148
    v_max3_f32 v5, v5, v149, v150
    v_max_f32 v5, v5, v151
    v_mfma_f32_16x16x32_bf16 v[32:35], v[56:59], a[240:243], v[32:35]
    v_mov_b32 v6, v5
    s_nop 1
    v_permlane32_swap_b32 v5, v6
    s_mul_i32 s48, s36, 786432
    s_mul_i32 s18, s37, 6144
    s_add_u32 s48, s48, s18
    s_add_u32 s48, s48, 15728640
    buffer_load_dwordx4 v[80:83], v10, s[28:31], s48 offen offset:0
    s_waitcnt lgkmcnt(2)
    v_mfma_f32_16x16x32_bf16 v[28:31], v[60:63], a[172:175], v[28:31]
    v_max_f32 v5, v5, v6
    v_mov_b32 v6, v5
    v_mfma_f32_16x16x32_bf16 v[32:35], v[60:63], a[244:247], v[32:35]
    s_nop 0
    v_permlane16_swap_b32 v5, v6
    v_max_f32 v5, v5, v6
    v_sub_f32 v144, v144, v5
    buffer_load_dwordx4 v[84:87], v10, s[28:31], s48 offen offset:512
    s_waitcnt lgkmcnt(1)
    v_mfma_f32_16x16x32_bf16 v[28:31], v[64:67], a[176:179], v[28:31]
    v_sub_f32 v145, v145, v5
    v_sub_f32 v146, v146, v5
    v_sub_f32 v147, v147, v5
    v_mfma_f32_16x16x32_bf16 v[32:35], v[64:67], a[248:251], v[32:35]
    v_sub_f32 v148, v148, v5
    v_sub_f32 v149, v149, v5
    v_sub_f32 v150, v150, v5
    buffer_load_dwordx4 v[88:91], v10, s[28:31], s48 offen offset:1024
    s_waitcnt lgkmcnt(0)
    v_mfma_f32_16x16x32_bf16 v[28:31], v[104:107], a[180:183], v[28:31]
    v_sub_f32 v151, v151, v5
    v_exp_f32 v144, v144
    v_exp_f32 v145, v145
    v_mfma_f32_16x16x32_bf16 v[32:35], v[104:107], a[252:255], v[32:35]
    v_exp_f32 v146, v146
    v_exp_f32 v147, v147
    v_exp_f32 v148, v148
    v_exp_f32 v149, v149
    v_exp_f32 v150, v150
    v_exp_f32 v151, v151
    v_cvt_pk_bf16_f32 v68, v144, v145
    v_cvt_pk_bf16_f32 v69, v146, v147
    v_cvt_pk_bf16_f32 v70, v148, v149
    v_cvt_pk_bf16_f32 v71, v150, v151
    s_nop 1
    v_mfma_f32_16x16x32_bf16 v[16:19], v[116:119], v[68:71], 0
    s_mul_i32 s46, s57, 36864
    s_add_u32 s46, s46, 17301504
    s_nop 5
    v_rcp_f32 v6, v16
    v_mul_f32 v94, v97, v48
    v_fma_f32 v28, v28, v96, -v94
    v_mul_f32 v94, v99, v49
    v_fma_f32 v29, v29, v98, -v94
    v_mul_f32 v94, v101, v50
    v_fma_f32 v30, v30, v100, -v94
    v_mul_f32 v94, v103, v51
    v_fma_f32 v31, v31, v102, -v94
    v_cvt_pk_bf16_f32 v138, v28, v29
    v_cvt_pk_bf16_f32 v139, v30, v31
    v_mul_f32 v94, v97, v52
    v_fma_f32 v32, v32, v96, -v94
    v_mfma_f32_16x16x32_bf16 v[20:23], v[136:139], v[68:71], 0
    v_mul_f32 v94, v99, v53
    v_fma_f32 v33, v33, v98, -v94
    v_mul_f32 v94, v101, v54
    v_fma_f32 v34, v34, v100, -v94
    v_mul_f32 v94, v103, v55
    v_fma_f32 v35, v35, v102, -v94
    v_cvt_pk_bf16_f32 v142, v32, v33
    v_cvt_pk_bf16_f32 v143, v34, v35
    v_mov_b32 v136, v138
    v_mov_b32 v137, v139
    v_mfma_f32_16x16x32_bf16 v[24:27], v[140:143], v[68:71], 0
    v_mul_f32 v20, v6, v20
    v_mul_f32 v21, v6, v21
    v_mul_f32 v22, v6, v22
    v_mul_f32 v23, v6, v23
    v_cvt_pk_bf16_f32 v20, v20, v21
    v_cvt_pk_bf16_f32 v21, v22, v23
    buffer_store_dwordx2 v[20:21], v13, s[8:11], s46 offen sc1
    v_mov_b32 v140, v142
    v_mov_b32 v141, v143
    v_mul_f32 v24, v6, v24
    v_mul_f32 v25, v6, v25
    v_cvt_pk_bf16_f32 v24, v24, v25
    s_mov_b64 exec, 0xffff
    buffer_store_dword v24, v14, s[8:11], s46 offen sc1
    s_mov_b64 exec, -1
    s_mul_i32 s43, s57, 22528
    s_add_u32 s43, s43, s49
    s_cmp_lg_u32 s62, 0
    s_cbranch_scc1 Laq_item
    buffer_load_dword v2, v1, s[8:11], s42 offen sc1
    s_waitcnt vmcnt(0)
    s_cmp_ge_u32 s37, 64
    s_cbranch_scc1 Laq_fin
    v_cmp_eq_u32 vcc, 0, v2
    s_nop 0
    s_cbranch_vccnz Laq_pub
    s_add_u32 m0, s59, 0
    s_add_u32 s47, s41, 0
    buffer_load_dwordx4 v111, s[8:11], s47 offen offset:0 lds
    buffer_load_dwordx4 v111, s[8:11], s47 offen offset:1024 lds
    buffer_load_dwordx4 v111, s[8:11], s47 offen offset:2048 lds
    buffer_load_dwordx4 v111, s[8:11], s47 offen offset:3072 lds
    s_add_u32 m0, s59, 4096
    s_add_u32 s47, s41, 4096
    buffer_load_dwordx4 v111, s[8:11], s47 offen offset:0 lds
    buffer_load_dwordx4 v111, s[8:11], s47 offen offset:1024 lds
    buffer_load_dwordx4 v111, s[8:11], s47 offen offset:2048 lds
    buffer_load_dwordx4 v111, s[8:11], s47 offen offset:3072 lds
    s_add_u32 m0, s59, 8192
    s_add_u32 s47, s41, 8192
    buffer_load_dwordx4 v111, s[8:11], s47 offen offset:0 lds
    s_mul_i32 s48, s36, 786432
    s_mul_i32 s18, s37, 6144
    s_add_u32 s48, s48, s18
    s_add_u32 s48, s48, 15728640
    buffer_load_dwordx4 v[80:83], v10, s[8:11], s48 offen offset:0
    buffer_load_dwordx4 v[84:87], v10, s[8:11], s48 offen offset:512
    buffer_load_dwordx4 v[88:91], v10, s[8:11], s48 offen offset:1024
    s_cmp_lg_u32 s43, 0
    s_cselect_b64 exec, 1, 0
    buffer_store_dword v3, v4, s[8:11], s43 offen sc1
    s_mov_b64 exec, -1
    s_mov_b32 s43, 0
    s_waitcnt vmcnt(1)
    s_branch Laq_go
Laq_fin:
    s_cmp_lg_u32 s43, 0
    s_cselect_b64 exec, 1, 0
    buffer_store_dword v3, v4, s[8:11], s43 offen sc1
    s_mov_b64 exec, -1
    s_mov_b32 s43, 0
    s_branch L_role_aq_exit
Laq_pub:
    s_cmp_lg_u32 s43, 0
    s_cselect_b64 exec, 1, 0
    buffer_store_dword v3, v4, s[8:11], s43 offen sc1
    s_mov_b64 exec, -1
    s_mov_b32 s43, 0
Laq_poll:
    s_mov_b32 s16, 0
Laq_pl:
    buffer_load_dword v2, v1, s[8:11], s42 offen sc1
    s_add_u32 s16, s16, 1
    s_cmp_gt_u32 s16, 100000
    s_cbranch_scc1 L_role_aq_abort
    s_waitcnt vmcnt(0)
    v_cmp_eq_u32 vcc, 0, v2
    s_nop 0
    s_cbranch_vccz Laq_pld
    s_sleep 4
    s_branch Laq_pl
Laq_pld:
    s_add_u32 m0, s59, 0
    s_add_u32 s47, s41, 0
    buffer_load_dwordx4 v111, s[8:11], s47 offen offset:0 lds
    buffer_load_dwordx4 v111, s[8:11], s47 offen offset:1024 lds
    buffer_load_dwordx4 v111, s[8:11], s47 offen offset:2048 lds
    buffer_load_dwordx4 v111, s[8:11], s47 offen offset:3072 lds
    s_add_u32 m0, s59, 4096
    s_add_u32 s47, s41, 4096
    buffer_load_dwordx4 v111, s[8:11], s47 offen offset:0 lds
    buffer_load_dwordx4 v111, s[8:11], s47 offen offset:1024 lds
    buffer_load_dwordx4 v111, s[8:11], s47 offen offset:2048 lds
    buffer_load_dwordx4 v111, s[8:11], s47 offen offset:3072 lds
    s_add_u32 m0, s59, 8192
    s_add_u32 s47, s41, 8192
    buffer_load_dwordx4 v111, s[8:11], s47 offen offset:0 lds
    s_mul_i32 s48, s36, 786432
    s_mul_i32 s18, s37, 6144
    s_add_u32 s48, s48, s18
    s_add_u32 s48, s48, 15728640
    buffer_load_dwordx4 v[80:83], v10, s[8:11], s48 offen offset:0
    buffer_load_dwordx4 v[84:87], v10, s[8:11], s48 offen offset:512
    buffer_load_dwordx4 v[88:91], v10, s[8:11], s48 offen offset:1024
    s_waitcnt vmcnt(0)
    s_branch Laq_go
L_role_aq_abort:
    s_waitcnt lgkmcnt(0)
    s_mov_b64 exec, -1
    v_mov_b32 v0, 60
    s_lshl_b32 s5, s3, 8
    s_or_b32 s5, s5, s4
    s_or_b32 s5, s5, 0x10000
    v_mov_b32 v1, s5
    global_store_dword v0, v1, s[12:13]
    s_endpgm
L_role_aq_exit:
    s_and_b32 s6, s15, 15
    s_add_u32 s6, s6, s14
    s_cmp_lg_u32 s6, 0
    s_cbranch_scc1 L_role_aq_nowb
    s_waitcnt vmcnt(0)
    buffer_wbl2 sc1
    s_waitcnt vmcnt(0)
L_role_aq_nowb:
    s_endpgm
.p2align 6
L_role_ta:
    v_and_b32 v5, 63, v0
    v_lshlrev_b32 v0, 4, v5
    v_and_b32 v7, 15, v5
    v_lshrrev_b32 v8, 4, v5
    v_min_u32 v1, 11, v5
    v_lshrrev_b32 v6, 2, v1
    v_and_b32 v1, 3, v1
    v_lshlrev_b32 v1, 2, v1
    v_lshl_add_u32 v1, v6, 7, v1
    v_mov_b32 v3, 1
    v_mov_b32 v4, 0
    s_mov_b32 s44, 0x05040100
    s_mov_b32 s45, 0x07060302
    s_lshl_b32 s17, s15, 2
    s_add_u32 s17, s17, s14
    s_lshr_b32 s36, s17, 5
    s_and_b32 s50, s17, 31
    s_mov_b32 s37, 0
    s_mov_b32 s52, 0x3e0293ee
    v_lshrrev_b32 v5, 2, v7
    v_and_b32 v6, 1, v7
    v_lshl_add_u32 v5, v5, 1, v6
    v_lshlrev_b32 v9, 8, v5
    v_lshl_add_u32 v9, v8, 4, v9
    v_lshrrev_b32 v10, 1, v0
    v_mov_b32 v6, 0xf149f2ca
    v_mov_b32 v21, 0
    v_mov_b32 v22, 0
    s_mul_i32 s42, s36, 1441792
    s_lshl_b32 s17, s50, 9
    s_add_u32 s42, s42, s17
    s_add_u32 s42, s42, 185600
    s_mul_i32 s51, s36, 50331648
    s_lshl_b32 s17, s50, 13
    s_add_u32 s51, s51, s17
    s_add_u32 s51, s51, 44040192
    s_lshl_b32 s47, s36, 11
    s_add_u32 s47, s47, s50
    s_lshl_b32 s48, s47, 13
    s_add_u32 s48, s48, 144703488
    s_mul_i32 s35, s36, 256
    s_add_u32 s35, s35, s50
    s_lshl_b32 s35, s35, 12
    s_add_u32 s35, s35, 27262976
    s_mul_i32 s43, s36, 1441792
    s_lshr_b32 s17, s50, 2
    s_lshl_b32 s17, s17, 7
    s_add_u32 s43, s43, s17
    s_lshl_b32 s17, s14, 2
    s_add_u32 s43, s43, s17
    s_add_u32 s43, s43, 184448
    s_mov_b32 s28, s8
    s_mov_b32 s29, s9
    s_mov_b32 s30, 0
    s_mov_b32 s31, 0x00020000
    s_mov_b32 s39, 0
    s_mov_b32 s49, 0
    s_mov_b32 s66, 0
    s_lshl_b32 s47, s36, 2
    s_add_u32 s47, s47, 192
    v_mov_b32 v16, 0x3f803f80
    v_lshl_add_u32 v5, v8, 2, 0
    v_cmp_le_u32 vcc, v5, v7
    s_nop 1
    v_cndmask_b32 v236, v6, v4, vcc
    v_mov_b32 v17, 0x3f803f80
    v_lshl_add_u32 v5, v8, 2, 1
    v_cmp_le_u32 vcc, v5, v7
    s_nop 1
    v_cndmask_b32 v237, v6, v4, vcc
    v_mov_b32 v18, 0x3f803f80
    v_lshl_add_u32 v5, v8, 2, 2
    v_cmp_le_u32 vcc, v5, v7
    s_nop 1
    v_cndmask_b32 v238, v6, v4, vcc
    v_mov_b32 v19, 0x3f803f80
    v_lshl_add_u32 v5, v8, 2, 3
    v_cmp_le_u32 vcc, v5, v7
    s_nop 1
    v_cndmask_b32 v239, v6, v4, vcc
    s_cmp_lg_u32 s14, 0
    s_cbranch_scc1 Lta_ini_d
    v_mov_b32 v5, 160
    s_mov_b32 s16, 0
Lta_ini:
    global_load_dword v6, v5, s[12:13] sc1
    s_add_u32 s16, s16, 1
    s_cmp_gt_u32 s16, 100000
    s_cbranch_scc1 L_role_ta_abort
    s_waitcnt vmcnt(0)
    v_cmp_gt_u32 vcc, 123, v6
    s_nop 0
    s_cbranch_vccz Lta_ini_d
    s_sleep 64
    s_branch Lta_ini
Lta_ini_d:
    s_barrier
    s_cmp_lg_u32 s14, 0
    s_cbranch_scc1 Lta_team_d
    v_mov_b32 v5, s47
    s_mov_b32 s16, 0
Lta_team:
    global_load_dword v6, v5, s[12:13] sc1
    s_add_u32 s16, s16, 1
    s_cmp_gt_u32 s16, 100000
    s_cbranch_scc1 L_role_ta_abort
    s_waitcnt vmcnt(0)
    v_cmp_gt_u32 vcc, 32, v6
    s_nop 0
    s_cbranch_vccz Lta_team_d
    s_sleep 64
    s_branch Lta_team
Lta_team_d:
    s_barrier
    v_mbcnt_lo_u32_b32 v5, -1, 0
    v_mbcnt_hi_u32_b32 v5, -1, v5
    v_and_b32 v6, 1, v5
    v_lshlrev_b32 v6, 7, v6
    v_lshlrev_b32 v5, 1, v5
    v_and_or_b32 v5, v5, 12, v6
    s_mov_b32 s16, 0
Lta_pure:
    global_load_dword v6, v5, s[12:13] sc1
    s_add_u32 s16, s16, 1
    s_cmp_gt_u32 s16, 100000
    s_cbranch_scc1 L_role_ta_abort
    s_mov_b32 s6, 0
    s_waitcnt vmcnt(0)
    v_readlane_b32 s7, v6, 0
    s_nop 0
    s_add_u32 s6, s6, s7
    v_readlane_b32 s7, v6, 1
    s_nop 0
    s_add_u32 s6, s6, s7
    v_readlane_b32 s7, v6, 2
    s_nop 0
    s_add_u32 s6, s6, s7
    v_readlane_b32 s7, v6, 3
    s_nop 0
    s_add_u32 s6, s6, s7
    v_readlane_b32 s7, v6, 4
    s_nop 0
    s_add_u32 s6, s6, s7
    v_readlane_b32 s7, v6, 5
    s_nop 0
    s_add_u32 s6, s6, s7
    v_readlane_b32 s7, v6, 6
    s_nop 0
    s_add_u32 s6, s6, s7
    v_readlane_b32 s7, v6, 7
    s_nop 0
    s_add_u32 s6, s6, s7
    v_readlane_b32 s7, v6, s3
    s_nop 0
    s_cmp_ge_u32 s7, 32
    s_cselect_b32 s61, 1, 0
    s_cselect_b32 s6, 256, s6
    s_cmp_lt_u32 s6, 256
    s_cbranch_scc1 Lta_pure
LtaF0:
    s_sub_u32 s17, s37, 33
    s_mul_i32 s18, s17, 43
    s_lshr_b32 s18, s18, 7
    s_mul_i32 s18, s18, 3
    s_cmp_eq_u32 s18, s17
    s_cselect_b32 s18, 1, 0
    s_cmp_lt_u32 s37, 34
    s_cselect_b32 s18, 1, s18
    s_cmp_eq_u32 s36, 0
    s_cselect_b32 s18, 1, s18
    s_and_b32 s18, s18, s61
    s_cbranch_scc0 LtaS0_in
LtaF0_in:
    s_and_b32 s17, s37, 7
    s_mul_i32 s17, s17, 131072
    s_add_u32 s47, s35, s17
    s_bfe_u32 s34, s37, 65539
    s_cmp_eq_u32 s39, 1
    s_cbranch_scc1 LtaF0_have
    s_waitcnt vmcnt(0)
    s_and_b32 s17, s49, s66
    s_cselect_b64 exec, 1, 0
    buffer_store_dword v3, v4, s[8:11], s43 offen
    s_andn2_b32 s17, s49, s66
    s_cselect_b64 exec, 1, 0
    buffer_store_dword v3, v4, s[8:11], s43 offen sc1
    s_mov_b64 exec, -1
    s_add_u32 s43, s43, s49
    s_mov_b32 s49, 0
    s_mov_b32 s16, 0
LtaF0_f_2:
    buffer_load_dword v2, v1, s[8:11], s42 offen sc1
    s_add_u32 s16, s16, 1
    s_cmp_gt_u32 s16, 100000
    s_cbranch_scc1 L_role_ta_abort
    s_waitcnt vmcnt(0)
    v_cmp_eq_u32 vcc, 0, v2
    s_nop 0
    s_cbranch_vccz LtaF0_fd_3
    s_sleep 4
    s_branch LtaF0_f_2
LtaF0_fd_3:
    s_add_u32 s46, s51, 0
    buffer_load_dwordx4 v[140:143], v0, s[8:11], s46 offen offset:0
    buffer_load_dwordx4 v[144:147], v0, s[8:11], s46 offen offset:1024
    buffer_load_dwordx4 v[148:151], v0, s[8:11], s46 offen offset:2048
    buffer_load_dwordx4 v[152:155], v0, s[8:11], s46 offen offset:3072
    s_add_u32 s46, s51, 4096
    buffer_load_dwordx4 v[156:159], v0, s[8:11], s46 offen offset:0
    buffer_load_dwordx4 v[160:163], v0, s[8:11], s46 offen offset:1024
    buffer_load_dwordx4 v[164:167], v0, s[8:11], s46 offen offset:2048
    buffer_load_dwordx4 v[168:171], v0, s[8:11], s46 offen offset:3072
    s_add_u32 s46, s51, 16777216
    buffer_load_dwordx4 v[172:175], v0, s[8:11], s46 offen offset:0
    buffer_load_dwordx4 v[176:179], v0, s[8:11], s46 offen offset:1024
    buffer_load_dwordx4 v[180:183], v0, s[8:11], s46 offen offset:2048
    buffer_load_dwordx4 v[184:187], v0, s[8:11], s46 offen offset:3072
    s_add_u32 s46, s51, 16781312
    buffer_load_dwordx4 v[188:191], v0, s[8:11], s46 offen offset:0
    buffer_load_dwordx4 v[192:195], v0, s[8:11], s46 offen offset:1024
    buffer_load_dwordx4 v[196:199], v0, s[8:11], s46 offen offset:2048
    buffer_load_dwordx4 v[200:203], v0, s[8:11], s46 offen offset:3072
    s_add_u32 s46, s51, 33554432
    buffer_load_dwordx4 v[204:207], v0, s[8:11], s46 offen offset:0
    buffer_load_dwordx4 v[208:211], v0, s[8:11], s46 offen offset:1024
    buffer_load_dwordx4 v[212:215], v0, s[8:11], s46 offen offset:2048
    buffer_load_dwordx4 v[216:219], v0, s[8:11], s46 offen offset:3072
    s_add_u32 s46, s51, 33558528
    buffer_load_dwordx4 v[220:223], v0, s[8:11], s46 offen offset:0
    buffer_load_dwordx4 v[224:227], v0, s[8:11], s46 offen offset:1024
    buffer_load_dwordx4 v[228:231], v0, s[8:11], s46 offen offset:2048
    buffer_load_dwordx4 v[232:235], v0, s[8:11], s46 offen offset:3072
LtaF0_have:
    s_add_u32 s17, s42, 22528
    buffer_load_dword v15, v1, s[8:11], s17 offen sc1
    buffer_load_dwordx4 v[52:55], v9, s[8:11], s47 offen offset:0 sc1
    buffer_load_dwordx4 v[56:59], v9, s[8:11], s47 offen offset:64 sc1
    buffer_load_dwordx4 v[60:63], v9, s[8:11], s47 offen offset:128 sc1
    buffer_load_dwordx4 v[64:67], v9, s[8:11], s47 offen offset:192 sc1
    buffer_load_dwordx2 v[68:69], v10, s[8:11], s47 offen offset:2048 sc1
    buffer_load_dwordx2 v[70:71], v10, s[8:11], s47 offen offset:2560 sc1
    buffer_load_dwordx2 v[72:73], v10, s[8:11], s47 offen offset:3072 sc1
    buffer_load_dwordx2 v[74:75], v10, s[8:11], s47 offen offset:3584 sc1
    s_waitcnt vmcnt(9)
    s_and_b32 s17, s49, s66
    s_cselect_b64 exec, 1, 0
    buffer_store_dword v3, v4, s[8:11], s43 offen
    s_andn2_b32 s17, s49, s66
    s_cselect_b64 exec, 1, 0
    buffer_store_dword v3, v4, s[8:11], s43 offen sc1
    s_mov_b64 exec, -1
    s_add_u32 s43, s43, s49
    s_mov_b32 s49, 0
    v_mfma_f32_16x16x32_bf16 v[32:35], v[172:175], v[140:143], 0
    v_mfma_f32_16x16x32_bf16 v[36:39], v[172:175], v[144:147], 0
    v_mfma_f32_16x16x32_bf16 v[40:43], v[176:179], v[144:147], 0
    v_mfma_f32_16x16x32_bf16 v[32:35], v[180:183], v[148:151], v[32:35]
    v_mfma_f32_16x16x32_bf16 v[36:39], v[180:183], v[152:155], v[36:39]
    v_mfma_f32_16x16x32_bf16 v[40:43], v[184:187], v[152:155], v[40:43]
    v_mfma_f32_16x16x32_bf16 v[32:35], v[188:191], v[156:159], v[32:35]
    v_mfma_f32_16x16x32_bf16 v[36:39], v[188:191], v[160:163], v[36:39]
    v_mfma_f32_16x16x32_bf16 v[40:43], v[192:195], v[160:163], v[40:43]
    v_mfma_f32_16x16x32_bf16 v[32:35], v[196:199], v[164:167], v[32:35]
    v_mfma_f32_16x16x32_bf16 v[36:39], v[196:199], v[168:171], v[36:39]
    v_mfma_f32_16x16x32_bf16 v[40:43], v[200:203], v[168:171], v[40:43]
    s_waitcnt vmcnt(2)
    v_cmp_eq_u32 vcc, 0, v15
    s_add_u32 s51, s51, 262144
    s_add_u32 s42, s42, 22528
    s_add_u32 s37, s37, 1
    s_cmp_eq_u64 vcc, 0
    s_cselect_b32 s39, 1, 0
    s_cmp_lt_u32 s37, 64
    s_cselect_b32 s39, s39, 0
    s_cmp_eq_u32 s39, 1
    s_cselect_b32 s30, 268435456, 0
    v_fma_f32 v32, v32, s52, v236
    v_fma_f32 v33, v33, s52, v237
    v_fma_f32 v34, v34, s52, v238
    v_fma_f32 v35, v35, s52, v239
    v_mul_f32 v36, s52, v36
    v_mul_f32 v37, s52, v37
    v_mul_f32 v38, s52, v38
    v_mul_f32 v39, s52, v39
    v_fma_f32 v40, v40, s52, v236
    v_fma_f32 v41, v41, s52, v237
    v_fma_f32 v42, v42, s52, v238
    v_fma_f32 v43, v43, s52, v239
    v_xor_b32 v5, s34, v52
    v_xor_b32 v6, s34, v56
    v_or_b32 v5, v5, v6
    v_xor_b32 v6, s34, v60
    v_or_b32 v5, v5, v6
    v_xor_b32 v6, s34, v64
    v_or_b32 v5, v5, v6
    v_xor_b32 v6, s34, v68
    v_or_b32 v5, v5, v6
    v_xor_b32 v6, s34, v70
    v_or_b32 v5, v5, v6
    v_xor_b32 v6, s34, v72
    v_or_b32 v5, v5, v6
    v_xor_b32 v6, s34, v74
    v_or_b32 v5, v5, v6
    v_and_b32 v5, 1, v5
    v_cmp_ne_u32 vcc, 0, v5
    s_nop 0
    s_cbranch_vccz LtaF0_r
    s_mov_b32 s16, 0
LtaF0_rp:
    buffer_load_dwordx4 v[52:55], v9, s[8:11], s47 offen offset:0 sc1
    buffer_load_dwordx4 v[56:59], v9, s[8:11], s47 offen offset:64 sc1
    buffer_load_dwordx4 v[60:63], v9, s[8:11], s47 offen offset:128 sc1
    buffer_load_dwordx4 v[64:67], v9, s[8:11], s47 offen offset:192 sc1
    buffer_load_dwordx2 v[68:69], v10, s[8:11], s47 offen offset:2048 sc1
    buffer_load_dwordx2 v[70:71], v10, s[8:11], s47 offen offset:2560 sc1
    buffer_load_dwordx2 v[72:73], v10, s[8:11], s47 offen offset:3072 sc1
    buffer_load_dwordx2 v[74:75], v10, s[8:11], s47 offen offset:3584 sc1
    s_add_u32 s16, s16, 1
    s_cmp_gt_u32 s16, 100000
    s_cbranch_scc1 L_role_ta_abort
    s_waitcnt vmcnt(0)
    v_xor_b32 v5, s34, v52
    v_xor_b32 v6, s34, v56
    v_or_b32 v5, v5, v6
    v_xor_b32 v6, s34, v60
    v_or_b32 v5, v5, v6
    v_xor_b32 v6, s34, v64
    v_or_b32 v5, v5, v6
    v_xor_b32 v6, s34, v68
    v_or_b32 v5, v5, v6
    v_xor_b32 v6, s34, v70
    v_or_b32 v5, v5, v6
    v_xor_b32 v6, s34, v72
    v_or_b32 v5, v5, v6
    v_xor_b32 v6, s34, v74
    v_or_b32 v5, v5, v6
    v_and_b32 v5, 1, v5
    v_cmp_ne_u32 vcc, 0, v5
    s_nop 0
    s_cbranch_vccz LtaF0_r
    s_sleep 2
    s_branch LtaF0_rp
LtaF0_r:
    s_and_b32 s17, s37, 3
    s_cmp_eq_u32 s17, 0
    s_cselect_b32 s17, s36, 0
    s_cmp_lg_u32 s17, 0
    s_cselect_b64 exec, 1, 0
    s_sub_u32 s17, s42, 22528
    buffer_store_dword v3, v4, s[8:11], s17 offen offset:384 sc1
    s_mov_b64 exec, -1
    s_add_u32 s46, s51, 0
    buffer_load_dwordx4 a[0:3], v0, s[28:31], s46 offen offset:0
    buffer_load_dwordx4 a[4:7], v0, s[28:31], s46 offen offset:1024
    v_mfma_f32_16x16x32_bf16 v[44:47], v[52:55], v[140:143], 0
    v_mfma_f32_16x16x32_bf16 v[48:51], v[52:55], v[144:147], 0
    v_mfma_f32_16x16x32_bf16 v[44:47], v[56:59], v[148:151], v[44:47]
    v_mfma_f32_16x16x32_bf16 v[48:51], v[56:59], v[152:155], v[48:51]
    v_mfma_f32_16x16x32_bf16 v[44:47], v[60:63], v[156:159], v[44:47]
    v_mfma_f32_16x16x32_bf16 v[48:51], v[60:63], v[160:163], v[48:51]
    v_mfma_f32_16x16x32_bf16 v[44:47], v[64:67], v[164:167], v[44:47]
    v_mfma_f32_16x16x32_bf16 v[48:51], v[64:67], v[168:171], v[48:51]
    v_max3_f32 v5, v32, v33, v34
    v_max_f32 v5, v5, v35
    s_nop 4
    v_mul_f32 v44, s52, v44
    v_mul_f32 v45, s52, v45
    v_max3_f32 v5, v5, v44, v45
    v_mov_b32 v6, v5
    buffer_load_dwordx4 a[8:11], v0, s[28:31], s46 offen offset:2048
    s_nop 0
    v_permlane32_swap_b32 v5, v6
    v_max_f32 v5, v5, v6
    v_mov_b32 v6, v5
    buffer_load_dwordx4 a[12:15], v0, s[28:31], s46 offen offset:3072
    s_nop 0
    v_permlane16_swap_b32 v5, v6
    v_max_f32 v5, v5, v6
    v_sub_f32 v32, v32, v5
    v_sub_f32 v33, v33, v5
    v_sub_f32 v34, v34, v5
    v_sub_f32 v35, v35, v5
    v_sub_f32 v44, v44, v5
    v_sub_f32 v45, v45, v5
    v_exp_f32 v32, v32
    v_exp_f32 v33, v33
    v_exp_f32 v34, v34
    v_exp_f32 v35, v35
    v_exp_f32 v44, v44
    v_exp_f32 v45, v45
    v_cvt_pk_bf16_f32 v24, v32, v33
    v_cvt_pk_bf16_f32 v25, v34, v35
    v_mov_b32 v26, 0
    v_mov_b32 v27, 0
    v_cvt_pk_bf16_f32 v20, v44, v45
    v_cvt_pk_bf16_f32 v23, v44, v45
    v_mfma_f32_16x16x32_bf16 v[28:31], v[16:19], v[24:27], 0
    v_mfma_f32_16x16x32_bf16 v[76:79], v[204:207], v[24:27], 0
    v_mfma_f32_16x16x32_bf16 v[80:83], v[208:211], v[24:27], 0
    s_add_u32 s46, s51, 4096
    buffer_load_dwordx4 a[16:19], v0, s[28:31], s46 offen offset:0
    v_mfma_f32_16x16x32_bf16 v[84:87], v[212:215], v[24:27], 0
    v_mfma_f32_16x16x32_bf16 v[88:91], v[216:219], v[24:27], 0
    buffer_load_dwordx4 a[20:23], v0, s[28:31], s46 offen offset:1024
    v_mfma_f32_16x16x32_bf16 v[92:95], v[220:223], v[24:27], 0
    v_mfma_f32_16x16x32_bf16 v[96:99], v[224:227], v[24:27], 0
    buffer_load_dwordx4 a[24:27], v0, s[28:31], s46 offen offset:2048
    v_mfma_f32_16x16x16_bf16 v[28:31], v[16:17], v[20:21], v[28:31]
    v_mfma_f32_16x16x32_bf16 v[100:103], v[228:231], v[24:27], 0
    v_mfma_f32_16x16x32_bf16 v[104:107], v[232:235], v[24:27], 0
    buffer_load_dwordx4 a[28:31], v0, s[28:31], s46 offen offset:3072
    v_mfma_f32_16x16x16_bf16 v[76:79], v[68:69], v[20:21], v[76:79]
    v_mfma_f32_16x16x16_bf16 v[80:83], v[68:69], v[22:23], v[80:83]
    s_nop 2
    v_rcp_f32 v6, v28
    v_mfma_f32_16x16x16_bf16 v[84:87], v[70:71], v[20:21], v[84:87]
    v_mfma_f32_16x16x16_bf16 v[88:91], v[70:71], v[22:23], v[88:91]
    s_nop 0
    v_mul_f32 v76, v6, v76
    v_mul_f32 v80, v6, v80
    v_cvt_pk_bf16_f32 v108, v76, v80
    v_mul_f32 v77, v6, v77
    v_mul_f32 v81, v6, v81
    v_cvt_pk_bf16_f32 v109, v77, v81
    v_mul_f32 v78, v6, v78
    v_mul_f32 v82, v6, v82
    v_cvt_pk_bf16_f32 v110, v78, v82
    v_mul_f32 v79, v6, v79
    v_mul_f32 v83, v6, v83
    v_cvt_pk_bf16_f32 v111, v79, v83
    s_add_u32 s17, s48, 0
    buffer_store_dwordx4 v[108:111], v0, s[8:11], s17 offen offset:0
    s_add_u32 s46, s51, 16777216
    buffer_load_dwordx4 a[32:35], v0, s[28:31], s46 offen offset:0
    v_mfma_f32_16x16x16_bf16 v[92:95], v[72:73], v[20:21], v[92:95]
    v_mfma_f32_16x16x16_bf16 v[96:99], v[72:73], v[22:23], v[96:99]
    v_mul_f32 v84, v6, v84
    v_mul_f32 v88, v6, v88
    v_cvt_pk_bf16_f32 v112, v84, v88
    v_mul_f32 v85, v6, v85
    v_mul_f32 v89, v6, v89
    v_cvt_pk_bf16_f32 v113, v85, v89
    v_mul_f32 v86, v6, v86
    v_mul_f32 v90, v6, v90
    v_cvt_pk_bf16_f32 v114, v86, v90
    v_mul_f32 v87, v6, v87
    v_mul_f32 v91, v6, v91
    v_cvt_pk_bf16_f32 v115, v87, v91
    buffer_store_dwordx4 v[112:115], v0, s[8:11], s17 offen offset:2048
    buffer_load_dwordx4 a[36:39], v0, s[28:31], s46 offen offset:1024
    v_mfma_f32_16x16x16_bf16 v[100:103], v[74:75], v[20:21], v[100:103]
    v_mfma_f32_16x16x16_bf16 v[104:107], v[74:75], v[22:23], v[104:107]
    v_mul_f32 v92, v6, v92
    v_mul_f32 v96, v6, v96
    v_cvt_pk_bf16_f32 v116, v92, v96
    v_mul_f32 v93, v6, v93
    v_mul_f32 v97, v6, v97
    v_cvt_pk_bf16_f32 v117, v93, v97
    v_mul_f32 v94, v6, v94
    v_mul_f32 v98, v6, v98
    v_cvt_pk_bf16_f32 v118, v94, v98
    v_mul_f32 v95, v6, v95
    v_mul_f32 v99, v6, v99
    v_cvt_pk_bf16_f32 v119, v95, v99
    s_add_u32 s17, s48, 4096
    buffer_store_dwordx4 v[116:119], v0, s[8:11], s17 offen offset:0
    buffer_load_dwordx4 a[40:43], v0, s[28:31], s46 offen offset:2048
    v_mul_f32 v100, v6, v100
    v_mul_f32 v104, v6, v104
    v_cvt_pk_bf16_f32 v120, v100, v104
    v_mul_f32 v101, v6, v101
    v_mul_f32 v105, v6, v105
    v_cvt_pk_bf16_f32 v121, v101, v105
    v_mul_f32 v102, v6, v102
    v_mul_f32 v106, v6, v106
    v_cvt_pk_bf16_f32 v122, v102, v106
    v_mul_f32 v103, v6, v103
    v_mul_f32 v107, v6, v107
    v_cvt_pk_bf16_f32 v123, v103, v107
    buffer_store_dwordx4 v[120:123], v0, s[8:11], s17 offen offset:2048
    buffer_load_dwordx4 a[44:47], v0, s[28:31], s46 offen offset:3072
    v_max3_f32 v5, v36, v37, v38
    v_max_f32 v5, v5, v39
    v_max3_f32 v5, v5, v40, v41
    v_max3_f32 v5, v5, v42, v43
    v_mul_f32 v48, s52, v48
    v_mul_f32 v49, s52, v49
    v_max3_f32 v5, v5, v48, v49
    v_mov_b32 v6, v5
    s_add_u32 s46, s51, 16781312
    buffer_load_dwordx4 a[48:51], v0, s[28:31], s46 offen offset:0
    v_permlane32_swap_b32 v5, v6
    v_max_f32 v5, v5, v6
    v_mov_b32 v6, v5
    buffer_load_dwordx4 a[52:55], v0, s[28:31], s46 offen offset:1024
    s_nop 0
    v_permlane16_swap_b32 v5, v6
    v_max_f32 v5, v5, v6
    v_sub_f32 v36, v36, v5
    v_sub_f32 v37, v37, v5
    v_sub_f32 v38, v38, v5
    v_sub_f32 v39, v39, v5
    v_sub_f32 v40, v40, v5
    v_sub_f32 v41, v41, v5
    v_sub_f32 v42, v42, v5
    v_sub_f32 v43, v43, v5
    v_sub_f32 v48, v48, v5
    v_sub_f32 v49, v49, v5
    v_exp_f32 v36, v36
    v_exp_f32 v37, v37
    v_exp_f32 v38, v38
    v_exp_f32 v39, v39
    v_exp_f32 v40, v40
    v_exp_f32 v41, v41
    v_exp_f32 v42, v42
    v_exp_f32 v43, v43
    v_exp_f32 v48, v48
    v_exp_f32 v49, v49
    v_cvt_pk_bf16_f32 v24, v36, v37
    v_cvt_pk_bf16_f32 v25, v38, v39
    v_cvt_pk_bf16_f32 v26, v40, v41
    v_cvt_pk_bf16_f32 v27, v42, v43
    v_cvt_pk_bf16_f32 v20, v48, v49
    v_cvt_pk_bf16_f32 v23, v48, v49
    v_mfma_f32_16x16x32_bf16 v[28:31], v[16:19], v[24:27], 0
    v_mfma_f32_16x16x32_bf16 v[76:79], v[204:207], v[24:27], 0
    v_mfma_f32_16x16x32_bf16 v[80:83], v[208:211], v[24:27], 0
    buffer_load_dwordx4 a[56:59], v0, s[28:31], s46 offen offset:2048
    v_mfma_f32_16x16x32_bf16 v[84:87], v[212:215], v[24:27], 0
    v_mfma_f32_16x16x32_bf16 v[88:91], v[216:219], v[24:27], 0
    buffer_load_dwordx4 a[60:63], v0, s[28:31], s46 offen offset:3072
    v_mfma_f32_16x16x32_bf16 v[92:95], v[220:223], v[24:27], 0
    v_mfma_f32_16x16x32_bf16 v[96:99], v[224:227], v[24:27], 0
    s_add_u32 s46, s51, 33554432
    buffer_load_dwordx4 a[64:67], v0, s[28:31], s46 offen offset:0
    v_mfma_f32_16x16x16_bf16 v[28:31], v[16:17], v[20:21], v[28:31]
    v_mfma_f32_16x16x32_bf16 v[100:103], v[228:231], v[24:27], 0
    v_mfma_f32_16x16x32_bf16 v[104:107], v[232:235], v[24:27], 0
    buffer_load_dwordx4 a[68:71], v0, s[28:31], s46 offen offset:1024
    v_mfma_f32_16x16x16_bf16 v[76:79], v[68:69], v[20:21], v[76:79]
    v_mfma_f32_16x16x16_bf16 v[80:83], v[68:69], v[22:23], v[80:83]
    s_nop 2
    v_rcp_f32 v6, v28
    v_mfma_f32_16x16x16_bf16 v[84:87], v[70:71], v[20:21], v[84:87]
    v_mfma_f32_16x16x16_bf16 v[88:91], v[70:71], v[22:23], v[88:91]
    s_nop 0
    v_mul_f32 v76, v6, v76
    v_mul_f32 v80, v6, v80
    v_cvt_pk_bf16_f32 v124, v76, v80
    v_mul_f32 v77, v6, v77
    v_mul_f32 v81, v6, v81
    v_cvt_pk_bf16_f32 v125, v77, v81
    v_mul_f32 v78, v6, v78
    v_mul_f32 v82, v6, v82
    v_cvt_pk_bf16_f32 v126, v78, v82
    v_mul_f32 v79, v6, v79
    v_mul_f32 v83, v6, v83
    v_cvt_pk_bf16_f32 v127, v79, v83
    s_add_u32 s17, s48, 0
    buffer_store_dwordx4 v[124:127], v0, s[8:11], s17 offen offset:1024
    buffer_load_dwordx4 a[72:75], v0, s[28:31], s46 offen offset:2048
    v_mfma_f32_16x16x16_bf16 v[92:95], v[72:73], v[20:21], v[92:95]
    v_mfma_f32_16x16x16_bf16 v[96:99], v[72:73], v[22:23], v[96:99]
    v_mul_f32 v84, v6, v84
    v_mul_f32 v88, v6, v88
    v_cvt_pk_bf16_f32 v128, v84, v88
    v_mul_f32 v85, v6, v85
    v_mul_f32 v89, v6, v89
    v_cvt_pk_bf16_f32 v129, v85, v89
    v_mul_f32 v86, v6, v86
    v_mul_f32 v90, v6, v90
    v_cvt_pk_bf16_f32 v130, v86, v90
    v_mul_f32 v87, v6, v87
    v_mul_f32 v91, v6, v91
    v_cvt_pk_bf16_f32 v131, v87, v91
    buffer_store_dwordx4 v[128:131], v0, s[8:11], s17 offen offset:3072
    buffer_load_dwordx4 a[76:79], v0, s[28:31], s46 offen offset:3072
    v_mfma_f32_16x16x16_bf16 v[100:103], v[74:75], v[20:21], v[100:103]
    v_mfma_f32_16x16x16_bf16 v[104:107], v[74:75], v[22:23], v[104:107]
    v_mul_f32 v92, v6, v92
    v_mul_f32 v96, v6, v96
    v_cvt_pk_bf16_f32 v132, v92, v96
    v_mul_f32 v93, v6, v93
    v_mul_f32 v97, v6, v97
    v_cvt_pk_bf16_f32 v133, v93, v97
    v_mul_f32 v94, v6, v94
    v_mul_f32 v98, v6, v98
    v_cvt_pk_bf16_f32 v134, v94, v98
    v_mul_f32 v95, v6, v95
    v_mul_f32 v99, v6, v99
    v_cvt_pk_bf16_f32 v135, v95, v99
    s_add_u32 s17, s48, 4096
    buffer_store_dwordx4 v[132:135], v0, s[8:11], s17 offen offset:1024
    s_add_u32 s46, s51, 33558528
    buffer_load_dwordx4 a[80:83], v0, s[28:31], s46 offen offset:0
    v_mul_f32 v100, v6, v100
    v_mul_f32 v104, v6, v104
    v_cvt_pk_bf16_f32 v136, v100, v104
    v_mul_f32 v101, v6, v101
    v_mul_f32 v105, v6, v105
    v_cvt_pk_bf16_f32 v137, v101, v105
    v_mul_f32 v102, v6, v102
    v_mul_f32 v106, v6, v106
    v_cvt_pk_bf16_f32 v138, v102, v106
    v_mul_f32 v103, v6, v103
    v_mul_f32 v107, v6, v107
    v_cvt_pk_bf16_f32 v139, v103, v107
    buffer_store_dwordx4 v[136:139], v0, s[8:11], s17 offen offset:3072
    buffer_load_dwordx4 a[84:87], v0, s[28:31], s46 offen offset:1024
    buffer_load_dwordx4 a[88:91], v0, s[28:31], s46 offen offset:2048
    buffer_load_dwordx4 a[92:95], v0, s[28:31], s46 offen offset:3072
    s_add_u32 s48, s48, 262144
    s_mov_b32 s49, 22528
    s_mov_b32 s66, -1
    s_cmp_ge_u32 s37, 64
    s_cbranch_scc1 LtaF_end
LtaF1:
    s_sub_u32 s17, s37, 33
    s_mul_i32 s18, s17, 43
    s_lshr_b32 s18, s18, 7
    s_mul_i32 s18, s18, 3
    s_cmp_eq_u32 s18, s17
    s_cselect_b32 s18, 1, 0
    s_cmp_lt_u32 s37, 34
    s_cselect_b32 s18, 1, s18
    s_cmp_eq_u32 s36, 0
    s_cselect_b32 s18, 1, s18
    s_and_b32 s18, s18, s61
    s_cbranch_scc0 LtaS1_in
LtaF1_in:
    s_and_b32 s17, s37, 7
    s_mul_i32 s17, s17, 131072
    s_add_u32 s47, s35, s17
    s_bfe_u32 s34, s37, 65539
    s_cmp_eq_u32 s39, 1
    s_cbranch_scc1 LtaF1_have
    s_waitcnt vmcnt(0)
    s_and_b32 s17, s49, s66
    s_cselect_b64 exec, 1, 0
    buffer_store_dword v3, v4, s[8:11], s43 offen
    s_andn2_b32 s17, s49, s66
    s_cselect_b64 exec, 1, 0
    buffer_store_dword v3, v4, s[8:11], s43 offen sc1
    s_mov_b64 exec, -1
    s_add_u32 s43, s43, s49
    s_mov_b32 s49, 0
    s_mov_b32 s16, 0
LtaF1_f_4:
    buffer_load_dword v2, v1, s[8:11], s42 offen sc1
    s_add_u32 s16, s16, 1
    s_cmp_gt_u32 s16, 100000
    s_cbranch_scc1 L_role_ta_abort
    s_waitcnt vmcnt(0)
    v_cmp_eq_u32 vcc, 0, v2
    s_nop 0
    s_cbranch_vccz LtaF1_fd_5
    s_sleep 4
    s_branch LtaF1_f_4
LtaF1_fd_5:
    s_add_u32 s46, s51, 0
    buffer_load_dwordx4 a[0:3], v0, s[8:11], s46 offen offset:0
    buffer_load_dwordx4 a[4:7], v0, s[8:11], s46 offen offset:1024
    buffer_load_dwordx4 a[8:11], v0, s[8:11], s46 offen offset:2048
    buffer_load_dwordx4 a[12:15], v0, s[8:11], s46 offen offset:3072
    s_add_u32 s46, s51, 4096
    buffer_load_dwordx4 a[16:19], v0, s[8:11], s46 offen offset:0
    buffer_load_dwordx4 a[20:23], v0, s[8:11], s46 offen offset:1024
    buffer_load_dwordx4 a[24:27], v0, s[8:11], s46 offen offset:2048
    buffer_load_dwordx4 a[28:31], v0, s[8:11], s46 offen offset:3072
    s_add_u32 s46, s51, 16777216
    buffer_load_dwordx4 a[32:35], v0, s[8:11], s46 offen offset:0
    buffer_load_dwordx4 a[36:39], v0, s[8:11], s46 offen offset:1024
    buffer_load_dwordx4 a[40:43], v0, s[8:11], s46 offen offset:2048
    buffer_load_dwordx4 a[44:47], v0, s[8:11], s46 offen offset:3072
    s_add_u32 s46, s51, 16781312
    buffer_load_dwordx4 a[48:51], v0, s[8:11], s46 offen offset:0
    buffer_load_dwordx4 a[52:55], v0, s[8:11], s46 offen offset:1024
    buffer_load_dwordx4 a[56:59], v0, s[8:11], s46 offen offset:2048
    buffer_load_dwordx4 a[60:63], v0, s[8:11], s46 offen offset:3072
    s_add_u32 s46, s51, 33554432
    buffer_load_dwordx4 a[64:67], v0, s[8:11], s46 offen offset:0
    buffer_load_dwordx4 a[68:71], v0, s[8:11], s46 offen offset:1024
    buffer_load_dwordx4 a[72:75], v0, s[8:11], s46 offen offset:2048
    buffer_load_dwordx4 a[76:79], v0, s[8:11], s46 offen offset:3072
    s_add_u32 s46, s51, 33558528
    buffer_load_dwordx4 a[80:83], v0, s[8:11], s46 offen offset:0
    buffer_load_dwordx4 a[84:87], v0, s[8:11], s46 offen offset:1024
    buffer_load_dwordx4 a[88:91], v0, s[8:11], s46 offen offset:2048
    buffer_load_dwordx4 a[92:95], v0, s[8:11], s46 offen offset:3072
LtaF1_have:
    s_add_u32 s17, s42, 22528
    buffer_load_dword v15, v1, s[8:11], s17 offen sc1
    buffer_load_dwordx4 v[52:55], v9, s[8:11], s47 offen offset:0 sc1
    buffer_load_dwordx4 v[56:59], v9, s[8:11], s47 offen offset:64 sc1
    buffer_load_dwordx4 v[60:63], v9, s[8:11], s47 offen offset:128 sc1
    buffer_load_dwordx4 v[64:67], v9, s[8:11], s47 offen offset:192 sc1
    buffer_load_dwordx2 v[68:69], v10, s[8:11], s47 offen offset:2048 sc1
    buffer_load_dwordx2 v[70:71], v10, s[8:11], s47 offen offset:2560 sc1
    buffer_load_dwordx2 v[72:73], v10, s[8:11], s47 offen offset:3072 sc1
    buffer_load_dwordx2 v[74:75], v10, s[8:11], s47 offen offset:3584 sc1
    s_waitcnt vmcnt(9)
    s_and_b32 s17, s49, s66
    s_cselect_b64 exec, 1, 0
    buffer_store_dword v3, v4, s[8:11], s43 offen
    s_andn2_b32 s17, s49, s66
    s_cselect_b64 exec, 1, 0
    buffer_store_dword v3, v4, s[8:11], s43 offen sc1
    s_mov_b64 exec, -1
    s_add_u32 s43, s43, s49
    s_mov_b32 s49, 0
    v_mfma_f32_16x16x32_bf16 v[32:35], a[32:35], a[0:3], 0
    v_mfma_f32_16x16x32_bf16 v[36:39], a[32:35], a[4:7], 0
    v_mfma_f32_16x16x32_bf16 v[40:43], a[36:39], a[4:7], 0
    v_mfma_f32_16x16x32_bf16 v[32:35], a[40:43], a[8:11], v[32:35]
    v_mfma_f32_16x16x32_bf16 v[36:39], a[40:43], a[12:15], v[36:39]
    v_mfma_f32_16x16x32_bf16 v[40:43], a[44:47], a[12:15], v[40:43]
    v_mfma_f32_16x16x32_bf16 v[32:35], a[48:51], a[16:19], v[32:35]
    v_mfma_f32_16x16x32_bf16 v[36:39], a[48:51], a[20:23], v[36:39]
    v_mfma_f32_16x16x32_bf16 v[40:43], a[52:55], a[20:23], v[40:43]
    v_mfma_f32_16x16x32_bf16 v[32:35], a[56:59], a[24:27], v[32:35]
    v_mfma_f32_16x16x32_bf16 v[36:39], a[56:59], a[28:31], v[36:39]
    v_mfma_f32_16x16x32_bf16 v[40:43], a[60:63], a[28:31], v[40:43]
    s_waitcnt vmcnt(2)
    v_cmp_eq_u32 vcc, 0, v15
    s_add_u32 s51, s51, 262144
    s_add_u32 s42, s42, 22528
    s_add_u32 s37, s37, 1
    s_cmp_eq_u64 vcc, 0
    s_cselect_b32 s39, 1, 0
    s_cmp_lt_u32 s37, 64
    s_cselect_b32 s39, s39, 0
    s_cmp_eq_u32 s39, 1
    s_cselect_b32 s30, 268435456, 0
    v_fma_f32 v32, v32, s52, v236
    v_fma_f32 v33, v33, s52, v237
    v_fma_f32 v34, v34, s52, v238
    v_fma_f32 v35, v35, s52, v239
    v_mul_f32 v36, s52, v36
    v_mul_f32 v37, s52, v37
    v_mul_f32 v38, s52, v38
    v_mul_f32 v39, s52, v39
    v_fma_f32 v40, v40, s52, v236
    v_fma_f32 v41, v41, s52, v237
    v_fma_f32 v42, v42, s52, v238
    v_fma_f32 v43, v43, s52, v239
    v_xor_b32 v5, s34, v52
    v_xor_b32 v6, s34, v56
    v_or_b32 v5, v5, v6
    v_xor_b32 v6, s34, v60
    v_or_b32 v5, v5, v6
    v_xor_b32 v6, s34, v64
    v_or_b32 v5, v5, v6
    v_xor_b32 v6, s34, v68
    v_or_b32 v5, v5, v6
    v_xor_b32 v6, s34, v70
    v_or_b32 v5, v5, v6
    v_xor_b32 v6, s34, v72
    v_or_b32 v5, v5, v6
    v_xor_b32 v6, s34, v74
    v_or_b32 v5, v5, v6
    v_and_b32 v5, 1, v5
    v_cmp_ne_u32 vcc, 0, v5
    s_nop 0
    s_cbranch_vccz LtaF1_r
    s_mov_b32 s16, 0
LtaF1_rp:
    buffer_load_dwordx4 v[52:55], v9, s[8:11], s47 offen offset:0 sc1
    buffer_load_dwordx4 v[56:59], v9, s[8:11], s47 offen offset:64 sc1
    buffer_load_dwordx4 v[60:63], v9, s[8:11], s47 offen offset:128 sc1
    buffer_load_dwordx4 v[64:67], v9, s[8:11], s47 offen offset:192 sc1
    buffer_load_dwordx2 v[68:69], v10, s[8:11], s47 offen offset:2048 sc1
    buffer_load_dwordx2 v[70:71], v10, s[8:11], s47 offen offset:2560 sc1
    buffer_load_dwordx2 v[72:73], v10, s[8:11], s47 offen offset:3072 sc1
    buffer_load_dwordx2 v[74:75], v10, s[8:11], s47 offen offset:3584 sc1
    s_add_u32 s16, s16, 1
    s_cmp_gt_u32 s16, 100000
    s_cbranch_scc1 L_role_ta_abort
    s_waitcnt vmcnt(0)
    v_xor_b32 v5, s34, v52
    v_xor_b32 v6, s34, v56
    v_or_b32 v5, v5, v6
    v_xor_b32 v6, s34, v60
    v_or_b32 v5, v5, v6
    v_xor_b32 v6, s34, v64
    v_or_b32 v5, v5, v6
    v_xor_b32 v6, s34, v68
    v_or_b32 v5, v5, v6
    v_xor_b32 v6, s34, v70
    v_or_b32 v5, v5, v6
    v_xor_b32 v6, s34, v72
    v_or_b32 v5, v5, v6
    v_xor_b32 v6, s34, v74
    v_or_b32 v5, v5, v6
    v_and_b32 v5, 1, v5
    v_cmp_ne_u32 vcc, 0, v5
    s_nop 0
    s_cbranch_vccz LtaF1_r
    s_sleep 2
    s_branch LtaF1_rp
LtaF1_r:
    s_and_b32 s17, s37, 3
    s_cmp_eq_u32 s17, 0
    s_cselect_b32 s17, s36, 0
    s_cmp_lg_u32 s17, 0
    s_cselect_b64 exec, 1, 0
    s_sub_u32 s17, s42, 22528
    buffer_store_dword v3, v4, s[8:11], s17 offen offset:384 sc1
    s_mov_b64 exec, -1
    s_add_u32 s46, s51, 0
    buffer_load_dwordx4 v[140:143], v0, s[28:31], s46 offen offset:0
    buffer_load_dwordx4 v[144:147], v0, s[28:31], s46 offen offset:1024
    v_mfma_f32_16x16x32_bf16 v[44:47], v[52:55], a[0:3], 0
    v_mfma_f32_16x16x32_bf16 v[48:51], v[52:55], a[4:7], 0
    v_mfma_f32_16x16x32_bf16 v[44:47], v[56:59], a[8:11], v[44:47]
    v_mfma_f32_16x16x32_bf16 v[48:51], v[56:59], a[12:15], v[48:51]
    v_mfma_f32_16x16x32_bf16 v[44:47], v[60:63], a[16:19], v[44:47]
    v_mfma_f32_16x16x32_bf16 v[48:51], v[60:63], a[20:23], v[48:51]
    v_mfma_f32_16x16x32_bf16 v[44:47], v[64:67], a[24:27], v[44:47]
    v_mfma_f32_16x16x32_bf16 v[48:51], v[64:67], a[28:31], v[48:51]
    v_max3_f32 v5, v32, v33, v34
    v_max_f32 v5, v5, v35
    s_nop 4
    v_mul_f32 v44, s52, v44
    v_mul_f32 v45, s52, v45
    v_max3_f32 v5, v5, v44, v45
    v_mov_b32 v6, v5
    buffer_load_dwordx4 v[148:151], v0, s[28:31], s46 offen offset:2048
    s_nop 0
    v_permlane32_swap_b32 v5, v6
    v_max_f32 v5, v5, v6
    v_mov_b32 v6, v5
    buffer_load_dwordx4 v[152:155], v0, s[28:31], s46 offen offset:3072
    s_nop 0
    v_permlane16_swap_b32 v5, v6
    v_max_f32 v5, v5, v6
    v_sub_f32 v32, v32, v5
    v_sub_f32 v33, v33, v5
    v_sub_f32 v34, v34, v5
    v_sub_f32 v35, v35, v5
    v_sub_f32 v44, v44, v5
    v_sub_f32 v45, v45, v5
    v_exp_f32 v32, v32
    v_exp_f32 v33, v33
    v_exp_f32 v34, v34
    v_exp_f32 v35, v35
    v_exp_f32 v44, v44
    v_exp_f32 v45, v45
    v_cvt_pk_bf16_f32 v24, v32, v33
    v_cvt_pk_bf16_f32 v25, v34, v35
    v_mov_b32 v26, 0
    v_mov_b32 v27, 0
    v_cvt_pk_bf16_f32 v20, v44, v45
    v_cvt_pk_bf16_f32 v23, v44, v45
    v_mfma_f32_16x16x32_bf16 v[28:31], v[16:19], v[24:27], 0
    v_mfma_f32_16x16x32_bf16 v[76:79], a[64:67], v[24:27], 0
    v_mfma_f32_16x16x32_bf16 v[80:83], a[68:71], v[24:27], 0
    s_add_u32 s46, s51, 4096
    buffer_load_dwordx4 v[156:159], v0, s[28:31], s46 offen offset:0
    v_mfma_f32_16x16x32_bf16 v[84:87], a[72:75], v[24:27], 0
    v_mfma_f32_16x16x32_bf16 v[88:91], a[76:79], v[24:27], 0
    buffer_load_dwordx4 v[160:163], v0, s[28:31], s46 offen offset:1024
    v_mfma_f32_16x16x32_bf16 v[92:95], a[80:83], v[24:27], 0
    v_mfma_f32_16x16x32_bf16 v[96:99], a[84:87], v[24:27], 0
    buffer_load_dwordx4 v[164:167], v0, s[28:31], s46 offen offset:2048
    v_mfma_f32_16x16x16_bf16 v[28:31], v[16:17], v[20:21], v[28:31]
    v_mfma_f32_16x16x32_bf16 v[100:103], a[88:91], v[24:27], 0
    v_mfma_f32_16x16x32_bf16 v[104:107], a[92:95], v[24:27], 0
    buffer_load_dwordx4 v[168:171], v0, s[28:31], s46 offen offset:3072
    v_mfma_f32_16x16x16_bf16 v[76:79], v[68:69], v[20:21], v[76:79]
    v_mfma_f32_16x16x16_bf16 v[80:83], v[68:69], v[22:23], v[80:83]
    s_nop 2
    v_rcp_f32 v6, v28
    v_mfma_f32_16x16x16_bf16 v[84:87], v[70:71], v[20:21], v[84:87]
    v_mfma_f32_16x16x16_bf16 v[88:91], v[70:71], v[22:23], v[88:91]
    s_nop 0
    v_mul_f32 v76, v6, v76
    v_mul_f32 v80, v6, v80
    v_cvt_pk_bf16_f32 v108, v76, v80
    v_mul_f32 v77, v6, v77
    v_mul_f32 v81, v6, v81
    v_cvt_pk_bf16_f32 v109, v77, v81
    v_mul_f32 v78, v6, v78
    v_mul_f32 v82, v6, v82
    v_cvt_pk_bf16_f32 v110, v78, v82
    v_mul_f32 v79, v6, v79
    v_mul_f32 v83, v6, v83
    v_cvt_pk_bf16_f32 v111, v79, v83
    s_add_u32 s17, s48, 0
    buffer_store_dwordx4 v[108:111], v0, s[8:11], s17 offen offset:0
    s_add_u32 s46, s51, 16777216
    buffer_load_dwordx4 v[172:175], v0, s[28:31], s46 offen offset:0
    v_mfma_f32_16x16x16_bf16 v[92:95], v[72:73], v[20:21], v[92:95]
    v_mfma_f32_16x16x16_bf16 v[96:99], v[72:73], v[22:23], v[96:99]
    v_mul_f32 v84, v6, v84
    v_mul_f32 v88, v6, v88
    v_cvt_pk_bf16_f32 v112, v84, v88
    v_mul_f32 v85, v6, v85
    v_mul_f32 v89, v6, v89
    v_cvt_pk_bf16_f32 v113, v85, v89
    v_mul_f32 v86, v6, v86
    v_mul_f32 v90, v6, v90
    v_cvt_pk_bf16_f32 v114, v86, v90
    v_mul_f32 v87, v6, v87
    v_mul_f32 v91, v6, v91
    v_cvt_pk_bf16_f32 v115, v87, v91
    buffer_store_dwordx4 v[112:115], v0, s[8:11], s17 offen offset:2048
    buffer_load_dwordx4 v[176:179], v0, s[28:31], s46 offen offset:1024
    v_mfma_f32_16x16x16_bf16 v[100:103], v[74:75], v[20:21], v[100:103]
    v_mfma_f32_16x16x16_bf16 v[104:107], v[74:75], v[22:23], v[104:107]
    v_mul_f32 v92, v6, v92
    v_mul_f32 v96, v6, v96
    v_cvt_pk_bf16_f32 v116, v92, v96
    v_mul_f32 v93, v6, v93
    v_mul_f32 v97, v6, v97
    v_cvt_pk_bf16_f32 v117, v93, v97
    v_mul_f32 v94, v6, v94
    v_mul_f32 v98, v6, v98
    v_cvt_pk_bf16_f32 v118, v94, v98
    v_mul_f32 v95, v6, v95
    v_mul_f32 v99, v6, v99
    v_cvt_pk_bf16_f32 v119, v95, v99
    s_add_u32 s17, s48, 4096
    buffer_store_dwordx4 v[116:119], v0, s[8:11], s17 offen offset:0
    buffer_load_dwordx4 v[180:183], v0, s[28:31], s46 offen offset:2048
    v_mul_f32 v100, v6, v100
    v_mul_f32 v104, v6, v104
    v_cvt_pk_bf16_f32 v120, v100, v104
    v_mul_f32 v101, v6, v101
    v_mul_f32 v105, v6, v105
    v_cvt_pk_bf16_f32 v121, v101, v105
    v_mul_f32 v102, v6, v102
    v_mul_f32 v106, v6, v106
    v_cvt_pk_bf16_f32 v122, v102, v106
    v_mul_f32 v103, v6, v103
    v_mul_f32 v107, v6, v107
    v_cvt_pk_bf16_f32 v123, v103, v107
    buffer_store_dwordx4 v[120:123], v0, s[8:11], s17 offen offset:2048
    buffer_load_dwordx4 v[184:187], v0, s[28:31], s46 offen offset:3072
    v_max3_f32 v5, v36, v37, v38
    v_max_f32 v5, v5, v39
    v_max3_f32 v5, v5, v40, v41
    v_max3_f32 v5, v5, v42, v43
    v_mul_f32 v48, s52, v48
    v_mul_f32 v49, s52, v49
    v_max3_f32 v5, v5, v48, v49
    v_mov_b32 v6, v5
    s_add_u32 s46, s51, 16781312
    buffer_load_dwordx4 v[188:191], v0, s[28:31], s46 offen offset:0
    v_permlane32_swap_b32 v5, v6
    v_max_f32 v5, v5, v6
    v_mov_b32 v6, v5
    buffer_load_dwordx4 v[192:195], v0, s[28:31], s46 offen offset:1024
    s_nop 0
    v_permlane16_swap_b32 v5, v6
    v_max_f32 v5, v5, v6
    v_sub_f32 v36, v36, v5
    v_sub_f32 v37, v37, v5
    v_sub_f32 v38, v38, v5
    v_sub_f32 v39, v39, v5
    v_sub_f32 v40, v40, v5
    v_sub_f32 v41, v41, v5
    v_sub_f32 v42, v42, v5
    v_sub_f32 v43, v43, v5
    v_sub_f32 v48, v48, v5
    v_sub_f32 v49, v49, v5
    v_exp_f32 v36, v36
    v_exp_f32 v37, v37
    v_exp_f32 v38, v38
    v_exp_f32 v39, v39
    v_exp_f32 v40, v40
    v_exp_f32 v41, v41
    v_exp_f32 v42, v42
    v_exp_f32 v43, v43
    v_exp_f32 v48, v48
    v_exp_f32 v49, v49
    v_cvt_pk_bf16_f32 v24, v36, v37
    v_cvt_pk_bf16_f32 v25, v38, v39
    v_cvt_pk_bf16_f32 v26, v40, v41
    v_cvt_pk_bf16_f32 v27, v42, v43
    v_cvt_pk_bf16_f32 v20, v48, v49
    v_cvt_pk_bf16_f32 v23, v48, v49
    v_mfma_f32_16x16x32_bf16 v[28:31], v[16:19], v[24:27], 0
    v_mfma_f32_16x16x32_bf16 v[76:79], a[64:67], v[24:27], 0
    v_mfma_f32_16x16x32_bf16 v[80:83], a[68:71], v[24:27], 0
    buffer_load_dwordx4 v[196:199], v0, s[28:31], s46 offen offset:2048
    v_mfma_f32_16x16x32_bf16 v[84:87], a[72:75], v[24:27], 0
    v_mfma_f32_16x16x32_bf16 v[88:91], a[76:79], v[24:27], 0
    buffer_load_dwordx4 v[200:203], v0, s[28:31], s46 offen offset:3072
    v_mfma_f32_16x16x32_bf16 v[92:95], a[80:83], v[24:27], 0
    v_mfma_f32_16x16x32_bf16 v[96:99], a[84:87], v[24:27], 0
    s_add_u32 s46, s51, 33554432
    buffer_load_dwordx4 v[204:207], v0, s[28:31], s46 offen offset:0
    v_mfma_f32_16x16x16_bf16 v[28:31], v[16:17], v[20:21], v[28:31]
    v_mfma_f32_16x16x32_bf16 v[100:103], a[88:91], v[24:27], 0
    v_mfma_f32_16x16x32_bf16 v[104:107], a[92:95], v[24:27], 0
    buffer_load_dwordx4 v[208:211], v0, s[28:31], s46 offen offset:1024
    v_mfma_f32_16x16x16_bf16 v[76:79], v[68:69], v[20:21], v[76:79]
    v_mfma_f32_16x16x16_bf16 v[80:83], v[68:69], v[22:23], v[80:83]
    s_nop 2
    v_rcp_f32 v6, v28
    v_mfma_f32_16x16x16_bf16 v[84:87], v[70:71], v[20:21], v[84:87]
    v_mfma_f32_16x16x16_bf16 v[88:91], v[70:71], v[22:23], v[88:91]
    s_nop 0
    v_mul_f32 v76, v6, v76
    v_mul_f32 v80, v6, v80
    v_cvt_pk_bf16_f32 v124, v76, v80
    v_mul_f32 v77, v6, v77
    v_mul_f32 v81, v6, v81
    v_cvt_pk_bf16_f32 v125, v77, v81
    v_mul_f32 v78, v6, v78
    v_mul_f32 v82, v6, v82
    v_cvt_pk_bf16_f32 v126, v78, v82
    v_mul_f32 v79, v6, v79
    v_mul_f32 v83, v6, v83
    v_cvt_pk_bf16_f32 v127, v79, v83
    s_add_u32 s17, s48, 0
    buffer_store_dwordx4 v[124:127], v0, s[8:11], s17 offen offset:1024
    buffer_load_dwordx4 v[212:215], v0, s[28:31], s46 offen offset:2048
    v_mfma_f32_16x16x16_bf16 v[92:95], v[72:73], v[20:21], v[92:95]
    v_mfma_f32_16x16x16_bf16 v[96:99], v[72:73], v[22:23], v[96:99]
    v_mul_f32 v84, v6, v84
    v_mul_f32 v88, v6, v88
    v_cvt_pk_bf16_f32 v128, v84, v88
    v_mul_f32 v85, v6, v85
    v_mul_f32 v89, v6, v89
    v_cvt_pk_bf16_f32 v129, v85, v89
    v_mul_f32 v86, v6, v86
    v_mul_f32 v90, v6, v90
    v_cvt_pk_bf16_f32 v130, v86, v90
    v_mul_f32 v87, v6, v87
    v_mul_f32 v91, v6, v91
    v_cvt_pk_bf16_f32 v131, v87, v91
    buffer_store_dwordx4 v[128:131], v0, s[8:11], s17 offen offset:3072
    buffer_load_dwordx4 v[216:219], v0, s[28:31], s46 offen offset:3072
    v_mfma_f32_16x16x16_bf16 v[100:103], v[74:75], v[20:21], v[100:103]
    v_mfma_f32_16x16x16_bf16 v[104:107], v[74:75], v[22:23], v[104:107]
    v_mul_f32 v92, v6, v92
    v_mul_f32 v96, v6, v96
    v_cvt_pk_bf16_f32 v132, v92, v96
    v_mul_f32 v93, v6, v93
    v_mul_f32 v97, v6, v97
    v_cvt_pk_bf16_f32 v133, v93, v97
    v_mul_f32 v94, v6, v94
    v_mul_f32 v98, v6, v98
    v_cvt_pk_bf16_f32 v134, v94, v98
    v_mul_f32 v95, v6, v95
    v_mul_f32 v99, v6, v99
    v_cvt_pk_bf16_f32 v135, v95, v99
    s_add_u32 s17, s48, 4096
    buffer_store_dwordx4 v[132:135], v0, s[8:11], s17 offen offset:1024
    s_add_u32 s46, s51, 33558528
    buffer_load_dwordx4 v[220:223], v0, s[28:31], s46 offen offset:0
    v_mul_f32 v100, v6, v100
    v_mul_f32 v104, v6, v104
    v_cvt_pk_bf16_f32 v136, v100, v104
    v_mul_f32 v101, v6, v101
    v_mul_f32 v105, v6, v105
    v_cvt_pk_bf16_f32 v137, v101, v105
    v_mul_f32 v102, v6, v102
    v_mul_f32 v106, v6, v106
    v_cvt_pk_bf16_f32 v138, v102, v106
    v_mul_f32 v103, v6, v103
    v_mul_f32 v107, v6, v107
    v_cvt_pk_bf16_f32 v139, v103, v107
    buffer_store_dwordx4 v[136:139], v0, s[8:11], s17 offen offset:3072
    buffer_load_dwordx4 v[224:227], v0, s[28:31], s46 offen offset:1024
    buffer_load_dwordx4 v[228:231], v0, s[28:31], s46 offen offset:2048
    buffer_load_dwordx4 v[232:235], v0, s[28:31], s46 offen offset:3072
    s_add_u32 s48, s48, 262144
    s_mov_b32 s49, 22528
    s_mov_b32 s66, -1
    s_cmp_ge_u32 s37, 64
    s_cbranch_scc1 LtaF_end
    s_branch LtaF0
LtaF_end:
    s_waitcnt vmcnt(0)
    s_and_b32 s17, s49, s66
    s_cselect_b64 exec, 1, 0
    buffer_store_dword v3, v4, s[8:11], s43 offen
    s_andn2_b32 s17, s49, s66
    s_cselect_b64 exec, 1, 0
    buffer_store_dword v3, v4, s[8:11], s43 offen sc1
    s_mov_b64 exec, -1
    s_add_u32 s43, s43, s49
    s_mov_b32 s49, 0
    s_branch L_role_ta_exit
LtaS0:
    s_sub_u32 s17, s37, 33
    s_mul_i32 s18, s17, 43
    s_lshr_b32 s18, s18, 7
    s_mul_i32 s18, s18, 3
    s_cmp_eq_u32 s18, s17
    s_cselect_b32 s18, 1, 0
    s_cmp_lt_u32 s37, 34
    s_cselect_b32 s18, 1, s18
    s_cmp_eq_u32 s36, 0
    s_cselect_b32 s18, 1, s18
    s_and_b32 s18, s18, s61
    s_cbranch_scc1 LtaF0_in
LtaS0_in:
    s_and_b32 s17, s37, 7
    s_mul_i32 s17, s17, 131072
    s_add_u32 s47, s35, s17
    s_bfe_u32 s34, s37, 65539
    s_cmp_eq_u32 s39, 1
    s_cbranch_scc1 LtaS0_have
    s_waitcnt vmcnt(0)
    s_and_b32 s17, s49, s66
    s_cselect_b64 exec, 1, 0
    buffer_store_dword v3, v4, s[8:11], s43 offen
    s_andn2_b32 s17, s49, s66
    s_cselect_b64 exec, 1, 0
    buffer_store_dword v3, v4, s[8:11], s43 offen sc1
    s_mov_b64 exec, -1
    s_add_u32 s43, s43, s49
    s_mov_b32 s49, 0
    s_mov_b32 s16, 0
LtaS0_f_6:
    buffer_load_dword v2, v1, s[8:11], s42 offen sc1
    s_add_u32 s16, s16, 1
    s_cmp_gt_u32 s16, 100000
    s_cbranch_scc1 L_role_ta_abort
    s_waitcnt vmcnt(0)
    v_cmp_eq_u32 vcc, 0, v2
    s_nop 0
    s_cbranch_vccz LtaS0_fd_7
    s_sleep 4
    s_branch LtaS0_f_6
LtaS0_fd_7:
    s_add_u32 s46, s51, 0
    buffer_load_dwordx4 v[140:143], v0, s[8:11], s46 offen offset:0
    buffer_load_dwordx4 v[144:147], v0, s[8:11], s46 offen offset:1024
    buffer_load_dwordx4 v[148:151], v0, s[8:11], s46 offen offset:2048
    buffer_load_dwordx4 v[152:155], v0, s[8:11], s46 offen offset:3072
    s_add_u32 s46, s51, 4096
    buffer_load_dwordx4 v[156:159], v0, s[8:11], s46 offen offset:0
    buffer_load_dwordx4 v[160:163], v0, s[8:11], s46 offen offset:1024
    buffer_load_dwordx4 v[164:167], v0, s[8:11], s46 offen offset:2048
    buffer_load_dwordx4 v[168:171], v0, s[8:11], s46 offen offset:3072
    s_add_u32 s46, s51, 16777216
    buffer_load_dwordx4 v[172:175], v0, s[8:11], s46 offen offset:0
    buffer_load_dwordx4 v[176:179], v0, s[8:11], s46 offen offset:1024
    buffer_load_dwordx4 v[180:183], v0, s[8:11], s46 offen offset:2048
    buffer_load_dwordx4 v[184:187], v0, s[8:11], s46 offen offset:3072
    s_add_u32 s46, s51, 16781312
    buffer_load_dwordx4 v[188:191], v0, s[8:11], s46 offen offset:0
    buffer_load_dwordx4 v[192:195], v0, s[8:11], s46 offen offset:1024
    buffer_load_dwordx4 v[196:199], v0, s[8:11], s46 offen offset:2048
    buffer_load_dwordx4 v[200:203], v0, s[8:11], s46 offen offset:3072
    s_add_u32 s46, s51, 33554432
    buffer_load_dwordx4 v[204:207], v0, s[8:11], s46 offen offset:0
    buffer_load_dwordx4 v[208:211], v0, s[8:11], s46 offen offset:1024
    buffer_load_dwordx4 v[212:215], v0, s[8:11], s46 offen offset:2048
    buffer_load_dwordx4 v[216:219], v0, s[8:11], s46 offen offset:3072
    s_add_u32 s46, s51, 33558528
    buffer_load_dwordx4 v[220:223], v0, s[8:11], s46 offen offset:0
    buffer_load_dwordx4 v[224:227], v0, s[8:11], s46 offen offset:1024
    buffer_load_dwordx4 v[228:231], v0, s[8:11], s46 offen offset:2048
    buffer_load_dwordx4 v[232:235], v0, s[8:11], s46 offen offset:3072
LtaS0_have:
    s_add_u32 s17, s42, 22528
    buffer_load_dword v15, v1, s[8:11], s17 offen sc1
    buffer_load_dwordx4 v[52:55], v9, s[8:11], s47 offen offset:0 sc1
    buffer_load_dwordx4 v[56:59], v9, s[8:11], s47 offen offset:64 sc1
    buffer_load_dwordx4 v[60:63], v9, s[8:11], s47 offen offset:128 sc1
    buffer_load_dwordx4 v[64:67], v9, s[8:11], s47 offen offset:192 sc1
    buffer_load_dwordx2 v[68:69], v10, s[8:11], s47 offen offset:2048 sc1
    buffer_load_dwordx2 v[70:71], v10, s[8:11], s47 offen offset:2560 sc1
    buffer_load_dwordx2 v[72:73], v10, s[8:11], s47 offen offset:3072 sc1
    buffer_load_dwordx2 v[74:75], v10, s[8:11], s47 offen offset:3584 sc1
    s_waitcnt vmcnt(9)
    s_and_b32 s17, s49, s66
    s_cselect_b64 exec, 1, 0
    buffer_store_dword v3, v4, s[8:11], s43 offen
    s_andn2_b32 s17, s49, s66
    s_cselect_b64 exec, 1, 0
    buffer_store_dword v3, v4, s[8:11], s43 offen sc1
    s_mov_b64 exec, -1
    s_add_u32 s43, s43, s49
    s_mov_b32 s49, 0
    v_mfma_f32_16x16x32_bf16 v[32:35], v[172:175], v[140:143], 0
    v_mfma_f32_16x16x32_bf16 v[36:39], v[172:175], v[144:147], 0
    v_mfma_f32_16x16x32_bf16 v[40:43], v[176:179], v[144:147], 0
    v_mfma_f32_16x16x32_bf16 v[32:35], v[180:183], v[148:151], v[32:35]
    v_mfma_f32_16x16x32_bf16 v[36:39], v[180:183], v[152:155], v[36:39]
    v_mfma_f32_16x16x32_bf16 v[40:43], v[184:187], v[152:155], v[40:43]
    v_mfma_f32_16x16x32_bf16 v[32:35], v[188:191], v[156:159], v[32:35]
    v_mfma_f32_16x16x32_bf16 v[36:39], v[188:191], v[160:163], v[36:39]
    v_mfma_f32_16x16x32_bf16 v[40:43], v[192:195], v[160:163], v[40:43]
    v_mfma_f32_16x16x32_bf16 v[32:35], v[196:199], v[164:167], v[32:35]
    v_mfma_f32_16x16x32_bf16 v[36:39], v[196:199], v[168:171], v[36:39]
    v_mfma_f32_16x16x32_bf16 v[40:43], v[200:203], v[168:171], v[40:43]
    s_waitcnt vmcnt(2)
    v_cmp_eq_u32 vcc, 0, v15
    s_add_u32 s51, s51, 262144
    s_add_u32 s42, s42, 22528
    s_add_u32 s37, s37, 1
    s_cmp_eq_u64 vcc, 0
    s_cselect_b32 s39, 1, 0
    s_cmp_lt_u32 s37, 64
    s_cselect_b32 s39, s39, 0
    s_cmp_eq_u32 s39, 1
    s_cselect_b32 s30, 268435456, 0
    v_fma_f32 v32, v32, s52, v236
    v_fma_f32 v33, v33, s52, v237
    v_fma_f32 v34, v34, s52, v238
    v_fma_f32 v35, v35, s52, v239
    v_mul_f32 v36, s52, v36
    v_mul_f32 v37, s52, v37
    v_mul_f32 v38, s52, v38
    v_mul_f32 v39, s52, v39
    v_fma_f32 v40, v40, s52, v236
    v_fma_f32 v41, v41, s52, v237
    v_fma_f32 v42, v42, s52, v238
    v_fma_f32 v43, v43, s52, v239
    v_xor_b32 v5, s34, v52
    v_xor_b32 v6, s34, v56
    v_or_b32 v5, v5, v6
    v_xor_b32 v6, s34, v60
    v_or_b32 v5, v5, v6
    v_xor_b32 v6, s34, v64
    v_or_b32 v5, v5, v6
    v_xor_b32 v6, s34, v68
    v_or_b32 v5, v5, v6
    v_xor_b32 v6, s34, v70
    v_or_b32 v5, v5, v6
    v_xor_b32 v6, s34, v72
    v_or_b32 v5, v5, v6
    v_xor_b32 v6, s34, v74
    v_or_b32 v5, v5, v6
    v_and_b32 v5, 1, v5
    v_cmp_ne_u32 vcc, 0, v5
    s_nop 0
    s_cbranch_vccz LtaS0_r
    s_mov_b32 s16, 0
LtaS0_rp:
    buffer_load_dwordx4 v[52:55], v9, s[8:11], s47 offen offset:0 sc1
    buffer_load_dwordx4 v[56:59], v9, s[8:11], s47 offen offset:64 sc1
    buffer_load_dwordx4 v[60:63], v9, s[8:11], s47 offen offset:128 sc1
    buffer_load_dwordx4 v[64:67], v9, s[8:11], s47 offen offset:192 sc1
    buffer_load_dwordx2 v[68:69], v10, s[8:11], s47 offen offset:2048 sc1
    buffer_load_dwordx2 v[70:71], v10, s[8:11], s47 offen offset:2560 sc1
    buffer_load_dwordx2 v[72:73], v10, s[8:11], s47 offen offset:3072 sc1
    buffer_load_dwordx2 v[74:75], v10, s[8:11], s47 offen offset:3584 sc1
    s_add_u32 s16, s16, 1
    s_cmp_gt_u32 s16, 100000
    s_cbranch_scc1 L_role_ta_abort
    s_waitcnt vmcnt(0)
    v_xor_b32 v5, s34, v52
    v_xor_b32 v6, s34, v56
    v_or_b32 v5, v5, v6
    v_xor_b32 v6, s34, v60
    v_or_b32 v5, v5, v6
    v_xor_b32 v6, s34, v64
    v_or_b32 v5, v5, v6
    v_xor_b32 v6, s34, v68
    v_or_b32 v5, v5, v6
    v_xor_b32 v6, s34, v70
    v_or_b32 v5, v5, v6
    v_xor_b32 v6, s34, v72
    v_or_b32 v5, v5, v6
    v_xor_b32 v6, s34, v74
    v_or_b32 v5, v5, v6
    v_and_b32 v5, 1, v5
    v_cmp_ne_u32 vcc, 0, v5
    s_nop 0
    s_cbranch_vccz LtaS0_r
    s_sleep 2
    s_branch LtaS0_rp
LtaS0_r:
    s_and_b32 s17, s37, 3
    s_cmp_eq_u32 s17, 0
    s_cselect_b32 s17, s36, 0
    s_cmp_lg_u32 s17, 0
    s_cselect_b64 exec, 1, 0
    s_sub_u32 s17, s42, 22528
    buffer_store_dword v3, v4, s[8:11], s17 offen offset:384 sc1
    s_mov_b64 exec, -1
    s_add_u32 s46, s51, 0
    buffer_load_dwordx4 a[0:3], v0, s[28:31], s46 offen offset:0
    buffer_load_dwordx4 a[4:7], v0, s[28:31], s46 offen offset:1024
    v_mfma_f32_16x16x32_bf16 v[44:47], v[52:55], v[140:143], 0
    v_mfma_f32_16x16x32_bf16 v[48:51], v[52:55], v[144:147], 0
    v_mfma_f32_16x16x32_bf16 v[44:47], v[56:59], v[148:151], v[44:47]
    v_mfma_f32_16x16x32_bf16 v[48:51], v[56:59], v[152:155], v[48:51]
    v_mfma_f32_16x16x32_bf16 v[44:47], v[60:63], v[156:159], v[44:47]
    v_mfma_f32_16x16x32_bf16 v[48:51], v[60:63], v[160:163], v[48:51]
    v_mfma_f32_16x16x32_bf16 v[44:47], v[64:67], v[164:167], v[44:47]
    v_mfma_f32_16x16x32_bf16 v[48:51], v[64:67], v[168:171], v[48:51]
    v_max3_f32 v5, v32, v33, v34
    v_max_f32 v5, v5, v35
    s_nop 4
    v_mul_f32 v44, s52, v44
    v_mul_f32 v45, s52, v45
    v_max3_f32 v5, v5, v44, v45
    v_mov_b32 v6, v5
    buffer_load_dwordx4 a[8:11], v0, s[28:31], s46 offen offset:2048
    s_nop 0
    v_permlane32_swap_b32 v5, v6
    v_max_f32 v5, v5, v6
    v_mov_b32 v6, v5
    buffer_load_dwordx4 a[12:15], v0, s[28:31], s46 offen offset:3072
    s_nop 0
    v_permlane16_swap_b32 v5, v6
    v_max_f32 v5, v5, v6
    v_sub_f32 v32, v32, v5
    v_sub_f32 v33, v33, v5
    v_sub_f32 v34, v34, v5
    v_sub_f32 v35, v35, v5
    v_sub_f32 v44, v44, v5
    v_sub_f32 v45, v45, v5
    v_exp_f32 v32, v32
    v_exp_f32 v33, v33
    v_exp_f32 v34, v34
    v_exp_f32 v35, v35
    v_exp_f32 v44, v44
    v_exp_f32 v45, v45
    v_cvt_pk_bf16_f32 v24, v32, v33
    v_cvt_pk_bf16_f32 v25, v34, v35
    v_mov_b32 v26, 0
    v_mov_b32 v27, 0
    v_cvt_pk_bf16_f32 v20, v44, v45
    v_cvt_pk_bf16_f32 v23, v44, v45
    v_mfma_f32_16x16x32_bf16 v[28:31], v[16:19], v[24:27], 0
    v_mfma_f32_16x16x32_bf16 v[76:79], v[204:207], v[24:27], 0
    v_mfma_f32_16x16x32_bf16 v[80:83], v[208:211], v[24:27], 0
    s_add_u32 s46, s51, 4096
    buffer_load_dwordx4 a[16:19], v0, s[28:31], s46 offen offset:0
    v_mfma_f32_16x16x32_bf16 v[84:87], v[212:215], v[24:27], 0
    v_mfma_f32_16x16x32_bf16 v[88:91], v[216:219], v[24:27], 0
    buffer_load_dwordx4 a[20:23], v0, s[28:31], s46 offen offset:1024
    v_mfma_f32_16x16x32_bf16 v[92:95], v[220:223], v[24:27], 0
    v_mfma_f32_16x16x32_bf16 v[96:99], v[224:227], v[24:27], 0
    buffer_load_dwordx4 a[24:27], v0, s[28:31], s46 offen offset:2048
    v_mfma_f32_16x16x16_bf16 v[28:31], v[16:17], v[20:21], v[28:31]
    v_mfma_f32_16x16x32_bf16 v[100:103], v[228:231], v[24:27], 0
    v_mfma_f32_16x16x32_bf16 v[104:107], v[232:235], v[24:27], 0
    buffer_load_dwordx4 a[28:31], v0, s[28:31], s46 offen offset:3072
    v_mfma_f32_16x16x16_bf16 v[76:79], v[68:69], v[20:21], v[76:79]
    v_mfma_f32_16x16x16_bf16 v[80:83], v[68:69], v[22:23], v[80:83]
    s_nop 2
    v_rcp_f32 v6, v28
    v_mfma_f32_16x16x16_bf16 v[84:87], v[70:71], v[20:21], v[84:87]
    v_mfma_f32_16x16x16_bf16 v[88:91], v[70:71], v[22:23], v[88:91]
    s_nop 0
    v_mul_f32 v76, v6, v76
    v_mul_f32 v80, v6, v80
    v_cvt_pk_bf16_f32 v108, v76, v80
    v_mul_f32 v77, v6, v77
    v_mul_f32 v81, v6, v81
    v_cvt_pk_bf16_f32 v109, v77, v81
    v_mul_f32 v78, v6, v78
    v_mul_f32 v82, v6, v82
    v_cvt_pk_bf16_f32 v110, v78, v82
    v_mul_f32 v79, v6, v79
    v_mul_f32 v83, v6, v83
    v_cvt_pk_bf16_f32 v111, v79, v83
    s_add_u32 s17, s48, 0
    buffer_store_dwordx4 v[108:111], v0, s[8:11], s17 offen offset:0 sc1
    s_add_u32 s46, s51, 16777216
    buffer_load_dwordx4 a[32:35], v0, s[28:31], s46 offen offset:0
    v_mfma_f32_16x16x16_bf16 v[92:95], v[72:73], v[20:21], v[92:95]
    v_mfma_f32_16x16x16_bf16 v[96:99], v[72:73], v[22:23], v[96:99]
    v_mul_f32 v84, v6, v84
    v_mul_f32 v88, v6, v88
    v_cvt_pk_bf16_f32 v112, v84, v88
    v_mul_f32 v85, v6, v85
    v_mul_f32 v89, v6, v89
    v_cvt_pk_bf16_f32 v113, v85, v89
    v_mul_f32 v86, v6, v86
    v_mul_f32 v90, v6, v90
    v_cvt_pk_bf16_f32 v114, v86, v90
    v_mul_f32 v87, v6, v87
    v_mul_f32 v91, v6, v91
    v_cvt_pk_bf16_f32 v115, v87, v91
    buffer_store_dwordx4 v[112:115], v0, s[8:11], s17 offen offset:2048 sc1
    buffer_load_dwordx4 a[36:39], v0, s[28:31], s46 offen offset:1024
    v_mfma_f32_16x16x16_bf16 v[100:103], v[74:75], v[20:21], v[100:103]
    v_mfma_f32_16x16x16_bf16 v[104:107], v[74:75], v[22:23], v[104:107]
    v_mul_f32 v92, v6, v92
    v_mul_f32 v96, v6, v96
    v_cvt_pk_bf16_f32 v116, v92, v96
    v_mul_f32 v93, v6, v93
    v_mul_f32 v97, v6, v97
    v_cvt_pk_bf16_f32 v117, v93, v97
    v_mul_f32 v94, v6, v94
    v_mul_f32 v98, v6, v98
    v_cvt_pk_bf16_f32 v118, v94, v98
    v_mul_f32 v95, v6, v95
    v_mul_f32 v99, v6, v99
    v_cvt_pk_bf16_f32 v119, v95, v99
    s_add_u32 s17, s48, 4096
    buffer_store_dwordx4 v[116:119], v0, s[8:11], s17 offen offset:0 sc1
    buffer_load_dwordx4 a[40:43], v0, s[28:31], s46 offen offset:2048
    v_mul_f32 v100, v6, v100
    v_mul_f32 v104, v6, v104
    v_cvt_pk_bf16_f32 v120, v100, v104
    v_mul_f32 v101, v6, v101
    v_mul_f32 v105, v6, v105
    v_cvt_pk_bf16_f32 v121, v101, v105
    v_mul_f32 v102, v6, v102
    v_mul_f32 v106, v6, v106
    v_cvt_pk_bf16_f32 v122, v102, v106
    v_mul_f32 v103, v6, v103
    v_mul_f32 v107, v6, v107
    v_cvt_pk_bf16_f32 v123, v103, v107
    buffer_store_dwordx4 v[120:123], v0, s[8:11], s17 offen offset:2048 sc1
    buffer_load_dwordx4 a[44:47], v0, s[28:31], s46 offen offset:3072
    v_max3_f32 v5, v36, v37, v38
    v_max_f32 v5, v5, v39
    v_max3_f32 v5, v5, v40, v41
    v_max3_f32 v5, v5, v42, v43
    v_mul_f32 v48, s52, v48
    v_mul_f32 v49, s52, v49
    v_max3_f32 v5, v5, v48, v49
    v_mov_b32 v6, v5
    s_add_u32 s46, s51, 16781312
    buffer_load_dwordx4 a[48:51], v0, s[28:31], s46 offen offset:0
    v_permlane32_swap_b32 v5, v6
    v_max_f32 v5, v5, v6
    v_mov_b32 v6, v5
    buffer_load_dwordx4 a[52:55], v0, s[28:31], s46 offen offset:1024
    s_nop 0
    v_permlane16_swap_b32 v5, v6
    v_max_f32 v5, v5, v6
    v_sub_f32 v36, v36, v5
    v_sub_f32 v37, v37, v5
    v_sub_f32 v38, v38, v5
    v_sub_f32 v39, v39, v5
    v_sub_f32 v40, v40, v5
    v_sub_f32 v41, v41, v5
    v_sub_f32 v42, v42, v5
    v_sub_f32 v43, v43, v5
    v_sub_f32 v48, v48, v5
    v_sub_f32 v49, v49, v5
    v_exp_f32 v36, v36
    v_exp_f32 v37, v37
    v_exp_f32 v38, v38
    v_exp_f32 v39, v39
    v_exp_f32 v40, v40
    v_exp_f32 v41, v41
    v_exp_f32 v42, v42
    v_exp_f32 v43, v43
    v_exp_f32 v48, v48
    v_exp_f32 v49, v49
    v_cvt_pk_bf16_f32 v24, v36, v37
    v_cvt_pk_bf16_f32 v25, v38, v39
    v_cvt_pk_bf16_f32 v26, v40, v41
    v_cvt_pk_bf16_f32 v27, v42, v43
    v_cvt_pk_bf16_f32 v20, v48, v49
    v_cvt_pk_bf16_f32 v23, v48, v49
    v_mfma_f32_16x16x32_bf16 v[28:31], v[16:19], v[24:27], 0
    v_mfma_f32_16x16x32_bf16 v[76:79], v[204:207], v[24:27], 0
    v_mfma_f32_16x16x32_bf16 v[80:83], v[208:211], v[24:27], 0
    buffer_load_dwordx4 a[56:59], v0, s[28:31], s46 offen offset:2048
    v_mfma_f32_16x16x32_bf16 v[84:87], v[212:215], v[24:27], 0
    v_mfma_f32_16x16x32_bf16 v[88:91], v[216:219], v[24:27], 0
    buffer_load_dwordx4 a[60:63], v0, s[28:31], s46 offen offset:3072
    v_mfma_f32_16x16x32_bf16 v[92:95], v[220:223], v[24:27], 0
    v_mfma_f32_16x16x32_bf16 v[96:99], v[224:227], v[24:27], 0
    s_add_u32 s46, s51, 33554432
    buffer_load_dwordx4 a[64:67], v0, s[28:31], s46 offen offset:0
    v_mfma_f32_16x16x16_bf16 v[28:31], v[16:17], v[20:21], v[28:31]
    v_mfma_f32_16x16x32_bf16 v[100:103], v[228:231], v[24:27], 0
    v_mfma_f32_16x16x32_bf16 v[104:107], v[232:235], v[24:27], 0
    buffer_load_dwordx4 a[68:71], v0, s[28:31], s46 offen offset:1024
    v_mfma_f32_16x16x16_bf16 v[76:79], v[68:69], v[20:21], v[76:79]
    v_mfma_f32_16x16x16_bf16 v[80:83], v[68:69], v[22:23], v[80:83]
    s_nop 2
    v_rcp_f32 v6, v28
    v_mfma_f32_16x16x16_bf16 v[84:87], v[70:71], v[20:21], v[84:87]
    v_mfma_f32_16x16x16_bf16 v[88:91], v[70:71], v[22:23], v[88:91]
    s_nop 0
    v_mul_f32 v76, v6, v76
    v_mul_f32 v80, v6, v80
    v_cvt_pk_bf16_f32 v124, v76, v80
    v_mul_f32 v77, v6, v77
    v_mul_f32 v81, v6, v81
    v_cvt_pk_bf16_f32 v125, v77, v81
    v_mul_f32 v78, v6, v78
    v_mul_f32 v82, v6, v82
    v_cvt_pk_bf16_f32 v126, v78, v82
    v_mul_f32 v79, v6, v79
    v_mul_f32 v83, v6, v83
    v_cvt_pk_bf16_f32 v127, v79, v83
    s_add_u32 s17, s48, 0
    buffer_store_dwordx4 v[124:127], v0, s[8:11], s17 offen offset:1024 sc1
    buffer_load_dwordx4 a[72:75], v0, s[28:31], s46 offen offset:2048
    v_mfma_f32_16x16x16_bf16 v[92:95], v[72:73], v[20:21], v[92:95]
    v_mfma_f32_16x16x16_bf16 v[96:99], v[72:73], v[22:23], v[96:99]
    v_mul_f32 v84, v6, v84
    v_mul_f32 v88, v6, v88
    v_cvt_pk_bf16_f32 v128, v84, v88
    v_mul_f32 v85, v6, v85
    v_mul_f32 v89, v6, v89
    v_cvt_pk_bf16_f32 v129, v85, v89
    v_mul_f32 v86, v6, v86
    v_mul_f32 v90, v6, v90
    v_cvt_pk_bf16_f32 v130, v86, v90
    v_mul_f32 v87, v6, v87
    v_mul_f32 v91, v6, v91
    v_cvt_pk_bf16_f32 v131, v87, v91
    buffer_store_dwordx4 v[128:131], v0, s[8:11], s17 offen offset:3072 sc1
    buffer_load_dwordx4 a[76:79], v0, s[28:31], s46 offen offset:3072
    v_mfma_f32_16x16x16_bf16 v[100:103], v[74:75], v[20:21], v[100:103]
    v_mfma_f32_16x16x16_bf16 v[104:107], v[74:75], v[22:23], v[104:107]
    v_mul_f32 v92, v6, v92
    v_mul_f32 v96, v6, v96
    v_cvt_pk_bf16_f32 v132, v92, v96
    v_mul_f32 v93, v6, v93
    v_mul_f32 v97, v6, v97
    v_cvt_pk_bf16_f32 v133, v93, v97
    v_mul_f32 v94, v6, v94
    v_mul_f32 v98, v6, v98
    v_cvt_pk_bf16_f32 v134, v94, v98
    v_mul_f32 v95, v6, v95
    v_mul_f32 v99, v6, v99
    v_cvt_pk_bf16_f32 v135, v95, v99
    s_add_u32 s17, s48, 4096
    buffer_store_dwordx4 v[132:135], v0, s[8:11], s17 offen offset:1024 sc1
    s_add_u32 s46, s51, 33558528
    buffer_load_dwordx4 a[80:83], v0, s[28:31], s46 offen offset:0
    v_mul_f32 v100, v6, v100
    v_mul_f32 v104, v6, v104
    v_cvt_pk_bf16_f32 v136, v100, v104
    v_mul_f32 v101, v6, v101
    v_mul_f32 v105, v6, v105
    v_cvt_pk_bf16_f32 v137, v101, v105
    v_mul_f32 v102, v6, v102
    v_mul_f32 v106, v6, v106
    v_cvt_pk_bf16_f32 v138, v102, v106
    v_mul_f32 v103, v6, v103
    v_mul_f32 v107, v6, v107
    v_cvt_pk_bf16_f32 v139, v103, v107
    buffer_store_dwordx4 v[136:139], v0, s[8:11], s17 offen offset:3072 sc1
    buffer_load_dwordx4 a[84:87], v0, s[28:31], s46 offen offset:1024
    buffer_load_dwordx4 a[88:91], v0, s[28:31], s46 offen offset:2048
    buffer_load_dwordx4 a[92:95], v0, s[28:31], s46 offen offset:3072
    s_add_u32 s48, s48, 262144
    s_mov_b32 s49, 22528
    s_mov_b32 s66, 0
    s_cmp_ge_u32 s37, 64
    s_cbranch_scc1 LtaS_end
LtaS1:
    s_sub_u32 s17, s37, 33
    s_mul_i32 s18, s17, 43
    s_lshr_b32 s18, s18, 7
    s_mul_i32 s18, s18, 3
    s_cmp_eq_u32 s18, s17
    s_cselect_b32 s18, 1, 0
    s_cmp_lt_u32 s37, 34
    s_cselect_b32 s18, 1, s18
    s_cmp_eq_u32 s36, 0
    s_cselect_b32 s18, 1, s18
    s_and_b32 s18, s18, s61
    s_cbranch_scc1 LtaF1_in
LtaS1_in:
    s_and_b32 s17, s37, 7
    s_mul_i32 s17, s17, 131072
    s_add_u32 s47, s35, s17
    s_bfe_u32 s34, s37, 65539
    s_cmp_eq_u32 s39, 1
    s_cbranch_scc1 LtaS1_have
    s_waitcnt vmcnt(0)
    s_and_b32 s17, s49, s66
    s_cselect_b64 exec, 1, 0
    buffer_store_dword v3, v4, s[8:11], s43 offen
    s_andn2_b32 s17, s49, s66
    s_cselect_b64 exec, 1, 0
    buffer_store_dword v3, v4, s[8:11], s43 offen sc1
    s_mov_b64 exec, -1
    s_add_u32 s43, s43, s49
    s_mov_b32 s49, 0
    s_mov_b32 s16, 0
LtaS1_f_8:
    buffer_load_dword v2, v1, s[8:11], s42 offen sc1
    s_add_u32 s16, s16, 1
    s_cmp_gt_u32 s16, 100000
    s_cbranch_scc1 L_role_ta_abort
    s_waitcnt vmcnt(0)
    v_cmp_eq_u32 vcc, 0, v2
    s_nop 0
    s_cbranch_vccz LtaS1_fd_9
    s_sleep 4
    s_branch LtaS1_f_8
LtaS1_fd_9:
    s_add_u32 s46, s51, 0
    buffer_load_dwordx4 a[0:3], v0, s[8:11], s46 offen offset:0
    buffer_load_dwordx4 a[4:7], v0, s[8:11], s46 offen offset:1024
    buffer_load_dwordx4 a[8:11], v0, s[8:11], s46 offen offset:2048
    buffer_load_dwordx4 a[12:15], v0, s[8:11], s46 offen offset:3072
    s_add_u32 s46, s51, 4096
    buffer_load_dwordx4 a[16:19], v0, s[8:11], s46 offen offset:0
    buffer_load_dwordx4 a[20:23], v0, s[8:11], s46 offen offset:1024
    buffer_load_dwordx4 a[24:27], v0, s[8:11], s46 offen offset:2048
    buffer_load_dwordx4 a[28:31], v0, s[8:11], s46 offen offset:3072
    s_add_u32 s46, s51, 16777216
    buffer_load_dwordx4 a[32:35], v0, s[8:11], s46 offen offset:0
    buffer_load_dwordx4 a[36:39], v0, s[8:11], s46 offen offset:1024
    buffer_load_dwordx4 a[40:43], v0, s[8:11], s46 offen offset:2048
    buffer_load_dwordx4 a[44:47], v0, s[8:11], s46 offen offset:3072
    s_add_u32 s46, s51, 16781312
    buffer_load_dwordx4 a[48:51], v0, s[8:11], s46 offen offset:0
    buffer_load_dwordx4 a[52:55], v0, s[8:11], s46 offen offset:1024
    buffer_load_dwordx4 a[56:59], v0, s[8:11], s46 offen offset:2048
    buffer_load_dwordx4 a[60:63], v0, s[8:11], s46 offen offset:3072
    s_add_u32 s46, s51, 33554432
    buffer_load_dwordx4 a[64:67], v0, s[8:11], s46 offen offset:0
    buffer_load_dwordx4 a[68:71], v0, s[8:11], s46 offen offset:1024
    buffer_load_dwordx4 a[72:75], v0, s[8:11], s46 offen offset:2048
    buffer_load_dwordx4 a[76:79], v0, s[8:11], s46 offen offset:3072
    s_add_u32 s46, s51, 33558528
    buffer_load_dwordx4 a[80:83], v0, s[8:11], s46 offen offset:0
    buffer_load_dwordx4 a[84:87], v0, s[8:11], s46 offen offset:1024
    buffer_load_dwordx4 a[88:91], v0, s[8:11], s46 offen offset:2048
    buffer_load_dwordx4 a[92:95], v0, s[8:11], s46 offen offset:3072
LtaS1_have:
    s_add_u32 s17, s42, 22528
    buffer_load_dword v15, v1, s[8:11], s17 offen sc1
    buffer_load_dwordx4 v[52:55], v9, s[8:11], s47 offen offset:0 sc1
    buffer_load_dwordx4 v[56:59], v9, s[8:11], s47 offen offset:64 sc1
    buffer_load_dwordx4 v[60:63], v9, s[8:11], s47 offen offset:128 sc1
    buffer_load_dwordx4 v[64:67], v9, s[8:11], s47 offen offset:192 sc1
    buffer_load_dwordx2 v[68:69], v10, s[8:11], s47 offen offset:2048 sc1
    buffer_load_dwordx2 v[70:71], v10, s[8:11], s47 offen offset:2560 sc1
    buffer_load_dwordx2 v[72:73], v10, s[8:11], s47 offen offset:3072 sc1
    buffer_load_dwordx2 v[74:75], v10, s[8:11], s47 offen offset:3584 sc1
    s_waitcnt vmcnt(9)
    s_and_b32 s17, s49, s66
    s_cselect_b64 exec, 1, 0
    buffer_store_dword v3, v4, s[8:11], s43 offen
    s_andn2_b32 s17, s49, s66
    s_cselect_b64 exec, 1, 0
    buffer_store_dword v3, v4, s[8:11], s43 offen sc1
    s_mov_b64 exec, -1
    s_add_u32 s43, s43, s49
    s_mov_b32 s49, 0
    v_mfma_f32_16x16x32_bf16 v[32:35], a[32:35], a[0:3], 0
    v_mfma_f32_16x16x32_bf16 v[36:39], a[32:35], a[4:7], 0
    v_mfma_f32_16x16x32_bf16 v[40:43], a[36:39], a[4:7], 0
    v_mfma_f32_16x16x32_bf16 v[32:35], a[40:43], a[8:11], v[32:35]
    v_mfma_f32_16x16x32_bf16 v[36:39], a[40:43], a[12:15], v[36:39]
    v_mfma_f32_16x16x32_bf16 v[40:43], a[44:47], a[12:15], v[40:43]
    v_mfma_f32_16x16x32_bf16 v[32:35], a[48:51], a[16:19], v[32:35]
    v_mfma_f32_16x16x32_bf16 v[36:39], a[48:51], a[20:23], v[36:39]
    v_mfma_f32_16x16x32_bf16 v[40:43], a[52:55], a[20:23], v[40:43]
    v_mfma_f32_16x16x32_bf16 v[32:35], a[56:59], a[24:27], v[32:35]
    v_mfma_f32_16x16x32_bf16 v[36:39], a[56:59], a[28:31], v[36:39]
    v_mfma_f32_16x16x32_bf16 v[40:43], a[60:63], a[28:31], v[40:43]
    s_waitcnt vmcnt(2)
    v_cmp_eq_u32 vcc, 0, v15
    s_add_u32 s51, s51, 262144
    s_add_u32 s42, s42, 22528
    s_add_u32 s37, s37, 1
    s_cmp_eq_u64 vcc, 0
    s_cselect_b32 s39, 1, 0
    s_cmp_lt_u32 s37, 64
    s_cselect_b32 s39, s39, 0
    s_cmp_eq_u32 s39, 1
    s_cselect_b32 s30, 268435456, 0
    v_fma_f32 v32, v32, s52, v236
    v_fma_f32 v33, v33, s52, v237
    v_fma_f32 v34, v34, s52, v238
    v_fma_f32 v35, v35, s52, v239
    v_mul_f32 v36, s52, v36
    v_mul_f32 v37, s52, v37
    v_mul_f32 v38, s52, v38
    v_mul_f32 v39, s52, v39
    v_fma_f32 v40, v40, s52, v236
    v_fma_f32 v41, v41, s52, v237
    v_fma_f32 v42, v42, s52, v238
    v_fma_f32 v43, v43, s52, v239
    v_xor_b32 v5, s34, v52
    v_xor_b32 v6, s34, v56
    v_or_b32 v5, v5, v6
    v_xor_b32 v6, s34, v60
    v_or_b32 v5, v5, v6
    v_xor_b32 v6, s34, v64
    v_or_b32 v5, v5, v6
    v_xor_b32 v6, s34, v68
    v_or_b32 v5, v5, v6
    v_xor_b32 v6, s34, v70
    v_or_b32 v5, v5, v6
    v_xor_b32 v6, s34, v72
    v_or_b32 v5, v5, v6
    v_xor_b32 v6, s34, v74
    v_or_b32 v5, v5, v6
    v_and_b32 v5, 1, v5
    v_cmp_ne_u32 vcc, 0, v5
    s_nop 0
    s_cbranch_vccz LtaS1_r
    s_mov_b32 s16, 0
LtaS1_rp:
    buffer_load_dwordx4 v[52:55], v9, s[8:11], s47 offen offset:0 sc1
    buffer_load_dwordx4 v[56:59], v9, s[8:11], s47 offen offset:64 sc1
    buffer_load_dwordx4 v[60:63], v9, s[8:11], s47 offen offset:128 sc1
    buffer_load_dwordx4 v[64:67], v9, s[8:11], s47 offen offset:192 sc1
    buffer_load_dwordx2 v[68:69], v10, s[8:11], s47 offen offset:2048 sc1
    buffer_load_dwordx2 v[70:71], v10, s[8:11], s47 offen offset:2560 sc1
    buffer_load_dwordx2 v[72:73], v10, s[8:11], s47 offen offset:3072 sc1
    buffer_load_dwordx2 v[74:75], v10, s[8:11], s47 offen offset:3584 sc1
    s_add_u32 s16, s16, 1
    s_cmp_gt_u32 s16, 100000
    s_cbranch_scc1 L_role_ta_abort
    s_waitcnt vmcnt(0)
    v_xor_b32 v5, s34, v52
    v_xor_b32 v6, s34, v56
    v_or_b32 v5, v5, v6
    v_xor_b32 v6, s34, v60
    v_or_b32 v5, v5, v6
    v_xor_b32 v6, s34, v64
    v_or_b32 v5, v5, v6
    v_xor_b32 v6, s34, v68
    v_or_b32 v5, v5, v6
    v_xor_b32 v6, s34, v70
    v_or_b32 v5, v5, v6
    v_xor_b32 v6, s34, v72
    v_or_b32 v5, v5, v6
    v_xor_b32 v6, s34, v74
    v_or_b32 v5, v5, v6
    v_and_b32 v5, 1, v5
    v_cmp_ne_u32 vcc, 0, v5
    s_nop 0
    s_cbranch_vccz LtaS1_r
    s_sleep 2
    s_branch LtaS1_rp
LtaS1_r:
    s_and_b32 s17, s37, 3
    s_cmp_eq_u32 s17, 0
    s_cselect_b32 s17, s36, 0
    s_cmp_lg_u32 s17, 0
    s_cselect_b64 exec, 1, 0
    s_sub_u32 s17, s42, 22528
    buffer_store_dword v3, v4, s[8:11], s17 offen offset:384 sc1
    s_mov_b64 exec, -1
    s_add_u32 s46, s51, 0
    buffer_load_dwordx4 v[140:143], v0, s[28:31], s46 offen offset:0
    buffer_load_dwordx4 v[144:147], v0, s[28:31], s46 offen offset:1024
    v_mfma_f32_16x16x32_bf16 v[44:47], v[52:55], a[0:3], 0
    v_mfma_f32_16x16x32_bf16 v[48:51], v[52:55], a[4:7], 0
    v_mfma_f32_16x16x32_bf16 v[44:47], v[56:59], a[8:11], v[44:47]
    v_mfma_f32_16x16x32_bf16 v[48:51], v[56:59], a[12:15], v[48:51]
    v_mfma_f32_16x16x32_bf16 v[44:47], v[60:63], a[16:19], v[44:47]
    v_mfma_f32_16x16x32_bf16 v[48:51], v[60:63], a[20:23], v[48:51]
    v_mfma_f32_16x16x32_bf16 v[44:47], v[64:67], a[24:27], v[44:47]
    v_mfma_f32_16x16x32_bf16 v[48:51], v[64:67], a[28:31], v[48:51]
    v_max3_f32 v5, v32, v33, v34
    v_max_f32 v5, v5, v35
    s_nop 4
    v_mul_f32 v44, s52, v44
    v_mul_f32 v45, s52, v45
    v_max3_f32 v5, v5, v44, v45
    v_mov_b32 v6, v5
    buffer_load_dwordx4 v[148:151], v0, s[28:31], s46 offen offset:2048
    s_nop 0
    v_permlane32_swap_b32 v5, v6
    v_max_f32 v5, v5, v6
    v_mov_b32 v6, v5
    buffer_load_dwordx4 v[152:155], v0, s[28:31], s46 offen offset:3072
    s_nop 0
    v_permlane16_swap_b32 v5, v6
    v_max_f32 v5, v5, v6
    v_sub_f32 v32, v32, v5
    v_sub_f32 v33, v33, v5
    v_sub_f32 v34, v34, v5
    v_sub_f32 v35, v35, v5
    v_sub_f32 v44, v44, v5
    v_sub_f32 v45, v45, v5
    v_exp_f32 v32, v32
    v_exp_f32 v33, v33
    v_exp_f32 v34, v34
    v_exp_f32 v35, v35
    v_exp_f32 v44, v44
    v_exp_f32 v45, v45
    v_cvt_pk_bf16_f32 v24, v32, v33
    v_cvt_pk_bf16_f32 v25, v34, v35
    v_mov_b32 v26, 0
    v_mov_b32 v27, 0
    v_cvt_pk_bf16_f32 v20, v44, v45
    v_cvt_pk_bf16_f32 v23, v44, v45
    v_mfma_f32_16x16x32_bf16 v[28:31], v[16:19], v[24:27], 0
    v_mfma_f32_16x16x32_bf16 v[76:79], a[64:67], v[24:27], 0
    v_mfma_f32_16x16x32_bf16 v[80:83], a[68:71], v[24:27], 0
    s_add_u32 s46, s51, 4096
    buffer_load_dwordx4 v[156:159], v0, s[28:31], s46 offen offset:0
    v_mfma_f32_16x16x32_bf16 v[84:87], a[72:75], v[24:27], 0
    v_mfma_f32_16x16x32_bf16 v[88:91], a[76:79], v[24:27], 0
    buffer_load_dwordx4 v[160:163], v0, s[28:31], s46 offen offset:1024
    v_mfma_f32_16x16x32_bf16 v[92:95], a[80:83], v[24:27], 0
    v_mfma_f32_16x16x32_bf16 v[96:99], a[84:87], v[24:27], 0
    buffer_load_dwordx4 v[164:167], v0, s[28:31], s46 offen offset:2048
    v_mfma_f32_16x16x16_bf16 v[28:31], v[16:17], v[20:21], v[28:31]
    v_mfma_f32_16x16x32_bf16 v[100:103], a[88:91], v[24:27], 0
    v_mfma_f32_16x16x32_bf16 v[104:107], a[92:95], v[24:27], 0
    buffer_load_dwordx4 v[168:171], v0, s[28:31], s46 offen offset:3072
    v_mfma_f32_16x16x16_bf16 v[76:79], v[68:69], v[20:21], v[76:79]
    v_mfma_f32_16x16x16_bf16 v[80:83], v[68:69], v[22:23], v[80:83]
    s_nop 2
    v_rcp_f32 v6, v28
    v_mfma_f32_16x16x16_bf16 v[84:87], v[70:71], v[20:21], v[84:87]
    v_mfma_f32_16x16x16_bf16 v[88:91], v[70:71], v[22:23], v[88:91]
    s_nop 0
    v_mul_f32 v76, v6, v76
    v_mul_f32 v80, v6, v80
    v_cvt_pk_bf16_f32 v108, v76, v80
    v_mul_f32 v77, v6, v77
    v_mul_f32 v81, v6, v81
    v_cvt_pk_bf16_f32 v109, v77, v81
    v_mul_f32 v78, v6, v78
    v_mul_f32 v82, v6, v82
    v_cvt_pk_bf16_f32 v110, v78, v82
    v_mul_f32 v79, v6, v79
    v_mul_f32 v83, v6, v83
    v_cvt_pk_bf16_f32 v111, v79, v83
    s_add_u32 s17, s48, 0
    buffer_store_dwordx4 v[108:111], v0, s[8:11], s17 offen offset:0 sc1
    s_add_u32 s46, s51, 16777216
    buffer_load_dwordx4 v[172:175], v0, s[28:31], s46 offen offset:0
    v_mfma_f32_16x16x16_bf16 v[92:95], v[72:73], v[20:21], v[92:95]
    v_mfma_f32_16x16x16_bf16 v[96:99], v[72:73], v[22:23], v[96:99]
    v_mul_f32 v84, v6, v84
    v_mul_f32 v88, v6, v88
    v_cvt_pk_bf16_f32 v112, v84, v88
    v_mul_f32 v85, v6, v85
    v_mul_f32 v89, v6, v89
    v_cvt_pk_bf16_f32 v113, v85, v89
    v_mul_f32 v86, v6, v86
    v_mul_f32 v90, v6, v90
    v_cvt_pk_bf16_f32 v114, v86, v90
    v_mul_f32 v87, v6, v87
    v_mul_f32 v91, v6, v91
    v_cvt_pk_bf16_f32 v115, v87, v91
    buffer_store_dwordx4 v[112:115], v0, s[8:11], s17 offen offset:2048 sc1
    buffer_load_dwordx4 v[176:179], v0, s[28:31], s46 offen offset:1024
    v_mfma_f32_16x16x16_bf16 v[100:103], v[74:75], v[20:21], v[100:103]
    v_mfma_f32_16x16x16_bf16 v[104:107], v[74:75], v[22:23], v[104:107]
    v_mul_f32 v92, v6, v92
    v_mul_f32 v96, v6, v96
    v_cvt_pk_bf16_f32 v116, v92, v96
    v_mul_f32 v93, v6, v93
    v_mul_f32 v97, v6, v97
    v_cvt_pk_bf16_f32 v117, v93, v97
    v_mul_f32 v94, v6, v94
    v_mul_f32 v98, v6, v98
    v_cvt_pk_bf16_f32 v118, v94, v98
    v_mul_f32 v95, v6, v95
    v_mul_f32 v99, v6, v99
    v_cvt_pk_bf16_f32 v119, v95, v99
    s_add_u32 s17, s48, 4096
    buffer_store_dwordx4 v[116:119], v0, s[8:11], s17 offen offset:0 sc1
    buffer_load_dwordx4 v[180:183], v0, s[28:31], s46 offen offset:2048
    v_mul_f32 v100, v6, v100
    v_mul_f32 v104, v6, v104
    v_cvt_pk_bf16_f32 v120, v100, v104
    v_mul_f32 v101, v6, v101
    v_mul_f32 v105, v6, v105
    v_cvt_pk_bf16_f32 v121, v101, v105
    v_mul_f32 v102, v6, v102
    v_mul_f32 v106, v6, v106
    v_cvt_pk_bf16_f32 v122, v102, v106
    v_mul_f32 v103, v6, v103
    v_mul_f32 v107, v6, v107
    v_cvt_pk_bf16_f32 v123, v103, v107
    buffer_store_dwordx4 v[120:123], v0, s[8:11], s17 offen offset:2048 sc1
    buffer_load_dwordx4 v[184:187], v0, s[28:31], s46 offen offset:3072
    v_max3_f32 v5, v36, v37, v38
    v_max_f32 v5, v5, v39
    v_max3_f32 v5, v5, v40, v41
    v_max3_f32 v5, v5, v42, v43
    v_mul_f32 v48, s52, v48
    v_mul_f32 v49, s52, v49
    v_max3_f32 v5, v5, v48, v49
    v_mov_b32 v6, v5
    s_add_u32 s46, s51, 16781312
    buffer_load_dwordx4 v[188:191], v0, s[28:31], s46 offen offset:0
    v_permlane32_swap_b32 v5, v6
    v_max_f32 v5, v5, v6
    v_mov_b32 v6, v5
    buffer_load_dwordx4 v[192:195], v0, s[28:31], s46 offen offset:1024
    s_nop 0
    v_permlane16_swap_b32 v5, v6
    v_max_f32 v5, v5, v6
    v_sub_f32 v36, v36, v5
    v_sub_f32 v37, v37, v5
    v_sub_f32 v38, v38, v5
    v_sub_f32 v39, v39, v5
    v_sub_f32 v40, v40, v5
    v_sub_f32 v41, v41, v5
    v_sub_f32 v42, v42, v5
    v_sub_f32 v43, v43, v5
    v_sub_f32 v48, v48, v5
    v_sub_f32 v49, v49, v5
    v_exp_f32 v36, v36
    v_exp_f32 v37, v37
    v_exp_f32 v38, v38
    v_exp_f32 v39, v39
    v_exp_f32 v40, v40
    v_exp_f32 v41, v41
    v_exp_f32 v42, v42
    v_exp_f32 v43, v43
    v_exp_f32 v48, v48
    v_exp_f32 v49, v49
    v_cvt_pk_bf16_f32 v24, v36, v37
    v_cvt_pk_bf16_f32 v25, v38, v39
    v_cvt_pk_bf16_f32 v26, v40, v41
    v_cvt_pk_bf16_f32 v27, v42, v43
    v_cvt_pk_bf16_f32 v20, v48, v49
    v_cvt_pk_bf16_f32 v23, v48, v49
    v_mfma_f32_16x16x32_bf16 v[28:31], v[16:19], v[24:27], 0
    v_mfma_f32_16x16x32_bf16 v[76:79], a[64:67], v[24:27], 0
    v_mfma_f32_16x16x32_bf16 v[80:83], a[68:71], v[24:27], 0
    buffer_load_dwordx4 v[196:199], v0, s[28:31], s46 offen offset:2048
    v_mfma_f32_16x16x32_bf16 v[84:87], a[72:75], v[24:27], 0
    v_mfma_f32_16x16x32_bf16 v[88:91], a[76:79], v[24:27], 0
    buffer_load_dwordx4 v[200:203], v0, s[28:31], s46 offen offset:3072
    v_mfma_f32_16x16x32_bf16 v[92:95], a[80:83], v[24:27], 0
    v_mfma_f32_16x16x32_bf16 v[96:99], a[84:87], v[24:27], 0
    s_add_u32 s46, s51, 33554432
    buffer_load_dwordx4 v[204:207], v0, s[28:31], s46 offen offset:0
    v_mfma_f32_16x16x16_bf16 v[28:31], v[16:17], v[20:21], v[28:31]
    v_mfma_f32_16x16x32_bf16 v[100:103], a[88:91], v[24:27], 0
    v_mfma_f32_16x16x32_bf16 v[104:107], a[92:95], v[24:27], 0
    buffer_load_dwordx4 v[208:211], v0, s[28:31], s46 offen offset:1024
    v_mfma_f32_16x16x16_bf16 v[76:79], v[68:69], v[20:21], v[76:79]
    v_mfma_f32_16x16x16_bf16 v[80:83], v[68:69], v[22:23], v[80:83]
    s_nop 2
    v_rcp_f32 v6, v28
    v_mfma_f32_16x16x16_bf16 v[84:87], v[70:71], v[20:21], v[84:87]
    v_mfma_f32_16x16x16_bf16 v[88:91], v[70:71], v[22:23], v[88:91]
    s_nop 0
    v_mul_f32 v76, v6, v76
    v_mul_f32 v80, v6, v80
    v_cvt_pk_bf16_f32 v124, v76, v80
    v_mul_f32 v77, v6, v77
    v_mul_f32 v81, v6, v81
    v_cvt_pk_bf16_f32 v125, v77, v81
    v_mul_f32 v78, v6, v78
    v_mul_f32 v82, v6, v82
    v_cvt_pk_bf16_f32 v126, v78, v82
    v_mul_f32 v79, v6, v79
    v_mul_f32 v83, v6, v83
    v_cvt_pk_bf16_f32 v127, v79, v83
    s_add_u32 s17, s48, 0
    buffer_store_dwordx4 v[124:127], v0, s[8:11], s17 offen offset:1024 sc1
    buffer_load_dwordx4 v[212:215], v0, s[28:31], s46 offen offset:2048
    v_mfma_f32_16x16x16_bf16 v[92:95], v[72:73], v[20:21], v[92:95]
    v_mfma_f32_16x16x16_bf16 v[96:99], v[72:73], v[22:23], v[96:99]
    v_mul_f32 v84, v6, v84
    v_mul_f32 v88, v6, v88
    v_cvt_pk_bf16_f32 v128, v84, v88
    v_mul_f32 v85, v6, v85
    v_mul_f32 v89, v6, v89
    v_cvt_pk_bf16_f32 v129, v85, v89
    v_mul_f32 v86, v6, v86
    v_mul_f32 v90, v6, v90
    v_cvt_pk_bf16_f32 v130, v86, v90
    v_mul_f32 v87, v6, v87
    v_mul_f32 v91, v6, v91
    v_cvt_pk_bf16_f32 v131, v87, v91
    buffer_store_dwordx4 v[128:131], v0, s[8:11], s17 offen offset:3072 sc1
    buffer_load_dwordx4 v[216:219], v0, s[28:31], s46 offen offset:3072
    v_mfma_f32_16x16x16_bf16 v[100:103], v[74:75], v[20:21], v[100:103]
    v_mfma_f32_16x16x16_bf16 v[104:107], v[74:75], v[22:23], v[104:107]
    v_mul_f32 v92, v6, v92
    v_mul_f32 v96, v6, v96
    v_cvt_pk_bf16_f32 v132, v92, v96
    v_mul_f32 v93, v6, v93
    v_mul_f32 v97, v6, v97
    v_cvt_pk_bf16_f32 v133, v93, v97
    v_mul_f32 v94, v6, v94
    v_mul_f32 v98, v6, v98
    v_cvt_pk_bf16_f32 v134, v94, v98
    v_mul_f32 v95, v6, v95
    v_mul_f32 v99, v6, v99
    v_cvt_pk_bf16_f32 v135, v95, v99
    s_add_u32 s17, s48, 4096
    buffer_store_dwordx4 v[132:135], v0, s[8:11], s17 offen offset:1024 sc1
    s_add_u32 s46, s51, 33558528
    buffer_load_dwordx4 v[220:223], v0, s[28:31], s46 offen offset:0
    v_mul_f32 v100, v6, v100
    v_mul_f32 v104, v6, v104
    v_cvt_pk_bf16_f32 v136, v100, v104
    v_mul_f32 v101, v6, v101
    v_mul_f32 v105, v6, v105
    v_cvt_pk_bf16_f32 v137, v101, v105
    v_mul_f32 v102, v6, v102
    v_mul_f32 v106, v6, v106
    v_cvt_pk_bf16_f32 v138, v102, v106
    v_mul_f32 v103, v6, v103
    v_mul_f32 v107, v6, v107
    v_cvt_pk_bf16_f32 v139, v103, v107
    buffer_store_dwordx4 v[136:139], v0, s[8:11], s17 offen offset:3072 sc1
    buffer_load_dwordx4 v[224:227], v0, s[28:31], s46 offen offset:1024
    buffer_load_dwordx4 v[228:231], v0, s[28:31], s46 offen offset:2048
    buffer_load_dwordx4 v[232:235], v0, s[28:31], s46 offen offset:3072
    s_add_u32 s48, s48, 262144
    s_mov_b32 s49, 22528
    s_mov_b32 s66, 0
    s_cmp_ge_u32 s37, 64
    s_cbranch_scc1 LtaS_end
    s_branch LtaS0
LtaS_end:
    s_waitcnt vmcnt(0)
    s_and_b32 s17, s49, s66
    s_cselect_b64 exec, 1, 0
    buffer_store_dword v3, v4, s[8:11], s43 offen
    s_andn2_b32 s17, s49, s66
    s_cselect_b64 exec, 1, 0
    buffer_store_dword v3, v4, s[8:11], s43 offen sc1
    s_mov_b64 exec, -1
    s_add_u32 s43, s43, s49
    s_mov_b32 s49, 0
    s_branch L_role_ta_exit
L_role_ta_abort:
    s_waitcnt lgkmcnt(0)
    s_mov_b64 exec, -1
    v_mov_b32 v0, 60
    s_lshl_b32 s5, s3, 8
    s_or_b32 s5, s5, s4
    s_or_b32 s5, s5, 0x10000
    v_mov_b32 v1, s5
    global_store_dword v0, v1, s[12:13]
    s_endpgm
L_role_ta_exit:
    s_and_b32 s6, s15, 7
    s_add_u32 s6, s6, s14
    s_cmp_lg_u32 s6, 0
    s_cbranch_scc1 L_role_ta_nowb
    s_waitcnt vmcnt(0)
    buffer_wbl2 sc1
    s_waitcnt vmcnt(0)
L_role_ta_nowb:
    s_endpgm
.p2align 6
L_role_r:
    s_mov_b32 s32, s3
    s_mov_b32 s15, s4
    v_and_b32 v10, 63, v0
    v_and_b32 v60, 15, v10
    v_lshrrev_b32 v61, 4, v10
    v_lshlrev_b32 v0, 4, v10
    v_lshlrev_b32 v8, 2, v10
    s_mul_i32 s17, s14, 26624
    s_add_u32 s17, s17, 57344
    v_add_u32 v9, s17, v0
    s_mov_b32 s54, 0xfffffffe
    s_mov_b32 s46, 0x3e0293ee
    s_mov_b32 s47, 0x3e0293ee
    s_mov_b32 s50, 0x00ff00ff
    s_mov_b32 s51, 0x00ff00ff
    s_mov_b32 s52, -1
    s_mov_b32 s53, 0
    s_mov_b32 s68, 0x3f803f80
    s_mov_b32 s69, 0x3f803f80
    s_mov_b32 s39, 0
    v_lshrrev_b32 v63, 2, v60
    v_and_b32 v64, 1, v60
    v_lshl_add_u32 v62, v63, 1, v64
    v_bfe_u32 v65, v60, 1, 1
    v_mov_b32 v1, 0x4444
    v_mov_b32 v63, 0xeeee
    v_cmp_eq_u32 vcc, 0, v65
    s_nop 1
    v_cndmask_b32 v1, v63, v1, vcc
    v_mul_u32_u24 v63, 576, v61
    v_lshl_add_u32 v2, v60, 2, v63
    s_lshl_b32 s17, s14, 6
    v_add_u32 v2, s17, v2
    v_mul_u32_u24 v63, 288, v62
    v_lshl_add_u32 v3, v61, 4, v63
    v_lshl_add_u32 v4, v61, 5, v63
    v_lshl_add_u32 v4, v65, 4, v4
    s_cmp_eq_u32 s32, 0
    s_cbranch_scc1 Lr_noord
    s_cmp_lg_u32 s14, 0
    s_cbranch_scc1 Lr_ord_d
    v_mov_b32 v63, 48
    s_mov_b32 s16, 0
Lr_ord:
    global_load_dword v64, v63, s[12:13] sc1
    s_add_u32 s16, s16, 1
    s_cmp_gt_u32 s16, 100000
    s_cbranch_scc1 Lr_abort
    s_waitcnt vmcnt(0)
    v_cmp_gt_u32 vcc, 16, v64
    s_nop 0
    s_cbranch_vccz Lr_ord_d
    s_sleep 32
    s_branch Lr_ord
Lr_ord_d:
    s_barrier
Lr_noord:
    s_cmp_lg_u32 s32, 0
    s_cbranch_scc1 Lr_ld1
    s_load_dwordx2 s[20:21], s[0:1], 40
    s_mov_b32 s22, 4718592
    s_mov_b32 s23, 0x00020000
    s_waitcnt lgkmcnt(0)
    s_and_b32 s21, s21, 0xffff
    s_load_dwordx2 s[24:25], s[0:1], 48
    s_mov_b32 s26, 4718592
    s_mov_b32 s27, 0x00020000
    s_waitcnt lgkmcnt(0)
    s_and_b32 s25, s25, 0xffff
    s_load_dwordx2 s[28:29], s[0:1], 56
    s_mov_b32 s30, 4718592
    s_mov_b32 s31, 0x00020000
    s_waitcnt lgkmcnt(0)
    s_and_b32 s29, s29, 0xffff
    s_load_dwordx2 s[80:81], s[0:1], 64
    s_mov_b32 s82, 4718592
    s_mov_b32 s83, 0x00020000
    s_waitcnt lgkmcnt(0)
    s_and_b32 s81, s81, 0xffff
    v_lshlrev_b32 v71, 1, v61
    v_xor_b32 v71, v71, v60
    v_lshlrev_b32 v71, 4, v71
    v_lshl_add_u32 v62, v61, 13, v71
    v_xor_b32 v63, 128, v62
    v_lshrrev_b32 v64, 1, v61
    v_lshlrev_b32 v64, 3, v64
    v_and_b32 v65, 1, v61
    v_lshl_add_u32 v64, v65, 2, v64
    v_lshl_add_u32 v64, v64, 13, v71
    v_xor_b32 v65, 128, v64
    s_mul_i32 s57, s14, 1179648
    s_lshl_b32 s17, s15, 8
    s_add_u32 s57, s57, s17
    s_lshl_b32 s58, s14, 12
    v_lshrrev_b32 v71, 2, v60
    v_lshl_add_u32 v66, v61, 3, v71
    v_lshlrev_b32 v66, 8, v66
    v_bfe_u32 v67, v60, 1, 1
    s_lshl_b32 s17, s14, 2
    v_add_u32 v67, s17, v67
    v_lshlrev_b32 v71, 1, v71
    v_xor_b32 v67, v67, v71
    v_and_b32 v71, 1, v61
    v_lshlrev_b32 v71, 3, v71
    v_xor_b32 v67, v67, v71
    v_and_b32 v71, 1, v60
    v_lshl_add_u32 v66, v71, 3, v66
    v_xor_b32 v71, 2, v67
    v_lshl_add_u32 v67, v71, 4, v66
    v_xor_b32 v71, 2, v71
    v_lshl_add_u32 v66, v71, 4, v66
    v_lshrrev_b32 v71, 2, v60
    v_lshl_add_u32 v70, v61, 2, v71
    v_mul_u32_u24 v70, 1152, v70
    v_and_b32 v71, 3, v60
    v_lshl_add_u32 v70, v71, 3, v70
    s_mul_i32 s17, s14, 288
    v_add_u32 v70, s17, v70
    v_add_u32 v71, 0, v10
    v_mul_u32_u24 v59, 911, v71
    v_lshrrev_b32 v59, 16, v59
    v_mul_u32_u24 v60, 72, v59
    v_sub_u32 v71, v71, v60
    v_and_b32 v60, 1, v59
    v_lshlrev_b32 v60, 4, v60
    v_lshrrev_b32 v59, 1, v59
    v_lshl_add_u32 v60, v59, 2, v60
    v_mul_u32_u24 v60, 1152, v60
    v_lshl_add_u32 v50, v71, 4, v60
    v_add_u32 v71, 64, v10
    v_mul_u32_u24 v59, 911, v71
    v_lshrrev_b32 v59, 16, v59
    v_mul_u32_u24 v60, 72, v59
    v_sub_u32 v71, v71, v60
    v_and_b32 v60, 1, v59
    v_lshlrev_b32 v60, 4, v60
    v_lshrrev_b32 v59, 1, v59
    v_lshl_add_u32 v60, v59, 2, v60
    v_mul_u32_u24 v60, 1152, v60
    v_lshl_add_u32 v51, v71, 4, v60
    v_add_u32 v71, 128, v10
    v_mul_u32_u24 v59, 911, v71
    v_lshrrev_b32 v59, 16, v59
    v_mul_u32_u24 v60, 72, v59
    v_sub_u32 v71, v71, v60
    v_and_b32 v60, 1, v59
    v_lshlrev_b32 v60, 4, v60
    v_lshrrev_b32 v59, 1, v59
    v_lshl_add_u32 v60, v59, 2, v60
    v_mul_u32_u24 v60, 1152, v60
    v_lshl_add_u32 v52, v71, 4, v60
    v_add_u32 v71, 192, v10
    v_mul_u32_u24 v59, 911, v71
    v_lshrrev_b32 v59, 16, v59
    v_mul_u32_u24 v60, 72, v59
    v_sub_u32 v71, v71, v60
    v_and_b32 v60, 1, v59
    v_lshlrev_b32 v60, 4, v60
    v_lshrrev_b32 v59, 1, v59
    v_lshl_add_u32 v60, v59, 2, v60
    v_mul_u32_u24 v60, 1152, v60
    v_lshl_add_u32 v53, v71, 4, v60
    v_add_u32 v71, 256, v10
    v_mul_u32_u24 v59, 911, v71
    v_lshrrev_b32 v59, 16, v59
    v_mul_u32_u24 v60, 72, v59
    v_sub_u32 v71, v71, v60
    v_and_b32 v60, 1, v59
    v_lshlrev_b32 v60, 4, v60
    v_lshrrev_b32 v59, 1, v59
    v_lshl_add_u32 v60, v59, 2, v60
    v_mul_u32_u24 v60, 1152, v60
    v_lshl_add_u32 v54, v71, 4, v60
    s_lshr_b32 s17, s14, 1
    s_lshl_b32 s17, s17, 3
    s_and_b32 s18, s14, 1
    s_lshl_b32 s18, s18, 1
    s_add_u32 s17, s17, s18
    s_lshl_b32 s18, s15, 7
    s_add_u32 s17, s17, s18
    s_mul_i32 s59, s17, 1152
    s_mul_i32 s60, s14, 4608
    s_add_u32 m0, s58, 49152
    s_add_u32 s17, s57, 0
    buffer_load_dwordx4 v62, s[20:23], s17 offen nt lds
    s_add_u32 m0, s58, 50176
    s_add_u32 s17, s57, 32768
    buffer_load_dwordx4 v62, s[20:23], s17 offen nt lds
    s_add_u32 m0, s58, 51200
    s_add_u32 s17, s57, 65536
    buffer_load_dwordx4 v63, s[20:23], s17 offen nt lds
    s_add_u32 m0, s58, 52224
    s_add_u32 s17, s57, 98304
    buffer_load_dwordx4 v63, s[20:23], s17 offen nt lds
    s_add_u32 m0, s58, 65536
    s_add_u32 s17, s57, 0
    buffer_load_dwordx4 v62, s[24:27], s17 offen nt lds
    s_add_u32 m0, s58, 66560
    s_add_u32 s17, s57, 32768
    buffer_load_dwordx4 v62, s[24:27], s17 offen nt lds
    s_add_u32 m0, s58, 67584
    s_add_u32 s17, s57, 65536
    buffer_load_dwordx4 v63, s[24:27], s17 offen nt lds
    s_add_u32 m0, s58, 68608
    s_add_u32 s17, s57, 98304
    buffer_load_dwordx4 v63, s[24:27], s17 offen nt lds
    s_add_u32 m0, s58, 81920
    s_add_u32 s17, s57, 0
    buffer_load_dwordx4 v62, s[28:31], s17 offen nt lds
    s_add_u32 m0, s58, 82944
    s_add_u32 s17, s57, 32768
    buffer_load_dwordx4 v62, s[28:31], s17 offen nt lds
    s_add_u32 m0, s58, 83968
    s_add_u32 s17, s57, 65536
    buffer_load_dwordx4 v63, s[28:31], s17 offen nt lds
    s_add_u32 m0, s58, 84992
    s_add_u32 s17, s57, 98304
    buffer_load_dwordx4 v63, s[28:31], s17 offen nt lds
    s_add_u32 m0, s58, 98304
    s_add_u32 s17, s57, 131072
    buffer_load_dwordx4 v62, s[20:23], s17 offen nt lds
    s_add_u32 m0, s58, 99328
    s_add_u32 s17, s57, 163840
    buffer_load_dwordx4 v62, s[20:23], s17 offen nt lds
    s_add_u32 m0, s58, 100352
    s_add_u32 s17, s57, 196608
    buffer_load_dwordx4 v63, s[20:23], s17 offen nt lds
    s_add_u32 m0, s58, 101376
    s_add_u32 s17, s57, 229376
    buffer_load_dwordx4 v63, s[20:23], s17 offen nt lds
    s_add_u32 m0, s58, 114688
    s_add_u32 s17, s57, 131072
    buffer_load_dwordx4 v62, s[24:27], s17 offen nt lds
    s_add_u32 m0, s58, 115712
    s_add_u32 s17, s57, 163840
    buffer_load_dwordx4 v62, s[24:27], s17 offen nt lds
    s_add_u32 m0, s58, 116736
    s_add_u32 s17, s57, 196608
    buffer_load_dwordx4 v63, s[24:27], s17 offen nt lds
    s_add_u32 m0, s58, 117760
    s_add_u32 s17, s57, 229376
    buffer_load_dwordx4 v63, s[24:27], s17 offen nt lds
    s_add_u32 m0, s58, 131072
    s_add_u32 s17, s57, 131072
    buffer_load_dwordx4 v62, s[28:31], s17 offen nt lds
    s_add_u32 m0, s58, 132096
    s_add_u32 s17, s57, 163840
    buffer_load_dwordx4 v62, s[28:31], s17 offen nt lds
    s_add_u32 m0, s58, 133120
    s_add_u32 s17, s57, 196608
    buffer_load_dwordx4 v63, s[28:31], s17 offen nt lds
    s_add_u32 m0, s58, 134144
    s_add_u32 s17, s57, 229376
    buffer_load_dwordx4 v63, s[28:31], s17 offen nt lds
    s_add_u32 m0, s58, 147456
    s_add_u32 s17, s57, 262144
    buffer_load_dwordx4 v62, s[20:23], s17 offen nt lds
    s_add_u32 m0, s58, 148480
    s_add_u32 s17, s57, 294912
    buffer_load_dwordx4 v62, s[20:23], s17 offen nt lds
    s_add_u32 m0, s58, 149504
    s_add_u32 s17, s57, 327680
    buffer_load_dwordx4 v63, s[20:23], s17 offen nt lds
    s_add_u32 m0, s58, 150528
    s_add_u32 s17, s57, 360448
    buffer_load_dwordx4 v63, s[20:23], s17 offen nt lds
    s_add_u32 m0, s58, 0
    s_add_u32 s17, s57, 262144
    buffer_load_dwordx4 v62, s[24:27], s17 offen nt lds
    s_add_u32 m0, s58, 1024
    s_add_u32 s17, s57, 294912
    buffer_load_dwordx4 v62, s[24:27], s17 offen nt lds
    s_add_u32 m0, s58, 2048
    s_add_u32 s17, s57, 327680
    buffer_load_dwordx4 v63, s[24:27], s17 offen nt lds
    s_add_u32 m0, s58, 3072
    s_add_u32 s17, s57, 360448
    buffer_load_dwordx4 v63, s[24:27], s17 offen nt lds
    s_add_u32 m0, s58, 16384
    s_add_u32 s17, s57, 262144
    buffer_load_dwordx4 v62, s[28:31], s17 offen nt lds
    s_add_u32 m0, s58, 17408
    s_add_u32 s17, s57, 294912
    buffer_load_dwordx4 v62, s[28:31], s17 offen nt lds
    s_add_u32 m0, s58, 18432
    s_add_u32 s17, s57, 327680
    buffer_load_dwordx4 v63, s[28:31], s17 offen nt lds
    s_add_u32 m0, s58, 19456
    s_add_u32 s17, s57, 360448
    buffer_load_dwordx4 v63, s[28:31], s17 offen nt lds
    v_and_b32 v12, 15, v10
    v_lshrrev_b32 v13, 4, v10
    s_lshr_b32 s84, s15, 3
    s_bfe_u32 s85, s15, 0x20001
    s_and_b32 s86, s15, 1
    s_cmp_lt_u32 s14, 2
    s_cbranch_scc1 Lr_jaba
    s_lshr_b32 s84, s15, 1
    s_and_b32 s84, s84, 3
Lr_jaba:
    s_cmp_lt_u32 s15, 8
    s_cselect_b32 s62, 1, 0
    v_bfe_u32 v20, v12, 2, 1
    v_lshl_add_u32 v17, v20, 2, v13
    v_mul_u32_u24 v17, 12288, v17
    v_lshrrev_b32 v21, 3, v12
    v_lshlrev_b32 v21, 2, v21
    v_and_b32 v20, 3, v12
    v_add_u32 v21, v21, v20
    v_lshl_add_u32 v6, v21, 4, v17
    s_mul_i32 s17, s84, 2304
    s_lshl_b32 s18, s14, 10
    s_add_u32 s17, s17, s18
    s_lshl_b32 s18, s86, 7
    s_add_u32 s17, s17, s18
    s_lshl_b32 s18, s85, 8
    s_cmp_lt_u32 s14, 2
    s_cselect_b32 s18, s18, 0
    s_add_u32 s17, s17, s18
    v_add_u32 v6, s17, v6
    v_bfe_u32 v24, v12, 1, 2
    v_and_b32 v25, 1, v12
    v_lshrrev_b32 v26, 1, v13
    v_and_b32 v27, 1, v13
    s_cmp_lt_u32 s14, 2
    s_cbranch_scc0 Lr_jca
    s_lshl_b32 s17, s14, 2
    v_add_u32 v18, s17, v24
    v_lshlrev_b32 v7, 10, v18
    v_lshl_add_u32 v19, v27, 1, v25
    s_lshl_b32 s17, s84, 4
    s_lshl_b32 s18, s85, 2
    s_add_u32 s17, s17, s18
    v_add_u32 v19, s17, v19
    v_lshl_add_u32 v7, v19, 4, v7
    s_lshl_b32 s17, s86, 1
    v_add_u32 v19, s17, v26
    v_lshl_add_u32 v7, v19, 2, v7
    s_lshl_b32 s17, s85, 1
    v_add_u32 v19, s17, v25
    v_mul_u32_u24 v19, 576, v19
    v_lshl_add_u32 v19, v18, 4, v19
    v_lshl_add_u32 v19, v13, 1, v19
    s_mul_i32 s17, s84, 144
    s_lshl_b32 s18, s86, 3
    s_add_u32 s17, s17, s18
    v_add_u32 v19, s17, v19
    v_lshlrev_b32 v14, 1, v19
    v_add_u32 v15, 2, v14
    s_branch Lr_jda
Lr_jca:
    s_lshl_b32 s17, s86, 1
    v_add_u32 v18, s17, v26
    v_lshlrev_b32 v19, 2, v18
    v_lshl_add_u32 v19, v27, 1, v19
    v_add_u32 v19, v19, v25
    s_lshl_b32 s17, s84, 4
    v_add_u32 v19, s17, v19
    v_lshlrev_b32 v7, 4, v19
    v_lshl_add_u32 v7, v24, 2, v7
    v_add_u32 v7, 8192, v7
    v_lshl_add_u32 v19, v18, 1, v25
    v_mul_u32_u24 v19, 576, v19
    v_lshl_add_u32 v19, v27, 3, v19
    v_add_u32 v19, v19, v24
    s_mul_i32 s17, s84, 144
    s_add_u32 s17, s17, 128
    v_add_u32 v19, s17, v19
    v_lshlrev_b32 v14, 1, v19
    v_add_u32 v15, 8, v14
Lr_jda:
    s_mul_i32 s48, s32, 1048576
    s_add_u32 s48, s48, 4194304
    s_lshl_b32 s18, s14, 11
    s_lshl_b32 s19, s14, 8
    s_add_u32 s19, s19, 8192
    s_mul_i32 s17, s15, 12288
    s_add_u32 s17, s17, s48
    s_mul_i32 s38, s14, 2304
    s_add_u32 s38, s38, s17
    s_add_u32 s37, s48, 983040
    s_xor_b32 s36, s37, 16384
    s_add_u32 s34, s37, s18
    s_add_u32 s35, s37, s19
    s_mul_i32 s17, s32, 50331648
    s_lshl_b32 s19, s15, 13
    s_add_u32 s17, s17, s19
    s_add_u32 s40, s17, 61079552
    s_add_u32 s17, s17, s18
    s_add_u32 s41, s17, 60817408
    s_add_u32 s42, s17, 77594624
    s_mul_i32 s17, s32, 1048576
    s_lshl_b32 s19, s15, 12
    s_add_u32 s17, s17, s19
    s_lshl_b32 s19, s14, 9
    s_add_u32 s17, s17, s19
    s_add_u32 s45, s17, 27262976
    s_mov_b32 s86, s19
    s_mov_b32 s43, s45
    s_mov_b32 s66, 0
    s_mov_b32 s67, 1464320
    s_mov_b32 s78, 0xff
    s_mov_b32 s79, 0
    s_mul_i32 s17, s32, 1441792
    s_lshl_b32 s19, s15, 9
    s_add_u32 s17, s17, s19
    s_add_u32 s44, s17, 185600
    s_mov_b32 s33, 0
    s_load_dwordx2 s[88:89], s[0:1], 32
    s_mov_b32 s90, 9216
    s_mov_b32 s91, 0x00020000
    s_waitcnt lgkmcnt(0)
    s_and_b32 s89, s89, 0xffff
    s_cmp_eq_u32 s14, 3
    s_cbranch_scc1 Lr_mem0_donea
    s_cmp_lt_u32 s14, 2
    s_cselect_b32 s17, 1, s62
    s_cmp_eq_u32 s17, 0
    s_cbranch_scc1 Lr_mem0_donea
    s_mov_b64 exec, s[50:51]
    buffer_load_ushort v20, v14, s[88:91], 0 offen
    buffer_load_ushort v21, v15, s[88:91], 0 offen
    s_waitcnt vmcnt(0)
    v_lshl_or_b32 v20, v21, 16, v20
    v_min_u32 v20, s54, v20
    buffer_store_dword v20, v7, s[8:11], s37 offen sc1
    v_mov_b32 v20, -1
    buffer_store_dword v20, v7, s[8:11], s36 offen sc1
    s_mov_b64 exec, -1
Lr_mem0_donea:
    v_mov_b32 v20, 1
    v_mov_b32 v21, 1
    v_mov_b32 v22, 1
    v_mov_b32 v23, 1
    s_xor_b32 s17, s38, 524288
    buffer_store_dwordx4 v[20:23], v0, s[8:11], s38 offen offset:0 sc1
    buffer_store_dwordx4 v[20:23], v0, s[8:11], s38 offen offset:1024 sc1
    buffer_store_dword v20, v8, s[8:11], s38 offen offset:2048 sc1
    buffer_store_dwordx4 v[20:23], v0, s[8:11], s17 offen offset:0 sc1
    buffer_store_dwordx4 v[20:23], v0, s[8:11], s17 offen offset:1024 sc1
    buffer_store_dword v20, v8, s[8:11], s17 offen offset:2048 sc1
    v_lshrrev_b32 v17, 1, v0
    s_mov_b32 s17, s45
    buffer_store_dwordx2 v[20:21], v17, s[8:11], s17 offen offset:2048 sc1
    s_mov_b64 exec, s[52:53]
    buffer_store_dwordx4 v[20:23], v0, s[8:11], s17 offen sc1
    s_mov_b64 exec, -1
    s_add_u32 s17, s17, 131072
    buffer_store_dwordx2 v[20:21], v17, s[8:11], s17 offen offset:2048 sc1
    s_mov_b64 exec, s[52:53]
    buffer_store_dwordx4 v[20:23], v0, s[8:11], s17 offen sc1
    s_mov_b64 exec, -1
    s_add_u32 s17, s17, 131072
    buffer_store_dwordx2 v[20:21], v17, s[8:11], s17 offen offset:2048 sc1
    s_mov_b64 exec, s[52:53]
    buffer_store_dwordx4 v[20:23], v0, s[8:11], s17 offen sc1
    s_mov_b64 exec, -1
    s_add_u32 s17, s17, 131072
    buffer_store_dwordx2 v[20:21], v17, s[8:11], s17 offen offset:2048 sc1
    s_mov_b64 exec, s[52:53]
    buffer_store_dwordx4 v[20:23], v0, s[8:11], s17 offen sc1
    s_mov_b64 exec, -1
    s_add_u32 s17, s17, 131072
    buffer_store_dwordx2 v[20:21], v17, s[8:11], s17 offen offset:2048 sc1
    s_mov_b64 exec, s[52:53]
    buffer_store_dwordx4 v[20:23], v0, s[8:11], s17 offen sc1
    s_mov_b64 exec, -1
    s_add_u32 s17, s17, 131072
    buffer_store_dwordx2 v[20:21], v17, s[8:11], s17 offen offset:2048 sc1
    s_mov_b64 exec, s[52:53]
    buffer_store_dwordx4 v[20:23], v0, s[8:11], s17 offen sc1
    s_mov_b64 exec, -1
    s_add_u32 s17, s17, 131072
    buffer_store_dwordx2 v[20:21], v17, s[8:11], s17 offen offset:2048 sc1
    s_mov_b64 exec, s[52:53]
    buffer_store_dwordx4 v[20:23], v0, s[8:11], s17 offen sc1
    s_mov_b64 exec, -1
    s_add_u32 s17, s17, 131072
    buffer_store_dwordx2 v[20:21], v17, s[8:11], s17 offen offset:2048 sc1
    s_mov_b64 exec, s[52:53]
    buffer_store_dwordx4 v[20:23], v0, s[8:11], s17 offen sc1
    s_mov_b64 exec, -1
    s_add_u32 s17, s17, 131072
    s_cmp_lg_u32 s14, 3
    s_cbranch_scc1 Lr_not_w3a
    v_and_b32 v7, 12, v8
    v_and_b32 v17, 4, v10
    v_lshl_add_u32 v7, v17, 5, v7
    s_add_u32 s17, s44, 4294877568
    s_cmp_eq_u32 s32, 0
    s_cselect_b32 s67, s67, s17
    s_add_u32 s17, s44, 22656
    s_min_u32 s18, s17, s67
    s_sub_u32 s17, s17, s18
    v_add_u32 v7, s17, v7
    s_sub_u32 s17, s67, s18
    v_mov_b32 v17, s17
    v_cmp_gt_u32 vcc, 8, v10
    s_nop 1
    v_cndmask_b32 v7, v17, v7, vcc
    s_mov_b32 s67, s18
Lr_not_w3a:
    v_lshlrev_b32 v5, 3, v0
    s_add_u32 s56, s40, 16777216
    s_waitcnt vmcnt(32)
    s_barrier
    s_cmp_lg_u32 s14, 0
    s_cbranch_scc1 Lr_noadda
    s_lshl_b32 s17, s32, 2
    s_add_u32 s17, s17, 192
    v_mov_b32 v48, s17
    v_mov_b32 v49, 1
    s_mov_b64 exec, 1
    global_atomic_add v48, v49, s[12:13]
    s_mov_b64 exec, -1
Lr_noadda:
    s_add_u32 m0, s58, 32768
    s_add_u32 s17, s57, 393216
    buffer_load_dwordx4 v62, s[20:23], s17 offen nt lds
    s_add_u32 m0, s58, 33792
    s_add_u32 s17, s57, 425984
    buffer_load_dwordx4 v62, s[20:23], s17 offen nt lds
    s_add_u32 m0, s58, 34816
    s_add_u32 s17, s57, 458752
    buffer_load_dwordx4 v63, s[20:23], s17 offen nt lds
    s_add_u32 m0, s58, 35840
    s_add_u32 s17, s57, 491520
    buffer_load_dwordx4 v63, s[20:23], s17 offen nt lds
    v_add_u32 v68, 49152, v66
    v_add_u32 v69, 49152, v67
    ds_read_b64_tr_b16 v[72:73], v68 offset:0
    ds_read_b64_tr_b16 v[74:75], v68 offset:1024
    ds_read_b64_tr_b16 v[76:77], v68 offset:8192
    ds_read_b64_tr_b16 v[78:79], v68 offset:9216
    ds_read_b64_tr_b16 v[80:81], v69 offset:0
    ds_read_b64_tr_b16 v[82:83], v69 offset:1024
    ds_read_b64_tr_b16 v[84:85], v69 offset:8192
    ds_read_b64_tr_b16 v[86:87], v69 offset:9216
    s_waitcnt lgkmcnt(0)
    s_waitcnt vmcnt(32)
    s_barrier
    s_add_u32 m0, s58, 49152
    s_add_u32 s17, s57, 393216
    buffer_load_dwordx4 v62, s[24:27], s17 offen nt lds
    s_add_u32 m0, s58, 50176
    s_add_u32 s17, s57, 425984
    buffer_load_dwordx4 v62, s[24:27], s17 offen nt lds
    s_add_u32 m0, s58, 51200
    s_add_u32 s17, s57, 458752
    buffer_load_dwordx4 v63, s[24:27], s17 offen nt lds
    s_add_u32 m0, s58, 52224
    s_add_u32 s17, s57, 491520
    buffer_load_dwordx4 v63, s[24:27], s17 offen nt lds
    v_add_u32 v68, 65536, v66
    v_add_u32 v69, 65536, v67
    ds_read_b64_tr_b16 v[88:89], v68 offset:0
    ds_read_b64_tr_b16 v[90:91], v68 offset:1024
    ds_read_b64_tr_b16 v[92:93], v68 offset:8192
    ds_read_b64_tr_b16 v[94:95], v68 offset:9216
    ds_read_b64_tr_b16 a[176:177], v69 offset:0
    ds_read_b64_tr_b16 a[178:179], v69 offset:1024
    ds_read_b64_tr_b16 a[180:181], v69 offset:8192
    ds_read_b64_tr_b16 a[182:183], v69 offset:9216
    s_waitcnt lgkmcnt(0)
    s_waitcnt vmcnt(32)
    s_barrier
    s_add_u32 m0, s58, 65536
    s_add_u32 s17, s57, 393216
    buffer_load_dwordx4 v62, s[28:31], s17 offen nt lds
    s_add_u32 m0, s58, 66560
    s_add_u32 s17, s57, 425984
    buffer_load_dwordx4 v62, s[28:31], s17 offen nt lds
    s_add_u32 m0, s58, 67584
    s_add_u32 s17, s57, 458752
    buffer_load_dwordx4 v63, s[28:31], s17 offen nt lds
    s_add_u32 m0, s58, 68608
    s_add_u32 s17, s57, 491520
    buffer_load_dwordx4 v63, s[28:31], s17 offen nt lds
    v_add_u32 v68, 81920, v66
    v_add_u32 v69, 81920, v67
    ds_read_b64_tr_b16 v[96:97], v68 offset:0
    ds_read_b64_tr_b16 v[98:99], v68 offset:1024
    ds_read_b64_tr_b16 v[100:101], v68 offset:8192
    ds_read_b64_tr_b16 v[102:103], v68 offset:9216
    ds_read_b64_tr_b16 v[104:105], v69 offset:0
    ds_read_b64_tr_b16 v[106:107], v69 offset:1024
    ds_read_b64_tr_b16 v[108:109], v69 offset:8192
    ds_read_b64_tr_b16 v[110:111], v69 offset:9216
    s_waitcnt lgkmcnt(0)
    s_waitcnt vmcnt(32)
    s_barrier
    s_add_u32 m0, s58, 81920
    s_add_u32 s17, s57, 524288
    buffer_load_dwordx4 v62, s[20:23], s17 offen nt lds
    s_add_u32 m0, s58, 82944
    s_add_u32 s17, s57, 557056
    buffer_load_dwordx4 v62, s[20:23], s17 offen nt lds
    s_add_u32 m0, s58, 83968
    s_add_u32 s17, s57, 589824
    buffer_load_dwordx4 v63, s[20:23], s17 offen nt lds
    s_add_u32 m0, s58, 84992
    s_add_u32 s17, s57, 622592
    buffer_load_dwordx4 v63, s[20:23], s17 offen nt lds
    v_add_u32 v68, 98304, v66
    v_add_u32 v69, 98304, v67
    ds_read_b64_tr_b16 v[112:113], v68 offset:0
    ds_read_b64_tr_b16 v[114:115], v68 offset:1024
    ds_read_b64_tr_b16 v[116:117], v68 offset:8192
    ds_read_b64_tr_b16 v[118:119], v68 offset:9216
    ds_read_b64_tr_b16 v[120:121], v69 offset:0
    ds_read_b64_tr_b16 v[122:123], v69 offset:1024
    ds_read_b64_tr_b16 v[124:125], v69 offset:8192
    ds_read_b64_tr_b16 v[126:127], v69 offset:9216
    s_waitcnt lgkmcnt(0)
    s_waitcnt vmcnt(32)
    s_barrier
    s_add_u32 m0, s58, 98304
    s_add_u32 s17, s57, 524288
    buffer_load_dwordx4 v62, s[24:27], s17 offen nt lds
    s_add_u32 m0, s58, 99328
    s_add_u32 s17, s57, 557056
    buffer_load_dwordx4 v62, s[24:27], s17 offen nt lds
    s_add_u32 m0, s58, 100352
    s_add_u32 s17, s57, 589824
    buffer_load_dwordx4 v63, s[24:27], s17 offen nt lds
    s_add_u32 m0, s58, 101376
    s_add_u32 s17, s57, 622592
    buffer_load_dwordx4 v63, s[24:27], s17 offen nt lds
    v_add_u32 v68, 114688, v66
    v_add_u32 v69, 114688, v67
    ds_read_b64_tr_b16 v[128:129], v68 offset:0
    ds_read_b64_tr_b16 v[130:131], v68 offset:1024
    ds_read_b64_tr_b16 v[132:133], v68 offset:8192
    ds_read_b64_tr_b16 v[134:135], v68 offset:9216
    ds_read_b64_tr_b16 a[184:185], v69 offset:0
    ds_read_b64_tr_b16 a[186:187], v69 offset:1024
    ds_read_b64_tr_b16 a[188:189], v69 offset:8192
    ds_read_b64_tr_b16 a[190:191], v69 offset:9216
    s_waitcnt lgkmcnt(0)
    s_waitcnt vmcnt(32)
    s_barrier
    s_add_u32 m0, s58, 114688
    s_add_u32 s17, s57, 524288
    buffer_load_dwordx4 v62, s[28:31], s17 offen nt lds
    s_add_u32 m0, s58, 115712
    s_add_u32 s17, s57, 557056
    buffer_load_dwordx4 v62, s[28:31], s17 offen nt lds
    s_add_u32 m0, s58, 116736
    s_add_u32 s17, s57, 589824
    buffer_load_dwordx4 v63, s[28:31], s17 offen nt lds
    s_add_u32 m0, s58, 117760
    s_add_u32 s17, s57, 622592
    buffer_load_dwordx4 v63, s[28:31], s17 offen nt lds
    v_add_u32 v68, 131072, v66
    v_add_u32 v69, 131072, v67
    ds_read_b64_tr_b16 v[136:137], v68 offset:0
    ds_read_b64_tr_b16 v[138:139], v68 offset:1024
    ds_read_b64_tr_b16 v[140:141], v68 offset:8192
    ds_read_b64_tr_b16 v[142:143], v68 offset:9216
    ds_read_b64_tr_b16 v[144:145], v69 offset:0
    ds_read_b64_tr_b16 v[146:147], v69 offset:1024
    ds_read_b64_tr_b16 v[148:149], v69 offset:8192
    ds_read_b64_tr_b16 v[150:151], v69 offset:9216
    s_waitcnt lgkmcnt(0)
    s_waitcnt vmcnt(32)
    s_barrier
    s_add_u32 m0, s58, 131072
    s_add_u32 s17, s57, 655360
    buffer_load_dwordx4 v62, s[20:23], s17 offen nt lds
    s_add_u32 m0, s58, 132096
    s_add_u32 s17, s57, 688128
    buffer_load_dwordx4 v62, s[20:23], s17 offen nt lds
    s_add_u32 m0, s58, 133120
    s_add_u32 s17, s57, 720896
    buffer_load_dwordx4 v63, s[20:23], s17 offen nt lds
    s_add_u32 m0, s58, 134144
    s_add_u32 s17, s57, 753664
    buffer_load_dwordx4 v63, s[20:23], s17 offen nt lds
    v_add_u32 v68, 147456, v66
    v_add_u32 v69, 147456, v67
    ds_read_b64_tr_b16 v[152:153], v68 offset:0
    ds_read_b64_tr_b16 v[154:155], v68 offset:1024
    ds_read_b64_tr_b16 v[156:157], v68 offset:8192
    ds_read_b64_tr_b16 v[158:159], v68 offset:9216
    ds_read_b64_tr_b16 v[160:161], v69 offset:0
    ds_read_b64_tr_b16 v[162:163], v69 offset:1024
    ds_read_b64_tr_b16 v[164:165], v69 offset:8192
    ds_read_b64_tr_b16 v[166:167], v69 offset:9216
    s_waitcnt lgkmcnt(0)
    s_waitcnt vmcnt(32)
    s_barrier
    s_add_u32 m0, s58, 147456
    s_add_u32 s17, s57, 655360
    buffer_load_dwordx4 v62, s[24:27], s17 offen nt lds
    s_add_u32 m0, s58, 148480
    s_add_u32 s17, s57, 688128
    buffer_load_dwordx4 v62, s[24:27], s17 offen nt lds
    s_add_u32 m0, s58, 149504
    s_add_u32 s17, s57, 720896
    buffer_load_dwordx4 v63, s[24:27], s17 offen nt lds
    s_add_u32 m0, s58, 150528
    s_add_u32 s17, s57, 753664
    buffer_load_dwordx4 v63, s[24:27], s17 offen nt lds
    v_add_u32 v68, 0, v66
    v_add_u32 v69, 0, v67
    ds_read_b64_tr_b16 v[168:169], v68 offset:0
    ds_read_b64_tr_b16 v[170:171], v68 offset:1024
    ds_read_b64_tr_b16 v[172:173], v68 offset:8192
    ds_read_b64_tr_b16 v[174:175], v68 offset:9216
    ds_read_b64_tr_b16 a[192:193], v69 offset:0
    ds_read_b64_tr_b16 a[194:195], v69 offset:1024
    ds_read_b64_tr_b16 a[196:197], v69 offset:8192
    ds_read_b64_tr_b16 a[198:199], v69 offset:9216
    s_waitcnt lgkmcnt(0)
    s_waitcnt vmcnt(32)
    s_barrier
    s_add_u32 m0, s58, 0
    s_add_u32 s17, s57, 655360
    buffer_load_dwordx4 v62, s[28:31], s17 offen nt lds
    s_add_u32 m0, s58, 1024
    s_add_u32 s17, s57, 688128
    buffer_load_dwordx4 v62, s[28:31], s17 offen nt lds
    s_add_u32 m0, s58, 2048
    s_add_u32 s17, s57, 720896
    buffer_load_dwordx4 v63, s[28:31], s17 offen nt lds
    s_add_u32 m0, s58, 3072
    s_add_u32 s17, s57, 753664
    buffer_load_dwordx4 v63, s[28:31], s17 offen nt lds
    v_add_u32 v68, 16384, v66
    v_add_u32 v69, 16384, v67
    ds_read_b64_tr_b16 v[176:177], v68 offset:0
    ds_read_b64_tr_b16 v[178:179], v68 offset:1024
    ds_read_b64_tr_b16 v[180:181], v68 offset:8192
    ds_read_b64_tr_b16 v[182:183], v68 offset:9216
    ds_read_b64_tr_b16 v[184:185], v69 offset:0
    ds_read_b64_tr_b16 v[186:187], v69 offset:1024
    ds_read_b64_tr_b16 v[188:189], v69 offset:8192
    ds_read_b64_tr_b16 v[190:191], v69 offset:9216
    s_waitcnt lgkmcnt(0)
    s_waitcnt vmcnt(32)
    s_barrier
    s_add_u32 m0, s58, 16384
    s_add_u32 s17, s57, 786432
    buffer_load_dwordx4 v62, s[20:23], s17 offen nt lds
    s_add_u32 m0, s58, 17408
    s_add_u32 s17, s57, 819200
    buffer_load_dwordx4 v62, s[20:23], s17 offen nt lds
    s_add_u32 m0, s58, 18432
    s_add_u32 s17, s57, 851968
    buffer_load_dwordx4 v63, s[20:23], s17 offen nt lds
    s_add_u32 m0, s58, 19456
    s_add_u32 s17, s57, 884736
    buffer_load_dwordx4 v63, s[20:23], s17 offen nt lds
    v_add_u32 v68, 32768, v66
    v_add_u32 v69, 32768, v67
    ds_read_b64_tr_b16 v[192:193], v68 offset:0
    ds_read_b64_tr_b16 v[194:195], v68 offset:1024
    ds_read_b64_tr_b16 v[196:197], v68 offset:8192
    ds_read_b64_tr_b16 v[198:199], v68 offset:9216
    ds_read_b64_tr_b16 v[200:201], v69 offset:0
    ds_read_b64_tr_b16 v[202:203], v69 offset:1024
    ds_read_b64_tr_b16 v[204:205], v69 offset:8192
    ds_read_b64_tr_b16 v[206:207], v69 offset:9216
    s_waitcnt lgkmcnt(0)
    s_waitcnt vmcnt(32)
    s_barrier
    s_add_u32 m0, s58, 32768
    s_add_u32 s17, s57, 786432
    buffer_load_dwordx4 v62, s[24:27], s17 offen nt lds
    s_add_u32 m0, s58, 33792
    s_add_u32 s17, s57, 819200
    buffer_load_dwordx4 v62, s[24:27], s17 offen nt lds
    s_add_u32 m0, s58, 34816
    s_add_u32 s17, s57, 851968
    buffer_load_dwordx4 v63, s[24:27], s17 offen nt lds
    s_add_u32 m0, s58, 35840
    s_add_u32 s17, s57, 884736
    buffer_load_dwordx4 v63, s[24:27], s17 offen nt lds
    v_add_u32 v68, 49152, v66
    v_add_u32 v69, 49152, v67
    ds_read_b64_tr_b16 v[208:209], v68 offset:0
    ds_read_b64_tr_b16 v[210:211], v68 offset:1024
    ds_read_b64_tr_b16 v[212:213], v68 offset:8192
    ds_read_b64_tr_b16 v[214:215], v68 offset:9216
    ds_read_b64_tr_b16 a[200:201], v69 offset:0
    ds_read_b64_tr_b16 a[202:203], v69 offset:1024
    ds_read_b64_tr_b16 a[204:205], v69 offset:8192
    ds_read_b64_tr_b16 a[206:207], v69 offset:9216
    s_waitcnt lgkmcnt(0)
    s_waitcnt vmcnt(32)
    s_barrier
    s_add_u32 m0, s58, 49152
    s_add_u32 s17, s57, 786432
    buffer_load_dwordx4 v62, s[28:31], s17 offen nt lds
    s_add_u32 m0, s58, 50176
    s_add_u32 s17, s57, 819200
    buffer_load_dwordx4 v62, s[28:31], s17 offen nt lds
    s_add_u32 m0, s58, 51200
    s_add_u32 s17, s57, 851968
    buffer_load_dwordx4 v63, s[28:31], s17 offen nt lds
    s_add_u32 m0, s58, 52224
    s_add_u32 s17, s57, 884736
    buffer_load_dwordx4 v63, s[28:31], s17 offen nt lds
    v_add_u32 v68, 65536, v66
    v_add_u32 v69, 65536, v67
    ds_read_b64_tr_b16 v[216:217], v68 offset:0
    ds_read_b64_tr_b16 v[218:219], v68 offset:1024
    ds_read_b64_tr_b16 v[220:221], v68 offset:8192
    ds_read_b64_tr_b16 v[222:223], v68 offset:9216
    ds_read_b64_tr_b16 v[224:225], v69 offset:0
    ds_read_b64_tr_b16 v[226:227], v69 offset:1024
    ds_read_b64_tr_b16 v[228:229], v69 offset:8192
    ds_read_b64_tr_b16 v[230:231], v69 offset:9216
    s_waitcnt lgkmcnt(0)
    s_waitcnt vmcnt(32)
    s_barrier
    s_add_u32 m0, s58, 65536
    s_add_u32 s17, s57, 917504
    buffer_load_dwordx4 v62, s[20:23], s17 offen nt lds
    s_add_u32 m0, s58, 66560
    s_add_u32 s17, s57, 950272
    buffer_load_dwordx4 v62, s[20:23], s17 offen nt lds
    s_add_u32 m0, s58, 67584
    s_add_u32 s17, s57, 983040
    buffer_load_dwordx4 v63, s[20:23], s17 offen nt lds
    s_add_u32 m0, s58, 68608
    s_add_u32 s17, s57, 1015808
    buffer_load_dwordx4 v63, s[20:23], s17 offen nt lds
    v_add_u32 v68, 81920, v66
    v_add_u32 v69, 81920, v67
    ds_read_b64_tr_b16 v[232:233], v68 offset:0
    ds_read_b64_tr_b16 v[234:235], v68 offset:1024
    ds_read_b64_tr_b16 v[236:237], v68 offset:8192
    ds_read_b64_tr_b16 v[238:239], v68 offset:9216
    ds_read_b64_tr_b16 v[240:241], v69 offset:0
    ds_read_b64_tr_b16 v[242:243], v69 offset:1024
    ds_read_b64_tr_b16 v[244:245], v69 offset:8192
    ds_read_b64_tr_b16 v[246:247], v69 offset:9216
    s_waitcnt lgkmcnt(0)
    s_waitcnt vmcnt(32)
    s_barrier
    s_add_u32 m0, s58, 81920
    s_add_u32 s17, s57, 917504
    buffer_load_dwordx4 v62, s[24:27], s17 offen nt lds
    s_add_u32 m0, s58, 82944
    s_add_u32 s17, s57, 950272
    buffer_load_dwordx4 v62, s[24:27], s17 offen nt lds
    s_add_u32 m0, s58, 83968
    s_add_u32 s17, s57, 983040
    buffer_load_dwordx4 v63, s[24:27], s17 offen nt lds
    s_add_u32 m0, s58, 84992
    s_add_u32 s17, s57, 1015808
    buffer_load_dwordx4 v63, s[24:27], s17 offen nt lds
    v_add_u32 v68, 98304, v66
    v_add_u32 v69, 98304, v67
    ds_read_b64_tr_b16 v[248:249], v68 offset:0
    ds_read_b64_tr_b16 v[250:251], v68 offset:1024
    ds_read_b64_tr_b16 v[252:253], v68 offset:8192
    ds_read_b64_tr_b16 v[254:255], v68 offset:9216
    ds_read_b64_tr_b16 a[208:209], v69 offset:0
    ds_read_b64_tr_b16 a[210:211], v69 offset:1024
    ds_read_b64_tr_b16 a[212:213], v69 offset:8192
    ds_read_b64_tr_b16 a[214:215], v69 offset:9216
    s_waitcnt lgkmcnt(0)
    s_waitcnt vmcnt(32)
    s_barrier
    s_add_u32 m0, s58, 98304
    s_add_u32 s17, s57, 917504
    buffer_load_dwordx4 v62, s[28:31], s17 offen nt lds
    s_add_u32 m0, s58, 99328
    s_add_u32 s17, s57, 950272
    buffer_load_dwordx4 v62, s[28:31], s17 offen nt lds
    s_add_u32 m0, s58, 100352
    s_add_u32 s17, s57, 983040
    buffer_load_dwordx4 v63, s[28:31], s17 offen nt lds
    s_add_u32 m0, s58, 101376
    s_add_u32 s17, s57, 1015808
    buffer_load_dwordx4 v63, s[28:31], s17 offen nt lds
    v_add_u32 v68, 114688, v66
    v_add_u32 v69, 114688, v67
    ds_read_b64_tr_b16 a[0:1], v68 offset:0
    ds_read_b64_tr_b16 a[2:3], v68 offset:1024
    ds_read_b64_tr_b16 a[4:5], v68 offset:8192
    ds_read_b64_tr_b16 a[6:7], v68 offset:9216
    ds_read_b64_tr_b16 a[8:9], v69 offset:0
    ds_read_b64_tr_b16 a[10:11], v69 offset:1024
    ds_read_b64_tr_b16 a[12:13], v69 offset:8192
    ds_read_b64_tr_b16 a[14:15], v69 offset:9216
    s_waitcnt lgkmcnt(0)
    s_waitcnt vmcnt(32)
    s_barrier
    s_add_u32 m0, s58, 114688
    s_add_u32 s17, s57, 1048576
    buffer_load_dwordx4 v64, s[20:23], s17 offen nt lds
    s_add_u32 m0, s58, 115712
    s_add_u32 s17, s57, 1056768
    buffer_load_dwordx4 v64, s[20:23], s17 offen nt lds
    s_add_u32 m0, s58, 116736
    s_add_u32 s17, s57, 1064960
    buffer_load_dwordx4 v65, s[20:23], s17 offen nt lds
    s_add_u32 m0, s58, 117760
    s_add_u32 s17, s57, 1073152
    buffer_load_dwordx4 v65, s[20:23], s17 offen nt lds
    v_add_u32 v68, 131072, v66
    v_add_u32 v69, 131072, v67
    ds_read_b64_tr_b16 a[16:17], v68 offset:0
    ds_read_b64_tr_b16 a[18:19], v68 offset:1024
    ds_read_b64_tr_b16 a[20:21], v68 offset:8192
    ds_read_b64_tr_b16 a[22:23], v68 offset:9216
    ds_read_b64_tr_b16 a[24:25], v69 offset:0
    ds_read_b64_tr_b16 a[26:27], v69 offset:1024
    ds_read_b64_tr_b16 a[28:29], v69 offset:8192
    ds_read_b64_tr_b16 a[30:31], v69 offset:9216
    s_waitcnt lgkmcnt(0)
    s_waitcnt vmcnt(32)
    s_barrier
    s_add_u32 m0, s58, 131072
    s_add_u32 s17, s57, 1048576
    buffer_load_dwordx4 v64, s[24:27], s17 offen nt lds
    s_add_u32 m0, s58, 132096
    s_add_u32 s17, s57, 1056768
    buffer_load_dwordx4 v64, s[24:27], s17 offen nt lds
    s_add_u32 m0, s58, 133120
    s_add_u32 s17, s57, 1064960
    buffer_load_dwordx4 v65, s[24:27], s17 offen nt lds
    s_add_u32 m0, s58, 134144
    s_add_u32 s17, s57, 1073152
    buffer_load_dwordx4 v65, s[24:27], s17 offen nt lds
    v_add_u32 v68, 147456, v66
    v_add_u32 v69, 147456, v67
    ds_read_b64_tr_b16 a[32:33], v68 offset:0
    ds_read_b64_tr_b16 a[34:35], v68 offset:1024
    ds_read_b64_tr_b16 a[36:37], v68 offset:8192
    ds_read_b64_tr_b16 a[38:39], v68 offset:9216
    ds_read_b64_tr_b16 a[216:217], v69 offset:0
    ds_read_b64_tr_b16 a[218:219], v69 offset:1024
    ds_read_b64_tr_b16 a[220:221], v69 offset:8192
    ds_read_b64_tr_b16 a[222:223], v69 offset:9216
    s_waitcnt lgkmcnt(0)
    s_waitcnt vmcnt(32)
    s_barrier
    s_add_u32 m0, s58, 147456
    s_add_u32 s17, s57, 1048576
    buffer_load_dwordx4 v64, s[28:31], s17 offen nt lds
    s_add_u32 m0, s58, 148480
    s_add_u32 s17, s57, 1056768
    buffer_load_dwordx4 v64, s[28:31], s17 offen nt lds
    s_add_u32 m0, s58, 149504
    s_add_u32 s17, s57, 1064960
    buffer_load_dwordx4 v65, s[28:31], s17 offen nt lds
    s_add_u32 m0, s58, 150528
    s_add_u32 s17, s57, 1073152
    buffer_load_dwordx4 v65, s[28:31], s17 offen nt lds
    v_add_u32 v68, 0, v66
    v_add_u32 v69, 0, v67
    ds_read_b64_tr_b16 a[40:41], v68 offset:0
    ds_read_b64_tr_b16 a[42:43], v68 offset:1024
    ds_read_b64_tr_b16 a[44:45], v68 offset:8192
    ds_read_b64_tr_b16 a[46:47], v68 offset:9216
    ds_read_b64_tr_b16 a[48:49], v69 offset:0
    ds_read_b64_tr_b16 a[50:51], v69 offset:1024
    ds_read_b64_tr_b16 a[52:53], v69 offset:8192
    ds_read_b64_tr_b16 a[54:55], v69 offset:9216
    s_waitcnt lgkmcnt(0)
    s_waitcnt vmcnt(32)
    s_barrier
    v_add_u32 v68, 16384, v66
    v_add_u32 v69, 16384, v67
    ds_read_b64_tr_b16 a[56:57], v68 offset:0
    ds_read_b64_tr_b16 a[58:59], v68 offset:1024
    ds_read_b64_tr_b16 a[60:61], v68 offset:8192
    ds_read_b64_tr_b16 a[62:63], v68 offset:9216
    ds_read_b64_tr_b16 a[64:65], v69 offset:0
    ds_read_b64_tr_b16 a[66:67], v69 offset:1024
    ds_read_b64_tr_b16 a[68:69], v69 offset:8192
    ds_read_b64_tr_b16 a[70:71], v69 offset:9216
    s_waitcnt lgkmcnt(0)
    s_waitcnt vmcnt(28)
    s_barrier
    v_add_u32 v68, 32768, v66
    v_add_u32 v69, 32768, v67
    ds_read_b64_tr_b16 a[72:73], v68 offset:0
    ds_read_b64_tr_b16 a[74:75], v68 offset:1024
    ds_read_b64_tr_b16 a[76:77], v68 offset:8192
    ds_read_b64_tr_b16 a[78:79], v68 offset:9216
    ds_read_b64_tr_b16 a[224:225], v69 offset:0
    ds_read_b64_tr_b16 a[226:227], v69 offset:1024
    ds_read_b64_tr_b16 a[228:229], v69 offset:8192
    ds_read_b64_tr_b16 a[230:231], v69 offset:9216
    s_waitcnt lgkmcnt(0)
    s_waitcnt vmcnt(24)
    s_barrier
    v_add_u32 v68, 49152, v66
    v_add_u32 v69, 49152, v67
    ds_read_b64_tr_b16 a[80:81], v68 offset:0
    ds_read_b64_tr_b16 a[82:83], v68 offset:1024
    ds_read_b64_tr_b16 a[84:85], v68 offset:8192
    ds_read_b64_tr_b16 a[86:87], v68 offset:9216
    ds_read_b64_tr_b16 a[88:89], v69 offset:0
    ds_read_b64_tr_b16 a[90:91], v69 offset:1024
    ds_read_b64_tr_b16 a[92:93], v69 offset:8192
    ds_read_b64_tr_b16 a[94:95], v69 offset:9216
    s_waitcnt lgkmcnt(0)
    s_waitcnt vmcnt(20)
    s_barrier
    s_add_u32 s17, s59, 0
    s_add_u32 m0, s60, 0
    s_nop 0
    buffer_load_dwordx4 v50, s[80:83], s17 offen nt lds
    s_add_u32 m0, s60, 1024
    s_nop 0
    buffer_load_dwordx4 v51, s[80:83], s17 offen nt lds
    s_add_u32 m0, s60, 2048
    s_nop 0
    buffer_load_dwordx4 v52, s[80:83], s17 offen nt lds
    s_add_u32 m0, s60, 3072
    s_nop 0
    buffer_load_dwordx4 v53, s[80:83], s17 offen nt lds
    s_add_u32 m0, s60, 4096
    s_mov_b64 exec, s[52:53]
    buffer_load_dwordx4 v54, s[80:83], s17 offen nt lds
    s_mov_b64 exec, -1
    v_add_u32 v68, 65536, v66
    v_add_u32 v69, 65536, v67
    ds_read_b64_tr_b16 a[96:97], v68 offset:0
    ds_read_b64_tr_b16 a[98:99], v68 offset:1024
    ds_read_b64_tr_b16 a[100:101], v68 offset:8192
    ds_read_b64_tr_b16 a[102:103], v68 offset:9216
    ds_read_b64_tr_b16 a[104:105], v69 offset:0
    ds_read_b64_tr_b16 a[106:107], v69 offset:1024
    ds_read_b64_tr_b16 a[108:109], v69 offset:8192
    ds_read_b64_tr_b16 a[110:111], v69 offset:9216
    s_waitcnt lgkmcnt(0)
    s_waitcnt vmcnt(21)
    s_barrier
    s_add_u32 s17, s59, 1152
    s_add_u32 m0, s60, 18432
    s_nop 0
    buffer_load_dwordx4 v50, s[80:83], s17 offen nt lds
    s_add_u32 m0, s60, 19456
    s_nop 0
    buffer_load_dwordx4 v51, s[80:83], s17 offen nt lds
    s_add_u32 m0, s60, 20480
    s_nop 0
    buffer_load_dwordx4 v52, s[80:83], s17 offen nt lds
    s_add_u32 m0, s60, 21504
    s_nop 0
    buffer_load_dwordx4 v53, s[80:83], s17 offen nt lds
    s_add_u32 m0, s60, 22528
    s_mov_b64 exec, s[52:53]
    buffer_load_dwordx4 v54, s[80:83], s17 offen nt lds
    s_mov_b64 exec, -1
    v_add_u32 v68, 81920, v66
    v_add_u32 v69, 81920, v67
    ds_read_b64_tr_b16 a[112:113], v68 offset:0
    ds_read_b64_tr_b16 a[114:115], v68 offset:1024
    ds_read_b64_tr_b16 a[116:117], v68 offset:8192
    ds_read_b64_tr_b16 a[118:119], v68 offset:9216
    ds_read_b64_tr_b16 a[232:233], v69 offset:0
    ds_read_b64_tr_b16 a[234:235], v69 offset:1024
    ds_read_b64_tr_b16 a[236:237], v69 offset:8192
    ds_read_b64_tr_b16 a[238:239], v69 offset:9216
    s_waitcnt lgkmcnt(0)
    s_waitcnt vmcnt(22)
    s_barrier
    s_add_u32 s17, s59, 36864
    s_add_u32 m0, s60, 36864
    s_nop 0
    buffer_load_dwordx4 v50, s[80:83], s17 offen nt lds
    s_add_u32 m0, s60, 37888
    s_nop 0
    buffer_load_dwordx4 v51, s[80:83], s17 offen nt lds
    s_add_u32 m0, s60, 38912
    s_nop 0
    buffer_load_dwordx4 v52, s[80:83], s17 offen nt lds
    s_add_u32 m0, s60, 39936
    s_nop 0
    buffer_load_dwordx4 v53, s[80:83], s17 offen nt lds
    s_add_u32 m0, s60, 40960
    s_mov_b64 exec, s[52:53]
    buffer_load_dwordx4 v54, s[80:83], s17 offen nt lds
    s_mov_b64 exec, -1
    v_add_u32 v68, 98304, v66
    v_add_u32 v69, 98304, v67
    ds_read_b64_tr_b16 a[120:121], v68 offset:0
    ds_read_b64_tr_b16 a[122:123], v68 offset:1024
    ds_read_b64_tr_b16 a[124:125], v68 offset:8192
    ds_read_b64_tr_b16 a[126:127], v68 offset:9216
    ds_read_b64_tr_b16 a[128:129], v69 offset:0
    ds_read_b64_tr_b16 a[130:131], v69 offset:1024
    ds_read_b64_tr_b16 a[132:133], v69 offset:8192
    ds_read_b64_tr_b16 a[134:135], v69 offset:9216
    s_waitcnt lgkmcnt(0)
    s_waitcnt vmcnt(23)
    s_barrier
    v_add_u32 v68, 114688, v66
    v_add_u32 v69, 114688, v67
    ds_read_b64_tr_b16 a[136:137], v68 offset:0
    ds_read_b64_tr_b16 a[138:139], v68 offset:1024
    ds_read_b64_tr_b16 a[140:141], v68 offset:8192
    ds_read_b64_tr_b16 a[142:143], v68 offset:9216
    ds_read_b64_tr_b16 a[144:145], v69 offset:0
    ds_read_b64_tr_b16 a[146:147], v69 offset:1024
    ds_read_b64_tr_b16 a[148:149], v69 offset:8192
    ds_read_b64_tr_b16 a[150:151], v69 offset:9216
    s_waitcnt lgkmcnt(0)
    s_waitcnt vmcnt(19)
    s_barrier
    v_add_u32 v68, 131072, v66
    v_add_u32 v69, 131072, v67
    ds_read_b64_tr_b16 a[152:153], v68 offset:0
    ds_read_b64_tr_b16 a[154:155], v68 offset:1024
    ds_read_b64_tr_b16 a[156:157], v68 offset:8192
    ds_read_b64_tr_b16 a[158:159], v68 offset:9216
    ds_read_b64_tr_b16 a[240:241], v69 offset:0
    ds_read_b64_tr_b16 a[242:243], v69 offset:1024
    ds_read_b64_tr_b16 a[244:245], v69 offset:8192
    ds_read_b64_tr_b16 a[246:247], v69 offset:9216
    s_waitcnt lgkmcnt(0)
    s_waitcnt vmcnt(15)
    s_barrier
    v_add_u32 v68, 147456, v66
    v_add_u32 v69, 147456, v67
    ds_read_b64_tr_b16 a[160:161], v68 offset:0
    ds_read_b64_tr_b16 a[162:163], v68 offset:1024
    ds_read_b64_tr_b16 a[164:165], v68 offset:8192
    ds_read_b64_tr_b16 a[166:167], v68 offset:9216
    ds_read_b64_tr_b16 a[168:169], v69 offset:0
    ds_read_b64_tr_b16 a[170:171], v69 offset:1024
    ds_read_b64_tr_b16 a[172:173], v69 offset:8192
    ds_read_b64_tr_b16 a[174:175], v69 offset:9216
    s_waitcnt lgkmcnt(0)
    s_barrier
    ds_write_b128 v9, a[176:179] offset:0
    ds_write_b128 v9, a[180:183] offset:1024
    ds_write_b128 v9, a[184:187] offset:2048
    ds_write_b128 v9, a[188:191] offset:3072
    ds_write_b128 v9, a[192:195] offset:4096
    ds_write_b128 v9, a[196:199] offset:5120
    ds_write_b128 v9, a[200:203] offset:6144
    ds_write_b128 v9, a[204:207] offset:7168
    ds_write_b128 v9, a[208:211] offset:8192
    ds_write_b128 v9, a[212:215] offset:9216
    ds_write_b128 v9, a[216:219] offset:10240
    ds_write_b128 v9, a[220:223] offset:11264
    ds_write_b128 v9, a[224:227] offset:12288
    ds_write_b128 v9, a[228:231] offset:13312
    ds_write_b128 v9, a[232:235] offset:14336
    ds_write_b128 v9, a[236:239] offset:15360
    ds_write_b128 v9, a[240:243] offset:16384
    ds_write_b128 v9, a[244:247] offset:17408
    s_waitcnt lgkmcnt(0)
    s_waitcnt vmcnt(10)
    s_barrier
    ds_read_b64_tr_b16 a[176:177], v70 offset:0
    ds_read_b64_tr_b16 a[192:193], v70 offset:32
    ds_read_b64_tr_b16 v[12:13], v70 offset:64
    ds_read_b64_tr_b16 a[208:209], v70 offset:96
    ds_read_b64_tr_b16 v[20:21], v70 offset:128
    ds_read_b64_tr_b16 a[224:225], v70 offset:160
    ds_read_b64_tr_b16 a[240:241], v70 offset:192
    ds_read_b64_tr_b16 v[28:29], v70 offset:224
    ds_read_b64_tr_b16 v[36:37], v70 offset:256
    s_waitcnt lgkmcnt(0)
    s_waitcnt vmcnt(5)
    s_barrier
    s_add_u32 s17, s59, 38016
    s_add_u32 m0, s60, 0
    s_nop 0
    buffer_load_dwordx4 v50, s[80:83], s17 offen nt lds
    s_add_u32 m0, s60, 1024
    s_nop 0
    buffer_load_dwordx4 v51, s[80:83], s17 offen nt lds
    s_add_u32 m0, s60, 2048
    s_nop 0
    buffer_load_dwordx4 v52, s[80:83], s17 offen nt lds
    s_add_u32 m0, s60, 3072
    s_nop 0
    buffer_load_dwordx4 v53, s[80:83], s17 offen nt lds
    s_add_u32 m0, s60, 4096
    s_mov_b64 exec, s[52:53]
    buffer_load_dwordx4 v54, s[80:83], s17 offen nt lds
    s_mov_b64 exec, -1
    ds_read_b64_tr_b16 a[178:179], v70 offset:18432
    ds_read_b64_tr_b16 a[194:195], v70 offset:18464
    ds_read_b64_tr_b16 v[14:15], v70 offset:18496
    ds_read_b64_tr_b16 a[210:211], v70 offset:18528
    ds_read_b64_tr_b16 v[22:23], v70 offset:18560
    ds_read_b64_tr_b16 a[226:227], v70 offset:18592
    ds_read_b64_tr_b16 a[242:243], v70 offset:18624
    ds_read_b64_tr_b16 v[30:31], v70 offset:18656
    ds_read_b64_tr_b16 v[38:39], v70 offset:18688
    s_waitcnt lgkmcnt(0)
    s_waitcnt vmcnt(5)
    s_barrier
    s_add_u32 s17, s59, 73728
    s_add_u32 m0, s60, 18432
    s_nop 0
    buffer_load_dwordx4 v50, s[80:83], s17 offen nt lds
    s_add_u32 m0, s60, 19456
    s_nop 0
    buffer_load_dwordx4 v51, s[80:83], s17 offen nt lds
    s_add_u32 m0, s60, 20480
    s_nop 0
    buffer_load_dwordx4 v52, s[80:83], s17 offen nt lds
    s_add_u32 m0, s60, 21504
    s_nop 0
    buffer_load_dwordx4 v53, s[80:83], s17 offen nt lds
    s_add_u32 m0, s60, 22528
    s_mov_b64 exec, s[52:53]
    buffer_load_dwordx4 v54, s[80:83], s17 offen nt lds
    s_mov_b64 exec, -1
    ds_read_b64_tr_b16 a[180:181], v70 offset:36864
    ds_read_b64_tr_b16 a[196:197], v70 offset:36896
    ds_read_b64_tr_b16 v[16:17], v70 offset:36928
    ds_read_b64_tr_b16 a[212:213], v70 offset:36960
    ds_read_b64_tr_b16 v[24:25], v70 offset:36992
    ds_read_b64_tr_b16 a[228:229], v70 offset:37024
    ds_read_b64_tr_b16 a[244:245], v70 offset:37056
    ds_read_b64_tr_b16 v[32:33], v70 offset:37088
    ds_read_b64_tr_b16 v[40:41], v70 offset:37120
    s_waitcnt lgkmcnt(0)
    s_waitcnt vmcnt(5)
    s_barrier
    s_add_u32 s17, s59, 74880
    s_add_u32 m0, s60, 36864
    s_nop 0
    buffer_load_dwordx4 v50, s[80:83], s17 offen nt lds
    s_add_u32 m0, s60, 37888
    s_nop 0
    buffer_load_dwordx4 v51, s[80:83], s17 offen nt lds
    s_add_u32 m0, s60, 38912
    s_nop 0
    buffer_load_dwordx4 v52, s[80:83], s17 offen nt lds
    s_add_u32 m0, s60, 39936
    s_nop 0
    buffer_load_dwordx4 v53, s[80:83], s17 offen nt lds
    s_add_u32 m0, s60, 40960
    s_mov_b64 exec, s[52:53]
    buffer_load_dwordx4 v54, s[80:83], s17 offen nt lds
    s_mov_b64 exec, -1
    ds_read_b64_tr_b16 a[182:183], v70 offset:0
    ds_read_b64_tr_b16 a[198:199], v70 offset:32
    ds_read_b64_tr_b16 v[18:19], v70 offset:64
    ds_read_b64_tr_b16 a[214:215], v70 offset:96
    ds_read_b64_tr_b16 v[26:27], v70 offset:128
    ds_read_b64_tr_b16 a[230:231], v70 offset:160
    ds_read_b64_tr_b16 a[246:247], v70 offset:192
    ds_read_b64_tr_b16 v[34:35], v70 offset:224
    ds_read_b64_tr_b16 v[42:43], v70 offset:256
    s_waitcnt lgkmcnt(0)
    ds_write_b128 v9, v[12:15] offset:18432
    ds_write_b128 v9, v[16:19] offset:19456
    ds_write_b128 v9, v[20:23] offset:20480
    ds_write_b128 v9, v[24:27] offset:21504
    ds_write_b128 v9, v[28:31] offset:22528
    ds_write_b128 v9, v[32:35] offset:23552
    ds_write_b128 v9, v[36:39] offset:24576
    ds_write_b128 v9, v[40:43] offset:25600
    s_waitcnt lgkmcnt(0)
    s_waitcnt vmcnt(5)
    s_barrier
    s_add_u32 s17, s59, 110592
    s_add_u32 m0, s60, 0
    s_nop 0
    buffer_load_dwordx4 v50, s[80:83], s17 offen nt lds
    s_add_u32 m0, s60, 1024
    s_nop 0
    buffer_load_dwordx4 v51, s[80:83], s17 offen nt lds
    s_add_u32 m0, s60, 2048
    s_nop 0
    buffer_load_dwordx4 v52, s[80:83], s17 offen nt lds
    s_add_u32 m0, s60, 3072
    s_nop 0
    buffer_load_dwordx4 v53, s[80:83], s17 offen nt lds
    s_add_u32 m0, s60, 4096
    s_mov_b64 exec, s[52:53]
    buffer_load_dwordx4 v54, s[80:83], s17 offen nt lds
    s_mov_b64 exec, -1
    ds_read_b64_tr_b16 a[184:185], v70 offset:18432
    ds_read_b64_tr_b16 v[12:13], v70 offset:18464
    ds_read_b64_tr_b16 a[200:201], v70 offset:18496
    ds_read_b64_tr_b16 a[216:217], v70 offset:18528
    ds_read_b64_tr_b16 v[20:21], v70 offset:18560
    ds_read_b64_tr_b16 a[232:233], v70 offset:18592
    ds_read_b64_tr_b16 v[28:29], v70 offset:18624
    ds_read_b64_tr_b16 a[248:249], v70 offset:18656
    ds_read_b64_tr_b16 v[36:37], v70 offset:18688
    s_waitcnt lgkmcnt(0)
    s_waitcnt vmcnt(5)
    s_barrier
    s_add_u32 s17, s59, 111744
    s_add_u32 m0, s60, 18432
    s_nop 0
    buffer_load_dwordx4 v50, s[80:83], s17 offen nt lds
    s_add_u32 m0, s60, 19456
    s_nop 0
    buffer_load_dwordx4 v51, s[80:83], s17 offen nt lds
    s_add_u32 m0, s60, 20480
    s_nop 0
    buffer_load_dwordx4 v52, s[80:83], s17 offen nt lds
    s_add_u32 m0, s60, 21504
    s_nop 0
    buffer_load_dwordx4 v53, s[80:83], s17 offen nt lds
    s_add_u32 m0, s60, 22528
    s_mov_b64 exec, s[52:53]
    buffer_load_dwordx4 v54, s[80:83], s17 offen nt lds
    s_mov_b64 exec, -1
    ds_read_b64_tr_b16 a[186:187], v70 offset:36864
    ds_read_b64_tr_b16 v[14:15], v70 offset:36896
    ds_read_b64_tr_b16 a[202:203], v70 offset:36928
    ds_read_b64_tr_b16 a[218:219], v70 offset:36960
    ds_read_b64_tr_b16 v[22:23], v70 offset:36992
    ds_read_b64_tr_b16 a[234:235], v70 offset:37024
    ds_read_b64_tr_b16 v[30:31], v70 offset:37056
    ds_read_b64_tr_b16 a[250:251], v70 offset:37088
    ds_read_b64_tr_b16 v[38:39], v70 offset:37120
    s_waitcnt lgkmcnt(0)
    s_waitcnt vmcnt(5)
    s_barrier
    ds_read_b64_tr_b16 a[188:189], v70 offset:0
    ds_read_b64_tr_b16 v[16:17], v70 offset:32
    ds_read_b64_tr_b16 a[204:205], v70 offset:64
    ds_read_b64_tr_b16 a[220:221], v70 offset:96
    ds_read_b64_tr_b16 v[24:25], v70 offset:128
    ds_read_b64_tr_b16 a[236:237], v70 offset:160
    ds_read_b64_tr_b16 v[32:33], v70 offset:192
    ds_read_b64_tr_b16 a[252:253], v70 offset:224
    ds_read_b64_tr_b16 v[40:41], v70 offset:256
    s_waitcnt lgkmcnt(0)
    s_waitcnt vmcnt(0)
    s_barrier
    ds_read_b64_tr_b16 a[190:191], v70 offset:18432
    ds_read_b64_tr_b16 v[18:19], v70 offset:18464
    ds_read_b64_tr_b16 a[206:207], v70 offset:18496
    ds_read_b64_tr_b16 a[222:223], v70 offset:18528
    ds_read_b64_tr_b16 v[26:27], v70 offset:18560
    ds_read_b64_tr_b16 a[238:239], v70 offset:18592
    ds_read_b64_tr_b16 v[34:35], v70 offset:18624
    ds_read_b64_tr_b16 a[254:255], v70 offset:18656
    ds_read_b64_tr_b16 v[42:43], v70 offset:18688
    s_waitcnt lgkmcnt(0)
    s_barrier
    s_lshl_b32 s17, s14, 13
    v_add_u32 v71, s17, v0
    ds_write_b128 v71, v[12:15] offset:24576
    ds_write_b128 v71, v[16:19] offset:25600
    ds_write_b128 v71, v[20:23] offset:26624
    ds_write_b128 v71, v[24:27] offset:27648
    ds_write_b128 v71, v[28:31] offset:28672
    ds_write_b128 v71, v[32:35] offset:29696
    ds_write_b128 v71, v[36:39] offset:30720
    ds_write_b128 v71, v[40:43] offset:31744
    s_waitcnt vmcnt(0) lgkmcnt(0)
    s_barrier
    s_branch Lr_ldd
Lr_ld1:
    s_load_dwordx2 s[20:21], s[0:1], 40
    s_mov_b32 s22, 4718592
    s_mov_b32 s23, 0x00020000
    s_waitcnt lgkmcnt(0)
    s_and_b32 s21, s21, 0xffff
    s_load_dwordx2 s[24:25], s[0:1], 48
    s_mov_b32 s26, 4718592
    s_mov_b32 s27, 0x00020000
    s_waitcnt lgkmcnt(0)
    s_and_b32 s25, s25, 0xffff
    s_load_dwordx2 s[28:29], s[0:1], 56
    s_mov_b32 s30, 4718592
    s_mov_b32 s31, 0x00020000
    s_waitcnt lgkmcnt(0)
    s_and_b32 s29, s29, 0xffff
    s_load_dwordx2 s[80:81], s[0:1], 64
    s_mov_b32 s82, 4718592
    s_mov_b32 s83, 0x00020000
    s_waitcnt lgkmcnt(0)
    s_and_b32 s81, s81, 0xffff
    v_lshlrev_b32 v71, 1, v61
    v_xor_b32 v71, v71, v60
    v_lshlrev_b32 v71, 4, v71
    v_lshl_add_u32 v62, v61, 13, v71
    v_xor_b32 v63, 128, v62
    v_lshrrev_b32 v64, 1, v61
    v_lshlrev_b32 v64, 3, v64
    v_and_b32 v65, 1, v61
    v_lshl_add_u32 v64, v65, 2, v64
    v_lshl_add_u32 v64, v64, 13, v71
    v_xor_b32 v65, 128, v64
    s_mul_i32 s57, s14, 1179648
    s_lshl_b32 s17, s15, 8
    s_add_u32 s57, s57, s17
    s_lshl_b32 s58, s14, 12
    v_lshrrev_b32 v71, 2, v60
    v_lshl_add_u32 v66, v61, 3, v71
    v_lshlrev_b32 v66, 8, v66
    v_bfe_u32 v67, v60, 1, 1
    s_lshl_b32 s17, s14, 2
    v_add_u32 v67, s17, v67
    v_lshlrev_b32 v71, 1, v71
    v_xor_b32 v67, v67, v71
    v_and_b32 v71, 1, v61
    v_lshlrev_b32 v71, 3, v71
    v_xor_b32 v67, v67, v71
    v_and_b32 v71, 1, v60
    v_lshl_add_u32 v66, v71, 3, v66
    v_xor_b32 v71, 2, v67
    v_lshl_add_u32 v67, v71, 4, v66
    v_xor_b32 v71, 2, v71
    v_lshl_add_u32 v66, v71, 4, v66
    v_lshrrev_b32 v71, 2, v60
    v_lshl_add_u32 v70, v61, 2, v71
    v_mul_u32_u24 v70, 1152, v70
    v_and_b32 v71, 3, v60
    v_lshl_add_u32 v70, v71, 3, v70
    s_mul_i32 s17, s14, 288
    v_add_u32 v70, s17, v70
    v_add_u32 v71, 0, v10
    v_mul_u32_u24 v59, 911, v71
    v_lshrrev_b32 v59, 16, v59
    v_mul_u32_u24 v60, 72, v59
    v_sub_u32 v71, v71, v60
    v_and_b32 v60, 1, v59
    v_lshlrev_b32 v60, 4, v60
    v_lshrrev_b32 v59, 1, v59
    v_lshl_add_u32 v60, v59, 2, v60
    v_mul_u32_u24 v60, 1152, v60
    v_lshl_add_u32 v50, v71, 4, v60
    v_add_u32 v71, 64, v10
    v_mul_u32_u24 v59, 911, v71
    v_lshrrev_b32 v59, 16, v59
    v_mul_u32_u24 v60, 72, v59
    v_sub_u32 v71, v71, v60
    v_and_b32 v60, 1, v59
    v_lshlrev_b32 v60, 4, v60
    v_lshrrev_b32 v59, 1, v59
    v_lshl_add_u32 v60, v59, 2, v60
    v_mul_u32_u24 v60, 1152, v60
    v_lshl_add_u32 v51, v71, 4, v60
    v_add_u32 v71, 128, v10
    v_mul_u32_u24 v59, 911, v71
    v_lshrrev_b32 v59, 16, v59
    v_mul_u32_u24 v60, 72, v59
    v_sub_u32 v71, v71, v60
    v_and_b32 v60, 1, v59
    v_lshlrev_b32 v60, 4, v60
    v_lshrrev_b32 v59, 1, v59
    v_lshl_add_u32 v60, v59, 2, v60
    v_mul_u32_u24 v60, 1152, v60
    v_lshl_add_u32 v52, v71, 4, v60
    v_add_u32 v71, 192, v10
    v_mul_u32_u24 v59, 911, v71
    v_lshrrev_b32 v59, 16, v59
    v_mul_u32_u24 v60, 72, v59
    v_sub_u32 v71, v71, v60
    v_and_b32 v60, 1, v59
    v_lshlrev_b32 v60, 4, v60
    v_lshrrev_b32 v59, 1, v59
    v_lshl_add_u32 v60, v59, 2, v60
    v_mul_u32_u24 v60, 1152, v60
    v_lshl_add_u32 v53, v71, 4, v60
    v_add_u32 v71, 256, v10
    v_mul_u32_u24 v59, 911, v71
    v_lshrrev_b32 v59, 16, v59
    v_mul_u32_u24 v60, 72, v59
    v_sub_u32 v71, v71, v60
    v_and_b32 v60, 1, v59
    v_lshlrev_b32 v60, 4, v60
    v_lshrrev_b32 v59, 1, v59
    v_lshl_add_u32 v60, v59, 2, v60
    v_mul_u32_u24 v60, 1152, v60
    v_lshl_add_u32 v54, v71, 4, v60
    s_lshr_b32 s17, s14, 1
    s_lshl_b32 s17, s17, 3
    s_and_b32 s18, s14, 1
    s_lshl_b32 s18, s18, 1
    s_add_u32 s17, s17, s18
    s_lshl_b32 s18, s15, 7
    s_add_u32 s17, s17, s18
    s_mul_i32 s59, s17, 1152
    s_mul_i32 s60, s14, 4608
    s_add_u32 m0, s58, 49152
    s_add_u32 s17, s57, 0
    buffer_load_dwordx4 v62, s[20:23], s17 offen lds
    s_add_u32 m0, s58, 50176
    s_add_u32 s17, s57, 32768
    buffer_load_dwordx4 v62, s[20:23], s17 offen lds
    s_add_u32 m0, s58, 51200
    s_add_u32 s17, s57, 65536
    buffer_load_dwordx4 v63, s[20:23], s17 offen lds
    s_add_u32 m0, s58, 52224
    s_add_u32 s17, s57, 98304
    buffer_load_dwordx4 v63, s[20:23], s17 offen lds
    s_add_u32 m0, s58, 65536
    s_add_u32 s17, s57, 0
    buffer_load_dwordx4 v62, s[24:27], s17 offen lds
    s_add_u32 m0, s58, 66560
    s_add_u32 s17, s57, 32768
    buffer_load_dwordx4 v62, s[24:27], s17 offen lds
    s_add_u32 m0, s58, 67584
    s_add_u32 s17, s57, 65536
    buffer_load_dwordx4 v63, s[24:27], s17 offen lds
    s_add_u32 m0, s58, 68608
    s_add_u32 s17, s57, 98304
    buffer_load_dwordx4 v63, s[24:27], s17 offen lds
    s_add_u32 m0, s58, 81920
    s_add_u32 s17, s57, 0
    buffer_load_dwordx4 v62, s[28:31], s17 offen lds
    s_add_u32 m0, s58, 82944
    s_add_u32 s17, s57, 32768
    buffer_load_dwordx4 v62, s[28:31], s17 offen lds
    s_add_u32 m0, s58, 83968
    s_add_u32 s17, s57, 65536
    buffer_load_dwordx4 v63, s[28:31], s17 offen lds
    s_add_u32 m0, s58, 84992
    s_add_u32 s17, s57, 98304
    buffer_load_dwordx4 v63, s[28:31], s17 offen lds
    s_add_u32 m0, s58, 98304
    s_add_u32 s17, s57, 131072
    buffer_load_dwordx4 v62, s[20:23], s17 offen lds
    s_add_u32 m0, s58, 99328
    s_add_u32 s17, s57, 163840
    buffer_load_dwordx4 v62, s[20:23], s17 offen lds
    s_add_u32 m0, s58, 100352
    s_add_u32 s17, s57, 196608
    buffer_load_dwordx4 v63, s[20:23], s17 offen lds
    s_add_u32 m0, s58, 101376
    s_add_u32 s17, s57, 229376
    buffer_load_dwordx4 v63, s[20:23], s17 offen lds
    s_add_u32 m0, s58, 114688
    s_add_u32 s17, s57, 131072
    buffer_load_dwordx4 v62, s[24:27], s17 offen lds
    s_add_u32 m0, s58, 115712
    s_add_u32 s17, s57, 163840
    buffer_load_dwordx4 v62, s[24:27], s17 offen lds
    s_add_u32 m0, s58, 116736
    s_add_u32 s17, s57, 196608
    buffer_load_dwordx4 v63, s[24:27], s17 offen lds
    s_add_u32 m0, s58, 117760
    s_add_u32 s17, s57, 229376
    buffer_load_dwordx4 v63, s[24:27], s17 offen lds
    s_add_u32 m0, s58, 131072
    s_add_u32 s17, s57, 131072
    buffer_load_dwordx4 v62, s[28:31], s17 offen lds
    s_add_u32 m0, s58, 132096
    s_add_u32 s17, s57, 163840
    buffer_load_dwordx4 v62, s[28:31], s17 offen lds
    s_add_u32 m0, s58, 133120
    s_add_u32 s17, s57, 196608
    buffer_load_dwordx4 v63, s[28:31], s17 offen lds
    s_add_u32 m0, s58, 134144
    s_add_u32 s17, s57, 229376
    buffer_load_dwordx4 v63, s[28:31], s17 offen lds
    s_add_u32 m0, s58, 147456
    s_add_u32 s17, s57, 262144
    buffer_load_dwordx4 v62, s[20:23], s17 offen lds
    s_add_u32 m0, s58, 148480
    s_add_u32 s17, s57, 294912
    buffer_load_dwordx4 v62, s[20:23], s17 offen lds
    s_add_u32 m0, s58, 149504
    s_add_u32 s17, s57, 327680
    buffer_load_dwordx4 v63, s[20:23], s17 offen lds
    s_add_u32 m0, s58, 150528
    s_add_u32 s17, s57, 360448
    buffer_load_dwordx4 v63, s[20:23], s17 offen lds
    s_add_u32 m0, s58, 0
    s_add_u32 s17, s57, 262144
    buffer_load_dwordx4 v62, s[24:27], s17 offen lds
    s_add_u32 m0, s58, 1024
    s_add_u32 s17, s57, 294912
    buffer_load_dwordx4 v62, s[24:27], s17 offen lds
    s_add_u32 m0, s58, 2048
    s_add_u32 s17, s57, 327680
    buffer_load_dwordx4 v63, s[24:27], s17 offen lds
    s_add_u32 m0, s58, 3072
    s_add_u32 s17, s57, 360448
    buffer_load_dwordx4 v63, s[24:27], s17 offen lds
    s_add_u32 m0, s58, 16384
    s_add_u32 s17, s57, 262144
    buffer_load_dwordx4 v62, s[28:31], s17 offen lds
    s_add_u32 m0, s58, 17408
    s_add_u32 s17, s57, 294912
    buffer_load_dwordx4 v62, s[28:31], s17 offen lds
    s_add_u32 m0, s58, 18432
    s_add_u32 s17, s57, 327680
    buffer_load_dwordx4 v63, s[28:31], s17 offen lds
    s_add_u32 m0, s58, 19456
    s_add_u32 s17, s57, 360448
    buffer_load_dwordx4 v63, s[28:31], s17 offen lds
    v_and_b32 v12, 15, v10
    v_lshrrev_b32 v13, 4, v10
    s_lshr_b32 s84, s15, 3
    s_bfe_u32 s85, s15, 0x20001
    s_and_b32 s86, s15, 1
    s_cmp_lt_u32 s14, 2
    s_cbranch_scc1 Lr_jabb
    s_lshr_b32 s84, s15, 1
    s_and_b32 s84, s84, 3
Lr_jabb:
    s_cmp_lt_u32 s15, 8
    s_cselect_b32 s62, 1, 0
    v_bfe_u32 v20, v12, 2, 1
    v_lshl_add_u32 v17, v20, 2, v13
    v_mul_u32_u24 v17, 12288, v17
    v_lshrrev_b32 v21, 3, v12
    v_lshlrev_b32 v21, 2, v21
    v_and_b32 v20, 3, v12
    v_add_u32 v21, v21, v20
    v_lshl_add_u32 v6, v21, 4, v17
    s_mul_i32 s17, s84, 2304
    s_lshl_b32 s18, s14, 10
    s_add_u32 s17, s17, s18
    s_lshl_b32 s18, s86, 7
    s_add_u32 s17, s17, s18
    s_lshl_b32 s18, s85, 8
    s_cmp_lt_u32 s14, 2
    s_cselect_b32 s18, s18, 0
    s_add_u32 s17, s17, s18
    v_add_u32 v6, s17, v6
    v_bfe_u32 v24, v12, 1, 2
    v_and_b32 v25, 1, v12
    v_lshrrev_b32 v26, 1, v13
    v_and_b32 v27, 1, v13
    s_cmp_lt_u32 s14, 2
    s_cbranch_scc0 Lr_jcb
    s_lshl_b32 s17, s14, 2
    v_add_u32 v18, s17, v24
    v_lshlrev_b32 v7, 10, v18
    v_lshl_add_u32 v19, v27, 1, v25
    s_lshl_b32 s17, s84, 4
    s_lshl_b32 s18, s85, 2
    s_add_u32 s17, s17, s18
    v_add_u32 v19, s17, v19
    v_lshl_add_u32 v7, v19, 4, v7
    s_lshl_b32 s17, s86, 1
    v_add_u32 v19, s17, v26
    v_lshl_add_u32 v7, v19, 2, v7
    s_lshl_b32 s17, s85, 1
    v_add_u32 v19, s17, v25
    v_mul_u32_u24 v19, 576, v19
    v_lshl_add_u32 v19, v18, 4, v19
    v_lshl_add_u32 v19, v13, 1, v19
    s_mul_i32 s17, s84, 144
    s_lshl_b32 s18, s86, 3
    s_add_u32 s17, s17, s18
    v_add_u32 v19, s17, v19
    v_lshlrev_b32 v14, 1, v19
    v_add_u32 v15, 2, v14
    s_branch Lr_jdb
Lr_jcb:
    s_lshl_b32 s17, s86, 1
    v_add_u32 v18, s17, v26
    v_lshlrev_b32 v19, 2, v18
    v_lshl_add_u32 v19, v27, 1, v19
    v_add_u32 v19, v19, v25
    s_lshl_b32 s17, s84, 4
    v_add_u32 v19, s17, v19
    v_lshlrev_b32 v7, 4, v19
    v_lshl_add_u32 v7, v24, 2, v7
    v_add_u32 v7, 8192, v7
    v_lshl_add_u32 v19, v18, 1, v25
    v_mul_u32_u24 v19, 576, v19
    v_lshl_add_u32 v19, v27, 3, v19
    v_add_u32 v19, v19, v24
    s_mul_i32 s17, s84, 144
    s_add_u32 s17, s17, 128
    v_add_u32 v19, s17, v19
    v_lshlrev_b32 v14, 1, v19
    v_add_u32 v15, 8, v14
Lr_jdb:
    s_mul_i32 s48, s32, 1048576
    s_add_u32 s48, s48, 4194304
    s_lshl_b32 s18, s14, 11
    s_lshl_b32 s19, s14, 8
    s_add_u32 s19, s19, 8192
    s_mul_i32 s17, s15, 12288
    s_add_u32 s17, s17, s48
    s_mul_i32 s38, s14, 2304
    s_add_u32 s38, s38, s17
    s_add_u32 s37, s48, 983040
    s_xor_b32 s36, s37, 16384
    s_add_u32 s34, s37, s18
    s_add_u32 s35, s37, s19
    s_mul_i32 s17, s32, 50331648
    s_lshl_b32 s19, s15, 13
    s_add_u32 s17, s17, s19
    s_add_u32 s40, s17, 61079552
    s_add_u32 s17, s17, s18
    s_add_u32 s41, s17, 60817408
    s_add_u32 s42, s17, 77594624
    s_mul_i32 s17, s32, 1048576
    s_lshl_b32 s19, s15, 12
    s_add_u32 s17, s17, s19
    s_lshl_b32 s19, s14, 9
    s_add_u32 s17, s17, s19
    s_add_u32 s45, s17, 27262976
    s_mov_b32 s86, s19
    s_mov_b32 s43, s45
    s_mov_b32 s66, 0
    s_mov_b32 s67, 1464320
    s_mov_b32 s78, 0xff
    s_mov_b32 s79, 0
    s_mul_i32 s17, s32, 1441792
    s_lshl_b32 s19, s15, 9
    s_add_u32 s17, s17, s19
    s_add_u32 s44, s17, 185600
    s_mov_b32 s33, 0
    s_load_dwordx2 s[88:89], s[0:1], 32
    s_mov_b32 s90, 9216
    s_mov_b32 s91, 0x00020000
    s_waitcnt lgkmcnt(0)
    s_and_b32 s89, s89, 0xffff
    s_cmp_eq_u32 s14, 3
    s_cbranch_scc1 Lr_mem0_doneb
    s_cmp_lt_u32 s14, 2
    s_cselect_b32 s17, 1, s62
    s_cmp_eq_u32 s17, 0
    s_cbranch_scc1 Lr_mem0_doneb
    s_mov_b64 exec, s[50:51]
    buffer_load_ushort v20, v14, s[88:91], 0 offen
    buffer_load_ushort v21, v15, s[88:91], 0 offen
    s_waitcnt vmcnt(0)
    v_lshl_or_b32 v20, v21, 16, v20
    v_min_u32 v20, s54, v20
    buffer_store_dword v20, v7, s[8:11], s37 offen sc1
    v_mov_b32 v20, -1
    buffer_store_dword v20, v7, s[8:11], s36 offen sc1
    s_mov_b64 exec, -1
Lr_mem0_doneb:
    v_mov_b32 v20, 1
    v_mov_b32 v21, 1
    v_mov_b32 v22, 1
    v_mov_b32 v23, 1
    s_xor_b32 s17, s38, 524288
    buffer_store_dwordx4 v[20:23], v0, s[8:11], s38 offen offset:0 sc1
    buffer_store_dwordx4 v[20:23], v0, s[8:11], s38 offen offset:1024 sc1
    buffer_store_dword v20, v8, s[8:11], s38 offen offset:2048 sc1
    buffer_store_dwordx4 v[20:23], v0, s[8:11], s17 offen offset:0 sc1
    buffer_store_dwordx4 v[20:23], v0, s[8:11], s17 offen offset:1024 sc1
    buffer_store_dword v20, v8, s[8:11], s17 offen offset:2048 sc1
    v_lshrrev_b32 v17, 1, v0
    s_mov_b32 s17, s45
    buffer_store_dwordx2 v[20:21], v17, s[8:11], s17 offen offset:2048 sc1
    s_mov_b64 exec, s[52:53]
    buffer_store_dwordx4 v[20:23], v0, s[8:11], s17 offen sc1
    s_mov_b64 exec, -1
    s_add_u32 s17, s17, 131072
    buffer_store_dwordx2 v[20:21], v17, s[8:11], s17 offen offset:2048 sc1
    s_mov_b64 exec, s[52:53]
    buffer_store_dwordx4 v[20:23], v0, s[8:11], s17 offen sc1
    s_mov_b64 exec, -1
    s_add_u32 s17, s17, 131072
    buffer_store_dwordx2 v[20:21], v17, s[8:11], s17 offen offset:2048 sc1
    s_mov_b64 exec, s[52:53]
    buffer_store_dwordx4 v[20:23], v0, s[8:11], s17 offen sc1
    s_mov_b64 exec, -1
    s_add_u32 s17, s17, 131072
    buffer_store_dwordx2 v[20:21], v17, s[8:11], s17 offen offset:2048 sc1
    s_mov_b64 exec, s[52:53]
    buffer_store_dwordx4 v[20:23], v0, s[8:11], s17 offen sc1
    s_mov_b64 exec, -1
    s_add_u32 s17, s17, 131072
    buffer_store_dwordx2 v[20:21], v17, s[8:11], s17 offen offset:2048 sc1
    s_mov_b64 exec, s[52:53]
    buffer_store_dwordx4 v[20:23], v0, s[8:11], s17 offen sc1
    s_mov_b64 exec, -1
    s_add_u32 s17, s17, 131072
    buffer_store_dwordx2 v[20:21], v17, s[8:11], s17 offen offset:2048 sc1
    s_mov_b64 exec, s[52:53]
    buffer_store_dwordx4 v[20:23], v0, s[8:11], s17 offen sc1
    s_mov_b64 exec, -1
    s_add_u32 s17, s17, 131072
    buffer_store_dwordx2 v[20:21], v17, s[8:11], s17 offen offset:2048 sc1
    s_mov_b64 exec, s[52:53]
    buffer_store_dwordx4 v[20:23], v0, s[8:11], s17 offen sc1
    s_mov_b64 exec, -1
    s_add_u32 s17, s17, 131072
    buffer_store_dwordx2 v[20:21], v17, s[8:11], s17 offen offset:2048 sc1
    s_mov_b64 exec, s[52:53]
    buffer_store_dwordx4 v[20:23], v0, s[8:11], s17 offen sc1
    s_mov_b64 exec, -1
    s_add_u32 s17, s17, 131072
    s_cmp_lg_u32 s14, 3
    s_cbranch_scc1 Lr_not_w3b
    v_and_b32 v7, 12, v8
    v_and_b32 v17, 4, v10
    v_lshl_add_u32 v7, v17, 5, v7
    s_add_u32 s17, s44, 4294877568
    s_cmp_eq_u32 s32, 0
    s_cselect_b32 s67, s67, s17
    s_add_u32 s17, s44, 22656
    s_min_u32 s18, s17, s67
    s_sub_u32 s17, s17, s18
    v_add_u32 v7, s17, v7
    s_sub_u32 s17, s67, s18
    v_mov_b32 v17, s17
    v_cmp_gt_u32 vcc, 8, v10
    s_nop 1
    v_cndmask_b32 v7, v17, v7, vcc
    s_mov_b32 s67, s18
Lr_not_w3b:
    v_lshlrev_b32 v5, 3, v0
    s_add_u32 s56, s40, 16777216
    s_waitcnt vmcnt(32)
    s_barrier
    s_cmp_lg_u32 s14, 0
    s_cbranch_scc1 Lr_noaddb
    s_lshl_b32 s17, s32, 2
    s_add_u32 s17, s17, 192
    v_mov_b32 v48, s17
    v_mov_b32 v49, 1
    s_mov_b64 exec, 1
    global_atomic_add v48, v49, s[12:13]
    s_mov_b64 exec, -1
Lr_noaddb:
    s_add_u32 m0, s58, 32768
    s_add_u32 s17, s57, 393216
    buffer_load_dwordx4 v62, s[20:23], s17 offen lds
    s_add_u32 m0, s58, 33792
    s_add_u32 s17, s57, 425984
    buffer_load_dwordx4 v62, s[20:23], s17 offen lds
    s_add_u32 m0, s58, 34816
    s_add_u32 s17, s57, 458752
    buffer_load_dwordx4 v63, s[20:23], s17 offen lds
    s_add_u32 m0, s58, 35840
    s_add_u32 s17, s57, 491520
    buffer_load_dwordx4 v63, s[20:23], s17 offen lds
    v_add_u32 v68, 49152, v66
    v_add_u32 v69, 49152, v67
    ds_read_b64_tr_b16 v[72:73], v68 offset:0
    ds_read_b64_tr_b16 v[74:75], v68 offset:1024
    ds_read_b64_tr_b16 v[76:77], v68 offset:8192
    ds_read_b64_tr_b16 v[78:79], v68 offset:9216
    ds_read_b64_tr_b16 v[80:81], v69 offset:0
    ds_read_b64_tr_b16 v[82:83], v69 offset:1024
    ds_read_b64_tr_b16 v[84:85], v69 offset:8192
    ds_read_b64_tr_b16 v[86:87], v69 offset:9216
    s_waitcnt lgkmcnt(0)
    s_waitcnt vmcnt(32)
    s_barrier
    s_add_u32 m0, s58, 49152
    s_add_u32 s17, s57, 393216
    buffer_load_dwordx4 v62, s[24:27], s17 offen lds
    s_add_u32 m0, s58, 50176
    s_add_u32 s17, s57, 425984
    buffer_load_dwordx4 v62, s[24:27], s17 offen lds
    s_add_u32 m0, s58, 51200
    s_add_u32 s17, s57, 458752
    buffer_load_dwordx4 v63, s[24:27], s17 offen lds
    s_add_u32 m0, s58, 52224
    s_add_u32 s17, s57, 491520
    buffer_load_dwordx4 v63, s[24:27], s17 offen lds
    v_add_u32 v68, 65536, v66
    v_add_u32 v69, 65536, v67
    ds_read_b64_tr_b16 v[88:89], v68 offset:0
    ds_read_b64_tr_b16 v[90:91], v68 offset:1024
    ds_read_b64_tr_b16 v[92:93], v68 offset:8192
    ds_read_b64_tr_b16 v[94:95], v68 offset:9216
    ds_read_b64_tr_b16 a[176:177], v69 offset:0
    ds_read_b64_tr_b16 a[178:179], v69 offset:1024
    ds_read_b64_tr_b16 a[180:181], v69 offset:8192
    ds_read_b64_tr_b16 a[182:183], v69 offset:9216
    s_waitcnt lgkmcnt(0)
    s_waitcnt vmcnt(32)
    s_barrier
    s_add_u32 m0, s58, 65536
    s_add_u32 s17, s57, 393216
    buffer_load_dwordx4 v62, s[28:31], s17 offen lds
    s_add_u32 m0, s58, 66560
    s_add_u32 s17, s57, 425984
    buffer_load_dwordx4 v62, s[28:31], s17 offen lds
    s_add_u32 m0, s58, 67584
    s_add_u32 s17, s57, 458752
    buffer_load_dwordx4 v63, s[28:31], s17 offen lds
    s_add_u32 m0, s58, 68608
    s_add_u32 s17, s57, 491520
    buffer_load_dwordx4 v63, s[28:31], s17 offen lds
    v_add_u32 v68, 81920, v66
    v_add_u32 v69, 81920, v67
    ds_read_b64_tr_b16 v[96:97], v68 offset:0
    ds_read_b64_tr_b16 v[98:99], v68 offset:1024
    ds_read_b64_tr_b16 v[100:101], v68 offset:8192
    ds_read_b64_tr_b16 v[102:103], v68 offset:9216
    ds_read_b64_tr_b16 v[104:105], v69 offset:0
    ds_read_b64_tr_b16 v[106:107], v69 offset:1024
    ds_read_b64_tr_b16 v[108:109], v69 offset:8192
    ds_read_b64_tr_b16 v[110:111], v69 offset:9216
    s_waitcnt lgkmcnt(0)
    s_waitcnt vmcnt(32)
    s_barrier
    s_add_u32 m0, s58, 81920
    s_add_u32 s17, s57, 524288
    buffer_load_dwordx4 v62, s[20:23], s17 offen lds
    s_add_u32 m0, s58, 82944
    s_add_u32 s17, s57, 557056
    buffer_load_dwordx4 v62, s[20:23], s17 offen lds
    s_add_u32 m0, s58, 83968
    s_add_u32 s17, s57, 589824
    buffer_load_dwordx4 v63, s[20:23], s17 offen lds
    s_add_u32 m0, s58, 84992
    s_add_u32 s17, s57, 622592
    buffer_load_dwordx4 v63, s[20:23], s17 offen lds
    v_add_u32 v68, 98304, v66
    v_add_u32 v69, 98304, v67
    ds_read_b64_tr_b16 v[112:113], v68 offset:0
    ds_read_b64_tr_b16 v[114:115], v68 offset:1024
    ds_read_b64_tr_b16 v[116:117], v68 offset:8192
    ds_read_b64_tr_b16 v[118:119], v68 offset:9216
    ds_read_b64_tr_b16 v[120:121], v69 offset:0
    ds_read_b64_tr_b16 v[122:123], v69 offset:1024
    ds_read_b64_tr_b16 v[124:125], v69 offset:8192
    ds_read_b64_tr_b16 v[126:127], v69 offset:9216
    s_waitcnt lgkmcnt(0)
    s_waitcnt vmcnt(32)
    s_barrier
    s_add_u32 m0, s58, 98304
    s_add_u32 s17, s57, 524288
    buffer_load_dwordx4 v62, s[24:27], s17 offen lds
    s_add_u32 m0, s58, 99328
    s_add_u32 s17, s57, 557056
    buffer_load_dwordx4 v62, s[24:27], s17 offen lds
    s_add_u32 m0, s58, 100352
    s_add_u32 s17, s57, 589824
    buffer_load_dwordx4 v63, s[24:27], s17 offen lds
    s_add_u32 m0, s58, 101376
    s_add_u32 s17, s57, 622592
    buffer_load_dwordx4 v63, s[24:27], s17 offen lds
    v_add_u32 v68, 114688, v66
    v_add_u32 v69, 114688, v67
    ds_read_b64_tr_b16 v[128:129], v68 offset:0
    ds_read_b64_tr_b16 v[130:131], v68 offset:1024
    ds_read_b64_tr_b16 v[132:133], v68 offset:8192
    ds_read_b64_tr_b16 v[134:135], v68 offset:9216
    ds_read_b64_tr_b16 a[184:185], v69 offset:0
    ds_read_b64_tr_b16 a[186:187], v69 offset:1024
    ds_read_b64_tr_b16 a[188:189], v69 offset:8192
    ds_read_b64_tr_b16 a[190:191], v69 offset:9216
    s_waitcnt lgkmcnt(0)
    s_waitcnt vmcnt(32)
    s_barrier
    s_add_u32 m0, s58, 114688
    s_add_u32 s17, s57, 524288
    buffer_load_dwordx4 v62, s[28:31], s17 offen lds
    s_add_u32 m0, s58, 115712
    s_add_u32 s17, s57, 557056
    buffer_load_dwordx4 v62, s[28:31], s17 offen lds
    s_add_u32 m0, s58, 116736
    s_add_u32 s17, s57, 589824
    buffer_load_dwordx4 v63, s[28:31], s17 offen lds
    s_add_u32 m0, s58, 117760
    s_add_u32 s17, s57, 622592
    buffer_load_dwordx4 v63, s[28:31], s17 offen lds
    v_add_u32 v68, 131072, v66
    v_add_u32 v69, 131072, v67
    ds_read_b64_tr_b16 v[136:137], v68 offset:0
    ds_read_b64_tr_b16 v[138:139], v68 offset:1024
    ds_read_b64_tr_b16 v[140:141], v68 offset:8192
    ds_read_b64_tr_b16 v[142:143], v68 offset:9216
    ds_read_b64_tr_b16 v[144:145], v69 offset:0
    ds_read_b64_tr_b16 v[146:147], v69 offset:1024
    ds_read_b64_tr_b16 v[148:149], v69 offset:8192
    ds_read_b64_tr_b16 v[150:151], v69 offset:9216
    s_waitcnt lgkmcnt(0)
    s_waitcnt vmcnt(32)
    s_barrier
    s_add_u32 m0, s58, 131072
    s_add_u32 s17, s57, 655360
    buffer_load_dwordx4 v62, s[20:23], s17 offen lds
    s_add_u32 m0, s58, 132096
    s_add_u32 s17, s57, 688128
    buffer_load_dwordx4 v62, s[20:23], s17 offen lds
    s_add_u32 m0, s58, 133120
    s_add_u32 s17, s57, 720896
    buffer_load_dwordx4 v63, s[20:23], s17 offen lds
    s_add_u32 m0, s58, 134144
    s_add_u32 s17, s57, 753664
    buffer_load_dwordx4 v63, s[20:23], s17 offen lds
    v_add_u32 v68, 147456, v66
    v_add_u32 v69, 147456, v67
    ds_read_b64_tr_b16 v[152:153], v68 offset:0
    ds_read_b64_tr_b16 v[154:155], v68 offset:1024
    ds_read_b64_tr_b16 v[156:157], v68 offset:8192
    ds_read_b64_tr_b16 v[158:159], v68 offset:9216
    ds_read_b64_tr_b16 v[160:161], v69 offset:0
    ds_read_b64_tr_b16 v[162:163], v69 offset:1024
    ds_read_b64_tr_b16 v[164:165], v69 offset:8192
    ds_read_b64_tr_b16 v[166:167], v69 offset:9216
    s_waitcnt lgkmcnt(0)
    s_waitcnt vmcnt(32)
    s_barrier
    s_add_u32 m0, s58, 147456
    s_add_u32 s17, s57, 655360
    buffer_load_dwordx4 v62, s[24:27], s17 offen lds
    s_add_u32 m0, s58, 148480
    s_add_u32 s17, s57, 688128
    buffer_load_dwordx4 v62, s[24:27], s17 offen lds
    s_add_u32 m0, s58, 149504
    s_add_u32 s17, s57, 720896
    buffer_load_dwordx4 v63, s[24:27], s17 offen lds
    s_add_u32 m0, s58, 150528
    s_add_u32 s17, s57, 753664
    buffer_load_dwordx4 v63, s[24:27], s17 offen lds
    v_add_u32 v68, 0, v66
    v_add_u32 v69, 0, v67
    ds_read_b64_tr_b16 v[168:169], v68 offset:0
    ds_read_b64_tr_b16 v[170:171], v68 offset:1024
    ds_read_b64_tr_b16 v[172:173], v68 offset:8192
    ds_read_b64_tr_b16 v[174:175], v68 offset:9216
    ds_read_b64_tr_b16 a[192:193], v69 offset:0
    ds_read_b64_tr_b16 a[194:195], v69 offset:1024
    ds_read_b64_tr_b16 a[196:197], v69 offset:8192
    ds_read_b64_tr_b16 a[198:199], v69 offset:9216
    s_waitcnt lgkmcnt(0)
    s_waitcnt vmcnt(32)
    s_barrier
    s_add_u32 m0, s58, 0
    s_add_u32 s17, s57, 655360
    buffer_load_dwordx4 v62, s[28:31], s17 offen lds
    s_add_u32 m0, s58, 1024
    s_add_u32 s17, s57, 688128
    buffer_load_dwordx4 v62, s[28:31], s17 offen lds
    s_add_u32 m0, s58, 2048
    s_add_u32 s17, s57, 720896
    buffer_load_dwordx4 v63, s[28:31], s17 offen lds
    s_add_u32 m0, s58, 3072
    s_add_u32 s17, s57, 753664
    buffer_load_dwordx4 v63, s[28:31], s17 offen lds
    v_add_u32 v68, 16384, v66
    v_add_u32 v69, 16384, v67
    ds_read_b64_tr_b16 v[176:177], v68 offset:0
    ds_read_b64_tr_b16 v[178:179], v68 offset:1024
    ds_read_b64_tr_b16 v[180:181], v68 offset:8192
    ds_read_b64_tr_b16 v[182:183], v68 offset:9216
    ds_read_b64_tr_b16 v[184:185], v69 offset:0
    ds_read_b64_tr_b16 v[186:187], v69 offset:1024
    ds_read_b64_tr_b16 v[188:189], v69 offset:8192
    ds_read_b64_tr_b16 v[190:191], v69 offset:9216
    s_waitcnt lgkmcnt(0)
    s_waitcnt vmcnt(32)
    s_barrier
    s_add_u32 m0, s58, 16384
    s_add_u32 s17, s57, 786432
    buffer_load_dwordx4 v62, s[20:23], s17 offen lds
    s_add_u32 m0, s58, 17408
    s_add_u32 s17, s57, 819200
    buffer_load_dwordx4 v62, s[20:23], s17 offen lds
    s_add_u32 m0, s58, 18432
    s_add_u32 s17, s57, 851968
    buffer_load_dwordx4 v63, s[20:23], s17 offen lds
    s_add_u32 m0, s58, 19456
    s_add_u32 s17, s57, 884736
    buffer_load_dwordx4 v63, s[20:23], s17 offen lds
    v_add_u32 v68, 32768, v66
    v_add_u32 v69, 32768, v67
    ds_read_b64_tr_b16 v[192:193], v68 offset:0
    ds_read_b64_tr_b16 v[194:195], v68 offset:1024
    ds_read_b64_tr_b16 v[196:197], v68 offset:8192
    ds_read_b64_tr_b16 v[198:199], v68 offset:9216
    ds_read_b64_tr_b16 v[200:201], v69 offset:0
    ds_read_b64_tr_b16 v[202:203], v69 offset:1024
    ds_read_b64_tr_b16 v[204:205], v69 offset:8192
    ds_read_b64_tr_b16 v[206:207], v69 offset:9216
    s_waitcnt lgkmcnt(0)
    s_waitcnt vmcnt(32)
    s_barrier
    s_add_u32 m0, s58, 32768
    s_add_u32 s17, s57, 786432
    buffer_load_dwordx4 v62, s[24:27], s17 offen lds
    s_add_u32 m0, s58, 33792
    s_add_u32 s17, s57, 819200
    buffer_load_dwordx4 v62, s[24:27], s17 offen lds
    s_add_u32 m0, s58, 34816
    s_add_u32 s17, s57, 851968
    buffer_load_dwordx4 v63, s[24:27], s17 offen lds
    s_add_u32 m0, s58, 35840
    s_add_u32 s17, s57, 884736
    buffer_load_dwordx4 v63, s[24:27], s17 offen lds
    v_add_u32 v68, 49152, v66
    v_add_u32 v69, 49152, v67
    ds_read_b64_tr_b16 v[208:209], v68 offset:0
    ds_read_b64_tr_b16 v[210:211], v68 offset:1024
    ds_read_b64_tr_b16 v[212:213], v68 offset:8192
    ds_read_b64_tr_b16 v[214:215], v68 offset:9216
    ds_read_b64_tr_b16 a[200:201], v69 offset:0
    ds_read_b64_tr_b16 a[202:203], v69 offset:1024
    ds_read_b64_tr_b16 a[204:205], v69 offset:8192
    ds_read_b64_tr_b16 a[206:207], v69 offset:9216
    s_waitcnt lgkmcnt(0)
    s_waitcnt vmcnt(32)
    s_barrier
    s_add_u32 m0, s58, 49152
    s_add_u32 s17, s57, 786432
    buffer_load_dwordx4 v62, s[28:31], s17 offen lds
    s_add_u32 m0, s58, 50176
    s_add_u32 s17, s57, 819200
    buffer_load_dwordx4 v62, s[28:31], s17 offen lds
    s_add_u32 m0, s58, 51200
    s_add_u32 s17, s57, 851968
    buffer_load_dwordx4 v63, s[28:31], s17 offen lds
    s_add_u32 m0, s58, 52224
    s_add_u32 s17, s57, 884736
    buffer_load_dwordx4 v63, s[28:31], s17 offen lds
    v_add_u32 v68, 65536, v66
    v_add_u32 v69, 65536, v67
    ds_read_b64_tr_b16 v[216:217], v68 offset:0
    ds_read_b64_tr_b16 v[218:219], v68 offset:1024
    ds_read_b64_tr_b16 v[220:221], v68 offset:8192
    ds_read_b64_tr_b16 v[222:223], v68 offset:9216
    ds_read_b64_tr_b16 v[224:225], v69 offset:0
    ds_read_b64_tr_b16 v[226:227], v69 offset:1024
    ds_read_b64_tr_b16 v[228:229], v69 offset:8192
    ds_read_b64_tr_b16 v[230:231], v69 offset:9216
    s_waitcnt lgkmcnt(0)
    s_waitcnt vmcnt(32)
    s_barrier
    s_add_u32 m0, s58, 65536
    s_add_u32 s17, s57, 917504
    buffer_load_dwordx4 v62, s[20:23], s17 offen lds
    s_add_u32 m0, s58, 66560
    s_add_u32 s17, s57, 950272
    buffer_load_dwordx4 v62, s[20:23], s17 offen lds
    s_add_u32 m0, s58, 67584
    s_add_u32 s17, s57, 983040
    buffer_load_dwordx4 v63, s[20:23], s17 offen lds
    s_add_u32 m0, s58, 68608
    s_add_u32 s17, s57, 1015808
    buffer_load_dwordx4 v63, s[20:23], s17 offen lds
    v_add_u32 v68, 81920, v66
    v_add_u32 v69, 81920, v67
    ds_read_b64_tr_b16 v[232:233], v68 offset:0
    ds_read_b64_tr_b16 v[234:235], v68 offset:1024
    ds_read_b64_tr_b16 v[236:237], v68 offset:8192
    ds_read_b64_tr_b16 v[238:239], v68 offset:9216
    ds_read_b64_tr_b16 v[240:241], v69 offset:0
    ds_read_b64_tr_b16 v[242:243], v69 offset:1024
    ds_read_b64_tr_b16 v[244:245], v69 offset:8192
    ds_read_b64_tr_b16 v[246:247], v69 offset:9216
    s_waitcnt lgkmcnt(0)
    s_waitcnt vmcnt(32)
    s_barrier
    s_add_u32 m0, s58, 81920
    s_add_u32 s17, s57, 917504
    buffer_load_dwordx4 v62, s[24:27], s17 offen lds
    s_add_u32 m0, s58, 82944
    s_add_u32 s17, s57, 950272
    buffer_load_dwordx4 v62, s[24:27], s17 offen lds
    s_add_u32 m0, s58, 83968
    s_add_u32 s17, s57, 983040
    buffer_load_dwordx4 v63, s[24:27], s17 offen lds
    s_add_u32 m0, s58, 84992
    s_add_u32 s17, s57, 1015808
    buffer_load_dwordx4 v63, s[24:27], s17 offen lds
    v_add_u32 v68, 98304, v66
    v_add_u32 v69, 98304, v67
    ds_read_b64_tr_b16 v[248:249], v68 offset:0
    ds_read_b64_tr_b16 v[250:251], v68 offset:1024
    ds_read_b64_tr_b16 v[252:253], v68 offset:8192
    ds_read_b64_tr_b16 v[254:255], v68 offset:9216
    ds_read_b64_tr_b16 a[208:209], v69 offset:0
    ds_read_b64_tr_b16 a[210:211], v69 offset:1024
    ds_read_b64_tr_b16 a[212:213], v69 offset:8192
    ds_read_b64_tr_b16 a[214:215], v69 offset:9216
    s_waitcnt lgkmcnt(0)
    s_waitcnt vmcnt(32)
    s_barrier
    s_add_u32 m0, s58, 98304
    s_add_u32 s17, s57, 917504
    buffer_load_dwordx4 v62, s[28:31], s17 offen lds
    s_add_u32 m0, s58, 99328
    s_add_u32 s17, s57, 950272
    buffer_load_dwordx4 v62, s[28:31], s17 offen lds
    s_add_u32 m0, s58, 100352
    s_add_u32 s17, s57, 983040
    buffer_load_dwordx4 v63, s[28:31], s17 offen lds
    s_add_u32 m0, s58, 101376
    s_add_u32 s17, s57, 1015808
    buffer_load_dwordx4 v63, s[28:31], s17 offen lds
    v_add_u32 v68, 114688, v66
    v_add_u32 v69, 114688, v67
    ds_read_b64_tr_b16 a[0:1], v68 offset:0
    ds_read_b64_tr_b16 a[2:3], v68 offset:1024
    ds_read_b64_tr_b16 a[4:5], v68 offset:8192
    ds_read_b64_tr_b16 a[6:7], v68 offset:9216
    ds_read_b64_tr_b16 a[8:9], v69 offset:0
    ds_read_b64_tr_b16 a[10:11], v69 offset:1024
    ds_read_b64_tr_b16 a[12:13], v69 offset:8192
    ds_read_b64_tr_b16 a[14:15], v69 offset:9216
    s_waitcnt lgkmcnt(0)
    s_waitcnt vmcnt(32)
    s_barrier
    s_add_u32 m0, s58, 114688
    s_add_u32 s17, s57, 1048576
    buffer_load_dwordx4 v64, s[20:23], s17 offen lds
    s_add_u32 m0, s58, 115712
    s_add_u32 s17, s57, 1056768
    buffer_load_dwordx4 v64, s[20:23], s17 offen lds
    s_add_u32 m0, s58, 116736
    s_add_u32 s17, s57, 1064960
    buffer_load_dwordx4 v65, s[20:23], s17 offen lds
    s_add_u32 m0, s58, 117760
    s_add_u32 s17, s57, 1073152
    buffer_load_dwordx4 v65, s[20:23], s17 offen lds
    v_add_u32 v68, 131072, v66
    v_add_u32 v69, 131072, v67
    ds_read_b64_tr_b16 a[16:17], v68 offset:0
    ds_read_b64_tr_b16 a[18:19], v68 offset:1024
    ds_read_b64_tr_b16 a[20:21], v68 offset:8192
    ds_read_b64_tr_b16 a[22:23], v68 offset:9216
    ds_read_b64_tr_b16 a[24:25], v69 offset:0
    ds_read_b64_tr_b16 a[26:27], v69 offset:1024
    ds_read_b64_tr_b16 a[28:29], v69 offset:8192
    ds_read_b64_tr_b16 a[30:31], v69 offset:9216
    s_waitcnt lgkmcnt(0)
    s_waitcnt vmcnt(32)
    s_barrier
    s_add_u32 m0, s58, 131072
    s_add_u32 s17, s57, 1048576
    buffer_load_dwordx4 v64, s[24:27], s17 offen lds
    s_add_u32 m0, s58, 132096
    s_add_u32 s17, s57, 1056768
    buffer_load_dwordx4 v64, s[24:27], s17 offen lds
    s_add_u32 m0, s58, 133120
    s_add_u32 s17, s57, 1064960
    buffer_load_dwordx4 v65, s[24:27], s17 offen lds
    s_add_u32 m0, s58, 134144
    s_add_u32 s17, s57, 1073152
    buffer_load_dwordx4 v65, s[24:27], s17 offen lds
    v_add_u32 v68, 147456, v66
    v_add_u32 v69, 147456, v67
    ds_read_b64_tr_b16 a[32:33], v68 offset:0
    ds_read_b64_tr_b16 a[34:35], v68 offset:1024
    ds_read_b64_tr_b16 a[36:37], v68 offset:8192
    ds_read_b64_tr_b16 a[38:39], v68 offset:9216
    ds_read_b64_tr_b16 a[216:217], v69 offset:0
    ds_read_b64_tr_b16 a[218:219], v69 offset:1024
    ds_read_b64_tr_b16 a[220:221], v69 offset:8192
    ds_read_b64_tr_b16 a[222:223], v69 offset:9216
    s_waitcnt lgkmcnt(0)
    s_waitcnt vmcnt(32)
    s_barrier
    s_add_u32 m0, s58, 147456
    s_add_u32 s17, s57, 1048576
    buffer_load_dwordx4 v64, s[28:31], s17 offen lds
    s_add_u32 m0, s58, 148480
    s_add_u32 s17, s57, 1056768
    buffer_load_dwordx4 v64, s[28:31], s17 offen lds
    s_add_u32 m0, s58, 149504
    s_add_u32 s17, s57, 1064960
    buffer_load_dwordx4 v65, s[28:31], s17 offen lds
    s_add_u32 m0, s58, 150528
    s_add_u32 s17, s57, 1073152
    buffer_load_dwordx4 v65, s[28:31], s17 offen lds
    v_add_u32 v68, 0, v66
    v_add_u32 v69, 0, v67
    ds_read_b64_tr_b16 a[40:41], v68 offset:0
    ds_read_b64_tr_b16 a[42:43], v68 offset:1024
    ds_read_b64_tr_b16 a[44:45], v68 offset:8192
    ds_read_b64_tr_b16 a[46:47], v68 offset:9216
    ds_read_b64_tr_b16 a[48:49], v69 offset:0
    ds_read_b64_tr_b16 a[50:51], v69 offset:1024
    ds_read_b64_tr_b16 a[52:53], v69 offset:8192
    ds_read_b64_tr_b16 a[54:55], v69 offset:9216
    s_waitcnt lgkmcnt(0)
    s_waitcnt vmcnt(32)
    s_barrier
    v_add_u32 v68, 16384, v66
    v_add_u32 v69, 16384, v67
    ds_read_b64_tr_b16 a[56:57], v68 offset:0
    ds_read_b64_tr_b16 a[58:59], v68 offset:1024
    ds_read_b64_tr_b16 a[60:61], v68 offset:8192
    ds_read_b64_tr_b16 a[62:63], v68 offset:9216
    ds_read_b64_tr_b16 a[64:65], v69 offset:0
    ds_read_b64_tr_b16 a[66:67], v69 offset:1024
    ds_read_b64_tr_b16 a[68:69], v69 offset:8192
    ds_read_b64_tr_b16 a[70:71], v69 offset:9216
    s_waitcnt lgkmcnt(0)
    s_waitcnt vmcnt(28)
    s_barrier
    v_add_u32 v68, 32768, v66
    v_add_u32 v69, 32768, v67
    ds_read_b64_tr_b16 a[72:73], v68 offset:0
    ds_read_b64_tr_b16 a[74:75], v68 offset:1024
    ds_read_b64_tr_b16 a[76:77], v68 offset:8192
    ds_read_b64_tr_b16 a[78:79], v68 offset:9216
    ds_read_b64_tr_b16 a[224:225], v69 offset:0
    ds_read_b64_tr_b16 a[226:227], v69 offset:1024
    ds_read_b64_tr_b16 a[228:229], v69 offset:8192
    ds_read_b64_tr_b16 a[230:231], v69 offset:9216
    s_waitcnt lgkmcnt(0)
    s_waitcnt vmcnt(24)
    s_barrier
    v_add_u32 v68, 49152, v66
    v_add_u32 v69, 49152, v67
    ds_read_b64_tr_b16 a[80:81], v68 offset:0
    ds_read_b64_tr_b16 a[82:83], v68 offset:1024
    ds_read_b64_tr_b16 a[84:85], v68 offset:8192
    ds_read_b64_tr_b16 a[86:87], v68 offset:9216
    ds_read_b64_tr_b16 a[88:89], v69 offset:0
    ds_read_b64_tr_b16 a[90:91], v69 offset:1024
    ds_read_b64_tr_b16 a[92:93], v69 offset:8192
    ds_read_b64_tr_b16 a[94:95], v69 offset:9216
    s_waitcnt lgkmcnt(0)
    s_waitcnt vmcnt(20)
    s_barrier
    s_add_u32 s17, s59, 0
    s_add_u32 m0, s60, 0
    s_nop 0
    buffer_load_dwordx4 v50, s[80:83], s17 offen lds
    s_add_u32 m0, s60, 1024
    s_nop 0
    buffer_load_dwordx4 v51, s[80:83], s17 offen lds
    s_add_u32 m0, s60, 2048
    s_nop 0
    buffer_load_dwordx4 v52, s[80:83], s17 offen lds
    s_add_u32 m0, s60, 3072
    s_nop 0
    buffer_load_dwordx4 v53, s[80:83], s17 offen lds
    s_add_u32 m0, s60, 4096
    s_mov_b64 exec, s[52:53]
    buffer_load_dwordx4 v54, s[80:83], s17 offen lds
    s_mov_b64 exec, -1
    v_add_u32 v68, 65536, v66
    v_add_u32 v69, 65536, v67
    ds_read_b64_tr_b16 a[96:97], v68 offset:0
    ds_read_b64_tr_b16 a[98:99], v68 offset:1024
    ds_read_b64_tr_b16 a[100:101], v68 offset:8192
    ds_read_b64_tr_b16 a[102:103], v68 offset:9216
    ds_read_b64_tr_b16 a[104:105], v69 offset:0
    ds_read_b64_tr_b16 a[106:107], v69 offset:1024
    ds_read_b64_tr_b16 a[108:109], v69 offset:8192
    ds_read_b64_tr_b16 a[110:111], v69 offset:9216
    s_waitcnt lgkmcnt(0)
    s_waitcnt vmcnt(21)
    s_barrier
    s_add_u32 s17, s59, 1152
    s_add_u32 m0, s60, 18432
    s_nop 0
    buffer_load_dwordx4 v50, s[80:83], s17 offen lds
    s_add_u32 m0, s60, 19456
    s_nop 0
    buffer_load_dwordx4 v51, s[80:83], s17 offen lds
    s_add_u32 m0, s60, 20480
    s_nop 0
    buffer_load_dwordx4 v52, s[80:83], s17 offen lds
    s_add_u32 m0, s60, 21504
    s_nop 0
    buffer_load_dwordx4 v53, s[80:83], s17 offen lds
    s_add_u32 m0, s60, 22528
    s_mov_b64 exec, s[52:53]
    buffer_load_dwordx4 v54, s[80:83], s17 offen lds
    s_mov_b64 exec, -1
    v_add_u32 v68, 81920, v66
    v_add_u32 v69, 81920, v67
    ds_read_b64_tr_b16 a[112:113], v68 offset:0
    ds_read_b64_tr_b16 a[114:115], v68 offset:1024
    ds_read_b64_tr_b16 a[116:117], v68 offset:8192
    ds_read_b64_tr_b16 a[118:119], v68 offset:9216
    ds_read_b64_tr_b16 a[232:233], v69 offset:0
    ds_read_b64_tr_b16 a[234:235], v69 offset:1024
    ds_read_b64_tr_b16 a[236:237], v69 offset:8192
    ds_read_b64_tr_b16 a[238:239], v69 offset:9216
    s_waitcnt lgkmcnt(0)
    s_waitcnt vmcnt(22)
    s_barrier
    s_add_u32 s17, s59, 36864
    s_add_u32 m0, s60, 36864
    s_nop 0
    buffer_load_dwordx4 v50, s[80:83], s17 offen lds
    s_add_u32 m0, s60, 37888
    s_nop 0
    buffer_load_dwordx4 v51, s[80:83], s17 offen lds
    s_add_u32 m0, s60, 38912
    s_nop 0
    buffer_load_dwordx4 v52, s[80:83], s17 offen lds
    s_add_u32 m0, s60, 39936
    s_nop 0
    buffer_load_dwordx4 v53, s[80:83], s17 offen lds
    s_add_u32 m0, s60, 40960
    s_mov_b64 exec, s[52:53]
    buffer_load_dwordx4 v54, s[80:83], s17 offen lds
    s_mov_b64 exec, -1
    v_add_u32 v68, 98304, v66
    v_add_u32 v69, 98304, v67
    ds_read_b64_tr_b16 a[120:121], v68 offset:0
    ds_read_b64_tr_b16 a[122:123], v68 offset:1024
    ds_read_b64_tr_b16 a[124:125], v68 offset:8192
    ds_read_b64_tr_b16 a[126:127], v68 offset:9216
    ds_read_b64_tr_b16 a[128:129], v69 offset:0
    ds_read_b64_tr_b16 a[130:131], v69 offset:1024
    ds_read_b64_tr_b16 a[132:133], v69 offset:8192
    ds_read_b64_tr_b16 a[134:135], v69 offset:9216
    s_waitcnt lgkmcnt(0)
    s_waitcnt vmcnt(23)
    s_barrier
    v_add_u32 v68, 114688, v66
    v_add_u32 v69, 114688, v67
    ds_read_b64_tr_b16 a[136:137], v68 offset:0
    ds_read_b64_tr_b16 a[138:139], v68 offset:1024
    ds_read_b64_tr_b16 a[140:141], v68 offset:8192
    ds_read_b64_tr_b16 a[142:143], v68 offset:9216
    ds_read_b64_tr_b16 a[144:145], v69 offset:0
    ds_read_b64_tr_b16 a[146:147], v69 offset:1024
    ds_read_b64_tr_b16 a[148:149], v69 offset:8192
    ds_read_b64_tr_b16 a[150:151], v69 offset:9216
    s_waitcnt lgkmcnt(0)
    s_waitcnt vmcnt(19)
    s_barrier
    v_add_u32 v68, 131072, v66
    v_add_u32 v69, 131072, v67
    ds_read_b64_tr_b16 a[152:153], v68 offset:0
    ds_read_b64_tr_b16 a[154:155], v68 offset:1024
    ds_read_b64_tr_b16 a[156:157], v68 offset:8192
    ds_read_b64_tr_b16 a[158:159], v68 offset:9216
    ds_read_b64_tr_b16 a[240:241], v69 offset:0
    ds_read_b64_tr_b16 a[242:243], v69 offset:1024
    ds_read_b64_tr_b16 a[244:245], v69 offset:8192
    ds_read_b64_tr_b16 a[246:247], v69 offset:9216
    s_waitcnt lgkmcnt(0)
    s_waitcnt vmcnt(15)
    s_barrier
    v_add_u32 v68, 147456, v66
    v_add_u32 v69, 147456, v67
    ds_read_b64_tr_b16 a[160:161], v68 offset:0
    ds_read_b64_tr_b16 a[162:163], v68 offset:1024
    ds_read_b64_tr_b16 a[164:165], v68 offset:8192
    ds_read_b64_tr_b16 a[166:167], v68 offset:9216
    ds_read_b64_tr_b16 a[168:169], v69 offset:0
    ds_read_b64_tr_b16 a[170:171], v69 offset:1024
    ds_read_b64_tr_b16 a[172:173], v69 offset:8192
    ds_read_b64_tr_b16 a[174:175], v69 offset:9216
    s_waitcnt lgkmcnt(0)
    s_barrier
    ds_write_b128 v9, a[176:179] offset:0
    ds_write_b128 v9, a[180:183] offset:1024
    ds_write_b128 v9, a[184:187] offset:2048
    ds_write_b128 v9, a[188:191] offset:3072
    ds_write_b128 v9, a[192:195] offset:4096
    ds_write_b128 v9, a[196:199] offset:5120
    ds_write_b128 v9, a[200:203] offset:6144
    ds_write_b128 v9, a[204:207] offset:7168
    ds_write_b128 v9, a[208:211] offset:8192
    ds_write_b128 v9, a[212:215] offset:9216
    ds_write_b128 v9, a[216:219] offset:10240
    ds_write_b128 v9, a[220:223] offset:11264
    ds_write_b128 v9, a[224:227] offset:12288
    ds_write_b128 v9, a[228:231] offset:13312
    ds_write_b128 v9, a[232:235] offset:14336
    ds_write_b128 v9, a[236:239] offset:15360
    ds_write_b128 v9, a[240:243] offset:16384
    ds_write_b128 v9, a[244:247] offset:17408
    s_waitcnt lgkmcnt(0)
    s_waitcnt vmcnt(10)
    s_barrier
    ds_read_b64_tr_b16 a[176:177], v70 offset:0
    ds_read_b64_tr_b16 a[192:193], v70 offset:32
    ds_read_b64_tr_b16 v[12:13], v70 offset:64
    ds_read_b64_tr_b16 a[208:209], v70 offset:96
    ds_read_b64_tr_b16 v[20:21], v70 offset:128
    ds_read_b64_tr_b16 a[224:225], v70 offset:160
    ds_read_b64_tr_b16 a[240:241], v70 offset:192
    ds_read_b64_tr_b16 v[28:29], v70 offset:224
    ds_read_b64_tr_b16 v[36:37], v70 offset:256
    s_waitcnt lgkmcnt(0)
    s_waitcnt vmcnt(5)
    s_barrier
    s_add_u32 s17, s59, 38016
    s_add_u32 m0, s60, 0
    s_nop 0
    buffer_load_dwordx4 v50, s[80:83], s17 offen lds
    s_add_u32 m0, s60, 1024
    s_nop 0
    buffer_load_dwordx4 v51, s[80:83], s17 offen lds
    s_add_u32 m0, s60, 2048
    s_nop 0
    buffer_load_dwordx4 v52, s[80:83], s17 offen lds
    s_add_u32 m0, s60, 3072
    s_nop 0
    buffer_load_dwordx4 v53, s[80:83], s17 offen lds
    s_add_u32 m0, s60, 4096
    s_mov_b64 exec, s[52:53]
    buffer_load_dwordx4 v54, s[80:83], s17 offen lds
    s_mov_b64 exec, -1
    ds_read_b64_tr_b16 a[178:179], v70 offset:18432
    ds_read_b64_tr_b16 a[194:195], v70 offset:18464
    ds_read_b64_tr_b16 v[14:15], v70 offset:18496
    ds_read_b64_tr_b16 a[210:211], v70 offset:18528
    ds_read_b64_tr_b16 v[22:23], v70 offset:18560
    ds_read_b64_tr_b16 a[226:227], v70 offset:18592
    ds_read_b64_tr_b16 a[242:243], v70 offset:18624
    ds_read_b64_tr_b16 v[30:31], v70 offset:18656
    ds_read_b64_tr_b16 v[38:39], v70 offset:18688
    s_waitcnt lgkmcnt(0)
    s_waitcnt vmcnt(5)
    s_barrier
    s_add_u32 s17, s59, 73728
    s_add_u32 m0, s60, 18432
    s_nop 0
    buffer_load_dwordx4 v50, s[80:83], s17 offen lds
    s_add_u32 m0, s60, 19456
    s_nop 0
    buffer_load_dwordx4 v51, s[80:83], s17 offen lds
    s_add_u32 m0, s60, 20480
    s_nop 0
    buffer_load_dwordx4 v52, s[80:83], s17 offen lds
    s_add_u32 m0, s60, 21504
    s_nop 0
    buffer_load_dwordx4 v53, s[80:83], s17 offen lds
    s_add_u32 m0, s60, 22528
    s_mov_b64 exec, s[52:53]
    buffer_load_dwordx4 v54, s[80:83], s17 offen lds
    s_mov_b64 exec, -1
    ds_read_b64_tr_b16 a[180:181], v70 offset:36864
    ds_read_b64_tr_b16 a[196:197], v70 offset:36896
    ds_read_b64_tr_b16 v[16:17], v70 offset:36928
    ds_read_b64_tr_b16 a[212:213], v70 offset:36960
    ds_read_b64_tr_b16 v[24:25], v70 offset:36992
    ds_read_b64_tr_b16 a[228:229], v70 offset:37024
    ds_read_b64_tr_b16 a[244:245], v70 offset:37056
    ds_read_b64_tr_b16 v[32:33], v70 offset:37088
    ds_read_b64_tr_b16 v[40:41], v70 offset:37120
    s_waitcnt lgkmcnt(0)
    s_waitcnt vmcnt(5)
    s_barrier
    s_add_u32 s17, s59, 74880
    s_add_u32 m0, s60, 36864
    s_nop 0
    buffer_load_dwordx4 v50, s[80:83], s17 offen lds
    s_add_u32 m0, s60, 37888
    s_nop 0
    buffer_load_dwordx4 v51, s[80:83], s17 offen lds
    s_add_u32 m0, s60, 38912
    s_nop 0
    buffer_load_dwordx4 v52, s[80:83], s17 offen lds
    s_add_u32 m0, s60, 39936
    s_nop 0
    buffer_load_dwordx4 v53, s[80:83], s17 offen lds
    s_add_u32 m0, s60, 40960
    s_mov_b64 exec, s[52:53]
    buffer_load_dwordx4 v54, s[80:83], s17 offen lds
    s_mov_b64 exec, -1
    ds_read_b64_tr_b16 a[182:183], v70 offset:0
    ds_read_b64_tr_b16 a[198:199], v70 offset:32
    ds_read_b64_tr_b16 v[18:19], v70 offset:64
    ds_read_b64_tr_b16 a[214:215], v70 offset:96
    ds_read_b64_tr_b16 v[26:27], v70 offset:128
    ds_read_b64_tr_b16 a[230:231], v70 offset:160
    ds_read_b64_tr_b16 a[246:247], v70 offset:192
    ds_read_b64_tr_b16 v[34:35], v70 offset:224
    ds_read_b64_tr_b16 v[42:43], v70 offset:256
    s_waitcnt lgkmcnt(0)
    ds_write_b128 v9, v[12:15] offset:18432
    ds_write_b128 v9, v[16:19] offset:19456
    ds_write_b128 v9, v[20:23] offset:20480
    ds_write_b128 v9, v[24:27] offset:21504
    ds_write_b128 v9, v[28:31] offset:22528
    ds_write_b128 v9, v[32:35] offset:23552
    ds_write_b128 v9, v[36:39] offset:24576
    ds_write_b128 v9, v[40:43] offset:25600
    s_waitcnt lgkmcnt(0)
    s_waitcnt vmcnt(5)
    s_barrier
    s_add_u32 s17, s59, 110592
    s_add_u32 m0, s60, 0
    s_nop 0
    buffer_load_dwordx4 v50, s[80:83], s17 offen lds
    s_add_u32 m0, s60, 1024
    s_nop 0
    buffer_load_dwordx4 v51, s[80:83], s17 offen lds
    s_add_u32 m0, s60, 2048
    s_nop 0
    buffer_load_dwordx4 v52, s[80:83], s17 offen lds
    s_add_u32 m0, s60, 3072
    s_nop 0
    buffer_load_dwordx4 v53, s[80:83], s17 offen lds
    s_add_u32 m0, s60, 4096
    s_mov_b64 exec, s[52:53]
    buffer_load_dwordx4 v54, s[80:83], s17 offen lds
    s_mov_b64 exec, -1
    ds_read_b64_tr_b16 a[184:185], v70 offset:18432
    ds_read_b64_tr_b16 v[12:13], v70 offset:18464
    ds_read_b64_tr_b16 a[200:201], v70 offset:18496
    ds_read_b64_tr_b16 a[216:217], v70 offset:18528
    ds_read_b64_tr_b16 v[20:21], v70 offset:18560
    ds_read_b64_tr_b16 a[232:233], v70 offset:18592
    ds_read_b64_tr_b16 v[28:29], v70 offset:18624
    ds_read_b64_tr_b16 a[248:249], v70 offset:18656
    ds_read_b64_tr_b16 v[36:37], v70 offset:18688
    s_waitcnt lgkmcnt(0)
    s_waitcnt vmcnt(5)
    s_barrier
    s_add_u32 s17, s59, 111744
    s_add_u32 m0, s60, 18432
    s_nop 0
    buffer_load_dwordx4 v50, s[80:83], s17 offen lds
    s_add_u32 m0, s60, 19456
    s_nop 0
    buffer_load_dwordx4 v51, s[80:83], s17 offen lds
    s_add_u32 m0, s60, 20480
    s_nop 0
    buffer_load_dwordx4 v52, s[80:83], s17 offen lds
    s_add_u32 m0, s60, 21504
    s_nop 0
    buffer_load_dwordx4 v53, s[80:83], s17 offen lds
    s_add_u32 m0, s60, 22528
    s_mov_b64 exec, s[52:53]
    buffer_load_dwordx4 v54, s[80:83], s17 offen lds
    s_mov_b64 exec, -1
    ds_read_b64_tr_b16 a[186:187], v70 offset:36864
    ds_read_b64_tr_b16 v[14:15], v70 offset:36896
    ds_read_b64_tr_b16 a[202:203], v70 offset:36928
    ds_read_b64_tr_b16 a[218:219], v70 offset:36960
    ds_read_b64_tr_b16 v[22:23], v70 offset:36992
    ds_read_b64_tr_b16 a[234:235], v70 offset:37024
    ds_read_b64_tr_b16 v[30:31], v70 offset:37056
    ds_read_b64_tr_b16 a[250:251], v70 offset:37088
    ds_read_b64_tr_b16 v[38:39], v70 offset:37120
    s_waitcnt lgkmcnt(0)
    s_waitcnt vmcnt(5)
    s_barrier
    ds_read_b64_tr_b16 a[188:189], v70 offset:0
    ds_read_b64_tr_b16 v[16:17], v70 offset:32
    ds_read_b64_tr_b16 a[204:205], v70 offset:64
    ds_read_b64_tr_b16 a[220:221], v70 offset:96
    ds_read_b64_tr_b16 v[24:25], v70 offset:128
    ds_read_b64_tr_b16 a[236:237], v70 offset:160
    ds_read_b64_tr_b16 v[32:33], v70 offset:192
    ds_read_b64_tr_b16 a[252:253], v70 offset:224
    ds_read_b64_tr_b16 v[40:41], v70 offset:256
    s_waitcnt lgkmcnt(0)
    s_waitcnt vmcnt(0)
    s_barrier
    ds_read_b64_tr_b16 a[190:191], v70 offset:18432
    ds_read_b64_tr_b16 v[18:19], v70 offset:18464
    ds_read_b64_tr_b16 a[206:207], v70 offset:18496
    ds_read_b64_tr_b16 a[222:223], v70 offset:18528
    ds_read_b64_tr_b16 v[26:27], v70 offset:18560
    ds_read_b64_tr_b16 a[238:239], v70 offset:18592
    ds_read_b64_tr_b16 v[34:35], v70 offset:18624
    ds_read_b64_tr_b16 a[254:255], v70 offset:18656
    ds_read_b64_tr_b16 v[42:43], v70 offset:18688
    s_waitcnt lgkmcnt(0)
    s_barrier
    s_lshl_b32 s17, s14, 13
    v_add_u32 v71, s17, v0
    ds_write_b128 v71, v[12:15] offset:24576
    ds_write_b128 v71, v[16:19] offset:25600
    ds_write_b128 v71, v[20:23] offset:26624
    ds_write_b128 v71, v[24:27] offset:27648
    ds_write_b128 v71, v[28:31] offset:28672
    ds_write_b128 v71, v[32:35] offset:29696
    ds_write_b128 v71, v[36:39] offset:30720
    ds_write_b128 v71, v[40:43] offset:31744
    s_waitcnt vmcnt(0) lgkmcnt(0)
    s_barrier
Lr_ldd:
    s_add_u32 s17, s32, s14
    s_cmp_lg_u32 s17, 0
    s_cbranch_scc1 Lr_nold
    v_mov_b32 v63, 48
    v_mov_b32 v64, 1
    s_mov_b64 exec, 1
    global_atomic_add v63, v64, s[12:13]
    s_mov_b64 exec, -1
Lr_nold:
    s_add_u32 s57, s48, 0
    s_add_u32 s58, s48, 98304
    s_add_u32 s59, s48, 196608
    s_add_u32 s60, s48, 294912
    s_mov_b64 exec, 0xff
    v_lshlrev_b32 v12, 5, v8
    v_and_b32 v12, 128, v12
    v_lshrrev_b32 v13, 1, v8
    v_and_or_b32 v12, v13, 12, v12
    s_mov_b32 s16, 0
L_pure:
    global_load_dword v13, v12, s[12:13] sc1
    s_add_u32 s16, s16, 1
    s_cmp_gt_u32 s16, 100000
    s_cbranch_scc1 Lr_abort
    s_mov_b32 s6, 0
    s_waitcnt vmcnt(0)
    v_readlane_b32 s7, v13, 0
    s_nop 0
    s_add_u32 s6, s6, s7
    v_readlane_b32 s7, v13, 1
    s_nop 0
    s_add_u32 s6, s6, s7
    v_readlane_b32 s7, v13, 2
    s_nop 0
    s_add_u32 s6, s6, s7
    v_readlane_b32 s7, v13, 3
    s_nop 0
    s_add_u32 s6, s6, s7
    v_readlane_b32 s7, v13, 4
    s_nop 0
    s_add_u32 s6, s6, s7
    v_readlane_b32 s7, v13, 5
    s_nop 0
    s_add_u32 s6, s6, s7
    v_readlane_b32 s7, v13, 6
    s_nop 0
    s_add_u32 s6, s6, s7
    v_readlane_b32 s7, v13, 7
    s_nop 0
    s_add_u32 s6, s6, s7
    v_readlane_b32 s7, v13, s32
    s_nop 0
    s_cmp_ge_u32 s7, 32
    s_cselect_b32 s55, 1, 0
    s_cselect_b32 s6, 256, s6
    s_cmp_lt_u32 s6, 256
    s_cbranch_scc1 L_pure
    s_mov_b64 exec, -1
    s_lshl_b32 s6, s32, 2
    s_add_u32 s6, s6, 192
    s_cmp_lg_u32 s14, 0
    s_cbranch_scc1 L_team_d
    v_mov_b32 v12, s6
    s_mov_b32 s16, 0
L_team:
    global_load_dword v13, v12, s[12:13] sc1
    s_add_u32 s16, s16, 1
    s_cmp_gt_u32 s16, 100000
    s_cbranch_scc1 Lr_abort
    s_waitcnt vmcnt(0)
    v_cmp_gt_u32 vcc, 32, v13
    s_nop 0
    s_cbranch_vccz L_team_d
    s_sleep 8
    s_branch L_team
L_team_d:
    s_barrier
    s_cmp_lg_u32 s14, 0
    s_cbranch_scc1 L_rpool_d
    v_mov_b32 v12, 160
    s_mov_b32 s16, 0
L_rpool:
    global_load_dword v13, v12, s[12:13] sc1
    s_add_u32 s16, s16, 1
    s_cmp_gt_u32 s16, 100000
    s_cbranch_scc1 Lr_abort
    s_waitcnt vmcnt(0)
    v_cmp_gt_u32 vcc, 123, v13
    s_nop 0
    s_cbranch_vccz L_rpool_d
    s_sleep 8
    s_branch L_rpool
L_rpool_d:
    s_barrier
    s_barrier
    s_cmp_eq_u32 s55, 0
    s_cbranch_scc1 L_slow
    s_cmp_lg_u32 s14, 0
    s_cbranch_scc1 L_w1_1
    s_barrier
    s_mov_b32 m0, 9216
    s_nop 0
    buffer_load_dwordx4 v0, s[8:11], s41 offen offset:0 lds
    buffer_load_dwordx4 v0, s[8:11], s41 offen offset:1024 lds
    s_add_u32 s41, s41, 262144
    s_waitcnt vmcnt(0)
    buffer_load_dwordx4 v[44:47], v0, s[8:11], s34 offen sc1
    buffer_load_dwordx4 v[48:51], v0, s[8:11], s34 offen offset:1024 sc1
    buffer_load_dword v10, v8, s[8:11], s35 offen sc1
    ds_read_b128 v[56:59], v9 offset:0
    ds_read_b128 v[60:63], v9 offset:1024
    ds_read_b128 v[64:67], v9 offset:2048
    ds_read_b128 v[68:71], v9 offset:3072
    v_mov_b64 v[12:13], 0
    v_mov_b64 v[14:15], 0
    v_mov_b64 v[16:17], 0
    v_mov_b64 v[18:19], 0
    v_mov_b64 v[20:21], 0
    v_mov_b64 v[22:23], 0
    v_mov_b64 v[24:25], 0
    v_mov_b64 v[26:27], 0
    v_mov_b64 v[28:29], 0
    v_mov_b64 v[30:31], 0
    v_mov_b64 v[32:33], 0
    v_mov_b64 v[34:35], 0
    s_waitcnt lgkmcnt(0)
Lr0f_step:
    s_mov_b32 s16, 0
    s_mov_b64 s[70:71], 0
    s_mov_b64 s[72:73], 0
    s_mov_b64 s[74:75], 0
Lr0f_p2:
    s_mov_b64 exec, s[70:71]
    buffer_load_dwordx4 v[44:47], v0, s[8:11], s34 offen sc1
    s_mov_b64 exec, s[72:73]
    buffer_load_dwordx4 v[48:51], v0, s[8:11], s34 offen offset:1024 sc1
    s_mov_b64 exec, s[74:75]
    buffer_load_dword v10, v8, s[8:11], s35 offen sc1
    s_mov_b64 exec, -1
    s_add_u32 s16, s16, 1
    s_cmp_gt_u32 s16, 100000
    s_cbranch_scc1 Lr_abort
    s_waitcnt vmcnt(5)
    v_max3_u32 v11, v44, v45, v46
    v_max_u32 v11, v11, v47
    v_cmp_eq_u32 s[70:71], -1, v11
    s_waitcnt vmcnt(4)
    v_max3_u32 v11, v48, v49, v50
    v_max_u32 v11, v11, v51
    v_cmp_eq_u32 s[72:73], -1, v11
    s_waitcnt vmcnt(3)
    v_cmp_eq_u32 s[74:75], -1, v10
    s_or_b64 vcc, s[70:71], s[72:73]
    s_or_b64 vcc, vcc, s[74:75]
    s_cbranch_scc1 Lr0f_p2
    v_smfmac_f32_16x16x64_bf16 v[12:15], v[44:47], v[72:79], v1
    ds_write_b128 v0, v[44:47] offset:0
    v_smfmac_f32_16x16x64_bf16 v[16:19], v[44:47], v[80:87], v1
    ds_write_b128 v0, v[48:51] offset:1024
    v_smfmac_f32_16x16x64_bf16 v[20:23], v[44:47], v[88:95], v1
    ds_write_b32 v8, v10 offset:8192
    v_smfmac_f32_16x16x64_bf16 v[24:27], v[44:47], v[56:63], v1
    s_waitcnt lgkmcnt(0)
    s_barrier
    ds_read_b128 v[52:55], v0 offset:2048
    v_smfmac_f32_16x16x64_bf16 v[12:15], v[48:51], v[112:119], v1
    ds_read_b128 v[36:39], v0 offset:3072
    v_smfmac_f32_16x16x64_bf16 v[16:19], v[48:51], v[120:127], v1
    ds_read_b128 v[56:59], v9 offset:4096
    v_smfmac_f32_16x16x64_bf16 v[20:23], v[48:51], v[128:135], v1
    ds_read_b128 v[60:63], v9 offset:5120
    v_smfmac_f32_16x16x64_bf16 v[24:27], v[48:51], v[64:71], v1
    ds_read_b128 v[40:43], v0 offset:4096
    s_waitcnt lgkmcnt(4)
    v_smfmac_f32_16x16x64_bf16 v[12:15], v[52:55], v[152:159], v1
    v_smfmac_f32_16x16x64_bf16 v[16:19], v[52:55], v[160:167], v1
    ds_read_b128 v[64:67], v9 offset:6144
    v_smfmac_f32_16x16x64_bf16 v[20:23], v[52:55], v[168:175], v1
    ds_read_b128 v[68:71], v9 offset:7168
    s_waitcnt lgkmcnt(3)
    v_smfmac_f32_16x16x64_bf16 v[24:27], v[52:55], v[56:63], v1
    v_smfmac_f32_16x16x64_bf16 v[12:15], v[36:39], v[192:199], v1
    ds_read_b128 v[52:55], v0 offset:5120
    v_smfmac_f32_16x16x64_bf16 v[16:19], v[36:39], v[200:207], v1
    ds_read_b128 v[56:59], v9 offset:8192
    v_smfmac_f32_16x16x64_bf16 v[20:23], v[36:39], v[208:215], v1
    ds_read_b128 v[60:63], v9 offset:9216
    s_waitcnt lgkmcnt(3)
    v_smfmac_f32_16x16x64_bf16 v[24:27], v[36:39], v[64:71], v1
    v_smfmac_f32_16x16x64_bf16 v[12:15], v[40:43], v[232:239], v1
    buffer_load_dwordx4 v[36:39], v0, s[8:11], s42 offen
    v_smfmac_f32_16x16x64_bf16 v[16:19], v[40:43], v[240:247], v1
    ds_read_b128 v[64:67], v9 offset:10240
    v_smfmac_f32_16x16x64_bf16 v[20:23], v[40:43], v[248:255], v1
    ds_read_b128 v[68:71], v9 offset:11264
    s_waitcnt lgkmcnt(2)
    v_smfmac_f32_16x16x64_bf16 v[24:27], v[40:43], v[56:63], v1
    s_waitcnt vmcnt(1)
    ds_read_b128 v[44:47], v0 offset:6144
    v_smfmac_f32_16x16x64_bf16 v[12:15], v[52:55], a[16:23], v1
    buffer_load_dwordx4 v[40:43], v0, s[8:11], s42 offen offset:1024
    v_smfmac_f32_16x16x64_bf16 v[16:19], v[52:55], a[24:31], v1
    ds_read_b128 v[56:59], v9 offset:12288
    v_smfmac_f32_16x16x64_bf16 v[20:23], v[52:55], a[32:39], v1
    ds_read_b128 v[60:63], v9 offset:13312
    s_waitcnt lgkmcnt(3)
    v_smfmac_f32_16x16x64_bf16 v[24:27], v[52:55], v[64:71], v1
    ds_read_b128 v[48:51], v0 offset:7168
    s_waitcnt lgkmcnt(3)
    v_smfmac_f32_16x16x64_bf16 v[12:15], v[44:47], a[56:63], v1
    ds_read_b128 v[52:55], v0 offset:8192
    v_smfmac_f32_16x16x64_bf16 v[16:19], v[44:47], a[64:71], v1
    ds_read_b128 v[64:67], v9 offset:14336
    v_smfmac_f32_16x16x64_bf16 v[20:23], v[44:47], a[72:79], v1
    ds_read_b128 v[68:71], v9 offset:15360
    s_waitcnt lgkmcnt(4)
    v_smfmac_f32_16x16x64_bf16 v[24:27], v[44:47], v[56:63], v1
    s_waitcnt lgkmcnt(3)
    v_smfmac_f32_16x16x64_bf16 v[12:15], v[48:51], a[96:103], v1
    v_smfmac_f32_16x16x64_bf16 v[16:19], v[48:51], a[104:111], v1
    ds_read_b128 v[56:59], v9 offset:16384
    s_waitcnt lgkmcnt(3)
    v_smfmac_f32_16x16x64_bf16 v[12:15], v[52:55], a[136:143], v1
    ds_read_b128 v[60:63], v9 offset:17408
    v_smfmac_f32_16x16x64_bf16 v[16:19], v[52:55], a[144:151], v1
    v_smfmac_f32_16x16x64_bf16 v[20:23], v[48:51], a[112:119], v1
    s_waitcnt lgkmcnt(2)
    v_smfmac_f32_16x16x64_bf16 v[24:27], v[48:51], v[64:71], v1
    ds_read_b128 v[64:67], v0 offset:9216
    s_nop 1
    v_add_f32 v12, v12, v14
    v_smfmac_f32_16x16x64_bf16 v[20:23], v[52:55], a[152:159], v1
    ds_read_b128 v[68:71], v0 offset:10240
    v_add_f32 v16, v16, v18
    s_waitcnt lgkmcnt(2)
    v_smfmac_f32_16x16x64_bf16 v[24:27], v[52:55], v[56:63], v1
    ds_read_b128 v[56:59], v0 offset:11264
    v_add_f32 v13, v13, v15
    v_add_f32 v17, v17, v19
    v_cvt_pk_bf16_f32 v14, v12, v16
    v_cvt_pk_bf16_f32 v15, v13, v17
    ds_write_b32 v2, v14 offset:17408
    ds_write_b32 v2, v15 offset:17696
    v_smfmac_f32_16x16x64_bf16 v[28:31], v[52:55], a[160:167], v1
    ds_read_b128 v[60:63], v0 offset:12288
    v_add_f32 v20, v20, v22
    v_add_f32 v24, v24, v26
    v_add_f32 v21, v21, v23
    v_add_f32 v25, v25, v27
    v_smfmac_f32_16x16x64_bf16 v[32:35], v[52:55], a[168:175], v1
    ds_read_b128 v[12:15], v0 offset:0
    v_cvt_pk_bf16_f32 v22, v20, v24
    v_cvt_pk_bf16_f32 v23, v21, v25
    ds_write_b32 v2, v22 offset:19712
    ds_write_b32 v2, v23 offset:20000
    v_smfmac_f32_16x16x64_bf16 v[28:31], v[48:51], a[120:127], v1
    ds_read_b128 v[16:19], v0 offset:1024
    v_smfmac_f32_16x16x64_bf16 v[32:35], v[48:51], a[128:135], v1
    ds_read_b128 v[20:23], v0 offset:2048
    v_smfmac_f32_16x16x64_bf16 v[28:31], v[44:47], a[80:87], v1
    ds_read_b128 v[24:27], v0 offset:3072
    v_smfmac_f32_16x16x64_bf16 v[32:35], v[44:47], a[88:95], v1
    s_waitcnt lgkmcnt(3)
    s_barrier
    ds_read_b128 v[44:47], v3 offset:17408
    v_smfmac_f32_16x16x64_bf16 v[28:31], v[12:15], v[96:103], v1
    ds_read_b128 v[52:55], v0 offset:4096
    v_smfmac_f32_16x16x64_bf16 v[32:35], v[12:15], v[104:111], v1
    ds_read_b128 v[12:15], v3 offset:19712
    s_waitcnt lgkmcnt(5)
    v_smfmac_f32_16x16x64_bf16 v[28:31], v[16:19], v[136:143], v1
    ds_read_b128 v[48:51], v0 offset:5120
    v_smfmac_f32_16x16x64_bf16 v[32:35], v[16:19], v[144:151], v1
    s_waitcnt lgkmcnt(5)
    v_smfmac_f32_16x16x64_bf16 v[28:31], v[20:23], v[176:183], v1
    v_smfmac_f32_16x16x64_bf16 v[32:35], v[20:23], v[184:191], v1
    ds_read_b128 v[20:23], v3 offset:17472
    s_waitcnt lgkmcnt(5)
    v_smfmac_f32_16x16x64_bf16 v[28:31], v[24:27], v[216:223], v1
    v_smfmac_f32_16x16x64_bf16 v[32:35], v[24:27], v[224:231], v1
    s_waitcnt lgkmcnt(3)
    v_smfmac_f32_16x16x64_bf16 v[28:31], v[52:55], a[0:7], v1
    v_smfmac_f32_16x16x64_bf16 v[32:35], v[52:55], a[8:15], v1
    ds_read_b128 v[52:55], v3 offset:19776
    s_waitcnt lgkmcnt(2)
    v_smfmac_f32_16x16x64_bf16 v[28:31], v[48:51], a[40:47], v1
    v_smfmac_f32_16x16x64_bf16 v[32:35], v[48:51], a[48:55], v1
    ds_read_b128 v[48:51], v3 offset:17536
    v_mfma_f32_16x16x32_bf16 v[24:27], v[12:15], v[44:47], 0
    v_mfma_f32_16x16x32_bf16 v[12:15], v[64:67], v[44:47], 0
    ds_read_b128 v[64:67], v0 offset:13312
    v_mfma_f32_16x16x32_bf16 v[16:19], v[68:71], v[44:47], 0
    ds_read_b128 v[68:71], v0 offset:14336
    s_waitcnt lgkmcnt(3)
    v_mfma_f32_16x16x32_bf16 v[24:27], v[52:55], v[20:23], v[24:27]
    ds_read_b128 v[44:47], v3 offset:19840
    v_add_f32 v28, v28, v30
    v_add_f32 v29, v29, v31
    v_mfma_f32_16x16x32_bf16 v[12:15], v[56:59], v[20:23], v[12:15]
    ds_read_b128 v[52:55], v3 offset:17600
    v_add_f32 v32, v32, v34
    v_add_f32 v33, v33, v35
    v_mfma_f32_16x16x32_bf16 v[16:19], v[60:63], v[20:23], v[16:19]
    ds_read_b128 v[56:59], v0 offset:15360
    v_cvt_pk_bf16_f32 v30, v28, v29
    v_cvt_pk_bf16_f32 v31, v32, v33
    s_waitcnt lgkmcnt(2)
    v_mfma_f32_16x16x32_bf16 v[24:27], v[44:47], v[48:51], v[24:27]
    ds_read_b128 v[20:23], v3 offset:19904
    v_lshrrev_b32 v10, 8, v0
    v_mul_u32_u24 v10, 288, v10
    v_mfma_f32_16x16x32_bf16 v[12:15], v[64:67], v[48:51], v[12:15]
    ds_read_b128 v[60:63], v0 offset:16384
    v_and_b32 v11, 0xf0, v0
    v_add_u32 v10, v10, v11
    v_mfma_f32_16x16x32_bf16 v[16:19], v[68:71], v[48:51], v[16:19]
    ds_read_b128 v[32:35], v10 offset:19712
    v_lshrrev_b32 v11, 1, v0
    v_bfi_b32 v30, 1, s66, v30
    s_waitcnt lgkmcnt(2)
    v_mfma_f32_16x16x32_bf16 v[24:27], v[20:23], v[52:55], v[24:27]
    buffer_store_dwordx2 v[30:31], v11, s[8:11], s43 offen offset:2048 sc1
    v_mov_b32 v49, 0
    v_mov_b32 v50, 0
    v_mfma_f32_16x16x32_bf16 v[12:15], v[56:59], v[52:55], v[12:15]
    v_mov_b64 v[64:65], s[68:69]
    v_mov_b64 v[66:67], s[68:69]
    s_waitcnt lgkmcnt(1)
    v_mfma_f32_16x16x32_bf16 v[16:19], v[60:63], v[52:55], v[16:19]
    s_waitcnt lgkmcnt(0)
    v_bfi_b32 v32, 1, s66, v32
    s_mov_b64 exec, s[52:53]
    buffer_store_dwordx4 v[32:35], v0, s[8:11], s43 offen sc1
    s_mov_b64 exec, -1
    v_max3_f32 v10, v24, v25, v12
    v_max3_f32 v10, v10, v13, v14
    s_nop 0
    v_max3_f32 v10, v10, v15, v16
    v_max3_f32 v10, v10, v17, v18
    v_max_f32 v10, v10, v19
    v_mov_b32 v11, v10
    s_nop 1
    v_permlane32_swap_b32 v10, v11
    v_max_f32 v10, v10, v11
    v_mov_b32 v11, v10
    s_nop 1
    v_permlane16_swap_b32 v10, v11
    v_max_f32 v10, v10, v11
    v_mul_f32 v20, s46, v10
    v_pk_fma_f32 v[24:25], v[24:25], s[46:47], v[20:21] op_sel_hi:[1,1,0] neg_lo:[0,0,1] neg_hi:[0,0,1]
    v_pk_fma_f32 v[12:13], v[12:13], s[46:47], v[20:21] op_sel_hi:[1,1,0] neg_lo:[0,0,1] neg_hi:[0,0,1]
    v_exp_f32 v24, v24
    v_exp_f32 v25, v25
    v_pk_fma_f32 v[14:15], v[14:15], s[46:47], v[20:21] op_sel_hi:[1,1,0] neg_lo:[0,0,1] neg_hi:[0,0,1]
    v_exp_f32 v12, v12
    v_exp_f32 v13, v13
    v_pk_fma_f32 v[16:17], v[16:17], s[46:47], v[20:21] op_sel_hi:[1,1,0] neg_lo:[0,0,1] neg_hi:[0,0,1]
    v_cvt_pk_bf16_f32 v48, v24, v25
    v_exp_f32 v14, v14
    v_pk_fma_f32 v[18:19], v[18:19], s[46:47], v[20:21] op_sel_hi:[1,1,0] neg_lo:[0,0,1] neg_hi:[0,0,1]
    v_cvt_pk_bf16_f32 v51, v24, v25
    v_exp_f32 v15, v15
    v_cvt_pk_bf16_f32 v44, v12, v13
    v_exp_f32 v16, v16
    v_exp_f32 v17, v17
    v_cvt_pk_bf16_f32 v45, v14, v15
    v_exp_f32 v18, v18
    v_exp_f32 v19, v19
    v_cvt_pk_bf16_f32 v46, v16, v17
    v_cvt_pk_bf16_f32 v47, v18, v19
    v_mfma_f32_16x16x16_bf16 v[68:71], v[64:65], v[48:49], 0
    v_mfma_f32_16x16x16_bf16 v[52:55], v[30:31], v[48:49], 0
    v_mfma_f32_16x16x16_bf16 v[56:59], v[30:31], v[50:51], 0
    v_mfma_f32_16x16x32_bf16 v[68:71], v[64:67], v[44:47], v[68:71]
    s_waitcnt vmcnt(3)
    v_mfma_f32_16x16x32_bf16 v[52:55], v[36:39], v[44:47], v[52:55]
    s_waitcnt vmcnt(2)
    v_mfma_f32_16x16x32_bf16 v[56:59], v[40:43], v[44:47], v[56:59]
    ds_read_b128 v[36:39], v0 offset:30720
    ds_read_b128 v[40:43], v0 offset:31744
    ds_read_b128 v[60:63], v9 offset:24576
    s_nop 0
    v_rcp_f32 v10, v68
    s_nop 0
    v_pk_mul_f32 v[52:53], v[52:53], v[10:11] op_sel_hi:[1,0]
    s_nop 0
    v_pk_mul_f32 v[56:57], v[56:57], v[10:11] op_sel_hi:[1,0]
    v_cvt_pk_bf16_f32 v16, v52, v56
    v_cvt_pk_bf16_f32 v17, v53, v57
    v_pk_mul_f32 v[54:55], v[54:55], v[10:11] op_sel_hi:[1,0]
    v_pk_mul_f32 v[58:59], v[58:59], v[10:11] op_sel_hi:[1,0]
    v_cvt_pk_bf16_f32 v18, v54, v58
    v_cvt_pk_bf16_f32 v19, v55, v59
    ds_write_b128 v3, v[16:19] offset:22016
    ds_read_b128 v[64:67], v9 offset:25600
    v_mov_b64 v[12:13], 0
    v_mov_b64 v[14:15], 0
    v_mov_b64 v[20:21], 0
    v_mov_b64 v[22:23], 0
    v_mov_b64 v[24:25], 0
    v_mov_b64 v[26:27], 0
    v_mov_b64 v[32:33], 0
    v_mov_b64 v[34:35], 0
    v_mov_b64 v[44:45], 0
    v_mov_b64 v[46:47], 0
    v_mov_b64 v[48:49], 0
    v_mov_b64 v[50:51], 0
    s_waitcnt lgkmcnt(1)
    s_barrier
    ds_read_b128 v[52:55], v4 offset:22016
    ds_read_b128 v[56:59], v4 offset:22144
    v_mov_b64 v[68:69], 0
    v_mov_b64 v[70:71], 0
    v_mov_b64 v[28:29], 0
    v_mov_b64 v[30:31], 0
    v_mov_b64 v[16:17], 0
    v_mov_b64 v[18:19], 0
    s_cmp_eq_u32 s33, 63
    s_cbranch_scc1 Lr0f_last
    s_waitcnt lgkmcnt(1)
    v_smfmac_f32_16x16x64_bf16 v[28:31], v[52:55], v[60:67], v1
    ds_read_b128 v[60:63], v0 offset:24576
    s_waitcnt lgkmcnt(1)
    v_smfmac_f32_16x16x64_bf16 v[28:31], v[56:59], v[36:43], v1
    ds_read_b128 v[64:67], v0 offset:25600
    ds_read_b128 v[36:39], v9 offset:18432
    v_smfmac_f32_16x16x64_bf16 v[12:15], v[52:55], a[176:183], v1
    ds_read_b128 v[40:43], v9 offset:19456
    v_smfmac_f32_16x16x64_bf16 v[12:15], v[56:59], a[184:191], v1
    buffer_load_dwordx4 v0, s[8:11], s41 offen offset:0 lds
    v_smfmac_f32_16x16x64_bf16 v[20:23], v[52:55], a[192:199], v1
    s_nop 0
    v_add_f32 v28, v28, v30
    v_add_f32 v29, v29, v31
    s_waitcnt lgkmcnt(2)
    v_smfmac_f32_16x16x64_bf16 v[20:23], v[56:59], v[60:67], v1
    ds_read_b128 v[60:63], v9 offset:20480
    v_cvt_pk_bf16_f32 v28, v28, v29
    v_bfi_b32 v28, 1, s39, v28
    buffer_store_dword v28, v8, s[8:11], s38 offen offset:2048
    s_waitcnt lgkmcnt(1)
    v_smfmac_f32_16x16x64_bf16 v[24:27], v[52:55], v[36:43], v1
    ds_read_b128 v[64:67], v9 offset:21504
    ds_read_b128 v[36:39], v0 offset:26624
    v_add_f32 v12, v12, v14
    v_add_f32 v13, v13, v15
    v_smfmac_f32_16x16x64_bf16 v[24:27], v[56:59], a[200:207], v1
    ds_read_b128 v[40:43], v0 offset:27648
    v_cvt_pk_bf16_f32 v12, v12, v13
    v_bfi_b32 v12, 1, s39, v12
    v_smfmac_f32_16x16x64_bf16 v[32:35], v[52:55], a[208:215], v1
    buffer_load_dwordx4 v0, s[8:11], s41 offen offset:1024 lds
    v_add_f32 v20, v20, v22
    v_add_f32 v21, v21, v23
    v_smfmac_f32_16x16x64_bf16 v[32:35], v[56:59], a[216:223], v1
    v_cvt_pk_bf16_f32 v13, v20, v21
    s_waitcnt lgkmcnt(2)
    v_smfmac_f32_16x16x64_bf16 v[44:47], v[52:55], v[60:67], v1
    ds_read_b128 v[60:63], v0 offset:28672
    v_add_f32 v24, v24, v26
    v_add_f32 v25, v25, v27
    s_waitcnt lgkmcnt(1)
    v_smfmac_f32_16x16x64_bf16 v[44:47], v[56:59], v[36:43], v1
    ds_read_b128 v[64:67], v0 offset:29696
    ds_read_b128 v[36:39], v9 offset:22528
    v_cvt_pk_bf16_f32 v14, v24, v25
    v_smfmac_f32_16x16x64_bf16 v[48:51], v[52:55], a[224:231], v1
    ds_read_b128 v[40:43], v9 offset:23552
    v_add_f32 v32, v32, v34
    v_add_f32 v33, v33, v35
    v_smfmac_f32_16x16x64_bf16 v[48:51], v[56:59], a[232:239], v1
    v_cvt_pk_bf16_f32 v15, v32, v33
    buffer_store_dwordx4 v[12:15], v0, s[8:11], s38 offen offset:0
    v_smfmac_f32_16x16x64_bf16 v[68:71], v[52:55], a[240:247], v1
    v_add_f32 v44, v44, v46
    v_add_f32 v45, v45, v47
    s_waitcnt lgkmcnt(2)
    v_smfmac_f32_16x16x64_bf16 v[68:71], v[56:59], v[60:67], v1
    v_cvt_pk_bf16_f32 v44, v44, v45
    v_bfi_b32 v44, 1, s39, v44
    s_waitcnt lgkmcnt(0)
    v_smfmac_f32_16x16x64_bf16 v[16:19], v[52:55], v[36:43], v1
    v_add_f32 v48, v48, v50
    v_add_f32 v49, v49, v51
    v_smfmac_f32_16x16x64_bf16 v[16:19], v[56:59], a[248:255], v1
    v_cvt_pk_bf16_f32 v45, v48, v49
    v_add_f32 v68, v68, v70
    v_add_f32 v69, v69, v71
    v_cvt_pk_bf16_f32 v46, v68, v69
    s_nop 3
    v_add_f32 v16, v16, v18
    v_add_f32 v17, v17, v19
    v_cvt_pk_bf16_f32 v47, v16, v17
    buffer_store_dwordx4 v[44:47], v0, s[8:11], s38 offen offset:1024
    s_sleep 6
    buffer_load_dwordx4 v[52:55], v6, s[8:11], s57 offen sc1
    buffer_load_dwordx4 v[56:59], v6, s[8:11], s58 offen sc1
    buffer_load_dwordx4 v[60:63], v6, s[8:11], s59 offen sc1
    buffer_load_dwordx4 v[64:67], v6, s[8:11], s60 offen sc1
    v_bfe_u32 v10, v0, 4, 4
    v_mov_b32 v11, 0x3f80
    v_mov_b32 v40, 0x3f800000
    v_cmp_eq_u32 vcc, 0, v10
    v_cmp_eq_u32 s[48:49], 1, v10
    s_nop 0
    v_cndmask_b32 v36, 0, v11, vcc
    v_cndmask_b32 v36, v36, v40, s[48:49]
    v_cmp_eq_u32 vcc, 2, v10
    v_cmp_eq_u32 s[48:49], 3, v10
    s_nop 0
    v_cndmask_b32 v37, 0, v11, vcc
    v_cndmask_b32 v37, v37, v40, s[48:49]
    v_cmp_eq_u32 vcc, 4, v10
    v_cmp_eq_u32 s[48:49], 5, v10
    s_nop 0
    v_cndmask_b32 v38, 0, v11, vcc
    v_cndmask_b32 v38, v38, v40, s[48:49]
    v_cmp_eq_u32 vcc, 6, v10
    v_cmp_eq_u32 s[48:49], 7, v10
    s_nop 0
    v_cndmask_b32 v39, 0, v11, vcc
    v_cndmask_b32 v39, v39, v40, s[48:49]
    s_mov_b32 s16, 0
    s_mov_b64 s[70:71], 0
    s_mov_b64 s[72:73], 0
    s_mov_b64 s[74:75], 0
    s_mov_b64 s[76:77], 0
Lr0f_p1:
    s_mov_b64 exec, s[70:71]
    buffer_load_dwordx4 v[52:55], v6, s[8:11], s57 offen sc1
    s_mov_b64 exec, s[72:73]
    buffer_load_dwordx4 v[56:59], v6, s[8:11], s58 offen sc1
    s_mov_b64 exec, s[74:75]
    buffer_load_dwordx4 v[60:63], v6, s[8:11], s59 offen sc1
    s_mov_b64 exec, s[76:77]
    buffer_load_dwordx4 v[64:67], v6, s[8:11], s60 offen sc1
    s_mov_b64 exec, -1
    s_add_u32 s16, s16, 1
    s_cmp_gt_u32 s16, 100000
    s_cbranch_scc1 Lr_abort
    s_waitcnt vmcnt(7)
    v_and_b32 v11, 1, v52
    v_cmp_ne_u32 s[70:71], s39, v11
    v_mfma_f32_16x16x32_bf16 v[40:43], v[52:55], v[36:39], 0
    s_waitcnt vmcnt(6)
    v_and_b32 v11, 1, v56
    v_cmp_ne_u32 s[72:73], s39, v11
    v_mfma_f32_16x16x32_bf16 v[40:43], v[56:59], v[36:39], v[40:43]
    s_waitcnt vmcnt(5)
    v_and_b32 v11, 1, v60
    v_cmp_ne_u32 s[74:75], s39, v11
    v_mfma_f32_16x16x32_bf16 v[40:43], v[60:63], v[36:39], v[40:43]
    s_or_b64 vcc, s[70:71], s[72:73]
    s_waitcnt vmcnt(4)
    v_and_b32 v11, 1, v64
    v_cmp_ne_u32 s[76:77], s39, v11
    v_mfma_f32_16x16x32_bf16 v[40:43], v[64:67], v[36:39], v[40:43]
    s_or_b64 vcc, vcc, s[74:75]
    s_or_b64 vcc, vcc, s[76:77]
    s_cbranch_scc1 Lr0f_p1
    s_nop 4
    v_permlane16_swap_b32 v40, v42
    v_permlane16_swap_b32 v41, v43
    s_mov_b64 exec, s[50:51]
    v_add_f32 v40, v40, v42
    v_add_f32 v41, v41, v43
    v_cvt_pk_bf16_f32 v40, v40, v41
    v_min_u32 v40, s54, v40
    buffer_store_dword v40, v7, s[8:11], s36 offen
    v_mov_b32 v41, -1
    buffer_store_dword v41, v7, s[8:11], s37 offen
    s_mov_b64 exec, -1
    s_xor_b32 s34, s34, 16384
    s_xor_b32 s35, s35, 16384
    s_barrier
    s_sleep 2
    buffer_load_dwordx4 v[44:47], v0, s[8:11], s34 offen sc1
    buffer_load_dwordx4 v[48:51], v0, s[8:11], s34 offen offset:1024 sc1
    buffer_load_dword v10, v8, s[8:11], s35 offen sc1
    s_add_u32 s33, s33, 1
    s_bfe_u32 s39, s33, 0x10001
    s_xor_b32 s38, s38, 524288
    s_xor_b32 s57, s57, 524288
    s_xor_b32 s58, s58, 524288
    s_xor_b32 s59, s59, 524288
    s_xor_b32 s60, s60, 524288
    s_xor_b32 s36, s36, 16384
    s_xor_b32 s37, s37, 16384
    s_and_b32 s17, s33, 7
    s_mul_i32 s17, s17, 131072
    s_add_u32 s43, s45, s17
    s_bfe_u32 s66, s33, 65539
    s_add_u32 s67, s67, 22528
    s_add_u32 s42, s42, 262144
    s_add_u32 s41, s41, 262144
    s_add_u32 s40, s40, 262144
    s_add_u32 s44, s44, 22528
    s_waitcnt vmcnt(5)
    ds_read_b128 v[56:59], v9 offset:0
    ds_read_b128 v[60:63], v9 offset:1024
    ds_read_b128 v[64:67], v9 offset:2048
    ds_read_b128 v[68:71], v9 offset:3072
    v_mov_b64 v[12:13], 0
    v_mov_b64 v[14:15], 0
    v_mov_b64 v[16:17], 0
    v_mov_b64 v[18:19], 0
    v_mov_b64 v[20:21], 0
    v_mov_b64 v[22:23], 0
    v_mov_b64 v[24:25], 0
    v_mov_b64 v[26:27], 0
    v_mov_b64 v[28:29], 0
    v_mov_b64 v[30:31], 0
    v_mov_b64 v[32:33], 0
    v_mov_b64 v[34:35], 0
    s_waitcnt lgkmcnt(0)
    s_branch Lr0f_step
Lr0f_last:
    s_waitcnt vmcnt(0) lgkmcnt(0)
    s_branch Lr_exit
L_w1_1:
    s_cmp_lg_u32 s14, 1
    s_cbranch_scc1 L_w2_1
    s_barrier
    s_mov_b32 m0, 11264
    s_nop 0
    buffer_load_dwordx4 v0, s[8:11], s41 offen offset:0 lds
    buffer_load_dwordx4 v0, s[8:11], s41 offen offset:1024 lds
    s_add_u32 s41, s41, 262144
    s_waitcnt vmcnt(0)
    buffer_load_dwordx4 v[44:47], v0, s[8:11], s34 offen sc1
    buffer_load_dwordx4 v[48:51], v0, s[8:11], s34 offen offset:1024 sc1
    buffer_load_dword v10, v8, s[8:11], s35 offen sc1
    ds_read_b128 v[56:59], v9 offset:4096
    ds_read_b128 v[60:63], v9 offset:5120
    ds_read_b128 v[64:67], v9 offset:6144
    ds_read_b128 v[68:71], v9 offset:7168
    v_mov_b64 v[12:13], 0
    v_mov_b64 v[14:15], 0
    v_mov_b64 v[16:17], 0
    v_mov_b64 v[18:19], 0
    v_mov_b64 v[20:21], 0
    v_mov_b64 v[22:23], 0
    v_mov_b64 v[24:25], 0
    v_mov_b64 v[26:27], 0
    v_mov_b64 v[28:29], 0
    v_mov_b64 v[30:31], 0
    v_mov_b64 v[32:33], 0
    v_mov_b64 v[34:35], 0
    s_waitcnt lgkmcnt(0)
Lr1f_step:
    s_mov_b32 s16, 0
    s_mov_b64 s[70:71], 0
    s_mov_b64 s[72:73], 0
    s_mov_b64 s[74:75], 0
Lr1f_p2:
    s_mov_b64 exec, s[70:71]
    buffer_load_dwordx4 v[44:47], v0, s[8:11], s34 offen sc1
    s_mov_b64 exec, s[72:73]
    buffer_load_dwordx4 v[48:51], v0, s[8:11], s34 offen offset:1024 sc1
    s_mov_b64 exec, s[74:75]
    buffer_load_dword v10, v8, s[8:11], s35 offen sc1
    s_mov_b64 exec, -1
    s_add_u32 s16, s16, 1
    s_cmp_gt_u32 s16, 100000
    s_cbranch_scc1 Lr_abort
    s_waitcnt vmcnt(5)
    v_max3_u32 v11, v44, v45, v46
    v_max_u32 v11, v11, v47
    v_cmp_eq_u32 s[70:71], -1, v11
    s_waitcnt vmcnt(4)
    v_max3_u32 v11, v48, v49, v50
    v_max_u32 v11, v11, v51
    v_cmp_eq_u32 s[72:73], -1, v11
    s_waitcnt vmcnt(3)
    v_cmp_eq_u32 s[74:75], -1, v10
    s_or_b64 vcc, s[70:71], s[72:73]
    s_or_b64 vcc, vcc, s[74:75]
    s_cbranch_scc1 Lr1f_p2
    v_smfmac_f32_16x16x64_bf16 v[12:15], v[44:47], v[152:159], v1
    ds_write_b128 v0, v[44:47] offset:2048
    v_smfmac_f32_16x16x64_bf16 v[16:19], v[44:47], v[160:167], v1
    ds_write_b128 v0, v[48:51] offset:3072
    v_smfmac_f32_16x16x64_bf16 v[20:23], v[44:47], v[168:175], v1
    ds_write_b32 v8, v10 offset:8448
    v_smfmac_f32_16x16x64_bf16 v[24:27], v[44:47], v[56:63], v1
    s_waitcnt lgkmcnt(0)
    s_barrier
    ds_read_b128 v[52:55], v0 offset:0
    v_smfmac_f32_16x16x64_bf16 v[12:15], v[48:51], v[192:199], v1
    ds_read_b128 v[36:39], v0 offset:1024
    v_smfmac_f32_16x16x64_bf16 v[16:19], v[48:51], v[200:207], v1
    ds_read_b128 v[56:59], v9 offset:0
    v_smfmac_f32_16x16x64_bf16 v[20:23], v[48:51], v[208:215], v1
    ds_read_b128 v[60:63], v9 offset:1024
    v_smfmac_f32_16x16x64_bf16 v[24:27], v[48:51], v[64:71], v1
    ds_read_b128 v[40:43], v0 offset:4096
    s_waitcnt lgkmcnt(4)
    v_smfmac_f32_16x16x64_bf16 v[12:15], v[52:55], v[72:79], v1
    v_smfmac_f32_16x16x64_bf16 v[16:19], v[52:55], v[80:87], v1
    ds_read_b128 v[64:67], v9 offset:2048
    v_smfmac_f32_16x16x64_bf16 v[20:23], v[52:55], v[88:95], v1
    ds_read_b128 v[68:71], v9 offset:3072
    s_waitcnt lgkmcnt(3)
    v_smfmac_f32_16x16x64_bf16 v[24:27], v[52:55], v[56:63], v1
    v_smfmac_f32_16x16x64_bf16 v[12:15], v[36:39], v[112:119], v1
    ds_read_b128 v[52:55], v0 offset:5120
    v_smfmac_f32_16x16x64_bf16 v[16:19], v[36:39], v[120:127], v1
    ds_read_b128 v[56:59], v9 offset:8192
    v_smfmac_f32_16x16x64_bf16 v[20:23], v[36:39], v[128:135], v1
    ds_read_b128 v[60:63], v9 offset:9216
    s_waitcnt lgkmcnt(3)
    v_smfmac_f32_16x16x64_bf16 v[24:27], v[36:39], v[64:71], v1
    v_smfmac_f32_16x16x64_bf16 v[12:15], v[40:43], v[232:239], v1
    buffer_load_dwordx4 v[36:39], v0, s[8:11], s42 offen
    v_smfmac_f32_16x16x64_bf16 v[16:19], v[40:43], v[240:247], v1
    ds_read_b128 v[64:67], v9 offset:10240
    v_smfmac_f32_16x16x64_bf16 v[20:23], v[40:43], v[248:255], v1
    ds_read_b128 v[68:71], v9 offset:11264
    s_waitcnt lgkmcnt(2)
    v_smfmac_f32_16x16x64_bf16 v[24:27], v[40:43], v[56:63], v1
    s_waitcnt vmcnt(1)
    ds_read_b128 v[44:47], v0 offset:6144
    v_smfmac_f32_16x16x64_bf16 v[12:15], v[52:55], a[16:23], v1
    buffer_load_dwordx4 v[40:43], v0, s[8:11], s42 offen offset:1024
    v_smfmac_f32_16x16x64_bf16 v[16:19], v[52:55], a[24:31], v1
    ds_read_b128 v[56:59], v9 offset:12288
    v_smfmac_f32_16x16x64_bf16 v[20:23], v[52:55], a[32:39], v1
    ds_read_b128 v[60:63], v9 offset:13312
    s_waitcnt lgkmcnt(3)
    v_smfmac_f32_16x16x64_bf16 v[24:27], v[52:55], v[64:71], v1
    ds_read_b128 v[48:51], v0 offset:7168
    s_waitcnt lgkmcnt(3)
    v_smfmac_f32_16x16x64_bf16 v[12:15], v[44:47], a[56:63], v1
    ds_read_b128 v[52:55], v0 offset:8192
    v_smfmac_f32_16x16x64_bf16 v[16:19], v[44:47], a[64:71], v1
    ds_read_b128 v[64:67], v9 offset:14336
    v_smfmac_f32_16x16x64_bf16 v[20:23], v[44:47], a[72:79], v1
    ds_read_b128 v[68:71], v9 offset:15360
    s_waitcnt lgkmcnt(4)
    v_smfmac_f32_16x16x64_bf16 v[24:27], v[44:47], v[56:63], v1
    s_waitcnt lgkmcnt(3)
    v_smfmac_f32_16x16x64_bf16 v[12:15], v[48:51], a[96:103], v1
    v_smfmac_f32_16x16x64_bf16 v[16:19], v[48:51], a[104:111], v1
    ds_read_b128 v[56:59], v9 offset:16384
    s_waitcnt lgkmcnt(3)
    v_smfmac_f32_16x16x64_bf16 v[12:15], v[52:55], a[136:143], v1
    ds_read_b128 v[60:63], v9 offset:17408
    v_smfmac_f32_16x16x64_bf16 v[16:19], v[52:55], a[144:151], v1
    v_smfmac_f32_16x16x64_bf16 v[20:23], v[48:51], a[112:119], v1
    s_waitcnt lgkmcnt(2)
    v_smfmac_f32_16x16x64_bf16 v[24:27], v[48:51], v[64:71], v1
    ds_read_b128 v[64:67], v0 offset:9216
    s_nop 1
    v_add_f32 v12, v12, v14
    v_smfmac_f32_16x16x64_bf16 v[20:23], v[52:55], a[152:159], v1
    ds_read_b128 v[68:71], v0 offset:10240
    v_add_f32 v16, v16, v18
    s_waitcnt lgkmcnt(2)
    v_smfmac_f32_16x16x64_bf16 v[24:27], v[52:55], v[56:63], v1
    ds_read_b128 v[56:59], v0 offset:11264
    v_add_f32 v13, v13, v15
    v_add_f32 v17, v17, v19
    v_cvt_pk_bf16_f32 v14, v12, v16
    v_cvt_pk_bf16_f32 v15, v13, v17
    ds_write_b32 v2, v14 offset:17408
    ds_write_b32 v2, v15 offset:17696
    v_smfmac_f32_16x16x64_bf16 v[28:31], v[52:55], a[160:167], v1
    ds_read_b128 v[60:63], v0 offset:12288
    v_add_f32 v20, v20, v22
    v_add_f32 v24, v24, v26
    v_add_f32 v21, v21, v23
    v_add_f32 v25, v25, v27
    v_smfmac_f32_16x16x64_bf16 v[32:35], v[52:55], a[168:175], v1
    ds_read_b128 v[12:15], v0 offset:2048
    v_cvt_pk_bf16_f32 v22, v20, v24
    v_cvt_pk_bf16_f32 v23, v21, v25
    ds_write_b32 v2, v22 offset:19712
    ds_write_b32 v2, v23 offset:20000
    v_smfmac_f32_16x16x64_bf16 v[28:31], v[48:51], a[120:127], v1
    ds_read_b128 v[16:19], v0 offset:3072
    v_smfmac_f32_16x16x64_bf16 v[32:35], v[48:51], a[128:135], v1
    ds_read_b128 v[20:23], v0 offset:0
    v_smfmac_f32_16x16x64_bf16 v[28:31], v[44:47], a[80:87], v1
    ds_read_b128 v[24:27], v0 offset:1024
    v_smfmac_f32_16x16x64_bf16 v[32:35], v[44:47], a[88:95], v1
    s_waitcnt lgkmcnt(3)
    s_barrier
    ds_read_b128 v[44:47], v3 offset:17408
    v_smfmac_f32_16x16x64_bf16 v[28:31], v[12:15], v[176:183], v1
    ds_read_b128 v[52:55], v0 offset:4096
    v_smfmac_f32_16x16x64_bf16 v[32:35], v[12:15], v[184:191], v1
    ds_read_b128 v[12:15], v3 offset:19712
    s_waitcnt lgkmcnt(5)
    v_smfmac_f32_16x16x64_bf16 v[28:31], v[16:19], v[216:223], v1
    ds_read_b128 v[48:51], v0 offset:5120
    v_smfmac_f32_16x16x64_bf16 v[32:35], v[16:19], v[224:231], v1
    s_waitcnt lgkmcnt(5)
    v_smfmac_f32_16x16x64_bf16 v[28:31], v[20:23], v[96:103], v1
    v_smfmac_f32_16x16x64_bf16 v[32:35], v[20:23], v[104:111], v1
    ds_read_b128 v[20:23], v3 offset:17472
    s_waitcnt lgkmcnt(5)
    v_smfmac_f32_16x16x64_bf16 v[28:31], v[24:27], v[136:143], v1
    v_smfmac_f32_16x16x64_bf16 v[32:35], v[24:27], v[144:151], v1
    s_waitcnt lgkmcnt(3)
    v_smfmac_f32_16x16x64_bf16 v[28:31], v[52:55], a[0:7], v1
    v_smfmac_f32_16x16x64_bf16 v[32:35], v[52:55], a[8:15], v1
    ds_read_b128 v[52:55], v3 offset:19776
    s_waitcnt lgkmcnt(2)
    v_smfmac_f32_16x16x64_bf16 v[28:31], v[48:51], a[40:47], v1
    v_smfmac_f32_16x16x64_bf16 v[32:35], v[48:51], a[48:55], v1
    ds_read_b128 v[48:51], v3 offset:17536
    v_mfma_f32_16x16x32_bf16 v[24:27], v[12:15], v[44:47], 0
    v_mfma_f32_16x16x32_bf16 v[12:15], v[64:67], v[44:47], 0
    ds_read_b128 v[64:67], v0 offset:13312
    v_mfma_f32_16x16x32_bf16 v[16:19], v[68:71], v[44:47], 0
    ds_read_b128 v[68:71], v0 offset:14336
    s_waitcnt lgkmcnt(3)
    v_mfma_f32_16x16x32_bf16 v[24:27], v[52:55], v[20:23], v[24:27]
    ds_read_b128 v[44:47], v3 offset:19840
    v_add_f32 v28, v28, v30
    v_add_f32 v29, v29, v31
    v_mfma_f32_16x16x32_bf16 v[12:15], v[56:59], v[20:23], v[12:15]
    ds_read_b128 v[52:55], v3 offset:17600
    v_add_f32 v32, v32, v34
    v_add_f32 v33, v33, v35
    v_mfma_f32_16x16x32_bf16 v[16:19], v[60:63], v[20:23], v[16:19]
    ds_read_b128 v[56:59], v0 offset:15360
    v_cvt_pk_bf16_f32 v30, v28, v29
    v_cvt_pk_bf16_f32 v31, v32, v33
    s_waitcnt lgkmcnt(2)
    v_mfma_f32_16x16x32_bf16 v[24:27], v[44:47], v[48:51], v[24:27]
    ds_read_b128 v[20:23], v3 offset:19904
    v_lshrrev_b32 v10, 8, v0
    v_mul_u32_u24 v10, 288, v10
    v_mfma_f32_16x16x32_bf16 v[12:15], v[64:67], v[48:51], v[12:15]
    ds_read_b128 v[60:63], v0 offset:16384
    v_and_b32 v11, 0xf0, v0
    v_add_u32 v10, v10, v11
    v_mfma_f32_16x16x32_bf16 v[16:19], v[68:71], v[48:51], v[16:19]
    ds_read_b128 v[32:35], v10 offset:20288
    v_lshrrev_b32 v11, 1, v0
    v_bfi_b32 v30, 1, s66, v30
    s_waitcnt lgkmcnt(2)
    v_mfma_f32_16x16x32_bf16 v[24:27], v[20:23], v[52:55], v[24:27]
    buffer_store_dwordx2 v[30:31], v11, s[8:11], s43 offen offset:2048 sc1
    v_mov_b32 v49, 0
    v_mov_b32 v50, 0
    v_mfma_f32_16x16x32_bf16 v[12:15], v[56:59], v[52:55], v[12:15]
    v_mov_b64 v[64:65], s[68:69]
    v_mov_b64 v[66:67], s[68:69]
    s_waitcnt lgkmcnt(1)
    v_mfma_f32_16x16x32_bf16 v[16:19], v[60:63], v[52:55], v[16:19]
    s_waitcnt lgkmcnt(0)
    v_bfi_b32 v32, 1, s66, v32
    s_mov_b64 exec, s[52:53]
    buffer_store_dwordx4 v[32:35], v0, s[8:11], s43 offen sc1
    s_mov_b64 exec, -1
    v_max3_f32 v10, v24, v25, v12
    v_max3_f32 v10, v10, v13, v14
    s_nop 0
    v_max3_f32 v10, v10, v15, v16
    v_max3_f32 v10, v10, v17, v18
    v_max_f32 v10, v10, v19
    v_mov_b32 v11, v10
    s_nop 1
    v_permlane32_swap_b32 v10, v11
    v_max_f32 v10, v10, v11
    v_mov_b32 v11, v10
    s_nop 1
    v_permlane16_swap_b32 v10, v11
    v_max_f32 v10, v10, v11
    v_mul_f32 v20, s46, v10
    v_pk_fma_f32 v[24:25], v[24:25], s[46:47], v[20:21] op_sel_hi:[1,1,0] neg_lo:[0,0,1] neg_hi:[0,0,1]
    v_pk_fma_f32 v[12:13], v[12:13], s[46:47], v[20:21] op_sel_hi:[1,1,0] neg_lo:[0,0,1] neg_hi:[0,0,1]
    v_exp_f32 v24, v24
    v_exp_f32 v25, v25
    v_pk_fma_f32 v[14:15], v[14:15], s[46:47], v[20:21] op_sel_hi:[1,1,0] neg_lo:[0,0,1] neg_hi:[0,0,1]
    v_exp_f32 v12, v12
    v_exp_f32 v13, v13
    v_pk_fma_f32 v[16:17], v[16:17], s[46:47], v[20:21] op_sel_hi:[1,1,0] neg_lo:[0,0,1] neg_hi:[0,0,1]
    v_cvt_pk_bf16_f32 v48, v24, v25
    v_exp_f32 v14, v14
    v_pk_fma_f32 v[18:19], v[18:19], s[46:47], v[20:21] op_sel_hi:[1,1,0] neg_lo:[0,0,1] neg_hi:[0,0,1]
    v_cvt_pk_bf16_f32 v51, v24, v25
    v_exp_f32 v15, v15
    v_cvt_pk_bf16_f32 v44, v12, v13
    v_exp_f32 v16, v16
    v_exp_f32 v17, v17
    v_cvt_pk_bf16_f32 v45, v14, v15
    v_exp_f32 v18, v18
    v_exp_f32 v19, v19
    v_cvt_pk_bf16_f32 v46, v16, v17
    v_cvt_pk_bf16_f32 v47, v18, v19
    v_mfma_f32_16x16x16_bf16 v[68:71], v[64:65], v[48:49], 0
    v_mfma_f32_16x16x16_bf16 v[52:55], v[30:31], v[48:49], 0
    v_mfma_f32_16x16x16_bf16 v[56:59], v[30:31], v[50:51], 0
    v_mfma_f32_16x16x32_bf16 v[68:71], v[64:67], v[44:47], v[68:71]
    s_waitcnt vmcnt(3)
    v_mfma_f32_16x16x32_bf16 v[52:55], v[36:39], v[44:47], v[52:55]
    s_waitcnt vmcnt(2)
    v_mfma_f32_16x16x32_bf16 v[56:59], v[40:43], v[44:47], v[56:59]
    ds_read_b128 v[36:39], v0 offset:38912
    ds_read_b128 v[40:43], v0 offset:39936
    ds_read_b128 v[60:63], v9 offset:24576
    s_nop 0
    v_rcp_f32 v10, v68
    s_nop 0
    v_pk_mul_f32 v[52:53], v[52:53], v[10:11] op_sel_hi:[1,0]
    s_nop 0
    v_pk_mul_f32 v[56:57], v[56:57], v[10:11] op_sel_hi:[1,0]
    v_cvt_pk_bf16_f32 v16, v52, v56
    v_cvt_pk_bf16_f32 v17, v53, v57
    v_pk_mul_f32 v[54:55], v[54:55], v[10:11] op_sel_hi:[1,0]
    v_pk_mul_f32 v[58:59], v[58:59], v[10:11] op_sel_hi:[1,0]
    v_cvt_pk_bf16_f32 v18, v54, v58
    v_cvt_pk_bf16_f32 v19, v55, v59
    ds_write_b128 v3, v[16:19] offset:22080
    ds_read_b128 v[64:67], v9 offset:25600
    v_mov_b64 v[12:13], 0
    v_mov_b64 v[14:15], 0
    v_mov_b64 v[20:21], 0
    v_mov_b64 v[22:23], 0
    v_mov_b64 v[24:25], 0
    v_mov_b64 v[26:27], 0
    v_mov_b64 v[32:33], 0
    v_mov_b64 v[34:35], 0
    v_mov_b64 v[44:45], 0
    v_mov_b64 v[46:47], 0
    v_mov_b64 v[48:49], 0
    v_mov_b64 v[50:51], 0
    s_waitcnt lgkmcnt(1)
    s_barrier
    ds_read_b128 v[52:55], v4 offset:22016
    ds_read_b128 v[56:59], v4 offset:22144
    v_mov_b64 v[68:69], 0
    v_mov_b64 v[70:71], 0
    v_mov_b64 v[28:29], 0
    v_mov_b64 v[30:31], 0
    v_mov_b64 v[16:17], 0
    v_mov_b64 v[18:19], 0
    s_cmp_eq_u32 s33, 63
    s_cbranch_scc1 Lr1f_last
    s_waitcnt lgkmcnt(1)
    v_smfmac_f32_16x16x64_bf16 v[28:31], v[52:55], v[60:67], v1
    ds_read_b128 v[60:63], v0 offset:32768
    s_waitcnt lgkmcnt(1)
    v_smfmac_f32_16x16x64_bf16 v[28:31], v[56:59], v[36:43], v1
    ds_read_b128 v[64:67], v0 offset:33792
    ds_read_b128 v[36:39], v9 offset:18432
    v_smfmac_f32_16x16x64_bf16 v[12:15], v[52:55], a[176:183], v1
    ds_read_b128 v[40:43], v9 offset:19456
    v_smfmac_f32_16x16x64_bf16 v[12:15], v[56:59], a[184:191], v1
    buffer_load_dwordx4 v0, s[8:11], s41 offen offset:0 lds
    v_smfmac_f32_16x16x64_bf16 v[20:23], v[52:55], a[192:199], v1
    s_nop 0
    v_add_f32 v28, v28, v30
    v_add_f32 v29, v29, v31
    s_waitcnt lgkmcnt(2)
    v_smfmac_f32_16x16x64_bf16 v[20:23], v[56:59], v[60:67], v1
    ds_read_b128 v[60:63], v9 offset:20480
    v_cvt_pk_bf16_f32 v28, v28, v29
    v_bfi_b32 v28, 1, s39, v28
    buffer_store_dword v28, v8, s[8:11], s38 offen offset:2048
    s_waitcnt lgkmcnt(1)
    v_smfmac_f32_16x16x64_bf16 v[24:27], v[52:55], v[36:43], v1
    ds_read_b128 v[64:67], v9 offset:21504
    ds_read_b128 v[36:39], v0 offset:34816
    v_add_f32 v12, v12, v14
    v_add_f32 v13, v13, v15
    v_smfmac_f32_16x16x64_bf16 v[24:27], v[56:59], a[200:207], v1
    ds_read_b128 v[40:43], v0 offset:35840
    v_cvt_pk_bf16_f32 v12, v12, v13
    v_bfi_b32 v12, 1, s39, v12
    v_smfmac_f32_16x16x64_bf16 v[32:35], v[52:55], a[208:215], v1
    buffer_load_dwordx4 v0, s[8:11], s41 offen offset:1024 lds
    v_add_f32 v20, v20, v22
    v_add_f32 v21, v21, v23
    v_smfmac_f32_16x16x64_bf16 v[32:35], v[56:59], a[216:223], v1
    v_cvt_pk_bf16_f32 v13, v20, v21
    s_waitcnt lgkmcnt(2)
    v_smfmac_f32_16x16x64_bf16 v[44:47], v[52:55], v[60:67], v1
    ds_read_b128 v[60:63], v0 offset:36864
    v_add_f32 v24, v24, v26
    v_add_f32 v25, v25, v27
    s_waitcnt lgkmcnt(1)
    v_smfmac_f32_16x16x64_bf16 v[44:47], v[56:59], v[36:43], v1
    ds_read_b128 v[64:67], v0 offset:37888
    ds_read_b128 v[36:39], v9 offset:22528
    v_cvt_pk_bf16_f32 v14, v24, v25
    v_smfmac_f32_16x16x64_bf16 v[48:51], v[52:55], a[224:231], v1
    ds_read_b128 v[40:43], v9 offset:23552
    v_add_f32 v32, v32, v34
    v_add_f32 v33, v33, v35
    v_smfmac_f32_16x16x64_bf16 v[48:51], v[56:59], a[232:239], v1
    v_cvt_pk_bf16_f32 v15, v32, v33
    buffer_store_dwordx4 v[12:15], v0, s[8:11], s38 offen offset:0
    v_smfmac_f32_16x16x64_bf16 v[68:71], v[52:55], a[240:247], v1
    v_add_f32 v44, v44, v46
    v_add_f32 v45, v45, v47
    s_waitcnt lgkmcnt(2)
    v_smfmac_f32_16x16x64_bf16 v[68:71], v[56:59], v[60:67], v1
    v_cvt_pk_bf16_f32 v44, v44, v45
    v_bfi_b32 v44, 1, s39, v44
    s_waitcnt lgkmcnt(0)
    v_smfmac_f32_16x16x64_bf16 v[16:19], v[52:55], v[36:43], v1
    v_add_f32 v48, v48, v50
    v_add_f32 v49, v49, v51
    v_smfmac_f32_16x16x64_bf16 v[16:19], v[56:59], a[248:255], v1
    v_cvt_pk_bf16_f32 v45, v48, v49
    v_add_f32 v68, v68, v70
    v_add_f32 v69, v69, v71
    v_cvt_pk_bf16_f32 v46, v68, v69
    s_nop 3
    v_add_f32 v16, v16, v18
    v_add_f32 v17, v17, v19
    v_cvt_pk_bf16_f32 v47, v16, v17
    buffer_store_dwordx4 v[44:47], v0, s[8:11], s38 offen offset:1024
    s_sleep 6
    buffer_load_dwordx4 v[52:55], v6, s[8:11], s57 offen sc1
    buffer_load_dwordx4 v[56:59], v6, s[8:11], s58 offen sc1
    buffer_load_dwordx4 v[60:63], v6, s[8:11], s59 offen sc1
    buffer_load_dwordx4 v[64:67], v6, s[8:11], s60 offen sc1
    v_bfe_u32 v10, v0, 4, 4
    v_mov_b32 v11, 0x3f80
    v_mov_b32 v40, 0x3f800000
    v_cmp_eq_u32 vcc, 0, v10
    v_cmp_eq_u32 s[48:49], 1, v10
    s_nop 0
    v_cndmask_b32 v36, 0, v11, vcc
    v_cndmask_b32 v36, v36, v40, s[48:49]
    v_cmp_eq_u32 vcc, 2, v10
    v_cmp_eq_u32 s[48:49], 3, v10
    s_nop 0
    v_cndmask_b32 v37, 0, v11, vcc
    v_cndmask_b32 v37, v37, v40, s[48:49]
    v_cmp_eq_u32 vcc, 4, v10
    v_cmp_eq_u32 s[48:49], 5, v10
    s_nop 0
    v_cndmask_b32 v38, 0, v11, vcc
    v_cndmask_b32 v38, v38, v40, s[48:49]
    v_cmp_eq_u32 vcc, 6, v10
    v_cmp_eq_u32 s[48:49], 7, v10
    s_nop 0
    v_cndmask_b32 v39, 0, v11, vcc
    v_cndmask_b32 v39, v39, v40, s[48:49]
    s_mov_b32 s16, 0
    s_mov_b64 s[70:71], 0
    s_mov_b64 s[72:73], 0
    s_mov_b64 s[74:75], 0
    s_mov_b64 s[76:77], 0
Lr1f_p1:
    s_mov_b64 exec, s[70:71]
    buffer_load_dwordx4 v[52:55], v6, s[8:11], s57 offen sc1
    s_mov_b64 exec, s[72:73]
    buffer_load_dwordx4 v[56:59], v6, s[8:11], s58 offen sc1
    s_mov_b64 exec, s[74:75]
    buffer_load_dwordx4 v[60:63], v6, s[8:11], s59 offen sc1
    s_mov_b64 exec, s[76:77]
    buffer_load_dwordx4 v[64:67], v6, s[8:11], s60 offen sc1
    s_mov_b64 exec, -1
    s_add_u32 s16, s16, 1
    s_cmp_gt_u32 s16, 100000
    s_cbranch_scc1 Lr_abort
    s_waitcnt vmcnt(7)
    v_and_b32 v11, 1, v52
    v_cmp_ne_u32 s[70:71], s39, v11
    v_mfma_f32_16x16x32_bf16 v[40:43], v[52:55], v[36:39], 0
    s_waitcnt vmcnt(6)
    v_and_b32 v11, 1, v56
    v_cmp_ne_u32 s[72:73], s39, v11
    v_mfma_f32_16x16x32_bf16 v[40:43], v[56:59], v[36:39], v[40:43]
    s_waitcnt vmcnt(5)
    v_and_b32 v11, 1, v60
    v_cmp_ne_u32 s[74:75], s39, v11
    v_mfma_f32_16x16x32_bf16 v[40:43], v[60:63], v[36:39], v[40:43]
    s_or_b64 vcc, s[70:71], s[72:73]
    s_waitcnt vmcnt(4)
    v_and_b32 v11, 1, v64
    v_cmp_ne_u32 s[76:77], s39, v11
    v_mfma_f32_16x16x32_bf16 v[40:43], v[64:67], v[36:39], v[40:43]
    s_or_b64 vcc, vcc, s[74:75]
    s_or_b64 vcc, vcc, s[76:77]
    s_cbranch_scc1 Lr1f_p1
    s_nop 4
    v_permlane16_swap_b32 v40, v42
    v_permlane16_swap_b32 v41, v43
    s_mov_b64 exec, s[50:51]
    v_add_f32 v40, v40, v42
    v_add_f32 v41, v41, v43
    v_cvt_pk_bf16_f32 v40, v40, v41
    v_min_u32 v40, s54, v40
    buffer_store_dword v40, v7, s[8:11], s36 offen
    v_mov_b32 v41, -1
    buffer_store_dword v41, v7, s[8:11], s37 offen
    s_mov_b64 exec, -1
    s_xor_b32 s34, s34, 16384
    s_xor_b32 s35, s35, 16384
    s_barrier
    s_sleep 2
    buffer_load_dwordx4 v[44:47], v0, s[8:11], s34 offen sc1
    buffer_load_dwordx4 v[48:51], v0, s[8:11], s34 offen offset:1024 sc1
    buffer_load_dword v10, v8, s[8:11], s35 offen sc1
    s_add_u32 s33, s33, 1
    s_bfe_u32 s39, s33, 0x10001
    s_xor_b32 s38, s38, 524288
    s_xor_b32 s57, s57, 524288
    s_xor_b32 s58, s58, 524288
    s_xor_b32 s59, s59, 524288
    s_xor_b32 s60, s60, 524288
    s_xor_b32 s36, s36, 16384
    s_xor_b32 s37, s37, 16384
    s_and_b32 s17, s33, 7
    s_mul_i32 s17, s17, 131072
    s_add_u32 s43, s45, s17
    s_bfe_u32 s66, s33, 65539
    s_add_u32 s67, s67, 22528
    s_add_u32 s42, s42, 262144
    s_add_u32 s41, s41, 262144
    s_add_u32 s40, s40, 262144
    s_add_u32 s44, s44, 22528
    s_waitcnt vmcnt(5)
    ds_read_b128 v[56:59], v9 offset:4096
    ds_read_b128 v[60:63], v9 offset:5120
    ds_read_b128 v[64:67], v9 offset:6144
    ds_read_b128 v[68:71], v9 offset:7168
    v_mov_b64 v[12:13], 0
    v_mov_b64 v[14:15], 0
    v_mov_b64 v[16:17], 0
    v_mov_b64 v[18:19], 0
    v_mov_b64 v[20:21], 0
    v_mov_b64 v[22:23], 0
    v_mov_b64 v[24:25], 0
    v_mov_b64 v[26:27], 0
    v_mov_b64 v[28:29], 0
    v_mov_b64 v[30:31], 0
    v_mov_b64 v[32:33], 0
    v_mov_b64 v[34:35], 0
    s_waitcnt lgkmcnt(0)
    s_branch Lr1f_step
Lr1f_last:
    s_waitcnt vmcnt(0) lgkmcnt(0)
    s_branch Lr_exit
L_w2_1:
    s_cmp_lg_u32 s14, 2
    s_cbranch_scc1 L_w3_1
    s_barrier
    s_mov_b32 m0, 13312
    s_nop 0
    buffer_load_dwordx4 v0, s[8:11], s41 offen offset:0 lds
    buffer_load_dwordx4 v0, s[8:11], s41 offen offset:1024 lds
    s_add_u32 s41, s41, 262144
    s_waitcnt vmcnt(0)
    buffer_load_dwordx4 v[44:47], v0, s[8:11], s34 offen sc1
    buffer_load_dwordx4 v[48:51], v0, s[8:11], s34 offen offset:1024 sc1
    buffer_load_dword v10, v8, s[8:11], s35 offen sc1
    ds_read_b128 v[56:59], v9 offset:8192
    ds_read_b128 v[60:63], v9 offset:9216
    ds_read_b128 v[64:67], v9 offset:10240
    ds_read_b128 v[68:71], v9 offset:11264
    v_mov_b64 v[12:13], 0
    v_mov_b64 v[14:15], 0
    v_mov_b64 v[16:17], 0
    v_mov_b64 v[18:19], 0
    v_mov_b64 v[20:21], 0
    v_mov_b64 v[22:23], 0
    v_mov_b64 v[24:25], 0
    v_mov_b64 v[26:27], 0
    v_mov_b64 v[28:29], 0
    v_mov_b64 v[30:31], 0
    v_mov_b64 v[32:33], 0
    v_mov_b64 v[34:35], 0
    s_waitcnt lgkmcnt(0)
Lr2f_step:
    s_mov_b32 s16, 0
    s_mov_b64 s[70:71], 0
    s_mov_b64 s[72:73], 0
    s_mov_b64 s[74:75], 0
Lr2f_p2:
    s_mov_b64 exec, s[70:71]
    buffer_load_dwordx4 v[44:47], v0, s[8:11], s34 offen sc1
    s_mov_b64 exec, s[72:73]
    buffer_load_dwordx4 v[48:51], v0, s[8:11], s34 offen offset:1024 sc1
    s_mov_b64 exec, s[74:75]
    buffer_load_dword v10, v8, s[8:11], s35 offen sc1
    s_mov_b64 exec, -1
    s_add_u32 s16, s16, 1
    s_cmp_gt_u32 s16, 100000
    s_cbranch_scc1 Lr_abort
    s_waitcnt vmcnt(5)
    v_max3_u32 v11, v44, v45, v46
    v_max_u32 v11, v11, v47
    v_cmp_eq_u32 s[70:71], -1, v11
    s_waitcnt vmcnt(4)
    v_max3_u32 v11, v48, v49, v50
    v_max_u32 v11, v11, v51
    v_cmp_eq_u32 s[72:73], -1, v11
    s_waitcnt vmcnt(3)
    v_cmp_eq_u32 s[74:75], -1, v10
    s_or_b64 vcc, s[70:71], s[72:73]
    s_or_b64 vcc, vcc, s[74:75]
    s_cbranch_scc1 Lr2f_p2
    v_smfmac_f32_16x16x64_bf16 v[12:15], v[44:47], v[232:239], v1
    ds_write_b128 v0, v[44:47] offset:4096
    v_smfmac_f32_16x16x64_bf16 v[16:19], v[44:47], v[240:247], v1
    ds_write_b128 v0, v[48:51] offset:5120
    v_smfmac_f32_16x16x64_bf16 v[20:23], v[44:47], v[248:255], v1
    ds_write_b32 v8, v10 offset:8704
    v_smfmac_f32_16x16x64_bf16 v[24:27], v[44:47], v[56:63], v1
    s_waitcnt lgkmcnt(0)
    s_barrier
    ds_read_b128 v[52:55], v0 offset:0
    v_smfmac_f32_16x16x64_bf16 v[12:15], v[48:51], a[16:23], v1
    ds_read_b128 v[36:39], v0 offset:1024
    v_smfmac_f32_16x16x64_bf16 v[16:19], v[48:51], a[24:31], v1
    ds_read_b128 v[56:59], v9 offset:0
    v_smfmac_f32_16x16x64_bf16 v[20:23], v[48:51], a[32:39], v1
    ds_read_b128 v[60:63], v9 offset:1024
    v_smfmac_f32_16x16x64_bf16 v[24:27], v[48:51], v[64:71], v1
    ds_read_b128 v[40:43], v0 offset:2048
    s_waitcnt lgkmcnt(4)
    v_smfmac_f32_16x16x64_bf16 v[12:15], v[52:55], v[72:79], v1
    v_smfmac_f32_16x16x64_bf16 v[16:19], v[52:55], v[80:87], v1
    ds_read_b128 v[64:67], v9 offset:2048
    v_smfmac_f32_16x16x64_bf16 v[20:23], v[52:55], v[88:95], v1
    ds_read_b128 v[68:71], v9 offset:3072
    s_waitcnt lgkmcnt(3)
    v_smfmac_f32_16x16x64_bf16 v[24:27], v[52:55], v[56:63], v1
    v_smfmac_f32_16x16x64_bf16 v[12:15], v[36:39], v[112:119], v1
    ds_read_b128 v[52:55], v0 offset:3072
    v_smfmac_f32_16x16x64_bf16 v[16:19], v[36:39], v[120:127], v1
    ds_read_b128 v[56:59], v9 offset:4096
    v_smfmac_f32_16x16x64_bf16 v[20:23], v[36:39], v[128:135], v1
    ds_read_b128 v[60:63], v9 offset:5120
    s_waitcnt lgkmcnt(3)
    v_smfmac_f32_16x16x64_bf16 v[24:27], v[36:39], v[64:71], v1
    v_smfmac_f32_16x16x64_bf16 v[12:15], v[40:43], v[152:159], v1
    buffer_load_dwordx4 v[36:39], v0, s[8:11], s42 offen
    v_smfmac_f32_16x16x64_bf16 v[16:19], v[40:43], v[160:167], v1
    ds_read_b128 v[64:67], v9 offset:6144
    v_smfmac_f32_16x16x64_bf16 v[20:23], v[40:43], v[168:175], v1
    ds_read_b128 v[68:71], v9 offset:7168
    s_waitcnt lgkmcnt(2)
    v_smfmac_f32_16x16x64_bf16 v[24:27], v[40:43], v[56:63], v1
    s_waitcnt vmcnt(1)
    ds_read_b128 v[44:47], v0 offset:6144
    v_smfmac_f32_16x16x64_bf16 v[12:15], v[52:55], v[192:199], v1
    buffer_load_dwordx4 v[40:43], v0, s[8:11], s42 offen offset:1024
    v_smfmac_f32_16x16x64_bf16 v[16:19], v[52:55], v[200:207], v1
    ds_read_b128 v[56:59], v9 offset:12288
    v_smfmac_f32_16x16x64_bf16 v[20:23], v[52:55], v[208:215], v1
    ds_read_b128 v[60:63], v9 offset:13312
    s_waitcnt lgkmcnt(3)
    v_smfmac_f32_16x16x64_bf16 v[24:27], v[52:55], v[64:71], v1
    ds_read_b128 v[48:51], v0 offset:7168
    s_waitcnt lgkmcnt(3)
    v_smfmac_f32_16x16x64_bf16 v[12:15], v[44:47], a[56:63], v1
    ds_read_b128 v[52:55], v0 offset:8192
    v_smfmac_f32_16x16x64_bf16 v[16:19], v[44:47], a[64:71], v1
    ds_read_b128 v[64:67], v9 offset:14336
    v_smfmac_f32_16x16x64_bf16 v[20:23], v[44:47], a[72:79], v1
    ds_read_b128 v[68:71], v9 offset:15360
    s_waitcnt lgkmcnt(4)
    v_smfmac_f32_16x16x64_bf16 v[24:27], v[44:47], v[56:63], v1
    s_waitcnt lgkmcnt(3)
    v_smfmac_f32_16x16x64_bf16 v[12:15], v[48:51], a[96:103], v1
    v_smfmac_f32_16x16x64_bf16 v[16:19], v[48:51], a[104:111], v1
    ds_read_b128 v[56:59], v9 offset:16384
    s_waitcnt lgkmcnt(3)
    v_smfmac_f32_16x16x64_bf16 v[12:15], v[52:55], a[136:143], v1
    ds_read_b128 v[60:63], v9 offset:17408
    v_smfmac_f32_16x16x64_bf16 v[16:19], v[52:55], a[144:151], v1
    v_smfmac_f32_16x16x64_bf16 v[20:23], v[48:51], a[112:119], v1
    s_waitcnt lgkmcnt(2)
    v_smfmac_f32_16x16x64_bf16 v[24:27], v[48:51], v[64:71], v1
    ds_read_b128 v[64:67], v0 offset:9216
    s_nop 1
    v_add_f32 v12, v12, v14
    v_smfmac_f32_16x16x64_bf16 v[20:23], v[52:55], a[152:159], v1
    ds_read_b128 v[68:71], v0 offset:10240
    v_add_f32 v16, v16, v18
    s_waitcnt lgkmcnt(2)
    v_smfmac_f32_16x16x64_bf16 v[24:27], v[52:55], v[56:63], v1
    ds_read_b128 v[56:59], v0 offset:11264
    v_add_f32 v13, v13, v15
    v_add_f32 v17, v17, v19
    v_cvt_pk_bf16_f32 v14, v12, v16
    v_cvt_pk_bf16_f32 v15, v13, v17
    ds_write_b32 v2, v14 offset:17408
    ds_write_b32 v2, v15 offset:17696
    v_smfmac_f32_16x16x64_bf16 v[28:31], v[52:55], a[160:167], v1
    ds_read_b128 v[60:63], v0 offset:12288
    v_add_f32 v20, v20, v22
    v_add_f32 v24, v24, v26
    v_add_f32 v21, v21, v23
    v_add_f32 v25, v25, v27
    v_smfmac_f32_16x16x64_bf16 v[32:35], v[52:55], a[168:175], v1
    ds_read_b128 v[12:15], v0 offset:4096
    v_cvt_pk_bf16_f32 v22, v20, v24
    v_cvt_pk_bf16_f32 v23, v21, v25
    ds_write_b32 v2, v22 offset:19712
    ds_write_b32 v2, v23 offset:20000
    v_smfmac_f32_16x16x64_bf16 v[28:31], v[48:51], a[120:127], v1
    ds_read_b128 v[16:19], v0 offset:5120
    v_smfmac_f32_16x16x64_bf16 v[32:35], v[48:51], a[128:135], v1
    ds_read_b128 v[20:23], v0 offset:0
    v_smfmac_f32_16x16x64_bf16 v[28:31], v[44:47], a[80:87], v1
    ds_read_b128 v[24:27], v0 offset:1024
    v_smfmac_f32_16x16x64_bf16 v[32:35], v[44:47], a[88:95], v1
    s_waitcnt lgkmcnt(3)
    s_barrier
    ds_read_b128 v[44:47], v3 offset:17408
    v_smfmac_f32_16x16x64_bf16 v[28:31], v[12:15], a[0:7], v1
    ds_read_b128 v[52:55], v0 offset:2048
    v_smfmac_f32_16x16x64_bf16 v[32:35], v[12:15], a[8:15], v1
    ds_read_b128 v[12:15], v3 offset:19712
    s_waitcnt lgkmcnt(5)
    v_smfmac_f32_16x16x64_bf16 v[28:31], v[16:19], a[40:47], v1
    ds_read_b128 v[48:51], v0 offset:3072
    v_smfmac_f32_16x16x64_bf16 v[32:35], v[16:19], a[48:55], v1
    s_waitcnt lgkmcnt(5)
    v_smfmac_f32_16x16x64_bf16 v[28:31], v[20:23], v[96:103], v1
    v_smfmac_f32_16x16x64_bf16 v[32:35], v[20:23], v[104:111], v1
    ds_read_b128 v[20:23], v3 offset:17472
    s_waitcnt lgkmcnt(5)
    v_smfmac_f32_16x16x64_bf16 v[28:31], v[24:27], v[136:143], v1
    v_smfmac_f32_16x16x64_bf16 v[32:35], v[24:27], v[144:151], v1
    s_waitcnt lgkmcnt(3)
    v_smfmac_f32_16x16x64_bf16 v[28:31], v[52:55], v[176:183], v1
    v_smfmac_f32_16x16x64_bf16 v[32:35], v[52:55], v[184:191], v1
    ds_read_b128 v[52:55], v3 offset:19776
    s_waitcnt lgkmcnt(2)
    v_smfmac_f32_16x16x64_bf16 v[28:31], v[48:51], v[216:223], v1
    v_smfmac_f32_16x16x64_bf16 v[32:35], v[48:51], v[224:231], v1
    ds_read_b128 v[48:51], v3 offset:17536
    v_mfma_f32_16x16x32_bf16 v[24:27], v[12:15], v[44:47], 0
    v_mfma_f32_16x16x32_bf16 v[12:15], v[64:67], v[44:47], 0
    ds_read_b128 v[64:67], v0 offset:13312
    v_mfma_f32_16x16x32_bf16 v[16:19], v[68:71], v[44:47], 0
    ds_read_b128 v[68:71], v0 offset:14336
    s_waitcnt lgkmcnt(3)
    v_mfma_f32_16x16x32_bf16 v[24:27], v[52:55], v[20:23], v[24:27]
    ds_read_b128 v[44:47], v3 offset:19840
    v_add_f32 v28, v28, v30
    v_add_f32 v29, v29, v31
    v_mfma_f32_16x16x32_bf16 v[12:15], v[56:59], v[20:23], v[12:15]
    ds_read_b128 v[52:55], v3 offset:17600
    v_add_f32 v32, v32, v34
    v_add_f32 v33, v33, v35
    v_mfma_f32_16x16x32_bf16 v[16:19], v[60:63], v[20:23], v[16:19]
    ds_read_b128 v[56:59], v0 offset:15360
    v_cvt_pk_bf16_f32 v30, v28, v29
    v_cvt_pk_bf16_f32 v31, v32, v33
    s_waitcnt lgkmcnt(2)
    v_mfma_f32_16x16x32_bf16 v[24:27], v[44:47], v[48:51], v[24:27]
    ds_read_b128 v[20:23], v3 offset:19904
    v_lshrrev_b32 v10, 8, v0
    v_mul_u32_u24 v10, 288, v10
    v_mfma_f32_16x16x32_bf16 v[12:15], v[64:67], v[48:51], v[12:15]
    ds_read_b128 v[60:63], v0 offset:16384
    v_and_b32 v11, 0xf0, v0
    v_add_u32 v10, v10, v11
    v_mfma_f32_16x16x32_bf16 v[16:19], v[68:71], v[48:51], v[16:19]
    ds_read_b128 v[32:35], v10 offset:20864
    v_lshrrev_b32 v11, 1, v0
    v_bfi_b32 v30, 1, s66, v30
    s_waitcnt lgkmcnt(2)
    v_mfma_f32_16x16x32_bf16 v[24:27], v[20:23], v[52:55], v[24:27]
    buffer_store_dwordx2 v[30:31], v11, s[8:11], s43 offen offset:2048 sc1
    v_mov_b32 v49, 0
    v_mov_b32 v50, 0
    v_mfma_f32_16x16x32_bf16 v[12:15], v[56:59], v[52:55], v[12:15]
    v_mov_b64 v[64:65], s[68:69]
    v_mov_b64 v[66:67], s[68:69]
    s_waitcnt lgkmcnt(1)
    v_mfma_f32_16x16x32_bf16 v[16:19], v[60:63], v[52:55], v[16:19]
    s_waitcnt lgkmcnt(0)
    v_bfi_b32 v32, 1, s66, v32
    s_mov_b64 exec, s[52:53]
    buffer_store_dwordx4 v[32:35], v0, s[8:11], s43 offen sc1
    s_mov_b64 exec, -1
    v_max3_f32 v10, v24, v25, v12
    v_max3_f32 v10, v10, v13, v14
    s_nop 0
    v_max3_f32 v10, v10, v15, v16
    v_max3_f32 v10, v10, v17, v18
    v_max_f32 v10, v10, v19
    v_mov_b32 v11, v10
    s_nop 1
    v_permlane32_swap_b32 v10, v11
    v_max_f32 v10, v10, v11
    v_mov_b32 v11, v10
    s_nop 1
    v_permlane16_swap_b32 v10, v11
    v_max_f32 v10, v10, v11
    v_mul_f32 v20, s46, v10
    v_pk_fma_f32 v[24:25], v[24:25], s[46:47], v[20:21] op_sel_hi:[1,1,0] neg_lo:[0,0,1] neg_hi:[0,0,1]
    v_pk_fma_f32 v[12:13], v[12:13], s[46:47], v[20:21] op_sel_hi:[1,1,0] neg_lo:[0,0,1] neg_hi:[0,0,1]
    v_exp_f32 v24, v24
    v_exp_f32 v25, v25
    v_pk_fma_f32 v[14:15], v[14:15], s[46:47], v[20:21] op_sel_hi:[1,1,0] neg_lo:[0,0,1] neg_hi:[0,0,1]
    v_exp_f32 v12, v12
    v_exp_f32 v13, v13
    v_pk_fma_f32 v[16:17], v[16:17], s[46:47], v[20:21] op_sel_hi:[1,1,0] neg_lo:[0,0,1] neg_hi:[0,0,1]
    v_cvt_pk_bf16_f32 v48, v24, v25
    v_exp_f32 v14, v14
    v_pk_fma_f32 v[18:19], v[18:19], s[46:47], v[20:21] op_sel_hi:[1,1,0] neg_lo:[0,0,1] neg_hi:[0,0,1]
    v_cvt_pk_bf16_f32 v51, v24, v25
    v_exp_f32 v15, v15
    v_cvt_pk_bf16_f32 v44, v12, v13
    v_exp_f32 v16, v16
    v_exp_f32 v17, v17
    v_cvt_pk_bf16_f32 v45, v14, v15
    v_exp_f32 v18, v18
    v_exp_f32 v19, v19
    v_cvt_pk_bf16_f32 v46, v16, v17
    v_cvt_pk_bf16_f32 v47, v18, v19
    v_mfma_f32_16x16x16_bf16 v[68:71], v[64:65], v[48:49], 0
    v_mfma_f32_16x16x16_bf16 v[52:55], v[30:31], v[48:49], 0
    v_mfma_f32_16x16x16_bf16 v[56:59], v[30:31], v[50:51], 0
    v_mfma_f32_16x16x32_bf16 v[68:71], v[64:67], v[44:47], v[68:71]
    s_waitcnt vmcnt(3)
    v_mfma_f32_16x16x32_bf16 v[52:55], v[36:39], v[44:47], v[52:55]
    s_waitcnt vmcnt(2)
    v_mfma_f32_16x16x32_bf16 v[56:59], v[40:43], v[44:47], v[56:59]
    ds_read_b128 v[36:39], v0 offset:47104
    ds_read_b128 v[40:43], v0 offset:48128
    ds_read_b128 v[60:63], v9 offset:24576
    s_nop 0
    v_rcp_f32 v10, v68
    s_nop 0
    v_pk_mul_f32 v[52:53], v[52:53], v[10:11] op_sel_hi:[1,0]
    s_nop 0
    v_pk_mul_f32 v[56:57], v[56:57], v[10:11] op_sel_hi:[1,0]
    v_cvt_pk_bf16_f32 v16, v52, v56
    v_cvt_pk_bf16_f32 v17, v53, v57
    v_pk_mul_f32 v[54:55], v[54:55], v[10:11] op_sel_hi:[1,0]
    v_pk_mul_f32 v[58:59], v[58:59], v[10:11] op_sel_hi:[1,0]
    v_cvt_pk_bf16_f32 v18, v54, v58
    v_cvt_pk_bf16_f32 v19, v55, v59
    ds_write_b128 v3, v[16:19] offset:22144
    ds_read_b128 v[64:67], v9 offset:25600
    v_mov_b64 v[12:13], 0
    v_mov_b64 v[14:15], 0
    v_mov_b64 v[20:21], 0
    v_mov_b64 v[22:23], 0
    v_mov_b64 v[24:25], 0
    v_mov_b64 v[26:27], 0
    v_mov_b64 v[32:33], 0
    v_mov_b64 v[34:35], 0
    v_mov_b64 v[44:45], 0
    v_mov_b64 v[46:47], 0
    v_mov_b64 v[48:49], 0
    v_mov_b64 v[50:51], 0
    s_waitcnt lgkmcnt(1)
    s_barrier
    ds_read_b128 v[52:55], v4 offset:22016
    ds_read_b128 v[56:59], v4 offset:22144
    v_mov_b64 v[68:69], 0
    v_mov_b64 v[70:71], 0
    v_mov_b64 v[28:29], 0
    v_mov_b64 v[30:31], 0
    v_mov_b64 v[16:17], 0
    v_mov_b64 v[18:19], 0
    s_cmp_eq_u32 s33, 63
    s_cbranch_scc1 Lr2f_last
    s_waitcnt lgkmcnt(1)
    v_smfmac_f32_16x16x64_bf16 v[28:31], v[52:55], v[60:67], v1
    ds_read_b128 v[60:63], v0 offset:40960
    s_waitcnt lgkmcnt(1)
    v_smfmac_f32_16x16x64_bf16 v[28:31], v[56:59], v[36:43], v1
    ds_read_b128 v[64:67], v0 offset:41984
    ds_read_b128 v[36:39], v9 offset:18432
    v_smfmac_f32_16x16x64_bf16 v[12:15], v[52:55], a[176:183], v1
    ds_read_b128 v[40:43], v9 offset:19456
    v_smfmac_f32_16x16x64_bf16 v[12:15], v[56:59], a[184:191], v1
    buffer_load_dwordx4 v0, s[8:11], s41 offen offset:0 lds
    v_smfmac_f32_16x16x64_bf16 v[20:23], v[52:55], a[192:199], v1
    s_nop 0
    v_add_f32 v28, v28, v30
    v_add_f32 v29, v29, v31
    s_waitcnt lgkmcnt(2)
    v_smfmac_f32_16x16x64_bf16 v[20:23], v[56:59], v[60:67], v1
    ds_read_b128 v[60:63], v9 offset:20480
    v_cvt_pk_bf16_f32 v28, v28, v29
    v_bfi_b32 v28, 1, s39, v28
    buffer_store_dword v28, v8, s[8:11], s38 offen offset:2048
    s_waitcnt lgkmcnt(1)
    v_smfmac_f32_16x16x64_bf16 v[24:27], v[52:55], v[36:43], v1
    ds_read_b128 v[64:67], v9 offset:21504
    ds_read_b128 v[36:39], v0 offset:43008
    v_add_f32 v12, v12, v14
    v_add_f32 v13, v13, v15
    v_smfmac_f32_16x16x64_bf16 v[24:27], v[56:59], a[200:207], v1
    ds_read_b128 v[40:43], v0 offset:44032
    v_cvt_pk_bf16_f32 v12, v12, v13
    v_bfi_b32 v12, 1, s39, v12
    v_smfmac_f32_16x16x64_bf16 v[32:35], v[52:55], a[208:215], v1
    buffer_load_dwordx4 v0, s[8:11], s41 offen offset:1024 lds
    v_add_f32 v20, v20, v22
    v_add_f32 v21, v21, v23
    v_smfmac_f32_16x16x64_bf16 v[32:35], v[56:59], a[216:223], v1
    v_cvt_pk_bf16_f32 v13, v20, v21
    s_waitcnt lgkmcnt(2)
    v_smfmac_f32_16x16x64_bf16 v[44:47], v[52:55], v[60:67], v1
    ds_read_b128 v[60:63], v0 offset:45056
    v_add_f32 v24, v24, v26
    v_add_f32 v25, v25, v27
    s_waitcnt lgkmcnt(1)
    v_smfmac_f32_16x16x64_bf16 v[44:47], v[56:59], v[36:43], v1
    ds_read_b128 v[64:67], v0 offset:46080
    ds_read_b128 v[36:39], v9 offset:22528
    v_cvt_pk_bf16_f32 v14, v24, v25
    v_smfmac_f32_16x16x64_bf16 v[48:51], v[52:55], a[224:231], v1
    ds_read_b128 v[40:43], v9 offset:23552
    v_add_f32 v32, v32, v34
    v_add_f32 v33, v33, v35
    v_smfmac_f32_16x16x64_bf16 v[48:51], v[56:59], a[232:239], v1
    v_cvt_pk_bf16_f32 v15, v32, v33
    buffer_store_dwordx4 v[12:15], v0, s[8:11], s38 offen offset:0
    v_smfmac_f32_16x16x64_bf16 v[68:71], v[52:55], a[240:247], v1
    v_add_f32 v44, v44, v46
    v_add_f32 v45, v45, v47
    s_waitcnt lgkmcnt(2)
    v_smfmac_f32_16x16x64_bf16 v[68:71], v[56:59], v[60:67], v1
    v_cvt_pk_bf16_f32 v44, v44, v45
    v_bfi_b32 v44, 1, s39, v44
    s_waitcnt lgkmcnt(0)
    v_smfmac_f32_16x16x64_bf16 v[16:19], v[52:55], v[36:43], v1
    v_add_f32 v48, v48, v50
    v_add_f32 v49, v49, v51
    v_smfmac_f32_16x16x64_bf16 v[16:19], v[56:59], a[248:255], v1
    v_cvt_pk_bf16_f32 v45, v48, v49
    v_add_f32 v68, v68, v70
    v_add_f32 v69, v69, v71
    v_cvt_pk_bf16_f32 v46, v68, v69
    s_nop 3
    v_add_f32 v16, v16, v18
    v_add_f32 v17, v17, v19
    v_cvt_pk_bf16_f32 v47, v16, v17
    buffer_store_dwordx4 v[44:47], v0, s[8:11], s38 offen offset:1024
    s_cmp_eq_u32 s62, 0
    s_cbranch_scc1 Lr2f_nojob
    s_sleep 6
    buffer_load_dwordx4 v[52:55], v6, s[8:11], s57 offen sc1
    buffer_load_dwordx4 v[56:59], v6, s[8:11], s58 offen sc1
    buffer_load_dwordx4 v[60:63], v6, s[8:11], s59 offen sc1
    buffer_load_dwordx4 v[64:67], v6, s[8:11], s60 offen sc1
    v_bfe_u32 v10, v0, 4, 4
    v_mov_b32 v11, 0x3f80
    v_mov_b32 v40, 0x3f800000
    v_cmp_eq_u32 vcc, 0, v10
    v_cmp_eq_u32 s[48:49], 1, v10
    s_nop 0
    v_cndmask_b32 v36, 0, v11, vcc
    v_cndmask_b32 v36, v36, v40, s[48:49]
    v_cmp_eq_u32 vcc, 2, v10
    v_cmp_eq_u32 s[48:49], 3, v10
    s_nop 0
    v_cndmask_b32 v37, 0, v11, vcc
    v_cndmask_b32 v37, v37, v40, s[48:49]
    v_cmp_eq_u32 vcc, 4, v10
    v_cmp_eq_u32 s[48:49], 5, v10
    s_nop 0
    v_cndmask_b32 v38, 0, v11, vcc
    v_cndmask_b32 v38, v38, v40, s[48:49]
    v_cmp_eq_u32 vcc, 6, v10
    v_cmp_eq_u32 s[48:49], 7, v10
    s_nop 0
    v_cndmask_b32 v39, 0, v11, vcc
    v_cndmask_b32 v39, v39, v40, s[48:49]
    s_mov_b32 s16, 0
    s_mov_b64 s[70:71], 0
    s_mov_b64 s[72:73], 0
    s_mov_b64 s[74:75], 0
    s_mov_b64 s[76:77], 0
Lr2f_p1:
    s_mov_b64 exec, s[70:71]
    buffer_load_dwordx4 v[52:55], v6, s[8:11], s57 offen sc1
    s_mov_b64 exec, s[72:73]
    buffer_load_dwordx4 v[56:59], v6, s[8:11], s58 offen sc1
    s_mov_b64 exec, s[74:75]
    buffer_load_dwordx4 v[60:63], v6, s[8:11], s59 offen sc1
    s_mov_b64 exec, s[76:77]
    buffer_load_dwordx4 v[64:67], v6, s[8:11], s60 offen sc1
    s_mov_b64 exec, -1
    s_add_u32 s16, s16, 1
    s_cmp_gt_u32 s16, 100000
    s_cbranch_scc1 Lr_abort
    s_waitcnt vmcnt(7)
    v_xor_b32 v10, v52, v53
    v_xor_b32 v11, v54, v55
    v_or_b32 v10, v10, v11
    v_xor_b32 v11, v52, v54
    v_or_b32 v10, v10, v11
    v_xor_b32 v11, s39, v52
    v_or_b32 v10, v10, v11
    v_and_b32 v10, 1, v10
    v_cmp_ne_u32 s[70:71], 0, v10
    v_mfma_f32_16x16x32_bf16 v[40:43], v[52:55], v[36:39], 0
    s_waitcnt vmcnt(6)
    v_xor_b32 v10, v56, v57
    v_xor_b32 v11, v58, v59
    v_or_b32 v10, v10, v11
    v_xor_b32 v11, v56, v58
    v_or_b32 v10, v10, v11
    v_xor_b32 v11, s39, v56
    v_or_b32 v10, v10, v11
    v_and_b32 v10, 1, v10
    v_cmp_ne_u32 s[72:73], 0, v10
    v_mfma_f32_16x16x32_bf16 v[40:43], v[56:59], v[36:39], v[40:43]
    s_waitcnt vmcnt(5)
    v_xor_b32 v10, v60, v61
    v_xor_b32 v11, v62, v63
    v_or_b32 v10, v10, v11
    v_xor_b32 v11, v60, v62
    v_or_b32 v10, v10, v11
    v_xor_b32 v11, s39, v60
    v_or_b32 v10, v10, v11
    v_and_b32 v10, 1, v10
    v_cmp_ne_u32 s[74:75], 0, v10
    v_mfma_f32_16x16x32_bf16 v[40:43], v[60:63], v[36:39], v[40:43]
    s_or_b64 vcc, s[70:71], s[72:73]
    s_waitcnt vmcnt(4)
    v_xor_b32 v10, v64, v65
    v_xor_b32 v11, v66, v67
    v_or_b32 v10, v10, v11
    v_xor_b32 v11, v64, v66
    v_or_b32 v10, v10, v11
    v_xor_b32 v11, s39, v64
    v_or_b32 v10, v10, v11
    v_and_b32 v10, 1, v10
    v_cmp_ne_u32 s[76:77], 0, v10
    v_mfma_f32_16x16x32_bf16 v[40:43], v[64:67], v[36:39], v[40:43]
    s_or_b64 vcc, vcc, s[74:75]
    s_or_b64 vcc, vcc, s[76:77]
    s_cbranch_scc1 Lr2f_p1
    s_nop 4
    v_permlane16_swap_b32 v40, v42
    v_permlane16_swap_b32 v41, v43
    s_mov_b64 exec, s[50:51]
    v_add_f32 v40, v40, v42
    v_add_f32 v41, v41, v43
    v_cvt_pk_bf16_f32 v40, v40, v41
    v_min_u32 v40, s54, v40
    buffer_store_dword v40, v7, s[8:11], s36 offen
    v_mov_b32 v41, -1
    buffer_store_dword v41, v7, s[8:11], s37 offen
    s_mov_b64 exec, -1
    s_branch Lr2f_jobdone
Lr2f_nojob:
Lr2f_jobdone:
    s_xor_b32 s34, s34, 16384
    s_xor_b32 s35, s35, 16384
    s_barrier
    s_sleep 2
    buffer_load_dwordx4 v[44:47], v0, s[8:11], s34 offen sc1
    buffer_load_dwordx4 v[48:51], v0, s[8:11], s34 offen offset:1024 sc1
    buffer_load_dword v10, v8, s[8:11], s35 offen sc1
    s_add_u32 s33, s33, 1
    s_bfe_u32 s39, s33, 0x10001
    s_xor_b32 s38, s38, 524288
    s_xor_b32 s57, s57, 524288
    s_xor_b32 s58, s58, 524288
    s_xor_b32 s59, s59, 524288
    s_xor_b32 s60, s60, 524288
    s_xor_b32 s36, s36, 16384
    s_xor_b32 s37, s37, 16384
    s_and_b32 s17, s33, 7
    s_mul_i32 s17, s17, 131072
    s_add_u32 s43, s45, s17
    s_bfe_u32 s66, s33, 65539
    s_add_u32 s67, s67, 22528
    s_add_u32 s42, s42, 262144
    s_add_u32 s41, s41, 262144
    s_add_u32 s40, s40, 262144
    s_add_u32 s44, s44, 22528
    s_waitcnt vmcnt(6)
    ds_read_b128 v[56:59], v9 offset:8192
    ds_read_b128 v[60:63], v9 offset:9216
    ds_read_b128 v[64:67], v9 offset:10240
    ds_read_b128 v[68:71], v9 offset:11264
    v_mov_b64 v[12:13], 0
    v_mov_b64 v[14:15], 0
    v_mov_b64 v[16:17], 0
    v_mov_b64 v[18:19], 0
    v_mov_b64 v[20:21], 0
    v_mov_b64 v[22:23], 0
    v_mov_b64 v[24:25], 0
    v_mov_b64 v[26:27], 0
    v_mov_b64 v[28:29], 0
    v_mov_b64 v[30:31], 0
    v_mov_b64 v[32:33], 0
    v_mov_b64 v[34:35], 0
    s_waitcnt lgkmcnt(0)
    s_branch Lr2f_step
Lr2f_last:
    s_waitcnt vmcnt(0) lgkmcnt(0)
    s_branch Lr_exit
L_w3_1:
    s_mov_b32 s16, 0
    s_add_u32 s17, s44, 128
    v_and_b32 v11, 16, v8
    v_lshlrev_b32 v11, 3, v11
    v_and_or_b32 v11, v8, 12, v11
Lr3f_fw_10:
    buffer_load_dword v10, v11, s[8:11], s17 offen sc1
    s_add_u32 s16, s16, 1
    s_cmp_gt_u32 s16, 100000
    s_cbranch_scc1 Lr_abort
    s_waitcnt vmcnt(0)
    v_cmp_eq_u32 vcc, 0, v10
    s_nop 0
    s_cbranch_vccz Lr3f_fw_10d
    s_sleep 4
    s_branch Lr3f_fw_10
Lr3f_fw_10d:
    s_barrier
    s_mov_b32 m0, 15360
    s_nop 0
    buffer_load_dwordx4 v0, s[8:11], s41 offen offset:0 lds
    buffer_load_dwordx4 v0, s[8:11], s41 offen offset:1024 lds
    s_add_u32 s41, s41, 262144
    s_waitcnt vmcnt(0)
    buffer_load_dwordx4 v[44:47], v0, s[8:11], s34 offen sc1
    buffer_load_dwordx4 v[48:51], v0, s[8:11], s34 offen offset:1024 sc1
    buffer_load_dword v10, v8, s[8:11], s35 offen sc1
    ds_read_b128 v[56:59], v9 offset:12288
    ds_read_b128 v[60:63], v9 offset:13312
    ds_read_b128 v[64:67], v9 offset:14336
    ds_read_b128 v[68:71], v9 offset:15360
    v_mov_b64 v[12:13], 0
    v_mov_b64 v[14:15], 0
    v_mov_b64 v[16:17], 0
    v_mov_b64 v[18:19], 0
    v_mov_b64 v[20:21], 0
    v_mov_b64 v[22:23], 0
    v_mov_b64 v[24:25], 0
    v_mov_b64 v[26:27], 0
    v_mov_b64 v[28:29], 0
    v_mov_b64 v[30:31], 0
    v_mov_b64 v[32:33], 0
    v_mov_b64 v[34:35], 0
    s_waitcnt lgkmcnt(0)
Lr3f_step:
    s_mov_b32 s16, 0
    s_mov_b64 s[70:71], 0
    s_mov_b64 s[72:73], 0
    s_mov_b64 s[74:75], 0
Lr3f_p2:
    s_mov_b64 exec, s[70:71]
    buffer_load_dwordx4 v[44:47], v0, s[8:11], s34 offen sc1
    s_mov_b64 exec, s[72:73]
    buffer_load_dwordx4 v[48:51], v0, s[8:11], s34 offen offset:1024 sc1
    s_mov_b64 exec, s[74:75]
    buffer_load_dword v10, v8, s[8:11], s35 offen sc1
    s_mov_b64 exec, -1
    s_add_u32 s16, s16, 1
    s_cmp_gt_u32 s16, 100000
    s_cbranch_scc1 Lr_abort
    s_waitcnt vmcnt(5)
    v_max3_u32 v11, v44, v45, v46
    v_max_u32 v11, v11, v47
    v_cmp_eq_u32 s[70:71], -1, v11
    s_waitcnt vmcnt(4)
    v_max3_u32 v11, v48, v49, v50
    v_max_u32 v11, v11, v51
    v_cmp_eq_u32 s[72:73], -1, v11
    s_waitcnt vmcnt(3)
    v_cmp_eq_u32 s[74:75], -1, v10
    s_or_b64 vcc, s[70:71], s[72:73]
    s_or_b64 vcc, vcc, s[74:75]
    s_cbranch_scc1 Lr3f_p2
    v_smfmac_f32_16x16x64_bf16 v[12:15], v[44:47], a[56:63], v1
    ds_write_b128 v0, v[44:47] offset:6144
    v_smfmac_f32_16x16x64_bf16 v[16:19], v[44:47], a[64:71], v1
    ds_write_b128 v0, v[48:51] offset:7168
    v_smfmac_f32_16x16x64_bf16 v[20:23], v[44:47], a[72:79], v1
    ds_write_b32 v8, v10 offset:8960
    v_smfmac_f32_16x16x64_bf16 v[24:27], v[44:47], v[56:63], v1
    s_waitcnt lgkmcnt(0)
    s_barrier
    ds_read_b128 v[52:55], v0 offset:0
    v_smfmac_f32_16x16x64_bf16 v[12:15], v[48:51], a[96:103], v1
    ds_read_b128 v[36:39], v0 offset:1024
    v_smfmac_f32_16x16x64_bf16 v[16:19], v[48:51], a[104:111], v1
    ds_read_b128 v[56:59], v9 offset:0
    v_smfmac_f32_16x16x64_bf16 v[20:23], v[48:51], a[112:119], v1
    ds_read_b128 v[60:63], v9 offset:1024
    v_smfmac_f32_16x16x64_bf16 v[24:27], v[48:51], v[64:71], v1
    ds_read_b128 v[40:43], v0 offset:2048
    s_waitcnt lgkmcnt(4)
    v_smfmac_f32_16x16x64_bf16 v[12:15], v[52:55], v[72:79], v1
    buffer_load_dword v6, v7, s[8:11], s67 offen sc1
    v_smfmac_f32_16x16x64_bf16 v[16:19], v[52:55], v[80:87], v1
    ds_read_b128 v[64:67], v9 offset:2048
    v_smfmac_f32_16x16x64_bf16 v[20:23], v[52:55], v[88:95], v1
    ds_read_b128 v[68:71], v9 offset:3072
    s_waitcnt lgkmcnt(3)
    v_smfmac_f32_16x16x64_bf16 v[24:27], v[52:55], v[56:63], v1
    v_smfmac_f32_16x16x64_bf16 v[12:15], v[36:39], v[112:119], v1
    ds_read_b128 v[52:55], v0 offset:3072
    v_smfmac_f32_16x16x64_bf16 v[16:19], v[36:39], v[120:127], v1
    ds_read_b128 v[56:59], v9 offset:4096
    v_smfmac_f32_16x16x64_bf16 v[20:23], v[36:39], v[128:135], v1
    ds_read_b128 v[60:63], v9 offset:5120
    s_waitcnt lgkmcnt(3)
    v_smfmac_f32_16x16x64_bf16 v[24:27], v[36:39], v[64:71], v1
    v_smfmac_f32_16x16x64_bf16 v[12:15], v[40:43], v[152:159], v1
    buffer_load_dwordx4 v[36:39], v0, s[8:11], s42 offen
    v_smfmac_f32_16x16x64_bf16 v[16:19], v[40:43], v[160:167], v1
    ds_read_b128 v[64:67], v9 offset:6144
    v_smfmac_f32_16x16x64_bf16 v[20:23], v[40:43], v[168:175], v1
    ds_read_b128 v[68:71], v9 offset:7168
    s_waitcnt lgkmcnt(2)
    v_smfmac_f32_16x16x64_bf16 v[24:27], v[40:43], v[56:63], v1
    s_waitcnt vmcnt(2)
    ds_read_b128 v[44:47], v0 offset:4096
    v_smfmac_f32_16x16x64_bf16 v[12:15], v[52:55], v[192:199], v1
    buffer_load_dwordx4 v[40:43], v0, s[8:11], s42 offen offset:1024
    v_smfmac_f32_16x16x64_bf16 v[16:19], v[52:55], v[200:207], v1
    ds_read_b128 v[56:59], v9 offset:8192
    v_smfmac_f32_16x16x64_bf16 v[20:23], v[52:55], v[208:215], v1
    ds_read_b128 v[60:63], v9 offset:9216
    s_waitcnt lgkmcnt(3)
    v_smfmac_f32_16x16x64_bf16 v[24:27], v[52:55], v[64:71], v1
    ds_read_b128 v[48:51], v0 offset:5120
    s_waitcnt lgkmcnt(3)
    v_smfmac_f32_16x16x64_bf16 v[12:15], v[44:47], v[232:239], v1
    ds_read_b128 v[52:55], v0 offset:8192
    v_smfmac_f32_16x16x64_bf16 v[16:19], v[44:47], v[240:247], v1
    ds_read_b128 v[64:67], v9 offset:10240
    v_smfmac_f32_16x16x64_bf16 v[20:23], v[44:47], v[248:255], v1
    ds_read_b128 v[68:71], v9 offset:11264
    s_waitcnt lgkmcnt(4)
    v_smfmac_f32_16x16x64_bf16 v[24:27], v[44:47], v[56:63], v1
    s_waitcnt lgkmcnt(3)
    v_smfmac_f32_16x16x64_bf16 v[12:15], v[48:51], a[16:23], v1
    v_smfmac_f32_16x16x64_bf16 v[16:19], v[48:51], a[24:31], v1
    ds_read_b128 v[56:59], v9 offset:16384
    s_waitcnt lgkmcnt(3)
    v_smfmac_f32_16x16x64_bf16 v[12:15], v[52:55], a[136:143], v1
    ds_read_b128 v[60:63], v9 offset:17408
    v_smfmac_f32_16x16x64_bf16 v[16:19], v[52:55], a[144:151], v1
    v_smfmac_f32_16x16x64_bf16 v[20:23], v[48:51], a[32:39], v1
    s_waitcnt lgkmcnt(2)
    v_smfmac_f32_16x16x64_bf16 v[24:27], v[48:51], v[64:71], v1
    ds_read_b128 v[64:67], v0 offset:9216
    s_nop 1
    v_add_f32 v12, v12, v14
    v_smfmac_f32_16x16x64_bf16 v[20:23], v[52:55], a[152:159], v1
    ds_read_b128 v[68:71], v0 offset:10240
    v_add_f32 v16, v16, v18
    s_waitcnt lgkmcnt(2)
    v_smfmac_f32_16x16x64_bf16 v[24:27], v[52:55], v[56:63], v1
    ds_read_b128 v[56:59], v0 offset:11264
    v_add_f32 v13, v13, v15
    v_add_f32 v17, v17, v19
    v_cvt_pk_bf16_f32 v14, v12, v16
    v_cvt_pk_bf16_f32 v15, v13, v17
    ds_write_b32 v2, v14 offset:17408
    ds_write_b32 v2, v15 offset:17696
    v_smfmac_f32_16x16x64_bf16 v[28:31], v[52:55], a[160:167], v1
    ds_read_b128 v[60:63], v0 offset:12288
    v_add_f32 v20, v20, v22
    v_add_f32 v24, v24, v26
    v_add_f32 v21, v21, v23
    v_add_f32 v25, v25, v27
    v_smfmac_f32_16x16x64_bf16 v[32:35], v[52:55], a[168:175], v1
    ds_read_b128 v[12:15], v0 offset:6144
    v_cvt_pk_bf16_f32 v22, v20, v24
    v_cvt_pk_bf16_f32 v23, v21, v25
    ds_write_b32 v2, v22 offset:19712
    ds_write_b32 v2, v23 offset:20000
    v_smfmac_f32_16x16x64_bf16 v[28:31], v[48:51], a[40:47], v1
    ds_read_b128 v[16:19], v0 offset:7168
    v_smfmac_f32_16x16x64_bf16 v[32:35], v[48:51], a[48:55], v1
    ds_read_b128 v[20:23], v0 offset:0
    v_smfmac_f32_16x16x64_bf16 v[28:31], v[44:47], a[0:7], v1
    ds_read_b128 v[24:27], v0 offset:1024
    v_smfmac_f32_16x16x64_bf16 v[32:35], v[44:47], a[8:15], v1
    s_waitcnt lgkmcnt(3)
    s_barrier
    ds_read_b128 v[44:47], v3 offset:17408
    v_smfmac_f32_16x16x64_bf16 v[28:31], v[12:15], a[80:87], v1
    ds_read_b128 v[52:55], v0 offset:2048
    v_smfmac_f32_16x16x64_bf16 v[32:35], v[12:15], a[88:95], v1
    ds_read_b128 v[12:15], v3 offset:19712
    s_waitcnt lgkmcnt(5)
    v_smfmac_f32_16x16x64_bf16 v[28:31], v[16:19], a[120:127], v1
    ds_read_b128 v[48:51], v0 offset:3072
    v_smfmac_f32_16x16x64_bf16 v[32:35], v[16:19], a[128:135], v1
    s_waitcnt lgkmcnt(5)
    v_smfmac_f32_16x16x64_bf16 v[28:31], v[20:23], v[96:103], v1
    v_smfmac_f32_16x16x64_bf16 v[32:35], v[20:23], v[104:111], v1
    ds_read_b128 v[20:23], v3 offset:17472
    s_waitcnt lgkmcnt(5)
    v_smfmac_f32_16x16x64_bf16 v[28:31], v[24:27], v[136:143], v1
    v_smfmac_f32_16x16x64_bf16 v[32:35], v[24:27], v[144:151], v1
    s_waitcnt lgkmcnt(3)
    v_smfmac_f32_16x16x64_bf16 v[28:31], v[52:55], v[176:183], v1
    v_smfmac_f32_16x16x64_bf16 v[32:35], v[52:55], v[184:191], v1
    ds_read_b128 v[52:55], v3 offset:19776
    s_waitcnt lgkmcnt(2)
    v_smfmac_f32_16x16x64_bf16 v[28:31], v[48:51], v[216:223], v1
    v_smfmac_f32_16x16x64_bf16 v[32:35], v[48:51], v[224:231], v1
    ds_read_b128 v[48:51], v3 offset:17536
    v_mfma_f32_16x16x32_bf16 v[24:27], v[12:15], v[44:47], 0
    s_waitcnt vmcnt(2)
    v_cmp_eq_u32 vcc, 0, v6
    s_nop 0
    s_and_b64 vcc, vcc, s[78:79]
    s_cbranch_scc1 Lr3f_flbad
Lr3f_flok:
    s_mov_b32 m0, 24320
    s_nop 0
    buffer_load_dword v5, s[8:11], s40 offen lds
    buffer_load_dword v5, s[8:11], s56 offen lds
    s_mov_b32 m0, 15360
    v_mfma_f32_16x16x32_bf16 v[12:15], v[64:67], v[44:47], 0
    ds_read_b128 v[64:67], v0 offset:13312
    v_mfma_f32_16x16x32_bf16 v[16:19], v[68:71], v[44:47], 0
    ds_read_b128 v[68:71], v0 offset:14336
    s_waitcnt lgkmcnt(3)
    v_mfma_f32_16x16x32_bf16 v[24:27], v[52:55], v[20:23], v[24:27]
    ds_read_b128 v[44:47], v3 offset:19840
    v_add_f32 v28, v28, v30
    v_add_f32 v29, v29, v31
    v_mfma_f32_16x16x32_bf16 v[12:15], v[56:59], v[20:23], v[12:15]
    ds_read_b128 v[52:55], v3 offset:17600
    v_add_f32 v32, v32, v34
    v_add_f32 v33, v33, v35
    v_mfma_f32_16x16x32_bf16 v[16:19], v[60:63], v[20:23], v[16:19]
    ds_read_b128 v[56:59], v0 offset:15360
    v_cvt_pk_bf16_f32 v30, v28, v29
    v_cvt_pk_bf16_f32 v31, v32, v33
    s_waitcnt lgkmcnt(2)
    v_mfma_f32_16x16x32_bf16 v[24:27], v[44:47], v[48:51], v[24:27]
    ds_read_b128 v[20:23], v3 offset:19904
    v_lshrrev_b32 v10, 8, v0
    v_mul_u32_u24 v10, 288, v10
    v_mfma_f32_16x16x32_bf16 v[12:15], v[64:67], v[48:51], v[12:15]
    ds_read_b128 v[60:63], v0 offset:16384
    v_and_b32 v11, 0xf0, v0
    v_add_u32 v10, v10, v11
    v_mfma_f32_16x16x32_bf16 v[16:19], v[68:71], v[48:51], v[16:19]
    ds_read_b128 v[32:35], v10 offset:21440
    v_lshrrev_b32 v11, 1, v0
    v_bfi_b32 v30, 1, s66, v30
    s_waitcnt lgkmcnt(2)
    v_mfma_f32_16x16x32_bf16 v[24:27], v[20:23], v[52:55], v[24:27]
    buffer_store_dwordx2 v[30:31], v11, s[8:11], s43 offen offset:2048 sc1
    v_mov_b32 v49, 0
    v_mov_b32 v50, 0
    v_mfma_f32_16x16x32_bf16 v[12:15], v[56:59], v[52:55], v[12:15]
    v_mov_b64 v[64:65], s[68:69]
    v_mov_b64 v[66:67], s[68:69]
    s_waitcnt lgkmcnt(1)
    v_mfma_f32_16x16x32_bf16 v[16:19], v[60:63], v[52:55], v[16:19]
    s_waitcnt lgkmcnt(0)
    v_bfi_b32 v32, 1, s66, v32
    s_mov_b64 exec, s[52:53]
    buffer_store_dwordx4 v[32:35], v0, s[8:11], s43 offen sc1
    s_mov_b64 exec, -1
    v_max3_f32 v10, v24, v25, v12
    v_max3_f32 v10, v10, v13, v14
    s_nop 0
    v_max3_f32 v10, v10, v15, v16
    v_max3_f32 v10, v10, v17, v18
    v_max_f32 v10, v10, v19
    v_mov_b32 v11, v10
    s_nop 1
    v_permlane32_swap_b32 v10, v11
    v_max_f32 v10, v10, v11
    v_mov_b32 v11, v10
    s_nop 1
    v_permlane16_swap_b32 v10, v11
    v_max_f32 v10, v10, v11
    v_mul_f32 v20, s46, v10
    v_pk_fma_f32 v[24:25], v[24:25], s[46:47], v[20:21] op_sel_hi:[1,1,0] neg_lo:[0,0,1] neg_hi:[0,0,1]
    v_pk_fma_f32 v[12:13], v[12:13], s[46:47], v[20:21] op_sel_hi:[1,1,0] neg_lo:[0,0,1] neg_hi:[0,0,1]
    v_exp_f32 v24, v24
    v_exp_f32 v25, v25
    v_pk_fma_f32 v[14:15], v[14:15], s[46:47], v[20:21] op_sel_hi:[1,1,0] neg_lo:[0,0,1] neg_hi:[0,0,1]
    v_exp_f32 v12, v12
    v_exp_f32 v13, v13
    v_pk_fma_f32 v[16:17], v[16:17], s[46:47], v[20:21] op_sel_hi:[1,1,0] neg_lo:[0,0,1] neg_hi:[0,0,1]
    v_cvt_pk_bf16_f32 v48, v24, v25
    v_exp_f32 v14, v14
    v_pk_fma_f32 v[18:19], v[18:19], s[46:47], v[20:21] op_sel_hi:[1,1,0] neg_lo:[0,0,1] neg_hi:[0,0,1]
    v_cvt_pk_bf16_f32 v51, v24, v25
    v_exp_f32 v15, v15
    v_cvt_pk_bf16_f32 v44, v12, v13
    v_exp_f32 v16, v16
    v_exp_f32 v17, v17
    v_cvt_pk_bf16_f32 v45, v14, v15
    v_exp_f32 v18, v18
    v_exp_f32 v19, v19
    v_cvt_pk_bf16_f32 v46, v16, v17
    v_cvt_pk_bf16_f32 v47, v18, v19
    v_mfma_f32_16x16x16_bf16 v[68:71], v[64:65], v[48:49], 0
    v_mfma_f32_16x16x16_bf16 v[52:55], v[30:31], v[48:49], 0
    v_mfma_f32_16x16x16_bf16 v[56:59], v[30:31], v[50:51], 0
    v_mfma_f32_16x16x32_bf16 v[68:71], v[64:67], v[44:47], v[68:71]
    s_waitcnt vmcnt(5)
    v_mfma_f32_16x16x32_bf16 v[52:55], v[36:39], v[44:47], v[52:55]
    s_waitcnt vmcnt(4)
    v_mfma_f32_16x16x32_bf16 v[56:59], v[40:43], v[44:47], v[56:59]
    ds_read_b128 v[36:39], v0 offset:55296
    ds_read_b128 v[40:43], v0 offset:56320
    ds_read_b128 v[60:63], v9 offset:24576
    s_nop 0
    v_rcp_f32 v10, v68
    s_nop 0
    v_pk_mul_f32 v[52:53], v[52:53], v[10:11] op_sel_hi:[1,0]
    s_nop 0
    v_pk_mul_f32 v[56:57], v[56:57], v[10:11] op_sel_hi:[1,0]
    v_cvt_pk_bf16_f32 v16, v52, v56
    v_cvt_pk_bf16_f32 v17, v53, v57
    v_pk_mul_f32 v[54:55], v[54:55], v[10:11] op_sel_hi:[1,0]
    v_pk_mul_f32 v[58:59], v[58:59], v[10:11] op_sel_hi:[1,0]
    v_cvt_pk_bf16_f32 v18, v54, v58
    v_cvt_pk_bf16_f32 v19, v55, v59
    ds_write_b128 v3, v[16:19] offset:22208
    ds_read_b128 v[64:67], v9 offset:25600
    v_mov_b64 v[12:13], 0
    v_mov_b64 v[14:15], 0
    v_mov_b64 v[20:21], 0
    v_mov_b64 v[22:23], 0
    v_mov_b64 v[24:25], 0
    v_mov_b64 v[26:27], 0
    v_mov_b64 v[32:33], 0
    v_mov_b64 v[34:35], 0
    v_mov_b64 v[44:45], 0
    v_mov_b64 v[46:47], 0
    v_mov_b64 v[48:49], 0
    v_mov_b64 v[50:51], 0
    s_waitcnt lgkmcnt(1)
    s_barrier
    ds_read_b128 v[52:55], v4 offset:22016
    ds_read_b128 v[56:59], v4 offset:22144
    v_mov_b64 v[68:69], 0
    v_mov_b64 v[70:71], 0
    v_mov_b64 v[28:29], 0
    v_mov_b64 v[30:31], 0
    v_mov_b64 v[16:17], 0
    v_mov_b64 v[18:19], 0
    s_cmp_eq_u32 s33, 63
    s_cbranch_scc1 Lr3f_last
    s_waitcnt lgkmcnt(1)
    v_smfmac_f32_16x16x64_bf16 v[28:31], v[52:55], v[60:67], v1
    ds_read_b128 v[60:63], v0 offset:49152
    s_waitcnt lgkmcnt(1)
    v_smfmac_f32_16x16x64_bf16 v[28:31], v[56:59], v[36:43], v1
    ds_read_b128 v[64:67], v0 offset:50176
    ds_read_b128 v[36:39], v9 offset:18432
    v_smfmac_f32_16x16x64_bf16 v[12:15], v[52:55], a[176:183], v1
    ds_read_b128 v[40:43], v9 offset:19456
    v_smfmac_f32_16x16x64_bf16 v[12:15], v[56:59], a[184:191], v1
    buffer_load_dwordx4 v0, s[8:11], s41 offen offset:0 lds
    v_smfmac_f32_16x16x64_bf16 v[20:23], v[52:55], a[192:199], v1
    s_nop 0
    v_add_f32 v28, v28, v30
    v_add_f32 v29, v29, v31
    s_waitcnt lgkmcnt(2)
    v_smfmac_f32_16x16x64_bf16 v[20:23], v[56:59], v[60:67], v1
    ds_read_b128 v[60:63], v9 offset:20480
    v_cvt_pk_bf16_f32 v28, v28, v29
    v_bfi_b32 v28, 1, s39, v28
    buffer_store_dword v28, v8, s[8:11], s38 offen offset:2048
    s_waitcnt lgkmcnt(1)
    v_smfmac_f32_16x16x64_bf16 v[24:27], v[52:55], v[36:43], v1
    ds_read_b128 v[64:67], v9 offset:21504
    ds_read_b128 v[36:39], v0 offset:51200
    v_add_f32 v12, v12, v14
    v_add_f32 v13, v13, v15
    v_smfmac_f32_16x16x64_bf16 v[24:27], v[56:59], a[200:207], v1
    ds_read_b128 v[40:43], v0 offset:52224
    v_cvt_pk_bf16_f32 v12, v12, v13
    v_bfi_b32 v12, 1, s39, v12
    v_smfmac_f32_16x16x64_bf16 v[32:35], v[52:55], a[208:215], v1
    buffer_load_dwordx4 v0, s[8:11], s41 offen offset:1024 lds
    v_add_f32 v20, v20, v22
    v_add_f32 v21, v21, v23
    v_smfmac_f32_16x16x64_bf16 v[32:35], v[56:59], a[216:223], v1
    v_cvt_pk_bf16_f32 v13, v20, v21
    s_waitcnt lgkmcnt(2)
    v_smfmac_f32_16x16x64_bf16 v[44:47], v[52:55], v[60:67], v1
    ds_read_b128 v[60:63], v0 offset:53248
    v_add_f32 v24, v24, v26
    v_add_f32 v25, v25, v27
    s_waitcnt lgkmcnt(1)
    v_smfmac_f32_16x16x64_bf16 v[44:47], v[56:59], v[36:43], v1
    ds_read_b128 v[64:67], v0 offset:54272
    ds_read_b128 v[36:39], v9 offset:22528
    v_cvt_pk_bf16_f32 v14, v24, v25
    v_smfmac_f32_16x16x64_bf16 v[48:51], v[52:55], a[224:231], v1
    ds_read_b128 v[40:43], v9 offset:23552
    v_add_f32 v32, v32, v34
    v_add_f32 v33, v33, v35
    v_smfmac_f32_16x16x64_bf16 v[48:51], v[56:59], a[232:239], v1
    v_cvt_pk_bf16_f32 v15, v32, v33
    buffer_store_dwordx4 v[12:15], v0, s[8:11], s38 offen offset:0
    v_smfmac_f32_16x16x64_bf16 v[68:71], v[52:55], a[240:247], v1
    v_add_f32 v44, v44, v46
    v_add_f32 v45, v45, v47
    s_waitcnt lgkmcnt(2)
    v_smfmac_f32_16x16x64_bf16 v[68:71], v[56:59], v[60:67], v1
    v_cvt_pk_bf16_f32 v44, v44, v45
    v_bfi_b32 v44, 1, s39, v44
    s_waitcnt lgkmcnt(0)
    v_smfmac_f32_16x16x64_bf16 v[16:19], v[52:55], v[36:43], v1
    v_add_f32 v48, v48, v50
    v_add_f32 v49, v49, v51
    v_smfmac_f32_16x16x64_bf16 v[16:19], v[56:59], a[248:255], v1
    v_cvt_pk_bf16_f32 v45, v48, v49
    v_add_f32 v68, v68, v70
    v_add_f32 v69, v69, v71
    v_cvt_pk_bf16_f32 v46, v68, v69
    s_nop 3
    v_add_f32 v16, v16, v18
    v_add_f32 v17, v17, v19
    v_cvt_pk_bf16_f32 v47, v16, v17
    buffer_store_dwordx4 v[44:47], v0, s[8:11], s38 offen offset:1024
    s_xor_b32 s34, s34, 16384
    s_xor_b32 s35, s35, 16384
    s_barrier
    s_sleep 2
    buffer_load_dwordx4 v[44:47], v0, s[8:11], s34 offen sc1
    buffer_load_dwordx4 v[48:51], v0, s[8:11], s34 offen offset:1024 sc1
    buffer_load_dword v10, v8, s[8:11], s35 offen sc1
    s_add_u32 s33, s33, 1
    s_bfe_u32 s39, s33, 0x10001
    s_xor_b32 s38, s38, 524288
    s_and_b32 s17, s33, 7
    s_mul_i32 s17, s17, 131072
    s_add_u32 s43, s45, s17
    s_bfe_u32 s66, s33, 65539
    s_add_u32 s67, s67, 22528
    s_and_b32 s17, s33, 3
    s_cmp_eq_u32 s17, 3
    s_cselect_b32 s17, 1, 0
    s_cmp_eq_u32 s32, 0
    s_cselect_b32 s17, 1, s17
    s_cmp_ge_u32 s33, 7
    s_cselect_b32 s17, s17, 0
    s_cmp_lg_u32 s17, 0
    s_cselect_b64 s[78:79], -1, 0xff
    s_add_u32 s56, s56, 262144
    s_add_u32 s42, s42, 262144
    s_add_u32 s41, s41, 262144
    s_add_u32 s40, s40, 262144
    s_add_u32 s44, s44, 22528
    ds_read_b128 v[56:59], v9 offset:12288
    ds_read_b128 v[60:63], v9 offset:13312
    ds_read_b128 v[64:67], v9 offset:14336
    ds_read_b128 v[68:71], v9 offset:15360
    v_mov_b64 v[12:13], 0
    v_mov_b64 v[14:15], 0
    v_mov_b64 v[16:17], 0
    v_mov_b64 v[18:19], 0
    v_mov_b64 v[20:21], 0
    v_mov_b64 v[22:23], 0
    v_mov_b64 v[24:25], 0
    v_mov_b64 v[26:27], 0
    v_mov_b64 v[28:29], 0
    v_mov_b64 v[30:31], 0
    v_mov_b64 v[32:33], 0
    v_mov_b64 v[34:35], 0
    s_waitcnt lgkmcnt(0)
    s_branch Lr3f_step
Lr3f_flbad:
    s_cmp_eq_u32 s33, 63
    s_cbranch_scc1 Lr3f_flok
    s_mov_b32 s16, 0
Lr3f_flp:
    buffer_load_dword v6, v7, s[8:11], s67 offen sc1
    s_add_u32 s16, s16, 1
    s_cmp_gt_u32 s16, 100000
    s_cbranch_scc1 Lr_abort
    s_waitcnt vmcnt(0)
    v_cmp_eq_u32 vcc, 0, v6
    s_nop 0
    s_and_b64 vcc, vcc, s[78:79]
    s_cbranch_scc1 Lr3f_flp
    s_branch Lr3f_flok
Lr3f_last:
    s_waitcnt vmcnt(0) lgkmcnt(0)
    s_branch Lr_exit
L_slow:
    s_cmp_lg_u32 s14, 0
    s_cbranch_scc1 L_w1_0
    s_barrier
    s_mov_b32 m0, 9216
    s_nop 0
    buffer_load_dwordx4 v0, s[8:11], s41 offen offset:0 lds
    buffer_load_dwordx4 v0, s[8:11], s41 offen offset:1024 lds
    s_add_u32 s41, s41, 262144
    s_waitcnt vmcnt(0)
    buffer_load_dwordx4 v[44:47], v0, s[8:11], s34 offen sc1
    buffer_load_dwordx4 v[48:51], v0, s[8:11], s34 offen offset:1024 sc1
    buffer_load_dword v10, v8, s[8:11], s35 offen sc1
    ds_read_b128 v[56:59], v9 offset:0
    ds_read_b128 v[60:63], v9 offset:1024
    ds_read_b128 v[64:67], v9 offset:2048
    ds_read_b128 v[68:71], v9 offset:3072
    v_mov_b64 v[12:13], 0
    v_mov_b64 v[14:15], 0
    v_mov_b64 v[16:17], 0
    v_mov_b64 v[18:19], 0
    v_mov_b64 v[20:21], 0
    v_mov_b64 v[22:23], 0
    v_mov_b64 v[24:25], 0
    v_mov_b64 v[26:27], 0
    v_mov_b64 v[28:29], 0
    v_mov_b64 v[30:31], 0
    v_mov_b64 v[32:33], 0
    v_mov_b64 v[34:35], 0
    s_waitcnt lgkmcnt(0)
Lr0s_step:
    s_mov_b32 s16, 0
    s_mov_b64 s[70:71], 0
    s_mov_b64 s[72:73], 0
    s_mov_b64 s[74:75], 0
Lr0s_p2:
    s_mov_b64 exec, s[70:71]
    buffer_load_dwordx4 v[44:47], v0, s[8:11], s34 offen sc1
    s_mov_b64 exec, s[72:73]
    buffer_load_dwordx4 v[48:51], v0, s[8:11], s34 offen offset:1024 sc1
    s_mov_b64 exec, s[74:75]
    buffer_load_dword v10, v8, s[8:11], s35 offen sc1
    s_mov_b64 exec, -1
    s_add_u32 s16, s16, 1
    s_cmp_gt_u32 s16, 100000
    s_cbranch_scc1 Lr_abort
    s_waitcnt vmcnt(5)
    v_max3_u32 v11, v44, v45, v46
    v_max_u32 v11, v11, v47
    v_cmp_eq_u32 s[70:71], -1, v11
    s_waitcnt vmcnt(4)
    v_max3_u32 v11, v48, v49, v50
    v_max_u32 v11, v11, v51
    v_cmp_eq_u32 s[72:73], -1, v11
    s_waitcnt vmcnt(3)
    v_cmp_eq_u32 s[74:75], -1, v10
    s_or_b64 vcc, s[70:71], s[72:73]
    s_or_b64 vcc, vcc, s[74:75]
    s_cbranch_scc1 Lr0s_p2
    v_smfmac_f32_16x16x64_bf16 v[12:15], v[44:47], v[72:79], v1
    ds_write_b128 v0, v[44:47] offset:0
    v_smfmac_f32_16x16x64_bf16 v[16:19], v[44:47], v[80:87], v1
    ds_write_b128 v0, v[48:51] offset:1024
    v_smfmac_f32_16x16x64_bf16 v[20:23], v[44:47], v[88:95], v1
    ds_write_b32 v8, v10 offset:8192
    v_smfmac_f32_16x16x64_bf16 v[24:27], v[44:47], v[56:63], v1
    s_waitcnt lgkmcnt(0)
    s_barrier
    ds_read_b128 v[52:55], v0 offset:2048
    v_smfmac_f32_16x16x64_bf16 v[12:15], v[48:51], v[112:119], v1
    ds_read_b128 v[36:39], v0 offset:3072
    v_smfmac_f32_16x16x64_bf16 v[16:19], v[48:51], v[120:127], v1
    ds_read_b128 v[56:59], v9 offset:4096
    v_smfmac_f32_16x16x64_bf16 v[20:23], v[48:51], v[128:135], v1
    ds_read_b128 v[60:63], v9 offset:5120
    v_smfmac_f32_16x16x64_bf16 v[24:27], v[48:51], v[64:71], v1
    ds_read_b128 v[40:43], v0 offset:4096
    s_waitcnt lgkmcnt(4)
    v_smfmac_f32_16x16x64_bf16 v[12:15], v[52:55], v[152:159], v1
    v_smfmac_f32_16x16x64_bf16 v[16:19], v[52:55], v[160:167], v1
    ds_read_b128 v[64:67], v9 offset:6144
    v_smfmac_f32_16x16x64_bf16 v[20:23], v[52:55], v[168:175], v1
    ds_read_b128 v[68:71], v9 offset:7168
    s_waitcnt lgkmcnt(3)
    v_smfmac_f32_16x16x64_bf16 v[24:27], v[52:55], v[56:63], v1
    v_smfmac_f32_16x16x64_bf16 v[12:15], v[36:39], v[192:199], v1
    ds_read_b128 v[52:55], v0 offset:5120
    v_smfmac_f32_16x16x64_bf16 v[16:19], v[36:39], v[200:207], v1
    ds_read_b128 v[56:59], v9 offset:8192
    v_smfmac_f32_16x16x64_bf16 v[20:23], v[36:39], v[208:215], v1
    ds_read_b128 v[60:63], v9 offset:9216
    s_waitcnt lgkmcnt(3)
    v_smfmac_f32_16x16x64_bf16 v[24:27], v[36:39], v[64:71], v1
    v_smfmac_f32_16x16x64_bf16 v[12:15], v[40:43], v[232:239], v1
    buffer_load_dwordx4 v[36:39], v0, s[8:11], s42 offen
    v_smfmac_f32_16x16x64_bf16 v[16:19], v[40:43], v[240:247], v1
    ds_read_b128 v[64:67], v9 offset:10240
    v_smfmac_f32_16x16x64_bf16 v[20:23], v[40:43], v[248:255], v1
    ds_read_b128 v[68:71], v9 offset:11264
    s_waitcnt lgkmcnt(2)
    v_smfmac_f32_16x16x64_bf16 v[24:27], v[40:43], v[56:63], v1
    s_waitcnt vmcnt(1)
    ds_read_b128 v[44:47], v0 offset:6144
    v_smfmac_f32_16x16x64_bf16 v[12:15], v[52:55], a[16:23], v1
    buffer_load_dwordx4 v[40:43], v0, s[8:11], s42 offen offset:1024
    v_smfmac_f32_16x16x64_bf16 v[16:19], v[52:55], a[24:31], v1
    ds_read_b128 v[56:59], v9 offset:12288
    v_smfmac_f32_16x16x64_bf16 v[20:23], v[52:55], a[32:39], v1
    ds_read_b128 v[60:63], v9 offset:13312
    s_waitcnt lgkmcnt(3)
    v_smfmac_f32_16x16x64_bf16 v[24:27], v[52:55], v[64:71], v1
    ds_read_b128 v[48:51], v0 offset:7168
    s_waitcnt lgkmcnt(3)
    v_smfmac_f32_16x16x64_bf16 v[12:15], v[44:47], a[56:63], v1
    ds_read_b128 v[52:55], v0 offset:8192
    v_smfmac_f32_16x16x64_bf16 v[16:19], v[44:47], a[64:71], v1
    ds_read_b128 v[64:67], v9 offset:14336
    v_smfmac_f32_16x16x64_bf16 v[20:23], v[44:47], a[72:79], v1
    ds_read_b128 v[68:71], v9 offset:15360
    s_waitcnt lgkmcnt(4)
    v_smfmac_f32_16x16x64_bf16 v[24:27], v[44:47], v[56:63], v1
    s_waitcnt lgkmcnt(3)
    v_smfmac_f32_16x16x64_bf16 v[12:15], v[48:51], a[96:103], v1
    v_smfmac_f32_16x16x64_bf16 v[16:19], v[48:51], a[104:111], v1
    ds_read_b128 v[56:59], v9 offset:16384
    s_waitcnt lgkmcnt(3)
    v_smfmac_f32_16x16x64_bf16 v[12:15], v[52:55], a[136:143], v1
    ds_read_b128 v[60:63], v9 offset:17408
    v_smfmac_f32_16x16x64_bf16 v[16:19], v[52:55], a[144:151], v1
    v_smfmac_f32_16x16x64_bf16 v[20:23], v[48:51], a[112:119], v1
    s_waitcnt lgkmcnt(2)
    v_smfmac_f32_16x16x64_bf16 v[24:27], v[48:51], v[64:71], v1
    ds_read_b128 v[64:67], v0 offset:9216
    s_nop 1
    v_add_f32 v12, v12, v14
    v_smfmac_f32_16x16x64_bf16 v[20:23], v[52:55], a[152:159], v1
    ds_read_b128 v[68:71], v0 offset:10240
    v_add_f32 v16, v16, v18
    s_waitcnt lgkmcnt(2)
    v_smfmac_f32_16x16x64_bf16 v[24:27], v[52:55], v[56:63], v1
    ds_read_b128 v[56:59], v0 offset:11264
    v_add_f32 v13, v13, v15
    v_add_f32 v17, v17, v19
    v_cvt_pk_bf16_f32 v14, v12, v16
    v_cvt_pk_bf16_f32 v15, v13, v17
    ds_write_b32 v2, v14 offset:17408
    ds_write_b32 v2, v15 offset:17696
    v_smfmac_f32_16x16x64_bf16 v[28:31], v[52:55], a[160:167], v1
    ds_read_b128 v[60:63], v0 offset:12288
    v_add_f32 v20, v20, v22
    v_add_f32 v24, v24, v26
    v_add_f32 v21, v21, v23
    v_add_f32 v25, v25, v27
    v_smfmac_f32_16x16x64_bf16 v[32:35], v[52:55], a[168:175], v1
    ds_read_b128 v[12:15], v0 offset:0
    v_cvt_pk_bf16_f32 v22, v20, v24
    v_cvt_pk_bf16_f32 v23, v21, v25
    ds_write_b32 v2, v22 offset:19712
    ds_write_b32 v2, v23 offset:20000
    v_smfmac_f32_16x16x64_bf16 v[28:31], v[48:51], a[120:127], v1
    ds_read_b128 v[16:19], v0 offset:1024
    v_smfmac_f32_16x16x64_bf16 v[32:35], v[48:51], a[128:135], v1
    ds_read_b128 v[20:23], v0 offset:2048
    v_smfmac_f32_16x16x64_bf16 v[28:31], v[44:47], a[80:87], v1
    ds_read_b128 v[24:27], v0 offset:3072
    v_smfmac_f32_16x16x64_bf16 v[32:35], v[44:47], a[88:95], v1
    s_waitcnt lgkmcnt(3)
    s_barrier
    ds_read_b128 v[44:47], v3 offset:17408
    v_smfmac_f32_16x16x64_bf16 v[28:31], v[12:15], v[96:103], v1
    ds_read_b128 v[52:55], v0 offset:4096
    v_smfmac_f32_16x16x64_bf16 v[32:35], v[12:15], v[104:111], v1
    ds_read_b128 v[12:15], v3 offset:19712
    s_waitcnt lgkmcnt(5)
    v_smfmac_f32_16x16x64_bf16 v[28:31], v[16:19], v[136:143], v1
    ds_read_b128 v[48:51], v0 offset:5120
    v_smfmac_f32_16x16x64_bf16 v[32:35], v[16:19], v[144:151], v1
    s_waitcnt lgkmcnt(5)
    v_smfmac_f32_16x16x64_bf16 v[28:31], v[20:23], v[176:183], v1
    v_smfmac_f32_16x16x64_bf16 v[32:35], v[20:23], v[184:191], v1
    ds_read_b128 v[20:23], v3 offset:17472
    s_waitcnt lgkmcnt(5)
    v_smfmac_f32_16x16x64_bf16 v[28:31], v[24:27], v[216:223], v1
    v_smfmac_f32_16x16x64_bf16 v[32:35], v[24:27], v[224:231], v1
    s_waitcnt lgkmcnt(3)
    v_smfmac_f32_16x16x64_bf16 v[28:31], v[52:55], a[0:7], v1
    v_smfmac_f32_16x16x64_bf16 v[32:35], v[52:55], a[8:15], v1
    ds_read_b128 v[52:55], v3 offset:19776
    s_waitcnt lgkmcnt(2)
    v_smfmac_f32_16x16x64_bf16 v[28:31], v[48:51], a[40:47], v1
    v_smfmac_f32_16x16x64_bf16 v[32:35], v[48:51], a[48:55], v1
    ds_read_b128 v[48:51], v3 offset:17536
    v_mfma_f32_16x16x32_bf16 v[24:27], v[12:15], v[44:47], 0
    v_mfma_f32_16x16x32_bf16 v[12:15], v[64:67], v[44:47], 0
    ds_read_b128 v[64:67], v0 offset:13312
    v_mfma_f32_16x16x32_bf16 v[16:19], v[68:71], v[44:47], 0
    ds_read_b128 v[68:71], v0 offset:14336
    s_waitcnt lgkmcnt(3)
    v_mfma_f32_16x16x32_bf16 v[24:27], v[52:55], v[20:23], v[24:27]
    ds_read_b128 v[44:47], v3 offset:19840
    v_add_f32 v28, v28, v30
    v_add_f32 v29, v29, v31
    v_mfma_f32_16x16x32_bf16 v[12:15], v[56:59], v[20:23], v[12:15]
    ds_read_b128 v[52:55], v3 offset:17600
    v_add_f32 v32, v32, v34
    v_add_f32 v33, v33, v35
    v_mfma_f32_16x16x32_bf16 v[16:19], v[60:63], v[20:23], v[16:19]
    ds_read_b128 v[56:59], v0 offset:15360
    v_cvt_pk_bf16_f32 v30, v28, v29
    v_cvt_pk_bf16_f32 v31, v32, v33
    s_waitcnt lgkmcnt(2)
    v_mfma_f32_16x16x32_bf16 v[24:27], v[44:47], v[48:51], v[24:27]
    ds_read_b128 v[20:23], v3 offset:19904
    v_lshrrev_b32 v10, 8, v0
    v_mul_u32_u24 v10, 288, v10
    v_mfma_f32_16x16x32_bf16 v[12:15], v[64:67], v[48:51], v[12:15]
    ds_read_b128 v[60:63], v0 offset:16384
    v_and_b32 v11, 0xf0, v0
    v_add_u32 v10, v10, v11
    v_mfma_f32_16x16x32_bf16 v[16:19], v[68:71], v[48:51], v[16:19]
    ds_read_b128 v[32:35], v10 offset:19712
    v_lshrrev_b32 v11, 1, v0
    v_bfi_b32 v30, 1, s66, v30
    s_waitcnt lgkmcnt(2)
    v_mfma_f32_16x16x32_bf16 v[24:27], v[20:23], v[52:55], v[24:27]
    buffer_store_dwordx2 v[30:31], v11, s[8:11], s43 offen offset:2048 sc1
    v_mov_b32 v49, 0
    v_mov_b32 v50, 0
    v_mfma_f32_16x16x32_bf16 v[12:15], v[56:59], v[52:55], v[12:15]
    v_mov_b64 v[64:65], s[68:69]
    v_mov_b64 v[66:67], s[68:69]
    s_waitcnt lgkmcnt(1)
    v_mfma_f32_16x16x32_bf16 v[16:19], v[60:63], v[52:55], v[16:19]
    s_waitcnt lgkmcnt(0)
    v_bfi_b32 v32, 1, s66, v32
    s_mov_b64 exec, s[52:53]
    buffer_store_dwordx4 v[32:35], v0, s[8:11], s43 offen sc1
    s_mov_b64 exec, -1
    v_max3_f32 v10, v24, v25, v12
    v_max3_f32 v10, v10, v13, v14
    s_nop 0
    v_max3_f32 v10, v10, v15, v16
    v_max3_f32 v10, v10, v17, v18
    v_max_f32 v10, v10, v19
    v_mov_b32 v11, v10
    s_nop 1
    v_permlane32_swap_b32 v10, v11
    v_max_f32 v10, v10, v11
    v_mov_b32 v11, v10
    s_nop 1
    v_permlane16_swap_b32 v10, v11
    v_max_f32 v10, v10, v11
    v_mul_f32 v20, s46, v10
    v_pk_fma_f32 v[24:25], v[24:25], s[46:47], v[20:21] op_sel_hi:[1,1,0] neg_lo:[0,0,1] neg_hi:[0,0,1]
    v_pk_fma_f32 v[12:13], v[12:13], s[46:47], v[20:21] op_sel_hi:[1,1,0] neg_lo:[0,0,1] neg_hi:[0,0,1]
    v_exp_f32 v24, v24
    v_exp_f32 v25, v25
    v_pk_fma_f32 v[14:15], v[14:15], s[46:47], v[20:21] op_sel_hi:[1,1,0] neg_lo:[0,0,1] neg_hi:[0,0,1]
    v_exp_f32 v12, v12
    v_exp_f32 v13, v13
    v_pk_fma_f32 v[16:17], v[16:17], s[46:47], v[20:21] op_sel_hi:[1,1,0] neg_lo:[0,0,1] neg_hi:[0,0,1]
    v_cvt_pk_bf16_f32 v48, v24, v25
    v_exp_f32 v14, v14
    v_pk_fma_f32 v[18:19], v[18:19], s[46:47], v[20:21] op_sel_hi:[1,1,0] neg_lo:[0,0,1] neg_hi:[0,0,1]
    v_cvt_pk_bf16_f32 v51, v24, v25
    v_exp_f32 v15, v15
    v_cvt_pk_bf16_f32 v44, v12, v13
    v_exp_f32 v16, v16
    v_exp_f32 v17, v17
    v_cvt_pk_bf16_f32 v45, v14, v15
    v_exp_f32 v18, v18
    v_exp_f32 v19, v19
    v_cvt_pk_bf16_f32 v46, v16, v17
    v_cvt_pk_bf16_f32 v47, v18, v19
    v_mfma_f32_16x16x16_bf16 v[68:71], v[64:65], v[48:49], 0
    v_mfma_f32_16x16x16_bf16 v[52:55], v[30:31], v[48:49], 0
    v_mfma_f32_16x16x16_bf16 v[56:59], v[30:31], v[50:51], 0
    v_mfma_f32_16x16x32_bf16 v[68:71], v[64:67], v[44:47], v[68:71]
    s_waitcnt vmcnt(3)
    v_mfma_f32_16x16x32_bf16 v[52:55], v[36:39], v[44:47], v[52:55]
    s_waitcnt vmcnt(2)
    v_mfma_f32_16x16x32_bf16 v[56:59], v[40:43], v[44:47], v[56:59]
    ds_read_b128 v[36:39], v0 offset:30720
    ds_read_b128 v[40:43], v0 offset:31744
    ds_read_b128 v[60:63], v9 offset:24576
    s_nop 0
    v_rcp_f32 v10, v68
    s_nop 0
    v_pk_mul_f32 v[52:53], v[52:53], v[10:11] op_sel_hi:[1,0]
    s_nop 0
    v_pk_mul_f32 v[56:57], v[56:57], v[10:11] op_sel_hi:[1,0]
    v_cvt_pk_bf16_f32 v16, v52, v56
    v_cvt_pk_bf16_f32 v17, v53, v57
    v_pk_mul_f32 v[54:55], v[54:55], v[10:11] op_sel_hi:[1,0]
    v_pk_mul_f32 v[58:59], v[58:59], v[10:11] op_sel_hi:[1,0]
    v_cvt_pk_bf16_f32 v18, v54, v58
    v_cvt_pk_bf16_f32 v19, v55, v59
    ds_write_b128 v3, v[16:19] offset:22016
    ds_read_b128 v[64:67], v9 offset:25600
    v_mov_b64 v[12:13], 0
    v_mov_b64 v[14:15], 0
    v_mov_b64 v[20:21], 0
    v_mov_b64 v[22:23], 0
    v_mov_b64 v[24:25], 0
    v_mov_b64 v[26:27], 0
    v_mov_b64 v[32:33], 0
    v_mov_b64 v[34:35], 0
    v_mov_b64 v[44:45], 0
    v_mov_b64 v[46:47], 0
    v_mov_b64 v[48:49], 0
    v_mov_b64 v[50:51], 0
    s_waitcnt lgkmcnt(1)
    s_barrier
    ds_read_b128 v[52:55], v4 offset:22016
    ds_read_b128 v[56:59], v4 offset:22144
    v_mov_b64 v[68:69], 0
    v_mov_b64 v[70:71], 0
    v_mov_b64 v[28:29], 0
    v_mov_b64 v[30:31], 0
    v_mov_b64 v[16:17], 0
    v_mov_b64 v[18:19], 0
    s_cmp_eq_u32 s33, 63
    s_cbranch_scc1 Lr0s_last
    s_waitcnt lgkmcnt(1)
    v_smfmac_f32_16x16x64_bf16 v[28:31], v[52:55], v[60:67], v1
    ds_read_b128 v[60:63], v0 offset:24576
    s_waitcnt lgkmcnt(1)
    v_smfmac_f32_16x16x64_bf16 v[28:31], v[56:59], v[36:43], v1
    ds_read_b128 v[64:67], v0 offset:25600
    ds_read_b128 v[36:39], v9 offset:18432
    v_smfmac_f32_16x16x64_bf16 v[12:15], v[52:55], a[176:183], v1
    ds_read_b128 v[40:43], v9 offset:19456
    v_smfmac_f32_16x16x64_bf16 v[12:15], v[56:59], a[184:191], v1
    buffer_load_dwordx4 v0, s[8:11], s41 offen offset:0 lds
    v_smfmac_f32_16x16x64_bf16 v[20:23], v[52:55], a[192:199], v1
    s_nop 0
    v_add_f32 v28, v28, v30
    v_add_f32 v29, v29, v31
    s_waitcnt lgkmcnt(2)
    v_smfmac_f32_16x16x64_bf16 v[20:23], v[56:59], v[60:67], v1
    ds_read_b128 v[60:63], v9 offset:20480
    v_cvt_pk_bf16_f32 v28, v28, v29
    v_bfi_b32 v28, 1, s39, v28
    buffer_store_dword v28, v8, s[8:11], s38 offen offset:2048 sc1
    s_waitcnt lgkmcnt(1)
    v_smfmac_f32_16x16x64_bf16 v[24:27], v[52:55], v[36:43], v1
    ds_read_b128 v[64:67], v9 offset:21504
    ds_read_b128 v[36:39], v0 offset:26624
    v_add_f32 v12, v12, v14
    v_add_f32 v13, v13, v15
    v_smfmac_f32_16x16x64_bf16 v[24:27], v[56:59], a[200:207], v1
    ds_read_b128 v[40:43], v0 offset:27648
    v_cvt_pk_bf16_f32 v12, v12, v13
    v_bfi_b32 v12, 1, s39, v12
    v_smfmac_f32_16x16x64_bf16 v[32:35], v[52:55], a[208:215], v1
    buffer_load_dwordx4 v0, s[8:11], s41 offen offset:1024 lds
    v_add_f32 v20, v20, v22
    v_add_f32 v21, v21, v23
    v_smfmac_f32_16x16x64_bf16 v[32:35], v[56:59], a[216:223], v1
    v_cvt_pk_bf16_f32 v13, v20, v21
    s_waitcnt lgkmcnt(2)
    v_smfmac_f32_16x16x64_bf16 v[44:47], v[52:55], v[60:67], v1
    ds_read_b128 v[60:63], v0 offset:28672
    v_add_f32 v24, v24, v26
    v_add_f32 v25, v25, v27
    s_waitcnt lgkmcnt(1)
    v_smfmac_f32_16x16x64_bf16 v[44:47], v[56:59], v[36:43], v1
    ds_read_b128 v[64:67], v0 offset:29696
    ds_read_b128 v[36:39], v9 offset:22528
    v_cvt_pk_bf16_f32 v14, v24, v25
    v_smfmac_f32_16x16x64_bf16 v[48:51], v[52:55], a[224:231], v1
    ds_read_b128 v[40:43], v9 offset:23552
    v_add_f32 v32, v32, v34
    v_add_f32 v33, v33, v35
    v_smfmac_f32_16x16x64_bf16 v[48:51], v[56:59], a[232:239], v1
    v_cvt_pk_bf16_f32 v15, v32, v33
    buffer_store_dwordx4 v[12:15], v0, s[8:11], s38 offen offset:0 sc1
    v_smfmac_f32_16x16x64_bf16 v[68:71], v[52:55], a[240:247], v1
    v_add_f32 v44, v44, v46
    v_add_f32 v45, v45, v47
    s_waitcnt lgkmcnt(2)
    v_smfmac_f32_16x16x64_bf16 v[68:71], v[56:59], v[60:67], v1
    v_cvt_pk_bf16_f32 v44, v44, v45
    v_bfi_b32 v44, 1, s39, v44
    s_waitcnt lgkmcnt(0)
    v_smfmac_f32_16x16x64_bf16 v[16:19], v[52:55], v[36:43], v1
    v_add_f32 v48, v48, v50
    v_add_f32 v49, v49, v51
    v_smfmac_f32_16x16x64_bf16 v[16:19], v[56:59], a[248:255], v1
    v_cvt_pk_bf16_f32 v45, v48, v49
    v_add_f32 v68, v68, v70
    v_add_f32 v69, v69, v71
    v_cvt_pk_bf16_f32 v46, v68, v69
    s_nop 3
    v_add_f32 v16, v16, v18
    v_add_f32 v17, v17, v19
    v_cvt_pk_bf16_f32 v47, v16, v17
    buffer_store_dwordx4 v[44:47], v0, s[8:11], s38 offen offset:1024 sc1
    s_sleep 6
    buffer_load_dwordx4 v[52:55], v6, s[8:11], s57 offen sc1
    buffer_load_dwordx4 v[56:59], v6, s[8:11], s58 offen sc1
    buffer_load_dwordx4 v[60:63], v6, s[8:11], s59 offen sc1
    buffer_load_dwordx4 v[64:67], v6, s[8:11], s60 offen sc1
    v_bfe_u32 v10, v0, 4, 4
    v_mov_b32 v11, 0x3f80
    v_mov_b32 v40, 0x3f800000
    v_cmp_eq_u32 vcc, 0, v10
    v_cmp_eq_u32 s[48:49], 1, v10
    s_nop 0
    v_cndmask_b32 v36, 0, v11, vcc
    v_cndmask_b32 v36, v36, v40, s[48:49]
    v_cmp_eq_u32 vcc, 2, v10
    v_cmp_eq_u32 s[48:49], 3, v10
    s_nop 0
    v_cndmask_b32 v37, 0, v11, vcc
    v_cndmask_b32 v37, v37, v40, s[48:49]
    v_cmp_eq_u32 vcc, 4, v10
    v_cmp_eq_u32 s[48:49], 5, v10
    s_nop 0
    v_cndmask_b32 v38, 0, v11, vcc
    v_cndmask_b32 v38, v38, v40, s[48:49]
    v_cmp_eq_u32 vcc, 6, v10
    v_cmp_eq_u32 s[48:49], 7, v10
    s_nop 0
    v_cndmask_b32 v39, 0, v11, vcc
    v_cndmask_b32 v39, v39, v40, s[48:49]
    s_mov_b32 s16, 0
    s_mov_b64 s[70:71], 0
    s_mov_b64 s[72:73], 0
    s_mov_b64 s[74:75], 0
    s_mov_b64 s[76:77], 0
Lr0s_p1:
    s_mov_b64 exec, s[70:71]
    buffer_load_dwordx4 v[52:55], v6, s[8:11], s57 offen sc1
    s_mov_b64 exec, s[72:73]
    buffer_load_dwordx4 v[56:59], v6, s[8:11], s58 offen sc1
    s_mov_b64 exec, s[74:75]
    buffer_load_dwordx4 v[60:63], v6, s[8:11], s59 offen sc1
    s_mov_b64 exec, s[76:77]
    buffer_load_dwordx4 v[64:67], v6, s[8:11], s60 offen sc1
    s_mov_b64 exec, -1
    s_add_u32 s16, s16, 1
    s_cmp_gt_u32 s16, 100000
    s_cbranch_scc1 Lr_abort
    s_waitcnt vmcnt(7)
    v_and_b32 v11, 1, v52
    v_cmp_ne_u32 s[70:71], s39, v11
    v_mfma_f32_16x16x32_bf16 v[40:43], v[52:55], v[36:39], 0
    s_waitcnt vmcnt(6)
    v_and_b32 v11, 1, v56
    v_cmp_ne_u32 s[72:73], s39, v11
    v_mfma_f32_16x16x32_bf16 v[40:43], v[56:59], v[36:39], v[40:43]
    s_waitcnt vmcnt(5)
    v_and_b32 v11, 1, v60
    v_cmp_ne_u32 s[74:75], s39, v11
    v_mfma_f32_16x16x32_bf16 v[40:43], v[60:63], v[36:39], v[40:43]
    s_or_b64 vcc, s[70:71], s[72:73]
    s_waitcnt vmcnt(4)
    v_and_b32 v11, 1, v64
    v_cmp_ne_u32 s[76:77], s39, v11
    v_mfma_f32_16x16x32_bf16 v[40:43], v[64:67], v[36:39], v[40:43]
    s_or_b64 vcc, vcc, s[74:75]
    s_or_b64 vcc, vcc, s[76:77]
    s_cbranch_scc1 Lr0s_p1
    s_nop 4
    v_permlane16_swap_b32 v40, v42
    v_permlane16_swap_b32 v41, v43
    s_mov_b64 exec, s[50:51]
    v_add_f32 v40, v40, v42
    v_add_f32 v41, v41, v43
    v_cvt_pk_bf16_f32 v40, v40, v41
    v_min_u32 v40, s54, v40
    buffer_store_dword v40, v7, s[8:11], s36 offen sc1
    v_mov_b32 v41, -1
    buffer_store_dword v41, v7, s[8:11], s37 offen sc1
    s_mov_b64 exec, -1
    s_xor_b32 s34, s34, 16384
    s_xor_b32 s35, s35, 16384
    s_barrier
    s_sleep 2
    buffer_load_dwordx4 v[44:47], v0, s[8:11], s34 offen sc1
    buffer_load_dwordx4 v[48:51], v0, s[8:11], s34 offen offset:1024 sc1
    buffer_load_dword v10, v8, s[8:11], s35 offen sc1
    s_add_u32 s33, s33, 1
    s_bfe_u32 s39, s33, 0x10001
    s_xor_b32 s38, s38, 524288
    s_xor_b32 s57, s57, 524288
    s_xor_b32 s58, s58, 524288
    s_xor_b32 s59, s59, 524288
    s_xor_b32 s60, s60, 524288
    s_xor_b32 s36, s36, 16384
    s_xor_b32 s37, s37, 16384
    s_and_b32 s17, s33, 7
    s_mul_i32 s17, s17, 131072
    s_add_u32 s43, s45, s17
    s_bfe_u32 s66, s33, 65539
    s_add_u32 s67, s67, 22528
    s_add_u32 s42, s42, 262144
    s_add_u32 s41, s41, 262144
    s_add_u32 s40, s40, 262144
    s_add_u32 s44, s44, 22528
    s_waitcnt vmcnt(5)
    ds_read_b128 v[56:59], v9 offset:0
    ds_read_b128 v[60:63], v9 offset:1024
    ds_read_b128 v[64:67], v9 offset:2048
    ds_read_b128 v[68:71], v9 offset:3072
    v_mov_b64 v[12:13], 0
    v_mov_b64 v[14:15], 0
    v_mov_b64 v[16:17], 0
    v_mov_b64 v[18:19], 0
    v_mov_b64 v[20:21], 0
    v_mov_b64 v[22:23], 0
    v_mov_b64 v[24:25], 0
    v_mov_b64 v[26:27], 0
    v_mov_b64 v[28:29], 0
    v_mov_b64 v[30:31], 0
    v_mov_b64 v[32:33], 0
    v_mov_b64 v[34:35], 0
    s_waitcnt lgkmcnt(0)
    s_branch Lr0s_step
Lr0s_last:
    s_waitcnt vmcnt(0) lgkmcnt(0)
    s_branch Lr_exit
L_w1_0:
    s_cmp_lg_u32 s14, 1
    s_cbranch_scc1 L_w2_0
    s_barrier
    s_mov_b32 m0, 11264
    s_nop 0
    buffer_load_dwordx4 v0, s[8:11], s41 offen offset:0 lds
    buffer_load_dwordx4 v0, s[8:11], s41 offen offset:1024 lds
    s_add_u32 s41, s41, 262144
    s_waitcnt vmcnt(0)
    buffer_load_dwordx4 v[44:47], v0, s[8:11], s34 offen sc1
    buffer_load_dwordx4 v[48:51], v0, s[8:11], s34 offen offset:1024 sc1
    buffer_load_dword v10, v8, s[8:11], s35 offen sc1
    ds_read_b128 v[56:59], v9 offset:4096
    ds_read_b128 v[60:63], v9 offset:5120
    ds_read_b128 v[64:67], v9 offset:6144
    ds_read_b128 v[68:71], v9 offset:7168
    v_mov_b64 v[12:13], 0
    v_mov_b64 v[14:15], 0
    v_mov_b64 v[16:17], 0
    v_mov_b64 v[18:19], 0
    v_mov_b64 v[20:21], 0
    v_mov_b64 v[22:23], 0
    v_mov_b64 v[24:25], 0
    v_mov_b64 v[26:27], 0
    v_mov_b64 v[28:29], 0
    v_mov_b64 v[30:31], 0
    v_mov_b64 v[32:33], 0
    v_mov_b64 v[34:35], 0
    s_waitcnt lgkmcnt(0)
Lr1s_step:
    s_mov_b32 s16, 0
    s_mov_b64 s[70:71], 0
    s_mov_b64 s[72:73], 0
    s_mov_b64 s[74:75], 0
Lr1s_p2:
    s_mov_b64 exec, s[70:71]
    buffer_load_dwordx4 v[44:47], v0, s[8:11], s34 offen sc1
    s_mov_b64 exec, s[72:73]
    buffer_load_dwordx4 v[48:51], v0, s[8:11], s34 offen offset:1024 sc1
    s_mov_b64 exec, s[74:75]
    buffer_load_dword v10, v8, s[8:11], s35 offen sc1
    s_mov_b64 exec, -1
    s_add_u32 s16, s16, 1
    s_cmp_gt_u32 s16, 100000
    s_cbranch_scc1 Lr_abort
    s_waitcnt vmcnt(5)
    v_max3_u32 v11, v44, v45, v46
    v_max_u32 v11, v11, v47
    v_cmp_eq_u32 s[70:71], -1, v11
    s_waitcnt vmcnt(4)
    v_max3_u32 v11, v48, v49, v50
    v_max_u32 v11, v11, v51
    v_cmp_eq_u32 s[72:73], -1, v11
    s_waitcnt vmcnt(3)
    v_cmp_eq_u32 s[74:75], -1, v10
    s_or_b64 vcc, s[70:71], s[72:73]
    s_or_b64 vcc, vcc, s[74:75]
    s_cbranch_scc1 Lr1s_p2
    v_smfmac_f32_16x16x64_bf16 v[12:15], v[44:47], v[152:159], v1
    ds_write_b128 v0, v[44:47] offset:2048
    v_smfmac_f32_16x16x64_bf16 v[16:19], v[44:47], v[160:167], v1
    ds_write_b128 v0, v[48:51] offset:3072
    v_smfmac_f32_16x16x64_bf16 v[20:23], v[44:47], v[168:175], v1
    ds_write_b32 v8, v10 offset:8448
    v_smfmac_f32_16x16x64_bf16 v[24:27], v[44:47], v[56:63], v1
    s_waitcnt lgkmcnt(0)
    s_barrier
    ds_read_b128 v[52:55], v0 offset:0
    v_smfmac_f32_16x16x64_bf16 v[12:15], v[48:51], v[192:199], v1
    ds_read_b128 v[36:39], v0 offset:1024
    v_smfmac_f32_16x16x64_bf16 v[16:19], v[48:51], v[200:207], v1
    ds_read_b128 v[56:59], v9 offset:0
    v_smfmac_f32_16x16x64_bf16 v[20:23], v[48:51], v[208:215], v1
    ds_read_b128 v[60:63], v9 offset:1024
    v_smfmac_f32_16x16x64_bf16 v[24:27], v[48:51], v[64:71], v1
    ds_read_b128 v[40:43], v0 offset:4096
    s_waitcnt lgkmcnt(4)
    v_smfmac_f32_16x16x64_bf16 v[12:15], v[52:55], v[72:79], v1
    v_smfmac_f32_16x16x64_bf16 v[16:19], v[52:55], v[80:87], v1
    ds_read_b128 v[64:67], v9 offset:2048
    v_smfmac_f32_16x16x64_bf16 v[20:23], v[52:55], v[88:95], v1
    ds_read_b128 v[68:71], v9 offset:3072
    s_waitcnt lgkmcnt(3)
    v_smfmac_f32_16x16x64_bf16 v[24:27], v[52:55], v[56:63], v1
    v_smfmac_f32_16x16x64_bf16 v[12:15], v[36:39], v[112:119], v1
    ds_read_b128 v[52:55], v0 offset:5120
    v_smfmac_f32_16x16x64_bf16 v[16:19], v[36:39], v[120:127], v1
    ds_read_b128 v[56:59], v9 offset:8192
    v_smfmac_f32_16x16x64_bf16 v[20:23], v[36:39], v[128:135], v1
    ds_read_b128 v[60:63], v9 offset:9216
    s_waitcnt lgkmcnt(3)
    v_smfmac_f32_16x16x64_bf16 v[24:27], v[36:39], v[64:71], v1
    v_smfmac_f32_16x16x64_bf16 v[12:15], v[40:43], v[232:239], v1
    buffer_load_dwordx4 v[36:39], v0, s[8:11], s42 offen
    v_smfmac_f32_16x16x64_bf16 v[16:19], v[40:43], v[240:247], v1
    ds_read_b128 v[64:67], v9 offset:10240
    v_smfmac_f32_16x16x64_bf16 v[20:23], v[40:43], v[248:255], v1
    ds_read_b128 v[68:71], v9 offset:11264
    s_waitcnt lgkmcnt(2)
    v_smfmac_f32_16x16x64_bf16 v[24:27], v[40:43], v[56:63], v1
    s_waitcnt vmcnt(1)
    ds_read_b128 v[44:47], v0 offset:6144
    v_smfmac_f32_16x16x64_bf16 v[12:15], v[52:55], a[16:23], v1
    buffer_load_dwordx4 v[40:43], v0, s[8:11], s42 offen offset:1024
    v_smfmac_f32_16x16x64_bf16 v[16:19], v[52:55], a[24:31], v1
    ds_read_b128 v[56:59], v9 offset:12288
    v_smfmac_f32_16x16x64_bf16 v[20:23], v[52:55], a[32:39], v1
    ds_read_b128 v[60:63], v9 offset:13312
    s_waitcnt lgkmcnt(3)
    v_smfmac_f32_16x16x64_bf16 v[24:27], v[52:55], v[64:71], v1
    ds_read_b128 v[48:51], v0 offset:7168
    s_waitcnt lgkmcnt(3)
    v_smfmac_f32_16x16x64_bf16 v[12:15], v[44:47], a[56:63], v1
    ds_read_b128 v[52:55], v0 offset:8192
    v_smfmac_f32_16x16x64_bf16 v[16:19], v[44:47], a[64:71], v1
    ds_read_b128 v[64:67], v9 offset:14336
    v_smfmac_f32_16x16x64_bf16 v[20:23], v[44:47], a[72:79], v1
    ds_read_b128 v[68:71], v9 offset:15360
    s_waitcnt lgkmcnt(4)
    v_smfmac_f32_16x16x64_bf16 v[24:27], v[44:47], v[56:63], v1
    s_waitcnt lgkmcnt(3)
    v_smfmac_f32_16x16x64_bf16 v[12:15], v[48:51], a[96:103], v1
    v_smfmac_f32_16x16x64_bf16 v[16:19], v[48:51], a[104:111], v1
    ds_read_b128 v[56:59], v9 offset:16384
    s_waitcnt lgkmcnt(3)
    v_smfmac_f32_16x16x64_bf16 v[12:15], v[52:55], a[136:143], v1
    ds_read_b128 v[60:63], v9 offset:17408
    v_smfmac_f32_16x16x64_bf16 v[16:19], v[52:55], a[144:151], v1
    v_smfmac_f32_16x16x64_bf16 v[20:23], v[48:51], a[112:119], v1
    s_waitcnt lgkmcnt(2)
    v_smfmac_f32_16x16x64_bf16 v[24:27], v[48:51], v[64:71], v1
    ds_read_b128 v[64:67], v0 offset:9216
    s_nop 1
    v_add_f32 v12, v12, v14
    v_smfmac_f32_16x16x64_bf16 v[20:23], v[52:55], a[152:159], v1
    ds_read_b128 v[68:71], v0 offset:10240
    v_add_f32 v16, v16, v18
    s_waitcnt lgkmcnt(2)
    v_smfmac_f32_16x16x64_bf16 v[24:27], v[52:55], v[56:63], v1
    ds_read_b128 v[56:59], v0 offset:11264
    v_add_f32 v13, v13, v15
    v_add_f32 v17, v17, v19
    v_cvt_pk_bf16_f32 v14, v12, v16
    v_cvt_pk_bf16_f32 v15, v13, v17
    ds_write_b32 v2, v14 offset:17408
    ds_write_b32 v2, v15 offset:17696
    v_smfmac_f32_16x16x64_bf16 v[28:31], v[52:55], a[160:167], v1
    ds_read_b128 v[60:63], v0 offset:12288
    v_add_f32 v20, v20, v22
    v_add_f32 v24, v24, v26
    v_add_f32 v21, v21, v23
    v_add_f32 v25, v25, v27
    v_smfmac_f32_16x16x64_bf16 v[32:35], v[52:55], a[168:175], v1
    ds_read_b128 v[12:15], v0 offset:2048
    v_cvt_pk_bf16_f32 v22, v20, v24
    v_cvt_pk_bf16_f32 v23, v21, v25
    ds_write_b32 v2, v22 offset:19712
    ds_write_b32 v2, v23 offset:20000
    v_smfmac_f32_16x16x64_bf16 v[28:31], v[48:51], a[120:127], v1
    ds_read_b128 v[16:19], v0 offset:3072
    v_smfmac_f32_16x16x64_bf16 v[32:35], v[48:51], a[128:135], v1
    ds_read_b128 v[20:23], v0 offset:0
    v_smfmac_f32_16x16x64_bf16 v[28:31], v[44:47], a[80:87], v1
    ds_read_b128 v[24:27], v0 offset:1024
    v_smfmac_f32_16x16x64_bf16 v[32:35], v[44:47], a[88:95], v1
    s_waitcnt lgkmcnt(3)
    s_barrier
    ds_read_b128 v[44:47], v3 offset:17408
    v_smfmac_f32_16x16x64_bf16 v[28:31], v[12:15], v[176:183], v1
    ds_read_b128 v[52:55], v0 offset:4096
    v_smfmac_f32_16x16x64_bf16 v[32:35], v[12:15], v[184:191], v1
    ds_read_b128 v[12:15], v3 offset:19712
    s_waitcnt lgkmcnt(5)
    v_smfmac_f32_16x16x64_bf16 v[28:31], v[16:19], v[216:223], v1
    ds_read_b128 v[48:51], v0 offset:5120
    v_smfmac_f32_16x16x64_bf16 v[32:35], v[16:19], v[224:231], v1
    s_waitcnt lgkmcnt(5)
    v_smfmac_f32_16x16x64_bf16 v[28:31], v[20:23], v[96:103], v1
    v_smfmac_f32_16x16x64_bf16 v[32:35], v[20:23], v[104:111], v1
    ds_read_b128 v[20:23], v3 offset:17472
    s_waitcnt lgkmcnt(5)
    v_smfmac_f32_16x16x64_bf16 v[28:31], v[24:27], v[136:143], v1
    v_smfmac_f32_16x16x64_bf16 v[32:35], v[24:27], v[144:151], v1
    s_waitcnt lgkmcnt(3)
    v_smfmac_f32_16x16x64_bf16 v[28:31], v[52:55], a[0:7], v1
    v_smfmac_f32_16x16x64_bf16 v[32:35], v[52:55], a[8:15], v1
    ds_read_b128 v[52:55], v3 offset:19776
    s_waitcnt lgkmcnt(2)
    v_smfmac_f32_16x16x64_bf16 v[28:31], v[48:51], a[40:47], v1
    v_smfmac_f32_16x16x64_bf16 v[32:35], v[48:51], a[48:55], v1
    ds_read_b128 v[48:51], v3 offset:17536
    v_mfma_f32_16x16x32_bf16 v[24:27], v[12:15], v[44:47], 0
    v_mfma_f32_16x16x32_bf16 v[12:15], v[64:67], v[44:47], 0
    ds_read_b128 v[64:67], v0 offset:13312
    v_mfma_f32_16x16x32_bf16 v[16:19], v[68:71], v[44:47], 0
    ds_read_b128 v[68:71], v0 offset:14336
    s_waitcnt lgkmcnt(3)
    v_mfma_f32_16x16x32_bf16 v[24:27], v[52:55], v[20:23], v[24:27]
    ds_read_b128 v[44:47], v3 offset:19840
    v_add_f32 v28, v28, v30
    v_add_f32 v29, v29, v31
    v_mfma_f32_16x16x32_bf16 v[12:15], v[56:59], v[20:23], v[12:15]
    ds_read_b128 v[52:55], v3 offset:17600
    v_add_f32 v32, v32, v34
    v_add_f32 v33, v33, v35
    v_mfma_f32_16x16x32_bf16 v[16:19], v[60:63], v[20:23], v[16:19]
    ds_read_b128 v[56:59], v0 offset:15360
    v_cvt_pk_bf16_f32 v30, v28, v29
    v_cvt_pk_bf16_f32 v31, v32, v33
    s_waitcnt lgkmcnt(2)
    v_mfma_f32_16x16x32_bf16 v[24:27], v[44:47], v[48:51], v[24:27]
    ds_read_b128 v[20:23], v3 offset:19904
    v_lshrrev_b32 v10, 8, v0
    v_mul_u32_u24 v10, 288, v10
    v_mfma_f32_16x16x32_bf16 v[12:15], v[64:67], v[48:51], v[12:15]
    ds_read_b128 v[60:63], v0 offset:16384
    v_and_b32 v11, 0xf0, v0
    v_add_u32 v10, v10, v11
    v_mfma_f32_16x16x32_bf16 v[16:19], v[68:71], v[48:51], v[16:19]
    ds_read_b128 v[32:35], v10 offset:20288
    v_lshrrev_b32 v11, 1, v0
    v_bfi_b32 v30, 1, s66, v30
    s_waitcnt lgkmcnt(2)
    v_mfma_f32_16x16x32_bf16 v[24:27], v[20:23], v[52:55], v[24:27]
    buffer_store_dwordx2 v[30:31], v11, s[8:11], s43 offen offset:2048 sc1
    v_mov_b32 v49, 0
    v_mov_b32 v50, 0
    v_mfma_f32_16x16x32_bf16 v[12:15], v[56:59], v[52:55], v[12:15]
    v_mov_b64 v[64:65], s[68:69]
    v_mov_b64 v[66:67], s[68:69]
    s_waitcnt lgkmcnt(1)
    v_mfma_f32_16x16x32_bf16 v[16:19], v[60:63], v[52:55], v[16:19]
    s_waitcnt lgkmcnt(0)
    v_bfi_b32 v32, 1, s66, v32
    s_mov_b64 exec, s[52:53]
    buffer_store_dwordx4 v[32:35], v0, s[8:11], s43 offen sc1
    s_mov_b64 exec, -1
    v_max3_f32 v10, v24, v25, v12
    v_max3_f32 v10, v10, v13, v14
    s_nop 0
    v_max3_f32 v10, v10, v15, v16
    v_max3_f32 v10, v10, v17, v18
    v_max_f32 v10, v10, v19
    v_mov_b32 v11, v10
    s_nop 1
    v_permlane32_swap_b32 v10, v11
    v_max_f32 v10, v10, v11
    v_mov_b32 v11, v10
    s_nop 1
    v_permlane16_swap_b32 v10, v11
    v_max_f32 v10, v10, v11
    v_mul_f32 v20, s46, v10
    v_pk_fma_f32 v[24:25], v[24:25], s[46:47], v[20:21] op_sel_hi:[1,1,0] neg_lo:[0,0,1] neg_hi:[0,0,1]
    v_pk_fma_f32 v[12:13], v[12:13], s[46:47], v[20:21] op_sel_hi:[1,1,0] neg_lo:[0,0,1] neg_hi:[0,0,1]
    v_exp_f32 v24, v24
    v_exp_f32 v25, v25
    v_pk_fma_f32 v[14:15], v[14:15], s[46:47], v[20:21] op_sel_hi:[1,1,0] neg_lo:[0,0,1] neg_hi:[0,0,1]
    v_exp_f32 v12, v12
    v_exp_f32 v13, v13
    v_pk_fma_f32 v[16:17], v[16:17], s[46:47], v[20:21] op_sel_hi:[1,1,0] neg_lo:[0,0,1] neg_hi:[0,0,1]
    v_cvt_pk_bf16_f32 v48, v24, v25
    v_exp_f32 v14, v14
    v_pk_fma_f32 v[18:19], v[18:19], s[46:47], v[20:21] op_sel_hi:[1,1,0] neg_lo:[0,0,1] neg_hi:[0,0,1]
    v_cvt_pk_bf16_f32 v51, v24, v25
    v_exp_f32 v15, v15
    v_cvt_pk_bf16_f32 v44, v12, v13
    v_exp_f32 v16, v16
    v_exp_f32 v17, v17
    v_cvt_pk_bf16_f32 v45, v14, v15
    v_exp_f32 v18, v18
    v_exp_f32 v19, v19
    v_cvt_pk_bf16_f32 v46, v16, v17
    v_cvt_pk_bf16_f32 v47, v18, v19
    v_mfma_f32_16x16x16_bf16 v[68:71], v[64:65], v[48:49], 0
    v_mfma_f32_16x16x16_bf16 v[52:55], v[30:31], v[48:49], 0
    v_mfma_f32_16x16x16_bf16 v[56:59], v[30:31], v[50:51], 0
    v_mfma_f32_16x16x32_bf16 v[68:71], v[64:67], v[44:47], v[68:71]
    s_waitcnt vmcnt(3)
    v_mfma_f32_16x16x32_bf16 v[52:55], v[36:39], v[44:47], v[52:55]
    s_waitcnt vmcnt(2)
    v_mfma_f32_16x16x32_bf16 v[56:59], v[40:43], v[44:47], v[56:59]
    ds_read_b128 v[36:39], v0 offset:38912
    ds_read_b128 v[40:43], v0 offset:39936
    ds_read_b128 v[60:63], v9 offset:24576
    s_nop 0
    v_rcp_f32 v10, v68
    s_nop 0
    v_pk_mul_f32 v[52:53], v[52:53], v[10:11] op_sel_hi:[1,0]
    s_nop 0
    v_pk_mul_f32 v[56:57], v[56:57], v[10:11] op_sel_hi:[1,0]
    v_cvt_pk_bf16_f32 v16, v52, v56
    v_cvt_pk_bf16_f32 v17, v53, v57
    v_pk_mul_f32 v[54:55], v[54:55], v[10:11] op_sel_hi:[1,0]
    v_pk_mul_f32 v[58:59], v[58:59], v[10:11] op_sel_hi:[1,0]
    v_cvt_pk_bf16_f32 v18, v54, v58
    v_cvt_pk_bf16_f32 v19, v55, v59
    ds_write_b128 v3, v[16:19] offset:22080
    ds_read_b128 v[64:67], v9 offset:25600
    v_mov_b64 v[12:13], 0
    v_mov_b64 v[14:15], 0
    v_mov_b64 v[20:21], 0
    v_mov_b64 v[22:23], 0
    v_mov_b64 v[24:25], 0
    v_mov_b64 v[26:27], 0
    v_mov_b64 v[32:33], 0
    v_mov_b64 v[34:35], 0
    v_mov_b64 v[44:45], 0
    v_mov_b64 v[46:47], 0
    v_mov_b64 v[48:49], 0
    v_mov_b64 v[50:51], 0
    s_waitcnt lgkmcnt(1)
    s_barrier
    ds_read_b128 v[52:55], v4 offset:22016
    ds_read_b128 v[56:59], v4 offset:22144
    v_mov_b64 v[68:69], 0
    v_mov_b64 v[70:71], 0
    v_mov_b64 v[28:29], 0
    v_mov_b64 v[30:31], 0
    v_mov_b64 v[16:17], 0
    v_mov_b64 v[18:19], 0
    s_cmp_eq_u32 s33, 63
    s_cbranch_scc1 Lr1s_last
    s_waitcnt lgkmcnt(1)
    v_smfmac_f32_16x16x64_bf16 v[28:31], v[52:55], v[60:67], v1
    ds_read_b128 v[60:63], v0 offset:32768
    s_waitcnt lgkmcnt(1)
    v_smfmac_f32_16x16x64_bf16 v[28:31], v[56:59], v[36:43], v1
    ds_read_b128 v[64:67], v0 offset:33792
    ds_read_b128 v[36:39], v9 offset:18432
    v_smfmac_f32_16x16x64_bf16 v[12:15], v[52:55], a[176:183], v1
    ds_read_b128 v[40:43], v9 offset:19456
    v_smfmac_f32_16x16x64_bf16 v[12:15], v[56:59], a[184:191], v1
    buffer_load_dwordx4 v0, s[8:11], s41 offen offset:0 lds
    v_smfmac_f32_16x16x64_bf16 v[20:23], v[52:55], a[192:199], v1
    s_nop 0
    v_add_f32 v28, v28, v30
    v_add_f32 v29, v29, v31
    s_waitcnt lgkmcnt(2)
    v_smfmac_f32_16x16x64_bf16 v[20:23], v[56:59], v[60:67], v1
    ds_read_b128 v[60:63], v9 offset:20480
    v_cvt_pk_bf16_f32 v28, v28, v29
    v_bfi_b32 v28, 1, s39, v28
    buffer_store_dword v28, v8, s[8:11], s38 offen offset:2048 sc1
    s_waitcnt lgkmcnt(1)
    v_smfmac_f32_16x16x64_bf16 v[24:27], v[52:55], v[36:43], v1
    ds_read_b128 v[64:67], v9 offset:21504
    ds_read_b128 v[36:39], v0 offset:34816
    v_add_f32 v12, v12, v14
    v_add_f32 v13, v13, v15
    v_smfmac_f32_16x16x64_bf16 v[24:27], v[56:59], a[200:207], v1
    ds_read_b128 v[40:43], v0 offset:35840
    v_cvt_pk_bf16_f32 v12, v12, v13
    v_bfi_b32 v12, 1, s39, v12
    v_smfmac_f32_16x16x64_bf16 v[32:35], v[52:55], a[208:215], v1
    buffer_load_dwordx4 v0, s[8:11], s41 offen offset:1024 lds
    v_add_f32 v20, v20, v22
    v_add_f32 v21, v21, v23
    v_smfmac_f32_16x16x64_bf16 v[32:35], v[56:59], a[216:223], v1
    v_cvt_pk_bf16_f32 v13, v20, v21
    s_waitcnt lgkmcnt(2)
    v_smfmac_f32_16x16x64_bf16 v[44:47], v[52:55], v[60:67], v1
    ds_read_b128 v[60:63], v0 offset:36864
    v_add_f32 v24, v24, v26
    v_add_f32 v25, v25, v27
    s_waitcnt lgkmcnt(1)
    v_smfmac_f32_16x16x64_bf16 v[44:47], v[56:59], v[36:43], v1
    ds_read_b128 v[64:67], v0 offset:37888
    ds_read_b128 v[36:39], v9 offset:22528
    v_cvt_pk_bf16_f32 v14, v24, v25
    v_smfmac_f32_16x16x64_bf16 v[48:51], v[52:55], a[224:231], v1
    ds_read_b128 v[40:43], v9 offset:23552
    v_add_f32 v32, v32, v34
    v_add_f32 v33, v33, v35
    v_smfmac_f32_16x16x64_bf16 v[48:51], v[56:59], a[232:239], v1
    v_cvt_pk_bf16_f32 v15, v32, v33
    buffer_store_dwordx4 v[12:15], v0, s[8:11], s38 offen offset:0 sc1
    v_smfmac_f32_16x16x64_bf16 v[68:71], v[52:55], a[240:247], v1
    v_add_f32 v44, v44, v46
    v_add_f32 v45, v45, v47
    s_waitcnt lgkmcnt(2)
    v_smfmac_f32_16x16x64_bf16 v[68:71], v[56:59], v[60:67], v1
    v_cvt_pk_bf16_f32 v44, v44, v45
    v_bfi_b32 v44, 1, s39, v44
    s_waitcnt lgkmcnt(0)
    v_smfmac_f32_16x16x64_bf16 v[16:19], v[52:55], v[36:43], v1
    v_add_f32 v48, v48, v50
    v_add_f32 v49, v49, v51
    v_smfmac_f32_16x16x64_bf16 v[16:19], v[56:59], a[248:255], v1
    v_cvt_pk_bf16_f32 v45, v48, v49
    v_add_f32 v68, v68, v70
    v_add_f32 v69, v69, v71
    v_cvt_pk_bf16_f32 v46, v68, v69
    s_nop 3
    v_add_f32 v16, v16, v18
    v_add_f32 v17, v17, v19
    v_cvt_pk_bf16_f32 v47, v16, v17
    buffer_store_dwordx4 v[44:47], v0, s[8:11], s38 offen offset:1024 sc1
    s_sleep 6
    buffer_load_dwordx4 v[52:55], v6, s[8:11], s57 offen sc1
    buffer_load_dwordx4 v[56:59], v6, s[8:11], s58 offen sc1
    buffer_load_dwordx4 v[60:63], v6, s[8:11], s59 offen sc1
    buffer_load_dwordx4 v[64:67], v6, s[8:11], s60 offen sc1
    v_bfe_u32 v10, v0, 4, 4
    v_mov_b32 v11, 0x3f80
    v_mov_b32 v40, 0x3f800000
    v_cmp_eq_u32 vcc, 0, v10
    v_cmp_eq_u32 s[48:49], 1, v10
    s_nop 0
    v_cndmask_b32 v36, 0, v11, vcc
    v_cndmask_b32 v36, v36, v40, s[48:49]
    v_cmp_eq_u32 vcc, 2, v10
    v_cmp_eq_u32 s[48:49], 3, v10
    s_nop 0
    v_cndmask_b32 v37, 0, v11, vcc
    v_cndmask_b32 v37, v37, v40, s[48:49]
    v_cmp_eq_u32 vcc, 4, v10
    v_cmp_eq_u32 s[48:49], 5, v10
    s_nop 0
    v_cndmask_b32 v38, 0, v11, vcc
    v_cndmask_b32 v38, v38, v40, s[48:49]
    v_cmp_eq_u32 vcc, 6, v10
    v_cmp_eq_u32 s[48:49], 7, v10
    s_nop 0
    v_cndmask_b32 v39, 0, v11, vcc
    v_cndmask_b32 v39, v39, v40, s[48:49]
    s_mov_b32 s16, 0
    s_mov_b64 s[70:71], 0
    s_mov_b64 s[72:73], 0
    s_mov_b64 s[74:75], 0
    s_mov_b64 s[76:77], 0
Lr1s_p1:
    s_mov_b64 exec, s[70:71]
    buffer_load_dwordx4 v[52:55], v6, s[8:11], s57 offen sc1
    s_mov_b64 exec, s[72:73]
    buffer_load_dwordx4 v[56:59], v6, s[8:11], s58 offen sc1
    s_mov_b64 exec, s[74:75]
    buffer_load_dwordx4 v[60:63], v6, s[8:11], s59 offen sc1
    s_mov_b64 exec, s[76:77]
    buffer_load_dwordx4 v[64:67], v6, s[8:11], s60 offen sc1
    s_mov_b64 exec, -1
    s_add_u32 s16, s16, 1
    s_cmp_gt_u32 s16, 100000
    s_cbranch_scc1 Lr_abort
    s_waitcnt vmcnt(7)
    v_and_b32 v11, 1, v52
    v_cmp_ne_u32 s[70:71], s39, v11
    v_mfma_f32_16x16x32_bf16 v[40:43], v[52:55], v[36:39], 0
    s_waitcnt vmcnt(6)
    v_and_b32 v11, 1, v56
    v_cmp_ne_u32 s[72:73], s39, v11
    v_mfma_f32_16x16x32_bf16 v[40:43], v[56:59], v[36:39], v[40:43]
    s_waitcnt vmcnt(5)
    v_and_b32 v11, 1, v60
    v_cmp_ne_u32 s[74:75], s39, v11
    v_mfma_f32_16x16x32_bf16 v[40:43], v[60:63], v[36:39], v[40:43]
    s_or_b64 vcc, s[70:71], s[72:73]
    s_waitcnt vmcnt(4)
    v_and_b32 v11, 1, v64
    v_cmp_ne_u32 s[76:77], s39, v11
    v_mfma_f32_16x16x32_bf16 v[40:43], v[64:67], v[36:39], v[40:43]
    s_or_b64 vcc, vcc, s[74:75]
    s_or_b64 vcc, vcc, s[76:77]
    s_cbranch_scc1 Lr1s_p1
    s_nop 4
    v_permlane16_swap_b32 v40, v42
    v_permlane16_swap_b32 v41, v43
    s_mov_b64 exec, s[50:51]
    v_add_f32 v40, v40, v42
    v_add_f32 v41, v41, v43
    v_cvt_pk_bf16_f32 v40, v40, v41
    v_min_u32 v40, s54, v40
    buffer_store_dword v40, v7, s[8:11], s36 offen sc1
    v_mov_b32 v41, -1
    buffer_store_dword v41, v7, s[8:11], s37 offen sc1
    s_mov_b64 exec, -1
    s_xor_b32 s34, s34, 16384
    s_xor_b32 s35, s35, 16384
    s_barrier
    s_sleep 2
    buffer_load_dwordx4 v[44:47], v0, s[8:11], s34 offen sc1
    buffer_load_dwordx4 v[48:51], v0, s[8:11], s34 offen offset:1024 sc1
    buffer_load_dword v10, v8, s[8:11], s35 offen sc1
    s_add_u32 s33, s33, 1
    s_bfe_u32 s39, s33, 0x10001
    s_xor_b32 s38, s38, 524288
    s_xor_b32 s57, s57, 524288
    s_xor_b32 s58, s58, 524288
    s_xor_b32 s59, s59, 524288
    s_xor_b32 s60, s60, 524288
    s_xor_b32 s36, s36, 16384
    s_xor_b32 s37, s37, 16384
    s_and_b32 s17, s33, 7
    s_mul_i32 s17, s17, 131072
    s_add_u32 s43, s45, s17
    s_bfe_u32 s66, s33, 65539
    s_add_u32 s67, s67, 22528
    s_add_u32 s42, s42, 262144
    s_add_u32 s41, s41, 262144
    s_add_u32 s40, s40, 262144
    s_add_u32 s44, s44, 22528
    s_waitcnt vmcnt(5)
    ds_read_b128 v[56:59], v9 offset:4096
    ds_read_b128 v[60:63], v9 offset:5120
    ds_read_b128 v[64:67], v9 offset:6144
    ds_read_b128 v[68:71], v9 offset:7168
    v_mov_b64 v[12:13], 0
    v_mov_b64 v[14:15], 0
    v_mov_b64 v[16:17], 0
    v_mov_b64 v[18:19], 0
    v_mov_b64 v[20:21], 0
    v_mov_b64 v[22:23], 0
    v_mov_b64 v[24:25], 0
    v_mov_b64 v[26:27], 0
    v_mov_b64 v[28:29], 0
    v_mov_b64 v[30:31], 0
    v_mov_b64 v[32:33], 0
    v_mov_b64 v[34:35], 0
    s_waitcnt lgkmcnt(0)
    s_branch Lr1s_step
Lr1s_last:
    s_waitcnt vmcnt(0) lgkmcnt(0)
    s_branch Lr_exit
L_w2_0:
    s_cmp_lg_u32 s14, 2
    s_cbranch_scc1 L_w3_0
    s_barrier
    s_mov_b32 m0, 13312
    s_nop 0
    buffer_load_dwordx4 v0, s[8:11], s41 offen offset:0 lds
    buffer_load_dwordx4 v0, s[8:11], s41 offen offset:1024 lds
    s_add_u32 s41, s41, 262144
    s_waitcnt vmcnt(0)
    buffer_load_dwordx4 v[44:47], v0, s[8:11], s34 offen sc1
    buffer_load_dwordx4 v[48:51], v0, s[8:11], s34 offen offset:1024 sc1
    buffer_load_dword v10, v8, s[8:11], s35 offen sc1
    ds_read_b128 v[56:59], v9 offset:8192
    ds_read_b128 v[60:63], v9 offset:9216
    ds_read_b128 v[64:67], v9 offset:10240
    ds_read_b128 v[68:71], v9 offset:11264
    v_mov_b64 v[12:13], 0
    v_mov_b64 v[14:15], 0
    v_mov_b64 v[16:17], 0
    v_mov_b64 v[18:19], 0
    v_mov_b64 v[20:21], 0
    v_mov_b64 v[22:23], 0
    v_mov_b64 v[24:25], 0
    v_mov_b64 v[26:27], 0
    v_mov_b64 v[28:29], 0
    v_mov_b64 v[30:31], 0
    v_mov_b64 v[32:33], 0
    v_mov_b64 v[34:35], 0
    s_waitcnt lgkmcnt(0)
Lr2s_step:
    s_mov_b32 s16, 0
    s_mov_b64 s[70:71], 0
    s_mov_b64 s[72:73], 0
    s_mov_b64 s[74:75], 0
Lr2s_p2:
    s_mov_b64 exec, s[70:71]
    buffer_load_dwordx4 v[44:47], v0, s[8:11], s34 offen sc1
    s_mov_b64 exec, s[72:73]
    buffer_load_dwordx4 v[48:51], v0, s[8:11], s34 offen offset:1024 sc1
    s_mov_b64 exec, s[74:75]
    buffer_load_dword v10, v8, s[8:11], s35 offen sc1
    s_mov_b64 exec, -1
    s_add_u32 s16, s16, 1
    s_cmp_gt_u32 s16, 100000
    s_cbranch_scc1 Lr_abort
    s_waitcnt vmcnt(5)
    v_max3_u32 v11, v44, v45, v46
    v_max_u32 v11, v11, v47
    v_cmp_eq_u32 s[70:71], -1, v11
    s_waitcnt vmcnt(4)
    v_max3_u32 v11, v48, v49, v50
    v_max_u32 v11, v11, v51
    v_cmp_eq_u32 s[72:73], -1, v11
    s_waitcnt vmcnt(3)
    v_cmp_eq_u32 s[74:75], -1, v10
    s_or_b64 vcc, s[70:71], s[72:73]
    s_or_b64 vcc, vcc, s[74:75]
    s_cbranch_scc1 Lr2s_p2
    v_smfmac_f32_16x16x64_bf16 v[12:15], v[44:47], v[232:239], v1
    ds_write_b128 v0, v[44:47] offset:4096
    v_smfmac_f32_16x16x64_bf16 v[16:19], v[44:47], v[240:247], v1
    ds_write_b128 v0, v[48:51] offset:5120
    v_smfmac_f32_16x16x64_bf16 v[20:23], v[44:47], v[248:255], v1
    ds_write_b32 v8, v10 offset:8704
    v_smfmac_f32_16x16x64_bf16 v[24:27], v[44:47], v[56:63], v1
    s_waitcnt lgkmcnt(0)
    s_barrier
    ds_read_b128 v[52:55], v0 offset:0
    v_smfmac_f32_16x16x64_bf16 v[12:15], v[48:51], a[16:23], v1
    ds_read_b128 v[36:39], v0 offset:1024
    v_smfmac_f32_16x16x64_bf16 v[16:19], v[48:51], a[24:31], v1
    ds_read_b128 v[56:59], v9 offset:0
    v_smfmac_f32_16x16x64_bf16 v[20:23], v[48:51], a[32:39], v1
    ds_read_b128 v[60:63], v9 offset:1024
    v_smfmac_f32_16x16x64_bf16 v[24:27], v[48:51], v[64:71], v1
    ds_read_b128 v[40:43], v0 offset:2048
    s_waitcnt lgkmcnt(4)
    v_smfmac_f32_16x16x64_bf16 v[12:15], v[52:55], v[72:79], v1
    v_smfmac_f32_16x16x64_bf16 v[16:19], v[52:55], v[80:87], v1
    ds_read_b128 v[64:67], v9 offset:2048
    v_smfmac_f32_16x16x64_bf16 v[20:23], v[52:55], v[88:95], v1
    ds_read_b128 v[68:71], v9 offset:3072
    s_waitcnt lgkmcnt(3)
    v_smfmac_f32_16x16x64_bf16 v[24:27], v[52:55], v[56:63], v1
    v_smfmac_f32_16x16x64_bf16 v[12:15], v[36:39], v[112:119], v1
    ds_read_b128 v[52:55], v0 offset:3072
    v_smfmac_f32_16x16x64_bf16 v[16:19], v[36:39], v[120:127], v1
    ds_read_b128 v[56:59], v9 offset:4096
    v_smfmac_f32_16x16x64_bf16 v[20:23], v[36:39], v[128:135], v1
    ds_read_b128 v[60:63], v9 offset:5120
    s_waitcnt lgkmcnt(3)
    v_smfmac_f32_16x16x64_bf16 v[24:27], v[36:39], v[64:71], v1
    v_smfmac_f32_16x16x64_bf16 v[12:15], v[40:43], v[152:159], v1
    buffer_load_dwordx4 v[36:39], v0, s[8:11], s42 offen
    v_smfmac_f32_16x16x64_bf16 v[16:19], v[40:43], v[160:167], v1
    ds_read_b128 v[64:67], v9 offset:6144
    v_smfmac_f32_16x16x64_bf16 v[20:23], v[40:43], v[168:175], v1
    ds_read_b128 v[68:71], v9 offset:7168
    s_waitcnt lgkmcnt(2)
    v_smfmac_f32_16x16x64_bf16 v[24:27], v[40:43], v[56:63], v1
    s_waitcnt vmcnt(1)
    ds_read_b128 v[44:47], v0 offset:6144
    v_smfmac_f32_16x16x64_bf16 v[12:15], v[52:55], v[192:199], v1
    buffer_load_dwordx4 v[40:43], v0, s[8:11], s42 offen offset:1024
    v_smfmac_f32_16x16x64_bf16 v[16:19], v[52:55], v[200:207], v1
    ds_read_b128 v[56:59], v9 offset:12288
    v_smfmac_f32_16x16x64_bf16 v[20:23], v[52:55], v[208:215], v1
    ds_read_b128 v[60:63], v9 offset:13312
    s_waitcnt lgkmcnt(3)
    v_smfmac_f32_16x16x64_bf16 v[24:27], v[52:55], v[64:71], v1
    ds_read_b128 v[48:51], v0 offset:7168
    s_waitcnt lgkmcnt(3)
    v_smfmac_f32_16x16x64_bf16 v[12:15], v[44:47], a[56:63], v1
    ds_read_b128 v[52:55], v0 offset:8192
    v_smfmac_f32_16x16x64_bf16 v[16:19], v[44:47], a[64:71], v1
    ds_read_b128 v[64:67], v9 offset:14336
    v_smfmac_f32_16x16x64_bf16 v[20:23], v[44:47], a[72:79], v1
    ds_read_b128 v[68:71], v9 offset:15360
    s_waitcnt lgkmcnt(4)
    v_smfmac_f32_16x16x64_bf16 v[24:27], v[44:47], v[56:63], v1
    s_waitcnt lgkmcnt(3)
    v_smfmac_f32_16x16x64_bf16 v[12:15], v[48:51], a[96:103], v1
    v_smfmac_f32_16x16x64_bf16 v[16:19], v[48:51], a[104:111], v1
    ds_read_b128 v[56:59], v9 offset:16384
    s_waitcnt lgkmcnt(3)
    v_smfmac_f32_16x16x64_bf16 v[12:15], v[52:55], a[136:143], v1
    ds_read_b128 v[60:63], v9 offset:17408
    v_smfmac_f32_16x16x64_bf16 v[16:19], v[52:55], a[144:151], v1
    v_smfmac_f32_16x16x64_bf16 v[20:23], v[48:51], a[112:119], v1
    s_waitcnt lgkmcnt(2)
    v_smfmac_f32_16x16x64_bf16 v[24:27], v[48:51], v[64:71], v1
    ds_read_b128 v[64:67], v0 offset:9216
    s_nop 1
    v_add_f32 v12, v12, v14
    v_smfmac_f32_16x16x64_bf16 v[20:23], v[52:55], a[152:159], v1
    ds_read_b128 v[68:71], v0 offset:10240
    v_add_f32 v16, v16, v18
    s_waitcnt lgkmcnt(2)
    v_smfmac_f32_16x16x64_bf16 v[24:27], v[52:55], v[56:63], v1
    ds_read_b128 v[56:59], v0 offset:11264
    v_add_f32 v13, v13, v15
    v_add_f32 v17, v17, v19
    v_cvt_pk_bf16_f32 v14, v12, v16
    v_cvt_pk_bf16_f32 v15, v13, v17
    ds_write_b32 v2, v14 offset:17408
    ds_write_b32 v2, v15 offset:17696
    v_smfmac_f32_16x16x64_bf16 v[28:31], v[52:55], a[160:167], v1
    ds_read_b128 v[60:63], v0 offset:12288
    v_add_f32 v20, v20, v22
    v_add_f32 v24, v24, v26
    v_add_f32 v21, v21, v23
    v_add_f32 v25, v25, v27
    v_smfmac_f32_16x16x64_bf16 v[32:35], v[52:55], a[168:175], v1
    ds_read_b128 v[12:15], v0 offset:4096
    v_cvt_pk_bf16_f32 v22, v20, v24
    v_cvt_pk_bf16_f32 v23, v21, v25
    ds_write_b32 v2, v22 offset:19712
    ds_write_b32 v2, v23 offset:20000
    v_smfmac_f32_16x16x64_bf16 v[28:31], v[48:51], a[120:127], v1
    ds_read_b128 v[16:19], v0 offset:5120
    v_smfmac_f32_16x16x64_bf16 v[32:35], v[48:51], a[128:135], v1
    ds_read_b128 v[20:23], v0 offset:0
    v_smfmac_f32_16x16x64_bf16 v[28:31], v[44:47], a[80:87], v1
    ds_read_b128 v[24:27], v0 offset:1024
    v_smfmac_f32_16x16x64_bf16 v[32:35], v[44:47], a[88:95], v1
    s_waitcnt lgkmcnt(3)
    s_barrier
    ds_read_b128 v[44:47], v3 offset:17408
    v_smfmac_f32_16x16x64_bf16 v[28:31], v[12:15], a[0:7], v1
    ds_read_b128 v[52:55], v0 offset:2048
    v_smfmac_f32_16x16x64_bf16 v[32:35], v[12:15], a[8:15], v1
    ds_read_b128 v[12:15], v3 offset:19712
    s_waitcnt lgkmcnt(5)
    v_smfmac_f32_16x16x64_bf16 v[28:31], v[16:19], a[40:47], v1
    ds_read_b128 v[48:51], v0 offset:3072
    v_smfmac_f32_16x16x64_bf16 v[32:35], v[16:19], a[48:55], v1
    s_waitcnt lgkmcnt(5)
    v_smfmac_f32_16x16x64_bf16 v[28:31], v[20:23], v[96:103], v1
    v_smfmac_f32_16x16x64_bf16 v[32:35], v[20:23], v[104:111], v1
    ds_read_b128 v[20:23], v3 offset:17472
    s_waitcnt lgkmcnt(5)
    v_smfmac_f32_16x16x64_bf16 v[28:31], v[24:27], v[136:143], v1
    v_smfmac_f32_16x16x64_bf16 v[32:35], v[24:27], v[144:151], v1
    s_waitcnt lgkmcnt(3)
    v_smfmac_f32_16x16x64_bf16 v[28:31], v[52:55], v[176:183], v1
    v_smfmac_f32_16x16x64_bf16 v[32:35], v[52:55], v[184:191], v1
    ds_read_b128 v[52:55], v3 offset:19776
    s_waitcnt lgkmcnt(2)
    v_smfmac_f32_16x16x64_bf16 v[28:31], v[48:51], v[216:223], v1
    v_smfmac_f32_16x16x64_bf16 v[32:35], v[48:51], v[224:231], v1
    ds_read_b128 v[48:51], v3 offset:17536
    v_mfma_f32_16x16x32_bf16 v[24:27], v[12:15], v[44:47], 0
    v_mfma_f32_16x16x32_bf16 v[12:15], v[64:67], v[44:47], 0
    ds_read_b128 v[64:67], v0 offset:13312
    v_mfma_f32_16x16x32_bf16 v[16:19], v[68:71], v[44:47], 0
    ds_read_b128 v[68:71], v0 offset:14336
    s_waitcnt lgkmcnt(3)
    v_mfma_f32_16x16x32_bf16 v[24:27], v[52:55], v[20:23], v[24:27]
    ds_read_b128 v[44:47], v3 offset:19840
    v_add_f32 v28, v28, v30
    v_add_f32 v29, v29, v31
    v_mfma_f32_16x16x32_bf16 v[12:15], v[56:59], v[20:23], v[12:15]
    ds_read_b128 v[52:55], v3 offset:17600
    v_add_f32 v32, v32, v34
    v_add_f32 v33, v33, v35
    v_mfma_f32_16x16x32_bf16 v[16:19], v[60:63], v[20:23], v[16:19]
    ds_read_b128 v[56:59], v0 offset:15360
    v_cvt_pk_bf16_f32 v30, v28, v29
    v_cvt_pk_bf16_f32 v31, v32, v33
    s_waitcnt lgkmcnt(2)
    v_mfma_f32_16x16x32_bf16 v[24:27], v[44:47], v[48:51], v[24:27]
    ds_read_b128 v[20:23], v3 offset:19904
    v_lshrrev_b32 v10, 8, v0
    v_mul_u32_u24 v10, 288, v10
    v_mfma_f32_16x16x32_bf16 v[12:15], v[64:67], v[48:51], v[12:15]
    ds_read_b128 v[60:63], v0 offset:16384
    v_and_b32 v11, 0xf0, v0
    v_add_u32 v10, v10, v11
    v_mfma_f32_16x16x32_bf16 v[16:19], v[68:71], v[48:51], v[16:19]
    ds_read_b128 v[32:35], v10 offset:20864
    v_lshrrev_b32 v11, 1, v0
    v_bfi_b32 v30, 1, s66, v30
    s_waitcnt lgkmcnt(2)
    v_mfma_f32_16x16x32_bf16 v[24:27], v[20:23], v[52:55], v[24:27]
    buffer_store_dwordx2 v[30:31], v11, s[8:11], s43 offen offset:2048 sc1
    v_mov_b32 v49, 0
    v_mov_b32 v50, 0
    v_mfma_f32_16x16x32_bf16 v[12:15], v[56:59], v[52:55], v[12:15]
    v_mov_b64 v[64:65], s[68:69]
    v_mov_b64 v[66:67], s[68:69]
    s_waitcnt lgkmcnt(1)
    v_mfma_f32_16x16x32_bf16 v[16:19], v[60:63], v[52:55], v[16:19]
    s_waitcnt lgkmcnt(0)
    v_bfi_b32 v32, 1, s66, v32
    s_mov_b64 exec, s[52:53]
    buffer_store_dwordx4 v[32:35], v0, s[8:11], s43 offen sc1
    s_mov_b64 exec, -1
    v_max3_f32 v10, v24, v25, v12
    v_max3_f32 v10, v10, v13, v14
    s_nop 0
    v_max3_f32 v10, v10, v15, v16
    v_max3_f32 v10, v10, v17, v18
    v_max_f32 v10, v10, v19
    v_mov_b32 v11, v10
    s_nop 1
    v_permlane32_swap_b32 v10, v11
    v_max_f32 v10, v10, v11
    v_mov_b32 v11, v10
    s_nop 1
    v_permlane16_swap_b32 v10, v11
    v_max_f32 v10, v10, v11
    v_mul_f32 v20, s46, v10
    v_pk_fma_f32 v[24:25], v[24:25], s[46:47], v[20:21] op_sel_hi:[1,1,0] neg_lo:[0,0,1] neg_hi:[0,0,1]
    v_pk_fma_f32 v[12:13], v[12:13], s[46:47], v[20:21] op_sel_hi:[1,1,0] neg_lo:[0,0,1] neg_hi:[0,0,1]
    v_exp_f32 v24, v24
    v_exp_f32 v25, v25
    v_pk_fma_f32 v[14:15], v[14:15], s[46:47], v[20:21] op_sel_hi:[1,1,0] neg_lo:[0,0,1] neg_hi:[0,0,1]
    v_exp_f32 v12, v12
    v_exp_f32 v13, v13
    v_pk_fma_f32 v[16:17], v[16:17], s[46:47], v[20:21] op_sel_hi:[1,1,0] neg_lo:[0,0,1] neg_hi:[0,0,1]
    v_cvt_pk_bf16_f32 v48, v24, v25
    v_exp_f32 v14, v14
    v_pk_fma_f32 v[18:19], v[18:19], s[46:47], v[20:21] op_sel_hi:[1,1,0] neg_lo:[0,0,1] neg_hi:[0,0,1]
    v_cvt_pk_bf16_f32 v51, v24, v25
    v_exp_f32 v15, v15
    v_cvt_pk_bf16_f32 v44, v12, v13
    v_exp_f32 v16, v16
    v_exp_f32 v17, v17
    v_cvt_pk_bf16_f32 v45, v14, v15
    v_exp_f32 v18, v18
    v_exp_f32 v19, v19
    v_cvt_pk_bf16_f32 v46, v16, v17
    v_cvt_pk_bf16_f32 v47, v18, v19
    v_mfma_f32_16x16x16_bf16 v[68:71], v[64:65], v[48:49], 0
    v_mfma_f32_16x16x16_bf16 v[52:55], v[30:31], v[48:49], 0
    v_mfma_f32_16x16x16_bf16 v[56:59], v[30:31], v[50:51], 0
    v_mfma_f32_16x16x32_bf16 v[68:71], v[64:67], v[44:47], v[68:71]
    s_waitcnt vmcnt(3)
    v_mfma_f32_16x16x32_bf16 v[52:55], v[36:39], v[44:47], v[52:55]
    s_waitcnt vmcnt(2)
    v_mfma_f32_16x16x32_bf16 v[56:59], v[40:43], v[44:47], v[56:59]
    ds_read_b128 v[36:39], v0 offset:47104
    ds_read_b128 v[40:43], v0 offset:48128
    ds_read_b128 v[60:63], v9 offset:24576
    s_nop 0
    v_rcp_f32 v10, v68
    s_nop 0
    v_pk_mul_f32 v[52:53], v[52:53], v[10:11] op_sel_hi:[1,0]
    s_nop 0
    v_pk_mul_f32 v[56:57], v[56:57], v[10:11] op_sel_hi:[1,0]
    v_cvt_pk_bf16_f32 v16, v52, v56
    v_cvt_pk_bf16_f32 v17, v53, v57
    v_pk_mul_f32 v[54:55], v[54:55], v[10:11] op_sel_hi:[1,0]
    v_pk_mul_f32 v[58:59], v[58:59], v[10:11] op_sel_hi:[1,0]
    v_cvt_pk_bf16_f32 v18, v54, v58
    v_cvt_pk_bf16_f32 v19, v55, v59
    ds_write_b128 v3, v[16:19] offset:22144
    ds_read_b128 v[64:67], v9 offset:25600
    v_mov_b64 v[12:13], 0
    v_mov_b64 v[14:15], 0
    v_mov_b64 v[20:21], 0
    v_mov_b64 v[22:23], 0
    v_mov_b64 v[24:25], 0
    v_mov_b64 v[26:27], 0
    v_mov_b64 v[32:33], 0
    v_mov_b64 v[34:35], 0
    v_mov_b64 v[44:45], 0
    v_mov_b64 v[46:47], 0
    v_mov_b64 v[48:49], 0
    v_mov_b64 v[50:51], 0
    s_waitcnt lgkmcnt(1)
    s_barrier
    ds_read_b128 v[52:55], v4 offset:22016
    ds_read_b128 v[56:59], v4 offset:22144
    v_mov_b64 v[68:69], 0
    v_mov_b64 v[70:71], 0
    v_mov_b64 v[28:29], 0
    v_mov_b64 v[30:31], 0
    v_mov_b64 v[16:17], 0
    v_mov_b64 v[18:19], 0
    s_cmp_eq_u32 s33, 63
    s_cbranch_scc1 Lr2s_last
    s_waitcnt lgkmcnt(1)
    v_smfmac_f32_16x16x64_bf16 v[28:31], v[52:55], v[60:67], v1
    ds_read_b128 v[60:63], v0 offset:40960
    s_waitcnt lgkmcnt(1)
    v_smfmac_f32_16x16x64_bf16 v[28:31], v[56:59], v[36:43], v1
    ds_read_b128 v[64:67], v0 offset:41984
    ds_read_b128 v[36:39], v9 offset:18432
    v_smfmac_f32_16x16x64_bf16 v[12:15], v[52:55], a[176:183], v1
    ds_read_b128 v[40:43], v9 offset:19456
    v_smfmac_f32_16x16x64_bf16 v[12:15], v[56:59], a[184:191], v1
    buffer_load_dwordx4 v0, s[8:11], s41 offen offset:0 lds
    v_smfmac_f32_16x16x64_bf16 v[20:23], v[52:55], a[192:199], v1
    s_nop 0
    v_add_f32 v28, v28, v30
    v_add_f32 v29, v29, v31
    s_waitcnt lgkmcnt(2)
    v_smfmac_f32_16x16x64_bf16 v[20:23], v[56:59], v[60:67], v1
    ds_read_b128 v[60:63], v9 offset:20480
    v_cvt_pk_bf16_f32 v28, v28, v29
    v_bfi_b32 v28, 1, s39, v28
    buffer_store_dword v28, v8, s[8:11], s38 offen offset:2048 sc1
    s_waitcnt lgkmcnt(1)
    v_smfmac_f32_16x16x64_bf16 v[24:27], v[52:55], v[36:43], v1
    ds_read_b128 v[64:67], v9 offset:21504
    ds_read_b128 v[36:39], v0 offset:43008
    v_add_f32 v12, v12, v14
    v_add_f32 v13, v13, v15
    v_smfmac_f32_16x16x64_bf16 v[24:27], v[56:59], a[200:207], v1
    ds_read_b128 v[40:43], v0 offset:44032
    v_cvt_pk_bf16_f32 v12, v12, v13
    v_bfi_b32 v12, 1, s39, v12
    v_smfmac_f32_16x16x64_bf16 v[32:35], v[52:55], a[208:215], v1
    buffer_load_dwordx4 v0, s[8:11], s41 offen offset:1024 lds
    v_add_f32 v20, v20, v22
    v_add_f32 v21, v21, v23
    v_smfmac_f32_16x16x64_bf16 v[32:35], v[56:59], a[216:223], v1
    v_cvt_pk_bf16_f32 v13, v20, v21
    s_waitcnt lgkmcnt(2)
    v_smfmac_f32_16x16x64_bf16 v[44:47], v[52:55], v[60:67], v1
    ds_read_b128 v[60:63], v0 offset:45056
    v_add_f32 v24, v24, v26
    v_add_f32 v25, v25, v27
    s_waitcnt lgkmcnt(1)
    v_smfmac_f32_16x16x64_bf16 v[44:47], v[56:59], v[36:43], v1
    ds_read_b128 v[64:67], v0 offset:46080
    ds_read_b128 v[36:39], v9 offset:22528
    v_cvt_pk_bf16_f32 v14, v24, v25
    v_smfmac_f32_16x16x64_bf16 v[48:51], v[52:55], a[224:231], v1
    ds_read_b128 v[40:43], v9 offset:23552
    v_add_f32 v32, v32, v34
    v_add_f32 v33, v33, v35
    v_smfmac_f32_16x16x64_bf16 v[48:51], v[56:59], a[232:239], v1
    v_cvt_pk_bf16_f32 v15, v32, v33
    buffer_store_dwordx4 v[12:15], v0, s[8:11], s38 offen offset:0 sc1
    v_smfmac_f32_16x16x64_bf16 v[68:71], v[52:55], a[240:247], v1
    v_add_f32 v44, v44, v46
    v_add_f32 v45, v45, v47
    s_waitcnt lgkmcnt(2)
    v_smfmac_f32_16x16x64_bf16 v[68:71], v[56:59], v[60:67], v1
    v_cvt_pk_bf16_f32 v44, v44, v45
    v_bfi_b32 v44, 1, s39, v44
    s_waitcnt lgkmcnt(0)
    v_smfmac_f32_16x16x64_bf16 v[16:19], v[52:55], v[36:43], v1
    v_add_f32 v48, v48, v50
    v_add_f32 v49, v49, v51
    v_smfmac_f32_16x16x64_bf16 v[16:19], v[56:59], a[248:255], v1
    v_cvt_pk_bf16_f32 v45, v48, v49
    v_add_f32 v68, v68, v70
    v_add_f32 v69, v69, v71
    v_cvt_pk_bf16_f32 v46, v68, v69
    s_nop 3
    v_add_f32 v16, v16, v18
    v_add_f32 v17, v17, v19
    v_cvt_pk_bf16_f32 v47, v16, v17
    buffer_store_dwordx4 v[44:47], v0, s[8:11], s38 offen offset:1024 sc1
    s_cmp_eq_u32 s62, 0
    s_cbranch_scc1 Lr2s_nojob
    s_sleep 6
    buffer_load_dwordx4 v[52:55], v6, s[8:11], s57 offen sc1
    buffer_load_dwordx4 v[56:59], v6, s[8:11], s58 offen sc1
    buffer_load_dwordx4 v[60:63], v6, s[8:11], s59 offen sc1
    buffer_load_dwordx4 v[64:67], v6, s[8:11], s60 offen sc1
    v_bfe_u32 v10, v0, 4, 4
    v_mov_b32 v11, 0x3f80
    v_mov_b32 v40, 0x3f800000
    v_cmp_eq_u32 vcc, 0, v10
    v_cmp_eq_u32 s[48:49], 1, v10
    s_nop 0
    v_cndmask_b32 v36, 0, v11, vcc
    v_cndmask_b32 v36, v36, v40, s[48:49]
    v_cmp_eq_u32 vcc, 2, v10
    v_cmp_eq_u32 s[48:49], 3, v10
    s_nop 0
    v_cndmask_b32 v37, 0, v11, vcc
    v_cndmask_b32 v37, v37, v40, s[48:49]
    v_cmp_eq_u32 vcc, 4, v10
    v_cmp_eq_u32 s[48:49], 5, v10
    s_nop 0
    v_cndmask_b32 v38, 0, v11, vcc
    v_cndmask_b32 v38, v38, v40, s[48:49]
    v_cmp_eq_u32 vcc, 6, v10
    v_cmp_eq_u32 s[48:49], 7, v10
    s_nop 0
    v_cndmask_b32 v39, 0, v11, vcc
    v_cndmask_b32 v39, v39, v40, s[48:49]
    s_mov_b32 s16, 0
    s_mov_b64 s[70:71], 0
    s_mov_b64 s[72:73], 0
    s_mov_b64 s[74:75], 0
    s_mov_b64 s[76:77], 0
Lr2s_p1:
    s_mov_b64 exec, s[70:71]
    buffer_load_dwordx4 v[52:55], v6, s[8:11], s57 offen sc1
    s_mov_b64 exec, s[72:73]
    buffer_load_dwordx4 v[56:59], v6, s[8:11], s58 offen sc1
    s_mov_b64 exec, s[74:75]
    buffer_load_dwordx4 v[60:63], v6, s[8:11], s59 offen sc1
    s_mov_b64 exec, s[76:77]
    buffer_load_dwordx4 v[64:67], v6, s[8:11], s60 offen sc1
    s_mov_b64 exec, -1
    s_add_u32 s16, s16, 1
    s_cmp_gt_u32 s16, 100000
    s_cbranch_scc1 Lr_abort
    s_waitcnt vmcnt(7)
    v_xor_b32 v10, v52, v53
    v_xor_b32 v11, v54, v55
    v_or_b32 v10, v10, v11
    v_xor_b32 v11, v52, v54
    v_or_b32 v10, v10, v11
    v_xor_b32 v11, s39, v52
    v_or_b32 v10, v10, v11
    v_and_b32 v10, 1, v10
    v_cmp_ne_u32 s[70:71], 0, v10
    v_mfma_f32_16x16x32_bf16 v[40:43], v[52:55], v[36:39], 0
    s_waitcnt vmcnt(6)
    v_xor_b32 v10, v56, v57
    v_xor_b32 v11, v58, v59
    v_or_b32 v10, v10, v11
    v_xor_b32 v11, v56, v58
    v_or_b32 v10, v10, v11
    v_xor_b32 v11, s39, v56
    v_or_b32 v10, v10, v11
    v_and_b32 v10, 1, v10
    v_cmp_ne_u32 s[72:73], 0, v10
    v_mfma_f32_16x16x32_bf16 v[40:43], v[56:59], v[36:39], v[40:43]
    s_waitcnt vmcnt(5)
    v_xor_b32 v10, v60, v61
    v_xor_b32 v11, v62, v63
    v_or_b32 v10, v10, v11
    v_xor_b32 v11, v60, v62
    v_or_b32 v10, v10, v11
    v_xor_b32 v11, s39, v60
    v_or_b32 v10, v10, v11
    v_and_b32 v10, 1, v10
    v_cmp_ne_u32 s[74:75], 0, v10
    v_mfma_f32_16x16x32_bf16 v[40:43], v[60:63], v[36:39], v[40:43]
    s_or_b64 vcc, s[70:71], s[72:73]
    s_waitcnt vmcnt(4)
    v_xor_b32 v10, v64, v65
    v_xor_b32 v11, v66, v67
    v_or_b32 v10, v10, v11
    v_xor_b32 v11, v64, v66
    v_or_b32 v10, v10, v11
    v_xor_b32 v11, s39, v64
    v_or_b32 v10, v10, v11
    v_and_b32 v10, 1, v10
    v_cmp_ne_u32 s[76:77], 0, v10
    v_mfma_f32_16x16x32_bf16 v[40:43], v[64:67], v[36:39], v[40:43]
    s_or_b64 vcc, vcc, s[74:75]
    s_or_b64 vcc, vcc, s[76:77]
    s_cbranch_scc1 Lr2s_p1
    s_nop 4
    v_permlane16_swap_b32 v40, v42
    v_permlane16_swap_b32 v41, v43
    s_mov_b64 exec, s[50:51]
    v_add_f32 v40, v40, v42
    v_add_f32 v41, v41, v43
    v_cvt_pk_bf16_f32 v40, v40, v41
    v_min_u32 v40, s54, v40
    buffer_store_dword v40, v7, s[8:11], s36 offen sc1
    v_mov_b32 v41, -1
    buffer_store_dword v41, v7, s[8:11], s37 offen sc1
    s_mov_b64 exec, -1
    s_branch Lr2s_jobdone
Lr2s_nojob:
Lr2s_jobdone:
    s_xor_b32 s34, s34, 16384
    s_xor_b32 s35, s35, 16384
    s_barrier
    s_sleep 2
    buffer_load_dwordx4 v[44:47], v0, s[8:11], s34 offen sc1
    buffer_load_dwordx4 v[48:51], v0, s[8:11], s34 offen offset:1024 sc1
    buffer_load_dword v10, v8, s[8:11], s35 offen sc1
    s_add_u32 s33, s33, 1
    s_bfe_u32 s39, s33, 0x10001
    s_xor_b32 s38, s38, 524288
    s_xor_b32 s57, s57, 524288
    s_xor_b32 s58, s58, 524288
    s_xor_b32 s59, s59, 524288
    s_xor_b32 s60, s60, 524288
    s_xor_b32 s36, s36, 16384
    s_xor_b32 s37, s37, 16384
    s_and_b32 s17, s33, 7
    s_mul_i32 s17, s17, 131072
    s_add_u32 s43, s45, s17
    s_bfe_u32 s66, s33, 65539
    s_add_u32 s67, s67, 22528
    s_add_u32 s42, s42, 262144
    s_add_u32 s41, s41, 262144
    s_add_u32 s40, s40, 262144
    s_add_u32 s44, s44, 22528
    s_waitcnt vmcnt(6)
    ds_read_b128 v[56:59], v9 offset:8192
    ds_read_b128 v[60:63], v9 offset:9216
    ds_read_b128 v[64:67], v9 offset:10240
    ds_read_b128 v[68:71], v9 offset:11264
    v_mov_b64 v[12:13], 0
    v_mov_b64 v[14:15], 0
    v_mov_b64 v[16:17], 0
    v_mov_b64 v[18:19], 0
    v_mov_b64 v[20:21], 0
    v_mov_b64 v[22:23], 0
    v_mov_b64 v[24:25], 0
    v_mov_b64 v[26:27], 0
    v_mov_b64 v[28:29], 0
    v_mov_b64 v[30:31], 0
    v_mov_b64 v[32:33], 0
    v_mov_b64 v[34:35], 0
    s_waitcnt lgkmcnt(0)
    s_branch Lr2s_step
Lr2s_last:
    s_waitcnt vmcnt(0) lgkmcnt(0)
    s_branch Lr_exit
L_w3_0:
    s_mov_b32 s16, 0
    s_add_u32 s17, s44, 128
    v_and_b32 v11, 16, v8
    v_lshlrev_b32 v11, 3, v11
    v_and_or_b32 v11, v8, 12, v11
Lr3s_fw_11:
    buffer_load_dword v10, v11, s[8:11], s17 offen sc1
    s_add_u32 s16, s16, 1
    s_cmp_gt_u32 s16, 100000
    s_cbranch_scc1 Lr_abort
    s_waitcnt vmcnt(0)
    v_cmp_eq_u32 vcc, 0, v10
    s_nop 0
    s_cbranch_vccz Lr3s_fw_11d
    s_sleep 4
    s_branch Lr3s_fw_11
Lr3s_fw_11d:
    s_barrier
    s_mov_b32 m0, 15360
    s_nop 0
    buffer_load_dwordx4 v0, s[8:11], s41 offen offset:0 lds
    buffer_load_dwordx4 v0, s[8:11], s41 offen offset:1024 lds
    s_add_u32 s41, s41, 262144
    s_waitcnt vmcnt(0)
    buffer_load_dwordx4 v[44:47], v0, s[8:11], s34 offen sc1
    buffer_load_dwordx4 v[48:51], v0, s[8:11], s34 offen offset:1024 sc1
    buffer_load_dword v10, v8, s[8:11], s35 offen sc1
    ds_read_b128 v[56:59], v9 offset:12288
    ds_read_b128 v[60:63], v9 offset:13312
    ds_read_b128 v[64:67], v9 offset:14336
    ds_read_b128 v[68:71], v9 offset:15360
    v_mov_b64 v[12:13], 0
    v_mov_b64 v[14:15], 0
    v_mov_b64 v[16:17], 0
    v_mov_b64 v[18:19], 0
    v_mov_b64 v[20:21], 0
    v_mov_b64 v[22:23], 0
    v_mov_b64 v[24:25], 0
    v_mov_b64 v[26:27], 0
    v_mov_b64 v[28:29], 0
    v_mov_b64 v[30:31], 0
    v_mov_b64 v[32:33], 0
    v_mov_b64 v[34:35], 0
    s_waitcnt lgkmcnt(0)
Lr3s_step:
    s_mov_b32 s16, 0
    s_mov_b64 s[70:71], 0
    s_mov_b64 s[72:73], 0
    s_mov_b64 s[74:75], 0
Lr3s_p2:
    s_mov_b64 exec, s[70:71]
    buffer_load_dwordx4 v[44:47], v0, s[8:11], s34 offen sc1
    s_mov_b64 exec, s[72:73]
    buffer_load_dwordx4 v[48:51], v0, s[8:11], s34 offen offset:1024 sc1
    s_mov_b64 exec, s[74:75]
    buffer_load_dword v10, v8, s[8:11], s35 offen sc1
    s_mov_b64 exec, -1
    s_add_u32 s16, s16, 1
    s_cmp_gt_u32 s16, 100000
    s_cbranch_scc1 Lr_abort
    s_waitcnt vmcnt(5)
    v_max3_u32 v11, v44, v45, v46
    v_max_u32 v11, v11, v47
    v_cmp_eq_u32 s[70:71], -1, v11
    s_waitcnt vmcnt(4)
    v_max3_u32 v11, v48, v49, v50
    v_max_u32 v11, v11, v51
    v_cmp_eq_u32 s[72:73], -1, v11
    s_waitcnt vmcnt(3)
    v_cmp_eq_u32 s[74:75], -1, v10
    s_or_b64 vcc, s[70:71], s[72:73]
    s_or_b64 vcc, vcc, s[74:75]
    s_cbranch_scc1 Lr3s_p2
    v_smfmac_f32_16x16x64_bf16 v[12:15], v[44:47], a[56:63], v1
    ds_write_b128 v0, v[44:47] offset:6144
    v_smfmac_f32_16x16x64_bf16 v[16:19], v[44:47], a[64:71], v1
    ds_write_b128 v0, v[48:51] offset:7168
    v_smfmac_f32_16x16x64_bf16 v[20:23], v[44:47], a[72:79], v1
    ds_write_b32 v8, v10 offset:8960
    v_smfmac_f32_16x16x64_bf16 v[24:27], v[44:47], v[56:63], v1
    s_waitcnt lgkmcnt(0)
    s_barrier
    ds_read_b128 v[52:55], v0 offset:0
    v_smfmac_f32_16x16x64_bf16 v[12:15], v[48:51], a[96:103], v1
    ds_read_b128 v[36:39], v0 offset:1024
    v_smfmac_f32_16x16x64_bf16 v[16:19], v[48:51], a[104:111], v1
    ds_read_b128 v[56:59], v9 offset:0
    v_smfmac_f32_16x16x64_bf16 v[20:23], v[48:51], a[112:119], v1
    ds_read_b128 v[60:63], v9 offset:1024
    v_smfmac_f32_16x16x64_bf16 v[24:27], v[48:51], v[64:71], v1
    ds_read_b128 v[40:43], v0 offset:2048
    s_waitcnt lgkmcnt(4)
    v_smfmac_f32_16x16x64_bf16 v[12:15], v[52:55], v[72:79], v1
    buffer_load_dword v6, v7, s[8:11], s67 offen sc1
    v_smfmac_f32_16x16x64_bf16 v[16:19], v[52:55], v[80:87], v1
    ds_read_b128 v[64:67], v9 offset:2048
    v_smfmac_f32_16x16x64_bf16 v[20:23], v[52:55], v[88:95], v1
    ds_read_b128 v[68:71], v9 offset:3072
    s_waitcnt lgkmcnt(3)
    v_smfmac_f32_16x16x64_bf16 v[24:27], v[52:55], v[56:63], v1
    v_smfmac_f32_16x16x64_bf16 v[12:15], v[36:39], v[112:119], v1
    ds_read_b128 v[52:55], v0 offset:3072
    v_smfmac_f32_16x16x64_bf16 v[16:19], v[36:39], v[120:127], v1
    ds_read_b128 v[56:59], v9 offset:4096
    v_smfmac_f32_16x16x64_bf16 v[20:23], v[36:39], v[128:135], v1
    ds_read_b128 v[60:63], v9 offset:5120
    s_waitcnt lgkmcnt(3)
    v_smfmac_f32_16x16x64_bf16 v[24:27], v[36:39], v[64:71], v1
    v_smfmac_f32_16x16x64_bf16 v[12:15], v[40:43], v[152:159], v1
    buffer_load_dwordx4 v[36:39], v0, s[8:11], s42 offen
    v_smfmac_f32_16x16x64_bf16 v[16:19], v[40:43], v[160:167], v1
    ds_read_b128 v[64:67], v9 offset:6144
    v_smfmac_f32_16x16x64_bf16 v[20:23], v[40:43], v[168:175], v1
    ds_read_b128 v[68:71], v9 offset:7168
    s_waitcnt lgkmcnt(2)
    v_smfmac_f32_16x16x64_bf16 v[24:27], v[40:43], v[56:63], v1
    s_waitcnt vmcnt(2)
    ds_read_b128 v[44:47], v0 offset:4096
    v_smfmac_f32_16x16x64_bf16 v[12:15], v[52:55], v[192:199], v1
    buffer_load_dwordx4 v[40:43], v0, s[8:11], s42 offen offset:1024
    v_smfmac_f32_16x16x64_bf16 v[16:19], v[52:55], v[200:207], v1
    ds_read_b128 v[56:59], v9 offset:8192
    v_smfmac_f32_16x16x64_bf16 v[20:23], v[52:55], v[208:215], v1
    ds_read_b128 v[60:63], v9 offset:9216
    s_waitcnt lgkmcnt(3)
    v_smfmac_f32_16x16x64_bf16 v[24:27], v[52:55], v[64:71], v1
    ds_read_b128 v[48:51], v0 offset:5120
    s_waitcnt lgkmcnt(3)
    v_smfmac_f32_16x16x64_bf16 v[12:15], v[44:47], v[232:239], v1
    ds_read_b128 v[52:55], v0 offset:8192
    v_smfmac_f32_16x16x64_bf16 v[16:19], v[44:47], v[240:247], v1
    ds_read_b128 v[64:67], v9 offset:10240
    v_smfmac_f32_16x16x64_bf16 v[20:23], v[44:47], v[248:255], v1
    ds_read_b128 v[68:71], v9 offset:11264
    s_waitcnt lgkmcnt(4)
    v_smfmac_f32_16x16x64_bf16 v[24:27], v[44:47], v[56:63], v1
    s_waitcnt lgkmcnt(3)
    v_smfmac_f32_16x16x64_bf16 v[12:15], v[48:51], a[16:23], v1
    v_smfmac_f32_16x16x64_bf16 v[16:19], v[48:51], a[24:31], v1
    ds_read_b128 v[56:59], v9 offset:16384
    s_waitcnt lgkmcnt(3)
    v_smfmac_f32_16x16x64_bf16 v[12:15], v[52:55], a[136:143], v1
    ds_read_b128 v[60:63], v9 offset:17408
    v_smfmac_f32_16x16x64_bf16 v[16:19], v[52:55], a[144:151], v1
    v_smfmac_f32_16x16x64_bf16 v[20:23], v[48:51], a[32:39], v1
    s_waitcnt lgkmcnt(2)
    v_smfmac_f32_16x16x64_bf16 v[24:27], v[48:51], v[64:71], v1
    ds_read_b128 v[64:67], v0 offset:9216
    s_nop 1
    v_add_f32 v12, v12, v14
    v_smfmac_f32_16x16x64_bf16 v[20:23], v[52:55], a[152:159], v1
    ds_read_b128 v[68:71], v0 offset:10240
    v_add_f32 v16, v16, v18
    s_waitcnt lgkmcnt(2)
    v_smfmac_f32_16x16x64_bf16 v[24:27], v[52:55], v[56:63], v1
    ds_read_b128 v[56:59], v0 offset:11264
    v_add_f32 v13, v13, v15
    v_add_f32 v17, v17, v19
    v_cvt_pk_bf16_f32 v14, v12, v16
    v_cvt_pk_bf16_f32 v15, v13, v17
    ds_write_b32 v2, v14 offset:17408
    ds_write_b32 v2, v15 offset:17696
    v_smfmac_f32_16x16x64_bf16 v[28:31], v[52:55], a[160:167], v1
    ds_read_b128 v[60:63], v0 offset:12288
    v_add_f32 v20, v20, v22
    v_add_f32 v24, v24, v26
    v_add_f32 v21, v21, v23
    v_add_f32 v25, v25, v27
    v_smfmac_f32_16x16x64_bf16 v[32:35], v[52:55], a[168:175], v1
    ds_read_b128 v[12:15], v0 offset:6144
    v_cvt_pk_bf16_f32 v22, v20, v24
    v_cvt_pk_bf16_f32 v23, v21, v25
    ds_write_b32 v2, v22 offset:19712
    ds_write_b32 v2, v23 offset:20000
    v_smfmac_f32_16x16x64_bf16 v[28:31], v[48:51], a[40:47], v1
    ds_read_b128 v[16:19], v0 offset:7168
    v_smfmac_f32_16x16x64_bf16 v[32:35], v[48:51], a[48:55], v1
    ds_read_b128 v[20:23], v0 offset:0
    v_smfmac_f32_16x16x64_bf16 v[28:31], v[44:47], a[0:7], v1
    ds_read_b128 v[24:27], v0 offset:1024
    v_smfmac_f32_16x16x64_bf16 v[32:35], v[44:47], a[8:15], v1
    s_waitcnt lgkmcnt(3)
    s_barrier
    ds_read_b128 v[44:47], v3 offset:17408
    v_smfmac_f32_16x16x64_bf16 v[28:31], v[12:15], a[80:87], v1
    ds_read_b128 v[52:55], v0 offset:2048
    v_smfmac_f32_16x16x64_bf16 v[32:35], v[12:15], a[88:95], v1
    ds_read_b128 v[12:15], v3 offset:19712
    s_waitcnt lgkmcnt(5)
    v_smfmac_f32_16x16x64_bf16 v[28:31], v[16:19], a[120:127], v1
    ds_read_b128 v[48:51], v0 offset:3072
    v_smfmac_f32_16x16x64_bf16 v[32:35], v[16:19], a[128:135], v1
    s_waitcnt lgkmcnt(5)
    v_smfmac_f32_16x16x64_bf16 v[28:31], v[20:23], v[96:103], v1
    v_smfmac_f32_16x16x64_bf16 v[32:35], v[20:23], v[104:111], v1
    ds_read_b128 v[20:23], v3 offset:17472
    s_waitcnt lgkmcnt(5)
    v_smfmac_f32_16x16x64_bf16 v[28:31], v[24:27], v[136:143], v1
    v_smfmac_f32_16x16x64_bf16 v[32:35], v[24:27], v[144:151], v1
    s_waitcnt lgkmcnt(3)
    v_smfmac_f32_16x16x64_bf16 v[28:31], v[52:55], v[176:183], v1
    v_smfmac_f32_16x16x64_bf16 v[32:35], v[52:55], v[184:191], v1
    ds_read_b128 v[52:55], v3 offset:19776
    s_waitcnt lgkmcnt(2)
    v_smfmac_f32_16x16x64_bf16 v[28:31], v[48:51], v[216:223], v1
    v_smfmac_f32_16x16x64_bf16 v[32:35], v[48:51], v[224:231], v1
    ds_read_b128 v[48:51], v3 offset:17536
    v_mfma_f32_16x16x32_bf16 v[24:27], v[12:15], v[44:47], 0
    s_waitcnt vmcnt(2)
    v_cmp_eq_u32 vcc, 0, v6
    s_nop 0
    s_and_b64 vcc, vcc, s[78:79]
    s_cbranch_scc1 Lr3s_flbad
Lr3s_flok:
    s_mov_b32 m0, 24320
    s_nop 0
    buffer_load_dword v5, s[8:11], s40 offen lds
    buffer_load_dword v5, s[8:11], s56 offen lds
    s_mov_b32 m0, 15360
    v_mfma_f32_16x16x32_bf16 v[12:15], v[64:67], v[44:47], 0
    ds_read_b128 v[64:67], v0 offset:13312
    v_mfma_f32_16x16x32_bf16 v[16:19], v[68:71], v[44:47], 0
    ds_read_b128 v[68:71], v0 offset:14336
    s_waitcnt lgkmcnt(3)
    v_mfma_f32_16x16x32_bf16 v[24:27], v[52:55], v[20:23], v[24:27]
    ds_read_b128 v[44:47], v3 offset:19840
    v_add_f32 v28, v28, v30
    v_add_f32 v29, v29, v31
    v_mfma_f32_16x16x32_bf16 v[12:15], v[56:59], v[20:23], v[12:15]
    ds_read_b128 v[52:55], v3 offset:17600
    v_add_f32 v32, v32, v34
    v_add_f32 v33, v33, v35
    v_mfma_f32_16x16x32_bf16 v[16:19], v[60:63], v[20:23], v[16:19]
    ds_read_b128 v[56:59], v0 offset:15360
    v_cvt_pk_bf16_f32 v30, v28, v29
    v_cvt_pk_bf16_f32 v31, v32, v33
    s_waitcnt lgkmcnt(2)
    v_mfma_f32_16x16x32_bf16 v[24:27], v[44:47], v[48:51], v[24:27]
    ds_read_b128 v[20:23], v3 offset:19904
    v_lshrrev_b32 v10, 8, v0
    v_mul_u32_u24 v10, 288, v10
    v_mfma_f32_16x16x32_bf16 v[12:15], v[64:67], v[48:51], v[12:15]
    ds_read_b128 v[60:63], v0 offset:16384
    v_and_b32 v11, 0xf0, v0
    v_add_u32 v10, v10, v11
    v_mfma_f32_16x16x32_bf16 v[16:19], v[68:71], v[48:51], v[16:19]
    ds_read_b128 v[32:35], v10 offset:21440
    v_lshrrev_b32 v11, 1, v0
    v_bfi_b32 v30, 1, s66, v30
    s_waitcnt lgkmcnt(2)
    v_mfma_f32_16x16x32_bf16 v[24:27], v[20:23], v[52:55], v[24:27]
    buffer_store_dwordx2 v[30:31], v11, s[8:11], s43 offen offset:2048 sc1
    v_mov_b32 v49, 0
    v_mov_b32 v50, 0
    v_mfma_f32_16x16x32_bf16 v[12:15], v[56:59], v[52:55], v[12:15]
    v_mov_b64 v[64:65], s[68:69]
    v_mov_b64 v[66:67], s[68:69]
    s_waitcnt lgkmcnt(1)
    v_mfma_f32_16x16x32_bf16 v[16:19], v[60:63], v[52:55], v[16:19]
    s_waitcnt lgkmcnt(0)
    v_bfi_b32 v32, 1, s66, v32
    s_mov_b64 exec, s[52:53]
    buffer_store_dwordx4 v[32:35], v0, s[8:11], s43 offen sc1
    s_mov_b64 exec, -1
    v_max3_f32 v10, v24, v25, v12
    v_max3_f32 v10, v10, v13, v14
    s_nop 0
    v_max3_f32 v10, v10, v15, v16
    v_max3_f32 v10, v10, v17, v18
    v_max_f32 v10, v10, v19
    v_mov_b32 v11, v10
    s_nop 1
    v_permlane32_swap_b32 v10, v11
    v_max_f32 v10, v10, v11
    v_mov_b32 v11, v10
    s_nop 1
    v_permlane16_swap_b32 v10, v11
    v_max_f32 v10, v10, v11
    v_mul_f32 v20, s46, v10
    v_pk_fma_f32 v[24:25], v[24:25], s[46:47], v[20:21] op_sel_hi:[1,1,0] neg_lo:[0,0,1] neg_hi:[0,0,1]
    v_pk_fma_f32 v[12:13], v[12:13], s[46:47], v[20:21] op_sel_hi:[1,1,0] neg_lo:[0,0,1] neg_hi:[0,0,1]
    v_exp_f32 v24, v24
    v_exp_f32 v25, v25
    v_pk_fma_f32 v[14:15], v[14:15], s[46:47], v[20:21] op_sel_hi:[1,1,0] neg_lo:[0,0,1] neg_hi:[0,0,1]
    v_exp_f32 v12, v12
    v_exp_f32 v13, v13
    v_pk_fma_f32 v[16:17], v[16:17], s[46:47], v[20:21] op_sel_hi:[1,1,0] neg_lo:[0,0,1] neg_hi:[0,0,1]
    v_cvt_pk_bf16_f32 v48, v24, v25
    v_exp_f32 v14, v14
    v_pk_fma_f32 v[18:19], v[18:19], s[46:47], v[20:21] op_sel_hi:[1,1,0] neg_lo:[0,0,1] neg_hi:[0,0,1]
    v_cvt_pk_bf16_f32 v51, v24, v25
    v_exp_f32 v15, v15
    v_cvt_pk_bf16_f32 v44, v12, v13
    v_exp_f32 v16, v16
    v_exp_f32 v17, v17
    v_cvt_pk_bf16_f32 v45, v14, v15
    v_exp_f32 v18, v18
    v_exp_f32 v19, v19
    v_cvt_pk_bf16_f32 v46, v16, v17
    v_cvt_pk_bf16_f32 v47, v18, v19
    v_mfma_f32_16x16x16_bf16 v[68:71], v[64:65], v[48:49], 0
    v_mfma_f32_16x16x16_bf16 v[52:55], v[30:31], v[48:49], 0
    v_mfma_f32_16x16x16_bf16 v[56:59], v[30:31], v[50:51], 0
    v_mfma_f32_16x16x32_bf16 v[68:71], v[64:67], v[44:47], v[68:71]
    s_waitcnt vmcnt(5)
    v_mfma_f32_16x16x32_bf16 v[52:55], v[36:39], v[44:47], v[52:55]
    s_waitcnt vmcnt(4)
    v_mfma_f32_16x16x32_bf16 v[56:59], v[40:43], v[44:47], v[56:59]
    ds_read_b128 v[36:39], v0 offset:55296
    ds_read_b128 v[40:43], v0 offset:56320
    ds_read_b128 v[60:63], v9 offset:24576
    s_nop 0
    v_rcp_f32 v10, v68
    s_nop 0
    v_pk_mul_f32 v[52:53], v[52:53], v[10:11] op_sel_hi:[1,0]
    s_nop 0
    v_pk_mul_f32 v[56:57], v[56:57], v[10:11] op_sel_hi:[1,0]
    v_cvt_pk_bf16_f32 v16, v52, v56
    v_cvt_pk_bf16_f32 v17, v53, v57
    v_pk_mul_f32 v[54:55], v[54:55], v[10:11] op_sel_hi:[1,0]
    v_pk_mul_f32 v[58:59], v[58:59], v[10:11] op_sel_hi:[1,0]
    v_cvt_pk_bf16_f32 v18, v54, v58
    v_cvt_pk_bf16_f32 v19, v55, v59
    ds_write_b128 v3, v[16:19] offset:22208
    ds_read_b128 v[64:67], v9 offset:25600
    v_mov_b64 v[12:13], 0
    v_mov_b64 v[14:15], 0
    v_mov_b64 v[20:21], 0
    v_mov_b64 v[22:23], 0
    v_mov_b64 v[24:25], 0
    v_mov_b64 v[26:27], 0
    v_mov_b64 v[32:33], 0
    v_mov_b64 v[34:35], 0
    v_mov_b64 v[44:45], 0
    v_mov_b64 v[46:47], 0
    v_mov_b64 v[48:49], 0
    v_mov_b64 v[50:51], 0
    s_waitcnt lgkmcnt(1)
    s_barrier
    ds_read_b128 v[52:55], v4 offset:22016
    ds_read_b128 v[56:59], v4 offset:22144
    v_mov_b64 v[68:69], 0
    v_mov_b64 v[70:71], 0
    v_mov_b64 v[28:29], 0
    v_mov_b64 v[30:31], 0
    v_mov_b64 v[16:17], 0
    v_mov_b64 v[18:19], 0
    s_cmp_eq_u32 s33, 63
    s_cbranch_scc1 Lr3s_last
    s_waitcnt lgkmcnt(1)
    v_smfmac_f32_16x16x64_bf16 v[28:31], v[52:55], v[60:67], v1
    ds_read_b128 v[60:63], v0 offset:49152
    s_waitcnt lgkmcnt(1)
    v_smfmac_f32_16x16x64_bf16 v[28:31], v[56:59], v[36:43], v1
    ds_read_b128 v[64:67], v0 offset:50176
    ds_read_b128 v[36:39], v9 offset:18432
    v_smfmac_f32_16x16x64_bf16 v[12:15], v[52:55], a[176:183], v1
    ds_read_b128 v[40:43], v9 offset:19456
    v_smfmac_f32_16x16x64_bf16 v[12:15], v[56:59], a[184:191], v1
    buffer_load_dwordx4 v0, s[8:11], s41 offen offset:0 lds
    v_smfmac_f32_16x16x64_bf16 v[20:23], v[52:55], a[192:199], v1
    s_nop 0
    v_add_f32 v28, v28, v30
    v_add_f32 v29, v29, v31
    s_waitcnt lgkmcnt(2)
    v_smfmac_f32_16x16x64_bf16 v[20:23], v[56:59], v[60:67], v1
    ds_read_b128 v[60:63], v9 offset:20480
    v_cvt_pk_bf16_f32 v28, v28, v29
    v_bfi_b32 v28, 1, s39, v28
    buffer_store_dword v28, v8, s[8:11], s38 offen offset:2048 sc1
    s_waitcnt lgkmcnt(1)
    v_smfmac_f32_16x16x64_bf16 v[24:27], v[52:55], v[36:43], v1
    ds_read_b128 v[64:67], v9 offset:21504
    ds_read_b128 v[36:39], v0 offset:51200
    v_add_f32 v12, v12, v14
    v_add_f32 v13, v13, v15
    v_smfmac_f32_16x16x64_bf16 v[24:27], v[56:59], a[200:207], v1
    ds_read_b128 v[40:43], v0 offset:52224
    v_cvt_pk_bf16_f32 v12, v12, v13
    v_bfi_b32 v12, 1, s39, v12
    v_smfmac_f32_16x16x64_bf16 v[32:35], v[52:55], a[208:215], v1
    buffer_load_dwordx4 v0, s[8:11], s41 offen offset:1024 lds
    v_add_f32 v20, v20, v22
    v_add_f32 v21, v21, v23
    v_smfmac_f32_16x16x64_bf16 v[32:35], v[56:59], a[216:223], v1
    v_cvt_pk_bf16_f32 v13, v20, v21
    s_waitcnt lgkmcnt(2)
    v_smfmac_f32_16x16x64_bf16 v[44:47], v[52:55], v[60:67], v1
    ds_read_b128 v[60:63], v0 offset:53248
    v_add_f32 v24, v24, v26
    v_add_f32 v25, v25, v27
    s_waitcnt lgkmcnt(1)
    v_smfmac_f32_16x16x64_bf16 v[44:47], v[56:59], v[36:43], v1
    ds_read_b128 v[64:67], v0 offset:54272
    ds_read_b128 v[36:39], v9 offset:22528
    v_cvt_pk_bf16_f32 v14, v24, v25
    v_smfmac_f32_16x16x64_bf16 v[48:51], v[52:55], a[224:231], v1
    ds_read_b128 v[40:43], v9 offset:23552
    v_add_f32 v32, v32, v34
    v_add_f32 v33, v33, v35
    v_smfmac_f32_16x16x64_bf16 v[48:51], v[56:59], a[232:239], v1
    v_cvt_pk_bf16_f32 v15, v32, v33
    buffer_store_dwordx4 v[12:15], v0, s[8:11], s38 offen offset:0 sc1
    v_smfmac_f32_16x16x64_bf16 v[68:71], v[52:55], a[240:247], v1
    v_add_f32 v44, v44, v46
    v_add_f32 v45, v45, v47
    s_waitcnt lgkmcnt(2)
    v_smfmac_f32_16x16x64_bf16 v[68:71], v[56:59], v[60:67], v1
    v_cvt_pk_bf16_f32 v44, v44, v45
    v_bfi_b32 v44, 1, s39, v44
    s_waitcnt lgkmcnt(0)
    v_smfmac_f32_16x16x64_bf16 v[16:19], v[52:55], v[36:43], v1
    v_add_f32 v48, v48, v50
    v_add_f32 v49, v49, v51
    v_smfmac_f32_16x16x64_bf16 v[16:19], v[56:59], a[248:255], v1
    v_cvt_pk_bf16_f32 v45, v48, v49
    v_add_f32 v68, v68, v70
    v_add_f32 v69, v69, v71
    v_cvt_pk_bf16_f32 v46, v68, v69
    s_nop 3
    v_add_f32 v16, v16, v18
    v_add_f32 v17, v17, v19
    v_cvt_pk_bf16_f32 v47, v16, v17
    buffer_store_dwordx4 v[44:47], v0, s[8:11], s38 offen offset:1024 sc1
    s_xor_b32 s34, s34, 16384
    s_xor_b32 s35, s35, 16384
    s_barrier
    s_sleep 2
    buffer_load_dwordx4 v[44:47], v0, s[8:11], s34 offen sc1
    buffer_load_dwordx4 v[48:51], v0, s[8:11], s34 offen offset:1024 sc1
    buffer_load_dword v10, v8, s[8:11], s35 offen sc1
    s_add_u32 s33, s33, 1
    s_bfe_u32 s39, s33, 0x10001
    s_xor_b32 s38, s38, 524288
    s_and_b32 s17, s33, 7
    s_mul_i32 s17, s17, 131072
    s_add_u32 s43, s45, s17
    s_bfe_u32 s66, s33, 65539
    s_add_u32 s67, s67, 22528
    s_and_b32 s17, s33, 3
    s_cmp_eq_u32 s17, 3
    s_cselect_b32 s17, 1, 0
    s_cmp_eq_u32 s32, 0
    s_cselect_b32 s17, 1, s17
    s_cmp_ge_u32 s33, 7
    s_cselect_b32 s17, s17, 0
    s_cmp_lg_u32 s17, 0
    s_cselect_b64 s[78:79], -1, 0xff
    s_add_u32 s56, s56, 262144
    s_add_u32 s42, s42, 262144
    s_add_u32 s41, s41, 262144
    s_add_u32 s40, s40, 262144
    s_add_u32 s44, s44, 22528
    ds_read_b128 v[56:59], v9 offset:12288
    ds_read_b128 v[60:63], v9 offset:13312
    ds_read_b128 v[64:67], v9 offset:14336
    ds_read_b128 v[68:71], v9 offset:15360
    v_mov_b64 v[12:13], 0
    v_mov_b64 v[14:15], 0
    v_mov_b64 v[16:17], 0
    v_mov_b64 v[18:19], 0
    v_mov_b64 v[20:21], 0
    v_mov_b64 v[22:23], 0
    v_mov_b64 v[24:25], 0
    v_mov_b64 v[26:27], 0
    v_mov_b64 v[28:29], 0
    v_mov_b64 v[30:31], 0
    v_mov_b64 v[32:33], 0
    v_mov_b64 v[34:35], 0
    s_waitcnt lgkmcnt(0)
    s_branch Lr3s_step
Lr3s_flbad:
    s_cmp_eq_u32 s33, 63
    s_cbranch_scc1 Lr3s_flok
    s_mov_b32 s16, 0
Lr3s_flp:
    buffer_load_dword v6, v7, s[8:11], s67 offen sc1
    s_add_u32 s16, s16, 1
    s_cmp_gt_u32 s16, 100000
    s_cbranch_scc1 Lr_abort
    s_waitcnt vmcnt(0)
    v_cmp_eq_u32 vcc, 0, v6
    s_nop 0
    s_and_b64 vcc, vcc, s[78:79]
    s_cbranch_scc1 Lr3s_flp
    s_branch Lr3s_flok
Lr3s_last:
    s_waitcnt vmcnt(0) lgkmcnt(0)
    s_branch Lr_exit
Lr_abort:
    s_waitcnt lgkmcnt(0)
    s_mov_b64 exec, -1
    v_mov_b32 v0, 60
    s_lshl_b32 s5, s3, 8
    s_or_b32 s5, s5, s4
    s_or_b32 s5, s5, 0x10000
    v_mov_b32 v1, s5
    global_store_dword v0, v1, s[12:13]
    s_endpgm
Lr_exit:
    s_add_u32 s6, s15, s14
    s_cmp_lg_u32 s6, 0
    s_cbranch_scc1 Lr_nowb
    s_waitcnt vmcnt(0)
    buffer_wbl2 sc1
    s_waitcnt vmcnt(0)
Lr_nowb:
    s_endpgm
.section .rodata,"a"
.p2align 6
.amdhsa_kernel interleave_layers__sliding_local_dilated__memory_aug_recurrent_mem_tr__prompt_kernel
  .amdhsa_next_free_vgpr 512
  .amdhsa_next_free_sgpr 102
  .amdhsa_accum_offset 256
  .amdhsa_group_segment_fixed_size 0
  .amdhsa_kernarg_size 104
  .amdhsa_user_sgpr_count 2
  .amdhsa_user_sgpr_kernarg_segment_ptr 1
  .amdhsa_system_sgpr_workgroup_id_x 1
.end_amdhsa_kernel
```

```asm
; @launch grid=(256,1,1) block=(256,1,1) lds=163840
.amdgcn_target "amdgcn-amd-amdhsa--gfx950"
.text
.globl interleave_layers__sliding_local_dilated__memory_aug_recurrent_mem_tr__prompt_kernel
.p2align 8
.type interleave_layers__sliding_local_dilated__memory_aug_recurrent_mem_tr__prompt_kernel,@function
interleave_layers__sliding_local_dilated__memory_aug_recurrent_mem_tr__prompt_kernel:
    s_cmp_ge_u32 s2, 256
    s_cbranch_scc1 L_exit
    s_load_dwordx2 s[8:9], s[0:1], 96
    s_mov_b32 s10, 268435456
    s_mov_b32 s11, 0x00020000
    s_waitcnt lgkmcnt(0)
    s_and_b32 s9, s9, 0xffff
    s_load_dwordx2 s[12:13], s[0:1], 88
    v_lshrrev_b32 v1, 6, v0
    s_getreg_b32 s3, hwreg(HW_REG_XCC_ID)
    v_readfirstlane_b32 s14, v1
    s_and_b32 s3, s3, 7
    s_and_b32 s17, s3, 1
    s_lshl_b32 s17, s17, 7
    s_lshl_b32 s18, s3, 1
    s_and_b32 s18, s18, 12
    s_add_u32 s17, s17, s18
    v_mov_b32 v2, 0
    v_mov_b32 v3, 1
    v_mov_b32 v4, s17
    s_mov_b32 s33, 0
    s_waitcnt lgkmcnt(0)
    s_cmp_lg_u32 s14, 0
    s_cbranch_scc1 L_tk_wait
    s_mov_b64 exec, 1
    global_atomic_add v3, v4, v3, s[12:13] sc0
    s_waitcnt vmcnt(0)
    v_readfirstlane_b32 s4, v3
    s_nop 0
    s_cmp_lt_u32 s4, 32
    s_cbranch_scc1 L_tk_have
    v_mov_b32 v3, 1
    v_mov_b32 v4, 32
    global_atomic_add v3, v4, v3, s[12:13] sc0
    s_waitcnt vmcnt(0)
    v_readfirstlane_b32 s5, v3
    s_mov_b64 exec, 0xff
    v_and_b32 v4, 1, v0
    v_lshlrev_b32 v4, 7, v4
    v_lshlrev_b32 v5, 1, v0
    v_and_or_b32 v4, v5, 12, v4
    s_mov_b32 s16, 0
L_hl_poll:
    global_load_dword v5, v4, s[12:13] sc1
    s_add_u32 s16, s16, 1
    s_cmp_gt_u32 s16, 100000
    s_cbranch_scc1 L_abort
    s_mov_b32 s6, 0
    s_waitcnt vmcnt(0)
    v_readlane_b32 s40, v5, 0
    s_nop 0
    s_add_u32 s6, s6, s40
    v_readlane_b32 s41, v5, 1
    s_nop 0
    s_add_u32 s6, s6, s41
    v_readlane_b32 s42, v5, 2
    s_nop 0
    s_add_u32 s6, s6, s42
    v_readlane_b32 s43, v5, 3
    s_nop 0
    s_add_u32 s6, s6, s43
    v_readlane_b32 s44, v5, 4
    s_nop 0
    s_add_u32 s6, s6, s44
    v_readlane_b32 s45, v5, 5
    s_nop 0
    s_add_u32 s6, s6, s45
    v_readlane_b32 s46, v5, 6
    s_nop 0
    s_add_u32 s6, s6, s46
    v_readlane_b32 s47, v5, 7
    s_nop 0
    s_add_u32 s6, s6, s47
    s_cmp_lt_u32 s6, 256
    s_cbranch_scc1 L_hl_poll
    s_mov_b32 s3, 0
    s_mov_b32 s4, 0
    s_min_u32 s6, s47, 32
    s_sub_u32 s7, 32, s6
    s_cmp_lt_u32 s5, s7
    s_cselect_b32 s3, 7, s3
    s_add_u32 s6, s6, s5
    s_cmp_lt_u32 s5, s7
    s_cselect_b32 s4, s6, s4
    s_sub_u32 s5, s5, s7
    s_min_u32 s6, s46, 32
    s_sub_u32 s7, 32, s6
    s_cmp_lt_u32 s5, s7
    s_cselect_b32 s3, 6, s3
    s_add_u32 s6, s6, s5
    s_cmp_lt_u32 s5, s7
    s_cselect_b32 s4, s6, s4
    s_sub_u32 s5, s5, s7
    s_min_u32 s6, s45, 32
    s_sub_u32 s7, 32, s6
    s_cmp_lt_u32 s5, s7
    s_cselect_b32 s3, 5, s3
    s_add_u32 s6, s6, s5
    s_cmp_lt_u32 s5, s7
    s_cselect_b32 s4, s6, s4
    s_sub_u32 s5, s5, s7
    s_min_u32 s6, s44, 32
    s_sub_u32 s7, 32, s6
    s_cmp_lt_u32 s5, s7
    s_cselect_b32 s3, 4, s3
    s_add_u32 s6, s6, s5
    s_cmp_lt_u32 s5, s7
    s_cselect_b32 s4, s6, s4
    s_sub_u32 s5, s5, s7
    s_min_u32 s6, s43, 32
    s_sub_u32 s7, 32, s6
    s_cmp_lt_u32 s5, s7
    s_cselect_b32 s3, 3, s3
    s_add_u32 s6, s6, s5
    s_cmp_lt_u32 s5, s7
    s_cselect_b32 s4, s6, s4
    s_sub_u32 s5, s5, s7
    s_min_u32 s6, s42, 32
    s_sub_u32 s7, 32, s6
    s_cmp_lt_u32 s5, s7
    s_cselect_b32 s3, 2, s3
    s_add_u32 s6, s6, s5
    s_cmp_lt_u32 s5, s7
    s_cselect_b32 s4, s6, s4
    s_sub_u32 s5, s5, s7
    s_min_u32 s6, s41, 32
    s_sub_u32 s7, 32, s6
    s_cmp_lt_u32 s5, s7
    s_cselect_b32 s3, 1, s3
    s_add_u32 s6, s6, s5
    s_cmp_lt_u32 s5, s7
    s_cselect_b32 s4, s6, s4
    s_sub_u32 s5, s5, s7
    s_min_u32 s6, s40, 32
    s_sub_u32 s7, 32, s6
    s_cmp_lt_u32 s5, s7
    s_cselect_b32 s3, 0, s3
    s_add_u32 s6, s6, s5
    s_cmp_lt_u32 s5, s7
    s_cselect_b32 s4, s6, s4
    s_sub_u32 s5, s5, s7
L_tk_have:
    s_lshl_b32 s5, s3, 8
    s_or_b32 s5, s5, s4
    v_mov_b32 v3, s5
    s_mov_b64 exec, 1
    ds_write_b32 v2, v3
    s_mov_b64 exec, -1
L_tk_wait:
    s_waitcnt vmcnt(0) lgkmcnt(0)
    s_barrier
    ds_read_b32 v3, v2
    s_waitcnt lgkmcnt(0)
    v_readfirstlane_b32 s5, v3
    s_nop 0
    s_lshr_b32 s3, s5, 8
    s_and_b32 s4, s5, 255
    s_barrier
    s_cmp_lt_u32 s3, 2
    s_cbranch_scc1 L_role_r
    s_cmp_lg_u32 s3, 2
    s_cbranch_scc1 L_ii2_no
    s_cmp_lt_u32 s4, 32
    s_cbranch_scc1 L_noinit
L_ii2_no:
    s_cmp_lg_u32 s3, 3
    s_cbranch_scc1 L_ii3_no
    s_cmp_lt_u32 s4, 16
    s_cbranch_scc1 L_noinit
    s_cmp_lt_u32 s4, 32
    s_add_u32 s6, s4, 4294967280
    s_cmp_lt_u32 s4, 32
    s_cbranch_scc1 L_doinit
L_ii3_no:
    s_cmp_lg_u32 s3, 4
    s_cbranch_scc1 L_ii4_no
    s_cmp_lt_u32 s4, 21
    s_cbranch_scc1 L_noinit
    s_cmp_lt_u32 s4, 32
    s_add_u32 s6, s4, 4294967291
    s_cmp_lt_u32 s4, 32
    s_cbranch_scc1 L_doinit
L_ii4_no:
    s_cmp_lg_u32 s3, 5
    s_cbranch_scc1 L_ii5_no
    s_cmp_lt_u32 s4, 32
    s_add_u32 s6, s4, 27
    s_cmp_lt_u32 s4, 32
    s_cbranch_scc1 L_doinit
L_ii5_no:
    s_cmp_lg_u32 s3, 6
    s_cbranch_scc1 L_ii6_no
    s_cmp_lt_u32 s4, 32
    s_add_u32 s6, s4, 59
    s_cmp_lt_u32 s4, 32
    s_cbranch_scc1 L_doinit
L_ii6_no:
    s_cmp_lg_u32 s3, 7
    s_cbranch_scc1 L_ii7_no
    s_cmp_lt_u32 s4, 32
    s_add_u32 s6, s4, 91
    s_cmp_lt_u32 s4, 32
    s_cbranch_scc1 L_doinit
L_ii7_no:
    s_endpgm
L_doinit:
    s_load_dwordx2 s[20:21], s[0:1], 0
    s_mov_b32 s22, 2359296
    s_mov_b32 s23, 0x00020000
    s_waitcnt lgkmcnt(0)
    s_and_b32 s21, s21, 0xffff
    v_lshlrev_b32 v7, 4, v0
    v_mov_b32 v12, 0
    v_mov_b32 v13, 0
    v_mov_b32 v14, 0
    v_mov_b32 v15, 0
    s_mov_b32 s46, s6
Li_loop:
    s_cmp_ge_u32 s46, 136
    s_cbranch_scc1 Li_nofl
    s_mul_i32 s41, s46, 22528
    s_add_u32 s41, s41, 180224
    s_sub_u32 s42, s46, 128
    s_lshl_b32 s42, s42, 12
    s_add_u32 s42, s42, 3080192
    s_cmp_ge_u32 s46, 128
    s_cselect_b32 s41, s42, s41
    buffer_store_dwordx4 v[12:15], v7, s[8:11], s41 offen sc1
    s_cbranch_scc1 Li_nofl
    s_add_u32 s41, s41, 4096
    buffer_store_dwordx4 v[12:15], v7, s[8:11], s41 offen sc1
    s_add_u32 s41, s41, 4096
    buffer_store_dwordx4 v[12:15], v7, s[8:11], s41 offen sc1
    s_add_u32 s41, s41, 4096
    buffer_store_dwordx4 v[12:15], v7, s[8:11], s41 offen sc1
    s_add_u32 s41, s41, 4096
    buffer_store_dwordx4 v[12:15], v7, s[8:11], s41 offen sc1
    s_add_u32 s41, s41, 4096
    v_cmp_gt_u32 vcc, 128, v0
    s_nop 0
    s_and_saveexec_b64 s[42:43], vcc
    s_cbranch_execz Li_fl5
    buffer_store_dwordx4 v[12:15], v7, s[8:11], s41 offen sc1
Li_fl5:
    s_mov_b64 exec, s[42:43]
Li_nofl:
    s_cmp_ge_u32 s46, 64
    s_cbranch_scc1 Li_rest
    s_mul_i32 s42, s46, 6144
    s_add_u32 s42, s42, 15728640
    s_add_u32 s43, s42, 2048
    buffer_store_dwordx4 v[12:15], v7, s[8:11], s43 offen sc1
    s_branch Li_done
Li_rest:
    s_cmp_ge_u32 s46, 192
    s_cbranch_scc1 Li_done
    s_sub_u32 s41, s46, 64
    s_lshr_b32 s42, s41, 6
    s_and_b32 s41, s41, 63
    s_mul_i32 s42, s42, 786432
    s_mul_i32 s41, s41, 6144
    s_add_u32 s41, s41, s42
    s_add_u32 s41, s41, 16126464
    v_cmp_gt_u32 vcc, 96, v0
    s_nop 0
    s_and_saveexec_b64 s[44:45], vcc
    s_cbranch_execz Li_rest2
    buffer_store_dwordx4 v[12:15], v7, s[8:11], s41 offen sc1
Li_rest2:
    s_mov_b64 exec, s[44:45]
Li_done:
    s_add_u32 s46, s46, 123
    s_cmp_lt_u32 s46, 192
    s_cbranch_scc1 Li_loop
    v_and_b32 v1, 31, v0
    v_lshrrev_b32 v2, 5, v0
    v_mul_u32_u24 v3, 1152, v1
    v_mul_u32_u24 v5, 144, v2
    v_add_u32 v3, v3, v5
    s_sub_u32 s47, s6, 59
    s_mul_i32 s41, s47, 36864
    s_cmp_lt_u32 s6, 59
    s_cselect_b32 s41, 0x7f000000, s41
    buffer_load_dwordx4 v[64:67], v3, s[20:23], s41 offen offset:0
    buffer_load_dwordx4 v[68:71], v3, s[20:23], s41 offen offset:16
    buffer_load_dwordx4 v[72:75], v3, s[20:23], s41 offen offset:32
    buffer_load_dwordx4 v[76:79], v3, s[20:23], s41 offen offset:48
    buffer_load_dwordx4 v[80:83], v3, s[20:23], s41 offen offset:64
    buffer_load_dwordx4 v[84:87], v3, s[20:23], s41 offen offset:80
    buffer_load_dwordx4 v[88:91], v3, s[20:23], s41 offen offset:96
    buffer_load_dwordx4 v[92:95], v3, s[20:23], s41 offen offset:112
    buffer_load_dwordx4 v[96:99], v3, s[20:23], s41 offen offset:128
    s_waitcnt vmcnt(9)
    s_barrier
    s_cmp_lg_u32 s14, 0
    s_cbranch_scc1 Li_mid
    v_mov_b32 v2, 160
    v_mov_b32 v3, 1
    s_mov_b64 exec, 1
    global_atomic_add v2, v3, s[12:13]
    s_mov_b64 exec, -1
Li_mid:
    s_cmp_lt_u32 s6, 59
    s_cbranch_scc1 Li_end
    s_waitcnt vmcnt(0)
    v_and_b32 v1, 31, v0
    v_lshrrev_b32 v2, 5, v0
    v_mul_u32_u24 v4, 4608, v2
    v_lshl_add_u32 v4, v1, 4, v4
    s_mul_i32 s41, s47, 36864
    s_add_u32 s41, s41, 6291456
    s_mul_i32 s42, s47, 6144
    s_add_u32 s42, s42, 15728640
    v_mov_b32 v60, 0
    v_mov_b32 v61, 0
    buffer_store_dwordx4 v[64:67], v4, s[8:11], s41 offen offset:0 sc1
    buffer_store_dwordx4 v[68:71], v4, s[8:11], s41 offen offset:512 sc1
    buffer_store_dwordx4 v[72:75], v4, s[8:11], s41 offen offset:1024 sc1
    buffer_store_dwordx4 v[76:79], v4, s[8:11], s41 offen offset:1536 sc1
    buffer_store_dwordx4 v[80:83], v4, s[8:11], s41 offen offset:2048 sc1
    buffer_store_dwordx4 v[84:87], v4, s[8:11], s41 offen offset:2560 sc1
    buffer_store_dwordx4 v[88:91], v4, s[8:11], s41 offen offset:3072 sc1
    buffer_store_dwordx4 v[92:95], v4, s[8:11], s41 offen offset:3584 sc1
    v_add_u32 v4, 4096, v4
    buffer_store_dwordx4 v[96:99], v4, s[8:11], s41 offen offset:0 sc1
    v_mov_b32 v62, 0x3f803f80
    v_dot2c_f32_bf16 v60, v64, v62
    v_dot2c_f32_bf16 v61, v64, v64
    v_dot2c_f32_bf16 v60, v65, v62
    v_dot2c_f32_bf16 v61, v65, v65
    v_dot2c_f32_bf16 v60, v66, v62
    v_dot2c_f32_bf16 v61, v66, v66
    v_dot2c_f32_bf16 v60, v67, v62
    v_dot2c_f32_bf16 v61, v67, v67
    v_dot2c_f32_bf16 v60, v68, v62
    v_dot2c_f32_bf16 v61, v68, v68
    v_dot2c_f32_bf16 v60, v69, v62
    v_dot2c_f32_bf16 v61, v69, v69
    v_dot2c_f32_bf16 v60, v70, v62
    v_dot2c_f32_bf16 v61, v70, v70
    v_dot2c_f32_bf16 v60, v71, v62
    v_dot2c_f32_bf16 v61, v71, v71
    v_dot2c_f32_bf16 v60, v72, v62
    v_dot2c_f32_bf16 v61, v72, v72
    v_dot2c_f32_bf16 v60, v73, v62
    v_dot2c_f32_bf16 v61, v73, v73
    v_dot2c_f32_bf16 v60, v74, v62
    v_dot2c_f32_bf16 v61, v74, v74
    v_dot2c_f32_bf16 v60, v75, v62
    v_dot2c_f32_bf16 v61, v75, v75
    v_dot2c_f32_bf16 v60, v76, v62
    v_dot2c_f32_bf16 v61, v76, v76
    v_dot2c_f32_bf16 v60, v77, v62
    v_dot2c_f32_bf16 v61, v77, v77
    v_dot2c_f32_bf16 v60, v78, v62
    v_dot2c_f32_bf16 v61, v78, v78
    v_dot2c_f32_bf16 v60, v79, v62
    v_dot2c_f32_bf16 v61, v79, v79
    v_dot2c_f32_bf16 v60, v80, v62
    v_dot2c_f32_bf16 v61, v80, v80
    v_dot2c_f32_bf16 v60, v81, v62
    v_dot2c_f32_bf16 v61, v81, v81
    v_dot2c_f32_bf16 v60, v82, v62
    v_dot2c_f32_bf16 v61, v82, v82
    v_dot2c_f32_bf16 v60, v83, v62
    v_dot2c_f32_bf16 v61, v83, v83
    v_dot2c_f32_bf16 v60, v84, v62
    v_dot2c_f32_bf16 v61, v84, v84
    v_dot2c_f32_bf16 v60, v85, v62
    v_dot2c_f32_bf16 v61, v85, v85
    v_dot2c_f32_bf16 v60, v86, v62
    v_dot2c_f32_bf16 v61, v86, v86
    v_dot2c_f32_bf16 v60, v87, v62
    v_dot2c_f32_bf16 v61, v87, v87
    v_dot2c_f32_bf16 v60, v88, v62
    v_dot2c_f32_bf16 v61, v88, v88
    v_dot2c_f32_bf16 v60, v89, v62
    v_dot2c_f32_bf16 v61, v89, v89
    v_dot2c_f32_bf16 v60, v90, v62
    v_dot2c_f32_bf16 v61, v90, v90
    v_dot2c_f32_bf16 v60, v91, v62
    v_dot2c_f32_bf16 v61, v91, v91
    v_dot2c_f32_bf16 v60, v92, v62
    v_dot2c_f32_bf16 v61, v92, v92
    v_dot2c_f32_bf16 v60, v93, v62
    v_dot2c_f32_bf16 v61, v93, v93
    v_dot2c_f32_bf16 v60, v94, v62
    v_dot2c_f32_bf16 v61, v94, v94
    v_dot2c_f32_bf16 v60, v95, v62
    v_dot2c_f32_bf16 v61, v95, v95
    v_dot2c_f32_bf16 v60, v96, v62
    v_dot2c_f32_bf16 v61, v96, v96
    v_dot2c_f32_bf16 v60, v97, v62
    v_dot2c_f32_bf16 v61, v97, v97
    v_dot2c_f32_bf16 v60, v98, v62
    v_dot2c_f32_bf16 v61, v98, v98
    v_dot2c_f32_bf16 v60, v99, v62
    v_dot2c_f32_bf16 v61, v99, v99
    s_nop 3
    v_lshrrev_b32 v5, 1, v2
    v_lshlrev_b32 v5, 9, v5
    v_lshl_add_u32 v5, v1, 4, v5
    v_and_b32 v6, 1, v2
    v_lshl_add_u32 v5, v6, 3, v5
    buffer_store_dwordx2 v[60:61], v5, s[8:11], s42 offen sc1
    s_waitcnt vmcnt(0)
    s_cmp_lg_u32 s14, 0
    s_cbranch_scc1 Li_pw_d
    v_mov_b32 v5, 160
    s_mov_b32 s16, 0
Li_pw:
    global_load_dword v6, v5, s[12:13] sc1
    s_add_u32 s16, s16, 1
    s_cmp_gt_u32 s16, 100000
    s_cbranch_scc1 L_abort
    s_waitcnt vmcnt(0)
    v_cmp_gt_u32 vcc, 123, v6
    s_nop 0
    s_cbranch_vccz Li_pw_d
    s_sleep 2
    s_branch Li_pw
Li_pw_d:
    s_barrier
    s_cmp_lg_u32 s14, 0
    s_cbranch_scc1 Li_end
    v_lshrrev_b32 v5, 2, v0
    v_lshlrev_b32 v5, 7, v5
    v_and_b32 v6, 3, v0
    v_lshl_add_u32 v5, v6, 2, v5
    v_mov_b32 v6, 1
    s_mul_i32 s41, s47, 22528
    s_mov_b32 exec_lo, -1
    s_mov_b32 exec_hi, 0xffff
    s_add_u32 s41, s41, 180224
    buffer_store_dword v6, v5, s[8:11], s41 offen offset:0 sc1
    s_mov_b64 exec, -1
Li_end:
L_noinit:
    s_cmp_lg_u32 s3, 2
    s_cbranch_scc1 L_cls2_no
    s_add_u32 s15, s4, 0
    s_cmp_lt_u32 s4, 32
    s_cbranch_scc1 L_role_p
    s_endpgm
L_cls2_no:
    s_cmp_lg_u32 s3, 3
    s_cbranch_scc1 L_cls3_no
    s_add_u32 s15, s4, 32
    s_cmp_lt_u32 s4, 32
    s_cbranch_scc1 L_role_p
    s_endpgm
L_cls3_no:
    s_cmp_lg_u32 s3, 4
    s_cbranch_scc1 L_cls4_no
    s_add_u32 s15, s4, 0
    s_cmp_lt_u32 s4, 16
    s_cbranch_scc1 L_role_aq
    s_add_u32 s15, s4, 4294967280
    s_cmp_lt_u32 s4, 21
    s_cbranch_scc1 L_role_awo
    s_add_u32 s15, s4, 43
    s_cmp_lt_u32 s4, 32
    s_cbranch_scc1 L_role_p
    s_endpgm
L_cls4_no:
    s_cmp_lg_u32 s3, 5
    s_cbranch_scc1 L_cls5_no
    s_add_u32 s15, s4, 16
    s_cmp_lt_u32 s4, 16
    s_cbranch_scc1 L_role_aq
    s_add_u32 s15, s4, 4294967285
    s_cmp_lt_u32 s4, 21
    s_cbranch_scc1 L_role_awo
    s_add_u32 s15, s4, 54
    s_cmp_lt_u32 s4, 32
    s_cbranch_scc1 L_role_p
    s_endpgm
L_cls5_no:
    s_cmp_lg_u32 s3, 6
    s_cbranch_scc1 L_cls6_no
    s_add_u32 s15, s4, 0
    s_cmp_lt_u32 s4, 8
    s_cbranch_scc1 L_role_ta
    s_add_u32 s15, s4, 4294967288
    s_cmp_lt_u32 s4, 32
    s_cbranch_scc1 L_role_tw
    s_endpgm
L_cls6_no:
    s_cmp_lg_u32 s3, 7
    s_cbranch_scc1 L_cls7_no
    s_add_u32 s15, s4, 8
    s_cmp_lt_u32 s4, 8
    s_cbranch_scc1 L_role_ta
    s_add_u32 s15, s4, 16
    s_cmp_lt_u32 s4, 20
    s_cbranch_scc1 L_role_tw
    s_add_u32 s15, s4, 66
    s_cmp_lt_u32 s4, 30
    s_cbranch_scc1 L_role_p
    s_endpgm
L_cls7_no:
L_exit:
    s_endpgm
L_abort:
    s_waitcnt lgkmcnt(0)
    s_mov_b64 exec, -1
    v_mov_b32 v0, 60
    s_lshl_b32 s5, s3, 8
    s_or_b32 s5, s5, s4
    s_or_b32 s5, s5, 0x10000
    v_mov_b32 v1, s5
    global_store_dword v0, v1, s[12:13]
    s_endpgm
.p2align 6
L_role_p:
    v_and_b32 v5, 63, v0
    v_lshlrev_b32 v0, 4, v5
    v_and_b32 v7, 15, v5
    v_lshrrev_b32 v8, 4, v5
    v_min_u32 v1, 17, v5
    v_lshrrev_b32 v6, 2, v1
    v_and_b32 v1, 3, v1
    v_lshlrev_b32 v1, 2, v1
    v_lshl_add_u32 v1, v6, 7, v1
    v_mov_b32 v3, 1
    v_mov_b32 v4, 0
    s_mov_b32 s44, 0x05040100
    s_mov_b32 s45, 0x07060302
    s_cmp_ge_u32 s15, 48
    s_cselect_b32 s63, 1, 0
    s_cselect_b32 s17, 48, 0
    s_sub_u32 s15, s15, s17
    s_lshr_b32 s50, s15, 4
    s_and_b32 s51, s15, 15
    s_lshl_b32 s51, s51, 1
    s_lshr_b32 s17, s14, 1
    s_add_u32 s51, s51, s17
    s_and_b32 s47, s14, 1
    s_lshl_b32 s17, s50, 3
    s_add_u32 s17, s17, 40
    s_load_dwordx2 s[20:21], s[0:1], s17
    s_mov_b32 s22, 4718592
    s_mov_b32 s23, 0x00020000
    s_lshl_b32 s49, s51, 8
    s_lshl_b32 s17, s47, 7
    s_add_u32 s49, s49, s17
    s_cmp_eq_u32 s63, 0
    s_cbranch_scc1 Lp_noord
    s_cmp_lg_u32 s14, 0
    s_cbranch_scc1 Lp_ord_d
    v_mov_b32 v5, 48
    s_mov_b32 s16, 0
Lp_ord:
    global_load_dword v6, v5, s[12:13] sc1
    s_add_u32 s16, s16, 1
    s_cmp_gt_u32 s16, 100000
    s_cbranch_scc1 L_role_p_abort
    s_waitcnt vmcnt(0)
    v_cmp_gt_u32 vcc, 1, v6
    s_nop 0
    s_cbranch_vccz Lp_ord_d
    s_sleep 64
    s_branch Lp_ord
Lp_ord_d:
    s_barrier
Lp_noord:
    v_lshrrev_b32 v5, 4, v0
    v_lshrrev_b32 v211, 3, v5
    v_lshlrev_b32 v211, 13, v211
    v_and_b32 v6, 7, v5
    v_lshl_add_u32 v211, v6, 4, v211
    v_lshrrev_b32 v210, 1, v8
    v_lshlrev_b32 v210, 3, v210
    v_lshrrev_b32 v6, 2, v7
    v_add_u32 v210, v210, v6
    v_lshlrev_b32 v210, 7, v210
    s_lshl_b32 s17, s14, 15
    v_add_u32 v210, s17, v210
    v_and_b32 v13, 1, v8
    v_and_b32 v6, 1, v7
    v_lshlrev_b32 v6, 3, v6
    v_lshl_add_u32 v6, v13, 4, v6
    v_bfe_u32 v9, v7, 1, 1
    v_lshl_add_u32 v6, v9, 5, v6
    v_and_b32 v9, 3, v7
    v_lshlrev_b32 v9, 3, v9
    v_lshl_add_u32 v13, v13, 5, v9
    s_cmp_eq_u32 s50, 2
    s_cselect_b64 vcc, -1, 0
    v_cndmask_b32 v6, v6, v13, vcc
    v_add_u32 v210, v210, v6
    s_waitcnt lgkmcnt(0)
    s_and_b32 s21, s21, 0xffff
    s_lshl_b32 s46, s14, 15
    s_add_u32 m0, s46, 0
    s_add_u32 s17, s49, 0
    buffer_load_dwordx4 v211, s[20:23], s17 offen lds
    s_add_u32 m0, s46, 1024
    s_add_u32 s17, s49, 65536
    buffer_load_dwordx4 v211, s[20:23], s17 offen lds
    s_add_u32 m0, s46, 2048
    s_add_u32 s17, s49, 131072
    buffer_load_dwordx4 v211, s[20:23], s17 offen lds
    s_add_u32 m0, s46, 3072
    s_add_u32 s17, s49, 196608
    buffer_load_dwordx4 v211, s[20:23], s17 offen lds
    s_add_u32 m0, s46, 4096
    s_add_u32 s17, s49, 262144
    buffer_load_dwordx4 v211, s[20:23], s17 offen lds
    s_add_u32 m0, s46, 5120
    s_add_u32 s17, s49, 327680
    buffer_load_dwordx4 v211, s[20:23], s17 offen lds
    s_add_u32 m0, s46, 6144
    s_add_u32 s17, s49, 393216
    buffer_load_dwordx4 v211, s[20:23], s17 offen lds
    s_add_u32 m0, s46, 7168
    s_add_u32 s17, s49, 458752
    buffer_load_dwordx4 v211, s[20:23], s17 offen lds
    s_add_u32 m0, s46, 8192
    s_add_u32 s17, s49, 524288
    buffer_load_dwordx4 v211, s[20:23], s17 offen lds
    s_add_u32 m0, s46, 9216
    s_add_u32 s17, s49, 589824
    buffer_load_dwordx4 v211, s[20:23], s17 offen lds
    s_add_u32 m0, s46, 10240
    s_add_u32 s17, s49, 655360
    buffer_load_dwordx4 v211, s[20:23], s17 offen lds
    s_add_u32 m0, s46, 11264
    s_add_u32 s17, s49, 720896
    buffer_load_dwordx4 v211, s[20:23], s17 offen lds
    s_add_u32 m0, s46, 12288
    s_add_u32 s17, s49, 786432
    buffer_load_dwordx4 v211, s[20:23], s17 offen lds
    s_add_u32 m0, s46, 13312
    s_add_u32 s17, s49, 851968
    buffer_load_dwordx4 v211, s[20:23], s17 offen lds
    s_add_u32 m0, s46, 14336
    s_add_u32 s17, s49, 917504
    buffer_load_dwordx4 v211, s[20:23], s17 offen lds
    s_add_u32 m0, s46, 15360
    s_add_u32 s17, s49, 983040
    buffer_load_dwordx4 v211, s[20:23], s17 offen lds
    s_add_u32 m0, s46, 16384
    s_add_u32 s17, s49, 1048576
    buffer_load_dwordx4 v211, s[20:23], s17 offen lds
    s_add_u32 m0, s46, 17408
    s_add_u32 s17, s49, 1114112
    buffer_load_dwordx4 v211, s[20:23], s17 offen lds
    s_add_u32 m0, s46, 18432
    s_add_u32 s17, s49, 1179648
    buffer_load_dwordx4 v211, s[20:23], s17 offen lds
    s_add_u32 m0, s46, 19456
    s_add_u32 s17, s49, 1245184
    buffer_load_dwordx4 v211, s[20:23], s17 offen lds
    s_add_u32 m0, s46, 20480
    s_add_u32 s17, s49, 1310720
    buffer_load_dwordx4 v211, s[20:23], s17 offen lds
    s_add_u32 m0, s46, 21504
    s_add_u32 s17, s49, 1376256
    buffer_load_dwordx4 v211, s[20:23], s17 offen lds
    s_add_u32 m0, s46, 22528
    s_add_u32 s17, s49, 1441792
    buffer_load_dwordx4 v211, s[20:23], s17 offen lds
    s_add_u32 m0, s46, 23552
    s_add_u32 s17, s49, 1507328
    buffer_load_dwordx4 v211, s[20:23], s17 offen lds
    s_add_u32 m0, s46, 24576
    s_add_u32 s17, s49, 1572864
    buffer_load_dwordx4 v211, s[20:23], s17 offen lds
    s_add_u32 m0, s46, 25600
    s_add_u32 s17, s49, 1638400
    buffer_load_dwordx4 v211, s[20:23], s17 offen lds
    s_add_u32 m0, s46, 26624
    s_add_u32 s17, s49, 1703936
    buffer_load_dwordx4 v211, s[20:23], s17 offen lds
    s_add_u32 m0, s46, 27648
    s_add_u32 s17, s49, 1769472
    buffer_load_dwordx4 v211, s[20:23], s17 offen lds
    s_add_u32 m0, s46, 28672
    s_add_u32 s17, s49, 1835008
    buffer_load_dwordx4 v211, s[20:23], s17 offen lds
    s_add_u32 m0, s46, 29696
    s_add_u32 s17, s49, 1900544
    buffer_load_dwordx4 v211, s[20:23], s17 offen lds
    s_add_u32 m0, s46, 30720
    s_add_u32 s17, s49, 1966080
    buffer_load_dwordx4 v211, s[20:23], s17 offen lds
    s_add_u32 m0, s46, 31744
    s_add_u32 s17, s49, 2031616
    buffer_load_dwordx4 v211, s[20:23], s17 offen lds
    s_waitcnt vmcnt(30)
    ds_read_b64_tr_b16 a[0:1], v210 offset:0
    ds_read_b64_tr_b16 a[2:3], v210 offset:512
    ds_read_b64_tr_b16 a[144:145], v210 offset:64
    ds_read_b64_tr_b16 a[146:147], v210 offset:576
    s_waitcnt lgkmcnt(0)
    s_add_u32 m0, s46, 0
    s_add_u32 s17, s49, 2097152
    buffer_load_dwordx4 v211, s[20:23], s17 offen lds
    s_add_u32 m0, s46, 1024
    s_add_u32 s17, s49, 2162688
    buffer_load_dwordx4 v211, s[20:23], s17 offen lds
    s_waitcnt vmcnt(30)
    ds_read_b64_tr_b16 a[4:5], v210 offset:2048
    ds_read_b64_tr_b16 a[6:7], v210 offset:2560
    ds_read_b64_tr_b16 a[148:149], v210 offset:2112
    ds_read_b64_tr_b16 a[150:151], v210 offset:2624
    s_waitcnt lgkmcnt(0)
    s_add_u32 m0, s46, 2048
    s_add_u32 s17, s49, 2228224
    buffer_load_dwordx4 v211, s[20:23], s17 offen lds
    s_add_u32 m0, s46, 3072
    s_add_u32 s17, s49, 2293760
    buffer_load_dwordx4 v211, s[20:23], s17 offen lds
    s_waitcnt vmcnt(30)
    ds_read_b64_tr_b16 a[8:9], v210 offset:4096
    ds_read_b64_tr_b16 a[10:11], v210 offset:4608
    ds_read_b64_tr_b16 a[152:153], v210 offset:4160
    ds_read_b64_tr_b16 a[154:155], v210 offset:4672
    s_waitcnt lgkmcnt(0)
    s_add_u32 m0, s46, 4096
    s_add_u32 s17, s49, 2359296
    buffer_load_dwordx4 v211, s[20:23], s17 offen lds
    s_add_u32 m0, s46, 5120
    s_add_u32 s17, s49, 2424832
    buffer_load_dwordx4 v211, s[20:23], s17 offen lds
    s_waitcnt vmcnt(30)
    ds_read_b64_tr_b16 a[12:13], v210 offset:6144
    ds_read_b64_tr_b16 a[14:15], v210 offset:6656
    ds_read_b64_tr_b16 a[156:157], v210 offset:6208
    ds_read_b64_tr_b16 a[158:159], v210 offset:6720
    s_waitcnt lgkmcnt(0)
    s_add_u32 m0, s46, 6144
    s_add_u32 s17, s49, 2490368
    buffer_load_dwordx4 v211, s[20:23], s17 offen lds
    s_add_u32 m0, s46, 7168
    s_add_u32 s17, s49, 2555904
    buffer_load_dwordx4 v211, s[20:23], s17 offen lds
    s_waitcnt vmcnt(30)
    ds_read_b64_tr_b16 a[16:17], v210 offset:8192
    ds_read_b64_tr_b16 a[18:19], v210 offset:8704
    ds_read_b64_tr_b16 a[160:161], v210 offset:8256
    ds_read_b64_tr_b16 a[162:163], v210 offset:8768
    s_waitcnt lgkmcnt(0)
    s_add_u32 m0, s46, 8192
    s_add_u32 s17, s49, 2621440
    buffer_load_dwordx4 v211, s[20:23], s17 offen lds
    s_add_u32 m0, s46, 9216
    s_add_u32 s17, s49, 2686976
    buffer_load_dwordx4 v211, s[20:23], s17 offen lds
    s_waitcnt vmcnt(30)
    ds_read_b64_tr_b16 a[20:21], v210 offset:10240
    ds_read_b64_tr_b16 a[22:23], v210 offset:10752
    ds_read_b64_tr_b16 a[164:165], v210 offset:10304
    ds_read_b64_tr_b16 a[166:167], v210 offset:10816
    s_waitcnt lgkmcnt(0)
    s_add_u32 m0, s46, 10240
    s_add_u32 s17, s49, 2752512
    buffer_load_dwordx4 v211, s[20:23], s17 offen lds
    s_add_u32 m0, s46, 11264
    s_add_u32 s17, s49, 2818048
    buffer_load_dwordx4 v211, s[20:23], s17 offen lds
    s_waitcnt vmcnt(30)
    ds_read_b64_tr_b16 a[24:25], v210 offset:12288
    ds_read_b64_tr_b16 a[26:27], v210 offset:12800
    ds_read_b64_tr_b16 a[168:169], v210 offset:12352
    ds_read_b64_tr_b16 a[170:171], v210 offset:12864
    s_waitcnt lgkmcnt(0)
    s_add_u32 m0, s46, 12288
    s_add_u32 s17, s49, 2883584
    buffer_load_dwordx4 v211, s[20:23], s17 offen lds
    s_add_u32 m0, s46, 13312
    s_add_u32 s17, s49, 2949120
    buffer_load_dwordx4 v211, s[20:23], s17 offen lds
    s_waitcnt vmcnt(30)
    ds_read_b64_tr_b16 a[28:29], v210 offset:14336
    ds_read_b64_tr_b16 a[30:31], v210 offset:14848
    ds_read_b64_tr_b16 a[172:173], v210 offset:14400
    ds_read_b64_tr_b16 a[174:175], v210 offset:14912
    s_waitcnt lgkmcnt(0)
    s_add_u32 m0, s46, 14336
    s_add_u32 s17, s49, 3014656
    buffer_load_dwordx4 v211, s[20:23], s17 offen lds
    s_add_u32 m0, s46, 15360
    s_add_u32 s17, s49, 3080192
    buffer_load_dwordx4 v211, s[20:23], s17 offen lds
    s_waitcnt vmcnt(30)
    ds_read_b64_tr_b16 a[32:33], v210 offset:16384
    ds_read_b64_tr_b16 a[34:35], v210 offset:16896
    ds_read_b64_tr_b16 a[176:177], v210 offset:16448
    ds_read_b64_tr_b16 a[178:179], v210 offset:16960
    s_waitcnt lgkmcnt(0)
    s_add_u32 m0, s46, 16384
    s_add_u32 s17, s49, 3145728
    buffer_load_dwordx4 v211, s[20:23], s17 offen lds
    s_add_u32 m0, s46, 17408
    s_add_u32 s17, s49, 3211264
    buffer_load_dwordx4 v211, s[20:23], s17 offen lds
    s_waitcnt vmcnt(30)
    ds_read_b64_tr_b16 a[36:37], v210 offset:18432
    ds_read_b64_tr_b16 a[38:39], v210 offset:18944
    ds_read_b64_tr_b16 a[180:181], v210 offset:18496
    ds_read_b64_tr_b16 a[182:183], v210 offset:19008
    s_waitcnt lgkmcnt(0)
    s_add_u32 m0, s46, 18432
    s_add_u32 s17, s49, 3276800
    buffer_load_dwordx4 v211, s[20:23], s17 offen lds
    s_add_u32 m0, s46, 19456
    s_add_u32 s17, s49, 3342336
    buffer_load_dwordx4 v211, s[20:23], s17 offen lds
    s_waitcnt vmcnt(30)
    ds_read_b64_tr_b16 a[40:41], v210 offset:20480
    ds_read_b64_tr_b16 a[42:43], v210 offset:20992
    ds_read_b64_tr_b16 a[184:185], v210 offset:20544
    ds_read_b64_tr_b16 a[186:187], v210 offset:21056
    s_waitcnt lgkmcnt(0)
    s_add_u32 m0, s46, 20480
    s_add_u32 s17, s49, 3407872
    buffer_load_dwordx4 v211, s[20:23], s17 offen lds
    s_add_u32 m0, s46, 21504
    s_add_u32 s17, s49, 3473408
    buffer_load_dwordx4 v211, s[20:23], s17 offen lds
    s_waitcnt vmcnt(30)
    ds_read_b64_tr_b16 a[44:45], v210 offset:22528
    ds_read_b64_tr_b16 a[46:47], v210 offset:23040
    ds_read_b64_tr_b16 a[188:189], v210 offset:22592
    ds_read_b64_tr_b16 a[190:191], v210 offset:23104
    s_waitcnt lgkmcnt(0)
    s_add_u32 m0, s46, 22528
    s_add_u32 s17, s49, 3538944
    buffer_load_dwordx4 v211, s[20:23], s17 offen lds
    s_add_u32 m0, s46, 23552
    s_add_u32 s17, s49, 3604480
    buffer_load_dwordx4 v211, s[20:23], s17 offen lds
    s_waitcnt vmcnt(30)
    ds_read_b64_tr_b16 a[48:49], v210 offset:24576
    ds_read_b64_tr_b16 a[50:51], v210 offset:25088
    ds_read_b64_tr_b16 a[192:193], v210 offset:24640
    ds_read_b64_tr_b16 a[194:195], v210 offset:25152
    s_waitcnt lgkmcnt(0)
    s_add_u32 m0, s46, 24576
    s_add_u32 s17, s49, 3670016
    buffer_load_dwordx4 v211, s[20:23], s17 offen lds
    s_add_u32 m0, s46, 25600
    s_add_u32 s17, s49, 3735552
    buffer_load_dwordx4 v211, s[20:23], s17 offen lds
    s_waitcnt vmcnt(30)
    ds_read_b64_tr_b16 a[52:53], v210 offset:26624
    ds_read_b64_tr_b16 a[54:55], v210 offset:27136
    ds_read_b64_tr_b16 a[196:197], v210 offset:26688
    ds_read_b64_tr_b16 a[198:199], v210 offset:27200
    s_waitcnt lgkmcnt(0)
    s_add_u32 m0, s46, 26624
    s_add_u32 s17, s49, 3801088
    buffer_load_dwordx4 v211, s[20:23], s17 offen lds
    s_add_u32 m0, s46, 27648
    s_add_u32 s17, s49, 3866624
    buffer_load_dwordx4 v211, s[20:23], s17 offen lds
    s_waitcnt vmcnt(30)
    ds_read_b64_tr_b16 a[56:57], v210 offset:28672
    ds_read_b64_tr_b16 a[58:59], v210 offset:29184
    ds_read_b64_tr_b16 a[200:201], v210 offset:28736
    ds_read_b64_tr_b16 a[202:203], v210 offset:29248
    s_waitcnt lgkmcnt(0)
    s_add_u32 m0, s46, 28672
    s_add_u32 s17, s49, 3932160
    buffer_load_dwordx4 v211, s[20:23], s17 offen lds
    s_add_u32 m0, s46, 29696
    s_add_u32 s17, s49, 3997696
    buffer_load_dwordx4 v211, s[20:23], s17 offen lds
    s_waitcnt vmcnt(30)
    ds_read_b64_tr_b16 a[60:61], v210 offset:30720
    ds_read_b64_tr_b16 a[62:63], v210 offset:31232
    ds_read_b64_tr_b16 a[204:205], v210 offset:30784
    ds_read_b64_tr_b16 a[206:207], v210 offset:31296
    s_waitcnt lgkmcnt(0)
    s_add_u32 m0, s46, 30720
    s_add_u32 s17, s49, 4063232
    buffer_load_dwordx4 v211, s[20:23], s17 offen lds
    s_add_u32 m0, s46, 31744
    s_add_u32 s17, s49, 4128768
    buffer_load_dwordx4 v211, s[20:23], s17 offen lds
    s_waitcnt vmcnt(30)
    ds_read_b64_tr_b16 a[64:65], v210 offset:0
    ds_read_b64_tr_b16 a[66:67], v210 offset:512
    ds_read_b64_tr_b16 a[208:209], v210 offset:64
    ds_read_b64_tr_b16 a[210:211], v210 offset:576
    s_waitcnt lgkmcnt(0)
    s_add_u32 m0, s46, 0
    s_add_u32 s17, s49, 4194304
    buffer_load_dwordx4 v211, s[20:23], s17 offen lds
    s_add_u32 m0, s46, 1024
    s_add_u32 s17, s49, 4259840
    buffer_load_dwordx4 v211, s[20:23], s17 offen lds
    s_waitcnt vmcnt(30)
    ds_read_b64_tr_b16 a[68:69], v210 offset:2048
    ds_read_b64_tr_b16 a[70:71], v210 offset:2560
    ds_read_b64_tr_b16 a[212:213], v210 offset:2112
    ds_read_b64_tr_b16 a[214:215], v210 offset:2624
    s_waitcnt lgkmcnt(0)
    s_add_u32 m0, s46, 2048
    s_add_u32 s17, s49, 4325376
    buffer_load_dwordx4 v211, s[20:23], s17 offen lds
    s_add_u32 m0, s46, 3072
    s_add_u32 s17, s49, 4390912
    buffer_load_dwordx4 v211, s[20:23], s17 offen lds
    s_waitcnt vmcnt(30)
    ds_read_b64_tr_b16 a[72:73], v210 offset:4096
    ds_read_b64_tr_b16 a[74:75], v210 offset:4608
    ds_read_b64_tr_b16 a[216:217], v210 offset:4160
    ds_read_b64_tr_b16 a[218:219], v210 offset:4672
    s_waitcnt lgkmcnt(0)
    s_add_u32 m0, s46, 4096
    s_add_u32 s17, s49, 4456448
    buffer_load_dwordx4 v211, s[20:23], s17 offen lds
    s_add_u32 m0, s46, 5120
    s_add_u32 s17, s49, 4521984
    buffer_load_dwordx4 v211, s[20:23], s17 offen lds
    s_waitcnt vmcnt(30)
    ds_read_b64_tr_b16 a[76:77], v210 offset:6144
    ds_read_b64_tr_b16 a[78:79], v210 offset:6656
    ds_read_b64_tr_b16 a[220:221], v210 offset:6208
    ds_read_b64_tr_b16 a[222:223], v210 offset:6720
    s_waitcnt lgkmcnt(0)
    s_add_u32 m0, s46, 6144
    s_add_u32 s17, s49, 4587520
    buffer_load_dwordx4 v211, s[20:23], s17 offen lds
    s_add_u32 m0, s46, 7168
    s_add_u32 s17, s49, 4653056
    buffer_load_dwordx4 v211, s[20:23], s17 offen lds
    s_waitcnt vmcnt(30)
    ds_read_b64_tr_b16 a[80:81], v210 offset:8192
    ds_read_b64_tr_b16 a[82:83], v210 offset:8704
    ds_read_b64_tr_b16 a[224:225], v210 offset:8256
    ds_read_b64_tr_b16 a[226:227], v210 offset:8768
    s_waitcnt vmcnt(28)
    ds_read_b64_tr_b16 a[84:85], v210 offset:10240
    ds_read_b64_tr_b16 a[86:87], v210 offset:10752
    ds_read_b64_tr_b16 a[228:229], v210 offset:10304
    ds_read_b64_tr_b16 a[230:231], v210 offset:10816
    s_waitcnt vmcnt(26)
    ds_read_b64_tr_b16 a[88:89], v210 offset:12288
    ds_read_b64_tr_b16 a[90:91], v210 offset:12800
    ds_read_b64_tr_b16 a[232:233], v210 offset:12352
    ds_read_b64_tr_b16 a[234:235], v210 offset:12864
    s_waitcnt vmcnt(24)
    ds_read_b64_tr_b16 a[92:93], v210 offset:14336
    ds_read_b64_tr_b16 a[94:95], v210 offset:14848
    ds_read_b64_tr_b16 a[236:237], v210 offset:14400
    ds_read_b64_tr_b16 a[238:239], v210 offset:14912
    s_waitcnt vmcnt(22)
    ds_read_b64_tr_b16 a[96:97], v210 offset:16384
    ds_read_b64_tr_b16 a[98:99], v210 offset:16896
    ds_read_b64_tr_b16 a[240:241], v210 offset:16448
    ds_read_b64_tr_b16 a[242:243], v210 offset:16960
    s_waitcnt vmcnt(20)
    ds_read_b64_tr_b16 a[100:101], v210 offset:18432
    ds_read_b64_tr_b16 a[102:103], v210 offset:18944
    ds_read_b64_tr_b16 a[244:245], v210 offset:18496
    ds_read_b64_tr_b16 a[246:247], v210 offset:19008
    s_waitcnt vmcnt(18)
    ds_read_b64_tr_b16 a[104:105], v210 offset:20480
    ds_read_b64_tr_b16 a[106:107], v210 offset:20992
    ds_read_b64_tr_b16 a[248:249], v210 offset:20544
    ds_read_b64_tr_b16 a[250:251], v210 offset:21056
    s_waitcnt vmcnt(16)
    ds_read_b64_tr_b16 a[108:109], v210 offset:22528
    ds_read_b64_tr_b16 a[110:111], v210 offset:23040
    ds_read_b64_tr_b16 a[252:253], v210 offset:22592
    ds_read_b64_tr_b16 a[254:255], v210 offset:23104
    s_waitcnt vmcnt(14)
    ds_read_b64_tr_b16 a[112:113], v210 offset:24576
    ds_read_b64_tr_b16 a[114:115], v210 offset:25088
    ds_read_b64_tr_b16 v[224:225], v210 offset:24640
    ds_read_b64_tr_b16 v[226:227], v210 offset:25152
    s_waitcnt vmcnt(12)
    ds_read_b64_tr_b16 a[116:117], v210 offset:26624
    ds_read_b64_tr_b16 a[118:119], v210 offset:27136
    ds_read_b64_tr_b16 v[228:229], v210 offset:26688
    ds_read_b64_tr_b16 v[230:231], v210 offset:27200
    s_waitcnt vmcnt(10)
    ds_read_b64_tr_b16 a[120:121], v210 offset:28672
    ds_read_b64_tr_b16 a[122:123], v210 offset:29184
    ds_read_b64_tr_b16 v[232:233], v210 offset:28736
    ds_read_b64_tr_b16 v[234:235], v210 offset:29248
    s_waitcnt vmcnt(8)
    ds_read_b64_tr_b16 a[124:125], v210 offset:30720
    ds_read_b64_tr_b16 a[126:127], v210 offset:31232
    ds_read_b64_tr_b16 v[236:237], v210 offset:30784
    ds_read_b64_tr_b16 v[238:239], v210 offset:31296
    s_waitcnt vmcnt(6)
    ds_read_b64_tr_b16 a[128:129], v210 offset:0
    ds_read_b64_tr_b16 a[130:131], v210 offset:512
    ds_read_b64_tr_b16 v[240:241], v210 offset:64
    ds_read_b64_tr_b16 v[242:243], v210 offset:576
    s_waitcnt vmcnt(4)
    ds_read_b64_tr_b16 a[132:133], v210 offset:2048
    ds_read_b64_tr_b16 a[134:135], v210 offset:2560
    ds_read_b64_tr_b16 v[244:245], v210 offset:2112
    ds_read_b64_tr_b16 v[246:247], v210 offset:2624
    s_waitcnt vmcnt(2)
    ds_read_b64_tr_b16 a[136:137], v210 offset:4096
    ds_read_b64_tr_b16 a[138:139], v210 offset:4608
    ds_read_b64_tr_b16 v[248:249], v210 offset:4160
    ds_read_b64_tr_b16 v[250:251], v210 offset:4672
    s_waitcnt vmcnt(0)
    ds_read_b64_tr_b16 a[140:141], v210 offset:6144
    ds_read_b64_tr_b16 a[142:143], v210 offset:6656
    ds_read_b64_tr_b16 v[252:253], v210 offset:6208
    ds_read_b64_tr_b16 v[254:255], v210 offset:6720
    s_waitcnt vmcnt(0) lgkmcnt(0)
    v_bfe_u32 v10, v0, 4, 5
    v_lshrrev_b32 v5, 9, v0
    v_lshlrev_b32 v10, 4, v10
    v_mul_u32_u24 v6, 2560, v5
    v_add_u32 v10, v10, v6
    v_add_u32 v10, 114688, v10
    s_lshl_b32 s67, s14, 10
    v_bfe_u32 v6, v0, 8, 1
    v_lshlrev_b32 v13, 10, v6
    v_lshl_add_u32 v13, v7, 4, v13
    v_lshl_add_u32 v13, v5, 8, v13
    v_mov_b32 v212, 1
    v_mov_b32 v213, 1
    s_mul_i32 s52, s50, 16777216
    s_lshl_b32 s17, s51, 13
    s_add_u32 s52, s52, s17
    s_lshl_b32 s17, s47, 12
    s_add_u32 s52, s52, s17
    s_add_u32 s52, s52, 44040192
    s_lshl_b32 s49, s51, 9
    s_lshl_b32 s17, s50, 7
    s_add_u32 s49, s49, s17
    s_lshl_b32 s17, s47, 3
    s_add_u32 s49, s49, s17
    s_add_u32 s49, s49, 185600
    v_mov_b32 v48, 0x3f803f80
    v_mov_b32 v49, 0x3f803f80
    v_mov_b32 v50, 0x3f803f80
    v_mov_b32 v51, 0x3f803f80
    s_lshl_b32 s17, s14, 8
    s_add_u32 s17, s17, 110592
    v_bfe_u32 v5, v0, 4, 5
    v_lshl_add_u32 v14, v5, 2, s17
    v_lshrrev_b32 v5, 9, v0
    v_lshl_add_u32 v214, v5, 4, s17
    s_cmp_eq_u32 s50, 2
    s_cbranch_scc1 Lp_v
    v_mfma_f32_32x32x16_bf16 v[148:163], a[0:3], v[48:51], 0
    v_mfma_f32_32x32x16_bf16 v[148:163], a[4:7], v[48:51], v[148:163]
    v_mfma_f32_32x32x16_bf16 v[148:163], a[8:11], v[48:51], v[148:163]
    v_mfma_f32_32x32x16_bf16 v[148:163], a[12:15], v[48:51], v[148:163]
    v_mfma_f32_32x32x16_bf16 v[148:163], a[16:19], v[48:51], v[148:163]
    v_mfma_f32_32x32x16_bf16 v[148:163], a[20:23], v[48:51], v[148:163]
    v_mfma_f32_32x32x16_bf16 v[148:163], a[24:27], v[48:51], v[148:163]
    v_mfma_f32_32x32x16_bf16 v[148:163], a[28:31], v[48:51], v[148:163]
    v_mfma_f32_32x32x16_bf16 v[148:163], a[32:35], v[48:51], v[148:163]
    v_mfma_f32_32x32x16_bf16 v[148:163], a[36:39], v[48:51], v[148:163]
    v_mfma_f32_32x32x16_bf16 v[148:163], a[40:43], v[48:51], v[148:163]
    v_mfma_f32_32x32x16_bf16 v[148:163], a[44:47], v[48:51], v[148:163]
    v_mfma_f32_32x32x16_bf16 v[148:163], a[48:51], v[48:51], v[148:163]
    v_mfma_f32_32x32x16_bf16 v[148:163], a[52:55], v[48:51], v[148:163]
    v_mfma_f32_32x32x16_bf16 v[148:163], a[56:59], v[48:51], v[148:163]
    v_mfma_f32_32x32x16_bf16 v[148:163], a[60:63], v[48:51], v[148:163]
    v_mfma_f32_32x32x16_bf16 v[148:163], a[64:67], v[48:51], v[148:163]
    v_mfma_f32_32x32x16_bf16 v[148:163], a[68:71], v[48:51], v[148:163]
    v_mfma_f32_32x32x16_bf16 v[148:163], a[72:75], v[48:51], v[148:163]
    v_mfma_f32_32x32x16_bf16 v[148:163], a[76:79], v[48:51], v[148:163]
    v_mfma_f32_32x32x16_bf16 v[148:163], a[80:83], v[48:51], v[148:163]
    v_mfma_f32_32x32x16_bf16 v[148:163], a[84:87], v[48:51], v[148:163]
    v_mfma_f32_32x32x16_bf16 v[148:163], a[88:91], v[48:51], v[148:163]
    v_mfma_f32_32x32x16_bf16 v[148:163], a[92:95], v[48:51], v[148:163]
    v_mfma_f32_32x32x16_bf16 v[148:163], a[96:99], v[48:51], v[148:163]
    v_mfma_f32_32x32x16_bf16 v[148:163], a[100:103], v[48:51], v[148:163]
    v_mfma_f32_32x32x16_bf16 v[148:163], a[104:107], v[48:51], v[148:163]
    v_mfma_f32_32x32x16_bf16 v[148:163], a[108:111], v[48:51], v[148:163]
    v_mfma_f32_32x32x16_bf16 v[148:163], a[112:115], v[48:51], v[148:163]
    v_mfma_f32_32x32x16_bf16 v[148:163], a[116:119], v[48:51], v[148:163]
    v_mfma_f32_32x32x16_bf16 v[148:163], a[120:123], v[48:51], v[148:163]
    v_mfma_f32_32x32x16_bf16 v[148:163], a[124:127], v[48:51], v[148:163]
    v_mfma_f32_32x32x16_bf16 v[148:163], a[128:131], v[48:51], v[148:163]
    v_mfma_f32_32x32x16_bf16 v[148:163], a[132:135], v[48:51], v[148:163]
    v_mfma_f32_32x32x16_bf16 v[148:163], a[136:139], v[48:51], v[148:163]
    v_mfma_f32_32x32x16_bf16 v[148:163], a[140:143], v[48:51], v[148:163]
    v_mfma_f32_32x32x16_bf16 v[164:179], a[144:147], v[48:51], 0
    v_mfma_f32_32x32x16_bf16 v[164:179], a[148:151], v[48:51], v[164:179]
    v_mfma_f32_32x32x16_bf16 v[164:179], a[152:155], v[48:51], v[164:179]
    v_mfma_f32_32x32x16_bf16 v[164:179], a[156:159], v[48:51], v[164:179]
    v_mfma_f32_32x32x16_bf16 v[164:179], a[160:163], v[48:51], v[164:179]
    v_mfma_f32_32x32x16_bf16 v[164:179], a[164:167], v[48:51], v[164:179]
    v_mfma_f32_32x32x16_bf16 v[164:179], a[168:171], v[48:51], v[164:179]
    v_mfma_f32_32x32x16_bf16 v[164:179], a[172:175], v[48:51], v[164:179]
    v_mfma_f32_32x32x16_bf16 v[164:179], a[176:179], v[48:51], v[164:179]
    v_mfma_f32_32x32x16_bf16 v[164:179], a[180:183], v[48:51], v[164:179]
    v_mfma_f32_32x32x16_bf16 v[164:179], a[184:187], v[48:51], v[164:179]
    v_mfma_f32_32x32x16_bf16 v[164:179], a[188:191], v[48:51], v[164:179]
    v_mfma_f32_32x32x16_bf16 v[164:179], a[192:195], v[48:51], v[164:179]
    v_mfma_f32_32x32x16_bf16 v[164:179], a[196:199], v[48:51], v[164:179]
    v_mfma_f32_32x32x16_bf16 v[164:179], a[200:203], v[48:51], v[164:179]
    v_mfma_f32_32x32x16_bf16 v[164:179], a[204:207], v[48:51], v[164:179]
    v_mfma_f32_32x32x16_bf16 v[164:179], a[208:211], v[48:51], v[164:179]
    v_mfma_f32_32x32x16_bf16 v[164:179], a[212:215], v[48:51], v[164:179]
    v_mfma_f32_32x32x16_bf16 v[164:179], a[216:219], v[48:51], v[164:179]
    v_mfma_f32_32x32x16_bf16 v[164:179], a[220:223], v[48:51], v[164:179]
    v_mfma_f32_32x32x16_bf16 v[164:179], a[224:227], v[48:51], v[164:179]
    v_mfma_f32_32x32x16_bf16 v[164:179], a[228:231], v[48:51], v[164:179]
    v_mfma_f32_32x32x16_bf16 v[164:179], a[232:235], v[48:51], v[164:179]
    v_mfma_f32_32x32x16_bf16 v[164:179], a[236:239], v[48:51], v[164:179]
    v_mfma_f32_32x32x16_bf16 v[164:179], a[240:243], v[48:51], v[164:179]
    v_mfma_f32_32x32x16_bf16 v[164:179], a[244:247], v[48:51], v[164:179]
    v_mfma_f32_32x32x16_bf16 v[164:179], a[248:251], v[48:51], v[164:179]
    v_mfma_f32_32x32x16_bf16 v[164:179], a[252:255], v[48:51], v[164:179]
    v_mfma_f32_32x32x16_bf16 v[164:179], v[224:227], v[48:51], v[164:179]
    v_mfma_f32_32x32x16_bf16 v[164:179], v[228:231], v[48:51], v[164:179]
    v_mfma_f32_32x32x16_bf16 v[164:179], v[232:235], v[48:51], v[164:179]
    v_mfma_f32_32x32x16_bf16 v[164:179], v[236:239], v[48:51], v[164:179]
    v_mfma_f32_32x32x16_bf16 v[164:179], v[240:243], v[48:51], v[164:179]
    v_mfma_f32_32x32x16_bf16 v[164:179], v[244:247], v[48:51], v[164:179]
    v_mfma_f32_32x32x16_bf16 v[164:179], v[248:251], v[48:51], v[164:179]
    v_mfma_f32_32x32x16_bf16 v[164:179], v[252:255], v[48:51], v[164:179]
    s_mov_b32 s66, 114688
    s_mov_b32 s71, 0x2000
    s_mov_b32 s36, s63
    s_mov_b32 s34, s63
    s_mov_b32 s37, 0
    s_lshl_b32 s56, s63, 6
    s_mul_i32 s58, s14, 9216
    s_mov_b32 s40, 36864
    s_mov_b32 s59, s58
    s_mov_b32 s43, 0
    s_mov_b32 s28, s8
    s_mov_b32 s29, s9
    s_mov_b32 s30, 0
    s_mov_b32 s31, 0x00020000
    s_mul_i32 s41, s63, 4718592
    s_add_u32 s41, s41, s58
    s_add_u32 s41, s41, 8650752
    s_mul_i32 s42, s56, 22528
    s_add_u32 s42, s42, 183808
    s_cmp_lg_u32 s14, 0
    s_cbranch_scc1 LpQ_ini_d
    v_mov_b32 v5, 160
    s_mov_b32 s16, 0
LpQ_ini:
    global_load_dword v6, v5, s[12:13] sc1
    s_add_u32 s16, s16, 1
    s_cmp_gt_u32 s16, 100000
    s_cbranch_scc1 L_role_p_abort
    s_waitcnt vmcnt(0)
    v_cmp_gt_u32 vcc, 123, v6
    s_nop 0
    s_cbranch_vccz LpQ_ini_d
    s_sleep 8
    s_branch LpQ_ini
LpQ_ini_d:
    s_barrier
    s_branch LpQ_poll
LpQ_item:
    s_waitcnt vmcnt(4)
LpQ_go:
    s_barrier
    s_xor_b32 s40, s40, 36864
    s_xor_b32 s59, s59, 36864
    s_xor_b32 s66, s66, 0x2000
    s_xor_b32 s71, s71, 0x2000
    s_mov_b32 s35, s37
    s_mov_b32 s57, s56
    s_add_u32 s37, s37, 1
    s_add_u32 s56, s56, 1
    s_add_u32 s41, s41, 36864
    s_add_u32 s42, s42, 22528
    s_mov_b32 s62, 0
    v_add_u32 v9, s40, v0
    v_add_u32 v5, s71, v10
    ds_read_b128 v[48:51], v9 offset:0
    ds_read_b128 v[52:55], v9 offset:1024
    ds_read_b128 v[56:59], v9 offset:2048
    s_waitcnt lgkmcnt(2)
    v_mfma_f32_32x32x16_bf16 v[16:31], a[0:3], v[48:51], 0
    ds_read_b128 v[60:63], v9 offset:3072
    ds_read_b128 v[96:99], v5 offset:0
    ds_read_b128 v[100:103], v5 offset:512
    s_waitcnt lgkmcnt(4)
    v_mfma_f32_32x32x16_bf16 v[16:31], a[4:7], v[52:55], v[16:31]
    ds_read_b128 v[64:67], v9 offset:4096
    ds_read_b128 v[104:107], v5 offset:1024
    ds_read_b128 v[108:111], v5 offset:1536
    s_waitcnt lgkmcnt(6)
    v_mfma_f32_32x32x16_bf16 v[16:31], a[8:11], v[56:59], v[16:31]
    ds_read_b128 v[68:71], v9 offset:5120
    ds_read_b128 v[112:115], v5 offset:2048
    s_waitcnt lgkmcnt(7)
    v_mfma_f32_32x32x16_bf16 v[16:31], a[12:15], v[60:63], v[16:31]
    ds_read_b128 v[72:75], v9 offset:6144
    s_waitcnt lgkmcnt(6)
    v_add_f32 v96, v96, v100
    s_waitcnt lgkmcnt(5)
    v_mfma_f32_32x32x16_bf16 v[16:31], a[16:19], v[64:67], v[16:31]
    ds_read_b128 v[76:79], v9 offset:7168
    v_add_f32 v97, v97, v101
    v_add_f32 v98, v98, v102
    s_waitcnt lgkmcnt(3)
    v_mfma_f32_32x32x16_bf16 v[16:31], a[20:23], v[68:71], v[16:31]
    ds_read_b128 v[80:83], v9 offset:8192
    v_add_f32 v99, v99, v103
    v_add_f32 v96, v96, v104
    s_waitcnt lgkmcnt(2)
    v_mfma_f32_32x32x16_bf16 v[16:31], a[24:27], v[72:75], v[16:31]
    ds_read_b128 v[84:87], v9 offset:9216
    v_add_f32 v97, v97, v105
    v_add_f32 v98, v98, v106
    s_waitcnt lgkmcnt(2)
    v_mfma_f32_32x32x16_bf16 v[16:31], a[28:31], v[76:79], v[16:31]
    ds_read_b128 v[88:91], v9 offset:10240
    v_add_f32 v99, v99, v107
    v_add_f32 v96, v96, v108
    s_waitcnt lgkmcnt(2)
    v_mfma_f32_32x32x16_bf16 v[16:31], a[32:35], v[80:83], v[16:31]
    ds_read_b128 v[92:95], v9 offset:11264
    v_add_f32 v97, v97, v109
    v_add_f32 v98, v98, v110
    v_mfma_f32_32x32x16_bf16 v[32:47], a[144:147], v[48:51], 0
    v_add_f32 v99, v99, v111
    v_add_f32 v96, v96, v112
    s_waitcnt lgkmcnt(2)
    v_mfma_f32_32x32x16_bf16 v[16:31], a[36:39], v[84:87], v[16:31]
    ds_read_b128 v[48:51], v9 offset:12288
    v_add_f32 v97, v97, v113
    v_add_f32 v98, v98, v114
    v_mfma_f32_32x32x16_bf16 v[32:47], a[148:151], v[52:55], v[32:47]
    v_add_f32 v99, v99, v115
    v_add_f32 v96, v96, v98
    s_waitcnt lgkmcnt(2)
    v_mfma_f32_32x32x16_bf16 v[16:31], a[40:43], v[88:91], v[16:31]
    ds_read_b128 v[52:55], v9 offset:13312
    v_add_f32 v97, v97, v99
    v_mov_b32 v98, v96
    v_mfma_f32_32x32x16_bf16 v[32:47], a[152:155], v[56:59], v[32:47]
    v_mov_b32 v99, v97
    v_permlane32_swap_b32 v96, v98
    s_waitcnt lgkmcnt(2)
    v_mfma_f32_32x32x16_bf16 v[16:31], a[44:47], v[92:95], v[16:31]
    ds_read_b128 v[56:59], v9 offset:14336
    v_permlane32_swap_b32 v97, v99
    v_add_f32 v96, v96, v98
    v_mfma_f32_32x32x16_bf16 v[32:47], a[156:159], v[60:63], v[32:47]
    v_add_f32 v97, v97, v99
    v_mul_f32 v96, 0x3ae38e39, v96
    s_waitcnt lgkmcnt(2)
    v_mfma_f32_32x32x16_bf16 v[16:31], a[48:51], v[48:51], v[16:31]
    ds_read_b128 v[60:63], v9 offset:15360
    v_mul_f32 v97, 0x3ae38e39, v97
    v_fma_f32 v97, -v96, v96, v97
    v_mfma_f32_32x32x16_bf16 v[32:47], a[160:163], v[64:67], v[32:47]
    v_max_f32 v97, 0, v97
    v_add_f32 v97, 0x3727c5ac, v97
    s_waitcnt lgkmcnt(2)
    v_mfma_f32_32x32x16_bf16 v[16:31], a[52:55], v[52:55], v[16:31]
    ds_read_b128 v[64:67], v9 offset:16384
    v_rsq_f32 v116, v97
    s_nop 0
    v_mul_f32 v117, v96, v116
    v_mfma_f32_32x32x16_bf16 v[32:47], a[164:167], v[68:71], v[32:47]
    s_mul_i32 s46, s34, 50331648
    s_lshl_b32 s19, s35, 18
    s_waitcnt lgkmcnt(2)
    v_mfma_f32_32x32x16_bf16 v[16:31], a[56:59], v[56:59], v[16:31]
    ds_read_b128 v[68:71], v9 offset:17408
    s_waitcnt vmcnt(0)
    buffer_load_dword v2, v1, s[8:11], s42 offen sc1
    s_cmp_lg_u32 s43, 0
    s_cselect_b64 exec, 1, 0
    buffer_store_dwordx2 v[212:213], v4, s[8:11], s43 offen sc1
    s_mov_b64 exec, -1
    s_mov_b32 s43, 0
    v_mfma_f32_32x32x16_bf16 v[32:47], a[168:171], v[72:75], v[32:47]
    s_add_u32 s46, s46, s19
    s_add_u32 s46, s46, s52
    s_waitcnt lgkmcnt(2)
    v_mfma_f32_32x32x16_bf16 v[16:31], a[60:63], v[60:63], v[16:31]
    ds_read_b128 v[72:75], v9 offset:18432
    v_mfma_f32_32x32x16_bf16 v[32:47], a[172:175], v[76:79], v[32:47]
    s_waitcnt lgkmcnt(2)
    v_mfma_f32_32x32x16_bf16 v[16:31], a[64:67], v[64:67], v[16:31]
    ds_read_b128 v[76:79], v9 offset:19456
    v_mfma_f32_32x32x16_bf16 v[32:47], a[176:179], v[80:83], v[32:47]
    s_waitcnt lgkmcnt(2)
    v_mfma_f32_32x32x16_bf16 v[16:31], a[68:71], v[68:71], v[16:31]
    ds_read_b128 v[80:83], v9 offset:20480
    v_mfma_f32_32x32x16_bf16 v[32:47], a[180:183], v[84:87], v[32:47]
    s_waitcnt lgkmcnt(2)
    v_mfma_f32_32x32x16_bf16 v[16:31], a[72:75], v[72:75], v[16:31]
    ds_read_b128 v[84:87], v9 offset:21504
    v_mfma_f32_32x32x16_bf16 v[32:47], a[184:187], v[88:91], v[32:47]
    s_waitcnt lgkmcnt(2)
    v_mfma_f32_32x32x16_bf16 v[16:31], a[76:79], v[76:79], v[16:31]
    ds_read_b128 v[88:91], v9 offset:22528
    v_mfma_f32_32x32x16_bf16 v[32:47], a[188:191], v[92:95], v[32:47]
    s_waitcnt lgkmcnt(2)
    v_mfma_f32_32x32x16_bf16 v[16:31], a[80:83], v[80:83], v[16:31]
    ds_read_b128 v[92:95], v9 offset:23552
    v_mfma_f32_32x32x16_bf16 v[32:47], a[192:195], v[48:51], v[32:47]
    s_waitcnt lgkmcnt(2)
    v_mfma_f32_32x32x16_bf16 v[16:31], a[84:87], v[84:87], v[16:31]
    ds_read_b128 v[48:51], v9 offset:24576
    v_mfma_f32_32x32x16_bf16 v[32:47], a[196:199], v[52:55], v[32:47]
    s_waitcnt lgkmcnt(2)
    v_mfma_f32_32x32x16_bf16 v[16:31], a[88:91], v[88:91], v[16:31]
    ds_read_b128 v[52:55], v9 offset:25600
    v_mfma_f32_32x32x16_bf16 v[32:47], a[200:203], v[56:59], v[32:47]
    s_waitcnt lgkmcnt(2)
    v_mfma_f32_32x32x16_bf16 v[16:31], a[92:95], v[92:95], v[16:31]
    ds_read_b128 v[56:59], v9 offset:26624
    v_mfma_f32_32x32x16_bf16 v[32:47], a[204:207], v[60:63], v[32:47]
    s_waitcnt lgkmcnt(2)
    v_mfma_f32_32x32x16_bf16 v[16:31], a[96:99], v[48:51], v[16:31]
    ds_read_b128 v[60:63], v9 offset:27648
    v_mfma_f32_32x32x16_bf16 v[32:47], a[208:211], v[64:67], v[32:47]
    s_waitcnt lgkmcnt(2)
    v_mfma_f32_32x32x16_bf16 v[16:31], a[100:103], v[52:55], v[16:31]
    ds_read_b128 v[64:67], v9 offset:28672
    s_waitcnt vmcnt(1)
    v_cmp_eq_u32 vcc, 0, v2
    s_nop 0
    s_cmp_eq_u64 vcc, 0
    s_cselect_b32 s62, 1, 0
    s_cmp_lt_u32 s37, 64
    s_cselect_b32 s62, s62, 0
    s_cmp_lg_u32 s62, 0
    s_cselect_b32 s30, 268435456, 0
    v_mfma_f32_32x32x16_bf16 v[32:47], a[212:215], v[68:71], v[32:47]
    s_waitcnt lgkmcnt(2)
    v_mfma_f32_32x32x16_bf16 v[16:31], a[104:107], v[56:59], v[16:31]
    ds_read_b128 v[68:71], v9 offset:29696
    s_add_u32 m0, s59, 0
    s_add_u32 s47, s41, 0
    buffer_load_dwordx4 v0, s[28:31], s47 offen offset:0 lds
    v_mfma_f32_32x32x16_bf16 v[32:47], a[216:219], v[72:75], v[32:47]
    s_waitcnt lgkmcnt(2)
    v_mfma_f32_32x32x16_bf16 v[16:31], a[108:111], v[60:63], v[16:31]
    ds_read_b128 v[72:75], v9 offset:30720
    buffer_load_dwordx4 v0, s[28:31], s47 offen offset:1024 lds
    v_mfma_f32_32x32x16_bf16 v[32:47], a[220:223], v[76:79], v[32:47]
    s_waitcnt lgkmcnt(2)
    v_mfma_f32_32x32x16_bf16 v[16:31], a[112:115], v[64:67], v[16:31]
    ds_read_b128 v[76:79], v9 offset:31744
    buffer_load_dwordx4 v0, s[28:31], s47 offen offset:2048 lds
    v_mfma_f32_32x32x16_bf16 v[32:47], a[224:227], v[80:83], v[32:47]
    s_waitcnt lgkmcnt(2)
    v_mfma_f32_32x32x16_bf16 v[16:31], a[116:119], v[68:71], v[16:31]
    ds_read_b128 v[80:83], v9 offset:32768
    buffer_load_dwordx4 v0, s[28:31], s47 offen offset:3072 lds
    v_mfma_f32_32x32x16_bf16 v[32:47], a[228:231], v[84:87], v[32:47]
    s_waitcnt lgkmcnt(2)
    v_mfma_f32_32x32x16_bf16 v[16:31], a[120:123], v[72:75], v[16:31]
    ds_read_b128 v[84:87], v9 offset:33792
    s_add_u32 m0, s59, 4096
    s_add_u32 s47, s41, 4096
    buffer_load_dwordx4 v0, s[28:31], s47 offen offset:0 lds
    v_mfma_f32_32x32x16_bf16 v[32:47], a[232:235], v[88:91], v[32:47]
    s_waitcnt lgkmcnt(2)
    v_mfma_f32_32x32x16_bf16 v[16:31], a[124:127], v[76:79], v[16:31]
    ds_read_b128 v[88:91], v9 offset:34816
    buffer_load_dwordx4 v0, s[28:31], s47 offen offset:1024 lds
    v_mfma_f32_32x32x16_bf16 v[32:47], a[236:239], v[92:95], v[32:47]
    s_waitcnt lgkmcnt(2)
    v_mfma_f32_32x32x16_bf16 v[16:31], a[128:131], v[80:83], v[16:31]
    ds_read_b128 v[92:95], v9 offset:35840
    buffer_load_dwordx4 v0, s[28:31], s47 offen offset:2048 lds
    v_mfma_f32_32x32x16_bf16 v[32:47], a[240:243], v[48:51], v[32:47]
    s_waitcnt lgkmcnt(2)
    v_mfma_f32_32x32x16_bf16 v[16:31], a[132:135], v[84:87], v[16:31]
    buffer_load_dwordx4 v0, s[28:31], s47 offen offset:3072 lds
    v_mfma_f32_32x32x16_bf16 v[32:47], a[244:247], v[52:55], v[32:47]
    s_waitcnt lgkmcnt(1)
    v_mfma_f32_32x32x16_bf16 v[16:31], a[136:139], v[88:91], v[16:31]
    s_add_u32 m0, s59, 8192
    s_add_u32 s47, s41, 8192
    buffer_load_dwordx4 v0, s[28:31], s47 offen offset:0 lds
    v_mfma_f32_32x32x16_bf16 v[32:47], a[248:251], v[56:59], v[32:47]
    s_waitcnt lgkmcnt(0)
    v_mfma_f32_32x32x16_bf16 v[16:31], a[140:143], v[92:95], v[16:31]
    s_mul_i32 s48, s36, 786432
    s_mul_i32 s18, s37, 6144
    s_add_u32 s48, s48, s18
    s_add_u32 s48, s48, 16125952
    s_add_u32 m0, s66, 4096
    s_nop 0
    buffer_load_dwordx4 v0, s[28:31], s48 offen lds
    v_mfma_f32_32x32x16_bf16 v[32:47], a[252:255], v[60:63], v[32:47]
    v_mfma_f32_32x32x16_bf16 v[32:47], v[224:227], v[64:67], v[32:47]
    s_add_u32 m0, s66, s67
    s_sub_u32 s48, s48, 4096
    s_add_u32 s48, s48, s67
    buffer_load_dwordx4 v0, s[28:31], s48 offen lds
    v_mfma_f32_32x32x16_bf16 v[32:47], v[228:231], v[68:71], v[32:47]
    v_mul_f32 v180, v117, v148
    v_fma_f32 v16, v16, v116, -v180
    v_mul_f32 v184, v117, v152
    v_fma_f32 v20, v20, v116, -v184
    v_cvt_pk_bf16_f32 v196, v16, v20
    v_mfma_f32_32x32x16_bf16 v[32:47], v[232:235], v[72:75], v[32:47]
    v_mul_f32 v181, v117, v149
    v_fma_f32 v17, v17, v116, -v181
    v_mul_f32 v185, v117, v153
    v_fma_f32 v21, v21, v116, -v185
    v_cvt_pk_bf16_f32 v197, v17, v21
    v_mfma_f32_32x32x16_bf16 v[32:47], v[236:239], v[76:79], v[32:47]
    v_mul_f32 v182, v117, v150
    v_fma_f32 v18, v18, v116, -v182
    v_mul_f32 v186, v117, v154
    v_fma_f32 v22, v22, v116, -v186
    v_cvt_pk_bf16_f32 v198, v18, v22
    v_mfma_f32_32x32x16_bf16 v[32:47], v[240:243], v[80:83], v[32:47]
    v_mul_f32 v183, v117, v151
    v_fma_f32 v19, v19, v116, -v183
    v_mul_f32 v187, v117, v155
    v_fma_f32 v23, v23, v116, -v187
    v_cvt_pk_bf16_f32 v199, v19, v23
    v_mfma_f32_32x32x16_bf16 v[32:47], v[244:247], v[84:87], v[32:47]
    buffer_store_dwordx4 v[196:199], v13, s[8:11], s46 offen offset:0 sc1
    v_mul_f32 v188, v117, v156
    v_fma_f32 v24, v24, v116, -v188
    v_mul_f32 v192, v117, v160
    v_fma_f32 v28, v28, v116, -v192
    v_mfma_f32_32x32x16_bf16 v[32:47], v[248:251], v[88:91], v[32:47]
    v_cvt_pk_bf16_f32 v200, v24, v28
    v_mul_f32 v189, v117, v157
    v_fma_f32 v25, v25, v116, -v189
    v_mul_f32 v193, v117, v161
    v_fma_f32 v29, v29, v116, -v193
    v_mfma_f32_32x32x16_bf16 v[32:47], v[252:255], v[92:95], v[32:47]
    v_cvt_pk_bf16_f32 v201, v25, v29
    v_mul_f32 v190, v117, v158
    v_fma_f32 v26, v26, v116, -v190
    v_mul_f32 v194, v117, v162
    v_fma_f32 v30, v30, v116, -v194
    v_cvt_pk_bf16_f32 v202, v26, v30
    v_mul_f32 v191, v117, v159
    v_fma_f32 v27, v27, v116, -v191
    v_mul_f32 v195, v117, v163
    v_fma_f32 v31, v31, v116, -v195
    v_cvt_pk_bf16_f32 v203, v27, v31
    buffer_store_dwordx4 v[200:203], v13, s[8:11], s46 offen offset:512 sc1
    v_mul_f32 v180, v117, v164
    v_fma_f32 v32, v32, v116, -v180
    v_mul_f32 v184, v117, v168
    v_fma_f32 v36, v36, v116, -v184
    v_cvt_pk_bf16_f32 v196, v32, v36
    v_mul_f32 v181, v117, v165
    v_fma_f32 v33, v33, v116, -v181
    v_mul_f32 v185, v117, v169
    v_fma_f32 v37, v37, v116, -v185
    v_cvt_pk_bf16_f32 v197, v33, v37
    v_mul_f32 v182, v117, v166
    v_fma_f32 v34, v34, v116, -v182
    v_mul_f32 v186, v117, v170
    v_fma_f32 v38, v38, v116, -v186
    v_cvt_pk_bf16_f32 v198, v34, v38
    v_mul_f32 v183, v117, v167
    v_fma_f32 v35, v35, v116, -v183
    v_mul_f32 v187, v117, v171
    v_fma_f32 v39, v39, v116, -v187
    v_cvt_pk_bf16_f32 v199, v35, v39
    buffer_store_dwordx4 v[196:199], v13, s[8:11], s46 offen offset:2048 sc1
    v_mul_f32 v188, v117, v172
    v_fma_f32 v40, v40, v116, -v188
    v_mul_f32 v192, v117, v176
    v_fma_f32 v44, v44, v116, -v192
    v_cvt_pk_bf16_f32 v200, v40, v44
    v_mul_f32 v189, v117, v173
    v_fma_f32 v41, v41, v116, -v189
    v_mul_f32 v193, v117, v177
    v_fma_f32 v45, v45, v116, -v193
    v_cvt_pk_bf16_f32 v201, v41, v45
    v_mul_f32 v190, v117, v174
    v_fma_f32 v42, v42, v116, -v190
    v_mul_f32 v194, v117, v178
    v_fma_f32 v46, v46, v116, -v194
    v_cvt_pk_bf16_f32 v202, v42, v46
    v_mul_f32 v191, v117, v175
    v_fma_f32 v43, v43, v116, -v191
    v_mul_f32 v195, v117, v179
    v_fma_f32 v47, v47, v116, -v195
    v_cvt_pk_bf16_f32 v203, v43, v47
    buffer_store_dwordx4 v[200:203], v13, s[8:11], s46 offen offset:2560 sc1
    s_mul_i32 s43, s57, 22528
    s_add_u32 s43, s43, s49
    s_cmp_lg_u32 s62, 0
    s_cbranch_scc1 LpQ_item
    buffer_load_dword v2, v1, s[8:11], s42 offen sc1
    s_waitcnt vmcnt(0)
    s_cmp_ge_u32 s37, 64
    s_cbranch_scc1 LpQ_fin
    v_cmp_eq_u32 vcc, 0, v2
    s_nop 0
    s_cbranch_vccnz LpQ_pub
    s_add_u32 m0, s59, 0
    s_add_u32 s47, s41, 0
    buffer_load_dwordx4 v0, s[8:11], s47 offen offset:0 lds
    buffer_load_dwordx4 v0, s[8:11], s47 offen offset:1024 lds
    buffer_load_dwordx4 v0, s[8:11], s47 offen offset:2048 lds
    buffer_load_dwordx4 v0, s[8:11], s47 offen offset:3072 lds
    s_add_u32 m0, s59, 4096
    s_add_u32 s47, s41, 4096
    buffer_load_dwordx4 v0, s[8:11], s47 offen offset:0 lds
    buffer_load_dwordx4 v0, s[8:11], s47 offen offset:1024 lds
    buffer_load_dwordx4 v0, s[8:11], s47 offen offset:2048 lds
    buffer_load_dwordx4 v0, s[8:11], s47 offen offset:3072 lds
    s_add_u32 m0, s59, 8192
    s_add_u32 s47, s41, 8192
    buffer_load_dwordx4 v0, s[8:11], s47 offen offset:0 lds
    s_mul_i32 s48, s36, 786432
    s_mul_i32 s18, s37, 6144
    s_add_u32 s48, s48, s18
    s_add_u32 s48, s48, 16125952
    s_add_u32 m0, s66, 4096
    s_nop 0
    buffer_load_dwordx4 v0, s[8:11], s48 offen lds
    s_add_u32 m0, s66, s67
    s_sub_u32 s48, s48, 4096
    s_add_u32 s48, s48, s67
    buffer_load_dwordx4 v0, s[8:11], s48 offen lds
    s_cmp_lg_u32 s43, 0
    s_cselect_b64 exec, 1, 0
    buffer_store_dwordx2 v[212:213], v4, s[8:11], s43 offen sc1
    s_mov_b64 exec, -1
    s_mov_b32 s43, 0
    s_waitcnt vmcnt(1)
    s_branch LpQ_go
LpQ_fin:
    s_cmp_lg_u32 s43, 0
    s_cselect_b64 exec, 1, 0
    buffer_store_dwordx2 v[212:213], v4, s[8:11], s43 offen sc1
    s_mov_b64 exec, -1
    s_mov_b32 s43, 0
    s_branch L_role_p_exit
LpQ_pub:
    s_cmp_lg_u32 s43, 0
    s_cselect_b64 exec, 1, 0
    buffer_store_dwordx2 v[212:213], v4, s[8:11], s43 offen sc1
    s_mov_b64 exec, -1
    s_mov_b32 s43, 0
LpQ_poll:
    s_mov_b32 s16, 0
LpQ_pl:
    buffer_load_dword v2, v1, s[8:11], s42 offen sc1
    s_add_u32 s16, s16, 1
    s_cmp_gt_u32 s16, 100000
    s_cbranch_scc1 L_role_p_abort
    s_waitcnt vmcnt(0)
    v_cmp_eq_u32 vcc, 0, v2
    s_nop 0
    s_cbranch_vccz LpQ_pld
    s_sleep 4
    s_branch LpQ_pl
LpQ_pld:
    s_add_u32 m0, s59, 0
    s_add_u32 s47, s41, 0
    buffer_load_dwordx4 v0, s[8:11], s47 offen offset:0 lds
    buffer_load_dwordx4 v0, s[8:11], s47 offen offset:1024 lds
    buffer_load_dwordx4 v0, s[8:11], s47 offen offset:2048 lds
    buffer_load_dwordx4 v0, s[8:11], s47 offen offset:3072 lds
    s_add_u32 m0, s59, 4096
    s_add_u32 s47, s41, 4096
    buffer_load_dwordx4 v0, s[8:11], s47 offen offset:0 lds
    buffer_load_dwordx4 v0, s[8:11], s47 offen offset:1024 lds
    buffer_load_dwordx4 v0, s[8:11], s47 offen offset:2048 lds
    buffer_load_dwordx4 v0, s[8:11], s47 offen offset:3072 lds
    s_add_u32 m0, s59, 8192
    s_add_u32 s47, s41, 8192
    buffer_load_dwordx4 v0, s[8:11], s47 offen offset:0 lds
    s_mul_i32 s48, s36, 786432
    s_mul_i32 s18, s37, 6144
    s_add_u32 s48, s48, s18
    s_add_u32 s48, s48, 16125952
    s_add_u32 m0, s66, 4096
    s_nop 0
    buffer_load_dwordx4 v0, s[8:11], s48 offen lds
    s_add_u32 m0, s66, s67
    s_sub_u32 s48, s48, 4096
    s_add_u32 s48, s48, s67
    buffer_load_dwordx4 v0, s[8:11], s48 offen lds
    s_waitcnt vmcnt(0)
    s_branch LpQ_go
Lp_v:
    v_mfma_f32_32x32x16_bf16 v[16:31], v[48:51], a[0:3], 0
    v_mfma_f32_32x32x16_bf16 v[16:31], v[48:51], a[4:7], v[16:31]
    v_mfma_f32_32x32x16_bf16 v[16:31], v[48:51], a[8:11], v[16:31]
    v_mfma_f32_32x32x16_bf16 v[16:31], v[48:51], a[12:15], v[16:31]
    v_mfma_f32_32x32x16_bf16 v[16:31], v[48:51], a[16:19], v[16:31]
    v_mfma_f32_32x32x16_bf16 v[16:31], v[48:51], a[20:23], v[16:31]
    v_mfma_f32_32x32x16_bf16 v[16:31], v[48:51], a[24:27], v[16:31]
    v_mfma_f32_32x32x16_bf16 v[16:31], v[48:51], a[28:31], v[16:31]
    v_mfma_f32_32x32x16_bf16 v[16:31], v[48:51], a[32:35], v[16:31]
    v_mfma_f32_32x32x16_bf16 v[16:31], v[48:51], a[36:39], v[16:31]
    v_mfma_f32_32x32x16_bf16 v[16:31], v[48:51], a[40:43], v[16:31]
    v_mfma_f32_32x32x16_bf16 v[16:31], v[48:51], a[44:47], v[16:31]
    v_mfma_f32_32x32x16_bf16 v[16:31], v[48:51], a[48:51], v[16:31]
    v_mfma_f32_32x32x16_bf16 v[16:31], v[48:51], a[52:55], v[16:31]
    v_mfma_f32_32x32x16_bf16 v[16:31], v[48:51], a[56:59], v[16:31]
    v_mfma_f32_32x32x16_bf16 v[16:31], v[48:51], a[60:63], v[16:31]
    v_mfma_f32_32x32x16_bf16 v[16:31], v[48:51], a[64:67], v[16:31]
    v_mfma_f32_32x32x16_bf16 v[16:31], v[48:51], a[68:71], v[16:31]
    v_mfma_f32_32x32x16_bf16 v[16:31], v[48:51], a[72:75], v[16:31]
    v_mfma_f32_32x32x16_bf16 v[16:31], v[48:51], a[76:79], v[16:31]
    v_mfma_f32_32x32x16_bf16 v[16:31], v[48:51], a[80:83], v[16:31]
    v_mfma_f32_32x32x16_bf16 v[16:31], v[48:51], a[84:87], v[16:31]
    v_mfma_f32_32x32x16_bf16 v[16:31], v[48:51], a[88:91], v[16:31]
    v_mfma_f32_32x32x16_bf16 v[16:31], v[48:51], a[92:95], v[16:31]
    v_mfma_f32_32x32x16_bf16 v[16:31], v[48:51], a[96:99], v[16:31]
    v_mfma_f32_32x32x16_bf16 v[16:31], v[48:51], a[100:103], v[16:31]
    v_mfma_f32_32x32x16_bf16 v[16:31], v[48:51], a[104:107], v[16:31]
    v_mfma_f32_32x32x16_bf16 v[16:31], v[48:51], a[108:111], v[16:31]
    v_mfma_f32_32x32x16_bf16 v[16:31], v[48:51], a[112:115], v[16:31]
    v_mfma_f32_32x32x16_bf16 v[16:31], v[48:51], a[116:119], v[16:31]
    v_mfma_f32_32x32x16_bf16 v[16:31], v[48:51], a[120:123], v[16:31]
    v_mfma_f32_32x32x16_bf16 v[16:31], v[48:51], a[124:127], v[16:31]
    v_mfma_f32_32x32x16_bf16 v[16:31], v[48:51], a[128:131], v[16:31]
    v_mfma_f32_32x32x16_bf16 v[16:31], v[48:51], a[132:135], v[16:31]
    v_mfma_f32_32x32x16_bf16 v[16:31], v[48:51], a[136:139], v[16:31]
    v_mfma_f32_32x32x16_bf16 v[16:31], v[48:51], a[140:143], v[16:31]
    v_mfma_f32_32x32x16_bf16 v[32:47], v[48:51], a[144:147], 0
    v_mfma_f32_32x32x16_bf16 v[32:47], v[48:51], a[148:151], v[32:47]
    v_mfma_f32_32x32x16_bf16 v[32:47], v[48:51], a[152:155], v[32:47]
    v_mfma_f32_32x32x16_bf16 v[32:47], v[48:51], a[156:159], v[32:47]
    v_mfma_f32_32x32x16_bf16 v[32:47], v[48:51], a[160:163], v[32:47]
    v_mfma_f32_32x32x16_bf16 v[32:47], v[48:51], a[164:167], v[32:47]
    v_mfma_f32_32x32x16_bf16 v[32:47], v[48:51], a[168:171], v[32:47]
    v_mfma_f32_32x32x16_bf16 v[32:47], v[48:51], a[172:175], v[32:47]
    v_mfma_f32_32x32x16_bf16 v[32:47], v[48:51], a[176:179], v[32:47]
    v_mfma_f32_32x32x16_bf16 v[32:47], v[48:51], a[180:183], v[32:47]
    v_mfma_f32_32x32x16_bf16 v[32:47], v[48:51], a[184:187], v[32:47]
    v_mfma_f32_32x32x16_bf16 v[32:47], v[48:51], a[188:191], v[32:47]
    v_mfma_f32_32x32x16_bf16 v[32:47], v[48:51], a[192:195], v[32:47]
    v_mfma_f32_32x32x16_bf16 v[32:47], v[48:51], a[196:199], v[32:47]
    v_mfma_f32_32x32x16_bf16 v[32:47], v[48:51], a[200:203], v[32:47]
    v_mfma_f32_32x32x16_bf16 v[32:47], v[48:51], a[204:207], v[32:47]
    v_mfma_f32_32x32x16_bf16 v[32:47], v[48:51], a[208:211], v[32:47]
    v_mfma_f32_32x32x16_bf16 v[32:47], v[48:51], a[212:215], v[32:47]
    v_mfma_f32_32x32x16_bf16 v[32:47], v[48:51], a[216:219], v[32:47]
    v_mfma_f32_32x32x16_bf16 v[32:47], v[48:51], a[220:223], v[32:47]
    v_mfma_f32_32x32x16_bf16 v[32:47], v[48:51], a[224:227], v[32:47]
    v_mfma_f32_32x32x16_bf16 v[32:47], v[48:51], a[228:231], v[32:47]
    v_mfma_f32_32x32x16_bf16 v[32:47], v[48:51], a[232:235], v[32:47]
    v_mfma_f32_32x32x16_bf16 v[32:47], v[48:51], a[236:239], v[32:47]
    v_mfma_f32_32x32x16_bf16 v[32:47], v[48:51], a[240:243], v[32:47]
    v_mfma_f32_32x32x16_bf16 v[32:47], v[48:51], a[244:247], v[32:47]
    v_mfma_f32_32x32x16_bf16 v[32:47], v[48:51], a[248:251], v[32:47]
    v_mfma_f32_32x32x16_bf16 v[32:47], v[48:51], a[252:255], v[32:47]
    v_mfma_f32_32x32x16_bf16 v[32:47], v[48:51], v[224:227], v[32:47]
    v_mfma_f32_32x32x16_bf16 v[32:47], v[48:51], v[228:231], v[32:47]
    v_mfma_f32_32x32x16_bf16 v[32:47], v[48:51], v[232:235], v[32:47]
    v_mfma_f32_32x32x16_bf16 v[32:47], v[48:51], v[236:239], v[32:47]
    v_mfma_f32_32x32x16_bf16 v[32:47], v[48:51], v[240:243], v[32:47]
    v_mfma_f32_32x32x16_bf16 v[32:47], v[48:51], v[244:247], v[32:47]
    v_mfma_f32_32x32x16_bf16 v[32:47], v[48:51], v[248:251], v[32:47]
    v_mfma_f32_32x32x16_bf16 v[32:47], v[48:51], v[252:255], v[32:47]
    v_mov_b32 v11, v16
    s_nop 10
    v_mov_b32 v12, v32
    s_mov_b32 s66, 114688
    s_mov_b32 s71, 0x2000
    s_mov_b32 s36, s63
    s_mov_b32 s34, s63
    s_mov_b32 s37, 0
    s_lshl_b32 s56, s63, 6
    s_mul_i32 s58, s14, 9216
    s_mov_b32 s40, 36864
    s_mov_b32 s59, s58
    s_mov_b32 s43, 0
    s_mov_b32 s28, s8
    s_mov_b32 s29, s9
    s_mov_b32 s30, 0
    s_mov_b32 s31, 0x00020000
    s_mul_i32 s41, s63, 4718592
    s_add_u32 s41, s41, s58
    s_add_u32 s41, s41, 8650752
    s_mul_i32 s42, s56, 22528
    s_add_u32 s42, s42, 183808
    s_cmp_lg_u32 s14, 0
    s_cbranch_scc1 LpV_ini_d
    v_mov_b32 v5, 160
    s_mov_b32 s16, 0
LpV_ini:
    global_load_dword v6, v5, s[12:13] sc1
    s_add_u32 s16, s16, 1
    s_cmp_gt_u32 s16, 100000
    s_cbranch_scc1 L_role_p_abort
    s_waitcnt vmcnt(0)
    v_cmp_gt_u32 vcc, 123, v6
    s_nop 0
    s_cbranch_vccz LpV_ini_d
    s_sleep 8
    s_branch LpV_ini
LpV_ini_d:
    s_barrier
    s_branch LpV_poll
LpV_item:
    s_waitcnt vmcnt(4)
LpV_go:
    s_barrier
    s_xor_b32 s40, s40, 36864
    s_xor_b32 s59, s59, 36864
    s_xor_b32 s66, s66, 0x2000
    s_xor_b32 s71, s71, 0x2000
    s_mov_b32 s35, s37
    s_mov_b32 s57, s56
    s_add_u32 s37, s37, 1
    s_add_u32 s56, s56, 1
    s_add_u32 s41, s41, 36864
    s_add_u32 s42, s42, 22528
    s_mov_b32 s62, 0
    v_add_u32 v9, s40, v0
    v_add_u32 v5, s71, v10
    ds_read_b128 v[48:51], v9 offset:0
    ds_read_b128 v[52:55], v9 offset:1024
    ds_read_b128 v[56:59], v9 offset:2048
    s_waitcnt lgkmcnt(2)
    v_mfma_f32_32x32x16_bf16 v[16:31], v[48:51], a[0:3], 0
    ds_read_b128 v[60:63], v9 offset:3072
    ds_read_b128 v[96:99], v5 offset:0
    ds_read_b128 v[100:103], v5 offset:512
    s_waitcnt lgkmcnt(4)
    v_mfma_f32_32x32x16_bf16 v[16:31], v[52:55], a[4:7], v[16:31]
    ds_read_b128 v[64:67], v9 offset:4096
    ds_read_b128 v[104:107], v5 offset:1024
    ds_read_b128 v[108:111], v5 offset:1536
    s_waitcnt lgkmcnt(6)
    v_mfma_f32_32x32x16_bf16 v[16:31], v[56:59], a[8:11], v[16:31]
    ds_read_b128 v[68:71], v9 offset:5120
    ds_read_b128 v[112:115], v5 offset:2048
    s_waitcnt lgkmcnt(7)
    v_mfma_f32_32x32x16_bf16 v[16:31], v[60:63], a[12:15], v[16:31]
    ds_read_b128 v[72:75], v9 offset:6144
    s_waitcnt lgkmcnt(6)
    v_add_f32 v96, v96, v100
    s_waitcnt lgkmcnt(5)
    v_mfma_f32_32x32x16_bf16 v[16:31], v[64:67], a[16:19], v[16:31]
    ds_read_b128 v[76:79], v9 offset:7168
    v_add_f32 v97, v97, v101
    v_add_f32 v98, v98, v102
    s_waitcnt lgkmcnt(3)
    v_mfma_f32_32x32x16_bf16 v[16:31], v[68:71], a[20:23], v[16:31]
    ds_read_b128 v[80:83], v9 offset:8192
    v_add_f32 v99, v99, v103
    v_add_f32 v96, v96, v104
    s_waitcnt lgkmcnt(2)
    v_mfma_f32_32x32x16_bf16 v[16:31], v[72:75], a[24:27], v[16:31]
    ds_read_b128 v[84:87], v9 offset:9216
    v_add_f32 v97, v97, v105
    v_add_f32 v98, v98, v106
    s_waitcnt lgkmcnt(2)
    v_mfma_f32_32x32x16_bf16 v[16:31], v[76:79], a[28:31], v[16:31]
    ds_read_b128 v[88:91], v9 offset:10240
    v_add_f32 v99, v99, v107
    v_add_f32 v96, v96, v108
    s_waitcnt lgkmcnt(2)
    v_mfma_f32_32x32x16_bf16 v[16:31], v[80:83], a[32:35], v[16:31]
    ds_read_b128 v[92:95], v9 offset:11264
    v_add_f32 v97, v97, v109
    v_add_f32 v98, v98, v110
    v_mfma_f32_32x32x16_bf16 v[32:47], v[48:51], a[144:147], 0
    v_add_f32 v99, v99, v111
    v_add_f32 v96, v96, v112
    s_waitcnt lgkmcnt(2)
    v_mfma_f32_32x32x16_bf16 v[16:31], v[84:87], a[36:39], v[16:31]
    ds_read_b128 v[48:51], v9 offset:12288
    v_add_f32 v97, v97, v113
    v_add_f32 v98, v98, v114
    v_mfma_f32_32x32x16_bf16 v[32:47], v[52:55], a[148:151], v[32:47]
    v_add_f32 v99, v99, v115
    v_add_f32 v96, v96, v98
    s_waitcnt lgkmcnt(2)
    v_mfma_f32_32x32x16_bf16 v[16:31], v[88:91], a[40:43], v[16:31]
    ds_read_b128 v[52:55], v9 offset:13312
    v_add_f32 v97, v97, v99
    v_mov_b32 v98, v96
    v_mfma_f32_32x32x16_bf16 v[32:47], v[56:59], a[152:155], v[32:47]
    v_mov_b32 v99, v97
    v_permlane32_swap_b32 v96, v98
    s_waitcnt lgkmcnt(2)
    v_mfma_f32_32x32x16_bf16 v[16:31], v[92:95], a[44:47], v[16:31]
    ds_read_b128 v[56:59], v9 offset:14336
    v_permlane32_swap_b32 v97, v99
    v_add_f32 v96, v96, v98
    v_mfma_f32_32x32x16_bf16 v[32:47], v[60:63], a[156:159], v[32:47]
    v_add_f32 v97, v97, v99
    v_mul_f32 v96, 0x3ae38e39, v96
    s_waitcnt lgkmcnt(2)
    v_mfma_f32_32x32x16_bf16 v[16:31], v[48:51], a[48:51], v[16:31]
    ds_read_b128 v[60:63], v9 offset:15360
    v_mul_f32 v97, 0x3ae38e39, v97
    v_fma_f32 v97, -v96, v96, v97
    v_mfma_f32_32x32x16_bf16 v[32:47], v[64:67], a[160:163], v[32:47]
    v_max_f32 v97, 0, v97
    v_add_f32 v97, 0x3727c5ac, v97
    s_waitcnt lgkmcnt(2)
    v_mfma_f32_32x32x16_bf16 v[16:31], v[52:55], a[52:55], v[16:31]
    ds_read_b128 v[64:67], v9 offset:16384
    v_rsq_f32 v116, v97
    s_nop 0
    v_mul_f32 v117, v96, v116
    v_mfma_f32_32x32x16_bf16 v[32:47], v[68:71], a[164:167], v[32:47]
    ds_write2_b32 v14, v116, v117 offset0:0 offset1:32
    ds_read_b128 v[116:119], v214 offset:0
    s_waitcnt lgkmcnt(4)
    v_mfma_f32_32x32x16_bf16 v[16:31], v[56:59], a[56:59], v[16:31]
    ds_read_b128 v[68:71], v9 offset:17408
    s_waitcnt vmcnt(0)
    buffer_load_dword v2, v1, s[8:11], s42 offen sc1
    s_cmp_lg_u32 s43, 0
    s_cselect_b64 exec, 1, 0
    buffer_store_dwordx2 v[212:213], v4, s[8:11], s43 offen sc1
    s_mov_b64 exec, -1
    s_mov_b32 s43, 0
    v_mfma_f32_32x32x16_bf16 v[32:47], v[72:75], a[168:171], v[32:47]
    ds_read_b128 v[120:123], v214 offset:32
    ds_read_b128 v[124:127], v214 offset:64
    s_waitcnt lgkmcnt(6)
    v_mfma_f32_32x32x16_bf16 v[16:31], v[60:63], a[60:63], v[16:31]
    ds_read_b128 v[72:75], v9 offset:18432
    ds_read_b128 v[128:131], v214 offset:96
    ds_read_b128 v[132:135], v214 offset:128
    v_mfma_f32_32x32x16_bf16 v[32:47], v[76:79], a[172:175], v[32:47]
    ds_read_b128 v[136:139], v214 offset:160
    ds_read_b128 v[140:143], v214 offset:192
    s_waitcnt lgkmcnt(10)
    v_mfma_f32_32x32x16_bf16 v[16:31], v[64:67], a[64:67], v[16:31]
    ds_read_b128 v[76:79], v9 offset:19456
    ds_read_b128 v[144:147], v214 offset:224
    s_mul_i32 s46, s34, 50331648
    v_mfma_f32_32x32x16_bf16 v[32:47], v[80:83], a[176:179], v[32:47]
    s_lshl_b32 s19, s35, 18
    s_add_u32 s46, s46, s19
    s_waitcnt lgkmcnt(9)
    v_mfma_f32_32x32x16_bf16 v[16:31], v[68:71], a[68:71], v[16:31]
    ds_read_b128 v[80:83], v9 offset:20480
    s_add_u32 s46, s46, s52
    v_mfma_f32_32x32x16_bf16 v[32:47], v[84:87], a[180:183], v[32:47]
    s_waitcnt lgkmcnt(7)
    v_mfma_f32_32x32x16_bf16 v[16:31], v[72:75], a[72:75], v[16:31]
    ds_read_b128 v[84:87], v9 offset:21504
    v_mfma_f32_32x32x16_bf16 v[32:47], v[88:91], a[184:187], v[32:47]
    s_waitcnt lgkmcnt(3)
    v_mfma_f32_32x32x16_bf16 v[16:31], v[76:79], a[76:79], v[16:31]
    ds_read_b128 v[88:91], v9 offset:22528
    v_mfma_f32_32x32x16_bf16 v[32:47], v[92:95], a[188:191], v[32:47]
    s_waitcnt lgkmcnt(2)
    v_mfma_f32_32x32x16_bf16 v[16:31], v[80:83], a[80:83], v[16:31]
    ds_read_b128 v[92:95], v9 offset:23552
    v_mfma_f32_32x32x16_bf16 v[32:47], v[48:51], a[192:195], v[32:47]
    s_waitcnt lgkmcnt(2)
    v_mfma_f32_32x32x16_bf16 v[16:31], v[84:87], a[84:87], v[16:31]
    ds_read_b128 v[48:51], v9 offset:24576
    v_mfma_f32_32x32x16_bf16 v[32:47], v[52:55], a[196:199], v[32:47]
    s_waitcnt lgkmcnt(2)
    v_mfma_f32_32x32x16_bf16 v[16:31], v[88:91], a[88:91], v[16:31]
    ds_read_b128 v[52:55], v9 offset:25600
    v_mfma_f32_32x32x16_bf16 v[32:47], v[56:59], a[200:203], v[32:47]
    s_waitcnt lgkmcnt(2)
    v_mfma_f32_32x32x16_bf16 v[16:31], v[92:95], a[92:95], v[16:31]
    ds_read_b128 v[56:59], v9 offset:26624
    v_mfma_f32_32x32x16_bf16 v[32:47], v[60:63], a[204:207], v[32:47]
    s_waitcnt lgkmcnt(2)
    v_mfma_f32_32x32x16_bf16 v[16:31], v[48:51], a[96:99], v[16:31]
    ds_read_b128 v[60:63], v9 offset:27648
    v_mfma_f32_32x32x16_bf16 v[32:47], v[64:67], a[208:211], v[32:47]
    s_waitcnt lgkmcnt(2)
    v_mfma_f32_32x32x16_bf16 v[16:31], v[52:55], a[100:103], v[16:31]
    ds_read_b128 v[64:67], v9 offset:28672
    s_waitcnt vmcnt(1)
    v_cmp_eq_u32 vcc, 0, v2
    s_nop 0
    s_cmp_eq_u64 vcc, 0
    s_cselect_b32 s62, 1, 0
    s_cmp_lt_u32 s37, 64
    s_cselect_b32 s62, s62, 0
    s_cmp_lg_u32 s62, 0
    s_cselect_b32 s30, 268435456, 0
    v_mfma_f32_32x32x16_bf16 v[32:47], v[68:71], a[212:215], v[32:47]
    s_waitcnt lgkmcnt(2)
    v_mfma_f32_32x32x16_bf16 v[16:31], v[56:59], a[104:107], v[16:31]
    ds_read_b128 v[68:71], v9 offset:29696
    s_add_u32 m0, s59, 0
    s_add_u32 s47, s41, 0
    buffer_load_dwordx4 v0, s[28:31], s47 offen offset:0 lds
    v_mfma_f32_32x32x16_bf16 v[32:47], v[72:75], a[216:219], v[32:47]
    s_waitcnt lgkmcnt(2)
    v_mfma_f32_32x32x16_bf16 v[16:31], v[60:63], a[108:111], v[16:31]
    ds_read_b128 v[72:75], v9 offset:30720
    buffer_load_dwordx4 v0, s[28:31], s47 offen offset:1024 lds
    v_mfma_f32_32x32x16_bf16 v[32:47], v[76:79], a[220:223], v[32:47]
    s_waitcnt lgkmcnt(2)
    v_mfma_f32_32x32x16_bf16 v[16:31], v[64:67], a[112:115], v[16:31]
    ds_read_b128 v[76:79], v9 offset:31744
    buffer_load_dwordx4 v0, s[28:31], s47 offen offset:2048 lds
    v_mfma_f32_32x32x16_bf16 v[32:47], v[80:83], a[224:227], v[32:47]
    s_waitcnt lgkmcnt(2)
    v_mfma_f32_32x32x16_bf16 v[16:31], v[68:71], a[116:119], v[16:31]
    ds_read_b128 v[80:83], v9 offset:32768
    buffer_load_dwordx4 v0, s[28:31], s47 offen offset:3072 lds
    v_mfma_f32_32x32x16_bf16 v[32:47], v[84:87], a[228:231], v[32:47]
    s_waitcnt lgkmcnt(2)
    v_mfma_f32_32x32x16_bf16 v[16:31], v[72:75], a[120:123], v[16:31]
    ds_read_b128 v[84:87], v9 offset:33792
    s_add_u32 m0, s59, 4096
    s_add_u32 s47, s41, 4096
    buffer_load_dwordx4 v0, s[28:31], s47 offen offset:0 lds
    v_mfma_f32_32x32x16_bf16 v[32:47], v[88:91], a[232:235], v[32:47]
    s_waitcnt lgkmcnt(2)
    v_mfma_f32_32x32x16_bf16 v[16:31], v[76:79], a[124:127], v[16:31]
    ds_read_b128 v[88:91], v9 offset:34816
    buffer_load_dwordx4 v0, s[28:31], s47 offen offset:1024 lds
    v_mfma_f32_32x32x16_bf16 v[32:47], v[92:95], a[236:239], v[32:47]
    s_waitcnt lgkmcnt(2)
    v_mfma_f32_32x32x16_bf16 v[16:31], v[80:83], a[128:131], v[16:31]
    ds_read_b128 v[92:95], v9 offset:35840
    buffer_load_dwordx4 v0, s[28:31], s47 offen offset:2048 lds
    v_mfma_f32_32x32x16_bf16 v[32:47], v[48:51], a[240:243], v[32:47]
    s_waitcnt lgkmcnt(2)
    v_mfma_f32_32x32x16_bf16 v[16:31], v[84:87], a[132:135], v[16:31]
    buffer_load_dwordx4 v0, s[28:31], s47 offen offset:3072 lds
    v_mfma_f32_32x32x16_bf16 v[32:47], v[52:55], a[244:247], v[32:47]
    s_waitcnt lgkmcnt(1)
    v_mfma_f32_32x32x16_bf16 v[16:31], v[88:91], a[136:139], v[16:31]
    s_add_u32 m0, s59, 8192
    s_add_u32 s47, s41, 8192
    buffer_load_dwordx4 v0, s[28:31], s47 offen offset:0 lds
    v_mfma_f32_32x32x16_bf16 v[32:47], v[56:59], a[248:251], v[32:47]
    s_waitcnt lgkmcnt(0)
    v_mfma_f32_32x32x16_bf16 v[16:31], v[92:95], a[140:143], v[16:31]
    s_mul_i32 s48, s36, 786432
    s_mul_i32 s18, s37, 6144
    s_add_u32 s48, s48, s18
    s_add_u32 s48, s48, 16125952
    s_add_u32 m0, s66, 4096
    s_nop 0
    buffer_load_dwordx4 v0, s[28:31], s48 offen lds
    v_mfma_f32_32x32x16_bf16 v[32:47], v[60:63], a[252:255], v[32:47]
    v_mfma_f32_32x32x16_bf16 v[32:47], v[64:67], v[224:227], v[32:47]
    s_add_u32 m0, s66, s67
    s_sub_u32 s48, s48, 4096
    s_add_u32 s48, s48, s67
    buffer_load_dwordx4 v0, s[28:31], s48 offen lds
    v_mfma_f32_32x32x16_bf16 v[32:47], v[68:71], v[228:231], v[32:47]
    v_mul_f32 v180, v11, v132
    v_fma_f32 v16, v16, v116, -v180
    v_mul_f32 v181, v11, v133
    v_fma_f32 v17, v17, v117, -v181
    v_cvt_pk_bf16_f32 v196, v16, v17
    v_mfma_f32_32x32x16_bf16 v[32:47], v[72:75], v[232:235], v[32:47]
    v_mul_f32 v182, v11, v134
    v_fma_f32 v18, v18, v118, -v182
    v_mul_f32 v183, v11, v135
    v_fma_f32 v19, v19, v119, -v183
    v_cvt_pk_bf16_f32 v197, v18, v19
    v_mfma_f32_32x32x16_bf16 v[32:47], v[76:79], v[236:239], v[32:47]
    v_mul_f32 v188, v11, v140
    v_fma_f32 v24, v24, v124, -v188
    v_mul_f32 v189, v11, v141
    v_fma_f32 v25, v25, v125, -v189
    v_cvt_pk_bf16_f32 v198, v24, v25
    v_mfma_f32_32x32x16_bf16 v[32:47], v[80:83], v[240:243], v[32:47]
    v_mul_f32 v190, v11, v142
    v_fma_f32 v26, v26, v126, -v190
    v_mul_f32 v191, v11, v143
    v_fma_f32 v27, v27, v127, -v191
    v_cvt_pk_bf16_f32 v199, v26, v27
    v_mfma_f32_32x32x16_bf16 v[32:47], v[84:87], v[244:247], v[32:47]
    buffer_store_dwordx4 v[196:199], v13, s[8:11], s46 offen offset:0 sc1
    v_mul_f32 v184, v11, v136
    v_fma_f32 v20, v20, v120, -v184
    v_mul_f32 v185, v11, v137
    v_fma_f32 v21, v21, v121, -v185
    v_mfma_f32_32x32x16_bf16 v[32:47], v[88:91], v[248:251], v[32:47]
    v_cvt_pk_bf16_f32 v200, v20, v21
    v_mul_f32 v186, v11, v138
    v_fma_f32 v22, v22, v122, -v186
    v_mul_f32 v187, v11, v139
    v_fma_f32 v23, v23, v123, -v187
    v_mfma_f32_32x32x16_bf16 v[32:47], v[92:95], v[252:255], v[32:47]
    v_cvt_pk_bf16_f32 v201, v22, v23
    v_mul_f32 v192, v11, v144
    v_fma_f32 v28, v28, v128, -v192
    v_mul_f32 v193, v11, v145
    v_fma_f32 v29, v29, v129, -v193
    v_cvt_pk_bf16_f32 v202, v28, v29
    v_mul_f32 v194, v11, v146
    v_fma_f32 v30, v30, v130, -v194
    v_mul_f32 v195, v11, v147
    v_fma_f32 v31, v31, v131, -v195
    v_cvt_pk_bf16_f32 v203, v30, v31
    buffer_store_dwordx4 v[200:203], v13, s[8:11], s46 offen offset:512 sc1
    v_mul_f32 v180, v12, v132
    v_fma_f32 v32, v32, v116, -v180
    v_mul_f32 v181, v12, v133
    v_fma_f32 v33, v33, v117, -v181
    v_cvt_pk_bf16_f32 v196, v32, v33
    v_mul_f32 v182, v12, v134
    v_fma_f32 v34, v34, v118, -v182
    v_mul_f32 v183, v12, v135
    v_fma_f32 v35, v35, v119, -v183
    v_cvt_pk_bf16_f32 v197, v34, v35
    v_mul_f32 v188, v12, v140
    v_fma_f32 v40, v40, v124, -v188
    v_mul_f32 v189, v12, v141
    v_fma_f32 v41, v41, v125, -v189
    v_cvt_pk_bf16_f32 v198, v40, v41
    v_mul_f32 v190, v12, v142
    v_fma_f32 v42, v42, v126, -v190
    v_mul_f32 v191, v12, v143
    v_fma_f32 v43, v43, v127, -v191
    v_cvt_pk_bf16_f32 v199, v42, v43
    buffer_store_dwordx4 v[196:199], v13, s[8:11], s46 offen offset:2048 sc1
    v_mul_f32 v184, v12, v136
    v_fma_f32 v36, v36, v120, -v184
    v_mul_f32 v185, v12, v137
    v_fma_f32 v37, v37, v121, -v185
    v_cvt_pk_bf16_f32 v200, v36, v37
    v_mul_f32 v186, v12, v138
    v_fma_f32 v38, v38, v122, -v186
    v_mul_f32 v187, v12, v139
    v_fma_f32 v39, v39, v123, -v187
    v_cvt_pk_bf16_f32 v201, v38, v39
    v_mul_f32 v192, v12, v144
    v_fma_f32 v44, v44, v128, -v192
    v_mul_f32 v193, v12, v145
    v_fma_f32 v45, v45, v129, -v193
    v_cvt_pk_bf16_f32 v202, v44, v45
    v_mul_f32 v194, v12, v146
    v_fma_f32 v46, v46, v130, -v194
    v_mul_f32 v195, v12, v147
    v_fma_f32 v47, v47, v131, -v195
    v_cvt_pk_bf16_f32 v203, v46, v47
    buffer_store_dwordx4 v[200:203], v13, s[8:11], s46 offen offset:2560 sc1
    s_mul_i32 s43, s57, 22528
    s_add_u32 s43, s43, s49
    s_cmp_lg_u32 s62, 0
    s_cbranch_scc1 LpV_item
    buffer_load_dword v2, v1, s[8:11], s42 offen sc1
    s_waitcnt vmcnt(0)
    s_cmp_ge_u32 s37, 64
    s_cbranch_scc1 LpV_fin
    v_cmp_eq_u32 vcc, 0, v2
    s_nop 0
    s_cbranch_vccnz LpV_pub
    s_add_u32 m0, s59, 0
    s_add_u32 s47, s41, 0
    buffer_load_dwordx4 v0, s[8:11], s47 offen offset:0 lds
    buffer_load_dwordx4 v0, s[8:11], s47 offen offset:1024 lds
    buffer_load_dwordx4 v0, s[8:11], s47 offen offset:2048 lds
    buffer_load_dwordx4 v0, s[8:11], s47 offen offset:3072 lds
    s_add_u32 m0, s59, 4096
    s_add_u32 s47, s41, 4096
    buffer_load_dwordx4 v0, s[8:11], s47 offen offset:0 lds
    buffer_load_dwordx4 v0, s[8:11], s47 offen offset:1024 lds
    buffer_load_dwordx4 v0, s[8:11], s47 offen offset:2048 lds
    buffer_load_dwordx4 v0, s[8:11], s47 offen offset:3072 lds
    s_add_u32 m0, s59, 8192
    s_add_u32 s47, s41, 8192
    buffer_load_dwordx4 v0, s[8:11], s47 offen offset:0 lds
    s_mul_i32 s48, s36, 786432
    s_mul_i32 s18, s37, 6144
    s_add_u32 s48, s48, s18
    s_add_u32 s48, s48, 16125952
    s_add_u32 m0, s66, 4096
    s_nop 0
    buffer_load_dwordx4 v0, s[8:11], s48 offen lds
    s_add_u32 m0, s66, s67
    s_sub_u32 s48, s48, 4096
    s_add_u32 s48, s48, s67
    buffer_load_dwordx4 v0, s[8:11], s48 offen lds
    s_cmp_lg_u32 s43, 0
    s_cselect_b64 exec, 1, 0
    buffer_store_dwordx2 v[212:213], v4, s[8:11], s43 offen sc1
    s_mov_b64 exec, -1
    s_mov_b32 s43, 0
    s_waitcnt vmcnt(1)
    s_branch LpV_go
LpV_fin:
    s_cmp_lg_u32 s43, 0
    s_cselect_b64 exec, 1, 0
    buffer_store_dwordx2 v[212:213], v4, s[8:11], s43 offen sc1
    s_mov_b64 exec, -1
    s_mov_b32 s43, 0
    s_branch L_role_p_exit
LpV_pub:
    s_cmp_lg_u32 s43, 0
    s_cselect_b64 exec, 1, 0
    buffer_store_dwordx2 v[212:213], v4, s[8:11], s43 offen sc1
    s_mov_b64 exec, -1
    s_mov_b32 s43, 0
LpV_poll:
    s_mov_b32 s16, 0
LpV_pl:
    buffer_load_dword v2, v1, s[8:11], s42 offen sc1
    s_add_u32 s16, s16, 1
    s_cmp_gt_u32 s16, 100000
    s_cbranch_scc1 L_role_p_abort
    s_waitcnt vmcnt(0)
    v_cmp_eq_u32 vcc, 0, v2
    s_nop 0
    s_cbranch_vccz LpV_pld
    s_sleep 4
    s_branch LpV_pl
LpV_pld:
    s_add_u32 m0, s59, 0
    s_add_u32 s47, s41, 0
    buffer_load_dwordx4 v0, s[8:11], s47 offen offset:0 lds
    buffer_load_dwordx4 v0, s[8:11], s47 offen offset:1024 lds
    buffer_load_dwordx4 v0, s[8:11], s47 offen offset:2048 lds
    buffer_load_dwordx4 v0, s[8:11], s47 offen offset:3072 lds
    s_add_u32 m0, s59, 4096
    s_add_u32 s47, s41, 4096
    buffer_load_dwordx4 v0, s[8:11], s47 offen offset:0 lds
    buffer_load_dwordx4 v0, s[8:11], s47 offen offset:1024 lds
    buffer_load_dwordx4 v0, s[8:11], s47 offen offset:2048 lds
    buffer_load_dwordx4 v0, s[8:11], s47 offen offset:3072 lds
    s_add_u32 m0, s59, 8192
    s_add_u32 s47, s41, 8192
    buffer_load_dwordx4 v0, s[8:11], s47 offen offset:0 lds
    s_mul_i32 s48, s36, 786432
    s_mul_i32 s18, s37, 6144
    s_add_u32 s48, s48, s18
    s_add_u32 s48, s48, 16125952
    s_add_u32 m0, s66, 4096
    s_nop 0
    buffer_load_dwordx4 v0, s[8:11], s48 offen lds
    s_add_u32 m0, s66, s67
    s_sub_u32 s48, s48, 4096
    s_add_u32 s48, s48, s67
    buffer_load_dwordx4 v0, s[8:11], s48 offen lds
    s_waitcnt vmcnt(0)
    s_branch LpV_go
L_role_p_abort:
    s_waitcnt lgkmcnt(0)
    s_mov_b64 exec, -1
    v_mov_b32 v0, 60
    s_lshl_b32 s5, s3, 8
    s_or_b32 s5, s5, s4
    s_or_b32 s5, s5, 0x10000
    v_mov_b32 v1, s5
    global_store_dword v0, v1, s[12:13]
    s_endpgm
L_role_p_exit:
    s_cmp_lg_u32 s63, 0
    s_cbranch_scc1 L_p_end
    s_cmp_ge_u32 s15, 24
    s_cbranch_scc1 L_p_end
    s_add_u32 s15, s15, 36
    v_lshrrev_b32 v0, 4, v0
    s_waitcnt vmcnt(0) lgkmcnt(0)
    s_barrier
    s_branch L_role_tw
L_p_end:
    s_endpgm
.p2align 6
L_role_tw:
    v_and_b32 v5, 63, v0
    v_lshlrev_b32 v0, 4, v5
    v_and_b32 v7, 15, v5
    v_lshrrev_b32 v8, 4, v5
    v_min_u32 v1, 31, v5
    v_lshrrev_b32 v6, 2, v1
    v_and_b32 v1, 3, v1
    v_lshlrev_b32 v1, 2, v1
    v_lshl_add_u32 v1, v6, 7, v1
    v_mov_b32 v3, 1
    v_mov_b32 v4, 0
    s_mov_b32 s44, 0x05040100
    s_mov_b32 s45, 0x07060302
    s_cmp_lt_u32 s15, 24
    s_cbranch_scc1 Ltw_noord
    s_cmp_lg_u32 s14, 0
    s_cbranch_scc1 Ltw_ord_d
    v_mov_b32 v5, 48
    s_mov_b32 s16, 0
Ltw_ord:
    global_load_dword v6, v5, s[12:13] sc1
    s_add_u32 s16, s16, 1
    s_cmp_gt_u32 s16, 100000
    s_cbranch_scc1 L_role_tw_abort
    s_waitcnt vmcnt(0)
    v_cmp_gt_u32 vcc, 1, v6
    s_nop 0
    s_cbranch_vccz Ltw_ord_d
    s_sleep 64
    s_branch Ltw_ord
Ltw_ord_d:
    s_barrier
Ltw_noord:
    s_load_dwordx2 s[20:21], s[0:1], 64
    s_mov_b32 s22, 4718592
    s_mov_b32 s23, 0x00020000
    s_waitcnt lgkmcnt(0)
    s_and_b32 s21, s21, 0xffff
    s_load_dwordx2 s[24:25], s[0:1], 80
    s_mov_b32 s26, 2359296
    s_mov_b32 s27, 0x00020000
    s_waitcnt lgkmcnt(0)
    s_and_b32 s25, s25, 0xffff
    s_mul_i32 s17, s15, 43
    s_lshr_b32 s32, s17, 9
    s_mul_i32 s17, s32, 12
    s_sub_u32 s50, s15, s17
    s_add_u32 s33, s32, 31
    s_cmp_eq_u32 s32, 2
    s_cselect_b32 s33, 0, s33
    s_cmp_lt_u32 s32, 2
    s_cselect_b32 s33, 64, s33
    s_cselect_b32 s32, s32, 64
    s_mul_i32 s49, s50, 96
    s_mul_i32 s17, s14, 1179648
    s_add_u32 s49, s49, s17
    v_mul_u32_u24 v5, 4608, v8
    v_lshl_add_u32 v9, v7, 2, v5
    v_add_u32 v10, 18432, v9
    v_and_b32 v6, 14, v7
    v_lshl_add_u32 v12, v6, 1, v5
    v_add_u32 v12, 64, v12
    v_add_u32 v13, 18432, v12
    v_and_b32 v5, 1, v7
    v_mov_b32 v11, s44
    v_mov_b32 v6, s45
    v_cmp_eq_u32 vcc, 1, v5
    s_nop 1
    v_cndmask_b32 v11, v11, v6, vcc
    s_add_u32 s17, s49, 0
    buffer_load_dword v16, v9, s[20:23], s17 offen
    buffer_load_dword v17, v10, s[20:23], s17 offen
    buffer_load_dword v18, v12, s[20:23], s17 offen
    buffer_load_dword v19, v13, s[20:23], s17 offen
    s_add_u32 s17, s49, 1152
    buffer_load_dword v20, v9, s[20:23], s17 offen
    buffer_load_dword v21, v10, s[20:23], s17 offen
    buffer_load_dword v22, v12, s[20:23], s17 offen
    buffer_load_dword v23, v13, s[20:23], s17 offen
    s_add_u32 s17, s49, 2304
    buffer_load_dword v24, v9, s[20:23], s17 offen
    buffer_load_dword v25, v10, s[20:23], s17 offen
    buffer_load_dword v26, v12, s[20:23], s17 offen
    buffer_load_dword v27, v13, s[20:23], s17 offen
    s_add_u32 s17, s49, 3456
    buffer_load_dword v28, v9, s[20:23], s17 offen
    buffer_load_dword v29, v10, s[20:23], s17 offen
    buffer_load_dword v30, v12, s[20:23], s17 offen
    buffer_load_dword v31, v13, s[20:23], s17 offen
    s_add_u32 s17, s49, 36864
    buffer_load_dword v32, v9, s[20:23], s17 offen
    buffer_load_dword v33, v10, s[20:23], s17 offen
    buffer_load_dword v34, v12, s[20:23], s17 offen
    buffer_load_dword v35, v13, s[20:23], s17 offen
    s_add_u32 s17, s49, 38016
    buffer_load_dword v36, v9, s[20:23], s17 offen
    buffer_load_dword v37, v10, s[20:23], s17 offen
    buffer_load_dword v38, v12, s[20:23], s17 offen
    buffer_load_dword v39, v13, s[20:23], s17 offen
    s_add_u32 s17, s49, 39168
    buffer_load_dword v40, v9, s[20:23], s17 offen
    buffer_load_dword v41, v10, s[20:23], s17 offen
    buffer_load_dword v42, v12, s[20:23], s17 offen
    buffer_load_dword v43, v13, s[20:23], s17 offen
    s_add_u32 s17, s49, 40320
    buffer_load_dword v44, v9, s[20:23], s17 offen
    buffer_load_dword v45, v10, s[20:23], s17 offen
    buffer_load_dword v46, v12, s[20:23], s17 offen
    buffer_load_dword v47, v13, s[20:23], s17 offen
    s_add_u32 s17, s49, 73728
    buffer_load_dword v48, v9, s[20:23], s17 offen
    buffer_load_dword v49, v10, s[20:23], s17 offen
    buffer_load_dword v50, v12, s[20:23], s17 offen
    buffer_load_dword v51, v13, s[20:23], s17 offen
    s_add_u32 s17, s49, 74880
    buffer_load_dword v52, v9, s[20:23], s17 offen
    buffer_load_dword v53, v10, s[20:23], s17 offen
    buffer_load_dword v54, v12, s[20:23], s17 offen
    buffer_load_dword v55, v13, s[20:23], s17 offen
    s_add_u32 s17, s49, 76032
    buffer_load_dword v56, v9, s[20:23], s17 offen
    buffer_load_dword v57, v10, s[20:23], s17 offen
    buffer_load_dword v58, v12, s[20:23], s17 offen
    buffer_load_dword v59, v13, s[20:23], s17 offen
    s_add_u32 s17, s49, 77184
    buffer_load_dword v60, v9, s[20:23], s17 offen
    buffer_load_dword v61, v10, s[20:23], s17 offen
    buffer_load_dword v62, v12, s[20:23], s17 offen
    buffer_load_dword v63, v13, s[20:23], s17 offen
    s_add_u32 s17, s49, 110592
    buffer_load_dword v64, v9, s[20:23], s17 offen
    buffer_load_dword v65, v10, s[20:23], s17 offen
    buffer_load_dword v66, v12, s[20:23], s17 offen
    buffer_load_dword v67, v13, s[20:23], s17 offen
    s_add_u32 s17, s49, 111744
    buffer_load_dword v68, v9, s[20:23], s17 offen
    buffer_load_dword v69, v10, s[20:23], s17 offen
    buffer_load_dword v70, v12, s[20:23], s17 offen
    buffer_load_dword v71, v13, s[20:23], s17 offen
    s_add_u32 s17, s49, 112896
    buffer_load_dword v72, v9, s[20:23], s17 offen
    buffer_load_dword v73, v10, s[20:23], s17 offen
    buffer_load_dword v74, v12, s[20:23], s17 offen
    buffer_load_dword v75, v13, s[20:23], s17 offen
    s_waitcnt vmcnt(58)
    v_perm_b32 v5, v17, v16, s44
    v_perm_b32 v6, v17, v16, s45
    s_waitcnt vmcnt(56)
    v_perm_b32 v128, v19, v18, v11
    v_accvgpr_write_b32 a0, v5
    v_accvgpr_write_b32 a4, v6
    s_add_u32 s17, s49, 114048
    buffer_load_dword v76, v9, s[20:23], s17 offen
    buffer_load_dword v77, v10, s[20:23], s17 offen
    buffer_load_dword v78, v12, s[20:23], s17 offen
    buffer_load_dword v79, v13, s[20:23], s17 offen
    s_waitcnt vmcnt(58)
    v_perm_b32 v5, v21, v20, s44
    v_perm_b32 v6, v21, v20, s45
    s_waitcnt vmcnt(56)
    v_perm_b32 v129, v23, v22, v11
    v_accvgpr_write_b32 a1, v5
    v_accvgpr_write_b32 a5, v6
    s_add_u32 s17, s49, 147456
    buffer_load_dword v80, v9, s[20:23], s17 offen
    buffer_load_dword v81, v10, s[20:23], s17 offen
    buffer_load_dword v82, v12, s[20:23], s17 offen
    buffer_load_dword v83, v13, s[20:23], s17 offen
    s_waitcnt vmcnt(58)
    v_perm_b32 v5, v25, v24, s44
    v_perm_b32 v6, v25, v24, s45
    s_waitcnt vmcnt(56)
    v_perm_b32 v130, v27, v26, v11
    v_accvgpr_write_b32 a2, v5
    v_accvgpr_write_b32 a6, v6
    s_add_u32 s17, s49, 148608
    buffer_load_dword v84, v9, s[20:23], s17 offen
    buffer_load_dword v85, v10, s[20:23], s17 offen
    buffer_load_dword v86, v12, s[20:23], s17 offen
    buffer_load_dword v87, v13, s[20:23], s17 offen
    s_waitcnt vmcnt(58)
    v_perm_b32 v5, v29, v28, s44
    v_perm_b32 v6, v29, v28, s45
    s_waitcnt vmcnt(56)
    v_perm_b32 v131, v31, v30, v11
    v_accvgpr_write_b32 a3, v5
    v_accvgpr_write_b32 a7, v6
    s_add_u32 s17, s49, 149760
    buffer_load_dword v88, v9, s[20:23], s17 offen
    buffer_load_dword v89, v10, s[20:23], s17 offen
    buffer_load_dword v90, v12, s[20:23], s17 offen
    buffer_load_dword v91, v13, s[20:23], s17 offen
    s_waitcnt vmcnt(58)
    v_perm_b32 v5, v33, v32, s44
    v_perm_b32 v6, v33, v32, s45
    s_waitcnt vmcnt(56)
    v_perm_b32 v132, v35, v34, v11
    v_accvgpr_write_b32 a8, v5
    v_accvgpr_write_b32 a12, v6
    s_add_u32 s17, s49, 150912
    buffer_load_dword v92, v9, s[20:23], s17 offen
    buffer_load_dword v93, v10, s[20:23], s17 offen
    buffer_load_dword v94, v12, s[20:23], s17 offen
    buffer_load_dword v95, v13, s[20:23], s17 offen
    s_waitcnt vmcnt(58)
    v_perm_b32 v5, v37, v36, s44
    v_perm_b32 v6, v37, v36, s45
    s_waitcnt vmcnt(56)
    v_perm_b32 v133, v39, v38, v11
    v_accvgpr_write_b32 a9, v5
    v_accvgpr_write_b32 a13, v6
    s_add_u32 s17, s49, 184320
    buffer_load_dword v96, v9, s[20:23], s17 offen
    buffer_load_dword v97, v10, s[20:23], s17 offen
    buffer_load_dword v98, v12, s[20:23], s17 offen
    buffer_load_dword v99, v13, s[20:23], s17 offen
    s_waitcnt vmcnt(58)
    v_perm_b32 v5, v41, v40, s44
    v_perm_b32 v6, v41, v40, s45
    s_waitcnt vmcnt(56)
    v_perm_b32 v134, v43, v42, v11
    v_accvgpr_write_b32 a10, v5
    v_accvgpr_write_b32 a14, v6
    s_add_u32 s17, s49, 185472
    buffer_load_dword v100, v9, s[20:23], s17 offen
    buffer_load_dword v101, v10, s[20:23], s17 offen
    buffer_load_dword v102, v12, s[20:23], s17 offen
    buffer_load_dword v103, v13, s[20:23], s17 offen
    s_waitcnt vmcnt(58)
    v_perm_b32 v5, v45, v44, s44
    v_perm_b32 v6, v45, v44, s45
    s_waitcnt vmcnt(56)
    v_perm_b32 v135, v47, v46, v11
    v_accvgpr_write_b32 a11, v5
    v_accvgpr_write_b32 a15, v6
    s_add_u32 s17, s49, 186624
    buffer_load_dword v104, v9, s[20:23], s17 offen
    buffer_load_dword v105, v10, s[20:23], s17 offen
    buffer_load_dword v106, v12, s[20:23], s17 offen
    buffer_load_dword v107, v13, s[20:23], s17 offen
    s_waitcnt vmcnt(58)
    v_perm_b32 v5, v49, v48, s44
    v_perm_b32 v6, v49, v48, s45
    s_waitcnt vmcnt(56)
    v_perm_b32 v136, v51, v50, v11
    v_accvgpr_write_b32 a16, v5
    v_accvgpr_write_b32 a20, v6
    s_add_u32 s17, s49, 187776
    buffer_load_dword v108, v9, s[20:23], s17 offen
    buffer_load_dword v109, v10, s[20:23], s17 offen
    buffer_load_dword v110, v12, s[20:23], s17 offen
    buffer_load_dword v111, v13, s[20:23], s17 offen
    s_waitcnt vmcnt(58)
    v_perm_b32 v5, v53, v52, s44
    v_perm_b32 v6, v53, v52, s45
    s_waitcnt vmcnt(56)
    v_perm_b32 v137, v55, v54, v11
    v_accvgpr_write_b32 a17, v5
    v_accvgpr_write_b32 a21, v6
    s_add_u32 s17, s49, 221184
    buffer_load_dword v112, v9, s[20:23], s17 offen
    buffer_load_dword v113, v10, s[20:23], s17 offen
    buffer_load_dword v114, v12, s[20:23], s17 offen
    buffer_load_dword v115, v13, s[20:23], s17 offen
    s_waitcnt vmcnt(58)
    v_perm_b32 v5, v57, v56, s44
    v_perm_b32 v6, v57, v56, s45
    s_waitcnt vmcnt(56)
    v_perm_b32 v138, v59, v58, v11
    v_accvgpr_write_b32 a18, v5
    v_accvgpr_write_b32 a22, v6
    s_add_u32 s17, s49, 222336
    buffer_load_dword v116, v9, s[20:23], s17 offen
    buffer_load_dword v117, v10, s[20:23], s17 offen
    buffer_load_dword v118, v12, s[20:23], s17 offen
    buffer_load_dword v119, v13, s[20:23], s17 offen
    s_waitcnt vmcnt(58)
    v_perm_b32 v5, v61, v60, s44
    v_perm_b32 v6, v61, v60, s45
    s_waitcnt vmcnt(56)
    v_perm_b32 v139, v63, v62, v11
    v_accvgpr_write_b32 a19, v5
    v_accvgpr_write_b32 a23, v6
    s_add_u32 s17, s49, 223488
    buffer_load_dword v120, v9, s[20:23], s17 offen
    buffer_load_dword v121, v10, s[20:23], s17 offen
    buffer_load_dword v122, v12, s[20:23], s17 offen
    buffer_load_dword v123, v13, s[20:23], s17 offen
    s_waitcnt vmcnt(58)
    v_perm_b32 v5, v65, v64, s44
    v_perm_b32 v6, v65, v64, s45
    s_waitcnt vmcnt(56)
    v_perm_b32 v140, v67, v66, v11
    v_accvgpr_write_b32 a24, v5
    v_accvgpr_write_b32 a28, v6
    s_add_u32 s17, s49, 224640
    buffer_load_dword v124, v9, s[20:23], s17 offen
    buffer_load_dword v125, v10, s[20:23], s17 offen
    buffer_load_dword v126, v12, s[20:23], s17 offen
    buffer_load_dword v127, v13, s[20:23], s17 offen
    s_waitcnt vmcnt(58)
    v_perm_b32 v5, v69, v68, s44
    v_perm_b32 v6, v69, v68, s45
    s_waitcnt vmcnt(56)
    v_perm_b32 v141, v71, v70, v11
    v_accvgpr_write_b32 a25, v5
    v_accvgpr_write_b32 a29, v6
    s_add_u32 s17, s49, 258048
    buffer_load_dword v16, v9, s[20:23], s17 offen
    buffer_load_dword v17, v10, s[20:23], s17 offen
    buffer_load_dword v18, v12, s[20:23], s17 offen
    buffer_load_dword v19, v13, s[20:23], s17 offen
    s_waitcnt vmcnt(58)
    v_perm_b32 v5, v73, v72, s44
    v_perm_b32 v6, v73, v72, s45
    s_waitcnt vmcnt(56)
    v_perm_b32 v142, v75, v74, v11
    v_accvgpr_write_b32 a26, v5
    v_accvgpr_write_b32 a30, v6
    s_add_u32 s17, s49, 259200
    buffer_load_dword v20, v9, s[20:23], s17 offen
    buffer_load_dword v21, v10, s[20:23], s17 offen
    buffer_load_dword v22, v12, s[20:23], s17 offen
    buffer_load_dword v23, v13, s[20:23], s17 offen
    s_waitcnt vmcnt(58)
    v_perm_b32 v5, v77, v76, s44
    v_perm_b32 v6, v77, v76, s45
    s_waitcnt vmcnt(56)
    v_perm_b32 v143, v79, v78, v11
    v_accvgpr_write_b32 a27, v5
    v_accvgpr_write_b32 a31, v6
    s_add_u32 s17, s49, 260352
    buffer_load_dword v24, v9, s[20:23], s17 offen
    buffer_load_dword v25, v10, s[20:23], s17 offen
    buffer_load_dword v26, v12, s[20:23], s17 offen
    buffer_load_dword v27, v13, s[20:23], s17 offen
    s_waitcnt vmcnt(58)
    v_perm_b32 v5, v81, v80, s44
    v_perm_b32 v6, v81, v80, s45
    s_waitcnt vmcnt(56)
    v_perm_b32 v144, v83, v82, v11
    v_accvgpr_write_b32 a32, v5
    v_accvgpr_write_b32 a36, v6
    s_add_u32 s17, s49, 261504
    buffer_load_dword v28, v9, s[20:23], s17 offen
    buffer_load_dword v29, v10, s[20:23], s17 offen
    buffer_load_dword v30, v12, s[20:23], s17 offen
    buffer_load_dword v31, v13, s[20:23], s17 offen
    s_waitcnt vmcnt(58)
    v_perm_b32 v5, v85, v84, s44
    v_perm_b32 v6, v85, v84, s45
    s_waitcnt vmcnt(56)
    v_perm_b32 v145, v87, v86, v11
    v_accvgpr_write_b32 a33, v5
    v_accvgpr_write_b32 a37, v6
    s_add_u32 s17, s49, 294912
    buffer_load_dword v32, v9, s[20:23], s17 offen
    buffer_load_dword v33, v10, s[20:23], s17 offen
    buffer_load_dword v34, v12, s[20:23], s17 offen
    buffer_load_dword v35, v13, s[20:23], s17 offen
    s_waitcnt vmcnt(58)
    v_perm_b32 v5, v89, v88, s44
    v_perm_b32 v6, v89, v88, s45
    s_waitcnt vmcnt(56)
    v_perm_b32 v146, v91, v90, v11
    v_accvgpr_write_b32 a34, v5
    v_accvgpr_write_b32 a38, v6
    s_add_u32 s17, s49, 296064
    buffer_load_dword v36, v9, s[20:23], s17 offen
    buffer_load_dword v37, v10, s[20:23], s17 offen
    buffer_load_dword v38, v12, s[20:23], s17 offen
    buffer_load_dword v39, v13, s[20:23], s17 offen
    s_waitcnt vmcnt(58)
    v_perm_b32 v5, v93, v92, s44
    v_perm_b32 v6, v93, v92, s45
    s_waitcnt vmcnt(56)
    v_perm_b32 v147, v95, v94, v11
    v_accvgpr_write_b32 a35, v5
    v_accvgpr_write_b32 a39, v6
    s_add_u32 s17, s49, 297216
    buffer_load_dword v40, v9, s[20:23], s17 offen
    buffer_load_dword v41, v10, s[20:23], s17 offen
    buffer_load_dword v42, v12, s[20:23], s17 offen
    buffer_load_dword v43, v13, s[20:23], s17 offen
    s_waitcnt vmcnt(58)
    v_perm_b32 v5, v97, v96, s44
    v_perm_b32 v6, v97, v96, s45
    s_waitcnt vmcnt(56)
    v_perm_b32 v148, v99, v98, v11
    v_accvgpr_write_b32 a40, v5
    v_accvgpr_write_b32 a44, v6
    s_add_u32 s17, s49, 298368
    buffer_load_dword v44, v9, s[20:23], s17 offen
    buffer_load_dword v45, v10, s[20:23], s17 offen
    buffer_load_dword v46, v12, s[20:23], s17 offen
    buffer_load_dword v47, v13, s[20:23], s17 offen
    s_waitcnt vmcnt(58)
    v_perm_b32 v5, v101, v100, s44
    v_perm_b32 v6, v101, v100, s45
    s_waitcnt vmcnt(56)
    v_perm_b32 v149, v103, v102, v11
    v_accvgpr_write_b32 a41, v5
    v_accvgpr_write_b32 a45, v6
    s_add_u32 s17, s49, 331776
    buffer_load_dword v48, v9, s[20:23], s17 offen
    buffer_load_dword v49, v10, s[20:23], s17 offen
    buffer_load_dword v50, v12, s[20:23], s17 offen
    buffer_load_dword v51, v13, s[20:23], s17 offen
    s_waitcnt vmcnt(58)
    v_perm_b32 v5, v105, v104, s44
    v_perm_b32 v6, v105, v104, s45
    s_waitcnt vmcnt(56)
    v_perm_b32 v150, v107, v106, v11
    v_accvgpr_write_b32 a42, v5
    v_accvgpr_write_b32 a46, v6
    s_add_u32 s17, s49, 332928
    buffer_load_dword v52, v9, s[20:23], s17 offen
    buffer_load_dword v53, v10, s[20:23], s17 offen
    buffer_load_dword v54, v12, s[20:23], s17 offen
    buffer_load_dword v55, v13, s[20:23], s17 offen
    s_waitcnt vmcnt(58)
    v_perm_b32 v5, v109, v108, s44
    v_perm_b32 v6, v109, v108, s45
    s_waitcnt vmcnt(56)
    v_perm_b32 v151, v111, v110, v11
    v_accvgpr_write_b32 a43, v5
    v_accvgpr_write_b32 a47, v6
    s_add_u32 s17, s49, 334080
    buffer_load_dword v56, v9, s[20:23], s17 offen
    buffer_load_dword v57, v10, s[20:23], s17 offen
    buffer_load_dword v58, v12, s[20:23], s17 offen
    buffer_load_dword v59, v13, s[20:23], s17 offen
    s_waitcnt vmcnt(58)
    v_perm_b32 v5, v113, v112, s44
    v_perm_b32 v6, v113, v112, s45
    s_waitcnt vmcnt(56)
    v_perm_b32 v152, v115, v114, v11
    v_accvgpr_write_b32 a48, v5
    v_accvgpr_write_b32 a52, v6
    s_add_u32 s17, s49, 335232
    buffer_load_dword v60, v9, s[20:23], s17 offen
    buffer_load_dword v61, v10, s[20:23], s17 offen
    buffer_load_dword v62, v12, s[20:23], s17 offen
    buffer_load_dword v63, v13, s[20:23], s17 offen
    s_waitcnt vmcnt(58)
    v_perm_b32 v5, v117, v116, s44
    v_perm_b32 v6, v117, v116, s45
    s_waitcnt vmcnt(56)
    v_perm_b32 v153, v119, v118, v11
    v_accvgpr_write_b32 a49, v5
    v_accvgpr_write_b32 a53, v6
    s_add_u32 s17, s49, 368640
    buffer_load_dword v64, v9, s[20:23], s17 offen
    buffer_load_dword v65, v10, s[20:23], s17 offen
    buffer_load_dword v66, v12, s[20:23], s17 offen
    buffer_load_dword v67, v13, s[20:23], s17 offen
    s_waitcnt vmcnt(58)
    v_perm_b32 v5, v121, v120, s44
    v_perm_b32 v6, v121, v120, s45
    s_waitcnt vmcnt(56)
    v_perm_b32 v154, v123, v122, v11
    v_accvgpr_write_b32 a50, v5
    v_accvgpr_write_b32 a54, v6
    s_add_u32 s17, s49, 369792
    buffer_load_dword v68, v9, s[20:23], s17 offen
    buffer_load_dword v69, v10, s[20:23], s17 offen
    buffer_load_dword v70, v12, s[20:23], s17 offen
    buffer_load_dword v71, v13, s[20:23], s17 offen
    s_waitcnt vmcnt(58)
    v_perm_b32 v5, v125, v124, s44
    v_perm_b32 v6, v125, v124, s45
    s_waitcnt vmcnt(56)
    v_perm_b32 v155, v127, v126, v11
    v_accvgpr_write_b32 a51, v5
    v_accvgpr_write_b32 a55, v6
    s_add_u32 s17, s49, 370944
    buffer_load_dword v72, v9, s[20:23], s17 offen
    buffer_load_dword v73, v10, s[20:23], s17 offen
    buffer_load_dword v74, v12, s[20:23], s17 offen
    buffer_load_dword v75, v13, s[20:23], s17 offen
    s_waitcnt vmcnt(58)
    v_perm_b32 v5, v17, v16, s44
    v_perm_b32 v6, v17, v16, s45
    s_waitcnt vmcnt(56)
    v_perm_b32 v156, v19, v18, v11
    v_accvgpr_write_b32 a56, v5
    v_accvgpr_write_b32 a60, v6
    s_add_u32 s17, s49, 372096
    buffer_load_dword v76, v9, s[20:23], s17 offen
    buffer_load_dword v77, v10, s[20:23], s17 offen
    buffer_load_dword v78, v12, s[20:23], s17 offen
    buffer_load_dword v79, v13, s[20:23], s17 offen
    s_waitcnt vmcnt(58)
    v_perm_b32 v5, v21, v20, s44
    v_perm_b32 v6, v21, v20, s45
    s_waitcnt vmcnt(56)
    v_perm_b32 v157, v23, v22, v11
    v_accvgpr_write_b32 a57, v5
    v_accvgpr_write_b32 a61, v6
    s_add_u32 s17, s49, 405504
    buffer_load_dword v80, v9, s[20:23], s17 offen
    buffer_load_dword v81, v10, s[20:23], s17 offen
    buffer_load_dword v82, v12, s[20:23], s17 offen
    buffer_load_dword v83, v13, s[20:23], s17 offen
    s_waitcnt vmcnt(58)
    v_perm_b32 v5, v25, v24, s44
    v_perm_b32 v6, v25, v24, s45
    s_waitcnt vmcnt(56)
    v_perm_b32 v158, v27, v26, v11
    v_accvgpr_write_b32 a58, v5
    v_accvgpr_write_b32 a62, v6
    s_add_u32 s17, s49, 406656
    buffer_load_dword v84, v9, s[20:23], s17 offen
    buffer_load_dword v85, v10, s[20:23], s17 offen
    buffer_load_dword v86, v12, s[20:23], s17 offen
    buffer_load_dword v87, v13, s[20:23], s17 offen
    s_waitcnt vmcnt(58)
    v_perm_b32 v5, v29, v28, s44
    v_perm_b32 v6, v29, v28, s45
    s_waitcnt vmcnt(56)
    v_perm_b32 v159, v31, v30, v11
    v_accvgpr_write_b32 a59, v5
    v_accvgpr_write_b32 a63, v6
    s_add_u32 s17, s49, 407808
    buffer_load_dword v88, v9, s[20:23], s17 offen
    buffer_load_dword v89, v10, s[20:23], s17 offen
    buffer_load_dword v90, v12, s[20:23], s17 offen
    buffer_load_dword v91, v13, s[20:23], s17 offen
    s_waitcnt vmcnt(58)
    v_perm_b32 v5, v33, v32, s44
    v_perm_b32 v6, v33, v32, s45
    s_waitcnt vmcnt(56)
    v_perm_b32 v160, v35, v34, v11
    v_accvgpr_write_b32 a64, v5
    v_accvgpr_write_b32 a68, v6
    s_add_u32 s17, s49, 408960
    buffer_load_dword v92, v9, s[20:23], s17 offen
    buffer_load_dword v93, v10, s[20:23], s17 offen
    buffer_load_dword v94, v12, s[20:23], s17 offen
    buffer_load_dword v95, v13, s[20:23], s17 offen
    s_waitcnt vmcnt(58)
    v_perm_b32 v5, v37, v36, s44
    v_perm_b32 v6, v37, v36, s45
    s_waitcnt vmcnt(56)
    v_perm_b32 v161, v39, v38, v11
    v_accvgpr_write_b32 a65, v5
    v_accvgpr_write_b32 a69, v6
    s_add_u32 s17, s49, 442368
    buffer_load_dword v96, v9, s[20:23], s17 offen
    buffer_load_dword v97, v10, s[20:23], s17 offen
    buffer_load_dword v98, v12, s[20:23], s17 offen
    buffer_load_dword v99, v13, s[20:23], s17 offen
    s_waitcnt vmcnt(58)
    v_perm_b32 v5, v41, v40, s44
    v_perm_b32 v6, v41, v40, s45
    s_waitcnt vmcnt(56)
    v_perm_b32 v162, v43, v42, v11
    v_accvgpr_write_b32 a66, v5
    v_accvgpr_write_b32 a70, v6
    s_add_u32 s17, s49, 443520
    buffer_load_dword v100, v9, s[20:23], s17 offen
    buffer_load_dword v101, v10, s[20:23], s17 offen
    buffer_load_dword v102, v12, s[20:23], s17 offen
    buffer_load_dword v103, v13, s[20:23], s17 offen
    s_waitcnt vmcnt(58)
    v_perm_b32 v5, v45, v44, s44
    v_perm_b32 v6, v45, v44, s45
    s_waitcnt vmcnt(56)
    v_perm_b32 v163, v47, v46, v11
    v_accvgpr_write_b32 a67, v5
    v_accvgpr_write_b32 a71, v6
    s_add_u32 s17, s49, 444672
    buffer_load_dword v104, v9, s[20:23], s17 offen
    buffer_load_dword v105, v10, s[20:23], s17 offen
    buffer_load_dword v106, v12, s[20:23], s17 offen
    buffer_load_dword v107, v13, s[20:23], s17 offen
    s_waitcnt vmcnt(58)
    v_perm_b32 v5, v49, v48, s44
    v_perm_b32 v6, v49, v48, s45
    s_waitcnt vmcnt(56)
    v_perm_b32 v164, v51, v50, v11
    v_accvgpr_write_b32 a72, v5
    v_accvgpr_write_b32 a76, v6
    s_add_u32 s17, s49, 445824
    buffer_load_dword v108, v9, s[20:23], s17 offen
    buffer_load_dword v109, v10, s[20:23], s17 offen
    buffer_load_dword v110, v12, s[20:23], s17 offen
    buffer_load_dword v111, v13, s[20:23], s17 offen
    s_waitcnt vmcnt(58)
    v_perm_b32 v5, v53, v52, s44
    v_perm_b32 v6, v53, v52, s45
    s_waitcnt vmcnt(56)
    v_perm_b32 v165, v55, v54, v11
    v_accvgpr_write_b32 a73, v5
    v_accvgpr_write_b32 a77, v6
    s_add_u32 s17, s49, 479232
    buffer_load_dword v112, v9, s[20:23], s17 offen
    buffer_load_dword v113, v10, s[20:23], s17 offen
    buffer_load_dword v114, v12, s[20:23], s17 offen
    buffer_load_dword v115, v13, s[20:23], s17 offen
    s_waitcnt vmcnt(58)
    v_perm_b32 v5, v57, v56, s44
    v_perm_b32 v6, v57, v56, s45
    s_waitcnt vmcnt(56)
    v_perm_b32 v166, v59, v58, v11
    v_accvgpr_write_b32 a74, v5
    v_accvgpr_write_b32 a78, v6
    s_add_u32 s17, s49, 480384
    buffer_load_dword v116, v9, s[20:23], s17 offen
    buffer_load_dword v117, v10, s[20:23], s17 offen
    buffer_load_dword v118, v12, s[20:23], s17 offen
    buffer_load_dword v119, v13, s[20:23], s17 offen
    s_waitcnt vmcnt(58)
    v_perm_b32 v5, v61, v60, s44
    v_perm_b32 v6, v61, v60, s45
    s_waitcnt vmcnt(56)
    v_perm_b32 v167, v63, v62, v11
    v_accvgpr_write_b32 a75, v5
    v_accvgpr_write_b32 a79, v6
    s_add_u32 s17, s49, 481536
    buffer_load_dword v120, v9, s[20:23], s17 offen
    buffer_load_dword v121, v10, s[20:23], s17 offen
    buffer_load_dword v122, v12, s[20:23], s17 offen
    buffer_load_dword v123, v13, s[20:23], s17 offen
    s_waitcnt vmcnt(58)
    v_perm_b32 v5, v65, v64, s44
    v_perm_b32 v6, v65, v64, s45
    s_waitcnt vmcnt(56)
    v_perm_b32 v168, v67, v66, v11
    v_accvgpr_write_b32 a80, v5
    v_accvgpr_write_b32 a84, v6
    s_add_u32 s17, s49, 482688
    buffer_load_dword v124, v9, s[20:23], s17 offen
    buffer_load_dword v125, v10, s[20:23], s17 offen
    buffer_load_dword v126, v12, s[20:23], s17 offen
    buffer_load_dword v127, v13, s[20:23], s17 offen
    s_waitcnt vmcnt(58)
    v_perm_b32 v5, v69, v68, s44
    v_perm_b32 v6, v69, v68, s45
    s_waitcnt vmcnt(56)
    v_perm_b32 v169, v71, v70, v11
    v_accvgpr_write_b32 a81, v5
    v_accvgpr_write_b32 a85, v6
    s_add_u32 s17, s49, 516096
    buffer_load_dword v16, v9, s[20:23], s17 offen
    buffer_load_dword v17, v10, s[20:23], s17 offen
    buffer_load_dword v18, v12, s[20:23], s17 offen
    buffer_load_dword v19, v13, s[20:23], s17 offen
    s_waitcnt vmcnt(58)
    v_perm_b32 v5, v73, v72, s44
    v_perm_b32 v6, v73, v72, s45
    s_waitcnt vmcnt(56)
    v_perm_b32 v170, v75, v74, v11
    v_accvgpr_write_b32 a82, v5
    v_accvgpr_write_b32 a86, v6
    s_add_u32 s17, s49, 517248
    buffer_load_dword v20, v9, s[20:23], s17 offen
    buffer_load_dword v21, v10, s[20:23], s17 offen
    buffer_load_dword v22, v12, s[20:23], s17 offen
    buffer_load_dword v23, v13, s[20:23], s17 offen
    s_waitcnt vmcnt(58)
    v_perm_b32 v5, v77, v76, s44
    v_perm_b32 v6, v77, v76, s45
    s_waitcnt vmcnt(56)
    v_perm_b32 v171, v79, v78, v11
    v_accvgpr_write_b32 a83, v5
    v_accvgpr_write_b32 a87, v6
    s_add_u32 s17, s49, 518400
    buffer_load_dword v24, v9, s[20:23], s17 offen
    buffer_load_dword v25, v10, s[20:23], s17 offen
    buffer_load_dword v26, v12, s[20:23], s17 offen
    buffer_load_dword v27, v13, s[20:23], s17 offen
    s_waitcnt vmcnt(58)
    v_perm_b32 v5, v81, v80, s44
    v_perm_b32 v6, v81, v80, s45
    s_waitcnt vmcnt(56)
    v_perm_b32 v172, v83, v82, v11
    v_accvgpr_write_b32 a88, v5
    v_accvgpr_write_b32 a92, v6
    s_add_u32 s17, s49, 519552
    buffer_load_dword v28, v9, s[20:23], s17 offen
    buffer_load_dword v29, v10, s[20:23], s17 offen
    buffer_load_dword v30, v12, s[20:23], s17 offen
    buffer_load_dword v31, v13, s[20:23], s17 offen
    s_waitcnt vmcnt(58)
    v_perm_b32 v5, v85, v84, s44
    v_perm_b32 v6, v85, v84, s45
    s_waitcnt vmcnt(56)
    v_perm_b32 v173, v87, v86, v11
    v_accvgpr_write_b32 a89, v5
    v_accvgpr_write_b32 a93, v6
    s_add_u32 s17, s49, 552960
    buffer_load_dword v32, v9, s[20:23], s17 offen
    buffer_load_dword v33, v10, s[20:23], s17 offen
    buffer_load_dword v34, v12, s[20:23], s17 offen
    buffer_load_dword v35, v13, s[20:23], s17 offen
    s_waitcnt vmcnt(58)
    v_perm_b32 v5, v89, v88, s44
    v_perm_b32 v6, v89, v88, s45
    s_waitcnt vmcnt(56)
    v_perm_b32 v174, v91, v90, v11
    v_accvgpr_write_b32 a90, v5
    v_accvgpr_write_b32 a94, v6
    s_add_u32 s17, s49, 554112
    buffer_load_dword v36, v9, s[20:23], s17 offen
    buffer_load_dword v37, v10, s[20:23], s17 offen
    buffer_load_dword v38, v12, s[20:23], s17 offen
    buffer_load_dword v39, v13, s[20:23], s17 offen
    s_waitcnt vmcnt(58)
    v_perm_b32 v5, v93, v92, s44
    v_perm_b32 v6, v93, v92, s45
    s_waitcnt vmcnt(56)
    v_perm_b32 v175, v95, v94, v11
    v_accvgpr_write_b32 a91, v5
    v_accvgpr_write_b32 a95, v6
    s_add_u32 s17, s49, 555264
    buffer_load_dword v40, v9, s[20:23], s17 offen
    buffer_load_dword v41, v10, s[20:23], s17 offen
    buffer_load_dword v42, v12, s[20:23], s17 offen
    buffer_load_dword v43, v13, s[20:23], s17 offen
    s_waitcnt vmcnt(58)
    v_perm_b32 v5, v97, v96, s44
    v_perm_b32 v6, v97, v96, s45
    s_waitcnt vmcnt(56)
    v_perm_b32 v176, v99, v98, v11
    v_accvgpr_write_b32 a96, v5
    v_accvgpr_write_b32 a100, v6
    s_add_u32 s17, s49, 556416
    buffer_load_dword v44, v9, s[20:23], s17 offen
    buffer_load_dword v45, v10, s[20:23], s17 offen
    buffer_load_dword v46, v12, s[20:23], s17 offen
    buffer_load_dword v47, v13, s[20:23], s17 offen
    s_waitcnt vmcnt(58)
    v_perm_b32 v5, v101, v100, s44
    v_perm_b32 v6, v101, v100, s45
    s_waitcnt vmcnt(56)
    v_perm_b32 v177, v103, v102, v11
    v_accvgpr_write_b32 a97, v5
    v_accvgpr_write_b32 a101, v6
    s_add_u32 s17, s49, 589824
    buffer_load_dword v48, v9, s[20:23], s17 offen
    buffer_load_dword v49, v10, s[20:23], s17 offen
    buffer_load_dword v50, v12, s[20:23], s17 offen
    buffer_load_dword v51, v13, s[20:23], s17 offen
    s_waitcnt vmcnt(58)
    v_perm_b32 v5, v105, v104, s44
    v_perm_b32 v6, v105, v104, s45
    s_waitcnt vmcnt(56)
    v_perm_b32 v178, v107, v106, v11
    v_accvgpr_write_b32 a98, v5
    v_accvgpr_write_b32 a102, v6
    s_add_u32 s17, s49, 590976
    buffer_load_dword v52, v9, s[20:23], s17 offen
    buffer_load_dword v53, v10, s[20:23], s17 offen
    buffer_load_dword v54, v12, s[20:23], s17 offen
    buffer_load_dword v55, v13, s[20:23], s17 offen
    s_waitcnt vmcnt(58)
    v_perm_b32 v5, v109, v108, s44
    v_perm_b32 v6, v109, v108, s45
    s_waitcnt vmcnt(56)
    v_perm_b32 v179, v111, v110, v11
    v_accvgpr_write_b32 a99, v5
    v_accvgpr_write_b32 a103, v6
    s_add_u32 s17, s49, 592128
    buffer_load_dword v56, v9, s[20:23], s17 offen
    buffer_load_dword v57, v10, s[20:23], s17 offen
    buffer_load_dword v58, v12, s[20:23], s17 offen
    buffer_load_dword v59, v13, s[20:23], s17 offen
    s_waitcnt vmcnt(58)
    v_perm_b32 v5, v113, v112, s44
    v_perm_b32 v6, v113, v112, s45
    s_waitcnt vmcnt(56)
    v_perm_b32 v180, v115, v114, v11
    v_accvgpr_write_b32 a104, v5
    v_accvgpr_write_b32 a108, v6
    s_add_u32 s17, s49, 593280
    buffer_load_dword v60, v9, s[20:23], s17 offen
    buffer_load_dword v61, v10, s[20:23], s17 offen
    buffer_load_dword v62, v12, s[20:23], s17 offen
    buffer_load_dword v63, v13, s[20:23], s17 offen
    s_waitcnt vmcnt(58)
    v_perm_b32 v5, v117, v116, s44
    v_perm_b32 v6, v117, v116, s45
    s_waitcnt vmcnt(56)
    v_perm_b32 v181, v119, v118, v11
    v_accvgpr_write_b32 a105, v5
    v_accvgpr_write_b32 a109, v6
    s_add_u32 s17, s49, 626688
    buffer_load_dword v64, v9, s[20:23], s17 offen
    buffer_load_dword v65, v10, s[20:23], s17 offen
    buffer_load_dword v66, v12, s[20:23], s17 offen
    buffer_load_dword v67, v13, s[20:23], s17 offen
    s_waitcnt vmcnt(58)
    v_perm_b32 v5, v121, v120, s44
    v_perm_b32 v6, v121, v120, s45
    s_waitcnt vmcnt(56)
    v_perm_b32 v182, v123, v122, v11
    v_accvgpr_write_b32 a106, v5
    v_accvgpr_write_b32 a110, v6
    s_add_u32 s17, s49, 627840
    buffer_load_dword v68, v9, s[20:23], s17 offen
    buffer_load_dword v69, v10, s[20:23], s17 offen
    buffer_load_dword v70, v12, s[20:23], s17 offen
    buffer_load_dword v71, v13, s[20:23], s17 offen
    s_waitcnt vmcnt(58)
    v_perm_b32 v5, v125, v124, s44
    v_perm_b32 v6, v125, v124, s45
    s_waitcnt vmcnt(56)
    v_perm_b32 v183, v127, v126, v11
    v_accvgpr_write_b32 a107, v5
    v_accvgpr_write_b32 a111, v6
    s_add_u32 s17, s49, 628992
    buffer_load_dword v72, v9, s[20:23], s17 offen
    buffer_load_dword v73, v10, s[20:23], s17 offen
    buffer_load_dword v74, v12, s[20:23], s17 offen
    buffer_load_dword v75, v13, s[20:23], s17 offen
    s_waitcnt vmcnt(58)
    v_perm_b32 v5, v17, v16, s44
    v_perm_b32 v6, v17, v16, s45
    s_waitcnt vmcnt(56)
    v_perm_b32 v184, v19, v18, v11
    v_accvgpr_write_b32 a112, v5
    v_accvgpr_write_b32 a116, v6
    s_add_u32 s17, s49, 630144
    buffer_load_dword v76, v9, s[20:23], s17 offen
    buffer_load_dword v77, v10, s[20:23], s17 offen
    buffer_load_dword v78, v12, s[20:23], s17 offen
    buffer_load_dword v79, v13, s[20:23], s17 offen
    s_waitcnt vmcnt(58)
    v_perm_b32 v5, v21, v20, s44
    v_perm_b32 v6, v21, v20, s45
    s_waitcnt vmcnt(56)
    v_perm_b32 v185, v23, v22, v11
    v_accvgpr_write_b32 a113, v5
    v_accvgpr_write_b32 a117, v6
    s_add_u32 s17, s49, 663552
    buffer_load_dword v80, v9, s[20:23], s17 offen
    buffer_load_dword v81, v10, s[20:23], s17 offen
    buffer_load_dword v82, v12, s[20:23], s17 offen
    buffer_load_dword v83, v13, s[20:23], s17 offen
    s_waitcnt vmcnt(58)
    v_perm_b32 v5, v25, v24, s44
    v_perm_b32 v6, v25, v24, s45
    s_waitcnt vmcnt(56)
    v_perm_b32 v186, v27, v26, v11
    v_accvgpr_write_b32 a114, v5
    v_accvgpr_write_b32 a118, v6
    s_add_u32 s17, s49, 664704
    buffer_load_dword v84, v9, s[20:23], s17 offen
    buffer_load_dword v85, v10, s[20:23], s17 offen
    buffer_load_dword v86, v12, s[20:23], s17 offen
    buffer_load_dword v87, v13, s[20:23], s17 offen
    s_waitcnt vmcnt(58)
    v_perm_b32 v5, v29, v28, s44
    v_perm_b32 v6, v29, v28, s45
    s_waitcnt vmcnt(56)
    v_perm_b32 v187, v31, v30, v11
    v_accvgpr_write_b32 a115, v5
    v_accvgpr_write_b32 a119, v6
    s_add_u32 s17, s49, 665856
    buffer_load_dword v88, v9, s[20:23], s17 offen
    buffer_load_dword v89, v10, s[20:23], s17 offen
    buffer_load_dword v90, v12, s[20:23], s17 offen
    buffer_load_dword v91, v13, s[20:23], s17 offen
    s_waitcnt vmcnt(58)
    v_perm_b32 v5, v33, v32, s44
    v_perm_b32 v6, v33, v32, s45
    s_waitcnt vmcnt(56)
    v_perm_b32 v188, v35, v34, v11
    v_accvgpr_write_b32 a120, v5
    v_accvgpr_write_b32 a124, v6
    s_add_u32 s17, s49, 667008
    buffer_load_dword v92, v9, s[20:23], s17 offen
    buffer_load_dword v93, v10, s[20:23], s17 offen
    buffer_load_dword v94, v12, s[20:23], s17 offen
    buffer_load_dword v95, v13, s[20:23], s17 offen
    s_waitcnt vmcnt(58)
    v_perm_b32 v5, v37, v36, s44
    v_perm_b32 v6, v37, v36, s45
    s_waitcnt vmcnt(56)
    v_perm_b32 v189, v39, v38, v11
    v_accvgpr_write_b32 a121, v5
    v_accvgpr_write_b32 a125, v6
    s_add_u32 s17, s49, 700416
    buffer_load_dword v96, v9, s[20:23], s17 offen
    buffer_load_dword v97, v10, s[20:23], s17 offen
    buffer_load_dword v98, v12, s[20:23], s17 offen
    buffer_load_dword v99, v13, s[20:23], s17 offen
    s_waitcnt vmcnt(58)
    v_perm_b32 v5, v41, v40, s44
    v_perm_b32 v6, v41, v40, s45
    s_waitcnt vmcnt(56)
    v_perm_b32 v190, v43, v42, v11
    v_accvgpr_write_b32 a122, v5
    v_accvgpr_write_b32 a126, v6
    s_add_u32 s17, s49, 701568
    buffer_load_dword v100, v9, s[20:23], s17 offen
    buffer_load_dword v101, v10, s[20:23], s17 offen
    buffer_load_dword v102, v12, s[20:23], s17 offen
    buffer_load_dword v103, v13, s[20:23], s17 offen
    s_waitcnt vmcnt(58)
    v_perm_b32 v5, v45, v44, s44
    v_perm_b32 v6, v45, v44, s45
    s_waitcnt vmcnt(56)
    v_perm_b32 v191, v47, v46, v11
    v_accvgpr_write_b32 a123, v5
    v_accvgpr_write_b32 a127, v6
    s_add_u32 s17, s49, 702720
    buffer_load_dword v104, v9, s[20:23], s17 offen
    buffer_load_dword v105, v10, s[20:23], s17 offen
    buffer_load_dword v106, v12, s[20:23], s17 offen
    buffer_load_dword v107, v13, s[20:23], s17 offen
    s_waitcnt vmcnt(58)
    v_perm_b32 v5, v49, v48, s44
    v_perm_b32 v6, v49, v48, s45
    s_waitcnt vmcnt(56)
    v_perm_b32 v192, v51, v50, v11
    v_accvgpr_write_b32 a128, v5
    v_accvgpr_write_b32 a132, v6
    s_add_u32 s17, s49, 703872
    buffer_load_dword v108, v9, s[20:23], s17 offen
    buffer_load_dword v109, v10, s[20:23], s17 offen
    buffer_load_dword v110, v12, s[20:23], s17 offen
    buffer_load_dword v111, v13, s[20:23], s17 offen
    s_waitcnt vmcnt(58)
    v_perm_b32 v5, v53, v52, s44
    v_perm_b32 v6, v53, v52, s45
    s_waitcnt vmcnt(56)
    v_perm_b32 v193, v55, v54, v11
    v_accvgpr_write_b32 a129, v5
    v_accvgpr_write_b32 a133, v6
    s_add_u32 s17, s49, 737280
    buffer_load_dword v112, v9, s[20:23], s17 offen
    buffer_load_dword v113, v10, s[20:23], s17 offen
    buffer_load_dword v114, v12, s[20:23], s17 offen
    buffer_load_dword v115, v13, s[20:23], s17 offen
    s_waitcnt vmcnt(58)
    v_perm_b32 v5, v57, v56, s44
    v_perm_b32 v6, v57, v56, s45
    s_waitcnt vmcnt(56)
    v_perm_b32 v194, v59, v58, v11
    v_accvgpr_write_b32 a130, v5
    v_accvgpr_write_b32 a134, v6
    s_add_u32 s17, s49, 738432
    buffer_load_dword v116, v9, s[20:23], s17 offen
    buffer_load_dword v117, v10, s[20:23], s17 offen
    buffer_load_dword v118, v12, s[20:23], s17 offen
    buffer_load_dword v119, v13, s[20:23], s17 offen
    s_waitcnt vmcnt(58)
    v_perm_b32 v5, v61, v60, s44
    v_perm_b32 v6, v61, v60, s45
    s_waitcnt vmcnt(56)
    v_perm_b32 v195, v63, v62, v11
    v_accvgpr_write_b32 a131, v5
    v_accvgpr_write_b32 a135, v6
    s_add_u32 s17, s49, 739584
    buffer_load_dword v120, v9, s[20:23], s17 offen
    buffer_load_dword v121, v10, s[20:23], s17 offen
    buffer_load_dword v122, v12, s[20:23], s17 offen
    buffer_load_dword v123, v13, s[20:23], s17 offen
    s_waitcnt vmcnt(58)
    v_perm_b32 v5, v65, v64, s44
    v_perm_b32 v6, v65, v64, s45
    s_waitcnt vmcnt(56)
    v_perm_b32 v196, v67, v66, v11
    v_accvgpr_write_b32 a136, v5
    v_accvgpr_write_b32 a140, v6
    s_add_u32 s17, s49, 740736
    buffer_load_dword v124, v9, s[20:23], s17 offen
    buffer_load_dword v125, v10, s[20:23], s17 offen
    buffer_load_dword v126, v12, s[20:23], s17 offen
    buffer_load_dword v127, v13, s[20:23], s17 offen
    s_waitcnt vmcnt(58)
    v_perm_b32 v5, v69, v68, s44
    v_perm_b32 v6, v69, v68, s45
    s_waitcnt vmcnt(56)
    v_perm_b32 v197, v71, v70, v11
    v_accvgpr_write_b32 a137, v5
    v_accvgpr_write_b32 a141, v6
    s_add_u32 s17, s49, 774144
    buffer_load_dword v16, v9, s[20:23], s17 offen
    buffer_load_dword v17, v10, s[20:23], s17 offen
    buffer_load_dword v18, v12, s[20:23], s17 offen
    buffer_load_dword v19, v13, s[20:23], s17 offen
    s_waitcnt vmcnt(58)
    v_perm_b32 v5, v73, v72, s44
    v_perm_b32 v6, v73, v72, s45
    s_waitcnt vmcnt(56)
    v_perm_b32 v198, v75, v74, v11
    v_accvgpr_write_b32 a138, v5
    v_accvgpr_write_b32 a142, v6
    s_add_u32 s17, s49, 775296
    buffer_load_dword v20, v9, s[20:23], s17 offen
    buffer_load_dword v21, v10, s[20:23], s17 offen
    buffer_load_dword v22, v12, s[20:23], s17 offen
    buffer_load_dword v23, v13, s[20:23], s17 offen
    s_waitcnt vmcnt(58)
    v_perm_b32 v5, v77, v76, s44
    v_perm_b32 v6, v77, v76, s45
    s_waitcnt vmcnt(56)
    v_perm_b32 v199, v79, v78, v11
    v_accvgpr_write_b32 a139, v5
    v_accvgpr_write_b32 a143, v6
    s_add_u32 s17, s49, 776448
    buffer_load_dword v24, v9, s[20:23], s17 offen
    buffer_load_dword v25, v10, s[20:23], s17 offen
    buffer_load_dword v26, v12, s[20:23], s17 offen
    buffer_load_dword v27, v13, s[20:23], s17 offen
    s_waitcnt vmcnt(58)
    v_perm_b32 v5, v81, v80, s44
    v_perm_b32 v6, v81, v80, s45
    s_waitcnt vmcnt(56)
    v_perm_b32 v200, v83, v82, v11
    v_accvgpr_write_b32 a144, v5
    v_accvgpr_write_b32 a148, v6
    s_add_u32 s17, s49, 777600
    buffer_load_dword v28, v9, s[20:23], s17 offen
    buffer_load_dword v29, v10, s[20:23], s17 offen
    buffer_load_dword v30, v12, s[20:23], s17 offen
    buffer_load_dword v31, v13, s[20:23], s17 offen
    s_waitcnt vmcnt(58)
    v_perm_b32 v5, v85, v84, s44
    v_perm_b32 v6, v85, v84, s45
    s_waitcnt vmcnt(56)
    v_perm_b32 v201, v87, v86, v11
    v_accvgpr_write_b32 a145, v5
    v_accvgpr_write_b32 a149, v6
    s_add_u32 s17, s49, 811008
    buffer_load_dword v32, v9, s[20:23], s17 offen
    buffer_load_dword v33, v10, s[20:23], s17 offen
    buffer_load_dword v34, v12, s[20:23], s17 offen
    buffer_load_dword v35, v13, s[20:23], s17 offen
    s_waitcnt vmcnt(58)
    v_perm_b32 v5, v89, v88, s44
    v_perm_b32 v6, v89, v88, s45
    s_waitcnt vmcnt(56)
    v_perm_b32 v202, v91, v90, v11
    v_accvgpr_write_b32 a146, v5
    v_accvgpr_write_b32 a150, v6
    s_add_u32 s17, s49, 812160
    buffer_load_dword v36, v9, s[20:23], s17 offen
    buffer_load_dword v37, v10, s[20:23], s17 offen
    buffer_load_dword v38, v12, s[20:23], s17 offen
    buffer_load_dword v39, v13, s[20:23], s17 offen
    s_waitcnt vmcnt(58)
    v_perm_b32 v5, v93, v92, s44
    v_perm_b32 v6, v93, v92, s45
    s_waitcnt vmcnt(56)
    v_perm_b32 v203, v95, v94, v11
    v_accvgpr_write_b32 a147, v5
    v_accvgpr_write_b32 a151, v6
    s_add_u32 s17, s49, 813312
    buffer_load_dword v40, v9, s[20:23], s17 offen
    buffer_load_dword v41, v10, s[20:23], s17 offen
    buffer_load_dword v42, v12, s[20:23], s17 offen
    buffer_load_dword v43, v13, s[20:23], s17 offen
    s_waitcnt vmcnt(58)
    v_perm_b32 v5, v97, v96, s44
    v_perm_b32 v6, v97, v96, s45
    s_waitcnt vmcnt(56)
    v_perm_b32 v204, v99, v98, v11
    v_accvgpr_write_b32 a152, v5
    v_accvgpr_write_b32 a156, v6
    s_add_u32 s17, s49, 814464
    buffer_load_dword v44, v9, s[20:23], s17 offen
    buffer_load_dword v45, v10, s[20:23], s17 offen
    buffer_load_dword v46, v12, s[20:23], s17 offen
    buffer_load_dword v47, v13, s[20:23], s17 offen
    s_waitcnt vmcnt(58)
    v_perm_b32 v5, v101, v100, s44
    v_perm_b32 v6, v101, v100, s45
    s_waitcnt vmcnt(56)
    v_perm_b32 v205, v103, v102, v11
    v_accvgpr_write_b32 a153, v5
    v_accvgpr_write_b32 a157, v6
    s_add_u32 s17, s49, 847872
    buffer_load_dword v48, v9, s[20:23], s17 offen
    buffer_load_dword v49, v10, s[20:23], s17 offen
    buffer_load_dword v50, v12, s[20:23], s17 offen
    buffer_load_dword v51, v13, s[20:23], s17 offen
    s_waitcnt vmcnt(58)
    v_perm_b32 v5, v105, v104, s44
    v_perm_b32 v6, v105, v104, s45
    s_waitcnt vmcnt(56)
    v_perm_b32 v206, v107, v106, v11
    v_accvgpr_write_b32 a154, v5
    v_accvgpr_write_b32 a158, v6
    s_add_u32 s17, s49, 849024
    buffer_load_dword v52, v9, s[20:23], s17 offen
    buffer_load_dword v53, v10, s[20:23], s17 offen
    buffer_load_dword v54, v12, s[20:23], s17 offen
    buffer_load_dword v55, v13, s[20:23], s17 offen
    s_waitcnt vmcnt(58)
    v_perm_b32 v5, v109, v108, s44
    v_perm_b32 v6, v109, v108, s45
    s_waitcnt vmcnt(56)
    v_perm_b32 v207, v111, v110, v11
    v_accvgpr_write_b32 a155, v5
    v_accvgpr_write_b32 a159, v6
    s_add_u32 s17, s49, 850176
    buffer_load_dword v56, v9, s[20:23], s17 offen
    buffer_load_dword v57, v10, s[20:23], s17 offen
    buffer_load_dword v58, v12, s[20:23], s17 offen
    buffer_load_dword v59, v13, s[20:23], s17 offen
    s_waitcnt vmcnt(58)
    v_perm_b32 v5, v113, v112, s44
    v_perm_b32 v6, v113, v112, s45
    s_waitcnt vmcnt(56)
    v_perm_b32 v208, v115, v114, v11
    v_accvgpr_write_b32 a160, v5
    v_accvgpr_write_b32 a164, v6
    s_add_u32 s17, s49, 851328
    buffer_load_dword v60, v9, s[20:23], s17 offen
    buffer_load_dword v61, v10, s[20:23], s17 offen
    buffer_load_dword v62, v12, s[20:23], s17 offen
    buffer_load_dword v63, v13, s[20:23], s17 offen
    s_waitcnt vmcnt(58)
    v_perm_b32 v5, v117, v116, s44
    v_perm_b32 v6, v117, v116, s45
    s_waitcnt vmcnt(56)
    v_perm_b32 v209, v119, v118, v11
    v_accvgpr_write_b32 a161, v5
    v_accvgpr_write_b32 a165, v6
    s_add_u32 s17, s49, 884736
    buffer_load_dword v64, v9, s[20:23], s17 offen
    buffer_load_dword v65, v10, s[20:23], s17 offen
    buffer_load_dword v66, v12, s[20:23], s17 offen
    buffer_load_dword v67, v13, s[20:23], s17 offen
    s_waitcnt vmcnt(58)
    v_perm_b32 v5, v121, v120, s44
    v_perm_b32 v6, v121, v120, s45
    s_waitcnt vmcnt(56)
    v_perm_b32 v210, v123, v122, v11
    v_accvgpr_write_b32 a162, v5
    v_accvgpr_write_b32 a166, v6
    s_add_u32 s17, s49, 885888
    buffer_load_dword v68, v9, s[20:23], s17 offen
    buffer_load_dword v69, v10, s[20:23], s17 offen
    buffer_load_dword v70, v12, s[20:23], s17 offen
    buffer_load_dword v71, v13, s[20:23], s17 offen
    s_waitcnt vmcnt(58)
    v_perm_b32 v5, v125, v124, s44
    v_perm_b32 v6, v125, v124, s45
    s_waitcnt vmcnt(56)
    v_perm_b32 v211, v127, v126, v11
    v_accvgpr_write_b32 a163, v5
    v_accvgpr_write_b32 a167, v6
    s_add_u32 s17, s49, 887040
    buffer_load_dword v72, v9, s[20:23], s17 offen
    buffer_load_dword v73, v10, s[20:23], s17 offen
    buffer_load_dword v74, v12, s[20:23], s17 offen
    buffer_load_dword v75, v13, s[20:23], s17 offen
    s_waitcnt vmcnt(58)
    v_perm_b32 v5, v17, v16, s44
    v_perm_b32 v6, v17, v16, s45
    s_waitcnt vmcnt(56)
    v_perm_b32 v212, v19, v18, v11
    v_accvgpr_write_b32 a168, v5
    v_accvgpr_write_b32 a172, v6
    s_add_u32 s17, s49, 888192
    buffer_load_dword v76, v9, s[20:23], s17 offen
    buffer_load_dword v77, v10, s[20:23], s17 offen
    buffer_load_dword v78, v12, s[20:23], s17 offen
    buffer_load_dword v79, v13, s[20:23], s17 offen
    s_waitcnt vmcnt(58)
    v_perm_b32 v5, v21, v20, s44
    v_perm_b32 v6, v21, v20, s45
    s_waitcnt vmcnt(56)
    v_perm_b32 v213, v23, v22, v11
    v_accvgpr_write_b32 a169, v5
    v_accvgpr_write_b32 a173, v6
    s_add_u32 s17, s49, 921600
    buffer_load_dword v80, v9, s[20:23], s17 offen
    buffer_load_dword v81, v10, s[20:23], s17 offen
    buffer_load_dword v82, v12, s[20:23], s17 offen
    buffer_load_dword v83, v13, s[20:23], s17 offen
    s_waitcnt vmcnt(58)
    v_perm_b32 v5, v25, v24, s44
    v_perm_b32 v6, v25, v24, s45
    s_waitcnt vmcnt(56)
    v_perm_b32 v214, v27, v26, v11
    v_accvgpr_write_b32 a170, v5
    v_accvgpr_write_b32 a174, v6
    s_add_u32 s17, s49, 922752
    buffer_load_dword v84, v9, s[20:23], s17 offen
    buffer_load_dword v85, v10, s[20:23], s17 offen
    buffer_load_dword v86, v12, s[20:23], s17 offen
    buffer_load_dword v87, v13, s[20:23], s17 offen
    s_waitcnt vmcnt(58)
    v_perm_b32 v5, v29, v28, s44
    v_perm_b32 v6, v29, v28, s45
    s_waitcnt vmcnt(56)
    v_perm_b32 v215, v31, v30, v11
    v_accvgpr_write_b32 a171, v5
    v_accvgpr_write_b32 a175, v6
    s_add_u32 s17, s49, 923904
    buffer_load_dword v88, v9, s[20:23], s17 offen
    buffer_load_dword v89, v10, s[20:23], s17 offen
    buffer_load_dword v90, v12, s[20:23], s17 offen
    buffer_load_dword v91, v13, s[20:23], s17 offen
    s_waitcnt vmcnt(58)
    v_perm_b32 v5, v33, v32, s44
    v_perm_b32 v6, v33, v32, s45
    s_waitcnt vmcnt(56)
    v_perm_b32 v216, v35, v34, v11
    v_accvgpr_write_b32 a176, v5
    v_accvgpr_write_b32 a180, v6
    s_add_u32 s17, s49, 925056
    buffer_load_dword v92, v9, s[20:23], s17 offen
    buffer_load_dword v93, v10, s[20:23], s17 offen
    buffer_load_dword v94, v12, s[20:23], s17 offen
    buffer_load_dword v95, v13, s[20:23], s17 offen
    s_waitcnt vmcnt(58)
    v_perm_b32 v5, v37, v36, s44
    v_perm_b32 v6, v37, v36, s45
    s_waitcnt vmcnt(56)
    v_perm_b32 v217, v39, v38, v11
    v_accvgpr_write_b32 a177, v5
    v_accvgpr_write_b32 a181, v6
    s_add_u32 s17, s49, 958464
    buffer_load_dword v96, v9, s[20:23], s17 offen
    buffer_load_dword v97, v10, s[20:23], s17 offen
    buffer_load_dword v98, v12, s[20:23], s17 offen
    buffer_load_dword v99, v13, s[20:23], s17 offen
    s_waitcnt vmcnt(58)
    v_perm_b32 v5, v41, v40, s44
    v_perm_b32 v6, v41, v40, s45
    s_waitcnt vmcnt(56)
    v_perm_b32 v218, v43, v42, v11
    v_accvgpr_write_b32 a178, v5
    v_accvgpr_write_b32 a182, v6
    s_add_u32 s17, s49, 959616
    buffer_load_dword v100, v9, s[20:23], s17 offen
    buffer_load_dword v101, v10, s[20:23], s17 offen
    buffer_load_dword v102, v12, s[20:23], s17 offen
    buffer_load_dword v103, v13, s[20:23], s17 offen
    s_waitcnt vmcnt(58)
    v_perm_b32 v5, v45, v44, s44
    v_perm_b32 v6, v45, v44, s45
    s_waitcnt vmcnt(56)
    v_perm_b32 v219, v47, v46, v11
    v_accvgpr_write_b32 a179, v5
    v_accvgpr_write_b32 a183, v6
    s_add_u32 s17, s49, 960768
    buffer_load_dword v104, v9, s[20:23], s17 offen
    buffer_load_dword v105, v10, s[20:23], s17 offen
    buffer_load_dword v106, v12, s[20:23], s17 offen
    buffer_load_dword v107, v13, s[20:23], s17 offen
    s_waitcnt vmcnt(58)
    v_perm_b32 v5, v49, v48, s44
    v_perm_b32 v6, v49, v48, s45
    s_waitcnt vmcnt(56)
    v_perm_b32 v220, v51, v50, v11
    v_accvgpr_write_b32 a184, v5
    v_accvgpr_write_b32 a188, v6
    s_add_u32 s17, s49, 961920
    buffer_load_dword v108, v9, s[20:23], s17 offen
    buffer_load_dword v109, v10, s[20:23], s17 offen
    buffer_load_dword v110, v12, s[20:23], s17 offen
    buffer_load_dword v111, v13, s[20:23], s17 offen
    s_waitcnt vmcnt(58)
    v_perm_b32 v5, v53, v52, s44
    v_perm_b32 v6, v53, v52, s45
    s_waitcnt vmcnt(56)
    v_perm_b32 v221, v55, v54, v11
    v_accvgpr_write_b32 a185, v5
    v_accvgpr_write_b32 a189, v6
    s_add_u32 s17, s49, 995328
    buffer_load_dword v112, v9, s[20:23], s17 offen
    buffer_load_dword v113, v10, s[20:23], s17 offen
    buffer_load_dword v114, v12, s[20:23], s17 offen
    buffer_load_dword v115, v13, s[20:23], s17 offen
    s_waitcnt vmcnt(58)
    v_perm_b32 v5, v57, v56, s44
    v_perm_b32 v6, v57, v56, s45
    s_waitcnt vmcnt(56)
    v_perm_b32 v222, v59, v58, v11
    v_accvgpr_write_b32 a186, v5
    v_accvgpr_write_b32 a190, v6
    s_add_u32 s17, s49, 996480
    buffer_load_dword v116, v9, s[20:23], s17 offen
    buffer_load_dword v117, v10, s[20:23], s17 offen
    buffer_load_dword v118, v12, s[20:23], s17 offen
    buffer_load_dword v119, v13, s[20:23], s17 offen
    s_waitcnt vmcnt(58)
    v_perm_b32 v5, v61, v60, s44
    v_perm_b32 v6, v61, v60, s45
    s_waitcnt vmcnt(56)
    v_perm_b32 v223, v63, v62, v11
    v_accvgpr_write_b32 a187, v5
    v_accvgpr_write_b32 a191, v6
    s_add_u32 s17, s49, 997632
    buffer_load_dword v120, v9, s[20:23], s17 offen
    buffer_load_dword v121, v10, s[20:23], s17 offen
    buffer_load_dword v122, v12, s[20:23], s17 offen
    buffer_load_dword v123, v13, s[20:23], s17 offen
    s_waitcnt vmcnt(58)
    v_perm_b32 v5, v65, v64, s44
    v_perm_b32 v6, v65, v64, s45
    s_waitcnt vmcnt(56)
    v_perm_b32 v224, v67, v66, v11
    v_accvgpr_write_b32 a192, v5
    v_accvgpr_write_b32 a196, v6
    s_add_u32 s17, s49, 998784
    buffer_load_dword v124, v9, s[20:23], s17 offen
    buffer_load_dword v125, v10, s[20:23], s17 offen
    buffer_load_dword v126, v12, s[20:23], s17 offen
    buffer_load_dword v127, v13, s[20:23], s17 offen
    s_waitcnt vmcnt(58)
    v_perm_b32 v5, v69, v68, s44
    v_perm_b32 v6, v69, v68, s45
    s_waitcnt vmcnt(56)
    v_perm_b32 v225, v71, v70, v11
    v_accvgpr_write_b32 a193, v5
    v_accvgpr_write_b32 a197, v6
    s_add_u32 s17, s49, 1032192
    buffer_load_dword v16, v9, s[20:23], s17 offen
    buffer_load_dword v17, v10, s[20:23], s17 offen
    buffer_load_dword v18, v12, s[20:23], s17 offen
    buffer_load_dword v19, v13, s[20:23], s17 offen
    s_waitcnt vmcnt(58)
    v_perm_b32 v5, v73, v72, s44
    v_perm_b32 v6, v73, v72, s45
    s_waitcnt vmcnt(56)
    v_perm_b32 v226, v75, v74, v11
    v_accvgpr_write_b32 a194, v5
    v_accvgpr_write_b32 a198, v6
    s_add_u32 s17, s49, 1033344
    buffer_load_dword v20, v9, s[20:23], s17 offen
    buffer_load_dword v21, v10, s[20:23], s17 offen
    buffer_load_dword v22, v12, s[20:23], s17 offen
    buffer_load_dword v23, v13, s[20:23], s17 offen
    s_waitcnt vmcnt(58)
    v_perm_b32 v5, v77, v76, s44
    v_perm_b32 v6, v77, v76, s45
    s_waitcnt vmcnt(56)
    v_perm_b32 v227, v79, v78, v11
    v_accvgpr_write_b32 a195, v5
    v_accvgpr_write_b32 a199, v6
    s_add_u32 s17, s49, 1034496
    buffer_load_dword v24, v9, s[20:23], s17 offen
    buffer_load_dword v25, v10, s[20:23], s17 offen
    buffer_load_dword v26, v12, s[20:23], s17 offen
    buffer_load_dword v27, v13, s[20:23], s17 offen
    s_waitcnt vmcnt(58)
    v_perm_b32 v5, v81, v80, s44
    v_perm_b32 v6, v81, v80, s45
    s_waitcnt vmcnt(56)
    v_perm_b32 v228, v83, v82, v11
    v_accvgpr_write_b32 a200, v5
    v_accvgpr_write_b32 a204, v6
    s_add_u32 s17, s49, 1035648
    buffer_load_dword v28, v9, s[20:23], s17 offen
    buffer_load_dword v29, v10, s[20:23], s17 offen
    buffer_load_dword v30, v12, s[20:23], s17 offen
    buffer_load_dword v31, v13, s[20:23], s17 offen
    s_waitcnt vmcnt(58)
    v_perm_b32 v5, v85, v84, s44
    v_perm_b32 v6, v85, v84, s45
    s_waitcnt vmcnt(56)
    v_perm_b32 v229, v87, v86, v11
    v_accvgpr_write_b32 a201, v5
    v_accvgpr_write_b32 a205, v6
    s_add_u32 s17, s49, 1069056
    buffer_load_dword v32, v9, s[20:23], s17 offen
    buffer_load_dword v33, v10, s[20:23], s17 offen
    buffer_load_dword v34, v12, s[20:23], s17 offen
    buffer_load_dword v35, v13, s[20:23], s17 offen
    s_waitcnt vmcnt(58)
    v_perm_b32 v5, v89, v88, s44
    v_perm_b32 v6, v89, v88, s45
    s_waitcnt vmcnt(56)
    v_perm_b32 v230, v91, v90, v11
    v_accvgpr_write_b32 a202, v5
    v_accvgpr_write_b32 a206, v6
    s_add_u32 s17, s49, 1070208
    buffer_load_dword v36, v9, s[20:23], s17 offen
    buffer_load_dword v37, v10, s[20:23], s17 offen
    buffer_load_dword v38, v12, s[20:23], s17 offen
    buffer_load_dword v39, v13, s[20:23], s17 offen
    s_waitcnt vmcnt(58)
    v_perm_b32 v5, v93, v92, s44
    v_perm_b32 v6, v93, v92, s45
    s_waitcnt vmcnt(56)
    v_perm_b32 v231, v95, v94, v11
    v_accvgpr_write_b32 a203, v5
    v_accvgpr_write_b32 a207, v6
    s_add_u32 s17, s49, 1071360
    buffer_load_dword v40, v9, s[20:23], s17 offen
    buffer_load_dword v41, v10, s[20:23], s17 offen
    buffer_load_dword v42, v12, s[20:23], s17 offen
    buffer_load_dword v43, v13, s[20:23], s17 offen
    s_waitcnt vmcnt(58)
    v_perm_b32 v5, v97, v96, s44
    v_perm_b32 v6, v97, v96, s45
    s_waitcnt vmcnt(56)
    v_perm_b32 v232, v99, v98, v11
    v_accvgpr_write_b32 a208, v5
    v_accvgpr_write_b32 a212, v6
    s_add_u32 s17, s49, 1072512
    buffer_load_dword v44, v9, s[20:23], s17 offen
    buffer_load_dword v45, v10, s[20:23], s17 offen
    buffer_load_dword v46, v12, s[20:23], s17 offen
    buffer_load_dword v47, v13, s[20:23], s17 offen
    s_waitcnt vmcnt(58)
    v_perm_b32 v5, v101, v100, s44
    v_perm_b32 v6, v101, v100, s45
    s_waitcnt vmcnt(56)
    v_perm_b32 v233, v103, v102, v11
    v_accvgpr_write_b32 a209, v5
    v_accvgpr_write_b32 a213, v6
    s_add_u32 s17, s49, 1105920
    buffer_load_dword v48, v9, s[20:23], s17 offen
    buffer_load_dword v49, v10, s[20:23], s17 offen
    buffer_load_dword v50, v12, s[20:23], s17 offen
    buffer_load_dword v51, v13, s[20:23], s17 offen
    s_waitcnt vmcnt(58)
    v_perm_b32 v5, v105, v104, s44
    v_perm_b32 v6, v105, v104, s45
    s_waitcnt vmcnt(56)
    v_perm_b32 v234, v107, v106, v11
    v_accvgpr_write_b32 a210, v5
    v_accvgpr_write_b32 a214, v6
    s_add_u32 s17, s49, 1107072
    buffer_load_dword v52, v9, s[20:23], s17 offen
    buffer_load_dword v53, v10, s[20:23], s17 offen
    buffer_load_dword v54, v12, s[20:23], s17 offen
    buffer_load_dword v55, v13, s[20:23], s17 offen
    s_waitcnt vmcnt(58)
    v_perm_b32 v5, v109, v108, s44
    v_perm_b32 v6, v109, v108, s45
    s_waitcnt vmcnt(56)
    v_perm_b32 v235, v111, v110, v11
    v_accvgpr_write_b32 a211, v5
    v_accvgpr_write_b32 a215, v6
    s_add_u32 s17, s49, 1108224
    buffer_load_dword v56, v9, s[20:23], s17 offen
    buffer_load_dword v57, v10, s[20:23], s17 offen
    buffer_load_dword v58, v12, s[20:23], s17 offen
    buffer_load_dword v59, v13, s[20:23], s17 offen
    s_waitcnt vmcnt(58)
    v_perm_b32 v5, v113, v112, s44
    v_perm_b32 v6, v113, v112, s45
    s_waitcnt vmcnt(56)
    v_perm_b32 v236, v115, v114, v11
    v_accvgpr_write_b32 a216, v5
    v_accvgpr_write_b32 a220, v6
    s_add_u32 s17, s49, 1109376
    buffer_load_dword v60, v9, s[20:23], s17 offen
    buffer_load_dword v61, v10, s[20:23], s17 offen
    buffer_load_dword v62, v12, s[20:23], s17 offen
    buffer_load_dword v63, v13, s[20:23], s17 offen
    s_waitcnt vmcnt(58)
    v_perm_b32 v5, v117, v116, s44
    v_perm_b32 v6, v117, v116, s45
    s_waitcnt vmcnt(56)
    v_perm_b32 v237, v119, v118, v11
    v_accvgpr_write_b32 a217, v5
    v_accvgpr_write_b32 a221, v6
    s_add_u32 s17, s49, 1142784
    buffer_load_dword v64, v9, s[20:23], s17 offen
    buffer_load_dword v65, v10, s[20:23], s17 offen
    buffer_load_dword v66, v12, s[20:23], s17 offen
    buffer_load_dword v67, v13, s[20:23], s17 offen
    s_waitcnt vmcnt(58)
    v_perm_b32 v5, v121, v120, s44
    v_perm_b32 v6, v121, v120, s45
    s_waitcnt vmcnt(56)
    v_perm_b32 v238, v123, v122, v11
    v_accvgpr_write_b32 a218, v5
    v_accvgpr_write_b32 a222, v6
    s_add_u32 s17, s49, 1143936
    buffer_load_dword v68, v9, s[20:23], s17 offen
    buffer_load_dword v69, v10, s[20:23], s17 offen
    buffer_load_dword v70, v12, s[20:23], s17 offen
    buffer_load_dword v71, v13, s[20:23], s17 offen
    s_waitcnt vmcnt(58)
    v_perm_b32 v5, v125, v124, s44
    v_perm_b32 v6, v125, v124, s45
    s_waitcnt vmcnt(56)
    v_perm_b32 v239, v127, v126, v11
    v_accvgpr_write_b32 a219, v5
    v_accvgpr_write_b32 a223, v6
    s_add_u32 s17, s49, 1145088
    buffer_load_dword v72, v9, s[20:23], s17 offen
    buffer_load_dword v73, v10, s[20:23], s17 offen
    buffer_load_dword v74, v12, s[20:23], s17 offen
    buffer_load_dword v75, v13, s[20:23], s17 offen
    s_waitcnt vmcnt(58)
    v_perm_b32 v5, v17, v16, s44
    v_perm_b32 v6, v17, v16, s45
    s_waitcnt vmcnt(56)
    v_perm_b32 v240, v19, v18, v11
    v_accvgpr_write_b32 a224, v5
    v_accvgpr_write_b32 a228, v6
    s_add_u32 s17, s49, 1146240
    buffer_load_dword v76, v9, s[20:23], s17 offen
    buffer_load_dword v77, v10, s[20:23], s17 offen
    buffer_load_dword v78, v12, s[20:23], s17 offen
    buffer_load_dword v79, v13, s[20:23], s17 offen
    s_waitcnt vmcnt(58)
    v_perm_b32 v5, v21, v20, s44
    v_perm_b32 v6, v21, v20, s45
    s_waitcnt vmcnt(56)
    v_perm_b32 v241, v23, v22, v11
    v_accvgpr_write_b32 a225, v5
    v_accvgpr_write_b32 a229, v6
    s_waitcnt vmcnt(54)
    v_perm_b32 v5, v25, v24, s44
    v_perm_b32 v6, v25, v24, s45
    s_waitcnt vmcnt(52)
    v_perm_b32 v242, v27, v26, v11
    v_accvgpr_write_b32 a226, v5
    v_accvgpr_write_b32 a230, v6
    s_waitcnt vmcnt(50)
    v_perm_b32 v5, v29, v28, s44
    v_perm_b32 v6, v29, v28, s45
    s_waitcnt vmcnt(48)
    v_perm_b32 v243, v31, v30, v11
    v_accvgpr_write_b32 a227, v5
    v_accvgpr_write_b32 a231, v6
    s_waitcnt vmcnt(46)
    v_perm_b32 v5, v33, v32, s44
    v_perm_b32 v6, v33, v32, s45
    s_waitcnt vmcnt(44)
    v_perm_b32 v244, v35, v34, v11
    v_accvgpr_write_b32 a232, v5
    v_accvgpr_write_b32 a236, v6
    s_waitcnt vmcnt(42)
    v_perm_b32 v5, v37, v36, s44
    v_perm_b32 v6, v37, v36, s45
    s_waitcnt vmcnt(40)
    v_perm_b32 v245, v39, v38, v11
    v_accvgpr_write_b32 a233, v5
    v_accvgpr_write_b32 a237, v6
    s_waitcnt vmcnt(38)
    v_perm_b32 v5, v41, v40, s44
    v_perm_b32 v6, v41, v40, s45
    s_waitcnt vmcnt(36)
    v_perm_b32 v246, v43, v42, v11
    v_accvgpr_write_b32 a234, v5
    v_accvgpr_write_b32 a238, v6
    s_waitcnt vmcnt(34)
    v_perm_b32 v5, v45, v44, s44
    v_perm_b32 v6, v45, v44, s45
    s_waitcnt vmcnt(32)
    v_perm_b32 v247, v47, v46, v11
    v_accvgpr_write_b32 a235, v5
    v_accvgpr_write_b32 a239, v6
    s_waitcnt vmcnt(30)
    v_perm_b32 v5, v49, v48, s44
    v_perm_b32 v6, v49, v48, s45
    s_waitcnt vmcnt(28)
    v_perm_b32 v248, v51, v50, v11
    v_accvgpr_write_b32 a240, v5
    v_accvgpr_write_b32 a244, v6
    s_waitcnt vmcnt(26)
    v_perm_b32 v5, v53, v52, s44
    v_perm_b32 v6, v53, v52, s45
    s_waitcnt vmcnt(24)
    v_perm_b32 v249, v55, v54, v11
    v_accvgpr_write_b32 a241, v5
    v_accvgpr_write_b32 a245, v6
    s_waitcnt vmcnt(22)
    v_perm_b32 v5, v57, v56, s44
    v_perm_b32 v6, v57, v56, s45
    s_waitcnt vmcnt(20)
    v_perm_b32 v250, v59, v58, v11
    v_accvgpr_write_b32 a242, v5
    v_accvgpr_write_b32 a246, v6
    s_waitcnt vmcnt(18)
    v_perm_b32 v5, v61, v60, s44
    v_perm_b32 v6, v61, v60, s45
    s_waitcnt vmcnt(16)
    v_perm_b32 v251, v63, v62, v11
    v_accvgpr_write_b32 a243, v5
    v_accvgpr_write_b32 a247, v6
    s_waitcnt vmcnt(14)
    v_perm_b32 v5, v65, v64, s44
    v_perm_b32 v6, v65, v64, s45
    s_waitcnt vmcnt(12)
    v_perm_b32 v252, v67, v66, v11
    v_accvgpr_write_b32 a248, v5
    v_accvgpr_write_b32 a252, v6
    s_waitcnt vmcnt(10)
    v_perm_b32 v5, v69, v68, s44
    v_perm_b32 v6, v69, v68, s45
    s_waitcnt vmcnt(8)
    v_perm_b32 v253, v71, v70, v11
    v_accvgpr_write_b32 a249, v5
    v_accvgpr_write_b32 a253, v6
    s_waitcnt vmcnt(6)
    v_perm_b32 v5, v73, v72, s44
    v_perm_b32 v6, v73, v72, s45
    s_waitcnt vmcnt(4)
    v_perm_b32 v254, v75, v74, v11
    v_accvgpr_write_b32 a250, v5
    v_accvgpr_write_b32 a254, v6
    s_waitcnt vmcnt(2)
    v_perm_b32 v5, v77, v76, s44
    v_perm_b32 v6, v77, v76, s45
    s_waitcnt vmcnt(0)
    v_perm_b32 v255, v79, v78, v11
    v_accvgpr_write_b32 a251, v5
    v_accvgpr_write_b32 a255, v6
    s_and_b32 s51, s14, 1
    s_lshl_b32 s17, s51, 4
    v_add_u32 v5, s17, v7
    v_lshlrev_b32 v14, 4, v5
    v_mul_u32_u24 v13, 1152, v5
    s_mul_i32 s17, s50, 96
    v_add_u32 v13, s17, v13
    s_mul_i32 s17, s50, 3072
    v_add_u32 v12, s17, v14
    s_lshl_b32 s17, s50, 9
    v_add_u32 v14, s17, v14
    s_lshl_b32 s49, s50, 7
    s_lshl_b32 s17, s14, 2
    s_add_u32 s49, s49, s17
    s_add_u32 s49, s49, 1622016
    s_mul_i32 s17, s14, 6144
    v_add_u32 v48, s17, v0
    v_mov_b32 v49, 0x10000
    v_lshrrev_b32 v51, 4, v0
    v_min_u32 v51, 42, v51
    s_mul_i32 s17, s50, 43
    v_add_u32 v51, s17, v51
    v_lshlrev_b32 v51, 7, v51
    s_cmp_gt_u32 s14, 1
    s_cbranch_scc1 Ltw_z
    v_lshl_add_u32 v12, v8, 9, v12
    v_lshl_add_u32 v13, v8, 4, v13
    s_lshl_b32 s58, s14, 16
    s_add_u32 s58, s58, 144703488
    s_mov_b32 s43, 0
    s_mov_b32 s28, s8
    s_mov_b32 s29, s9
    s_mov_b32 s30, 0
    s_mov_b32 s31, 0x00020000
    s_mul_i32 s17, s51, 3072
    v_add_u32 v50, s17, v0
    ds_write2_b32 v49, v4, v4 offset0:0 offset1:1
    s_waitcnt lgkmcnt(0)
    s_cmp_lg_u32 s14, 0
    s_cbranch_scc1 LtwX_ini_d
    v_mov_b32 v5, 160
    s_mov_b32 s16, 0
LtwX_ini:
    global_load_dword v6, v5, s[12:13] sc1
    s_add_u32 s16, s16, 1
    s_cmp_gt_u32 s16, 100000
    s_cbranch_scc1 L_role_tw_abort
    s_waitcnt vmcnt(0)
    v_cmp_gt_u32 vcc, 123, v6
    s_nop 0
    s_cbranch_vccz LtwX_ini_d
    s_sleep 8
    s_branch LtwX_ini
LtwX_ini_d:
    s_barrier
LtwX_idle:
    s_cmp_lg_u32 s14, 0
    s_cbranch_scc1 LtwX_nw0
    s_mul_i32 s60, s32, 22528
    s_add_u32 s60, s60, 184448
    s_cmp_lt_u32 s32, 64
    s_cselect_b32 s60, s60, 3080192
    s_mul_i32 s61, s33, 22528
    s_add_u32 s61, s61, 1626240
    s_cmp_lt_u32 s33, 64
    s_cselect_b32 s61, s61, 3080192
    s_mov_b32 s16, 0
LtwX_p_1:
    buffer_load_dword v2, v1, s[8:11], s60 offen sc1
    buffer_load_dword v15, v1, s[8:11], s61 offen sc1
    s_add_u32 s16, s16, 1
    s_cmp_gt_u32 s16, 100000
    s_cbranch_scc1 L_role_tw_abort
    s_waitcnt vmcnt(1)
    v_cmp_eq_u32 vcc, 0, v2
    s_waitcnt vmcnt(0)
    v_cmp_eq_u32 s[54:55], 0, v15
    s_nop 0
    s_cmp_eq_u64 s[54:55], 0
    s_cselect_b32 s62, 2, 0
    s_cmp_eq_u64 vcc, 0
    s_cselect_b32 s62, 1, s62
    s_cmp_lg_u32 s62, 0
    s_cbranch_scc1 LtwX_p_1d
    s_sleep 4
    s_branch LtwX_p_1
LtwX_p_1d:
    v_mov_b32 v5, s62
    ds_write_b32 v49, v5
    s_waitcnt lgkmcnt(0)
LtwX_nw0:
    s_barrier
    ds_read_b32 v6, v49
    v_xor_b32 v49, 4, v49
    s_waitcnt lgkmcnt(0)
    v_readfirstlane_b32 s62, v6
    s_nop 0
    s_cmp_eq_u32 s62, 0
    s_cbranch_scc1 L_role_tw_abort
    s_cmp_lt_u32 s33, 33
    s_cselect_b32 s38, 1, 3
    s_cmp_eq_u32 s62, 2
    s_cselect_b32 s36, 1, 0
    s_cselect_b32 s37, s33, s32
    s_cselect_b32 s17, s38, 0
    s_add_u32 s33, s33, s17
    s_cmp_eq_u32 s62, 1
    s_cselect_b32 s17, 2, 0
    s_add_u32 s32, s32, s17
    s_lshl_b32 s56, s36, 6
    s_add_u32 s56, s56, s37
    s_lshl_b32 s46, s56, 18
    s_add_u32 s46, s46, s58
    s_mul_i32 s41, s36, 4718592
    s_mul_i32 s17, s37, 36864
    s_add_u32 s41, s41, s17
    s_add_u32 s41, s41, 8650752
    s_cmp_ge_u32 s37, 64
    s_cbranch_scc1 L_role_tw_abort
    buffer_load_dword v10, v51, s[8:11], s46 offen
    s_add_u32 s48, s46, 0
    buffer_load_dwordx4 v[64:67], v0, s[8:11], s48 offen offset:0
    buffer_load_dwordx4 v[68:71], v0, s[8:11], s48 offen offset:1024
    buffer_load_dwordx4 v[72:75], v0, s[8:11], s48 offen offset:2048
    buffer_load_dwordx4 v[76:79], v0, s[8:11], s48 offen offset:3072
    s_add_u32 s48, s46, 4096
    buffer_load_dwordx4 v[80:83], v0, s[8:11], s48 offen offset:0
    buffer_load_dwordx4 v[84:87], v0, s[8:11], s48 offen offset:1024
    buffer_load_dwordx4 v[88:91], v0, s[8:11], s48 offen offset:2048
    buffer_load_dwordx4 v[92:95], v0, s[8:11], s48 offen offset:3072
    s_add_u32 s48, s46, 8192
    buffer_load_dwordx4 v[96:99], v0, s[8:11], s48 offen offset:0
    buffer_load_dwordx4 v[100:103], v0, s[8:11], s48 offen offset:1024
    buffer_load_dwordx4 v[104:107], v0, s[8:11], s48 offen offset:2048
    buffer_load_dwordx4 v[108:111], v0, s[8:11], s48 offen offset:3072
    s_add_u32 s48, s46, 12288
    buffer_load_dwordx4 v[112:115], v0, s[8:11], s48 offen offset:0
    buffer_load_dwordx4 v[116:119], v0, s[8:11], s48 offen offset:1024
    buffer_load_dwordx4 v[120:123], v0, s[8:11], s48 offen offset:2048
    buffer_load_dwordx4 v[40:43], v12, s[8:11], s41 offen
LtwX_item:
    s_mov_b32 s34, s36
    s_mov_b32 s35, s37
    s_mov_b32 s47, s41
    buffer_load_dwordx4 v[124:127], v0, s[8:11], s48 offen offset:3072
    s_waitcnt vmcnt(16)
    v_mfma_f32_16x16x32_bf16 v[16:19], a[0:3], v[64:67], 0
    v_mfma_f32_16x16x32_bf16 v[20:23], a[4:7], v[64:67], 0
    v_mfma_f32_16x16x32_bf16 v[24:27], v[128:131], v[64:67], 0
    s_add_u32 s48, s46, 16384
    buffer_load_dwordx4 v[64:67], v0, s[8:11], s48 offen offset:0
    s_waitcnt vmcnt(16)
    v_mfma_f32_16x16x32_bf16 v[28:31], a[0:3], v[68:71], 0
    v_mfma_f32_16x16x32_bf16 v[32:35], a[4:7], v[68:71], 0
    v_mfma_f32_16x16x32_bf16 v[36:39], v[128:131], v[68:71], 0
    buffer_load_dwordx4 v[68:71], v0, s[8:11], s48 offen offset:1024
    s_waitcnt vmcnt(16)
    v_mfma_f32_16x16x32_bf16 v[16:19], a[8:11], v[72:75], v[16:19]
    v_mfma_f32_16x16x32_bf16 v[20:23], a[12:15], v[72:75], v[20:23]
    v_mfma_f32_16x16x32_bf16 v[24:27], v[132:135], v[72:75], v[24:27]
    buffer_load_dwordx4 v[72:75], v0, s[8:11], s48 offen offset:2048
    s_waitcnt vmcnt(16)
    v_mfma_f32_16x16x32_bf16 v[28:31], a[8:11], v[76:79], v[28:31]
    v_mfma_f32_16x16x32_bf16 v[32:35], a[12:15], v[76:79], v[32:35]
    v_mfma_f32_16x16x32_bf16 v[36:39], v[132:135], v[76:79], v[36:39]
    buffer_load_dwordx4 v[76:79], v0, s[8:11], s48 offen offset:3072
    s_waitcnt vmcnt(16)
    v_mfma_f32_16x16x32_bf16 v[16:19], a[16:19], v[80:83], v[16:19]
    v_mfma_f32_16x16x32_bf16 v[20:23], a[20:23], v[80:83], v[20:23]
    v_mfma_f32_16x16x32_bf16 v[24:27], v[136:139], v[80:83], v[24:27]
    s_add_u32 s48, s46, 20480
    buffer_load_dwordx4 v[80:83], v0, s[8:11], s48 offen offset:0
    s_waitcnt vmcnt(16)
    v_mfma_f32_16x16x32_bf16 v[28:31], a[16:19], v[84:87], v[28:31]
    v_mfma_f32_16x16x32_bf16 v[32:35], a[20:23], v[84:87], v[32:35]
    v_mfma_f32_16x16x32_bf16 v[36:39], v[136:139], v[84:87], v[36:39]
    buffer_load_dwordx4 v[84:87], v0, s[8:11], s48 offen offset:1024
    s_waitcnt vmcnt(16)
    v_mfma_f32_16x16x32_bf16 v[16:19], a[24:27], v[88:91], v[16:19]
    v_mfma_f32_16x16x32_bf16 v[20:23], a[28:31], v[88:91], v[20:23]
    v_mfma_f32_16x16x32_bf16 v[24:27], v[140:143], v[88:91], v[24:27]
    buffer_load_dwordx4 v[88:91], v0, s[8:11], s48 offen offset:2048
    s_waitcnt vmcnt(16)
    v_mfma_f32_16x16x32_bf16 v[28:31], a[24:27], v[92:95], v[28:31]
    v_mfma_f32_16x16x32_bf16 v[32:35], a[28:31], v[92:95], v[32:35]
    v_mfma_f32_16x16x32_bf16 v[36:39], v[140:143], v[92:95], v[36:39]
    buffer_load_dwordx4 v[92:95], v0, s[8:11], s48 offen offset:3072
    s_waitcnt vmcnt(16)
    v_mfma_f32_16x16x32_bf16 v[16:19], a[32:35], v[96:99], v[16:19]
    v_mfma_f32_16x16x32_bf16 v[20:23], a[36:39], v[96:99], v[20:23]
    v_mfma_f32_16x16x32_bf16 v[24:27], v[144:147], v[96:99], v[24:27]
    s_add_u32 s48, s46, 24576
    buffer_load_dwordx4 v[96:99], v0, s[8:11], s48 offen offset:0
    s_waitcnt vmcnt(16)
    v_mfma_f32_16x16x32_bf16 v[28:31], a[32:35], v[100:103], v[28:31]
    v_mfma_f32_16x16x32_bf16 v[32:35], a[36:39], v[100:103], v[32:35]
    v_mfma_f32_16x16x32_bf16 v[36:39], v[144:147], v[100:103], v[36:39]
    buffer_load_dwordx4 v[100:103], v0, s[8:11], s48 offen offset:1024
    s_waitcnt vmcnt(16)
    v_mfma_f32_16x16x32_bf16 v[16:19], a[40:43], v[104:107], v[16:19]
    v_mfma_f32_16x16x32_bf16 v[20:23], a[44:47], v[104:107], v[20:23]
    v_mfma_f32_16x16x32_bf16 v[24:27], v[148:151], v[104:107], v[24:27]
    buffer_load_dwordx4 v[104:107], v0, s[8:11], s48 offen offset:2048
    s_waitcnt vmcnt(16)
    v_mfma_f32_16x16x32_bf16 v[28:31], a[40:43], v[108:111], v[28:31]
    v_mfma_f32_16x16x32_bf16 v[32:35], a[44:47], v[108:111], v[32:35]
    v_mfma_f32_16x16x32_bf16 v[36:39], v[148:151], v[108:111], v[36:39]
    buffer_load_dwordx4 v[108:111], v0, s[8:11], s48 offen offset:3072
    s_waitcnt vmcnt(16)
    v_mfma_f32_16x16x32_bf16 v[16:19], a[48:51], v[112:115], v[16:19]
    v_mfma_f32_16x16x32_bf16 v[20:23], a[52:55], v[112:115], v[20:23]
    v_mfma_f32_16x16x32_bf16 v[24:27], v[152:155], v[112:115], v[24:27]
    s_add_u32 s48, s46, 28672
    buffer_load_dwordx4 v[112:115], v0, s[8:11], s48 offen offset:0
    s_waitcnt vmcnt(16)
    v_mfma_f32_16x16x32_bf16 v[28:31], a[48:51], v[116:119], v[28:31]
    v_mfma_f32_16x16x32_bf16 v[32:35], a[52:55], v[116:119], v[32:35]
    v_mfma_f32_16x16x32_bf16 v[36:39], v[152:155], v[116:119], v[36:39]
    buffer_load_dwordx4 v[116:119], v0, s[8:11], s48 offen offset:1024
    s_waitcnt vmcnt(16)
    v_mfma_f32_16x16x32_bf16 v[16:19], a[56:59], v[120:123], v[16:19]
    v_mfma_f32_16x16x32_bf16 v[20:23], a[60:63], v[120:123], v[20:23]
    v_mfma_f32_16x16x32_bf16 v[24:27], v[156:159], v[120:123], v[24:27]
    buffer_load_dwordx4 v[120:123], v0, s[8:11], s48 offen offset:2048
    s_waitcnt vmcnt(15)
    v_mfma_f32_16x16x32_bf16 v[28:31], a[56:59], v[124:127], v[28:31]
    v_mfma_f32_16x16x32_bf16 v[32:35], a[60:63], v[124:127], v[32:35]
    v_mfma_f32_16x16x32_bf16 v[36:39], v[156:159], v[124:127], v[36:39]
    buffer_load_dwordx4 v[124:127], v0, s[8:11], s48 offen offset:3072
    s_waitcnt vmcnt(15)
    v_mfma_f32_16x16x32_bf16 v[16:19], a[64:67], v[64:67], v[16:19]
    v_mfma_f32_16x16x32_bf16 v[20:23], a[68:71], v[64:67], v[20:23]
    v_mfma_f32_16x16x32_bf16 v[24:27], v[160:163], v[64:67], v[24:27]
    s_add_u32 s48, s46, 32768
    buffer_load_dwordx4 v[64:67], v0, s[8:11], s48 offen offset:0
    s_waitcnt vmcnt(15)
    v_mfma_f32_16x16x32_bf16 v[28:31], a[64:67], v[68:71], v[28:31]
    v_mfma_f32_16x16x32_bf16 v[32:35], a[68:71], v[68:71], v[32:35]
    v_mfma_f32_16x16x32_bf16 v[36:39], v[160:163], v[68:71], v[36:39]
    s_cmp_lg_u32 s43, 0
    s_cselect_b64 exec, 1, 0
    buffer_store_dword v3, v4, s[8:11], s43 offen sc1
    s_mov_b64 exec, -1
    s_mov_b32 s43, 0
    buffer_load_dwordx4 v[68:71], v0, s[8:11], s48 offen offset:1024
    s_waitcnt vmcnt(16)
    v_mfma_f32_16x16x32_bf16 v[16:19], a[72:75], v[72:75], v[16:19]
    v_mfma_f32_16x16x32_bf16 v[20:23], a[76:79], v[72:75], v[20:23]
    v_mfma_f32_16x16x32_bf16 v[24:27], v[164:167], v[72:75], v[24:27]
    buffer_load_dwordx4 v[72:75], v0, s[8:11], s48 offen offset:2048
    s_waitcnt vmcnt(16)
    v_mfma_f32_16x16x32_bf16 v[28:31], a[72:75], v[76:79], v[28:31]
    v_mfma_f32_16x16x32_bf16 v[32:35], a[76:79], v[76:79], v[32:35]
    v_mfma_f32_16x16x32_bf16 v[36:39], v[164:167], v[76:79], v[36:39]
    buffer_load_dwordx4 v[76:79], v0, s[8:11], s48 offen offset:3072
    s_waitcnt vmcnt(16)
    v_mfma_f32_16x16x32_bf16 v[16:19], a[80:83], v[80:83], v[16:19]
    v_mfma_f32_16x16x32_bf16 v[20:23], a[84:87], v[80:83], v[20:23]
    v_mfma_f32_16x16x32_bf16 v[24:27], v[168:171], v[80:83], v[24:27]
    s_add_u32 s48, s46, 36864
    buffer_load_dwordx4 v[80:83], v0, s[8:11], s48 offen offset:0
    s_waitcnt vmcnt(16)
    v_mfma_f32_16x16x32_bf16 v[28:31], a[80:83], v[84:87], v[28:31]
    v_mfma_f32_16x16x32_bf16 v[32:35], a[84:87], v[84:87], v[32:35]
    v_mfma_f32_16x16x32_bf16 v[36:39], v[168:171], v[84:87], v[36:39]
    buffer_load_dwordx4 v[84:87], v0, s[8:11], s48 offen offset:1024
    s_waitcnt vmcnt(16)
    v_mfma_f32_16x16x32_bf16 v[16:19], a[88:91], v[88:91], v[16:19]
    v_mfma_f32_16x16x32_bf16 v[20:23], a[92:95], v[88:91], v[20:23]
    v_mfma_f32_16x16x32_bf16 v[24:27], v[172:175], v[88:91], v[24:27]
    buffer_load_dwordx4 v[88:91], v0, s[8:11], s48 offen offset:2048
    s_waitcnt vmcnt(16)
    v_mfma_f32_16x16x32_bf16 v[28:31], a[88:91], v[92:95], v[28:31]
    v_mfma_f32_16x16x32_bf16 v[32:35], a[92:95], v[92:95], v[32:35]
    v_mfma_f32_16x16x32_bf16 v[36:39], v[172:175], v[92:95], v[36:39]
    buffer_load_dwordx4 v[92:95], v0, s[8:11], s48 offen offset:3072
    s_waitcnt vmcnt(16)
    v_mfma_f32_16x16x32_bf16 v[16:19], a[96:99], v[96:99], v[16:19]
    v_mfma_f32_16x16x32_bf16 v[20:23], a[100:103], v[96:99], v[20:23]
    v_mfma_f32_16x16x32_bf16 v[24:27], v[176:179], v[96:99], v[24:27]
    s_add_u32 s48, s46, 40960
    buffer_load_dwordx4 v[96:99], v0, s[8:11], s48 offen offset:0
    s_waitcnt vmcnt(16)
    v_mfma_f32_16x16x32_bf16 v[28:31], a[96:99], v[100:103], v[28:31]
    v_mfma_f32_16x16x32_bf16 v[32:35], a[100:103], v[100:103], v[32:35]
    v_mfma_f32_16x16x32_bf16 v[36:39], v[176:179], v[100:103], v[36:39]
    buffer_load_dwordx4 v[100:103], v0, s[8:11], s48 offen offset:1024
    s_waitcnt vmcnt(16)
    v_mfma_f32_16x16x32_bf16 v[16:19], a[104:107], v[104:107], v[16:19]
    v_mfma_f32_16x16x32_bf16 v[20:23], a[108:111], v[104:107], v[20:23]
    v_mfma_f32_16x16x32_bf16 v[24:27], v[180:183], v[104:107], v[24:27]
    s_cmp_lg_u32 s14, 0
    s_cbranch_scc1 LtwX_nw1
    s_mul_i32 s60, s32, 22528
    s_add_u32 s60, s60, 184448
    s_cmp_lt_u32 s32, 64
    s_cselect_b32 s60, s60, 3080192
    s_mul_i32 s61, s33, 22528
    s_add_u32 s61, s61, 1626240
    s_cmp_lt_u32 s33, 64
    s_cselect_b32 s61, s61, 3080192
    buffer_load_dword v2, v1, s[8:11], s60 offen sc1
    buffer_load_dword v15, v1, s[8:11], s61 offen sc1
LtwX_nw1:
    buffer_load_dwordx4 v[104:107], v0, s[8:11], s48 offen offset:2048
    s_waitcnt vmcnt(16)
    v_mfma_f32_16x16x32_bf16 v[28:31], a[104:107], v[108:111], v[28:31]
    v_mfma_f32_16x16x32_bf16 v[32:35], a[108:111], v[108:111], v[32:35]
    v_mfma_f32_16x16x32_bf16 v[36:39], v[180:183], v[108:111], v[36:39]
    buffer_load_dwordx4 v[108:111], v0, s[8:11], s48 offen offset:3072
    s_waitcnt vmcnt(16)
    v_mfma_f32_16x16x32_bf16 v[16:19], a[112:115], v[112:115], v[16:19]
    v_mfma_f32_16x16x32_bf16 v[20:23], a[116:119], v[112:115], v[20:23]
    v_mfma_f32_16x16x32_bf16 v[24:27], v[184:187], v[112:115], v[24:27]
    s_add_u32 s48, s46, 45056
    buffer_load_dwordx4 v[112:115], v0, s[8:11], s48 offen offset:0
    s_waitcnt vmcnt(16)
    v_mfma_f32_16x16x32_bf16 v[28:31], a[112:115], v[116:119], v[28:31]
    v_mfma_f32_16x16x32_bf16 v[32:35], a[116:119], v[116:119], v[32:35]
    v_mfma_f32_16x16x32_bf16 v[36:39], v[184:187], v[116:119], v[36:39]
    buffer_load_dwordx4 v[116:119], v0, s[8:11], s48 offen offset:1024
    s_waitcnt vmcnt(16)
    v_mfma_f32_16x16x32_bf16 v[16:19], a[120:123], v[120:123], v[16:19]
    v_mfma_f32_16x16x32_bf16 v[20:23], a[124:127], v[120:123], v[20:23]
    v_mfma_f32_16x16x32_bf16 v[24:27], v[188:191], v[120:123], v[24:27]
    buffer_load_dwordx4 v[120:123], v0, s[8:11], s48 offen offset:2048
    s_waitcnt vmcnt(16)
    v_mfma_f32_16x16x32_bf16 v[28:31], a[120:123], v[124:127], v[28:31]
    v_mfma_f32_16x16x32_bf16 v[32:35], a[124:127], v[124:127], v[32:35]
    v_mfma_f32_16x16x32_bf16 v[36:39], v[188:191], v[124:127], v[36:39]
    buffer_load_dwordx4 v[124:127], v0, s[8:11], s48 offen offset:3072
    s_waitcnt vmcnt(16)
    v_mfma_f32_16x16x32_bf16 v[16:19], a[128:131], v[64:67], v[16:19]
    v_mfma_f32_16x16x32_bf16 v[20:23], a[132:135], v[64:67], v[20:23]
    v_mfma_f32_16x16x32_bf16 v[24:27], v[192:195], v[64:67], v[24:27]
    s_add_u32 s48, s46, 49152
    buffer_load_dwordx4 v[64:67], v0, s[8:11], s48 offen offset:0
    s_waitcnt vmcnt(15)
    v_mfma_f32_16x16x32_bf16 v[28:31], a[128:131], v[68:71], v[28:31]
    v_mfma_f32_16x16x32_bf16 v[32:35], a[132:135], v[68:71], v[32:35]
    v_mfma_f32_16x16x32_bf16 v[36:39], v[192:195], v[68:71], v[36:39]
    buffer_load_dwordx4 v[68:71], v0, s[8:11], s48 offen offset:1024
    s_waitcnt vmcnt(15)
    v_mfma_f32_16x16x32_bf16 v[16:19], a[136:139], v[72:75], v[16:19]
    v_mfma_f32_16x16x32_bf16 v[20:23], a[140:143], v[72:75], v[20:23]
    v_mfma_f32_16x16x32_bf16 v[24:27], v[196:199], v[72:75], v[24:27]
    buffer_load_dwordx4 v[72:75], v0, s[8:11], s48 offen offset:2048
    s_waitcnt vmcnt(15)
    v_mfma_f32_16x16x32_bf16 v[28:31], a[136:139], v[76:79], v[28:31]
    v_mfma_f32_16x16x32_bf16 v[32:35], a[140:143], v[76:79], v[32:35]
    v_mfma_f32_16x16x32_bf16 v[36:39], v[196:199], v[76:79], v[36:39]
    buffer_load_dwordx4 v[76:79], v0, s[8:11], s48 offen offset:3072
    s_waitcnt vmcnt(15)
    v_mfma_f32_16x16x32_bf16 v[16:19], a[144:147], v[80:83], v[16:19]
    v_mfma_f32_16x16x32_bf16 v[20:23], a[148:151], v[80:83], v[20:23]
    v_mfma_f32_16x16x32_bf16 v[24:27], v[200:203], v[80:83], v[24:27]
    s_add_u32 s48, s46, 53248
    buffer_load_dwordx4 v[80:83], v0, s[8:11], s48 offen offset:0
    s_waitcnt vmcnt(15)
    v_mfma_f32_16x16x32_bf16 v[28:31], a[144:147], v[84:87], v[28:31]
    v_mfma_f32_16x16x32_bf16 v[32:35], a[148:151], v[84:87], v[32:35]
    v_mfma_f32_16x16x32_bf16 v[36:39], v[200:203], v[84:87], v[36:39]
    buffer_load_dwordx4 v[84:87], v0, s[8:11], s48 offen offset:1024
    s_waitcnt vmcnt(15)
    v_mfma_f32_16x16x32_bf16 v[16:19], a[152:155], v[88:91], v[16:19]
    v_mfma_f32_16x16x32_bf16 v[20:23], a[156:159], v[88:91], v[20:23]
    v_mfma_f32_16x16x32_bf16 v[24:27], v[204:207], v[88:91], v[24:27]
    buffer_load_dwordx4 v[88:91], v0, s[8:11], s48 offen offset:2048
    s_waitcnt vmcnt(15)
    v_mfma_f32_16x16x32_bf16 v[28:31], a[152:155], v[92:95], v[28:31]
    v_mfma_f32_16x16x32_bf16 v[32:35], a[156:159], v[92:95], v[32:35]
    v_mfma_f32_16x16x32_bf16 v[36:39], v[204:207], v[92:95], v[36:39]
    buffer_load_dwordx4 v[92:95], v0, s[8:11], s48 offen offset:3072
    s_waitcnt vmcnt(15)
    v_mfma_f32_16x16x32_bf16 v[16:19], a[160:163], v[96:99], v[16:19]
    v_mfma_f32_16x16x32_bf16 v[20:23], a[164:167], v[96:99], v[20:23]
    v_mfma_f32_16x16x32_bf16 v[24:27], v[208:211], v[96:99], v[24:27]
    s_add_u32 s48, s46, 57344
    buffer_load_dwordx4 v[96:99], v0, s[8:11], s48 offen offset:0
    s_waitcnt vmcnt(15)
    v_mfma_f32_16x16x32_bf16 v[28:31], a[160:163], v[100:103], v[28:31]
    v_mfma_f32_16x16x32_bf16 v[32:35], a[164:167], v[100:103], v[32:35]
    v_mfma_f32_16x16x32_bf16 v[36:39], v[208:211], v[100:103], v[36:39]
    buffer_load_dwordx4 v[100:103], v0, s[8:11], s48 offen offset:1024
    s_waitcnt vmcnt(15)
    v_mfma_f32_16x16x32_bf16 v[16:19], a[168:171], v[104:107], v[16:19]
    v_mfma_f32_16x16x32_bf16 v[20:23], a[172:175], v[104:107], v[20:23]
    v_mfma_f32_16x16x32_bf16 v[24:27], v[212:215], v[104:107], v[24:27]
    buffer_load_dwordx4 v[104:107], v0, s[8:11], s48 offen offset:2048
    s_waitcnt vmcnt(15)
    v_mfma_f32_16x16x32_bf16 v[28:31], a[168:171], v[108:111], v[28:31]
    v_mfma_f32_16x16x32_bf16 v[32:35], a[172:175], v[108:111], v[32:35]
    v_mfma_f32_16x16x32_bf16 v[36:39], v[212:215], v[108:111], v[36:39]
    buffer_load_dwordx4 v[108:111], v0, s[8:11], s48 offen offset:3072
    s_waitcnt vmcnt(15)
    v_mfma_f32_16x16x32_bf16 v[16:19], a[176:179], v[112:115], v[16:19]
    v_mfma_f32_16x16x32_bf16 v[20:23], a[180:183], v[112:115], v[20:23]
    v_mfma_f32_16x16x32_bf16 v[24:27], v[216:219], v[112:115], v[24:27]
    s_cmp_lg_u32 s14, 0
    s_cbranch_scc1 LtwX_nw2
    v_cmp_eq_u32 vcc, 0, v2
    v_cmp_eq_u32 s[54:55], 0, v15
    s_nop 0
    s_cmp_eq_u64 s[54:55], 0
    s_cselect_b32 s62, 2, 0
    s_cmp_eq_u64 vcc, 0
    s_cselect_b32 s62, 1, s62
    v_mov_b32 v5, s62
    ds_write_b32 v49, v5
    s_waitcnt lgkmcnt(0)
LtwX_nw2:
    s_barrier
    ds_read_b32 v6, v49
    v_xor_b32 v49, 4, v49
    s_add_u32 s48, s46, 61440
    buffer_load_dwordx4 v[112:115], v0, s[8:11], s48 offen offset:0
    s_waitcnt vmcnt(15)
    v_mfma_f32_16x16x32_bf16 v[28:31], a[176:179], v[116:119], v[28:31]
    v_mfma_f32_16x16x32_bf16 v[32:35], a[180:183], v[116:119], v[32:35]
    v_mfma_f32_16x16x32_bf16 v[36:39], v[216:219], v[116:119], v[36:39]
    buffer_load_dwordx4 v[116:119], v0, s[8:11], s48 offen offset:1024
    s_waitcnt vmcnt(15)
    v_mfma_f32_16x16x32_bf16 v[16:19], a[184:187], v[120:123], v[16:19]
    v_mfma_f32_16x16x32_bf16 v[20:23], a[188:191], v[120:123], v[20:23]
    v_mfma_f32_16x16x32_bf16 v[24:27], v[220:223], v[120:123], v[24:27]
    buffer_load_dwordx4 v[120:123], v0, s[8:11], s48 offen offset:2048
    s_waitcnt vmcnt(15)
    v_mfma_f32_16x16x32_bf16 v[28:31], a[184:187], v[124:127], v[28:31]
    v_mfma_f32_16x16x32_bf16 v[32:35], a[188:191], v[124:127], v[32:35]
    v_mfma_f32_16x16x32_bf16 v[36:39], v[220:223], v[124:127], v[36:39]
    s_waitcnt lgkmcnt(0)
    v_readfirstlane_b32 s62, v6
    s_cmp_lt_u32 s33, 33
    s_cselect_b32 s38, 1, 3
    s_cmp_eq_u32 s62, 2
    s_cselect_b32 s36, 1, 0
    s_cselect_b32 s37, s33, s32
    s_cselect_b32 s17, s38, 0
    s_add_u32 s33, s33, s17
    s_cmp_eq_u32 s62, 1
    s_cselect_b32 s17, 2, 0
    s_add_u32 s32, s32, s17
    s_lshl_b32 s56, s36, 6
    s_add_u32 s56, s56, s37
    buffer_load_dwordx4 v[124:127], v0, s[8:11], s48 offen offset:3072
    s_waitcnt vmcnt(15)
    v_mfma_f32_16x16x32_bf16 v[16:19], a[192:195], v[64:67], v[16:19]
    v_mfma_f32_16x16x32_bf16 v[20:23], a[196:199], v[64:67], v[20:23]
    v_mfma_f32_16x16x32_bf16 v[24:27], v[224:227], v[64:67], v[24:27]
    s_cmp_lt_u32 s37, 64
    s_cselect_b32 s62, s62, 0
    s_lshl_b32 s46, s56, 18
    s_add_u32 s46, s46, s58
    s_mul_i32 s41, s36, 4718592
    s_mul_i32 s17, s37, 36864
    s_add_u32 s41, s41, s17
    s_add_u32 s41, s41, 8650752
    s_cmp_lg_u32 s62, 0
    s_cselect_b32 s30, 268435456, 0
    buffer_load_dword v10, v51, s[28:31], s46 offen
    s_add_u32 s48, s46, 0
    buffer_load_dwordx4 v[64:67], v0, s[28:31], s48 offen offset:0
    s_waitcnt vmcnt(15)
    v_mfma_f32_16x16x32_bf16 v[28:31], a[192:195], v[68:71], v[28:31]
    v_mfma_f32_16x16x32_bf16 v[32:35], a[196:199], v[68:71], v[32:35]
    v_mfma_f32_16x16x32_bf16 v[36:39], v[224:227], v[68:71], v[36:39]
    buffer_load_dwordx4 v[68:71], v0, s[28:31], s48 offen offset:1024
    s_waitcnt vmcnt(15)
    v_mfma_f32_16x16x32_bf16 v[16:19], a[200:203], v[72:75], v[16:19]
    v_mfma_f32_16x16x32_bf16 v[20:23], a[204:207], v[72:75], v[20:23]
    v_mfma_f32_16x16x32_bf16 v[24:27], v[228:231], v[72:75], v[24:27]
    buffer_load_dwordx4 v[72:75], v0, s[28:31], s48 offen offset:2048
    s_waitcnt vmcnt(15)
    v_mfma_f32_16x16x32_bf16 v[28:31], a[200:203], v[76:79], v[28:31]
    v_mfma_f32_16x16x32_bf16 v[32:35], a[204:207], v[76:79], v[32:35]
    v_mfma_f32_16x16x32_bf16 v[36:39], v[228:231], v[76:79], v[36:39]
    buffer_load_dwordx4 v[76:79], v0, s[28:31], s48 offen offset:3072
    s_waitcnt vmcnt(15)
    v_mfma_f32_16x16x32_bf16 v[16:19], a[208:211], v[80:83], v[16:19]
    v_mfma_f32_16x16x32_bf16 v[20:23], a[212:215], v[80:83], v[20:23]
    v_mfma_f32_16x16x32_bf16 v[24:27], v[232:235], v[80:83], v[24:27]
    s_add_u32 s48, s46, 4096
    buffer_load_dwordx4 v[80:83], v0, s[28:31], s48 offen offset:0
    s_waitcnt vmcnt(15)
    v_mfma_f32_16x16x32_bf16 v[28:31], a[208:211], v[84:87], v[28:31]
    v_mfma_f32_16x16x32_bf16 v[32:35], a[212:215], v[84:87], v[32:35]
    v_mfma_f32_16x16x32_bf16 v[36:39], v[232:235], v[84:87], v[36:39]
    buffer_load_dwordx4 v[84:87], v0, s[28:31], s48 offen offset:1024
    s_waitcnt vmcnt(15)
    v_mfma_f32_16x16x32_bf16 v[16:19], a[216:219], v[88:91], v[16:19]
    v_mfma_f32_16x16x32_bf16 v[20:23], a[220:223], v[88:91], v[20:23]
    v_mfma_f32_16x16x32_bf16 v[24:27], v[236:239], v[88:91], v[24:27]
    buffer_load_dwordx4 v[88:91], v0, s[28:31], s48 offen offset:2048
    s_waitcnt vmcnt(15)
    v_mfma_f32_16x16x32_bf16 v[28:31], a[216:219], v[92:95], v[28:31]
    v_mfma_f32_16x16x32_bf16 v[32:35], a[220:223], v[92:95], v[32:35]
    v_mfma_f32_16x16x32_bf16 v[36:39], v[236:239], v[92:95], v[36:39]
    buffer_load_dwordx4 v[92:95], v0, s[28:31], s48 offen offset:3072
    s_waitcnt vmcnt(15)
    v_mfma_f32_16x16x32_bf16 v[16:19], a[224:227], v[96:99], v[16:19]
    v_mfma_f32_16x16x32_bf16 v[20:23], a[228:231], v[96:99], v[20:23]
    v_mfma_f32_16x16x32_bf16 v[24:27], v[240:243], v[96:99], v[24:27]
    s_add_u32 s48, s46, 8192
    buffer_load_dwordx4 v[96:99], v0, s[28:31], s48 offen offset:0
    s_waitcnt vmcnt(15)
    v_mfma_f32_16x16x32_bf16 v[28:31], a[224:227], v[100:103], v[28:31]
    v_mfma_f32_16x16x32_bf16 v[32:35], a[228:231], v[100:103], v[32:35]
    v_mfma_f32_16x16x32_bf16 v[36:39], v[240:243], v[100:103], v[36:39]
    buffer_load_dwordx4 v[100:103], v0, s[28:31], s48 offen offset:1024
    s_waitcnt vmcnt(15)
    v_mfma_f32_16x16x32_bf16 v[16:19], a[232:235], v[104:107], v[16:19]
    v_mfma_f32_16x16x32_bf16 v[20:23], a[236:239], v[104:107], v[20:23]
    v_mfma_f32_16x16x32_bf16 v[24:27], v[244:247], v[104:107], v[24:27]
    buffer_load_dwordx4 v[104:107], v0, s[28:31], s48 offen offset:2048
    s_waitcnt vmcnt(15)
    v_mfma_f32_16x16x32_bf16 v[28:31], a[232:235], v[108:111], v[28:31]
    v_mfma_f32_16x16x32_bf16 v[32:35], a[236:239], v[108:111], v[32:35]
    v_mfma_f32_16x16x32_bf16 v[36:39], v[244:247], v[108:111], v[36:39]
    buffer_load_dwordx4 v[108:111], v0, s[28:31], s48 offen offset:3072
    s_waitcnt vmcnt(15)
    v_mfma_f32_16x16x32_bf16 v[16:19], a[240:243], v[112:115], v[16:19]
    v_mfma_f32_16x16x32_bf16 v[20:23], a[244:247], v[112:115], v[20:23]
    v_mfma_f32_16x16x32_bf16 v[24:27], v[248:251], v[112:115], v[24:27]
    s_add_u32 s48, s46, 12288
    buffer_load_dwordx4 v[112:115], v0, s[28:31], s48 offen offset:0
    s_waitcnt vmcnt(15)
    v_mfma_f32_16x16x32_bf16 v[28:31], a[240:243], v[116:119], v[28:31]
    v_mfma_f32_16x16x32_bf16 v[32:35], a[244:247], v[116:119], v[32:35]
    v_mfma_f32_16x16x32_bf16 v[36:39], v[248:251], v[116:119], v[36:39]
    buffer_load_dwordx4 v[116:119], v0, s[28:31], s48 offen offset:1024
    s_waitcnt vmcnt(15)
    v_mfma_f32_16x16x32_bf16 v[16:19], a[248:251], v[120:123], v[16:19]
    v_mfma_f32_16x16x32_bf16 v[20:23], a[252:255], v[120:123], v[20:23]
    v_mfma_f32_16x16x32_bf16 v[24:27], v[252:255], v[120:123], v[24:27]
    buffer_load_dwordx4 v[120:123], v0, s[28:31], s48 offen offset:2048
    s_waitcnt vmcnt(15)
    v_mfma_f32_16x16x32_bf16 v[28:31], a[248:251], v[124:127], v[28:31]
    v_mfma_f32_16x16x32_bf16 v[32:35], a[252:255], v[124:127], v[32:35]
    v_mfma_f32_16x16x32_bf16 v[36:39], v[252:255], v[124:127], v[36:39]
    s_nop 5
    ds_write_b128 v48, v[16:19] offset:0
    ds_write_b128 v48, v[20:23] offset:1024
    ds_write_b128 v48, v[24:27] offset:2048
    ds_write_b128 v48, v[28:31] offset:3072
    ds_write_b128 v48, v[32:35] offset:4096
    ds_write_b128 v48, v[36:39] offset:5120
    s_waitcnt lgkmcnt(0)
    s_barrier
    ds_read_b128 v[24:27], v50 offset:0
    ds_read_b128 v[28:31], v50 offset:1024
    ds_read_b128 v[32:35], v50 offset:6144
    ds_read_b128 v[36:39], v50 offset:7168
    ds_read_b128 v[56:59], v50 offset:12288
    ds_read_b128 v[60:63], v50 offset:13312
    ds_read_b128 v[124:127], v50 offset:18432
    ds_read_b128 v[52:55], v50 offset:19456
    v_xor_b32 v48, 0x8000, v48
    v_xor_b32 v50, 0x8000, v50
    v_lshlrev_b32 v16, 16, v40
    v_and_b32 v20, 0xffff0000, v40
    v_lshlrev_b32 v17, 16, v41
    v_and_b32 v21, 0xffff0000, v41
    v_lshlrev_b32 v18, 16, v42
    v_and_b32 v22, 0xffff0000, v42
    v_lshlrev_b32 v19, 16, v43
    v_and_b32 v23, 0xffff0000, v43
    buffer_load_dwordx4 v[40:43], v12, s[28:31], s41 offen
    s_waitcnt lgkmcnt(7)
    v_add_f32 v16, v16, v24
    v_add_f32 v17, v17, v25
    v_add_f32 v18, v18, v26
    v_add_f32 v19, v19, v27
    s_waitcnt lgkmcnt(6)
    v_add_f32 v20, v20, v28
    v_add_f32 v21, v21, v29
    v_add_f32 v22, v22, v30
    v_add_f32 v23, v23, v31
    s_waitcnt lgkmcnt(5)
    v_add_f32 v16, v16, v32
    v_add_f32 v17, v17, v33
    v_add_f32 v18, v18, v34
    v_add_f32 v19, v19, v35
    s_waitcnt lgkmcnt(4)
    v_add_f32 v20, v20, v36
    v_add_f32 v21, v21, v37
    v_add_f32 v22, v22, v38
    v_add_f32 v23, v23, v39
    s_waitcnt lgkmcnt(3)
    v_add_f32 v16, v16, v56
    v_add_f32 v17, v17, v57
    v_add_f32 v18, v18, v58
    v_add_f32 v19, v19, v59
    s_waitcnt lgkmcnt(2)
    v_add_f32 v20, v20, v60
    v_add_f32 v21, v21, v61
    v_add_f32 v22, v22, v62
    v_add_f32 v23, v23, v63
    s_waitcnt lgkmcnt(1)
    v_add_f32 v16, v16, v124
    v_add_f32 v17, v17, v125
    v_add_f32 v18, v18, v126
    v_add_f32 v19, v19, v127
    s_waitcnt lgkmcnt(0)
    v_add_f32 v20, v20, v52
    v_add_f32 v21, v21, v53
    v_add_f32 v22, v22, v54
    v_add_f32 v23, v23, v55
    v_cvt_pk_bf16_f32 v52, v16, v20
    v_cvt_pk_bf16_f32 v53, v17, v21
    v_cvt_pk_bf16_f32 v54, v18, v22
    v_cvt_pk_bf16_f32 v55, v19, v23
    s_cmp_eq_u32 s34, 0
    s_cbranch_scc1 LtwX_l0
    s_mul_i32 s17, s35, 36864
    buffer_store_dwordx4 v[52:55], v13, s[24:27], s17 offen
    s_cmp_lg_u32 s62, 0
    s_cbranch_scc1 LtwX_item
LtwX_chk:
    s_min_u32 s17, s32, s33
    s_cmp_lt_u32 s17, 64
    s_cbranch_scc1 LtwX_idle
    s_branch L_role_tw_exit
LtwX_l0:
    s_add_u32 s47, s47, 2359296
    buffer_store_dwordx4 v[52:55], v12, s[8:11], s47 offen sc1
    v_add_f32 v44, v16, v17
    v_mul_f32 v45, v16, v16
    v_fmac_f32 v45, v17, v17
    v_add_f32 v44, v44, v18
    v_fmac_f32 v45, v18, v18
    v_add_f32 v44, v44, v19
    v_fmac_f32 v45, v19, v19
    v_add_f32 v44, v44, v20
    v_fmac_f32 v45, v20, v20
    v_add_f32 v44, v44, v21
    v_fmac_f32 v45, v21, v21
    v_add_f32 v44, v44, v22
    v_fmac_f32 v45, v22, v22
    v_add_f32 v44, v44, v23
    v_fmac_f32 v45, v23, v23
    v_mov_b32 v46, v44
    v_mov_b32 v47, v45
    s_nop 0
    v_permlane32_swap_b32 v44, v46
    v_permlane32_swap_b32 v45, v47
    v_add_f32 v44, v44, v46
    v_add_f32 v45, v45, v47
    v_mov_b32 v46, v44
    v_mov_b32 v47, v45
    s_nop 0
    v_permlane16_swap_b32 v44, v46
    v_permlane16_swap_b32 v45, v47
    v_add_f32 v44, v44, v46
    v_add_f32 v45, v45, v47
    s_mul_i32 s17, s35, 6144
    s_add_u32 s17, s17, 16515072
    s_mov_b64 exec, 0xffff
    buffer_store_dwordx2 v[44:45], v14, s[8:11], s17 offen sc1
    s_mov_b64 exec, -1
    s_mul_i32 s43, s35, 22528
    s_add_u32 s43, s43, s49
    s_cmp_lg_u32 s62, 0
    s_cbranch_scc1 LtwX_item
    s_cmp_lg_u32 s14, 0
    s_cbranch_scc1 LtwX_nw3
    s_mul_i32 s60, s32, 22528
    s_add_u32 s60, s60, 184448
    s_cmp_lt_u32 s32, 64
    s_cselect_b32 s60, s60, 3080192
    s_mul_i32 s61, s33, 22528
    s_add_u32 s61, s61, 1626240
    s_cmp_lt_u32 s33, 64
    s_cselect_b32 s61, s61, 3080192
    buffer_load_dword v2, v1, s[8:11], s60 offen sc1
    buffer_load_dword v15, v1, s[8:11], s61 offen sc1
LtwX_nw3:
    s_waitcnt vmcnt(0)
    s_mov_b64 exec, 1
    buffer_store_dword v3, v4, s[8:11], s43 offen sc1
    s_mov_b64 exec, -1
    s_mov_b32 s43, 0
    s_min_u32 s17, s32, s33
    s_cmp_lt_u32 s17, 64
    s_cbranch_scc0 LtwX_chk
    s_cmp_lg_u32 s14, 0
    s_cbranch_scc1 LtwX_nw0
    v_cmp_eq_u32 vcc, 0, v2
    v_cmp_eq_u32 s[54:55], 0, v15
    s_nop 0
    s_cmp_eq_u64 s[54:55], 0
    s_cselect_b32 s62, 2, 0
    s_cmp_eq_u64 vcc, 0
    s_cselect_b32 s62, 1, s62
    s_cmp_eq_u32 s62, 0
    s_cbranch_scc1 LtwX_idle
    v_mov_b32 v5, s62
    ds_write_b32 v49, v5
    s_waitcnt lgkmcnt(0)
    s_branch LtwX_nw0
Ltw_z:
    v_lshrrev_b32 v5, 1, v8
    v_lshl_add_u32 v12, v5, 9, v12
    v_and_b32 v5, 1, v8
    v_lshl_add_u32 v12, v5, 3, v12
    v_add_u32 v12, 2048, v12
    v_lshl_add_u32 v13, v8, 3, v13
    v_add_u32 v13, 64, v13
    v_add_u32 v14, 8, v14
    s_lshl_b32 s58, s14, 16
    s_add_u32 s58, s58, 144703488
    s_mov_b32 s43, 0
    s_mov_b32 s28, s8
    s_mov_b32 s29, s9
    s_mov_b32 s30, 0
    s_mov_b32 s31, 0x00020000
    s_mul_i32 s17, s51, 3072
    v_add_u32 v50, s17, v0
    ds_write2_b32 v49, v4, v4 offset0:0 offset1:1
    s_waitcnt lgkmcnt(0)
    s_cmp_lg_u32 s14, 0
    s_cbranch_scc1 LtwZ_ini_d
    v_mov_b32 v5, 160
    s_mov_b32 s16, 0
LtwZ_ini:
    global_load_dword v6, v5, s[12:13] sc1
    s_add_u32 s16, s16, 1
    s_cmp_gt_u32 s16, 100000
    s_cbranch_scc1 L_role_tw_abort
    s_waitcnt vmcnt(0)
    v_cmp_gt_u32 vcc, 123, v6
    s_nop 0
    s_cbranch_vccz LtwZ_ini_d
    s_sleep 8
    s_branch LtwZ_ini
LtwZ_ini_d:
    s_barrier
LtwZ_idle:
    s_barrier
    ds_read_b32 v6, v49
    v_xor_b32 v49, 4, v49
    s_waitcnt lgkmcnt(0)
    v_readfirstlane_b32 s62, v6
    s_nop 0
    s_cmp_eq_u32 s62, 0
    s_cbranch_scc1 L_role_tw_abort
    s_cmp_lt_u32 s33, 33
    s_cselect_b32 s38, 1, 3
    s_cmp_eq_u32 s62, 2
    s_cselect_b32 s36, 1, 0
    s_cselect_b32 s37, s33, s32
    s_cselect_b32 s17, s38, 0
    s_add_u32 s33, s33, s17
    s_cmp_eq_u32 s62, 1
    s_cselect_b32 s17, 2, 0
    s_add_u32 s32, s32, s17
    s_lshl_b32 s56, s36, 6
    s_add_u32 s56, s56, s37
    s_lshl_b32 s46, s56, 18
    s_add_u32 s46, s46, s58
    s_mul_i32 s41, s36, 4718592
    s_mul_i32 s17, s37, 36864
    s_add_u32 s41, s41, s17
    s_add_u32 s41, s41, 8650752
    s_cmp_ge_u32 s37, 64
    s_cbranch_scc1 L_role_tw_abort
    buffer_load_dword v10, v51, s[8:11], s46 offen
    s_add_u32 s48, s46, 0
    buffer_load_dwordx4 v[64:67], v0, s[8:11], s48 offen offset:0
    buffer_load_dwordx4 v[68:71], v0, s[8:11], s48 offen offset:1024
    buffer_load_dwordx4 v[72:75], v0, s[8:11], s48 offen offset:2048
    buffer_load_dwordx4 v[76:79], v0, s[8:11], s48 offen offset:3072
    s_add_u32 s48, s46, 4096
    buffer_load_dwordx4 v[80:83], v0, s[8:11], s48 offen offset:0
    buffer_load_dwordx4 v[84:87], v0, s[8:11], s48 offen offset:1024
    buffer_load_dwordx4 v[88:91], v0, s[8:11], s48 offen offset:2048
    buffer_load_dwordx4 v[92:95], v0, s[8:11], s48 offen offset:3072
    s_add_u32 s48, s46, 8192
    buffer_load_dwordx4 v[96:99], v0, s[8:11], s48 offen offset:0
    buffer_load_dwordx4 v[100:103], v0, s[8:11], s48 offen offset:1024
    buffer_load_dwordx4 v[104:107], v0, s[8:11], s48 offen offset:2048
    buffer_load_dwordx4 v[108:111], v0, s[8:11], s48 offen offset:3072
    s_add_u32 s48, s46, 12288
    buffer_load_dwordx4 v[112:115], v0, s[8:11], s48 offen offset:0
    buffer_load_dwordx4 v[116:119], v0, s[8:11], s48 offen offset:1024
    buffer_load_dwordx4 v[120:123], v0, s[8:11], s48 offen offset:2048
    buffer_load_dwordx2 v[40:41], v12, s[8:11], s41 offen
LtwZ_item:
    s_mov_b32 s34, s36
    s_mov_b32 s35, s37
    s_mov_b32 s47, s41
    buffer_load_dwordx4 v[124:127], v0, s[8:11], s48 offen offset:3072
    s_waitcnt vmcnt(16)
    v_mfma_f32_16x16x32_bf16 v[16:19], a[0:3], v[64:67], 0
    v_mfma_f32_16x16x32_bf16 v[20:23], a[4:7], v[64:67], 0
    v_mfma_f32_16x16x32_bf16 v[24:27], v[128:131], v[64:67], 0
    s_add_u32 s48, s46, 16384
    buffer_load_dwordx4 v[64:67], v0, s[8:11], s48 offen offset:0
    s_waitcnt vmcnt(16)
    v_mfma_f32_16x16x32_bf16 v[28:31], a[0:3], v[68:71], 0
    v_mfma_f32_16x16x32_bf16 v[32:35], a[4:7], v[68:71], 0
    v_mfma_f32_16x16x32_bf16 v[36:39], v[128:131], v[68:71], 0
    buffer_load_dwordx4 v[68:71], v0, s[8:11], s48 offen offset:1024
    s_waitcnt vmcnt(16)
    v_mfma_f32_16x16x32_bf16 v[16:19], a[8:11], v[72:75], v[16:19]
    v_mfma_f32_16x16x32_bf16 v[20:23], a[12:15], v[72:75], v[20:23]
    v_mfma_f32_16x16x32_bf16 v[24:27], v[132:135], v[72:75], v[24:27]
    buffer_load_dwordx4 v[72:75], v0, s[8:11], s48 offen offset:2048
    s_waitcnt vmcnt(16)
    v_mfma_f32_16x16x32_bf16 v[28:31], a[8:11], v[76:79], v[28:31]
    v_mfma_f32_16x16x32_bf16 v[32:35], a[12:15], v[76:79], v[32:35]
    v_mfma_f32_16x16x32_bf16 v[36:39], v[132:135], v[76:79], v[36:39]
    buffer_load_dwordx4 v[76:79], v0, s[8:11], s48 offen offset:3072
    s_waitcnt vmcnt(16)
    v_mfma_f32_16x16x32_bf16 v[16:19], a[16:19], v[80:83], v[16:19]
    v_mfma_f32_16x16x32_bf16 v[20:23], a[20:23], v[80:83], v[20:23]
    v_mfma_f32_16x16x32_bf16 v[24:27], v[136:139], v[80:83], v[24:27]
    s_add_u32 s48, s46, 20480
    buffer_load_dwordx4 v[80:83], v0, s[8:11], s48 offen offset:0
    s_waitcnt vmcnt(16)
    v_mfma_f32_16x16x32_bf16 v[28:31], a[16:19], v[84:87], v[28:31]
    v_mfma_f32_16x16x32_bf16 v[32:35], a[20:23], v[84:87], v[32:35]
    v_mfma_f32_16x16x32_bf16 v[36:39], v[136:139], v[84:87], v[36:39]
    buffer_load_dwordx4 v[84:87], v0, s[8:11], s48 offen offset:1024
    s_waitcnt vmcnt(16)
    v_mfma_f32_16x16x32_bf16 v[16:19], a[24:27], v[88:91], v[16:19]
    v_mfma_f32_16x16x32_bf16 v[20:23], a[28:31], v[88:91], v[20:23]
    v_mfma_f32_16x16x32_bf16 v[24:27], v[140:143], v[88:91], v[24:27]
    buffer_load_dwordx4 v[88:91], v0, s[8:11], s48 offen offset:2048
    s_waitcnt vmcnt(16)
    v_mfma_f32_16x16x32_bf16 v[28:31], a[24:27], v[92:95], v[28:31]
    v_mfma_f32_16x16x32_bf16 v[32:35], a[28:31], v[92:95], v[32:35]
    v_mfma_f32_16x16x32_bf16 v[36:39], v[140:143], v[92:95], v[36:39]
    buffer_load_dwordx4 v[92:95], v0, s[8:11], s48 offen offset:3072
    s_waitcnt vmcnt(16)
    v_mfma_f32_16x16x32_bf16 v[16:19], a[32:35], v[96:99], v[16:19]
    v_mfma_f32_16x16x32_bf16 v[20:23], a[36:39], v[96:99], v[20:23]
    v_mfma_f32_16x16x32_bf16 v[24:27], v[144:147], v[96:99], v[24:27]
    s_add_u32 s48, s46, 24576
    buffer_load_dwordx4 v[96:99], v0, s[8:11], s48 offen offset:0
    s_waitcnt vmcnt(16)
    v_mfma_f32_16x16x32_bf16 v[28:31], a[32:35], v[100:103], v[28:31]
    v_mfma_f32_16x16x32_bf16 v[32:35], a[36:39], v[100:103], v[32:35]
    v_mfma_f32_16x16x32_bf16 v[36:39], v[144:147], v[100:103], v[36:39]
    buffer_load_dwordx4 v[100:103], v0, s[8:11], s48 offen offset:1024
    s_waitcnt vmcnt(16)
    v_mfma_f32_16x16x32_bf16 v[16:19], a[40:43], v[104:107], v[16:19]
    v_mfma_f32_16x16x32_bf16 v[20:23], a[44:47], v[104:107], v[20:23]
    v_mfma_f32_16x16x32_bf16 v[24:27], v[148:151], v[104:107], v[24:27]
    buffer_load_dwordx4 v[104:107], v0, s[8:11], s48 offen offset:2048
    s_waitcnt vmcnt(16)
    v_mfma_f32_16x16x32_bf16 v[28:31], a[40:43], v[108:111], v[28:31]
    v_mfma_f32_16x16x32_bf16 v[32:35], a[44:47], v[108:111], v[32:35]
    v_mfma_f32_16x16x32_bf16 v[36:39], v[148:151], v[108:111], v[36:39]
    buffer_load_dwordx4 v[108:111], v0, s[8:11], s48 offen offset:3072
    s_waitcnt vmcnt(16)
    v_mfma_f32_16x16x32_bf16 v[16:19], a[48:51], v[112:115], v[16:19]
    v_mfma_f32_16x16x32_bf16 v[20:23], a[52:55], v[112:115], v[20:23]
    v_mfma_f32_16x16x32_bf16 v[24:27], v[152:155], v[112:115], v[24:27]
    s_add_u32 s48, s46, 28672
    buffer_load_dwordx4 v[112:115], v0, s[8:11], s48 offen offset:0
    s_waitcnt vmcnt(16)
    v_mfma_f32_16x16x32_bf16 v[28:31], a[48:51], v[116:119], v[28:31]
    v_mfma_f32_16x16x32_bf16 v[32:35], a[52:55], v[116:119], v[32:35]
    v_mfma_f32_16x16x32_bf16 v[36:39], v[152:155], v[116:119], v[36:39]
    buffer_load_dwordx4 v[116:119], v0, s[8:11], s48 offen offset:1024
    s_waitcnt vmcnt(16)
    v_mfma_f32_16x16x32_bf16 v[16:19], a[56:59], v[120:123], v[16:19]
    v_mfma_f32_16x16x32_bf16 v[20:23], a[60:63], v[120:123], v[20:23]
    v_mfma_f32_16x16x32_bf16 v[24:27], v[156:159], v[120:123], v[24:27]
    buffer_load_dwordx4 v[120:123], v0, s[8:11], s48 offen offset:2048
    s_waitcnt vmcnt(15)
    v_mfma_f32_16x16x32_bf16 v[28:31], a[56:59], v[124:127], v[28:31]
    v_mfma_f32_16x16x32_bf16 v[32:35], a[60:63], v[124:127], v[32:35]
    v_mfma_f32_16x16x32_bf16 v[36:39], v[156:159], v[124:127], v[36:39]
    buffer_load_dwordx4 v[124:127], v0, s[8:11], s48 offen offset:3072
    s_waitcnt vmcnt(15)
    v_mfma_f32_16x16x32_bf16 v[16:19], a[64:67], v[64:67], v[16:19]
    v_mfma_f32_16x16x32_bf16 v[20:23], a[68:71], v[64:67], v[20:23]
    v_mfma_f32_16x16x32_bf16 v[24:27], v[160:163], v[64:67], v[24:27]
    s_add_u32 s48, s46, 32768
    buffer_load_dwordx4 v[64:67], v0, s[8:11], s48 offen offset:0
    s_waitcnt vmcnt(15)
    v_mfma_f32_16x16x32_bf16 v[28:31], a[64:67], v[68:71], v[28:31]
    v_mfma_f32_16x16x32_bf16 v[32:35], a[68:71], v[68:71], v[32:35]
    v_mfma_f32_16x16x32_bf16 v[36:39], v[160:163], v[68:71], v[36:39]
    s_cmp_lg_u32 s43, 0
    s_cselect_b64 exec, 1, 0
    buffer_store_dword v3, v4, s[8:11], s43 offen sc1
    s_mov_b64 exec, -1
    s_mov_b32 s43, 0
    buffer_load_dwordx4 v[68:71], v0, s[8:11], s48 offen offset:1024
    s_waitcnt vmcnt(16)
    v_mfma_f32_16x16x32_bf16 v[16:19], a[72:75], v[72:75], v[16:19]
    v_mfma_f32_16x16x32_bf16 v[20:23], a[76:79], v[72:75], v[20:23]
    v_mfma_f32_16x16x32_bf16 v[24:27], v[164:167], v[72:75], v[24:27]
    buffer_load_dwordx4 v[72:75], v0, s[8:11], s48 offen offset:2048
    s_waitcnt vmcnt(16)
    v_mfma_f32_16x16x32_bf16 v[28:31], a[72:75], v[76:79], v[28:31]
    v_mfma_f32_16x16x32_bf16 v[32:35], a[76:79], v[76:79], v[32:35]
    v_mfma_f32_16x16x32_bf16 v[36:39], v[164:167], v[76:79], v[36:39]
    buffer_load_dwordx4 v[76:79], v0, s[8:11], s48 offen offset:3072
    s_waitcnt vmcnt(16)
    v_mfma_f32_16x16x32_bf16 v[16:19], a[80:83], v[80:83], v[16:19]
    v_mfma_f32_16x16x32_bf16 v[20:23], a[84:87], v[80:83], v[20:23]
    v_mfma_f32_16x16x32_bf16 v[24:27], v[168:171], v[80:83], v[24:27]
    s_add_u32 s48, s46, 36864
    buffer_load_dwordx4 v[80:83], v0, s[8:11], s48 offen offset:0
    s_waitcnt vmcnt(16)
    v_mfma_f32_16x16x32_bf16 v[28:31], a[80:83], v[84:87], v[28:31]
    v_mfma_f32_16x16x32_bf16 v[32:35], a[84:87], v[84:87], v[32:35]
    v_mfma_f32_16x16x32_bf16 v[36:39], v[168:171], v[84:87], v[36:39]
    buffer_load_dwordx4 v[84:87], v0, s[8:11], s48 offen offset:1024
    s_waitcnt vmcnt(16)
    v_mfma_f32_16x16x32_bf16 v[16:19], a[88:91], v[88:91], v[16:19]
    v_mfma_f32_16x16x32_bf16 v[20:23], a[92:95], v[88:91], v[20:23]
    v_mfma_f32_16x16x32_bf16 v[24:27], v[172:175], v[88:91], v[24:27]
    buffer_load_dwordx4 v[88:91], v0, s[8:11], s48 offen offset:2048
    s_waitcnt vmcnt(16)
    v_mfma_f32_16x16x32_bf16 v[28:31], a[88:91], v[92:95], v[28:31]
    v_mfma_f32_16x16x32_bf16 v[32:35], a[92:95], v[92:95], v[32:35]
    v_mfma_f32_16x16x32_bf16 v[36:39], v[172:175], v[92:95], v[36:39]
    buffer_load_dwordx4 v[92:95], v0, s[8:11], s48 offen offset:3072
    s_waitcnt vmcnt(16)
    v_mfma_f32_16x16x32_bf16 v[16:19], a[96:99], v[96:99], v[16:19]
    v_mfma_f32_16x16x32_bf16 v[20:23], a[100:103], v[96:99], v[20:23]
    v_mfma_f32_16x16x32_bf16 v[24:27], v[176:179], v[96:99], v[24:27]
    s_add_u32 s48, s46, 40960
    buffer_load_dwordx4 v[96:99], v0, s[8:11], s48 offen offset:0
    s_waitcnt vmcnt(16)
    v_mfma_f32_16x16x32_bf16 v[28:31], a[96:99], v[100:103], v[28:31]
    v_mfma_f32_16x16x32_bf16 v[32:35], a[100:103], v[100:103], v[32:35]
    v_mfma_f32_16x16x32_bf16 v[36:39], v[176:179], v[100:103], v[36:39]
    buffer_load_dwordx4 v[100:103], v0, s[8:11], s48 offen offset:1024
    s_waitcnt vmcnt(16)
    v_mfma_f32_16x16x32_bf16 v[16:19], a[104:107], v[104:107], v[16:19]
    v_mfma_f32_16x16x32_bf16 v[20:23], a[108:111], v[104:107], v[20:23]
    v_mfma_f32_16x16x32_bf16 v[24:27], v[180:183], v[104:107], v[24:27]
    buffer_load_dwordx4 v[104:107], v0, s[8:11], s48 offen offset:2048
    s_waitcnt vmcnt(16)
    v_mfma_f32_16x16x32_bf16 v[28:31], a[104:107], v[108:111], v[28:31]
    v_mfma_f32_16x16x32_bf16 v[32:35], a[108:111], v[108:111], v[32:35]
    v_mfma_f32_16x16x32_bf16 v[36:39], v[180:183], v[108:111], v[36:39]
    buffer_load_dwordx4 v[108:111], v0, s[8:11], s48 offen offset:3072
    s_waitcnt vmcnt(16)
    v_mfma_f32_16x16x32_bf16 v[16:19], a[112:115], v[112:115], v[16:19]
    v_mfma_f32_16x16x32_bf16 v[20:23], a[116:119], v[112:115], v[20:23]
    v_mfma_f32_16x16x32_bf16 v[24:27], v[184:187], v[112:115], v[24:27]
    s_add_u32 s48, s46, 45056
    buffer_load_dwordx4 v[112:115], v0, s[8:11], s48 offen offset:0
    s_waitcnt vmcnt(16)
    v_mfma_f32_16x16x32_bf16 v[28:31], a[112:115], v[116:119], v[28:31]
    v_mfma_f32_16x16x32_bf16 v[32:35], a[116:119], v[116:119], v[32:35]
    v_mfma_f32_16x16x32_bf16 v[36:39], v[184:187], v[116:119], v[36:39]
    buffer_load_dwordx4 v[116:119], v0, s[8:11], s48 offen offset:1024
    s_waitcnt vmcnt(16)
    v_mfma_f32_16x16x32_bf16 v[16:19], a[120:123], v[120:123], v[16:19]
    v_mfma_f32_16x16x32_bf16 v[20:23], a[124:127], v[120:123], v[20:23]
    v_mfma_f32_16x16x32_bf16 v[24:27], v[188:191], v[120:123], v[24:27]
    buffer_load_dwordx4 v[120:123], v0, s[8:11], s48 offen offset:2048
    s_waitcnt vmcnt(16)
    v_mfma_f32_16x16x32_bf16 v[28:31], a[120:123], v[124:127], v[28:31]
    v_mfma_f32_16x16x32_bf16 v[32:35], a[124:127], v[124:127], v[32:35]
    v_mfma_f32_16x16x32_bf16 v[36:39], v[188:191], v[124:127], v[36:39]
    buffer_load_dwordx4 v[124:127], v0, s[8:11], s48 offen offset:3072
    s_waitcnt vmcnt(16)
    v_mfma_f32_16x16x32_bf16 v[16:19], a[128:131], v[64:67], v[16:19]
    v_mfma_f32_16x16x32_bf16 v[20:23], a[132:135], v[64:67], v[20:23]
    v_mfma_f32_16x16x32_bf16 v[24:27], v[192:195], v[64:67], v[24:27]
    s_add_u32 s48, s46, 49152
    buffer_load_dwordx4 v[64:67], v0, s[8:11], s48 offen offset:0
    s_waitcnt vmcnt(15)
    v_mfma_f32_16x16x32_bf16 v[28:31], a[128:131], v[68:71], v[28:31]
    v_mfma_f32_16x16x32_bf16 v[32:35], a[132:135], v[68:71], v[32:35]
    v_mfma_f32_16x16x32_bf16 v[36:39], v[192:195], v[68:71], v[36:39]
    buffer_load_dwordx4 v[68:71], v0, s[8:11], s48 offen offset:1024
    s_waitcnt vmcnt(15)
    v_mfma_f32_16x16x32_bf16 v[16:19], a[136:139], v[72:75], v[16:19]
    v_mfma_f32_16x16x32_bf16 v[20:23], a[140:143], v[72:75], v[20:23]
    v_mfma_f32_16x16x32_bf16 v[24:27], v[196:199], v[72:75], v[24:27]
    buffer_load_dwordx4 v[72:75], v0, s[8:11], s48 offen offset:2048
    s_waitcnt vmcnt(15)
    v_mfma_f32_16x16x32_bf16 v[28:31], a[136:139], v[76:79], v[28:31]
    v_mfma_f32_16x16x32_bf16 v[32:35], a[140:143], v[76:79], v[32:35]
    v_mfma_f32_16x16x32_bf16 v[36:39], v[196:199], v[76:79], v[36:39]
    buffer_load_dwordx4 v[76:79], v0, s[8:11], s48 offen offset:3072
    s_waitcnt vmcnt(15)
    v_mfma_f32_16x16x32_bf16 v[16:19], a[144:147], v[80:83], v[16:19]
    v_mfma_f32_16x16x32_bf16 v[20:23], a[148:151], v[80:83], v[20:23]
    v_mfma_f32_16x16x32_bf16 v[24:27], v[200:203], v[80:83], v[24:27]
    s_add_u32 s48, s46, 53248
    buffer_load_dwordx4 v[80:83], v0, s[8:11], s48 offen offset:0
    s_waitcnt vmcnt(15)
    v_mfma_f32_16x16x32_bf16 v[28:31], a[144:147], v[84:87], v[28:31]
    v_mfma_f32_16x16x32_bf16 v[32:35], a[148:151], v[84:87], v[32:35]
    v_mfma_f32_16x16x32_bf16 v[36:39], v[200:203], v[84:87], v[36:39]
    buffer_load_dwordx4 v[84:87], v0, s[8:11], s48 offen offset:1024
    s_waitcnt vmcnt(15)
    v_mfma_f32_16x16x32_bf16 v[16:19], a[152:155], v[88:91], v[16:19]
    v_mfma_f32_16x16x32_bf16 v[20:23], a[156:159], v[88:91], v[20:23]
    v_mfma_f32_16x16x32_bf16 v[24:27], v[204:207], v[88:91], v[24:27]
    buffer_load_dwordx4 v[88:91], v0, s[8:11], s48 offen offset:2048
    s_waitcnt vmcnt(15)
    v_mfma_f32_16x16x32_bf16 v[28:31], a[152:155], v[92:95], v[28:31]
    v_mfma_f32_16x16x32_bf16 v[32:35], a[156:159], v[92:95], v[32:35]
    v_mfma_f32_16x16x32_bf16 v[36:39], v[204:207], v[92:95], v[36:39]
    buffer_load_dwordx4 v[92:95], v0, s[8:11], s48 offen offset:3072
    s_waitcnt vmcnt(15)
    v_mfma_f32_16x16x32_bf16 v[16:19], a[160:163], v[96:99], v[16:19]
    v_mfma_f32_16x16x32_bf16 v[20:23], a[164:167], v[96:99], v[20:23]
    v_mfma_f32_16x16x32_bf16 v[24:27], v[208:211], v[96:99], v[24:27]
    s_add_u32 s48, s46, 57344
    buffer_load_dwordx4 v[96:99], v0, s[8:11], s48 offen offset:0
    s_waitcnt vmcnt(15)
    v_mfma_f32_16x16x32_bf16 v[28:31], a[160:163], v[100:103], v[28:31]
    v_mfma_f32_16x16x32_bf16 v[32:35], a[164:167], v[100:103], v[32:35]
    v_mfma_f32_16x16x32_bf16 v[36:39], v[208:211], v[100:103], v[36:39]
    buffer_load_dwordx4 v[100:103], v0, s[8:11], s48 offen offset:1024
    s_waitcnt vmcnt(15)
    v_mfma_f32_16x16x32_bf16 v[16:19], a[168:171], v[104:107], v[16:19]
    v_mfma_f32_16x16x32_bf16 v[20:23], a[172:175], v[104:107], v[20:23]
    v_mfma_f32_16x16x32_bf16 v[24:27], v[212:215], v[104:107], v[24:27]
    buffer_load_dwordx4 v[104:107], v0, s[8:11], s48 offen offset:2048
    s_waitcnt vmcnt(15)
    v_mfma_f32_16x16x32_bf16 v[28:31], a[168:171], v[108:111], v[28:31]
    v_mfma_f32_16x16x32_bf16 v[32:35], a[172:175], v[108:111], v[32:35]
    v_mfma_f32_16x16x32_bf16 v[36:39], v[212:215], v[108:111], v[36:39]
    buffer_load_dwordx4 v[108:111], v0, s[8:11], s48 offen offset:3072
    s_waitcnt vmcnt(15)
    v_mfma_f32_16x16x32_bf16 v[16:19], a[176:179], v[112:115], v[16:19]
    v_mfma_f32_16x16x32_bf16 v[20:23], a[180:183], v[112:115], v[20:23]
    v_mfma_f32_16x16x32_bf16 v[24:27], v[216:219], v[112:115], v[24:27]
    s_barrier
    ds_read_b32 v6, v49
    v_xor_b32 v49, 4, v49
    s_add_u32 s48, s46, 61440
    buffer_load_dwordx4 v[112:115], v0, s[8:11], s48 offen offset:0
    s_waitcnt vmcnt(15)
    v_mfma_f32_16x16x32_bf16 v[28:31], a[176:179], v[116:119], v[28:31]
    v_mfma_f32_16x16x32_bf16 v[32:35], a[180:183], v[116:119], v[32:35]
    v_mfma_f32_16x16x32_bf16 v[36:39], v[216:219], v[116:119], v[36:39]
    buffer_load_dwordx4 v[116:119], v0, s[8:11], s48 offen offset:1024
    s_waitcnt vmcnt(15)
    v_mfma_f32_16x16x32_bf16 v[16:19], a[184:187], v[120:123], v[16:19]
    v_mfma_f32_16x16x32_bf16 v[20:23], a[188:191], v[120:123], v[20:23]
    v_mfma_f32_16x16x32_bf16 v[24:27], v[220:223], v[120:123], v[24:27]
    buffer_load_dwordx4 v[120:123], v0, s[8:11], s48 offen offset:2048
    s_waitcnt vmcnt(15)
    v_mfma_f32_16x16x32_bf16 v[28:31], a[184:187], v[124:127], v[28:31]
    v_mfma_f32_16x16x32_bf16 v[32:35], a[188:191], v[124:127], v[32:35]
    v_mfma_f32_16x16x32_bf16 v[36:39], v[220:223], v[124:127], v[36:39]
    s_waitcnt lgkmcnt(0)
    v_readfirstlane_b32 s62, v6
    s_cmp_lt_u32 s33, 33
    s_cselect_b32 s38, 1, 3
    s_cmp_eq_u32 s62, 2
    s_cselect_b32 s36, 1, 0
    s_cselect_b32 s37, s33, s32
    s_cselect_b32 s17, s38, 0
    s_add_u32 s33, s33, s17
    s_cmp_eq_u32 s62, 1
    s_cselect_b32 s17, 2, 0
    s_add_u32 s32, s32, s17
    s_lshl_b32 s56, s36, 6
    s_add_u32 s56, s56, s37
    buffer_load_dwordx4 v[124:127], v0, s[8:11], s48 offen offset:3072
    s_waitcnt vmcnt(15)
    v_mfma_f32_16x16x32_bf16 v[16:19], a[192:195], v[64:67], v[16:19]
    v_mfma_f32_16x16x32_bf16 v[20:23], a[196:199], v[64:67], v[20:23]
    v_mfma_f32_16x16x32_bf16 v[24:27], v[224:227], v[64:67], v[24:27]
    s_cmp_lt_u32 s37, 64
    s_cselect_b32 s62, s62, 0
    s_lshl_b32 s46, s56, 18
    s_add_u32 s46, s46, s58
    s_mul_i32 s41, s36, 4718592
    s_mul_i32 s17, s37, 36864
    s_add_u32 s41, s41, s17
    s_add_u32 s41, s41, 8650752
    s_cmp_lg_u32 s62, 0
    s_cselect_b32 s30, 268435456, 0
    buffer_load_dword v10, v51, s[28:31], s46 offen
    s_add_u32 s48, s46, 0
    buffer_load_dwordx4 v[64:67], v0, s[28:31], s48 offen offset:0
    s_waitcnt vmcnt(15)
    v_mfma_f32_16x16x32_bf16 v[28:31], a[192:195], v[68:71], v[28:31]
    v_mfma_f32_16x16x32_bf16 v[32:35], a[196:199], v[68:71], v[32:35]
    v_mfma_f32_16x16x32_bf16 v[36:39], v[224:227], v[68:71], v[36:39]
    buffer_load_dwordx4 v[68:71], v0, s[28:31], s48 offen offset:1024
    s_waitcnt vmcnt(15)
    v_mfma_f32_16x16x32_bf16 v[16:19], a[200:203], v[72:75], v[16:19]
    v_mfma_f32_16x16x32_bf16 v[20:23], a[204:207], v[72:75], v[20:23]
    v_mfma_f32_16x16x32_bf16 v[24:27], v[228:231], v[72:75], v[24:27]
    buffer_load_dwordx4 v[72:75], v0, s[28:31], s48 offen offset:2048
    s_waitcnt vmcnt(15)
    v_mfma_f32_16x16x32_bf16 v[28:31], a[200:203], v[76:79], v[28:31]
    v_mfma_f32_16x16x32_bf16 v[32:35], a[204:207], v[76:79], v[32:35]
    v_mfma_f32_16x16x32_bf16 v[36:39], v[228:231], v[76:79], v[36:39]
    buffer_load_dwordx4 v[76:79], v0, s[28:31], s48 offen offset:3072
    s_waitcnt vmcnt(15)
    v_mfma_f32_16x16x32_bf16 v[16:19], a[208:211], v[80:83], v[16:19]
    v_mfma_f32_16x16x32_bf16 v[20:23], a[212:215], v[80:83], v[20:23]
    v_mfma_f32_16x16x32_bf16 v[24:27], v[232:235], v[80:83], v[24:27]
    s_add_u32 s48, s46, 4096
    buffer_load_dwordx4 v[80:83], v0, s[28:31], s48 offen offset:0
    s_waitcnt vmcnt(15)
    v_mfma_f32_16x16x32_bf16 v[28:31], a[208:211], v[84:87], v[28:31]
    v_mfma_f32_16x16x32_bf16 v[32:35], a[212:215], v[84:87], v[32:35]
    v_mfma_f32_16x16x32_bf16 v[36:39], v[232:235], v[84:87], v[36:39]
    buffer_load_dwordx4 v[84:87], v0, s[28:31], s48 offen offset:1024
    s_waitcnt vmcnt(15)
    v_mfma_f32_16x16x32_bf16 v[16:19], a[216:219], v[88:91], v[16:19]
    v_mfma_f32_16x16x32_bf16 v[20:23], a[220:223], v[88:91], v[20:23]
    v_mfma_f32_16x16x32_bf16 v[24:27], v[236:239], v[88:91], v[24:27]
    buffer_load_dwordx4 v[88:91], v0, s[28:31], s48 offen offset:2048
    s_waitcnt vmcnt(15)
    v_mfma_f32_16x16x32_bf16 v[28:31], a[216:219], v[92:95], v[28:31]
    v_mfma_f32_16x16x32_bf16 v[32:35], a[220:223], v[92:95], v[32:35]
    v_mfma_f32_16x16x32_bf16 v[36:39], v[236:239], v[92:95], v[36:39]
    buffer_load_dwordx4 v[92:95], v0, s[28:31], s48 offen offset:3072
    s_waitcnt vmcnt(15)
    v_mfma_f32_16x16x32_bf16 v[16:19], a[224:227], v[96:99], v[16:19]
    v_mfma_f32_16x16x32_bf16 v[20:23], a[228:231], v[96:99], v[20:23]
    v_mfma_f32_16x16x32_bf16 v[24:27], v[240:243], v[96:99], v[24:27]
    s_add_u32 s48, s46, 8192
    buffer_load_dwordx4 v[96:99], v0, s[28:31], s48 offen offset:0
    s_waitcnt vmcnt(15)
    v_mfma_f32_16x16x32_bf16 v[28:31], a[224:227], v[100:103], v[28:31]
    v_mfma_f32_16x16x32_bf16 v[32:35], a[228:231], v[100:103], v[32:35]
    v_mfma_f32_16x16x32_bf16 v[36:39], v[240:243], v[100:103], v[36:39]
    buffer_load_dwordx4 v[100:103], v0, s[28:31], s48 offen offset:1024
    s_waitcnt vmcnt(15)
    v_mfma_f32_16x16x32_bf16 v[16:19], a[232:235], v[104:107], v[16:19]
    v_mfma_f32_16x16x32_bf16 v[20:23], a[236:239], v[104:107], v[20:23]
    v_mfma_f32_16x16x32_bf16 v[24:27], v[244:247], v[104:107], v[24:27]
    buffer_load_dwordx4 v[104:107], v0, s[28:31], s48 offen offset:2048
    s_waitcnt vmcnt(15)
    v_mfma_f32_16x16x32_bf16 v[28:31], a[232:235], v[108:111], v[28:31]
    v_mfma_f32_16x16x32_bf16 v[32:35], a[236:239], v[108:111], v[32:35]
    v_mfma_f32_16x16x32_bf16 v[36:39], v[244:247], v[108:111], v[36:39]
    buffer_load_dwordx4 v[108:111], v0, s[28:31], s48 offen offset:3072
    s_waitcnt vmcnt(15)
    v_mfma_f32_16x16x32_bf16 v[16:19], a[240:243], v[112:115], v[16:19]
    v_mfma_f32_16x16x32_bf16 v[20:23], a[244:247], v[112:115], v[20:23]
    v_mfma_f32_16x16x32_bf16 v[24:27], v[248:251], v[112:115], v[24:27]
    s_add_u32 s48, s46, 12288
    buffer_load_dwordx4 v[112:115], v0, s[28:31], s48 offen offset:0
    s_waitcnt vmcnt(15)
    v_mfma_f32_16x16x32_bf16 v[28:31], a[240:243], v[116:119], v[28:31]
    v_mfma_f32_16x16x32_bf16 v[32:35], a[244:247], v[116:119], v[32:35]
    v_mfma_f32_16x16x32_bf16 v[36:39], v[248:251], v[116:119], v[36:39]
    buffer_load_dwordx4 v[116:119], v0, s[28:31], s48 offen offset:1024
    s_waitcnt vmcnt(15)
    v_mfma_f32_16x16x32_bf16 v[16:19], a[248:251], v[120:123], v[16:19]
    v_mfma_f32_16x16x32_bf16 v[20:23], a[252:255], v[120:123], v[20:23]
    v_mfma_f32_16x16x32_bf16 v[24:27], v[252:255], v[120:123], v[24:27]
    buffer_load_dwordx4 v[120:123], v0, s[28:31], s48 offen offset:2048
    s_waitcnt vmcnt(15)
    v_mfma_f32_16x16x32_bf16 v[28:31], a[248:251], v[124:127], v[28:31]
    v_mfma_f32_16x16x32_bf16 v[32:35], a[252:255], v[124:127], v[32:35]
    v_mfma_f32_16x16x32_bf16 v[36:39], v[252:255], v[124:127], v[36:39]
    s_nop 5
    ds_write_b128 v48, v[16:19] offset:0
    ds_write_b128 v48, v[20:23] offset:1024
    ds_write_b128 v48, v[24:27] offset:2048
    ds_write_b128 v48, v[28:31] offset:3072
    ds_write_b128 v48, v[32:35] offset:4096
    ds_write_b128 v48, v[36:39] offset:5120
    s_waitcnt lgkmcnt(0)
    s_barrier
    ds_read_b128 v[24:27], v50 offset:2048
    ds_read_b128 v[28:31], v50 offset:8192
    ds_read_b128 v[32:35], v50 offset:14336
    ds_read_b128 v[36:39], v50 offset:20480
    v_xor_b32 v48, 0x8000, v48
    v_xor_b32 v50, 0x8000, v50
    v_lshlrev_b32 v16, 16, v40
    v_and_b32 v17, 0xffff0000, v40
    v_lshlrev_b32 v18, 16, v41
    v_and_b32 v19, 0xffff0000, v41
    buffer_load_dwordx2 v[40:41], v12, s[28:31], s41 offen
    s_waitcnt lgkmcnt(3)
    v_add_f32 v16, v16, v24
    v_add_f32 v17, v17, v25
    v_add_f32 v18, v18, v26
    v_add_f32 v19, v19, v27
    s_waitcnt lgkmcnt(2)
    v_add_f32 v16, v16, v28
    v_add_f32 v17, v17, v29
    v_add_f32 v18, v18, v30
    v_add_f32 v19, v19, v31
    s_waitcnt lgkmcnt(1)
    v_add_f32 v16, v16, v32
    v_add_f32 v17, v17, v33
    v_add_f32 v18, v18, v34
    v_add_f32 v19, v19, v35
    s_waitcnt lgkmcnt(0)
    v_add_f32 v16, v16, v36
    v_add_f32 v17, v17, v37
    v_add_f32 v18, v18, v38
    v_add_f32 v19, v19, v39
    v_cvt_pk_bf16_f32 v52, v16, v17
    v_cvt_pk_bf16_f32 v53, v18, v19
    s_cmp_eq_u32 s34, 0
    s_cbranch_scc1 LtwZ_l0
    s_mul_i32 s17, s35, 36864
    buffer_store_dwordx2 v[52:53], v13, s[24:27], s17 offen
    s_cmp_lg_u32 s62, 0
    s_cbranch_scc1 LtwZ_item
LtwZ_chk:
    s_min_u32 s17, s32, s33
    s_cmp_lt_u32 s17, 64
    s_cbranch_scc1 LtwZ_idle
    s_branch L_role_tw_exit
LtwZ_l0:
    s_add_u32 s47, s47, 2359296
    buffer_store_dwordx2 v[52:53], v12, s[8:11], s47 offen sc1
    v_add_f32 v44, v16, v17
    v_mul_f32 v45, v16, v16
    v_fmac_f32 v45, v17, v17
    v_add_f32 v44, v44, v18
    v_fmac_f32 v45, v18, v18
    v_add_f32 v44, v44, v19
    v_fmac_f32 v45, v19, v19
    v_mov_b32 v46, v44
    v_mov_b32 v47, v45
    s_nop 0
    v_permlane32_swap_b32 v44, v46
    v_permlane32_swap_b32 v45, v47
    v_add_f32 v44, v44, v46
    v_add_f32 v45, v45, v47
    v_mov_b32 v46, v44
    v_mov_b32 v47, v45
    s_nop 0
    v_permlane16_swap_b32 v44, v46
    v_permlane16_swap_b32 v45, v47
    v_add_f32 v44, v44, v46
    v_add_f32 v45, v45, v47
    s_mul_i32 s17, s35, 6144
    s_add_u32 s17, s17, 16515072
    s_mov_b64 exec, 0xffff
    buffer_store_dwordx2 v[44:45], v14, s[8:11], s17 offen sc1
    s_mov_b64 exec, -1
    s_mul_i32 s43, s35, 22528
    s_add_u32 s43, s43, s49
    s_cmp_lg_u32 s62, 0
    s_cbranch_scc1 LtwZ_item
    s_waitcnt vmcnt(0)
    s_mov_b64 exec, 1
    buffer_store_dword v3, v4, s[8:11], s43 offen sc1
    s_mov_b64 exec, -1
    s_mov_b32 s43, 0
    s_min_u32 s17, s32, s33
    s_cmp_lt_u32 s17, 64
    s_cbranch_scc0 LtwZ_chk
    s_branch LtwZ_idle
L_role_tw_abort:
    s_waitcnt lgkmcnt(0)
    s_mov_b64 exec, -1
    v_mov_b32 v0, 60
    s_lshl_b32 s5, s3, 8
    s_or_b32 s5, s5, s4
    s_or_b32 s5, s5, 0x10000
    v_mov_b32 v1, s5
    global_store_dword v0, v1, s[12:13]
    s_endpgm
L_role_tw_exit:
    s_endpgm
.p2align 6
L_role_awo:
    v_and_b32 v5, 63, v0
    v_lshlrev_b32 v0, 4, v5
    v_and_b32 v7, 15, v5
    v_lshrrev_b32 v8, 4, v5
    v_min_u32 v1, 63, v5
    v_lshrrev_b32 v6, 2, v1
    v_and_b32 v1, 3, v1
    v_lshlrev_b32 v1, 2, v1
    v_lshl_add_u32 v1, v6, 7, v1
    v_mov_b32 v3, 1
    v_mov_b32 v4, 0
    s_mov_b32 s44, 0x05040100
    s_mov_b32 s45, 0x07060302
    s_cmp_lt_u32 s15, 5
    s_cbranch_scc1 Lawo_noord
    s_cmp_lg_u32 s14, 0
    s_cbranch_scc1 Lawo_ord_d
    v_mov_b32 v5, 48
    s_mov_b32 s16, 0
Lawo_ord:
    global_load_dword v6, v5, s[12:13] sc1
    s_add_u32 s16, s16, 1
    s_cmp_gt_u32 s16, 100000
    s_cbranch_scc1 L_role_awo_abort
    s_waitcnt vmcnt(0)
    v_cmp_gt_u32 vcc, 1, v6
    s_nop 0
    s_cbranch_vccz Lawo_ord_d
    s_sleep 64
    s_branch Lawo_ord
Lawo_ord_d:
    s_barrier
Lawo_noord:
    s_load_dwordx2 s[20:21], s[0:1], 16
    s_mov_b32 s22, 663552
    s_mov_b32 s23, 0x00020000
    s_waitcnt lgkmcnt(0)
    s_and_b32 s21, s21, 0xffff
    s_cmp_ge_u32 s15, 5
    s_cselect_b32 s63, 1, 0
    s_cselect_b32 s17, 5, 0
    s_sub_u32 s15, s15, s17
    s_lshl_b32 s50, s15, 2
    s_add_u32 s50, s50, s14
    s_min_u32 s50, s50, 17
    s_lshl_b32 s49, s50, 6
    v_bfe_u32 v10, v0, 4, 5
    v_and_b32 v14, 19, v10
    v_bfe_u32 v5, v10, 2, 1
    v_lshl_add_u32 v14, v5, 3, v14
    v_bfe_u32 v5, v10, 3, 1
    v_lshl_add_u32 v14, v5, 2, v14
    v_and_b32 v5, 1, v14
    v_mov_b32 v11, s44
    v_mov_b32 v6, s45
    v_cmp_eq_u32 vcc, 1, v5
    s_nop 1
    v_cndmask_b32 v11, v11, v6, vcc
    v_and_b32 v14, 30, v14
    v_lshlrev_b32 v14, 1, v14
    v_lshrrev_b32 v9, 9, v0
    v_mul_u32_u24 v5, 9216, v9
    v_add_u32 v12, v5, v14
    v_add_u32 v13, 1152, v12
    s_add_u32 s17, s49, 0
    buffer_load_dword v16, v12, s[20:23], s17 offen
    buffer_load_dword v17, v13, s[20:23], s17 offen
    s_add_u32 s17, s49, 2304
    buffer_load_dword v18, v12, s[20:23], s17 offen
    buffer_load_dword v19, v13, s[20:23], s17 offen
    s_add_u32 s17, s49, 4608
    buffer_load_dword v20, v12, s[20:23], s17 offen
    buffer_load_dword v21, v13, s[20:23], s17 offen
    s_add_u32 s17, s49, 6912
    buffer_load_dword v22, v12, s[20:23], s17 offen
    buffer_load_dword v23, v13, s[20:23], s17 offen
    s_add_u32 s17, s49, 23040
    buffer_load_dword v24, v12, s[20:23], s17 offen
    buffer_load_dword v25, v13, s[20:23], s17 offen
    s_add_u32 s17, s49, 25344
    buffer_load_dword v26, v12, s[20:23], s17 offen
    buffer_load_dword v27, v13, s[20:23], s17 offen
    s_add_u32 s17, s49, 27648
    buffer_load_dword v28, v12, s[20:23], s17 offen
    buffer_load_dword v29, v13, s[20:23], s17 offen
    s_add_u32 s17, s49, 29952
    buffer_load_dword v30, v12, s[20:23], s17 offen
    buffer_load_dword v31, v13, s[20:23], s17 offen
    s_add_u32 s17, s49, 41472
    buffer_load_dword v32, v12, s[20:23], s17 offen
    buffer_load_dword v33, v13, s[20:23], s17 offen
    s_add_u32 s17, s49, 43776
    buffer_load_dword v34, v12, s[20:23], s17 offen
    buffer_load_dword v35, v13, s[20:23], s17 offen
    s_add_u32 s17, s49, 46080
    buffer_load_dword v36, v12, s[20:23], s17 offen
    buffer_load_dword v37, v13, s[20:23], s17 offen
    s_add_u32 s17, s49, 48384
    buffer_load_dword v38, v12, s[20:23], s17 offen
    buffer_load_dword v39, v13, s[20:23], s17 offen
    s_add_u32 s17, s49, 64512
    buffer_load_dword v40, v12, s[20:23], s17 offen
    buffer_load_dword v41, v13, s[20:23], s17 offen
    s_add_u32 s17, s49, 66816
    buffer_load_dword v42, v12, s[20:23], s17 offen
    buffer_load_dword v43, v13, s[20:23], s17 offen
    s_add_u32 s17, s49, 69120
    buffer_load_dword v44, v12, s[20:23], s17 offen
    buffer_load_dword v45, v13, s[20:23], s17 offen
    s_add_u32 s17, s49, 71424
    buffer_load_dword v46, v12, s[20:23], s17 offen
    buffer_load_dword v47, v13, s[20:23], s17 offen
    s_add_u32 s17, s49, 82944
    buffer_load_dword v48, v12, s[20:23], s17 offen
    buffer_load_dword v49, v13, s[20:23], s17 offen
    s_add_u32 s17, s49, 85248
    buffer_load_dword v50, v12, s[20:23], s17 offen
    buffer_load_dword v51, v13, s[20:23], s17 offen
    s_add_u32 s17, s49, 87552
    buffer_load_dword v52, v12, s[20:23], s17 offen
    buffer_load_dword v53, v13, s[20:23], s17 offen
    s_add_u32 s17, s49, 89856
    buffer_load_dword v54, v12, s[20:23], s17 offen
    buffer_load_dword v55, v13, s[20:23], s17 offen
    s_add_u32 s17, s49, 105984
    buffer_load_dword v56, v12, s[20:23], s17 offen
    buffer_load_dword v57, v13, s[20:23], s17 offen
    s_add_u32 s17, s49, 108288
    buffer_load_dword v58, v12, s[20:23], s17 offen
    buffer_load_dword v59, v13, s[20:23], s17 offen
    s_add_u32 s17, s49, 110592
    buffer_load_dword v60, v12, s[20:23], s17 offen
    buffer_load_dword v61, v13, s[20:23], s17 offen
    s_add_u32 s17, s49, 112896
    buffer_load_dword v62, v12, s[20:23], s17 offen
    buffer_load_dword v63, v13, s[20:23], s17 offen
    s_add_u32 s17, s49, 124416
    buffer_load_dword v64, v12, s[20:23], s17 offen
    buffer_load_dword v65, v13, s[20:23], s17 offen
    s_add_u32 s17, s49, 126720
    buffer_load_dword v66, v12, s[20:23], s17 offen
    buffer_load_dword v67, v13, s[20:23], s17 offen
    s_add_u32 s17, s49, 129024
    buffer_load_dword v68, v12, s[20:23], s17 offen
    buffer_load_dword v69, v13, s[20:23], s17 offen
    s_add_u32 s17, s49, 131328
    buffer_load_dword v70, v12, s[20:23], s17 offen
    buffer_load_dword v71, v13, s[20:23], s17 offen
    s_add_u32 s17, s49, 147456
    buffer_load_dword v72, v12, s[20:23], s17 offen
    buffer_load_dword v73, v13, s[20:23], s17 offen
    s_waitcnt vmcnt(56)
    v_perm_b32 v112, v17, v16, v11
    s_add_u32 s17, s49, 149760
    buffer_load_dword v74, v12, s[20:23], s17 offen
    buffer_load_dword v75, v13, s[20:23], s17 offen
    s_waitcnt vmcnt(56)
    v_perm_b32 v113, v19, v18, v11
    s_add_u32 s17, s49, 152064
    buffer_load_dword v76, v12, s[20:23], s17 offen
    buffer_load_dword v77, v13, s[20:23], s17 offen
    s_waitcnt vmcnt(56)
    v_perm_b32 v114, v21, v20, v11
    s_add_u32 s17, s49, 154368
    buffer_load_dword v78, v12, s[20:23], s17 offen
    buffer_load_dword v79, v13, s[20:23], s17 offen
    s_waitcnt vmcnt(56)
    v_perm_b32 v115, v23, v22, v11
    s_add_u32 s17, s49, 165888
    buffer_load_dword v80, v12, s[20:23], s17 offen
    buffer_load_dword v81, v13, s[20:23], s17 offen
    s_waitcnt vmcnt(56)
    v_perm_b32 v116, v25, v24, v11
    s_add_u32 s17, s49, 168192
    buffer_load_dword v82, v12, s[20:23], s17 offen
    buffer_load_dword v83, v13, s[20:23], s17 offen
    s_waitcnt vmcnt(56)
    v_perm_b32 v117, v27, v26, v11
    s_add_u32 s17, s49, 170496
    buffer_load_dword v84, v12, s[20:23], s17 offen
    buffer_load_dword v85, v13, s[20:23], s17 offen
    s_waitcnt vmcnt(56)
    v_perm_b32 v118, v29, v28, v11
    s_add_u32 s17, s49, 172800
    buffer_load_dword v86, v12, s[20:23], s17 offen
    buffer_load_dword v87, v13, s[20:23], s17 offen
    s_waitcnt vmcnt(56)
    v_perm_b32 v119, v31, v30, v11
    s_add_u32 s17, s49, 188928
    buffer_load_dword v88, v12, s[20:23], s17 offen
    buffer_load_dword v89, v13, s[20:23], s17 offen
    s_waitcnt vmcnt(56)
    v_perm_b32 v120, v33, v32, v11
    s_add_u32 s17, s49, 191232
    buffer_load_dword v90, v12, s[20:23], s17 offen
    buffer_load_dword v91, v13, s[20:23], s17 offen
    s_waitcnt vmcnt(56)
    v_perm_b32 v121, v35, v34, v11
    s_add_u32 s17, s49, 193536
    buffer_load_dword v92, v12, s[20:23], s17 offen
    buffer_load_dword v93, v13, s[20:23], s17 offen
    s_waitcnt vmcnt(56)
    v_perm_b32 v122, v37, v36, v11
    s_add_u32 s17, s49, 195840
    buffer_load_dword v94, v12, s[20:23], s17 offen
    buffer_load_dword v95, v13, s[20:23], s17 offen
    s_waitcnt vmcnt(56)
    v_perm_b32 v123, v39, v38, v11
    s_add_u32 s17, s49, 207360
    buffer_load_dword v96, v12, s[20:23], s17 offen
    buffer_load_dword v97, v13, s[20:23], s17 offen
    s_waitcnt vmcnt(56)
    v_perm_b32 v124, v41, v40, v11
    s_add_u32 s17, s49, 209664
    buffer_load_dword v98, v12, s[20:23], s17 offen
    buffer_load_dword v99, v13, s[20:23], s17 offen
    s_waitcnt vmcnt(56)
    v_perm_b32 v125, v43, v42, v11
    s_add_u32 s17, s49, 211968
    buffer_load_dword v100, v12, s[20:23], s17 offen
    buffer_load_dword v101, v13, s[20:23], s17 offen
    s_waitcnt vmcnt(56)
    v_perm_b32 v126, v45, v44, v11
    s_add_u32 s17, s49, 214272
    buffer_load_dword v102, v12, s[20:23], s17 offen
    buffer_load_dword v103, v13, s[20:23], s17 offen
    s_waitcnt vmcnt(56)
    v_perm_b32 v127, v47, v46, v11
    s_add_u32 s17, s49, 230400
    buffer_load_dword v104, v12, s[20:23], s17 offen
    buffer_load_dword v105, v13, s[20:23], s17 offen
    s_waitcnt vmcnt(56)
    v_perm_b32 v128, v49, v48, v11
    s_add_u32 s17, s49, 232704
    buffer_load_dword v106, v12, s[20:23], s17 offen
    buffer_load_dword v107, v13, s[20:23], s17 offen
    s_waitcnt vmcnt(56)
    v_perm_b32 v129, v51, v50, v11
    s_add_u32 s17, s49, 235008
    buffer_load_dword v108, v12, s[20:23], s17 offen
    buffer_load_dword v109, v13, s[20:23], s17 offen
    s_waitcnt vmcnt(56)
    v_perm_b32 v130, v53, v52, v11
    s_add_u32 s17, s49, 237312
    buffer_load_dword v110, v12, s[20:23], s17 offen
    buffer_load_dword v111, v13, s[20:23], s17 offen
    s_waitcnt vmcnt(56)
    v_perm_b32 v131, v55, v54, v11
    s_add_u32 s17, s49, 248832
    buffer_load_dword v16, v12, s[20:23], s17 offen
    buffer_load_dword v17, v13, s[20:23], s17 offen
    s_waitcnt vmcnt(56)
    v_perm_b32 v132, v57, v56, v11
    s_add_u32 s17, s49, 251136
    buffer_load_dword v18, v12, s[20:23], s17 offen
    buffer_load_dword v19, v13, s[20:23], s17 offen
    s_waitcnt vmcnt(56)
    v_perm_b32 v133, v59, v58, v11
    s_add_u32 s17, s49, 253440
    buffer_load_dword v20, v12, s[20:23], s17 offen
    buffer_load_dword v21, v13, s[20:23], s17 offen
    s_waitcnt vmcnt(56)
    v_perm_b32 v134, v61, v60, v11
    s_add_u32 s17, s49, 255744
    buffer_load_dword v22, v12, s[20:23], s17 offen
    buffer_load_dword v23, v13, s[20:23], s17 offen
    s_waitcnt vmcnt(56)
    v_perm_b32 v135, v63, v62, v11
    s_add_u32 s17, s49, 271872
    buffer_load_dword v24, v12, s[20:23], s17 offen
    buffer_load_dword v25, v13, s[20:23], s17 offen
    s_waitcnt vmcnt(56)
    v_perm_b32 v136, v65, v64, v11
    s_add_u32 s17, s49, 274176
    buffer_load_dword v26, v12, s[20:23], s17 offen
    buffer_load_dword v27, v13, s[20:23], s17 offen
    s_waitcnt vmcnt(56)
    v_perm_b32 v137, v67, v66, v11
    s_add_u32 s17, s49, 276480
    buffer_load_dword v28, v12, s[20:23], s17 offen
    buffer_load_dword v29, v13, s[20:23], s17 offen
    s_waitcnt vmcnt(56)
    v_perm_b32 v138, v69, v68, v11
    s_add_u32 s17, s49, 278784
    buffer_load_dword v30, v12, s[20:23], s17 offen
    buffer_load_dword v31, v13, s[20:23], s17 offen
    s_waitcnt vmcnt(56)
    v_perm_b32 v139, v71, v70, v11
    s_add_u32 s17, s49, 290304
    buffer_load_dword v32, v12, s[20:23], s17 offen
    buffer_load_dword v33, v13, s[20:23], s17 offen
    s_waitcnt vmcnt(56)
    v_perm_b32 v140, v73, v72, v11
    s_add_u32 s17, s49, 292608
    buffer_load_dword v34, v12, s[20:23], s17 offen
    buffer_load_dword v35, v13, s[20:23], s17 offen
    s_waitcnt vmcnt(56)
    v_perm_b32 v141, v75, v74, v11
    s_add_u32 s17, s49, 294912
    buffer_load_dword v36, v12, s[20:23], s17 offen
    buffer_load_dword v37, v13, s[20:23], s17 offen
    s_waitcnt vmcnt(56)
    v_perm_b32 v142, v77, v76, v11
    s_add_u32 s17, s49, 297216
    buffer_load_dword v38, v12, s[20:23], s17 offen
    buffer_load_dword v39, v13, s[20:23], s17 offen
    s_waitcnt vmcnt(56)
    v_perm_b32 v143, v79, v78, v11
    s_add_u32 s17, s49, 313344
    buffer_load_dword v40, v12, s[20:23], s17 offen
    buffer_load_dword v41, v13, s[20:23], s17 offen
    s_waitcnt vmcnt(56)
    v_perm_b32 v144, v81, v80, v11
    s_add_u32 s17, s49, 315648
    buffer_load_dword v42, v12, s[20:23], s17 offen
    buffer_load_dword v43, v13, s[20:23], s17 offen
    s_waitcnt vmcnt(56)
    v_perm_b32 v145, v83, v82, v11
    s_add_u32 s17, s49, 317952
    buffer_load_dword v44, v12, s[20:23], s17 offen
    buffer_load_dword v45, v13, s[20:23], s17 offen
    s_waitcnt vmcnt(56)
    v_perm_b32 v146, v85, v84, v11
    s_add_u32 s17, s49, 320256
    buffer_load_dword v46, v12, s[20:23], s17 offen
    buffer_load_dword v47, v13, s[20:23], s17 offen
    s_waitcnt vmcnt(56)
    v_perm_b32 v147, v87, v86, v11
    s_add_u32 s17, s49, 331776
    buffer_load_dword v48, v12, s[20:23], s17 offen
    buffer_load_dword v49, v13, s[20:23], s17 offen
    s_waitcnt vmcnt(56)
    v_perm_b32 v148, v89, v88, v11
    s_add_u32 s17, s49, 334080
    buffer_load_dword v50, v12, s[20:23], s17 offen
    buffer_load_dword v51, v13, s[20:23], s17 offen
    s_waitcnt vmcnt(56)
    v_perm_b32 v149, v91, v90, v11
    s_add_u32 s17, s49, 336384
    buffer_load_dword v52, v12, s[20:23], s17 offen
    buffer_load_dword v53, v13, s[20:23], s17 offen
    s_waitcnt vmcnt(56)
    v_perm_b32 v150, v93, v92, v11
    s_add_u32 s17, s49, 338688
    buffer_load_dword v54, v12, s[20:23], s17 offen
    buffer_load_dword v55, v13, s[20:23], s17 offen
    s_waitcnt vmcnt(56)
    v_perm_b32 v151, v95, v94, v11
    s_add_u32 s17, s49, 354816
    buffer_load_dword v56, v12, s[20:23], s17 offen
    buffer_load_dword v57, v13, s[20:23], s17 offen
    s_waitcnt vmcnt(56)
    v_perm_b32 v152, v97, v96, v11
    s_add_u32 s17, s49, 357120
    buffer_load_dword v58, v12, s[20:23], s17 offen
    buffer_load_dword v59, v13, s[20:23], s17 offen
    s_waitcnt vmcnt(56)
    v_perm_b32 v153, v99, v98, v11
    s_add_u32 s17, s49, 359424
    buffer_load_dword v60, v12, s[20:23], s17 offen
    buffer_load_dword v61, v13, s[20:23], s17 offen
    s_waitcnt vmcnt(56)
    v_perm_b32 v154, v101, v100, v11
    s_add_u32 s17, s49, 361728
    buffer_load_dword v62, v12, s[20:23], s17 offen
    buffer_load_dword v63, v13, s[20:23], s17 offen
    s_waitcnt vmcnt(56)
    v_perm_b32 v155, v103, v102, v11
    s_add_u32 s17, s49, 373248
    buffer_load_dword v64, v12, s[20:23], s17 offen
    buffer_load_dword v65, v13, s[20:23], s17 offen
    s_waitcnt vmcnt(56)
    v_perm_b32 v156, v105, v104, v11
    s_add_u32 s17, s49, 375552
    buffer_load_dword v66, v12, s[20:23], s17 offen
    buffer_load_dword v67, v13, s[20:23], s17 offen
    s_waitcnt vmcnt(56)
    v_perm_b32 v157, v107, v106, v11
    s_add_u32 s17, s49, 377856
    buffer_load_dword v68, v12, s[20:23], s17 offen
    buffer_load_dword v69, v13, s[20:23], s17 offen
    s_waitcnt vmcnt(56)
    v_perm_b32 v158, v109, v108, v11
    s_add_u32 s17, s49, 380160
    buffer_load_dword v70, v12, s[20:23], s17 offen
    buffer_load_dword v71, v13, s[20:23], s17 offen
    s_waitcnt vmcnt(56)
    v_perm_b32 v159, v111, v110, v11
    s_add_u32 s17, s49, 396288
    buffer_load_dword v72, v12, s[20:23], s17 offen
    buffer_load_dword v73, v13, s[20:23], s17 offen
    s_waitcnt vmcnt(56)
    v_perm_b32 v160, v17, v16, v11
    s_add_u32 s17, s49, 398592
    buffer_load_dword v74, v12, s[20:23], s17 offen
    buffer_load_dword v75, v13, s[20:23], s17 offen
    s_waitcnt vmcnt(56)
    v_perm_b32 v161, v19, v18, v11
    s_add_u32 s17, s49, 400896
    buffer_load_dword v76, v12, s[20:23], s17 offen
    buffer_load_dword v77, v13, s[20:23], s17 offen
    s_waitcnt vmcnt(56)
    v_perm_b32 v162, v21, v20, v11
    s_add_u32 s17, s49, 403200
    buffer_load_dword v78, v12, s[20:23], s17 offen
    buffer_load_dword v79, v13, s[20:23], s17 offen
    s_waitcnt vmcnt(56)
    v_perm_b32 v163, v23, v22, v11
    s_add_u32 s17, s49, 414720
    buffer_load_dword v80, v12, s[20:23], s17 offen
    buffer_load_dword v81, v13, s[20:23], s17 offen
    s_waitcnt vmcnt(56)
    v_perm_b32 v164, v25, v24, v11
    s_add_u32 s17, s49, 417024
    buffer_load_dword v82, v12, s[20:23], s17 offen
    buffer_load_dword v83, v13, s[20:23], s17 offen
    s_waitcnt vmcnt(56)
    v_perm_b32 v165, v27, v26, v11
    s_add_u32 s17, s49, 419328
    buffer_load_dword v84, v12, s[20:23], s17 offen
    buffer_load_dword v85, v13, s[20:23], s17 offen
    s_waitcnt vmcnt(56)
    v_perm_b32 v166, v29, v28, v11
    s_add_u32 s17, s49, 421632
    buffer_load_dword v86, v12, s[20:23], s17 offen
    buffer_load_dword v87, v13, s[20:23], s17 offen
    s_waitcnt vmcnt(56)
    v_perm_b32 v167, v31, v30, v11
    s_add_u32 s17, s49, 437760
    buffer_load_dword v88, v12, s[20:23], s17 offen
    buffer_load_dword v89, v13, s[20:23], s17 offen
    s_waitcnt vmcnt(56)
    v_perm_b32 v168, v33, v32, v11
    s_add_u32 s17, s49, 440064
    buffer_load_dword v90, v12, s[20:23], s17 offen
    buffer_load_dword v91, v13, s[20:23], s17 offen
    s_waitcnt vmcnt(56)
    v_perm_b32 v169, v35, v34, v11
    s_add_u32 s17, s49, 442368
    buffer_load_dword v92, v12, s[20:23], s17 offen
    buffer_load_dword v93, v13, s[20:23], s17 offen
    s_waitcnt vmcnt(56)
    v_perm_b32 v170, v37, v36, v11
    s_add_u32 s17, s49, 444672
    buffer_load_dword v94, v12, s[20:23], s17 offen
    buffer_load_dword v95, v13, s[20:23], s17 offen
    s_waitcnt vmcnt(56)
    v_perm_b32 v171, v39, v38, v11
    s_add_u32 s17, s49, 456192
    buffer_load_dword v96, v12, s[20:23], s17 offen
    buffer_load_dword v97, v13, s[20:23], s17 offen
    s_waitcnt vmcnt(56)
    v_perm_b32 v172, v41, v40, v11
    s_add_u32 s17, s49, 458496
    buffer_load_dword v98, v12, s[20:23], s17 offen
    buffer_load_dword v99, v13, s[20:23], s17 offen
    s_waitcnt vmcnt(56)
    v_perm_b32 v173, v43, v42, v11
    s_add_u32 s17, s49, 460800
    buffer_load_dword v100, v12, s[20:23], s17 offen
    buffer_load_dword v101, v13, s[20:23], s17 offen
    s_waitcnt vmcnt(56)
    v_perm_b32 v174, v45, v44, v11
    s_add_u32 s17, s49, 463104
    buffer_load_dword v102, v12, s[20:23], s17 offen
    buffer_load_dword v103, v13, s[20:23], s17 offen
    s_waitcnt vmcnt(56)
    v_perm_b32 v175, v47, v46, v11
    s_add_u32 s17, s49, 479232
    buffer_load_dword v104, v12, s[20:23], s17 offen
    buffer_load_dword v105, v13, s[20:23], s17 offen
    s_waitcnt vmcnt(56)
    v_perm_b32 v176, v49, v48, v11
    s_add_u32 s17, s49, 481536
    buffer_load_dword v106, v12, s[20:23], s17 offen
    buffer_load_dword v107, v13, s[20:23], s17 offen
    s_waitcnt vmcnt(56)
    v_perm_b32 v177, v51, v50, v11
    s_add_u32 s17, s49, 483840
    buffer_load_dword v108, v12, s[20:23], s17 offen
    buffer_load_dword v109, v13, s[20:23], s17 offen
    s_waitcnt vmcnt(56)
    v_perm_b32 v178, v53, v52, v11
    s_add_u32 s17, s49, 486144
    buffer_load_dword v110, v12, s[20:23], s17 offen
    buffer_load_dword v111, v13, s[20:23], s17 offen
    s_waitcnt vmcnt(56)
    v_perm_b32 v179, v55, v54, v11
    s_add_u32 s17, s49, 497664
    buffer_load_dword v16, v12, s[20:23], s17 offen
    buffer_load_dword v17, v13, s[20:23], s17 offen
    s_waitcnt vmcnt(56)
    v_perm_b32 v180, v57, v56, v11
    s_add_u32 s17, s49, 499968
    buffer_load_dword v18, v12, s[20:23], s17 offen
    buffer_load_dword v19, v13, s[20:23], s17 offen
    s_waitcnt vmcnt(56)
    v_perm_b32 v181, v59, v58, v11
    s_add_u32 s17, s49, 502272
    buffer_load_dword v20, v12, s[20:23], s17 offen
    buffer_load_dword v21, v13, s[20:23], s17 offen
    s_waitcnt vmcnt(56)
    v_perm_b32 v182, v61, v60, v11
    s_add_u32 s17, s49, 504576
    buffer_load_dword v22, v12, s[20:23], s17 offen
    buffer_load_dword v23, v13, s[20:23], s17 offen
    s_waitcnt vmcnt(56)
    v_perm_b32 v183, v63, v62, v11
    s_add_u32 s17, s49, 520704
    buffer_load_dword v24, v12, s[20:23], s17 offen
    buffer_load_dword v25, v13, s[20:23], s17 offen
    s_waitcnt vmcnt(56)
    v_perm_b32 v184, v65, v64, v11
    s_add_u32 s17, s49, 523008
    buffer_load_dword v26, v12, s[20:23], s17 offen
    buffer_load_dword v27, v13, s[20:23], s17 offen
    s_waitcnt vmcnt(56)
    v_perm_b32 v185, v67, v66, v11
    s_add_u32 s17, s49, 525312
    buffer_load_dword v28, v12, s[20:23], s17 offen
    buffer_load_dword v29, v13, s[20:23], s17 offen
    s_waitcnt vmcnt(56)
    v_perm_b32 v186, v69, v68, v11
    s_add_u32 s17, s49, 527616
    buffer_load_dword v30, v12, s[20:23], s17 offen
    buffer_load_dword v31, v13, s[20:23], s17 offen
    s_waitcnt vmcnt(56)
    v_perm_b32 v187, v71, v70, v11
    s_add_u32 s17, s49, 539136
    buffer_load_dword v32, v12, s[20:23], s17 offen
    buffer_load_dword v33, v13, s[20:23], s17 offen
    s_waitcnt vmcnt(56)
    v_perm_b32 v188, v73, v72, v11
    s_add_u32 s17, s49, 541440
    buffer_load_dword v34, v12, s[20:23], s17 offen
    buffer_load_dword v35, v13, s[20:23], s17 offen
    s_waitcnt vmcnt(56)
    v_perm_b32 v189, v75, v74, v11
    s_add_u32 s17, s49, 543744
    buffer_load_dword v36, v12, s[20:23], s17 offen
    buffer_load_dword v37, v13, s[20:23], s17 offen
    s_waitcnt vmcnt(56)
    v_perm_b32 v190, v77, v76, v11
    s_add_u32 s17, s49, 546048
    buffer_load_dword v38, v12, s[20:23], s17 offen
    buffer_load_dword v39, v13, s[20:23], s17 offen
    s_waitcnt vmcnt(56)
    v_perm_b32 v191, v79, v78, v11
    s_add_u32 s17, s49, 562176
    buffer_load_dword v40, v12, s[20:23], s17 offen
    buffer_load_dword v41, v13, s[20:23], s17 offen
    s_waitcnt vmcnt(56)
    v_perm_b32 v192, v81, v80, v11
    s_add_u32 s17, s49, 564480
    buffer_load_dword v42, v12, s[20:23], s17 offen
    buffer_load_dword v43, v13, s[20:23], s17 offen
    s_waitcnt vmcnt(56)
    v_perm_b32 v193, v83, v82, v11
    s_add_u32 s17, s49, 566784
    buffer_load_dword v44, v12, s[20:23], s17 offen
    buffer_load_dword v45, v13, s[20:23], s17 offen
    s_waitcnt vmcnt(56)
    v_perm_b32 v194, v85, v84, v11
    s_add_u32 s17, s49, 569088
    buffer_load_dword v46, v12, s[20:23], s17 offen
    buffer_load_dword v47, v13, s[20:23], s17 offen
    s_waitcnt vmcnt(56)
    v_perm_b32 v195, v87, v86, v11
    s_add_u32 s17, s49, 580608
    buffer_load_dword v48, v12, s[20:23], s17 offen
    buffer_load_dword v49, v13, s[20:23], s17 offen
    s_waitcnt vmcnt(56)
    v_perm_b32 v196, v89, v88, v11
    s_add_u32 s17, s49, 582912
    buffer_load_dword v50, v12, s[20:23], s17 offen
    buffer_load_dword v51, v13, s[20:23], s17 offen
    s_waitcnt vmcnt(56)
    v_perm_b32 v197, v91, v90, v11
    s_add_u32 s17, s49, 585216
    buffer_load_dword v52, v12, s[20:23], s17 offen
    buffer_load_dword v53, v13, s[20:23], s17 offen
    s_waitcnt vmcnt(56)
    v_perm_b32 v198, v93, v92, v11
    s_add_u32 s17, s49, 587520
    buffer_load_dword v54, v12, s[20:23], s17 offen
    buffer_load_dword v55, v13, s[20:23], s17 offen
    s_waitcnt vmcnt(56)
    v_perm_b32 v199, v95, v94, v11
    s_add_u32 s17, s49, 603648
    buffer_load_dword v56, v12, s[20:23], s17 offen
    buffer_load_dword v57, v13, s[20:23], s17 offen
    s_waitcnt vmcnt(56)
    v_perm_b32 v200, v97, v96, v11
    s_add_u32 s17, s49, 605952
    buffer_load_dword v58, v12, s[20:23], s17 offen
    buffer_load_dword v59, v13, s[20:23], s17 offen
    s_waitcnt vmcnt(56)
    v_perm_b32 v201, v99, v98, v11
    s_add_u32 s17, s49, 608256
    buffer_load_dword v60, v12, s[20:23], s17 offen
    buffer_load_dword v61, v13, s[20:23], s17 offen
    s_waitcnt vmcnt(56)
    v_perm_b32 v202, v101, v100, v11
    s_add_u32 s17, s49, 610560
    buffer_load_dword v62, v12, s[20:23], s17 offen
    buffer_load_dword v63, v13, s[20:23], s17 offen
    s_waitcnt vmcnt(56)
    v_perm_b32 v203, v103, v102, v11
    s_add_u32 s17, s49, 622080
    buffer_load_dword v64, v12, s[20:23], s17 offen
    buffer_load_dword v65, v13, s[20:23], s17 offen
    s_waitcnt vmcnt(56)
    v_perm_b32 v204, v105, v104, v11
    s_add_u32 s17, s49, 624384
    buffer_load_dword v66, v12, s[20:23], s17 offen
    buffer_load_dword v67, v13, s[20:23], s17 offen
    s_waitcnt vmcnt(56)
    v_perm_b32 v205, v107, v106, v11
    s_add_u32 s17, s49, 626688
    buffer_load_dword v68, v12, s[20:23], s17 offen
    buffer_load_dword v69, v13, s[20:23], s17 offen
    s_waitcnt vmcnt(56)
    v_perm_b32 v206, v109, v108, v11
    s_add_u32 s17, s49, 628992
    buffer_load_dword v70, v12, s[20:23], s17 offen
    buffer_load_dword v71, v13, s[20:23], s17 offen
    s_waitcnt vmcnt(56)
    v_perm_b32 v207, v111, v110, v11
    s_add_u32 s17, s49, 645120
    buffer_load_dword v72, v12, s[20:23], s17 offen
    buffer_load_dword v73, v13, s[20:23], s17 offen
    s_waitcnt vmcnt(56)
    v_perm_b32 v208, v17, v16, v11
    s_add_u32 s17, s49, 647424
    buffer_load_dword v74, v12, s[20:23], s17 offen
    buffer_load_dword v75, v13, s[20:23], s17 offen
    s_waitcnt vmcnt(56)
    v_perm_b32 v209, v19, v18, v11
    s_add_u32 s17, s49, 649728
    buffer_load_dword v76, v12, s[20:23], s17 offen
    buffer_load_dword v77, v13, s[20:23], s17 offen
    s_waitcnt vmcnt(56)
    v_perm_b32 v210, v21, v20, v11
    s_add_u32 s17, s49, 652032
    buffer_load_dword v78, v12, s[20:23], s17 offen
    buffer_load_dword v79, v13, s[20:23], s17 offen
    s_waitcnt vmcnt(56)
    v_perm_b32 v211, v23, v22, v11
    s_waitcnt vmcnt(54)
    v_perm_b32 v212, v25, v24, v11
    s_waitcnt vmcnt(52)
    v_perm_b32 v213, v27, v26, v11
    s_waitcnt vmcnt(50)
    v_perm_b32 v214, v29, v28, v11
    s_waitcnt vmcnt(48)
    v_perm_b32 v215, v31, v30, v11
    s_waitcnt vmcnt(46)
    v_perm_b32 v216, v33, v32, v11
    s_waitcnt vmcnt(44)
    v_perm_b32 v217, v35, v34, v11
    s_waitcnt vmcnt(42)
    v_perm_b32 v218, v37, v36, v11
    s_waitcnt vmcnt(40)
    v_perm_b32 v219, v39, v38, v11
    s_waitcnt vmcnt(38)
    v_perm_b32 v220, v41, v40, v11
    s_waitcnt vmcnt(36)
    v_perm_b32 v221, v43, v42, v11
    s_waitcnt vmcnt(34)
    v_perm_b32 v222, v45, v44, v11
    s_waitcnt vmcnt(32)
    v_perm_b32 v223, v47, v46, v11
    s_waitcnt vmcnt(30)
    v_perm_b32 v224, v49, v48, v11
    s_waitcnt vmcnt(28)
    v_perm_b32 v225, v51, v50, v11
    s_waitcnt vmcnt(26)
    v_perm_b32 v226, v53, v52, v11
    s_waitcnt vmcnt(24)
    v_perm_b32 v227, v55, v54, v11
    s_waitcnt vmcnt(22)
    v_perm_b32 v228, v57, v56, v11
    s_waitcnt vmcnt(20)
    v_perm_b32 v229, v59, v58, v11
    s_waitcnt vmcnt(18)
    v_perm_b32 v230, v61, v60, v11
    s_waitcnt vmcnt(16)
    v_perm_b32 v231, v63, v62, v11
    s_waitcnt vmcnt(14)
    v_perm_b32 v232, v65, v64, v11
    s_waitcnt vmcnt(12)
    v_perm_b32 v233, v67, v66, v11
    s_waitcnt vmcnt(10)
    v_perm_b32 v234, v69, v68, v11
    s_waitcnt vmcnt(8)
    v_perm_b32 v235, v71, v70, v11
    s_waitcnt vmcnt(6)
    v_perm_b32 v236, v73, v72, v11
    s_waitcnt vmcnt(4)
    v_perm_b32 v237, v75, v74, v11
    s_waitcnt vmcnt(2)
    v_perm_b32 v238, v77, v76, v11
    s_waitcnt vmcnt(0)
    v_perm_b32 v239, v79, v78, v11
    v_mul_u32_u24 v5, 82944, v9
    v_add_u32 v12, v5, v14
    v_add_u32 v13, 1152, v12
    s_add_u32 s17, s49, 18432
    buffer_load_dword v16, v12, s[20:23], s17 offen
    buffer_load_dword v17, v13, s[20:23], s17 offen
    s_add_u32 s17, s49, 20736
    buffer_load_dword v18, v12, s[20:23], s17 offen
    buffer_load_dword v19, v13, s[20:23], s17 offen
    s_add_u32 s17, s49, 59904
    buffer_load_dword v20, v12, s[20:23], s17 offen
    buffer_load_dword v21, v13, s[20:23], s17 offen
    s_add_u32 s17, s49, 62208
    buffer_load_dword v22, v12, s[20:23], s17 offen
    buffer_load_dword v23, v13, s[20:23], s17 offen
    s_add_u32 s17, s49, 184320
    buffer_load_dword v24, v12, s[20:23], s17 offen
    buffer_load_dword v25, v13, s[20:23], s17 offen
    s_add_u32 s17, s49, 186624
    buffer_load_dword v26, v12, s[20:23], s17 offen
    buffer_load_dword v27, v13, s[20:23], s17 offen
    s_add_u32 s17, s49, 225792
    buffer_load_dword v28, v12, s[20:23], s17 offen
    buffer_load_dword v29, v13, s[20:23], s17 offen
    s_add_u32 s17, s49, 228096
    buffer_load_dword v30, v12, s[20:23], s17 offen
    buffer_load_dword v31, v13, s[20:23], s17 offen
    s_add_u32 s17, s49, 350208
    buffer_load_dword v32, v12, s[20:23], s17 offen
    buffer_load_dword v33, v13, s[20:23], s17 offen
    s_add_u32 s17, s49, 352512
    buffer_load_dword v34, v12, s[20:23], s17 offen
    buffer_load_dword v35, v13, s[20:23], s17 offen
    s_add_u32 s17, s49, 391680
    buffer_load_dword v36, v12, s[20:23], s17 offen
    buffer_load_dword v37, v13, s[20:23], s17 offen
    s_add_u32 s17, s49, 393984
    buffer_load_dword v38, v12, s[20:23], s17 offen
    buffer_load_dword v39, v13, s[20:23], s17 offen
    s_add_u32 s17, s49, 516096
    buffer_load_dword v40, v12, s[20:23], s17 offen
    buffer_load_dword v41, v13, s[20:23], s17 offen
    s_add_u32 s17, s49, 518400
    buffer_load_dword v42, v12, s[20:23], s17 offen
    buffer_load_dword v43, v13, s[20:23], s17 offen
    s_add_u32 s17, s49, 557568
    buffer_load_dword v44, v12, s[20:23], s17 offen
    buffer_load_dword v45, v13, s[20:23], s17 offen
    s_add_u32 s17, s49, 559872
    buffer_load_dword v46, v12, s[20:23], s17 offen
    buffer_load_dword v47, v13, s[20:23], s17 offen
    s_waitcnt vmcnt(30)
    v_perm_b32 v240, v17, v16, v11
    s_waitcnt vmcnt(28)
    v_perm_b32 v241, v19, v18, v11
    s_waitcnt vmcnt(26)
    v_perm_b32 v242, v21, v20, v11
    s_waitcnt vmcnt(24)
    v_perm_b32 v243, v23, v22, v11
    s_waitcnt vmcnt(22)
    v_perm_b32 v244, v25, v24, v11
    s_waitcnt vmcnt(20)
    v_perm_b32 v245, v27, v26, v11
    s_waitcnt vmcnt(18)
    v_perm_b32 v246, v29, v28, v11
    s_waitcnt vmcnt(16)
    v_perm_b32 v247, v31, v30, v11
    s_waitcnt vmcnt(14)
    v_perm_b32 v248, v33, v32, v11
    s_waitcnt vmcnt(12)
    v_perm_b32 v249, v35, v34, v11
    s_waitcnt vmcnt(10)
    v_perm_b32 v250, v37, v36, v11
    s_waitcnt vmcnt(8)
    v_perm_b32 v251, v39, v38, v11
    s_waitcnt vmcnt(6)
    v_perm_b32 v252, v41, v40, v11
    s_waitcnt vmcnt(4)
    v_perm_b32 v253, v43, v42, v11
    s_waitcnt vmcnt(2)
    v_perm_b32 v254, v45, v44, v11
    s_waitcnt vmcnt(0)
    v_perm_b32 v255, v47, v46, v11
    v_lshlrev_b32 v10, 4, v10
    v_lshl_add_u32 v14, v9, 9, v10
    s_lshl_b32 s17, s50, 11
    v_add_u32 v14, s17, v14
    s_lshr_b32 s17, s50, 1
    s_lshl_b32 s17, s17, 9
    s_and_b32 s18, s50, 1
    s_lshl_b32 s18, s18, 3
    s_add_u32 s17, s17, s18
    v_add_u32 v10, s17, v10
    s_lshr_b32 s49, s50, 2
    s_lshl_b32 s49, s49, 7
    s_and_b32 s17, s50, 3
    s_lshl_b32 s17, s17, 2
    s_add_u32 s49, s49, s17
    s_add_u32 s49, s49, 183808
    s_mov_b32 s36, s63
    s_mov_b32 s34, s63
    s_mov_b32 s37, 0
    s_lshl_b32 s56, s63, 6
    s_mul_i32 s58, s14, 9216
    s_mov_b32 s40, 36864
    s_mov_b32 s59, s58
    s_mov_b32 s43, 0
    s_mov_b32 s28, s8
    s_mov_b32 s29, s9
    s_mov_b32 s30, 0
    s_mov_b32 s31, 0x00020000
    s_mul_i32 s41, s63, 2359296
    s_add_u32 s41, s41, s58
    s_add_u32 s41, s41, 17301504
    s_mul_i32 s42, s56, 22528
    s_add_u32 s42, s42, 181760
    s_cmp_lg_u32 s14, 0
    s_cbranch_scc1 Lawo_ini_d
    v_mov_b32 v5, 160
    s_mov_b32 s16, 0
Lawo_ini:
    global_load_dword v6, v5, s[12:13] sc1
    s_add_u32 s16, s16, 1
    s_cmp_gt_u32 s16, 100000
    s_cbranch_scc1 L_role_awo_abort
    s_waitcnt vmcnt(0)
    v_cmp_gt_u32 vcc, 123, v6
    s_nop 0
    s_cbranch_vccz Lawo_ini_d
    s_sleep 8
    s_branch Lawo_ini
Lawo_ini_d:
    s_barrier
    s_branch Lawo_poll
Lawo_item:
    s_waitcnt vmcnt(3)
Lawo_go:
    s_barrier
    s_xor_b32 s40, s40, 36864
    s_xor_b32 s59, s59, 36864
    s_xor_b32 s66, s66, 0x2000
    s_xor_b32 s71, s71, 0x2000
    s_mov_b32 s35, s37
    s_mov_b32 s57, s56
    s_add_u32 s37, s37, 1
    s_add_u32 s56, s56, 1
    s_add_u32 s41, s41, 36864
    s_add_u32 s42, s42, 22528
    s_mov_b32 s62, 0
    v_add_u32 v9, s40, v0
    ds_read_b128 v[32:35], v9 offset:0
    ds_read_b128 v[36:39], v9 offset:1024
    ds_read_b128 v[40:43], v9 offset:2048
    ds_read_b128 v[44:47], v9 offset:3072
    ds_read_b128 v[48:51], v9 offset:4096
    ds_read_b128 v[52:55], v9 offset:5120
    ds_read_b128 v[56:59], v9 offset:6144
    v_lshlrev_b32 v16, 16, v64
    v_and_b32 v17, 0xffff0000, v64
    v_lshlrev_b32 v18, 16, v65
    v_and_b32 v19, 0xffff0000, v65
    v_lshlrev_b32 v20, 16, v66
    v_and_b32 v21, 0xffff0000, v66
    v_lshlrev_b32 v22, 16, v67
    v_and_b32 v23, 0xffff0000, v67
    v_lshlrev_b32 v24, 16, v68
    v_and_b32 v25, 0xffff0000, v68
    v_lshlrev_b32 v26, 16, v69
    v_and_b32 v27, 0xffff0000, v69
    v_lshlrev_b32 v28, 16, v70
    v_and_b32 v29, 0xffff0000, v70
    v_lshlrev_b32 v30, 16, v71
    v_and_b32 v31, 0xffff0000, v71
    s_waitcnt lgkmcnt(6)
    s_nop 0
    v_mfma_f32_32x32x16_bf16 v[16:31], v[112:115], v[32:35], v[16:31]
    ds_read_b128 v[60:63], v9 offset:7168
    s_mul_i32 s46, s34, 4718592
    s_waitcnt lgkmcnt(6)
    v_mfma_f32_32x32x16_bf16 v[16:31], v[116:119], v[36:39], v[16:31]
    ds_read_b128 v[32:35], v9 offset:8192
    s_mul_i32 s51, s35, 36864
    s_waitcnt lgkmcnt(6)
    v_mfma_f32_32x32x16_bf16 v[16:31], v[120:123], v[40:43], v[16:31]
    ds_read_b128 v[36:39], v9 offset:9216
    s_add_u32 s46, s46, s51
    s_waitcnt lgkmcnt(6)
    v_mfma_f32_32x32x16_bf16 v[16:31], v[124:127], v[44:47], v[16:31]
    ds_read_b128 v[40:43], v9 offset:10240
    s_add_u32 s46, s46, 8650752
    s_waitcnt lgkmcnt(6)
    v_mfma_f32_32x32x16_bf16 v[16:31], v[128:131], v[48:51], v[16:31]
    ds_read_b128 v[44:47], v9 offset:11264
    s_mul_i32 s52, s34, 786432
    s_waitcnt lgkmcnt(6)
    v_mfma_f32_32x32x16_bf16 v[16:31], v[132:135], v[52:55], v[16:31]
    ds_read_b128 v[48:51], v9 offset:12288
    s_mul_i32 s51, s35, 6144
    s_waitcnt lgkmcnt(6)
    v_mfma_f32_32x32x16_bf16 v[16:31], v[136:139], v[56:59], v[16:31]
    ds_read_b128 v[52:55], v9 offset:13312
    s_add_u32 s52, s52, s51
    s_waitcnt lgkmcnt(6)
    v_mfma_f32_32x32x16_bf16 v[16:31], v[140:143], v[60:63], v[16:31]
    ds_read_b128 v[56:59], v9 offset:14336
    s_add_u32 s52, s52, 16121856
    s_waitcnt lgkmcnt(6)
    v_mfma_f32_32x32x16_bf16 v[16:31], v[144:147], v[32:35], v[16:31]
    ds_read_b128 v[60:63], v9 offset:15360
    s_waitcnt lgkmcnt(6)
    v_mfma_f32_32x32x16_bf16 v[16:31], v[148:151], v[36:39], v[16:31]
    ds_read_b128 v[32:35], v9 offset:16384
    s_waitcnt lgkmcnt(6)
    v_mfma_f32_32x32x16_bf16 v[16:31], v[152:155], v[40:43], v[16:31]
    ds_read_b128 v[36:39], v9 offset:17408
    s_waitcnt lgkmcnt(6)
    v_mfma_f32_32x32x16_bf16 v[16:31], v[156:159], v[44:47], v[16:31]
    ds_read_b128 v[40:43], v9 offset:18432
    s_waitcnt lgkmcnt(6)
    v_mfma_f32_32x32x16_bf16 v[16:31], v[160:163], v[48:51], v[16:31]
    ds_read_b128 v[44:47], v9 offset:19456
    s_waitcnt lgkmcnt(6)
    v_mfma_f32_32x32x16_bf16 v[16:31], v[164:167], v[52:55], v[16:31]
    ds_read_b128 v[48:51], v9 offset:20480
    s_waitcnt lgkmcnt(6)
    v_mfma_f32_32x32x16_bf16 v[16:31], v[168:171], v[56:59], v[16:31]
    ds_read_b128 v[52:55], v9 offset:21504
    s_waitcnt vmcnt(0)
    buffer_load_dword v2, v1, s[8:11], s42 offen sc1
    s_cmp_lg_u32 s43, 0
    s_cselect_b64 exec, 1, 0
    buffer_store_dword v3, v4, s[8:11], s43 offen sc1
    s_mov_b64 exec, -1
    s_mov_b32 s43, 0
    s_waitcnt lgkmcnt(6)
    v_mfma_f32_32x32x16_bf16 v[16:31], v[172:175], v[60:63], v[16:31]
    ds_read_b128 v[56:59], v9 offset:22528
    s_waitcnt lgkmcnt(6)
    v_mfma_f32_32x32x16_bf16 v[16:31], v[176:179], v[32:35], v[16:31]
    ds_read_b128 v[60:63], v9 offset:23552
    s_waitcnt lgkmcnt(6)
    v_mfma_f32_32x32x16_bf16 v[16:31], v[180:183], v[36:39], v[16:31]
    ds_read_b128 v[32:35], v9 offset:24576
    s_waitcnt lgkmcnt(6)
    v_mfma_f32_32x32x16_bf16 v[16:31], v[184:187], v[40:43], v[16:31]
    ds_read_b128 v[36:39], v9 offset:25600
    s_waitcnt lgkmcnt(6)
    v_mfma_f32_32x32x16_bf16 v[16:31], v[188:191], v[44:47], v[16:31]
    ds_read_b128 v[40:43], v9 offset:26624
    s_waitcnt lgkmcnt(6)
    v_mfma_f32_32x32x16_bf16 v[16:31], v[192:195], v[48:51], v[16:31]
    ds_read_b128 v[44:47], v9 offset:27648
    s_waitcnt lgkmcnt(6)
    v_mfma_f32_32x32x16_bf16 v[16:31], v[196:199], v[52:55], v[16:31]
    ds_read_b128 v[48:51], v9 offset:28672
    s_waitcnt lgkmcnt(6)
    v_mfma_f32_32x32x16_bf16 v[16:31], v[200:203], v[56:59], v[16:31]
    ds_read_b128 v[52:55], v9 offset:29696
    s_waitcnt lgkmcnt(6)
    v_mfma_f32_32x32x16_bf16 v[16:31], v[204:207], v[60:63], v[16:31]
    ds_read_b128 v[56:59], v9 offset:30720
    s_waitcnt lgkmcnt(6)
    v_mfma_f32_32x32x16_bf16 v[16:31], v[208:211], v[32:35], v[16:31]
    ds_read_b128 v[60:63], v9 offset:31744
    s_waitcnt lgkmcnt(6)
    v_mfma_f32_32x32x16_bf16 v[16:31], v[212:215], v[36:39], v[16:31]
    ds_read_b128 v[32:35], v9 offset:32768
    s_waitcnt lgkmcnt(6)
    v_mfma_f32_32x32x16_bf16 v[16:31], v[216:219], v[40:43], v[16:31]
    ds_read_b128 v[36:39], v9 offset:33792
    s_waitcnt lgkmcnt(6)
    v_mfma_f32_32x32x16_bf16 v[16:31], v[220:223], v[44:47], v[16:31]
    ds_read_b128 v[40:43], v9 offset:34816
    s_waitcnt lgkmcnt(6)
    v_mfma_f32_32x32x16_bf16 v[16:31], v[224:227], v[48:51], v[16:31]
    ds_read_b128 v[44:47], v9 offset:35840
    s_waitcnt lgkmcnt(6)
    v_mfma_f32_32x32x16_bf16 v[16:31], v[228:231], v[52:55], v[16:31]
    s_waitcnt lgkmcnt(5)
    v_mfma_f32_32x32x16_bf16 v[16:31], v[232:235], v[56:59], v[16:31]
    s_waitcnt lgkmcnt(4)
    v_mfma_f32_32x32x16_bf16 v[16:31], v[236:239], v[60:63], v[16:31]
    s_waitcnt lgkmcnt(3)
    v_mfma_f32_32x32x16_bf16 v[16:31], v[240:243], v[32:35], v[16:31]
    s_waitcnt vmcnt(1)
    v_cmp_eq_u32 vcc, 0, v2
    s_nop 0
    s_cmp_eq_u64 vcc, 0
    s_cselect_b32 s62, 1, 0
    s_cmp_lt_u32 s37, 64
    s_cselect_b32 s62, s62, 0
    s_cmp_lg_u32 s62, 0
    s_cselect_b32 s30, 268435456, 0
    s_waitcnt lgkmcnt(2)
    v_mfma_f32_32x32x16_bf16 v[16:31], v[244:247], v[36:39], v[16:31]
    s_add_u32 m0, s59, 0
    s_add_u32 s47, s41, 0
    buffer_load_dwordx4 v0, s[28:31], s47 offen offset:0 lds
    buffer_load_dwordx4 v0, s[28:31], s47 offen offset:1024 lds
    s_waitcnt lgkmcnt(1)
    v_mfma_f32_32x32x16_bf16 v[16:31], v[248:251], v[40:43], v[16:31]
    buffer_load_dwordx4 v0, s[28:31], s47 offen offset:2048 lds
    buffer_load_dwordx4 v0, s[28:31], s47 offen offset:3072 lds
    s_waitcnt lgkmcnt(0)
    v_mfma_f32_32x32x16_bf16 v[16:31], v[252:255], v[44:47], v[16:31]
    s_add_u32 m0, s59, 4096
    s_add_u32 s47, s41, 4096
    buffer_load_dwordx4 v0, s[28:31], s47 offen offset:0 lds
    buffer_load_dwordx4 v0, s[28:31], s47 offen offset:1024 lds
    buffer_load_dwordx4 v0, s[28:31], s47 offen offset:2048 lds
    buffer_load_dwordx4 v0, s[28:31], s47 offen offset:3072 lds
    s_add_u32 m0, s59, 8192
    s_add_u32 s47, s41, 8192
    buffer_load_dwordx4 v0, s[28:31], s47 offen offset:0 lds
    s_mul_i32 s48, s36, 4718592
    s_mul_i32 s18, s37, 36864
    s_add_u32 s48, s48, s18
    s_add_u32 s48, s48, 6291456
    buffer_load_dwordx4 v[64:67], v14, s[28:31], s48 offen offset:0
    buffer_load_dwordx4 v[68:71], v14, s[28:31], s48 offen offset:1024
    v_cvt_pk_bf16_f32 v32, v16, v17
    v_cvt_pk_bf16_f32 v33, v18, v19
    v_cvt_pk_bf16_f32 v34, v20, v21
    v_cvt_pk_bf16_f32 v35, v22, v23
    buffer_store_dwordx4 v[32:35], v14, s[8:11], s46 offen offset:0 sc1
    v_cvt_pk_bf16_f32 v36, v24, v25
    v_cvt_pk_bf16_f32 v37, v26, v27
    v_cvt_pk_bf16_f32 v38, v28, v29
    v_cvt_pk_bf16_f32 v39, v30, v31
    buffer_store_dwordx4 v[36:39], v14, s[8:11], s46 offen offset:1024 sc1
    v_add_f32 v72, v16, v17
    v_mul_f32 v73, v16, v16
    v_fmac_f32 v73, v17, v17
    v_add_f32 v72, v72, v18
    v_fmac_f32 v73, v18, v18
    v_add_f32 v72, v72, v19
    v_fmac_f32 v73, v19, v19
    v_add_f32 v72, v72, v20
    v_fmac_f32 v73, v20, v20
    v_add_f32 v72, v72, v21
    v_fmac_f32 v73, v21, v21
    v_add_f32 v72, v72, v22
    v_fmac_f32 v73, v22, v22
    v_add_f32 v72, v72, v23
    v_fmac_f32 v73, v23, v23
    v_add_f32 v72, v72, v24
    v_fmac_f32 v73, v24, v24
    v_add_f32 v72, v72, v25
    v_fmac_f32 v73, v25, v25
    v_add_f32 v72, v72, v26
    v_fmac_f32 v73, v26, v26
    v_add_f32 v72, v72, v27
    v_fmac_f32 v73, v27, v27
    v_add_f32 v72, v72, v28
    v_fmac_f32 v73, v28, v28
    v_add_f32 v72, v72, v29
    v_fmac_f32 v73, v29, v29
    v_add_f32 v72, v72, v30
    v_fmac_f32 v73, v30, v30
    v_add_f32 v72, v72, v31
    v_fmac_f32 v73, v31, v31
    v_mov_b32 v74, v72
    v_mov_b32 v75, v73
    s_nop 0
    v_permlane32_swap_b32 v72, v74
    v_permlane32_swap_b32 v73, v75
    v_add_f32 v72, v72, v74
    v_add_f32 v73, v73, v75
    buffer_store_dwordx2 v[72:73], v10, s[8:11], s52 offen sc1
    s_mul_i32 s43, s57, 22528
    s_add_u32 s43, s43, s49
    s_cmp_lg_u32 s62, 0
    s_cbranch_scc1 Lawo_item
    buffer_load_dword v2, v1, s[8:11], s42 offen sc1
    s_waitcnt vmcnt(0)
    s_cmp_ge_u32 s37, 64
    s_cbranch_scc1 Lawo_fin
    v_cmp_eq_u32 vcc, 0, v2
    s_nop 0
    s_cbranch_vccnz Lawo_pub
    s_add_u32 m0, s59, 0
    s_add_u32 s47, s41, 0
    buffer_load_dwordx4 v0, s[8:11], s47 offen offset:0 lds
    buffer_load_dwordx4 v0, s[8:11], s47 offen offset:1024 lds
    buffer_load_dwordx4 v0, s[8:11], s47 offen offset:2048 lds
    buffer_load_dwordx4 v0, s[8:11], s47 offen offset:3072 lds
    s_add_u32 m0, s59, 4096
    s_add_u32 s47, s41, 4096
    buffer_load_dwordx4 v0, s[8:11], s47 offen offset:0 lds
    buffer_load_dwordx4 v0, s[8:11], s47 offen offset:1024 lds
    buffer_load_dwordx4 v0, s[8:11], s47 offen offset:2048 lds
    buffer_load_dwordx4 v0, s[8:11], s47 offen offset:3072 lds
    s_add_u32 m0, s59, 8192
    s_add_u32 s47, s41, 8192
    buffer_load_dwordx4 v0, s[8:11], s47 offen offset:0 lds
    s_mul_i32 s48, s36, 4718592
    s_mul_i32 s18, s37, 36864
    s_add_u32 s48, s48, s18
    s_add_u32 s48, s48, 6291456
    buffer_load_dwordx4 v[64:67], v14, s[8:11], s48 offen offset:0
    buffer_load_dwordx4 v[68:71], v14, s[8:11], s48 offen offset:1024
    s_cmp_lg_u32 s43, 0
    s_cselect_b64 exec, 1, 0
    buffer_store_dword v3, v4, s[8:11], s43 offen sc1
    s_mov_b64 exec, -1
    s_mov_b32 s43, 0
    s_waitcnt vmcnt(1)
    s_branch Lawo_go
Lawo_fin:
    s_cmp_lg_u32 s43, 0
    s_cselect_b64 exec, 1, 0
    buffer_store_dword v3, v4, s[8:11], s43 offen sc1
    s_mov_b64 exec, -1
    s_mov_b32 s43, 0
    s_branch L_role_awo_exit
Lawo_pub:
    s_cmp_lg_u32 s43, 0
    s_cselect_b64 exec, 1, 0
    buffer_store_dword v3, v4, s[8:11], s43 offen sc1
    s_mov_b64 exec, -1
    s_mov_b32 s43, 0
Lawo_poll:
    s_mov_b32 s16, 0
Lawo_pl:
    buffer_load_dword v2, v1, s[8:11], s42 offen sc1
    s_add_u32 s16, s16, 1
    s_cmp_gt_u32 s16, 100000
    s_cbranch_scc1 L_role_awo_abort
    s_waitcnt vmcnt(0)
    v_cmp_eq_u32 vcc, 0, v2
    s_nop 0
    s_cbranch_vccz Lawo_pld
    s_sleep 2
    s_branch Lawo_pl
Lawo_pld:
    s_add_u32 m0, s59, 0
    s_add_u32 s47, s41, 0
    buffer_load_dwordx4 v0, s[8:11], s47 offen offset:0 lds
    buffer_load_dwordx4 v0, s[8:11], s47 offen offset:1024 lds
    buffer_load_dwordx4 v0, s[8:11], s47 offen offset:2048 lds
    buffer_load_dwordx4 v0, s[8:11], s47 offen offset:3072 lds
    s_add_u32 m0, s59, 4096
    s_add_u32 s47, s41, 4096
    buffer_load_dwordx4 v0, s[8:11], s47 offen offset:0 lds
    buffer_load_dwordx4 v0, s[8:11], s47 offen offset:1024 lds
    buffer_load_dwordx4 v0, s[8:11], s47 offen offset:2048 lds
    buffer_load_dwordx4 v0, s[8:11], s47 offen offset:3072 lds
    s_add_u32 m0, s59, 8192
    s_add_u32 s47, s41, 8192
    buffer_load_dwordx4 v0, s[8:11], s47 offen offset:0 lds
    s_mul_i32 s48, s36, 4718592
    s_mul_i32 s18, s37, 36864
    s_add_u32 s48, s48, s18
    s_add_u32 s48, s48, 6291456
    buffer_load_dwordx4 v[64:67], v14, s[8:11], s48 offen offset:0
    buffer_load_dwordx4 v[68:71], v14, s[8:11], s48 offen offset:1024
    s_waitcnt vmcnt(0)
    s_branch Lawo_go
L_role_awo_abort:
    s_waitcnt lgkmcnt(0)
    s_mov_b64 exec, -1
    v_mov_b32 v0, 60
    s_lshl_b32 s5, s3, 8
    s_or_b32 s5, s5, s4
    s_or_b32 s5, s5, 0x10000
    v_mov_b32 v1, s5
    global_store_dword v0, v1, s[12:13]
    s_endpgm
L_role_awo_exit:
    s_endpgm
.p2align 6
L_role_aq:
    v_and_b32 v5, 63, v0
    v_lshlrev_b32 v0, 4, v5
    v_and_b32 v7, 15, v5
    v_lshrrev_b32 v8, 4, v5
    v_min_u32 v1, 47, v5
    v_lshrrev_b32 v6, 2, v1
    v_and_b32 v1, 3, v1
    v_lshlrev_b32 v1, 2, v1
    v_lshl_add_u32 v1, v6, 7, v1
    v_mov_b32 v3, 1
    v_mov_b32 v4, 0
    s_mov_b32 s44, 0x05040100
    s_mov_b32 s45, 0x07060302
    s_lshr_b32 s63, s15, 4
    s_and_b32 s15, s15, 15
    s_lshl_b32 s50, s15, 1
    s_lshr_b32 s17, s14, 1
    s_add_u32 s50, s50, s17
    s_and_b32 s51, s14, 1
    s_mul_i32 s49, s50, 36
    s_cmp_eq_u32 s63, 0
    s_cbranch_scc1 Laq_noord
    s_cmp_lg_u32 s14, 0
    s_cbranch_scc1 Laq_ord_d
    v_mov_b32 v5, 48
    s_mov_b32 s16, 0
Laq_ord:
    global_load_dword v6, v5, s[12:13] sc1
    s_add_u32 s16, s16, 1
    s_cmp_gt_u32 s16, 100000
    s_cbranch_scc1 L_role_aq_abort
    s_waitcnt vmcnt(0)
    v_cmp_gt_u32 vcc, 1, v6
    s_nop 0
    s_cbranch_vccz Laq_ord_d
    s_sleep 64
    s_branch Laq_ord
Laq_ord_d:
    s_barrier
Laq_noord:
    s_load_dwordx2 s[20:21], s[0:1], 8
    s_mov_b32 s22, 1990656
    s_mov_b32 s23, 0x00020000
    s_waitcnt lgkmcnt(0)
    s_and_b32 s21, s21, 0xffff
    v_lshrrev_b32 v24, 4, v0
    v_add_u32 v24, 0, v24
    v_mul_u32_u24 v25, 4370, v24
    v_lshrrev_b32 v25, 16, v25
    v_mul_u32_u24 v26, 15, v25
    v_sub_u32 v24, v24, v26
    v_mul_u32_u24 v16, 3456, v25
    v_mul_u32_u24 v25, 13108, v24
    v_lshrrev_b32 v25, 16, v25
    v_mul_u32_u24 v26, 5, v25
    v_sub_u32 v24, v24, v26
    v_mul_u32_u24 v25, 1152, v25
    v_lshlrev_b32 v24, 4, v24
    v_add3_u32 v16, v16, v24, v25
    v_lshrrev_b32 v24, 4, v0
    v_add_u32 v24, 64, v24
    v_mul_u32_u24 v25, 4370, v24
    v_lshrrev_b32 v25, 16, v25
    v_mul_u32_u24 v26, 15, v25
    v_sub_u32 v24, v24, v26
    v_mul_u32_u24 v17, 3456, v25
    v_mul_u32_u24 v25, 13108, v24
    v_lshrrev_b32 v25, 16, v25
    v_mul_u32_u24 v26, 5, v25
    v_sub_u32 v24, v24, v26
    v_mul_u32_u24 v25, 1152, v25
    v_lshlrev_b32 v24, 4, v24
    v_add3_u32 v17, v17, v24, v25
    s_mul_i32 s49, s15, 72
    s_and_b32 s48, s49, 15
    s_and_b32 s49, s49, -16
    s_mul_i32 s17, s14, 27648
    s_add_u32 s49, s49, s17
    s_mul_i32 s46, s14, 1920
    s_mov_b32 s54, -1
    s_mov_b32 s55, 0x00ffffff
    s_add_u32 s17, s49, 0
    s_add_u32 m0, s46, 0
    s_nop 0
    buffer_load_dwordx4 v16, s[20:23], s17 offen lds
    s_add_u32 m0, s46, 1024
    s_mov_b64 exec, s[54:55]
    buffer_load_dwordx4 v17, s[20:23], s17 offen lds
    s_mov_b64 exec, -1
    s_add_u32 s17, s49, 110592
    s_add_u32 m0, s46, 7680
    s_nop 0
    buffer_load_dwordx4 v16, s[20:23], s17 offen lds
    s_add_u32 m0, s46, 8704
    s_mov_b64 exec, s[54:55]
    buffer_load_dwordx4 v17, s[20:23], s17 offen lds
    s_mov_b64 exec, -1
    s_add_u32 s17, s49, 221184
    s_add_u32 m0, s46, 15360
    s_nop 0
    buffer_load_dwordx4 v16, s[20:23], s17 offen lds
    s_add_u32 m0, s46, 16384
    s_mov_b64 exec, s[54:55]
    buffer_load_dwordx4 v17, s[20:23], s17 offen lds
    s_mov_b64 exec, -1
    s_add_u32 s17, s49, 331776
    s_add_u32 m0, s46, 23040
    s_nop 0
    buffer_load_dwordx4 v16, s[20:23], s17 offen lds
    s_add_u32 m0, s46, 24064
    s_mov_b64 exec, s[54:55]
    buffer_load_dwordx4 v17, s[20:23], s17 offen lds
    s_mov_b64 exec, -1
    s_add_u32 s17, s49, 442368
    s_add_u32 m0, s46, 30720
    s_nop 0
    buffer_load_dwordx4 v16, s[20:23], s17 offen lds
    s_add_u32 m0, s46, 31744
    s_mov_b64 exec, s[54:55]
    buffer_load_dwordx4 v17, s[20:23], s17 offen lds
    s_mov_b64 exec, -1
    s_add_u32 s17, s49, 552960
    s_add_u32 m0, s46, 38400
    s_nop 0
    buffer_load_dwordx4 v16, s[20:23], s17 offen lds
    s_add_u32 m0, s46, 39424
    s_mov_b64 exec, s[54:55]
    buffer_load_dwordx4 v17, s[20:23], s17 offen lds
    s_mov_b64 exec, -1
    s_add_u32 s17, s49, 663552
    s_add_u32 m0, s46, 46080
    s_nop 0
    buffer_load_dwordx4 v16, s[20:23], s17 offen lds
    s_add_u32 m0, s46, 47104
    s_mov_b64 exec, s[54:55]
    buffer_load_dwordx4 v17, s[20:23], s17 offen lds
    s_mov_b64 exec, -1
    s_add_u32 s17, s49, 774144
    s_add_u32 m0, s46, 53760
    s_nop 0
    buffer_load_dwordx4 v16, s[20:23], s17 offen lds
    s_add_u32 m0, s46, 54784
    s_mov_b64 exec, s[54:55]
    buffer_load_dwordx4 v17, s[20:23], s17 offen lds
    s_mov_b64 exec, -1
    s_add_u32 s17, s49, 884736
    s_add_u32 m0, s46, 61440
    s_nop 0
    buffer_load_dwordx4 v16, s[20:23], s17 offen lds
    s_add_u32 m0, s46, 62464
    s_mov_b64 exec, s[54:55]
    buffer_load_dwordx4 v17, s[20:23], s17 offen lds
    s_mov_b64 exec, -1
    s_add_u32 s17, s49, 995328
    s_add_u32 m0, s46, 69120
    s_nop 0
    buffer_load_dwordx4 v16, s[20:23], s17 offen lds
    s_add_u32 m0, s46, 70144
    s_mov_b64 exec, s[54:55]
    buffer_load_dwordx4 v17, s[20:23], s17 offen lds
    s_mov_b64 exec, -1
    s_add_u32 s17, s49, 1105920
    s_add_u32 m0, s46, 76800
    s_nop 0
    buffer_load_dwordx4 v16, s[20:23], s17 offen lds
    s_add_u32 m0, s46, 77824
    s_mov_b64 exec, s[54:55]
    buffer_load_dwordx4 v17, s[20:23], s17 offen lds
    s_mov_b64 exec, -1
    s_add_u32 s17, s49, 1216512
    s_add_u32 m0, s46, 84480
    s_nop 0
    buffer_load_dwordx4 v16, s[20:23], s17 offen lds
    s_add_u32 m0, s46, 85504
    s_mov_b64 exec, s[54:55]
    buffer_load_dwordx4 v17, s[20:23], s17 offen lds
    s_mov_b64 exec, -1
    s_lshr_b32 s47, s14, 1
    s_mul_i32 s17, s47, 40
    s_add_u32 s17, s17, s48
    s_mul_i32 s18, s47, 4
    s_add_u32 s18, s18, s48
    s_add_u32 s18, s18, 32
    s_lshl_b32 s19, s47, 4
    s_add_u32 s19, s19, 138240
    v_lshrrev_b32 v5, 2, v7
    v_lshl_add_u32 v5, v8, 3, v5
    v_and_b32 v6, 3, v7
    v_mul_u32_u24 v19, 240, v5
    v_add_u32 v19, s17, v19
    v_lshl_add_u32 v19, v6, 3, v19
    v_lshlrev_b32 v20, 5, v5
    v_add_u32 v20, s19, v20
    v_mov_b32 v22, 156672
    v_cmp_eq_u32 vcc, 0, v6
    s_nop 1
    v_cndmask_b32 v20, v22, v20, vcc
    v_cndmask_b32 v21, 0, -1, vcc
    v_bfe_u32 v5, v0, 4, 5
    v_mul_u32_u24 v23, 240, v5
    v_add_u32 v23, s18, v23
    v_lshlrev_b32 v28, 5, v5
    v_add_u32 v28, s19, v28
    v_mov_b32 v24, 0
    v_mov_b32 v25, 0
    v_mov_b32 v26, 0
    v_mov_b32 v27, 0
    v_lshlrev_b32 v22, 4, v7
    v_add_u32 v22, 156672, v22
    ds_write_b128 v22, v[24:27]
    v_mov_b32 v104, 0x3f803f80
    v_mov_b32 v105, 0x3f803f80
    v_mov_b32 v106, 0x3f803f80
    v_mov_b32 v107, 0x3f803f80
    s_waitcnt vmcnt(12) lgkmcnt(0)
    s_barrier
    v_add_u32 v60, 0, v23
    v_mov_b32 v59, 0
    ds_read_b32 v56, v60
    ds_read_b32 v57, v60 offset:80
    ds_read_b32 v58, v60 offset:160
    v_add_u32 v68, 7680, v23
    v_mov_b32 v67, 0
    ds_read_b32 v64, v68
    ds_read_b32 v65, v68 offset:80
    ds_read_b32 v66, v68 offset:160
    v_add_u32 v76, 15360, v23
    v_mov_b32 v75, 0
    ds_read_b32 v72, v76
    ds_read_b32 v73, v76 offset:80
    ds_read_b32 v74, v76 offset:160
    v_add_u32 v84, 23040, v23
    v_mov_b32 v83, 0
    ds_read_b32 v80, v84
    ds_read_b32 v81, v84 offset:80
    ds_read_b32 v82, v84 offset:160
    v_add_u32 v92, 30720, v23
    v_mov_b32 v91, 0
    ds_read_b32 v88, v92
    ds_read_b32 v89, v92 offset:80
    ds_read_b32 v90, v92 offset:160
    v_add_u32 v100, 38400, v23
    v_mov_b32 v99, 0
    ds_read_b32 v96, v100
    ds_read_b32 v97, v100 offset:80
    ds_read_b32 v98, v100 offset:160
    v_add_u32 v61, 0, v19
    ds_read_b64_tr_b16 v[152:153], v61 offset:0
    ds_read_b64_tr_b16 v[224:225], v61 offset:80
    ds_read_b64_tr_b16 a[112:113], v61 offset:160
    ds_read_b64_tr_b16 v[154:155], v61 offset:960
    ds_read_b64_tr_b16 v[226:227], v61 offset:1040
    ds_read_b64_tr_b16 a[114:115], v61 offset:1120
    v_add_u32 v69, 7680, v19
    ds_read_b64_tr_b16 v[156:157], v69 offset:0
    ds_read_b64_tr_b16 v[228:229], v69 offset:80
    ds_read_b64_tr_b16 a[116:117], v69 offset:160
    ds_read_b64_tr_b16 v[158:159], v69 offset:960
    ds_read_b64_tr_b16 v[230:231], v69 offset:1040
    ds_read_b64_tr_b16 a[118:119], v69 offset:1120
    v_add_u32 v77, 15360, v19
    ds_read_b64_tr_b16 v[160:161], v77 offset:0
    ds_read_b64_tr_b16 v[232:233], v77 offset:80
    ds_read_b64_tr_b16 a[120:121], v77 offset:160
    ds_read_b64_tr_b16 v[162:163], v77 offset:960
    ds_read_b64_tr_b16 v[234:235], v77 offset:1040
    ds_read_b64_tr_b16 a[122:123], v77 offset:1120
    v_add_u32 v85, 23040, v19
    ds_read_b64_tr_b16 v[164:165], v85 offset:0
    ds_read_b64_tr_b16 v[236:237], v85 offset:80
    ds_read_b64_tr_b16 a[124:125], v85 offset:160
    ds_read_b64_tr_b16 v[166:167], v85 offset:960
    ds_read_b64_tr_b16 v[238:239], v85 offset:1040
    ds_read_b64_tr_b16 a[126:127], v85 offset:1120
    v_add_u32 v93, 30720, v19
    ds_read_b64_tr_b16 v[168:169], v93 offset:0
    ds_read_b64_tr_b16 v[240:241], v93 offset:80
    ds_read_b64_tr_b16 a[128:129], v93 offset:160
    ds_read_b64_tr_b16 v[170:171], v93 offset:960
    ds_read_b64_tr_b16 v[242:243], v93 offset:1040
    ds_read_b64_tr_b16 a[130:131], v93 offset:1120
    v_add_u32 v101, 38400, v19
    ds_read_b64_tr_b16 v[172:173], v101 offset:0
    ds_read_b64_tr_b16 v[244:245], v101 offset:80
    ds_read_b64_tr_b16 a[132:133], v101 offset:160
    ds_read_b64_tr_b16 v[174:175], v101 offset:960
    ds_read_b64_tr_b16 v[246:247], v101 offset:1040
    ds_read_b64_tr_b16 a[134:135], v101 offset:1120
    s_waitcnt lgkmcnt(15)
    ds_write_b64 v28, v[56:57] offset:0
    ds_write_b64 v28, v[58:59] offset:8
    ds_write_b64 v28, v[64:65] offset:1024
    ds_write_b64 v28, v[66:67] offset:1032
    ds_write_b64 v28, v[72:73] offset:2048
    ds_write_b64 v28, v[74:75] offset:2056
    ds_write_b64 v28, v[80:81] offset:3072
    ds_write_b64 v28, v[82:83] offset:3080
    ds_write_b64 v28, v[88:89] offset:4096
    ds_write_b64 v28, v[90:91] offset:4104
    ds_write_b64 v28, v[96:97] offset:5120
    ds_write_b64 v28, v[98:99] offset:5128
    s_waitcnt lgkmcnt(0)
    v_and_b32 v56, 0, v21
    v_add_u32 v56, v56, v20
    ds_read_b64_tr_b16 a[40:41], v56 offset:0
    ds_read_b64_tr_b16 a[42:43], v56 offset:128
    v_and_b32 v57, 8, v21
    v_add_u32 v57, v57, v20
    ds_read_b64_tr_b16 a[184:185], v57 offset:0
    ds_read_b64_tr_b16 a[186:187], v57 offset:128
    v_and_b32 v64, 1024, v21
    v_add_u32 v64, v64, v20
    ds_read_b64_tr_b16 a[44:45], v64 offset:0
    ds_read_b64_tr_b16 a[46:47], v64 offset:128
    v_and_b32 v65, 1032, v21
    v_add_u32 v65, v65, v20
    ds_read_b64_tr_b16 a[188:189], v65 offset:0
    ds_read_b64_tr_b16 a[190:191], v65 offset:128
    v_and_b32 v72, 2048, v21
    v_add_u32 v72, v72, v20
    ds_read_b64_tr_b16 a[48:49], v72 offset:0
    ds_read_b64_tr_b16 a[50:51], v72 offset:128
    v_and_b32 v73, 2056, v21
    v_add_u32 v73, v73, v20
    ds_read_b64_tr_b16 a[192:193], v73 offset:0
    ds_read_b64_tr_b16 a[194:195], v73 offset:128
    v_and_b32 v80, 3072, v21
    v_add_u32 v80, v80, v20
    ds_read_b64_tr_b16 a[52:53], v80 offset:0
    ds_read_b64_tr_b16 a[54:55], v80 offset:128
    v_and_b32 v81, 3080, v21
    v_add_u32 v81, v81, v20
    ds_read_b64_tr_b16 a[196:197], v81 offset:0
    ds_read_b64_tr_b16 a[198:199], v81 offset:128
    v_and_b32 v88, 4096, v21
    v_add_u32 v88, v88, v20
    ds_read_b64_tr_b16 a[56:57], v88 offset:0
    ds_read_b64_tr_b16 a[58:59], v88 offset:128
    v_and_b32 v89, 4104, v21
    v_add_u32 v89, v89, v20
    ds_read_b64_tr_b16 a[200:201], v89 offset:0
    ds_read_b64_tr_b16 a[202:203], v89 offset:128
    v_and_b32 v96, 5120, v21
    v_add_u32 v96, v96, v20
    ds_read_b64_tr_b16 a[60:61], v96 offset:0
    ds_read_b64_tr_b16 a[62:63], v96 offset:128
    v_and_b32 v97, 5128, v21
    v_add_u32 v97, v97, v20
    ds_read_b64_tr_b16 a[204:205], v97 offset:0
    ds_read_b64_tr_b16 a[206:207], v97 offset:128
    s_waitcnt lgkmcnt(0)
    s_add_u32 s17, s49, 1327104
    s_add_u32 m0, s46, 92160
    s_nop 0
    buffer_load_dwordx4 v16, s[20:23], s17 offen lds
    s_add_u32 m0, s46, 93184
    s_mov_b64 exec, s[54:55]
    buffer_load_dwordx4 v17, s[20:23], s17 offen lds
    s_mov_b64 exec, -1
    s_add_u32 s17, s49, 1437696
    s_add_u32 m0, s46, 99840
    s_nop 0
    buffer_load_dwordx4 v16, s[20:23], s17 offen lds
    s_add_u32 m0, s46, 100864
    s_mov_b64 exec, s[54:55]
    buffer_load_dwordx4 v17, s[20:23], s17 offen lds
    s_mov_b64 exec, -1
    s_add_u32 s17, s49, 1548288
    s_add_u32 m0, s46, 107520
    s_nop 0
    buffer_load_dwordx4 v16, s[20:23], s17 offen lds
    s_add_u32 m0, s46, 108544
    s_mov_b64 exec, s[54:55]
    buffer_load_dwordx4 v17, s[20:23], s17 offen lds
    s_mov_b64 exec, -1
    s_add_u32 s17, s49, 1658880
    s_add_u32 m0, s46, 115200
    s_nop 0
    buffer_load_dwordx4 v16, s[20:23], s17 offen lds
    s_add_u32 m0, s46, 116224
    s_mov_b64 exec, s[54:55]
    buffer_load_dwordx4 v17, s[20:23], s17 offen lds
    s_mov_b64 exec, -1
    s_add_u32 s17, s49, 1769472
    s_add_u32 m0, s46, 122880
    s_nop 0
    buffer_load_dwordx4 v16, s[20:23], s17 offen lds
    s_add_u32 m0, s46, 123904
    s_mov_b64 exec, s[54:55]
    buffer_load_dwordx4 v17, s[20:23], s17 offen lds
    s_mov_b64 exec, -1
    s_add_u32 s17, s49, 1880064
    s_add_u32 m0, s46, 130560
    s_nop 0
    buffer_load_dwordx4 v16, s[20:23], s17 offen lds
    s_add_u32 m0, s46, 131584
    s_mov_b64 exec, s[54:55]
    buffer_load_dwordx4 v17, s[20:23], s17 offen lds
    s_mov_b64 exec, -1
    v_mfma_f32_16x16x32_bf16 v[36:39], v[152:155], v[104:107], 0
    v_mfma_f32_16x16x32_bf16 v[40:43], v[224:227], v[104:107], 0
    v_mfma_f32_16x16x32_bf16 v[44:47], a[40:43], v[104:107], 0
    v_mfma_f32_16x16x32_bf16 v[48:51], v[104:107], a[112:115], 0
    v_mfma_f32_16x16x32_bf16 v[52:55], v[104:107], a[184:187], 0
    v_mfma_f32_16x16x32_bf16 v[36:39], v[156:159], v[104:107], v[36:39]
    v_mfma_f32_16x16x32_bf16 v[40:43], v[228:231], v[104:107], v[40:43]
    v_mfma_f32_16x16x32_bf16 v[44:47], a[44:47], v[104:107], v[44:47]
    v_mfma_f32_16x16x32_bf16 v[48:51], v[104:107], a[116:119], v[48:51]
    v_mfma_f32_16x16x32_bf16 v[52:55], v[104:107], a[188:191], v[52:55]
    v_mfma_f32_16x16x32_bf16 v[36:39], v[160:163], v[104:107], v[36:39]
    v_mfma_f32_16x16x32_bf16 v[40:43], v[232:235], v[104:107], v[40:43]
    v_mfma_f32_16x16x32_bf16 v[44:47], a[48:51], v[104:107], v[44:47]
    v_mfma_f32_16x16x32_bf16 v[48:51], v[104:107], a[120:123], v[48:51]
    v_mfma_f32_16x16x32_bf16 v[52:55], v[104:107], a[192:195], v[52:55]
    v_mfma_f32_16x16x32_bf16 v[36:39], v[164:167], v[104:107], v[36:39]
    v_mfma_f32_16x16x32_bf16 v[40:43], v[236:239], v[104:107], v[40:43]
    v_mfma_f32_16x16x32_bf16 v[44:47], a[52:55], v[104:107], v[44:47]
    v_mfma_f32_16x16x32_bf16 v[48:51], v[104:107], a[124:127], v[48:51]
    v_mfma_f32_16x16x32_bf16 v[52:55], v[104:107], a[196:199], v[52:55]
    v_mfma_f32_16x16x32_bf16 v[36:39], v[168:171], v[104:107], v[36:39]
    v_mfma_f32_16x16x32_bf16 v[40:43], v[240:243], v[104:107], v[40:43]
    v_mfma_f32_16x16x32_bf16 v[44:47], a[56:59], v[104:107], v[44:47]
    v_mfma_f32_16x16x32_bf16 v[48:51], v[104:107], a[128:131], v[48:51]
    v_mfma_f32_16x16x32_bf16 v[52:55], v[104:107], a[200:203], v[52:55]
    v_mfma_f32_16x16x32_bf16 v[36:39], v[172:175], v[104:107], v[36:39]
    v_mfma_f32_16x16x32_bf16 v[40:43], v[244:247], v[104:107], v[40:43]
    v_mfma_f32_16x16x32_bf16 v[44:47], a[60:63], v[104:107], v[44:47]
    v_mfma_f32_16x16x32_bf16 v[48:51], v[104:107], a[132:135], v[48:51]
    v_mfma_f32_16x16x32_bf16 v[52:55], v[104:107], a[204:207], v[52:55]
    s_waitcnt vmcnt(12)
    s_barrier
    v_add_u32 v60, 46080, v23
    v_mov_b32 v59, 0
    ds_read_b32 v56, v60
    ds_read_b32 v57, v60 offset:80
    ds_read_b32 v58, v60 offset:160
    v_add_u32 v68, 53760, v23
    v_mov_b32 v67, 0
    ds_read_b32 v64, v68
    ds_read_b32 v65, v68 offset:80
    ds_read_b32 v66, v68 offset:160
    v_add_u32 v76, 61440, v23
    v_mov_b32 v75, 0
    ds_read_b32 v72, v76
    ds_read_b32 v73, v76 offset:80
    ds_read_b32 v74, v76 offset:160
    v_add_u32 v84, 69120, v23
    v_mov_b32 v83, 0
    ds_read_b32 v80, v84
    ds_read_b32 v81, v84 offset:80
    ds_read_b32 v82, v84 offset:160
    v_add_u32 v92, 76800, v23
    v_mov_b32 v91, 0
    ds_read_b32 v88, v92
    ds_read_b32 v89, v92 offset:80
    ds_read_b32 v90, v92 offset:160
    v_add_u32 v100, 84480, v23
    v_mov_b32 v99, 0
    ds_read_b32 v96, v100
    ds_read_b32 v97, v100 offset:80
    ds_read_b32 v98, v100 offset:160
    v_add_u32 v61, 46080, v19
    ds_read_b64_tr_b16 v[176:177], v61 offset:0
    ds_read_b64_tr_b16 v[248:249], v61 offset:80
    ds_read_b64_tr_b16 a[136:137], v61 offset:160
    ds_read_b64_tr_b16 v[178:179], v61 offset:960
    ds_read_b64_tr_b16 v[250:251], v61 offset:1040
    ds_read_b64_tr_b16 a[138:139], v61 offset:1120
    v_add_u32 v69, 53760, v19
    ds_read_b64_tr_b16 v[180:181], v69 offset:0
    ds_read_b64_tr_b16 v[252:253], v69 offset:80
    ds_read_b64_tr_b16 a[140:141], v69 offset:160
    ds_read_b64_tr_b16 v[182:183], v69 offset:960
    ds_read_b64_tr_b16 v[254:255], v69 offset:1040
    ds_read_b64_tr_b16 a[142:143], v69 offset:1120
    v_add_u32 v77, 61440, v19
    ds_read_b64_tr_b16 v[184:185], v77 offset:0
    ds_read_b64_tr_b16 a[0:1], v77 offset:80
    ds_read_b64_tr_b16 a[144:145], v77 offset:160
    ds_read_b64_tr_b16 v[186:187], v77 offset:960
    ds_read_b64_tr_b16 a[2:3], v77 offset:1040
    ds_read_b64_tr_b16 a[146:147], v77 offset:1120
    v_add_u32 v85, 69120, v19
    ds_read_b64_tr_b16 v[188:189], v85 offset:0
    ds_read_b64_tr_b16 a[4:5], v85 offset:80
    ds_read_b64_tr_b16 a[148:149], v85 offset:160
    ds_read_b64_tr_b16 v[190:191], v85 offset:960
    ds_read_b64_tr_b16 a[6:7], v85 offset:1040
    ds_read_b64_tr_b16 a[150:151], v85 offset:1120
    v_add_u32 v93, 76800, v19
    ds_read_b64_tr_b16 v[192:193], v93 offset:0
    ds_read_b64_tr_b16 a[8:9], v93 offset:80
    ds_read_b64_tr_b16 a[152:153], v93 offset:160
    ds_read_b64_tr_b16 v[194:195], v93 offset:960
    ds_read_b64_tr_b16 a[10:11], v93 offset:1040
    ds_read_b64_tr_b16 a[154:155], v93 offset:1120
    v_add_u32 v101, 84480, v19
    ds_read_b64_tr_b16 v[196:197], v101 offset:0
    ds_read_b64_tr_b16 a[12:13], v101 offset:80
    ds_read_b64_tr_b16 a[156:157], v101 offset:160
    ds_read_b64_tr_b16 v[198:199], v101 offset:960
    ds_read_b64_tr_b16 a[14:15], v101 offset:1040
    ds_read_b64_tr_b16 a[158:159], v101 offset:1120
    s_waitcnt lgkmcnt(15)
    ds_write_b64 v28, v[56:57] offset:6144
    ds_write_b64 v28, v[58:59] offset:6152
    ds_write_b64 v28, v[64:65] offset:7168
    ds_write_b64 v28, v[66:67] offset:7176
    ds_write_b64 v28, v[72:73] offset:8192
    ds_write_b64 v28, v[74:75] offset:8200
    ds_write_b64 v28, v[80:81] offset:9216
    ds_write_b64 v28, v[82:83] offset:9224
    ds_write_b64 v28, v[88:89] offset:10240
    ds_write_b64 v28, v[90:91] offset:10248
    ds_write_b64 v28, v[96:97] offset:11264
    ds_write_b64 v28, v[98:99] offset:11272
    s_waitcnt lgkmcnt(0)
    v_and_b32 v56, 6144, v21
    v_add_u32 v56, v56, v20
    ds_read_b64_tr_b16 a[64:65], v56 offset:0
    ds_read_b64_tr_b16 a[66:67], v56 offset:128
    v_and_b32 v57, 6152, v21
    v_add_u32 v57, v57, v20
    ds_read_b64_tr_b16 a[208:209], v57 offset:0
    ds_read_b64_tr_b16 a[210:211], v57 offset:128
    v_and_b32 v64, 7168, v21
    v_add_u32 v64, v64, v20
    ds_read_b64_tr_b16 a[68:69], v64 offset:0
    ds_read_b64_tr_b16 a[70:71], v64 offset:128
    v_and_b32 v65, 7176, v21
    v_add_u32 v65, v65, v20
    ds_read_b64_tr_b16 a[212:213], v65 offset:0
    ds_read_b64_tr_b16 a[214:215], v65 offset:128
    v_and_b32 v72, 8192, v21
    v_add_u32 v72, v72, v20
    ds_read_b64_tr_b16 a[72:73], v72 offset:0
    ds_read_b64_tr_b16 a[74:75], v72 offset:128
    v_and_b32 v73, 8200, v21
    v_add_u32 v73, v73, v20
    ds_read_b64_tr_b16 a[216:217], v73 offset:0
    ds_read_b64_tr_b16 a[218:219], v73 offset:128
    v_and_b32 v80, 9216, v21
    v_add_u32 v80, v80, v20
    ds_read_b64_tr_b16 a[76:77], v80 offset:0
    ds_read_b64_tr_b16 a[78:79], v80 offset:128
    v_and_b32 v81, 9224, v21
    v_add_u32 v81, v81, v20
    ds_read_b64_tr_b16 a[220:221], v81 offset:0
    ds_read_b64_tr_b16 a[222:223], v81 offset:128
    v_and_b32 v88, 10240, v21
    v_add_u32 v88, v88, v20
    ds_read_b64_tr_b16 a[80:81], v88 offset:0
    ds_read_b64_tr_b16 a[82:83], v88 offset:128
    v_and_b32 v89, 10248, v21
    v_add_u32 v89, v89, v20
    ds_read_b64_tr_b16 a[224:225], v89 offset:0
    ds_read_b64_tr_b16 a[226:227], v89 offset:128
    v_and_b32 v96, 11264, v21
    v_add_u32 v96, v96, v20
    ds_read_b64_tr_b16 a[84:85], v96 offset:0
    ds_read_b64_tr_b16 a[86:87], v96 offset:128
    v_and_b32 v97, 11272, v21
    v_add_u32 v97, v97, v20
    ds_read_b64_tr_b16 a[228:229], v97 offset:0
    ds_read_b64_tr_b16 a[230:231], v97 offset:128
    s_waitcnt lgkmcnt(0)
    v_mfma_f32_16x16x32_bf16 v[36:39], v[176:179], v[104:107], v[36:39]
    v_mfma_f32_16x16x32_bf16 v[40:43], v[248:251], v[104:107], v[40:43]
    v_mfma_f32_16x16x32_bf16 v[44:47], a[64:67], v[104:107], v[44:47]
    v_mfma_f32_16x16x32_bf16 v[48:51], v[104:107], a[136:139], v[48:51]
    v_mfma_f32_16x16x32_bf16 v[52:55], v[104:107], a[208:211], v[52:55]
    v_mfma_f32_16x16x32_bf16 v[36:39], v[180:183], v[104:107], v[36:39]
    v_mfma_f32_16x16x32_bf16 v[40:43], v[252:255], v[104:107], v[40:43]
    v_mfma_f32_16x16x32_bf16 v[44:47], a[68:71], v[104:107], v[44:47]
    v_mfma_f32_16x16x32_bf16 v[48:51], v[104:107], a[140:143], v[48:51]
    v_mfma_f32_16x16x32_bf16 v[52:55], v[104:107], a[212:215], v[52:55]
    v_mfma_f32_16x16x32_bf16 v[36:39], v[184:187], v[104:107], v[36:39]
    v_mfma_f32_16x16x32_bf16 v[40:43], a[0:3], v[104:107], v[40:43]
    v_mfma_f32_16x16x32_bf16 v[44:47], a[72:75], v[104:107], v[44:47]
    v_mfma_f32_16x16x32_bf16 v[48:51], v[104:107], a[144:147], v[48:51]
    v_mfma_f32_16x16x32_bf16 v[52:55], v[104:107], a[216:219], v[52:55]
    v_mfma_f32_16x16x32_bf16 v[36:39], v[188:191], v[104:107], v[36:39]
    v_mfma_f32_16x16x32_bf16 v[40:43], a[4:7], v[104:107], v[40:43]
    v_mfma_f32_16x16x32_bf16 v[44:47], a[76:79], v[104:107], v[44:47]
    v_mfma_f32_16x16x32_bf16 v[48:51], v[104:107], a[148:151], v[48:51]
    v_mfma_f32_16x16x32_bf16 v[52:55], v[104:107], a[220:223], v[52:55]
    v_mfma_f32_16x16x32_bf16 v[36:39], v[192:195], v[104:107], v[36:39]
    v_mfma_f32_16x16x32_bf16 v[40:43], a[8:11], v[104:107], v[40:43]
    v_mfma_f32_16x16x32_bf16 v[44:47], a[80:83], v[104:107], v[44:47]
    v_mfma_f32_16x16x32_bf16 v[48:51], v[104:107], a[152:155], v[48:51]
    v_mfma_f32_16x16x32_bf16 v[52:55], v[104:107], a[224:227], v[52:55]
    v_mfma_f32_16x16x32_bf16 v[36:39], v[196:199], v[104:107], v[36:39]
    v_mfma_f32_16x16x32_bf16 v[40:43], a[12:15], v[104:107], v[40:43]
    v_mfma_f32_16x16x32_bf16 v[44:47], a[84:87], v[104:107], v[44:47]
    v_mfma_f32_16x16x32_bf16 v[48:51], v[104:107], a[156:159], v[48:51]
    v_mfma_f32_16x16x32_bf16 v[52:55], v[104:107], a[228:231], v[52:55]
    s_waitcnt vmcnt(0)
    s_barrier
    v_add_u32 v60, 92160, v23
    v_mov_b32 v59, 0
    ds_read_b32 v56, v60
    ds_read_b32 v57, v60 offset:80
    ds_read_b32 v58, v60 offset:160
    v_add_u32 v68, 99840, v23
    v_mov_b32 v67, 0
    ds_read_b32 v64, v68
    ds_read_b32 v65, v68 offset:80
    ds_read_b32 v66, v68 offset:160
    v_add_u32 v76, 107520, v23
    v_mov_b32 v75, 0
    ds_read_b32 v72, v76
    ds_read_b32 v73, v76 offset:80
    ds_read_b32 v74, v76 offset:160
    v_add_u32 v84, 115200, v23
    v_mov_b32 v83, 0
    ds_read_b32 v80, v84
    ds_read_b32 v81, v84 offset:80
    ds_read_b32 v82, v84 offset:160
    v_add_u32 v92, 122880, v23
    v_mov_b32 v91, 0
    ds_read_b32 v88, v92
    ds_read_b32 v89, v92 offset:80
    ds_read_b32 v90, v92 offset:160
    v_add_u32 v100, 130560, v23
    v_mov_b32 v99, 0
    ds_read_b32 v96, v100
    ds_read_b32 v97, v100 offset:80
    ds_read_b32 v98, v100 offset:160
    v_add_u32 v61, 92160, v19
    ds_read_b64_tr_b16 v[200:201], v61 offset:0
    ds_read_b64_tr_b16 a[16:17], v61 offset:80
    ds_read_b64_tr_b16 a[160:161], v61 offset:160
    ds_read_b64_tr_b16 v[202:203], v61 offset:960
    ds_read_b64_tr_b16 a[18:19], v61 offset:1040
    ds_read_b64_tr_b16 a[162:163], v61 offset:1120
    v_add_u32 v69, 99840, v19
    ds_read_b64_tr_b16 v[204:205], v69 offset:0
    ds_read_b64_tr_b16 a[20:21], v69 offset:80
    ds_read_b64_tr_b16 a[164:165], v69 offset:160
    ds_read_b64_tr_b16 v[206:207], v69 offset:960
    ds_read_b64_tr_b16 a[22:23], v69 offset:1040
    ds_read_b64_tr_b16 a[166:167], v69 offset:1120
    v_add_u32 v77, 107520, v19
    ds_read_b64_tr_b16 v[208:209], v77 offset:0
    ds_read_b64_tr_b16 a[24:25], v77 offset:80
    ds_read_b64_tr_b16 a[168:169], v77 offset:160
    ds_read_b64_tr_b16 v[210:211], v77 offset:960
    ds_read_b64_tr_b16 a[26:27], v77 offset:1040
    ds_read_b64_tr_b16 a[170:171], v77 offset:1120
    v_add_u32 v85, 115200, v19
    ds_read_b64_tr_b16 v[212:213], v85 offset:0
    ds_read_b64_tr_b16 a[28:29], v85 offset:80
    ds_read_b64_tr_b16 a[172:173], v85 offset:160
    ds_read_b64_tr_b16 v[214:215], v85 offset:960
    ds_read_b64_tr_b16 a[30:31], v85 offset:1040
    ds_read_b64_tr_b16 a[174:175], v85 offset:1120
    v_add_u32 v93, 122880, v19
    ds_read_b64_tr_b16 v[216:217], v93 offset:0
    ds_read_b64_tr_b16 a[32:33], v93 offset:80
    ds_read_b64_tr_b16 a[176:177], v93 offset:160
    ds_read_b64_tr_b16 v[218:219], v93 offset:960
    ds_read_b64_tr_b16 a[34:35], v93 offset:1040
    ds_read_b64_tr_b16 a[178:179], v93 offset:1120
    v_add_u32 v101, 130560, v19
    ds_read_b64_tr_b16 v[220:221], v101 offset:0
    ds_read_b64_tr_b16 a[36:37], v101 offset:80
    ds_read_b64_tr_b16 a[180:181], v101 offset:160
    ds_read_b64_tr_b16 v[222:223], v101 offset:960
    ds_read_b64_tr_b16 a[38:39], v101 offset:1040
    ds_read_b64_tr_b16 a[182:183], v101 offset:1120
    s_waitcnt lgkmcnt(15)
    ds_write_b64 v28, v[56:57] offset:12288
    ds_write_b64 v28, v[58:59] offset:12296
    ds_write_b64 v28, v[64:65] offset:13312
    ds_write_b64 v28, v[66:67] offset:13320
    ds_write_b64 v28, v[72:73] offset:14336
    ds_write_b64 v28, v[74:75] offset:14344
    ds_write_b64 v28, v[80:81] offset:15360
    ds_write_b64 v28, v[82:83] offset:15368
    ds_write_b64 v28, v[88:89] offset:16384
    ds_write_b64 v28, v[90:91] offset:16392
    ds_write_b64 v28, v[96:97] offset:17408
    ds_write_b64 v28, v[98:99] offset:17416
    s_waitcnt lgkmcnt(0)
    v_and_b32 v56, 12288, v21
    v_add_u32 v56, v56, v20
    ds_read_b64_tr_b16 a[88:89], v56 offset:0
    ds_read_b64_tr_b16 a[90:91], v56 offset:128
    v_and_b32 v57, 12296, v21
    v_add_u32 v57, v57, v20
    ds_read_b64_tr_b16 a[232:233], v57 offset:0
    ds_read_b64_tr_b16 a[234:235], v57 offset:128
    v_and_b32 v64, 13312, v21
    v_add_u32 v64, v64, v20
    ds_read_b64_tr_b16 a[92:93], v64 offset:0
    ds_read_b64_tr_b16 a[94:95], v64 offset:128
    v_and_b32 v65, 13320, v21
    v_add_u32 v65, v65, v20
    ds_read_b64_tr_b16 a[236:237], v65 offset:0
    ds_read_b64_tr_b16 a[238:239], v65 offset:128
    v_and_b32 v72, 14336, v21
    v_add_u32 v72, v72, v20
    ds_read_b64_tr_b16 a[96:97], v72 offset:0
    ds_read_b64_tr_b16 a[98:99], v72 offset:128
    v_and_b32 v73, 14344, v21
    v_add_u32 v73, v73, v20
    ds_read_b64_tr_b16 a[240:241], v73 offset:0
    ds_read_b64_tr_b16 a[242:243], v73 offset:128
    v_and_b32 v80, 15360, v21
    v_add_u32 v80, v80, v20
    ds_read_b64_tr_b16 a[100:101], v80 offset:0
    ds_read_b64_tr_b16 a[102:103], v80 offset:128
    v_and_b32 v81, 15368, v21
    v_add_u32 v81, v81, v20
    ds_read_b64_tr_b16 a[244:245], v81 offset:0
    ds_read_b64_tr_b16 a[246:247], v81 offset:128
    v_and_b32 v88, 16384, v21
    v_add_u32 v88, v88, v20
    ds_read_b64_tr_b16 a[104:105], v88 offset:0
    ds_read_b64_tr_b16 a[106:107], v88 offset:128
    v_and_b32 v89, 16392, v21
    v_add_u32 v89, v89, v20
    ds_read_b64_tr_b16 a[248:249], v89 offset:0
    ds_read_b64_tr_b16 a[250:251], v89 offset:128
    v_and_b32 v96, 17408, v21
    v_add_u32 v96, v96, v20
    ds_read_b64_tr_b16 a[108:109], v96 offset:0
    ds_read_b64_tr_b16 a[110:111], v96 offset:128
    v_and_b32 v97, 17416, v21
    v_add_u32 v97, v97, v20
    ds_read_b64_tr_b16 a[252:253], v97 offset:0
    ds_read_b64_tr_b16 a[254:255], v97 offset:128
    s_waitcnt lgkmcnt(0)
    v_mfma_f32_16x16x32_bf16 v[36:39], v[200:203], v[104:107], v[36:39]
    v_mfma_f32_16x16x32_bf16 v[40:43], a[16:19], v[104:107], v[40:43]
    v_mfma_f32_16x16x32_bf16 v[44:47], a[88:91], v[104:107], v[44:47]
    v_mfma_f32_16x16x32_bf16 v[48:51], v[104:107], a[160:163], v[48:51]
    v_mfma_f32_16x16x32_bf16 v[52:55], v[104:107], a[232:235], v[52:55]
    v_mfma_f32_16x16x32_bf16 v[36:39], v[204:207], v[104:107], v[36:39]
    v_mfma_f32_16x16x32_bf16 v[40:43], a[20:23], v[104:107], v[40:43]
    v_mfma_f32_16x16x32_bf16 v[44:47], a[92:95], v[104:107], v[44:47]
    v_mfma_f32_16x16x32_bf16 v[48:51], v[104:107], a[164:167], v[48:51]
    v_mfma_f32_16x16x32_bf16 v[52:55], v[104:107], a[236:239], v[52:55]
    v_mfma_f32_16x16x32_bf16 v[36:39], v[208:211], v[104:107], v[36:39]
    v_mfma_f32_16x16x32_bf16 v[40:43], a[24:27], v[104:107], v[40:43]
    v_mfma_f32_16x16x32_bf16 v[44:47], a[96:99], v[104:107], v[44:47]
    v_mfma_f32_16x16x32_bf16 v[48:51], v[104:107], a[168:171], v[48:51]
    v_mfma_f32_16x16x32_bf16 v[52:55], v[104:107], a[240:243], v[52:55]
    v_mfma_f32_16x16x32_bf16 v[36:39], v[212:215], v[104:107], v[36:39]
    v_mfma_f32_16x16x32_bf16 v[40:43], a[28:31], v[104:107], v[40:43]
    v_mfma_f32_16x16x32_bf16 v[44:47], a[100:103], v[104:107], v[44:47]
    v_mfma_f32_16x16x32_bf16 v[48:51], v[104:107], a[172:175], v[48:51]
    v_mfma_f32_16x16x32_bf16 v[52:55], v[104:107], a[244:247], v[52:55]
    v_mfma_f32_16x16x32_bf16 v[36:39], v[216:219], v[104:107], v[36:39]
    v_mfma_f32_16x16x32_bf16 v[40:43], a[32:35], v[104:107], v[40:43]
    v_mfma_f32_16x16x32_bf16 v[44:47], a[104:107], v[104:107], v[44:47]
    v_mfma_f32_16x16x32_bf16 v[48:51], v[104:107], a[176:179], v[48:51]
    v_mfma_f32_16x16x32_bf16 v[52:55], v[104:107], a[248:251], v[52:55]
    v_mfma_f32_16x16x32_bf16 v[36:39], v[220:223], v[104:107], v[36:39]
    v_mfma_f32_16x16x32_bf16 v[40:43], a[36:39], v[104:107], v[40:43]
    v_mfma_f32_16x16x32_bf16 v[44:47], a[108:111], v[104:107], v[44:47]
    v_mfma_f32_16x16x32_bf16 v[48:51], v[104:107], a[180:183], v[48:51]
    v_mfma_f32_16x16x32_bf16 v[52:55], v[104:107], a[252:255], v[52:55]
    s_barrier
    v_lshlrev_b32 v10, 5, v7
    s_lshl_b32 s17, s51, 4
    v_add_u32 v10, s17, v10
    v_mul_u32_u24 v6, 1536, v8
    v_add_u32 v10, v10, v6
    s_lshl_b32 s17, s14, 7
    s_add_u32 s17, s17, 73728
    v_lshl_add_u32 v11, v7, 3, s17
    v_lshl_add_u32 v12, v8, 5, s17
    v_lshlrev_b32 v13, 5, v7
    s_lshl_b32 s17, s51, 4
    v_add_u32 v13, s17, v13
    s_lshr_b32 s17, s50, 2
    s_add_u32 s17, s17, 64
    s_lshl_b32 s17, s17, 9
    s_and_b32 s18, s50, 3
    s_lshl_b32 s18, s18, 2
    s_add_u32 s17, s17, s18
    v_add_u32 v14, s17, v13
    v_lshrrev_b32 v5, 1, v8
    v_lshl_add_u32 v13, v5, 9, v13
    v_and_b32 v5, 1, v8
    v_lshl_add_u32 v13, v5, 3, v13
    s_lshl_b32 s17, s50, 10
    v_add_u32 v13, s17, v13
    s_lshl_b32 s49, s15, 7
    s_lshl_b32 s17, s14, 2
    s_add_u32 s49, s49, s17
    s_add_u32 s49, s49, 181760
    s_mov_b32 s52, 0x3eae1a93
    v_mov_b32 v6, 0xf149f2ca
    v_lshl_add_u32 v5, v8, 2, 0
    v_sub_u32 v5, v5, v7
    v_cmp_le_i32 vcc, 9, v5
    s_nop 1
    v_cndmask_b32 v72, v6, v4, vcc
    v_add_u32 v5, 7, v5
    v_cmp_ge_u32 vcc, 7, v5
    s_nop 1
    v_cndmask_b32 v76, v6, v4, vcc
    v_lshl_add_u32 v5, v8, 2, 1
    v_sub_u32 v5, v5, v7
    v_cmp_le_i32 vcc, 9, v5
    s_nop 1
    v_cndmask_b32 v73, v6, v4, vcc
    v_add_u32 v5, 7, v5
    v_cmp_ge_u32 vcc, 7, v5
    s_nop 1
    v_cndmask_b32 v77, v6, v4, vcc
    v_lshl_add_u32 v5, v8, 2, 2
    v_sub_u32 v5, v5, v7
    v_cmp_le_i32 vcc, 9, v5
    s_nop 1
    v_cndmask_b32 v74, v6, v4, vcc
    v_add_u32 v5, 7, v5
    v_cmp_ge_u32 vcc, 7, v5
    s_nop 1
    v_cndmask_b32 v78, v6, v4, vcc
    v_lshl_add_u32 v5, v8, 2, 3
    v_sub_u32 v5, v5, v7
    v_cmp_le_i32 vcc, 9, v5
    s_nop 1
    v_cndmask_b32 v75, v6, v4, vcc
    v_add_u32 v5, 7, v5
    v_cmp_ge_u32 vcc, 7, v5
    s_nop 1
    v_cndmask_b32 v79, v6, v4, vcc
    v_and_b32 v111, 0x200, v0
    v_lshl_add_u32 v111, v7, 5, v111
    v_and_b32 v5, 1, v8
    v_lshl_add_u32 v111, v5, 4, v111
    v_mov_b32 v112, 0
    v_mov_b32 v113, 0
    v_mov_b32 v114, 0
    v_mov_b32 v115, 0
    v_mov_b32 v136, 0
    v_mov_b32 v137, 0
    v_mov_b32 v138, 0
    v_mov_b32 v139, 0
    v_mov_b32 v140, 0
    v_mov_b32 v141, 0
    v_mov_b32 v142, 0
    v_mov_b32 v143, 0
    v_mov_b32 v116, 0x3f803f80
    v_mov_b32 v117, 0x3f803f80
    v_mov_b32 v118, 0x3f803f80
    v_mov_b32 v119, 0x3f803f80
    v_mov_b32 v131, 0
    v_mov_b32 v135, 0
    v_mbcnt_lo_u32_b32 v24, -1, 0
    v_mbcnt_hi_u32_b32 v24, -1, v24
    v_and_b32 v25, 1, v24
    v_lshlrev_b32 v25, 7, v25
    v_lshlrev_b32 v24, 1, v24
    v_and_or_b32 v24, v24, 12, v25
    s_mov_b32 s16, 0
Laq_pure:
    global_load_dword v25, v24, s[12:13] sc1
    s_add_u32 s16, s16, 1
    s_cmp_gt_u32 s16, 100000
    s_cbranch_scc1 L_role_aq_abort
    s_mov_b32 s6, 0
    s_waitcnt vmcnt(0)
    v_readlane_b32 s7, v25, 0
    s_nop 0
    s_add_u32 s6, s6, s7
    v_readlane_b32 s7, v25, 1
    s_nop 0
    s_add_u32 s6, s6, s7
    v_readlane_b32 s7, v25, 2
    s_nop 0
    s_add_u32 s6, s6, s7
    v_readlane_b32 s7, v25, 3
    s_nop 0
    s_add_u32 s6, s6, s7
    v_readlane_b32 s7, v25, 4
    s_nop 0
    s_add_u32 s6, s6, s7
    v_readlane_b32 s7, v25, 5
    s_nop 0
    s_add_u32 s6, s6, s7
    v_readlane_b32 s7, v25, 6
    s_nop 0
    s_add_u32 s6, s6, s7
    v_readlane_b32 s7, v25, 7
    s_nop 0
    s_add_u32 s6, s6, s7
    v_readlane_b32 s7, v25, s3
    s_nop 0
    s_cmp_ge_u32 s7, 32
    s_cselect_b32 s61, 1, 0
    s_cselect_b32 s6, 256, s6
    s_cmp_lt_u32 s6, 256
    s_cbranch_scc1 Laq_pure
    s_cmp_eq_u32 s61, 0
    s_cbranch_scc1 Laq_slow
    s_mov_b32 s36, s63
    s_mov_b32 s34, s63
    s_mov_b32 s37, 0
    s_lshl_b32 s56, s63, 6
    s_mul_i32 s58, s14, 9216
    s_mov_b32 s40, 36864
    s_mov_b32 s59, s58
    s_mov_b32 s43, 0
    s_mov_b32 s28, s8
    s_mov_b32 s29, s9
    s_mov_b32 s30, 0
    s_mov_b32 s31, 0x00020000
    s_mul_i32 s41, s63, 4718592
    s_add_u32 s41, s41, s58
    s_add_u32 s41, s41, 6291456
    s_mul_i32 s42, s56, 22528
    s_add_u32 s42, s42, 180224
    s_cmp_lg_u32 s14, 0
    s_cbranch_scc1 Laqf_ini_d
    v_mov_b32 v5, 160
    s_mov_b32 s16, 0
Laqf_ini:
    global_load_dword v6, v5, s[12:13] sc1
    s_add_u32 s16, s16, 1
    s_cmp_gt_u32 s16, 100000
    s_cbranch_scc1 L_role_aq_abort
    s_waitcnt vmcnt(0)
    v_cmp_gt_u32 vcc, 123, v6
    s_nop 0
    s_cbranch_vccz Laqf_ini_d
    s_sleep 8
    s_branch Laqf_ini
Laqf_ini_d:
    s_barrier
    s_branch Laqf_poll
Laqf_item:
    s_waitcnt vmcnt(2)
Laqf_go:
    s_barrier
    s_xor_b32 s40, s40, 36864
    s_xor_b32 s59, s59, 36864
    s_xor_b32 s66, s66, 0x2000
    s_xor_b32 s71, s71, 0x2000
    s_mov_b32 s35, s37
    s_mov_b32 s57, s56
    s_add_u32 s37, s37, 1
    s_add_u32 s56, s56, 1
    s_add_u32 s41, s41, 36864
    s_add_u32 s42, s42, 22528
    s_mov_b32 s62, 0
    v_lshlrev_b32 v9, 9, v8
    v_lshl_add_u32 v9, v7, 4, v9
    s_lshl_b32 s17, s51, 8
    s_add_u32 s17, s17, s40
    v_add_u32 v9, s17, v9
    ds_read_b128 v[56:59], v9 offset:0
    ds_read_b128 v[60:63], v9 offset:2048
    ds_read_b128 v[64:67], v9 offset:4096
    ds_read_b128 v[104:107], v9 offset:6144
    s_waitcnt lgkmcnt(3)
    v_mfma_f32_16x16x32_bf16 v[16:19], v[152:155], v[56:59], 0
    v_add_f32 v80, v80, v84
    v_mfma_f32_16x16x32_bf16 v[20:23], v[224:227], v[56:59], 0
    v_add_f32 v81, v81, v85
    v_mfma_f32_16x16x32_bf16 v[24:27], a[40:43], v[56:59], 0
    v_add_f32 v82, v82, v86
    v_mfma_f32_16x16x32_bf16 v[28:31], v[56:59], a[112:115], 0
    v_add_f32 v83, v83, v87
    v_mfma_f32_16x16x32_bf16 v[32:35], v[56:59], a[184:187], 0
    ds_read_b128 v[56:59], v9 offset:8192
    s_waitcnt lgkmcnt(3)
    v_mfma_f32_16x16x32_bf16 v[16:19], v[156:159], v[60:63], v[16:19]
    v_add_f32 v80, v80, v88
    v_mfma_f32_16x16x32_bf16 v[20:23], v[228:231], v[60:63], v[20:23]
    v_add_f32 v81, v81, v89
    v_mfma_f32_16x16x32_bf16 v[24:27], a[44:47], v[60:63], v[24:27]
    v_add_f32 v82, v82, v90
    v_mfma_f32_16x16x32_bf16 v[28:31], v[60:63], a[116:119], v[28:31]
    v_add_f32 v83, v83, v91
    v_mfma_f32_16x16x32_bf16 v[32:35], v[60:63], a[188:191], v[32:35]
    s_waitcnt vmcnt(0)
    buffer_load_dword v2, v1, s[8:11], s42 offen sc1
    s_cmp_lg_u32 s43, 0
    s_cselect_b64 exec, 1, 0
    buffer_store_dword v3, v4, s[8:11], s43 offen
    s_mov_b64 exec, -1
    s_mov_b32 s43, 0
    ds_read_b128 v[60:63], v9 offset:10240
    s_waitcnt lgkmcnt(3)
    v_mfma_f32_16x16x32_bf16 v[16:19], v[160:163], v[64:67], v[16:19]
    v_add_f32 v80, v80, v82
    v_mfma_f32_16x16x32_bf16 v[20:23], v[232:235], v[64:67], v[20:23]
    v_add_f32 v81, v81, v83
    v_mfma_f32_16x16x32_bf16 v[24:27], a[48:51], v[64:67], v[24:27]
    v_mov_b32 v82, v80
    v_mfma_f32_16x16x32_bf16 v[28:31], v[64:67], a[120:123], v[28:31]
    v_mov_b32 v83, v81
    v_mfma_f32_16x16x32_bf16 v[32:35], v[64:67], a[192:195], v[32:35]
    ds_read_b128 v[64:67], v9 offset:12288
    s_waitcnt lgkmcnt(3)
    v_mfma_f32_16x16x32_bf16 v[16:19], v[164:167], v[104:107], v[16:19]
    v_permlane32_swap_b32 v80, v82
    v_mfma_f32_16x16x32_bf16 v[20:23], v[236:239], v[104:107], v[20:23]
    v_permlane32_swap_b32 v81, v83
    v_mfma_f32_16x16x32_bf16 v[24:27], a[52:55], v[104:107], v[24:27]
    v_add_f32 v80, v80, v82
    v_mfma_f32_16x16x32_bf16 v[28:31], v[104:107], a[124:127], v[28:31]
    v_add_f32 v81, v81, v83
    v_mfma_f32_16x16x32_bf16 v[32:35], v[104:107], a[196:199], v[32:35]
    ds_read_b128 v[104:107], v9 offset:14336
    s_waitcnt lgkmcnt(3)
    v_mfma_f32_16x16x32_bf16 v[16:19], v[168:171], v[56:59], v[16:19]
    v_mov_b32 v82, v80
    v_mfma_f32_16x16x32_bf16 v[20:23], v[240:243], v[56:59], v[20:23]
    v_mov_b32 v83, v81
    v_mfma_f32_16x16x32_bf16 v[24:27], a[56:59], v[56:59], v[24:27]
    v_permlane16_swap_b32 v80, v82
    v_mfma_f32_16x16x32_bf16 v[28:31], v[56:59], a[128:131], v[28:31]
    v_permlane16_swap_b32 v81, v83
    v_mfma_f32_16x16x32_bf16 v[32:35], v[56:59], a[200:203], v[32:35]
    ds_read_b128 v[56:59], v9 offset:16384
    s_waitcnt lgkmcnt(3)
    v_mfma_f32_16x16x32_bf16 v[16:19], v[172:175], v[60:63], v[16:19]
    v_add_f32 v80, v80, v82
    v_mfma_f32_16x16x32_bf16 v[20:23], v[244:247], v[60:63], v[20:23]
    v_add_f32 v81, v81, v83
    v_mfma_f32_16x16x32_bf16 v[24:27], a[60:63], v[60:63], v[24:27]
    v_mul_f32 v80, 0x3ae38e39, v80
    v_mfma_f32_16x16x32_bf16 v[28:31], v[60:63], a[132:135], v[28:31]
    v_mul_f32 v81, 0x3ae38e39, v81
    v_mfma_f32_16x16x32_bf16 v[32:35], v[60:63], a[204:207], v[32:35]
    ds_read_b128 v[60:63], v9 offset:18432
    s_waitcnt lgkmcnt(3)
    v_mfma_f32_16x16x32_bf16 v[16:19], v[176:179], v[64:67], v[16:19]
    v_fma_f32 v81, -v80, v80, v81
    v_mfma_f32_16x16x32_bf16 v[20:23], v[248:251], v[64:67], v[20:23]
    v_max_f32 v81, 0, v81
    v_mfma_f32_16x16x32_bf16 v[24:27], a[64:67], v[64:67], v[24:27]
    v_add_f32 v81, 0x3727c5ac, v81
    v_mfma_f32_16x16x32_bf16 v[28:31], v[64:67], a[136:139], v[28:31]
    v_rsq_f32 v92, v81
    v_mfma_f32_16x16x32_bf16 v[32:35], v[64:67], a[208:211], v[32:35]
    ds_read_b128 v[64:67], v9 offset:20480
    s_waitcnt lgkmcnt(3)
    v_mfma_f32_16x16x32_bf16 v[16:19], v[180:183], v[104:107], v[16:19]
    v_mul_f32 v93, v80, v92
    v_mfma_f32_16x16x32_bf16 v[20:23], v[252:255], v[104:107], v[20:23]
    ds_write_b64 v11, v[92:93]
    v_mfma_f32_16x16x32_bf16 v[24:27], a[68:71], v[104:107], v[24:27]
    ds_read_b128 v[96:99], v12
    v_mfma_f32_16x16x32_bf16 v[28:31], v[104:107], a[140:143], v[28:31]
    ds_read_b128 v[100:103], v12 offset:16
    v_mfma_f32_16x16x32_bf16 v[32:35], v[104:107], a[212:215], v[32:35]
    ds_read_b128 v[104:107], v9 offset:22528
    s_waitcnt lgkmcnt(6)
    v_mfma_f32_16x16x32_bf16 v[16:19], v[184:187], v[56:59], v[16:19]
    v_mfma_f32_16x16x32_bf16 v[20:23], a[0:3], v[56:59], v[20:23]
    v_mfma_f32_16x16x32_bf16 v[24:27], a[72:75], v[56:59], v[24:27]
    v_mfma_f32_16x16x32_bf16 v[28:31], v[56:59], a[144:147], v[28:31]
    v_mfma_f32_16x16x32_bf16 v[32:35], v[56:59], a[216:219], v[32:35]
    ds_read_b128 v[56:59], v9 offset:24576
    s_waitcnt lgkmcnt(6)
    v_mfma_f32_16x16x32_bf16 v[16:19], v[188:191], v[60:63], v[16:19]
    v_mfma_f32_16x16x32_bf16 v[20:23], a[4:7], v[60:63], v[20:23]
    v_mfma_f32_16x16x32_bf16 v[24:27], a[76:79], v[60:63], v[24:27]
    v_mfma_f32_16x16x32_bf16 v[28:31], v[60:63], a[148:151], v[28:31]
    v_mfma_f32_16x16x32_bf16 v[32:35], v[60:63], a[220:223], v[32:35]
    ds_read_b128 v[60:63], v9 offset:26624
    s_waitcnt lgkmcnt(6)
    v_mfma_f32_16x16x32_bf16 v[16:19], v[192:195], v[64:67], v[16:19]
    v_mfma_f32_16x16x32_bf16 v[20:23], a[8:11], v[64:67], v[20:23]
    v_mfma_f32_16x16x32_bf16 v[24:27], a[80:83], v[64:67], v[24:27]
    v_mfma_f32_16x16x32_bf16 v[28:31], v[64:67], a[152:155], v[28:31]
    v_mfma_f32_16x16x32_bf16 v[32:35], v[64:67], a[224:227], v[32:35]
    ds_read_b128 v[64:67], v9 offset:28672
    s_waitcnt lgkmcnt(3)
    v_mfma_f32_16x16x32_bf16 v[16:19], v[196:199], v[104:107], v[16:19]
    v_mfma_f32_16x16x32_bf16 v[20:23], a[12:15], v[104:107], v[20:23]
    v_mfma_f32_16x16x32_bf16 v[24:27], a[84:87], v[104:107], v[24:27]
    v_mfma_f32_16x16x32_bf16 v[28:31], v[104:107], a[156:159], v[28:31]
    v_mfma_f32_16x16x32_bf16 v[32:35], v[104:107], a[228:231], v[32:35]
    s_waitcnt vmcnt(1)
    v_cmp_eq_u32 vcc, 0, v2
    s_nop 0
    s_cmp_eq_u64 vcc, 0
    s_cselect_b32 s62, 1, 0
    s_cmp_lt_u32 s37, 64
    s_cselect_b32 s62, s62, 0
    s_cmp_lg_u32 s62, 0
    s_cselect_b32 s30, 268435456, 0
    ds_read_b128 v[104:107], v9 offset:30720
    s_waitcnt lgkmcnt(3)
    v_mfma_f32_16x16x32_bf16 v[16:19], v[200:203], v[56:59], v[16:19]
    v_mfma_f32_16x16x32_bf16 v[20:23], a[16:19], v[56:59], v[20:23]
    v_mfma_f32_16x16x32_bf16 v[24:27], a[88:91], v[56:59], v[24:27]
    s_add_u32 m0, s59, 0
    s_add_u32 s47, s41, 0
    buffer_load_dwordx4 v111, s[28:31], s47 offen offset:0 lds
    v_mfma_f32_16x16x32_bf16 v[28:31], v[56:59], a[160:163], v[28:31]
    v_mfma_f32_16x16x32_bf16 v[32:35], v[56:59], a[232:235], v[32:35]
    buffer_load_dwordx4 v111, s[28:31], s47 offen offset:1024 lds
    ds_read_b128 v[56:59], v9 offset:32768
    s_waitcnt lgkmcnt(3)
    v_mfma_f32_16x16x32_bf16 v[16:19], v[204:207], v[60:63], v[16:19]
    v_mfma_f32_16x16x32_bf16 v[20:23], a[20:23], v[60:63], v[20:23]
    v_mfma_f32_16x16x32_bf16 v[24:27], a[92:95], v[60:63], v[24:27]
    buffer_load_dwordx4 v111, s[28:31], s47 offen offset:2048 lds
    v_mfma_f32_16x16x32_bf16 v[28:31], v[60:63], a[164:167], v[28:31]
    v_mfma_f32_16x16x32_bf16 v[32:35], v[60:63], a[236:239], v[32:35]
    buffer_load_dwordx4 v111, s[28:31], s47 offen offset:3072 lds
    ds_read_b128 v[60:63], v9 offset:34816
    s_waitcnt lgkmcnt(3)
    v_mfma_f32_16x16x32_bf16 v[16:19], v[208:211], v[64:67], v[16:19]
    v_mfma_f32_16x16x32_bf16 v[20:23], a[24:27], v[64:67], v[20:23]
    v_mfma_f32_16x16x32_bf16 v[24:27], a[96:99], v[64:67], v[24:27]
    s_add_u32 m0, s59, 4096
    s_add_u32 s47, s41, 4096
    buffer_load_dwordx4 v111, s[28:31], s47 offen offset:0 lds
    v_mfma_f32_16x16x32_bf16 v[28:31], v[64:67], a[168:171], v[28:31]
    v_mfma_f32_16x16x32_bf16 v[32:35], v[64:67], a[240:243], v[32:35]
    buffer_load_dwordx4 v111, s[28:31], s47 offen offset:1024 lds
    s_waitcnt lgkmcnt(2)
    v_mfma_f32_16x16x32_bf16 v[16:19], v[212:215], v[104:107], v[16:19]
    v_mfma_f32_16x16x32_bf16 v[20:23], a[28:31], v[104:107], v[20:23]
    v_mfma_f32_16x16x32_bf16 v[24:27], a[100:103], v[104:107], v[24:27]
    buffer_load_dwordx4 v111, s[28:31], s47 offen offset:2048 lds
    v_mfma_f32_16x16x32_bf16 v[28:31], v[104:107], a[172:175], v[28:31]
    v_mfma_f32_16x16x32_bf16 v[32:35], v[104:107], a[244:247], v[32:35]
    buffer_load_dwordx4 v111, s[28:31], s47 offen offset:3072 lds
    s_waitcnt lgkmcnt(1)
    v_mfma_f32_16x16x32_bf16 v[16:19], v[216:219], v[56:59], v[16:19]
    v_mfma_f32_16x16x32_bf16 v[20:23], a[32:35], v[56:59], v[20:23]
    v_mfma_f32_16x16x32_bf16 v[24:27], a[104:107], v[56:59], v[24:27]
    s_add_u32 m0, s59, 8192
    s_add_u32 s47, s41, 8192
    buffer_load_dwordx4 v111, s[28:31], s47 offen offset:0 lds
    v_mfma_f32_16x16x32_bf16 v[28:31], v[56:59], a[176:179], v[28:31]
    v_mfma_f32_16x16x32_bf16 v[32:35], v[56:59], a[248:251], v[32:35]
    s_mul_i32 s48, s36, 786432
    s_mul_i32 s18, s37, 6144
    s_add_u32 s48, s48, s18
    s_add_u32 s48, s48, 15728640
    buffer_load_dwordx4 v[80:83], v10, s[28:31], s48 offen offset:0
    s_waitcnt lgkmcnt(0)
    v_mfma_f32_16x16x32_bf16 v[16:19], v[220:223], v[60:63], v[16:19]
    v_mfma_f32_16x16x32_bf16 v[20:23], a[36:39], v[60:63], v[20:23]
    v_mfma_f32_16x16x32_bf16 v[24:27], a[108:111], v[60:63], v[24:27]
    buffer_load_dwordx4 v[84:87], v10, s[28:31], s48 offen offset:512
    v_mfma_f32_16x16x32_bf16 v[28:31], v[60:63], a[180:183], v[28:31]
    v_mfma_f32_16x16x32_bf16 v[32:35], v[60:63], a[252:255], v[32:35]
    buffer_load_dwordx4 v[88:91], v10, s[28:31], s48 offen offset:1024
    v_mul_f32 v94, v93, v36
    s_nop 0
    v_fma_f32 v16, v16, v92, -v94
    v_mul_f32 v94, v93, v37
    v_fma_f32 v17, v17, v92, -v94
    v_mul_f32 v94, v93, v38
    v_fma_f32 v18, v18, v92, -v94
    v_mul_f32 v94, v93, v39
    v_fma_f32 v19, v19, v92, -v94
    v_mul_f32 v94, v93, v44
    v_fma_f32 v24, v24, v92, -v94
    v_mul_f32 v94, v93, v45
    v_fma_f32 v25, v25, v92, -v94
    v_mul_f32 v94, v93, v46
    v_fma_f32 v26, v26, v92, -v94
    v_mul_f32 v94, v93, v47
    v_fma_f32 v27, v27, v92, -v94
    v_mul_f32 v94, v93, v40
    v_fma_f32 v20, v20, v92, -v94
    v_mul_f32 v94, v93, v41
    v_fma_f32 v21, v21, v92, -v94
    v_mul_f32 v94, v93, v42
    v_fma_f32 v22, v22, v92, -v94
    v_mul_f32 v94, v93, v43
    v_fma_f32 v23, v23, v92, -v94
    v_cvt_pk_bf16_f32 v128, v16, v17
    v_cvt_pk_bf16_f32 v129, v18, v19
    v_cvt_pk_bf16_f32 v130, v24, v25
    v_cvt_pk_bf16_f32 v132, v20, v21
    v_cvt_pk_bf16_f32 v133, v22, v23
    v_cvt_pk_bf16_f32 v134, v26, v27
    s_cmp_eq_u32 s35, 0
    s_cselect_b32 s46, 0xf149f2ca, 0
    v_mul_f32 v94, v97, v48
    v_fma_f32 v28, v28, v96, -v94
    v_mfma_f32_16x16x32_bf16 v[144:147], v[112:115], v[128:131], 0
    v_mul_f32 v94, v99, v49
    v_fma_f32 v29, v29, v98, -v94
    v_mfma_f32_16x16x32_bf16 v[148:151], v[132:135], v[128:131], 0
    v_mul_f32 v94, v101, v50
    v_fma_f32 v30, v30, v100, -v94
    v_mul_f32 v94, v103, v51
    v_fma_f32 v31, v31, v102, -v94
    v_mov_b32 v112, v132
    v_mov_b32 v113, v133
    v_mov_b32 v114, v134
    v_mul_f32 v94, v97, v52
    v_fma_f32 v32, v32, v96, -v94
    v_mul_f32 v94, v99, v53
    v_fma_f32 v33, v33, v98, -v94
    v_mul_f32 v94, v101, v54
    v_fma_f32 v34, v34, v100, -v94
    v_fma_f32 v144, v144, s52, v72
    v_fma_f32 v145, v145, s52, v73
    v_fma_f32 v146, v146, s52, v74
    v_fma_f32 v147, v147, s52, v75
    v_fma_f32 v148, v148, s52, v76
    v_fma_f32 v149, v149, s52, v77
    v_fma_f32 v150, v150, s52, v78
    v_fma_f32 v151, v151, s52, v79
    v_add_f32 v144, s46, v144
    v_add_f32 v145, s46, v145
    v_add_f32 v146, s46, v146
    v_add_f32 v147, s46, v147
    v_max3_f32 v5, v144, v145, v146
    v_max3_f32 v5, v5, v147, v148
    v_max3_f32 v5, v5, v149, v150
    v_max_f32 v5, v5, v151
    v_mov_b32 v6, v5
    v_mul_f32 v94, v103, v55
    v_fma_f32 v35, v35, v102, -v94
    v_permlane32_swap_b32 v5, v6
    v_max_f32 v5, v5, v6
    v_mov_b32 v6, v5
    s_nop 1
    v_permlane16_swap_b32 v5, v6
    v_max_f32 v5, v5, v6
    v_sub_f32 v144, v144, v5
    v_sub_f32 v145, v145, v5
    v_sub_f32 v146, v146, v5
    v_sub_f32 v147, v147, v5
    v_sub_f32 v148, v148, v5
    v_sub_f32 v149, v149, v5
    v_sub_f32 v150, v150, v5
    v_sub_f32 v151, v151, v5
    v_exp_f32 v144, v144
    v_exp_f32 v145, v145
    v_exp_f32 v146, v146
    v_exp_f32 v147, v147
    v_exp_f32 v148, v148
    v_exp_f32 v149, v149
    v_exp_f32 v150, v150
    v_exp_f32 v151, v151
    v_cvt_pk_bf16_f32 v68, v144, v145
    v_cvt_pk_bf16_f32 v69, v146, v147
    v_cvt_pk_bf16_f32 v70, v148, v149
    v_cvt_pk_bf16_f32 v71, v150, v151
    s_nop 1
    v_mfma_f32_16x16x32_bf16 v[16:19], v[116:119], v[68:71], 0
    s_mul_i32 s46, s57, 36864
    s_add_u32 s46, s46, 17301504
    s_nop 5
    v_rcp_f32 v6, v16
    v_cvt_pk_bf16_f32 v138, v28, v29
    v_cvt_pk_bf16_f32 v139, v30, v31
    s_nop 1
    v_mfma_f32_16x16x32_bf16 v[20:23], v[136:139], v[68:71], 0
    v_cvt_pk_bf16_f32 v142, v32, v33
    v_cvt_pk_bf16_f32 v143, v34, v35
    v_mov_b32 v136, v138
    v_mov_b32 v137, v139
    v_mfma_f32_16x16x32_bf16 v[24:27], v[140:143], v[68:71], 0
    s_nop 2
    v_mul_f32 v20, v6, v20
    v_mul_f32 v21, v6, v21
    v_mul_f32 v22, v6, v22
    v_mul_f32 v23, v6, v23
    v_cvt_pk_bf16_f32 v20, v20, v21
    v_cvt_pk_bf16_f32 v21, v22, v23
    buffer_store_dwordx2 v[20:21], v13, s[8:11], s46 offen
    v_mov_b32 v140, v142
    v_mov_b32 v141, v143
    v_mul_f32 v24, v6, v24
    v_mul_f32 v25, v6, v25
    v_cvt_pk_bf16_f32 v24, v24, v25
    s_mov_b64 exec, 0xffff
    buffer_store_dword v24, v14, s[8:11], s46 offen
    s_mov_b64 exec, -1
    s_mul_i32 s43, s57, 22528
    s_add_u32 s43, s43, s49
    s_cmp_lg_u32 s62, 0
    s_cbranch_scc1 Laqf_item
    buffer_load_dword v2, v1, s[8:11], s42 offen sc1
    s_waitcnt vmcnt(0)
    s_cmp_ge_u32 s37, 64
    s_cbranch_scc1 Laqf_fin
    v_cmp_eq_u32 vcc, 0, v2
    s_nop 0
    s_cbranch_vccnz Laqf_pub
    s_add_u32 m0, s59, 0
    s_add_u32 s47, s41, 0
    buffer_load_dwordx4 v111, s[8:11], s47 offen offset:0 lds
    buffer_load_dwordx4 v111, s[8:11], s47 offen offset:1024 lds
    buffer_load_dwordx4 v111, s[8:11], s47 offen offset:2048 lds
    buffer_load_dwordx4 v111, s[8:11], s47 offen offset:3072 lds
    s_add_u32 m0, s59, 4096
    s_add_u32 s47, s41, 4096
    buffer_load_dwordx4 v111, s[8:11], s47 offen offset:0 lds
    buffer_load_dwordx4 v111, s[8:11], s47 offen offset:1024 lds
    buffer_load_dwordx4 v111, s[8:11], s47 offen offset:2048 lds
    buffer_load_dwordx4 v111, s[8:11], s47 offen offset:3072 lds
    s_add_u32 m0, s59, 8192
    s_add_u32 s47, s41, 8192
    buffer_load_dwordx4 v111, s[8:11], s47 offen offset:0 lds
    s_mul_i32 s48, s36, 786432
    s_mul_i32 s18, s37, 6144
    s_add_u32 s48, s48, s18
    s_add_u32 s48, s48, 15728640
    buffer_load_dwordx4 v[80:83], v10, s[8:11], s48 offen offset:0
    buffer_load_dwordx4 v[84:87], v10, s[8:11], s48 offen offset:512
    buffer_load_dwordx4 v[88:91], v10, s[8:11], s48 offen offset:1024
    s_cmp_lg_u32 s43, 0
    s_cselect_b64 exec, 1, 0
    buffer_store_dword v3, v4, s[8:11], s43 offen
    s_mov_b64 exec, -1
    s_mov_b32 s43, 0
    s_waitcnt vmcnt(1)
    s_branch Laqf_go
Laqf_fin:
    s_cmp_lg_u32 s43, 0
    s_cselect_b64 exec, 1, 0
    buffer_store_dword v3, v4, s[8:11], s43 offen
    s_mov_b64 exec, -1
    s_mov_b32 s43, 0
    s_branch L_role_aq_exit
Laqf_pub:
    s_cmp_lg_u32 s43, 0
    s_cselect_b64 exec, 1, 0
    buffer_store_dword v3, v4, s[8:11], s43 offen
    s_mov_b64 exec, -1
    s_mov_b32 s43, 0
Laqf_poll:
    s_mov_b32 s16, 0
Laqf_pl:
    buffer_load_dword v2, v1, s[8:11], s42 offen sc1
    s_add_u32 s16, s16, 1
    s_cmp_gt_u32 s16, 100000
    s_cbranch_scc1 L_role_aq_abort
    s_waitcnt vmcnt(0)
    v_cmp_eq_u32 vcc, 0, v2
    s_nop 0
    s_cbranch_vccz Laqf_pld
    s_sleep 4
    s_branch Laqf_pl
Laqf_pld:
    s_add_u32 m0, s59, 0
    s_add_u32 s47, s41, 0
    buffer_load_dwordx4 v111, s[8:11], s47 offen offset:0 lds
    buffer_load_dwordx4 v111, s[8:11], s47 offen offset:1024 lds
    buffer_load_dwordx4 v111, s[8:11], s47 offen offset:2048 lds
    buffer_load_dwordx4 v111, s[8:11], s47 offen offset:3072 lds
    s_add_u32 m0, s59, 4096
    s_add_u32 s47, s41, 4096
    buffer_load_dwordx4 v111, s[8:11], s47 offen offset:0 lds
    buffer_load_dwordx4 v111, s[8:11], s47 offen offset:1024 lds
    buffer_load_dwordx4 v111, s[8:11], s47 offen offset:2048 lds
    buffer_load_dwordx4 v111, s[8:11], s47 offen offset:3072 lds
    s_add_u32 m0, s59, 8192
    s_add_u32 s47, s41, 8192
    buffer_load_dwordx4 v111, s[8:11], s47 offen offset:0 lds
    s_mul_i32 s48, s36, 786432
    s_mul_i32 s18, s37, 6144
    s_add_u32 s48, s48, s18
    s_add_u32 s48, s48, 15728640
    buffer_load_dwordx4 v[80:83], v10, s[8:11], s48 offen offset:0
    buffer_load_dwordx4 v[84:87], v10, s[8:11], s48 offen offset:512
    buffer_load_dwordx4 v[88:91], v10, s[8:11], s48 offen offset:1024
    s_waitcnt vmcnt(0)
    s_branch Laqf_go
Laq_slow:
    s_mov_b32 s36, s63
    s_mov_b32 s34, s63
    s_mov_b32 s37, 0
    s_lshl_b32 s56, s63, 6
    s_mul_i32 s58, s14, 9216
    s_mov_b32 s40, 36864
    s_mov_b32 s59, s58
    s_mov_b32 s43, 0
    s_mov_b32 s28, s8
    s_mov_b32 s29, s9
    s_mov_b32 s30, 0
    s_mov_b32 s31, 0x00020000
    s_mul_i32 s41, s63, 4718592
    s_add_u32 s41, s41, s58
    s_add_u32 s41, s41, 6291456
    s_mul_i32 s42, s56, 22528
    s_add_u32 s42, s42, 180224
    s_cmp_lg_u32 s14, 0
    s_cbranch_scc1 Laq_ini_d
    v_mov_b32 v5, 160
    s_mov_b32 s16, 0
Laq_ini:
    global_load_dword v6, v5, s[12:13] sc1
    s_add_u32 s16, s16, 1
    s_cmp_gt_u32 s16, 100000
    s_cbranch_scc1 L_role_aq_abort
    s_waitcnt vmcnt(0)
    v_cmp_gt_u32 vcc, 123, v6
    s_nop 0
    s_cbranch_vccz Laq_ini_d
    s_sleep 8
    s_branch Laq_ini
Laq_ini_d:
    s_barrier
    s_branch Laq_poll
Laq_item:
    s_waitcnt vmcnt(2)
Laq_go:
    s_barrier
    s_xor_b32 s40, s40, 36864
    s_xor_b32 s59, s59, 36864
    s_xor_b32 s66, s66, 0x2000
    s_xor_b32 s71, s71, 0x2000
    s_mov_b32 s35, s37
    s_mov_b32 s57, s56
    s_add_u32 s37, s37, 1
    s_add_u32 s56, s56, 1
    s_add_u32 s41, s41, 36864
    s_add_u32 s42, s42, 22528
    s_mov_b32 s62, 0
    v_lshlrev_b32 v9, 9, v8
    v_lshl_add_u32 v9, v7, 4, v9
    s_lshl_b32 s17, s51, 8
    s_add_u32 s17, s17, s40
    v_add_u32 v9, s17, v9
    ds_read_b128 v[56:59], v9 offset:0
    ds_read_b128 v[60:63], v9 offset:2048
    ds_read_b128 v[64:67], v9 offset:4096
    ds_read_b128 v[104:107], v9 offset:6144
    s_waitcnt lgkmcnt(3)
    v_mfma_f32_16x16x32_bf16 v[16:19], v[152:155], v[56:59], 0
    v_add_f32 v80, v80, v84
    v_mfma_f32_16x16x32_bf16 v[20:23], v[224:227], v[56:59], 0
    v_add_f32 v81, v81, v85
    v_mfma_f32_16x16x32_bf16 v[24:27], a[40:43], v[56:59], 0
    v_add_f32 v82, v82, v86
    v_mfma_f32_16x16x32_bf16 v[28:31], v[56:59], a[112:115], 0
    v_add_f32 v83, v83, v87
    v_mfma_f32_16x16x32_bf16 v[32:35], v[56:59], a[184:187], 0
    ds_read_b128 v[56:59], v9 offset:8192
    s_waitcnt lgkmcnt(3)
    v_mfma_f32_16x16x32_bf16 v[16:19], v[156:159], v[60:63], v[16:19]
    v_add_f32 v80, v80, v88
    v_mfma_f32_16x16x32_bf16 v[20:23], v[228:231], v[60:63], v[20:23]
    v_add_f32 v81, v81, v89
    v_mfma_f32_16x16x32_bf16 v[24:27], a[44:47], v[60:63], v[24:27]
    v_add_f32 v82, v82, v90
    v_mfma_f32_16x16x32_bf16 v[28:31], v[60:63], a[116:119], v[28:31]
    v_add_f32 v83, v83, v91
    v_mfma_f32_16x16x32_bf16 v[32:35], v[60:63], a[188:191], v[32:35]
    ds_read_b128 v[60:63], v9 offset:10240
    s_waitcnt lgkmcnt(3)
    v_mfma_f32_16x16x32_bf16 v[16:19], v[160:163], v[64:67], v[16:19]
    v_add_f32 v80, v80, v82
    v_mfma_f32_16x16x32_bf16 v[20:23], v[232:235], v[64:67], v[20:23]
    v_add_f32 v81, v81, v83
    v_mfma_f32_16x16x32_bf16 v[24:27], a[48:51], v[64:67], v[24:27]
    v_mov_b32 v82, v80
    v_mfma_f32_16x16x32_bf16 v[28:31], v[64:67], a[120:123], v[28:31]
    v_mov_b32 v83, v81
    v_mfma_f32_16x16x32_bf16 v[32:35], v[64:67], a[192:195], v[32:35]
    ds_read_b128 v[64:67], v9 offset:12288
    s_waitcnt lgkmcnt(3)
    v_mfma_f32_16x16x32_bf16 v[16:19], v[164:167], v[104:107], v[16:19]
    v_permlane32_swap_b32 v80, v82
    v_mfma_f32_16x16x32_bf16 v[20:23], v[236:239], v[104:107], v[20:23]
    v_permlane32_swap_b32 v81, v83
    v_mfma_f32_16x16x32_bf16 v[24:27], a[52:55], v[104:107], v[24:27]
    v_add_f32 v80, v80, v82
    v_mfma_f32_16x16x32_bf16 v[28:31], v[104:107], a[124:127], v[28:31]
    v_add_f32 v81, v81, v83
    v_mfma_f32_16x16x32_bf16 v[32:35], v[104:107], a[196:199], v[32:35]
    ds_read_b128 v[104:107], v9 offset:14336
    s_waitcnt lgkmcnt(3)
    v_mfma_f32_16x16x32_bf16 v[16:19], v[168:171], v[56:59], v[16:19]
    v_mov_b32 v82, v80
    v_mfma_f32_16x16x32_bf16 v[20:23], v[240:243], v[56:59], v[20:23]
    v_mov_b32 v83, v81
    v_mfma_f32_16x16x32_bf16 v[24:27], a[56:59], v[56:59], v[24:27]
    v_permlane16_swap_b32 v80, v82
    v_mfma_f32_16x16x32_bf16 v[28:31], v[56:59], a[128:131], v[28:31]
    v_permlane16_swap_b32 v81, v83
    v_mfma_f32_16x16x32_bf16 v[32:35], v[56:59], a[200:203], v[32:35]
    ds_read_b128 v[56:59], v9 offset:16384
    s_waitcnt lgkmcnt(3)
    v_mfma_f32_16x16x32_bf16 v[16:19], v[172:175], v[60:63], v[16:19]
    v_add_f32 v80, v80, v82
    v_mfma_f32_16x16x32_bf16 v[20:23], v[244:247], v[60:63], v[20:23]
    v_add_f32 v81, v81, v83
    v_mfma_f32_16x16x32_bf16 v[24:27], a[60:63], v[60:63], v[24:27]
    v_mul_f32 v80, 0x3ae38e39, v80
    v_mfma_f32_16x16x32_bf16 v[28:31], v[60:63], a[132:135], v[28:31]
    v_mul_f32 v81, 0x3ae38e39, v81
    v_mfma_f32_16x16x32_bf16 v[32:35], v[60:63], a[204:207], v[32:35]
    ds_read_b128 v[60:63], v9 offset:18432
    s_waitcnt lgkmcnt(3)
    v_mfma_f32_16x16x32_bf16 v[16:19], v[176:179], v[64:67], v[16:19]
    v_fma_f32 v81, -v80, v80, v81
    v_mfma_f32_16x16x32_bf16 v[20:23], v[248:251], v[64:67], v[20:23]
    v_max_f32 v81, 0, v81
    v_mfma_f32_16x16x32_bf16 v[24:27], a[64:67], v[64:67], v[24:27]
    v_add_f32 v81, 0x3727c5ac, v81
    v_mfma_f32_16x16x32_bf16 v[28:31], v[64:67], a[136:139], v[28:31]
    v_rsq_f32 v92, v81
    v_mfma_f32_16x16x32_bf16 v[32:35], v[64:67], a[208:211], v[32:35]
    ds_read_b128 v[64:67], v9 offset:20480
    s_waitcnt lgkmcnt(3)
    v_mfma_f32_16x16x32_bf16 v[16:19], v[180:183], v[104:107], v[16:19]
    v_mul_f32 v93, v80, v92
    v_mfma_f32_16x16x32_bf16 v[20:23], v[252:255], v[104:107], v[20:23]
    ds_write_b64 v11, v[92:93]
    v_mfma_f32_16x16x32_bf16 v[24:27], a[68:71], v[104:107], v[24:27]
    ds_read_b128 v[96:99], v12
    v_mfma_f32_16x16x32_bf16 v[28:31], v[104:107], a[140:143], v[28:31]
    ds_read_b128 v[100:103], v12 offset:16
    v_mfma_f32_16x16x32_bf16 v[32:35], v[104:107], a[212:215], v[32:35]
    ds_read_b128 v[104:107], v9 offset:22528
    s_waitcnt lgkmcnt(6)
    v_mfma_f32_16x16x32_bf16 v[16:19], v[184:187], v[56:59], v[16:19]
    v_mfma_f32_16x16x32_bf16 v[20:23], a[0:3], v[56:59], v[20:23]
    v_mfma_f32_16x16x32_bf16 v[24:27], a[72:75], v[56:59], v[24:27]
    v_mfma_f32_16x16x32_bf16 v[28:31], v[56:59], a[144:147], v[28:31]
    v_mfma_f32_16x16x32_bf16 v[32:35], v[56:59], a[216:219], v[32:35]
    ds_read_b128 v[56:59], v9 offset:24576
    s_waitcnt lgkmcnt(6)
    v_mfma_f32_16x16x32_bf16 v[16:19], v[188:191], v[60:63], v[16:19]
    v_mfma_f32_16x16x32_bf16 v[20:23], a[4:7], v[60:63], v[20:23]
    v_mfma_f32_16x16x32_bf16 v[24:27], a[76:79], v[60:63], v[24:27]
    v_mfma_f32_16x16x32_bf16 v[28:31], v[60:63], a[148:151], v[28:31]
    v_mfma_f32_16x16x32_bf16 v[32:35], v[60:63], a[220:223], v[32:35]
    ds_read_b128 v[60:63], v9 offset:26624
    s_waitcnt lgkmcnt(6)
    v_mfma_f32_16x16x32_bf16 v[16:19], v[192:195], v[64:67], v[16:19]
    v_mfma_f32_16x16x32_bf16 v[20:23], a[8:11], v[64:67], v[20:23]
    v_mfma_f32_16x16x32_bf16 v[24:27], a[80:83], v[64:67], v[24:27]
    v_mfma_f32_16x16x32_bf16 v[28:31], v[64:67], a[152:155], v[28:31]
    v_mfma_f32_16x16x32_bf16 v[32:35], v[64:67], a[224:227], v[32:35]
    s_waitcnt vmcnt(0)
    buffer_load_dword v2, v1, s[8:11], s42 offen sc1
    s_cmp_lg_u32 s43, 0
    s_cselect_b64 exec, 1, 0
    buffer_store_dword v3, v4, s[8:11], s43 offen sc1
    s_mov_b64 exec, -1
    s_mov_b32 s43, 0
    ds_read_b128 v[64:67], v9 offset:28672
    s_waitcnt lgkmcnt(3)
    v_mfma_f32_16x16x32_bf16 v[16:19], v[196:199], v[104:107], v[16:19]
    v_mfma_f32_16x16x32_bf16 v[20:23], a[12:15], v[104:107], v[20:23]
    v_mfma_f32_16x16x32_bf16 v[24:27], a[84:87], v[104:107], v[24:27]
    v_mfma_f32_16x16x32_bf16 v[28:31], v[104:107], a[156:159], v[28:31]
    v_mfma_f32_16x16x32_bf16 v[32:35], v[104:107], a[228:231], v[32:35]
    ds_read_b128 v[104:107], v9 offset:30720
    s_waitcnt lgkmcnt(3)
    v_mfma_f32_16x16x32_bf16 v[16:19], v[200:203], v[56:59], v[16:19]
    v_mfma_f32_16x16x32_bf16 v[20:23], a[16:19], v[56:59], v[20:23]
    v_mfma_f32_16x16x32_bf16 v[24:27], a[88:91], v[56:59], v[24:27]
    v_mfma_f32_16x16x32_bf16 v[28:31], v[56:59], a[160:163], v[28:31]
    v_mfma_f32_16x16x32_bf16 v[32:35], v[56:59], a[232:235], v[32:35]
    ds_read_b128 v[56:59], v9 offset:32768
    s_waitcnt lgkmcnt(3)
    v_mfma_f32_16x16x32_bf16 v[16:19], v[204:207], v[60:63], v[16:19]
    v_mfma_f32_16x16x32_bf16 v[20:23], a[20:23], v[60:63], v[20:23]
    v_mfma_f32_16x16x32_bf16 v[24:27], a[92:95], v[60:63], v[24:27]
    v_mfma_f32_16x16x32_bf16 v[28:31], v[60:63], a[164:167], v[28:31]
    v_mfma_f32_16x16x32_bf16 v[32:35], v[60:63], a[236:239], v[32:35]
    ds_read_b128 v[60:63], v9 offset:34816
    s_waitcnt lgkmcnt(3)
    v_mfma_f32_16x16x32_bf16 v[16:19], v[208:211], v[64:67], v[16:19]
    v_mfma_f32_16x16x32_bf16 v[20:23], a[24:27], v[64:67], v[20:23]
    v_mfma_f32_16x16x32_bf16 v[24:27], a[96:99], v[64:67], v[24:27]
    v_mfma_f32_16x16x32_bf16 v[28:31], v[64:67], a[168:171], v[28:31]
    v_mfma_f32_16x16x32_bf16 v[32:35], v[64:67], a[240:243], v[32:35]
    s_waitcnt vmcnt(1)
    v_cmp_eq_u32 vcc, 0, v2
    s_nop 0
    s_cmp_eq_u64 vcc, 0
    s_cselect_b32 s62, 1, 0
    s_cmp_lt_u32 s37, 64
    s_cselect_b32 s62, s62, 0
    s_cmp_lg_u32 s62, 0
    s_cselect_b32 s30, 268435456, 0
    s_waitcnt lgkmcnt(2)
    v_mfma_f32_16x16x32_bf16 v[16:19], v[212:215], v[104:107], v[16:19]
    v_mfma_f32_16x16x32_bf16 v[20:23], a[28:31], v[104:107], v[20:23]
    v_mfma_f32_16x16x32_bf16 v[24:27], a[100:103], v[104:107], v[24:27]
    s_add_u32 m0, s59, 0
    s_add_u32 s47, s41, 0
    buffer_load_dwordx4 v111, s[28:31], s47 offen offset:0 lds
    v_mfma_f32_16x16x32_bf16 v[28:31], v[104:107], a[172:175], v[28:31]
    v_mfma_f32_16x16x32_bf16 v[32:35], v[104:107], a[244:247], v[32:35]
    buffer_load_dwordx4 v111, s[28:31], s47 offen offset:1024 lds
    s_waitcnt lgkmcnt(1)
    v_mfma_f32_16x16x32_bf16 v[16:19], v[216:219], v[56:59], v[16:19]
    v_mfma_f32_16x16x32_bf16 v[20:23], a[32:35], v[56:59], v[20:23]
    v_mfma_f32_16x16x32_bf16 v[24:27], a[104:107], v[56:59], v[24:27]
    buffer_load_dwordx4 v111, s[28:31], s47 offen offset:2048 lds
    v_mfma_f32_16x16x32_bf16 v[28:31], v[56:59], a[176:179], v[28:31]
    v_mfma_f32_16x16x32_bf16 v[32:35], v[56:59], a[248:251], v[32:35]
    buffer_load_dwordx4 v111, s[28:31], s47 offen offset:3072 lds
    s_waitcnt lgkmcnt(0)
    v_mfma_f32_16x16x32_bf16 v[16:19], v[220:223], v[60:63], v[16:19]
    v_mfma_f32_16x16x32_bf16 v[20:23], a[36:39], v[60:63], v[20:23]
    v_mfma_f32_16x16x32_bf16 v[24:27], a[108:111], v[60:63], v[24:27]
    s_add_u32 m0, s59, 4096
    s_add_u32 s47, s41, 4096
    buffer_load_dwordx4 v111, s[28:31], s47 offen offset:0 lds
    v_mfma_f32_16x16x32_bf16 v[28:31], v[60:63], a[180:183], v[28:31]
    v_mfma_f32_16x16x32_bf16 v[32:35], v[60:63], a[252:255], v[32:35]
    buffer_load_dwordx4 v111, s[28:31], s47 offen offset:1024 lds
    buffer_load_dwordx4 v111, s[28:31], s47 offen offset:2048 lds
    buffer_load_dwordx4 v111, s[28:31], s47 offen offset:3072 lds
    s_add_u32 m0, s59, 8192
    s_add_u32 s47, s41, 8192
    buffer_load_dwordx4 v111, s[28:31], s47 offen offset:0 lds
    s_mul_i32 s48, s36, 786432
    s_mul_i32 s18, s37, 6144
    s_add_u32 s48, s48, s18
    s_add_u32 s48, s48, 15728640
    buffer_load_dwordx4 v[80:83], v10, s[28:31], s48 offen offset:0
    buffer_load_dwordx4 v[84:87], v10, s[28:31], s48 offen offset:512
    buffer_load_dwordx4 v[88:91], v10, s[28:31], s48 offen offset:1024
    v_mul_f32 v94, v93, v36
    v_fma_f32 v16, v16, v92, -v94
    v_mul_f32 v94, v93, v37
    v_fma_f32 v17, v17, v92, -v94
    v_mul_f32 v94, v93, v38
    v_fma_f32 v18, v18, v92, -v94
    v_mul_f32 v94, v93, v39
    v_fma_f32 v19, v19, v92, -v94
    v_mul_f32 v94, v93, v44
    v_fma_f32 v24, v24, v92, -v94
    v_mul_f32 v94, v93, v45
    v_fma_f32 v25, v25, v92, -v94
    v_mul_f32 v94, v93, v46
    v_fma_f32 v26, v26, v92, -v94
    v_mul_f32 v94, v93, v47
    v_fma_f32 v27, v27, v92, -v94
    v_mul_f32 v94, v93, v40
    v_fma_f32 v20, v20, v92, -v94
    v_mul_f32 v94, v93, v41
    v_fma_f32 v21, v21, v92, -v94
    v_mul_f32 v94, v93, v42
    v_fma_f32 v22, v22, v92, -v94
    v_mul_f32 v94, v93, v43
    v_fma_f32 v23, v23, v92, -v94
    v_cvt_pk_bf16_f32 v128, v16, v17
    v_cvt_pk_bf16_f32 v129, v18, v19
    v_cvt_pk_bf16_f32 v130, v24, v25
    v_cvt_pk_bf16_f32 v132, v20, v21
    v_cvt_pk_bf16_f32 v133, v22, v23
    v_cvt_pk_bf16_f32 v134, v26, v27
    s_cmp_eq_u32 s35, 0
    s_cselect_b32 s46, 0xf149f2ca, 0
    v_mul_f32 v94, v97, v48
    v_fma_f32 v28, v28, v96, -v94
    v_mfma_f32_16x16x32_bf16 v[144:147], v[112:115], v[128:131], 0
    v_mul_f32 v94, v99, v49
    v_fma_f32 v29, v29, v98, -v94
    v_mfma_f32_16x16x32_bf16 v[148:151], v[132:135], v[128:131], 0
    v_mul_f32 v94, v101, v50
    v_fma_f32 v30, v30, v100, -v94
    v_mul_f32 v94, v103, v51
    v_fma_f32 v31, v31, v102, -v94
    v_mov_b32 v112, v132
    v_mov_b32 v113, v133
    v_mov_b32 v114, v134
    v_mul_f32 v94, v97, v52
    v_fma_f32 v32, v32, v96, -v94
    v_mul_f32 v94, v99, v53
    v_fma_f32 v33, v33, v98, -v94
    v_mul_f32 v94, v101, v54
    v_fma_f32 v34, v34, v100, -v94
    v_fma_f32 v144, v144, s52, v72
    v_fma_f32 v145, v145, s52, v73
    v_fma_f32 v146, v146, s52, v74
    v_fma_f32 v147, v147, s52, v75
    v_fma_f32 v148, v148, s52, v76
    v_fma_f32 v149, v149, s52, v77
    v_fma_f32 v150, v150, s52, v78
    v_fma_f32 v151, v151, s52, v79
    v_add_f32 v144, s46, v144
    v_add_f32 v145, s46, v145
    v_add_f32 v146, s46, v146
    v_add_f32 v147, s46, v147
    v_max3_f32 v5, v144, v145, v146
    v_max3_f32 v5, v5, v147, v148
    v_max3_f32 v5, v5, v149, v150
    v_max_f32 v5, v5, v151
    v_mov_b32 v6, v5
    v_mul_f32 v94, v103, v55
    v_fma_f32 v35, v35, v102, -v94
    v_permlane32_swap_b32 v5, v6
    v_max_f32 v5, v5, v6
    v_mov_b32 v6, v5
    s_nop 1
    v_permlane16_swap_b32 v5, v6
    v_max_f32 v5, v5, v6
    v_sub_f32 v144, v144, v5
    v_sub_f32 v145, v145, v5
    v_sub_f32 v146, v146, v5
    v_sub_f32 v147, v147, v5
    v_sub_f32 v148, v148, v5
    v_sub_f32 v149, v149, v5
    v_sub_f32 v150, v150, v5
    v_sub_f32 v151, v151, v5
    v_exp_f32 v144, v144
    v_exp_f32 v145, v145
    v_exp_f32 v146, v146
    v_exp_f32 v147, v147
    v_exp_f32 v148, v148
    v_exp_f32 v149, v149
    v_exp_f32 v150, v150
    v_exp_f32 v151, v151
    v_cvt_pk_bf16_f32 v68, v144, v145
    v_cvt_pk_bf16_f32 v69, v146, v147
    v_cvt_pk_bf16_f32 v70, v148, v149
    v_cvt_pk_bf16_f32 v71, v150, v151
    s_nop 1
    v_mfma_f32_16x16x32_bf16 v[16:19], v[116:119], v[68:71], 0
    s_mul_i32 s46, s57, 36864
    s_add_u32 s46, s46, 17301504
    s_nop 5
    v_rcp_f32 v6, v16
    v_cvt_pk_bf16_f32 v138, v28, v29
    v_cvt_pk_bf16_f32 v139, v30, v31
    s_nop 1
    v_mfma_f32_16x16x32_bf16 v[20:23], v[136:139], v[68:71], 0
    v_cvt_pk_bf16_f32 v142, v32, v33
    v_cvt_pk_bf16_f32 v143, v34, v35
    v_mov_b32 v136, v138
    v_mov_b32 v137, v139
    v_mfma_f32_16x16x32_bf16 v[24:27], v[140:143], v[68:71], 0
    s_nop 2
    v_mul_f32 v20, v6, v20
    v_mul_f32 v21, v6, v21
    v_mul_f32 v22, v6, v22
    v_mul_f32 v23, v6, v23
    v_cvt_pk_bf16_f32 v20, v20, v21
    v_cvt_pk_bf16_f32 v21, v22, v23
    buffer_store_dwordx2 v[20:21], v13, s[8:11], s46 offen sc1
    v_mov_b32 v140, v142
    v_mov_b32 v141, v143
    v_mul_f32 v24, v6, v24
    v_mul_f32 v25, v6, v25
    v_cvt_pk_bf16_f32 v24, v24, v25
    s_mov_b64 exec, 0xffff
    buffer_store_dword v24, v14, s[8:11], s46 offen sc1
    s_mov_b64 exec, -1
    s_mul_i32 s43, s57, 22528
    s_add_u32 s43, s43, s49
    s_cmp_lg_u32 s62, 0
    s_cbranch_scc1 Laq_item
    buffer_load_dword v2, v1, s[8:11], s42 offen sc1
    s_waitcnt vmcnt(0)
    s_cmp_ge_u32 s37, 64
    s_cbranch_scc1 Laq_fin
    v_cmp_eq_u32 vcc, 0, v2
    s_nop 0
    s_cbranch_vccnz Laq_pub
    s_add_u32 m0, s59, 0
    s_add_u32 s47, s41, 0
    buffer_load_dwordx4 v111, s[8:11], s47 offen offset:0 lds
    buffer_load_dwordx4 v111, s[8:11], s47 offen offset:1024 lds
    buffer_load_dwordx4 v111, s[8:11], s47 offen offset:2048 lds
    buffer_load_dwordx4 v111, s[8:11], s47 offen offset:3072 lds
    s_add_u32 m0, s59, 4096
    s_add_u32 s47, s41, 4096
    buffer_load_dwordx4 v111, s[8:11], s47 offen offset:0 lds
    buffer_load_dwordx4 v111, s[8:11], s47 offen offset:1024 lds
    buffer_load_dwordx4 v111, s[8:11], s47 offen offset:2048 lds
    buffer_load_dwordx4 v111, s[8:11], s47 offen offset:3072 lds
    s_add_u32 m0, s59, 8192
    s_add_u32 s47, s41, 8192
    buffer_load_dwordx4 v111, s[8:11], s47 offen offset:0 lds
    s_mul_i32 s48, s36, 786432
    s_mul_i32 s18, s37, 6144
    s_add_u32 s48, s48, s18
    s_add_u32 s48, s48, 15728640
    buffer_load_dwordx4 v[80:83], v10, s[8:11], s48 offen offset:0
    buffer_load_dwordx4 v[84:87], v10, s[8:11], s48 offen offset:512
    buffer_load_dwordx4 v[88:91], v10, s[8:11], s48 offen offset:1024
    s_cmp_lg_u32 s43, 0
    s_cselect_b64 exec, 1, 0
    buffer_store_dword v3, v4, s[8:11], s43 offen sc1
    s_mov_b64 exec, -1
    s_mov_b32 s43, 0
    s_waitcnt vmcnt(1)
    s_branch Laq_go
Laq_fin:
    s_cmp_lg_u32 s43, 0
    s_cselect_b64 exec, 1, 0
    buffer_store_dword v3, v4, s[8:11], s43 offen sc1
    s_mov_b64 exec, -1
    s_mov_b32 s43, 0
    s_branch L_role_aq_exit
Laq_pub:
    s_cmp_lg_u32 s43, 0
    s_cselect_b64 exec, 1, 0
    buffer_store_dword v3, v4, s[8:11], s43 offen sc1
    s_mov_b64 exec, -1
    s_mov_b32 s43, 0
Laq_poll:
    s_mov_b32 s16, 0
Laq_pl:
    buffer_load_dword v2, v1, s[8:11], s42 offen sc1
    s_add_u32 s16, s16, 1
    s_cmp_gt_u32 s16, 100000
    s_cbranch_scc1 L_role_aq_abort
    s_waitcnt vmcnt(0)
    v_cmp_eq_u32 vcc, 0, v2
    s_nop 0
    s_cbranch_vccz Laq_pld
    s_sleep 4
    s_branch Laq_pl
Laq_pld:
    s_add_u32 m0, s59, 0
    s_add_u32 s47, s41, 0
    buffer_load_dwordx4 v111, s[8:11], s47 offen offset:0 lds
    buffer_load_dwordx4 v111, s[8:11], s47 offen offset:1024 lds
    buffer_load_dwordx4 v111, s[8:11], s47 offen offset:2048 lds
    buffer_load_dwordx4 v111, s[8:11], s47 offen offset:3072 lds
    s_add_u32 m0, s59, 4096
    s_add_u32 s47, s41, 4096
    buffer_load_dwordx4 v111, s[8:11], s47 offen offset:0 lds
    buffer_load_dwordx4 v111, s[8:11], s47 offen offset:1024 lds
    buffer_load_dwordx4 v111, s[8:11], s47 offen offset:2048 lds
    buffer_load_dwordx4 v111, s[8:11], s47 offen offset:3072 lds
    s_add_u32 m0, s59, 8192
    s_add_u32 s47, s41, 8192
    buffer_load_dwordx4 v111, s[8:11], s47 offen offset:0 lds
    s_mul_i32 s48, s36, 786432
    s_mul_i32 s18, s37, 6144
    s_add_u32 s48, s48, s18
    s_add_u32 s48, s48, 15728640
    buffer_load_dwordx4 v[80:83], v10, s[8:11], s48 offen offset:0
    buffer_load_dwordx4 v[84:87], v10, s[8:11], s48 offen offset:512
    buffer_load_dwordx4 v[88:91], v10, s[8:11], s48 offen offset:1024
    s_waitcnt vmcnt(0)
    s_branch Laq_go
L_role_aq_abort:
    s_waitcnt lgkmcnt(0)
    s_mov_b64 exec, -1
    v_mov_b32 v0, 60
    s_lshl_b32 s5, s3, 8
    s_or_b32 s5, s5, s4
    s_or_b32 s5, s5, 0x10000
    v_mov_b32 v1, s5
    global_store_dword v0, v1, s[12:13]
    s_endpgm
L_role_aq_exit:
    s_and_b32 s6, s15, 15
    s_add_u32 s6, s6, s14
    s_cmp_lg_u32 s6, 0
    s_cbranch_scc1 L_role_aq_nowb
    s_waitcnt vmcnt(0)
    buffer_wbl2 sc1
    s_waitcnt vmcnt(0)
L_role_aq_nowb:
    s_endpgm
.p2align 6
L_role_ta:
    v_and_b32 v5, 63, v0
    v_lshlrev_b32 v0, 4, v5
    v_and_b32 v7, 15, v5
    v_lshrrev_b32 v8, 4, v5
    v_min_u32 v1, 11, v5
    v_lshrrev_b32 v6, 2, v1
    v_and_b32 v1, 3, v1
    v_lshlrev_b32 v1, 2, v1
    v_lshl_add_u32 v1, v6, 7, v1
    v_mov_b32 v3, 1
    v_mov_b32 v4, 0
    s_mov_b32 s44, 0x05040100
    s_mov_b32 s45, 0x07060302
    s_lshl_b32 s17, s15, 2
    s_add_u32 s17, s17, s14
    s_lshr_b32 s36, s17, 5
    s_and_b32 s50, s17, 31
    s_mov_b32 s37, 0
    s_mov_b32 s52, 0x3e0293ee
    v_lshrrev_b32 v5, 2, v7
    v_and_b32 v6, 1, v7
    v_lshl_add_u32 v5, v5, 1, v6
    v_lshlrev_b32 v9, 8, v5
    v_lshl_add_u32 v9, v8, 4, v9
    v_lshrrev_b32 v10, 1, v0
    v_mov_b32 v6, 0xf149f2ca
    v_mov_b32 v21, 0
    v_mov_b32 v22, 0
    s_mul_i32 s42, s36, 1441792
    s_lshl_b32 s17, s50, 9
    s_add_u32 s42, s42, s17
    s_add_u32 s42, s42, 185600
    s_mul_i32 s51, s36, 50331648
    s_lshl_b32 s17, s50, 13
    s_add_u32 s51, s51, s17
    s_add_u32 s51, s51, 44040192
    s_lshl_b32 s47, s36, 11
    s_add_u32 s47, s47, s50
    s_lshl_b32 s48, s47, 13
    s_add_u32 s48, s48, 144703488
    s_mul_i32 s35, s36, 256
    s_add_u32 s35, s35, s50
    s_lshl_b32 s35, s35, 12
    s_add_u32 s35, s35, 27262976
    s_mul_i32 s43, s36, 1441792
    s_lshr_b32 s17, s50, 2
    s_lshl_b32 s17, s17, 7
    s_add_u32 s43, s43, s17
    s_lshl_b32 s17, s14, 2
    s_add_u32 s43, s43, s17
    s_add_u32 s43, s43, 184448
    s_mov_b32 s28, s8
    s_mov_b32 s29, s9
    s_mov_b32 s30, 0
    s_mov_b32 s31, 0x00020000
    s_mov_b32 s39, 0
    s_mov_b32 s49, 0
    s_mov_b32 s66, 0
    s_lshl_b32 s47, s36, 2
    s_add_u32 s47, s47, 192
    v_mov_b32 v16, 0x3f803f80
    v_lshl_add_u32 v5, v8, 2, 0
    v_cmp_le_u32 vcc, v5, v7
    s_nop 1
    v_cndmask_b32 v236, v6, v4, vcc
    v_mov_b32 v17, 0x3f803f80
    v_lshl_add_u32 v5, v8, 2, 1
    v_cmp_le_u32 vcc, v5, v7
    s_nop 1
    v_cndmask_b32 v237, v6, v4, vcc
    v_mov_b32 v18, 0x3f803f80
    v_lshl_add_u32 v5, v8, 2, 2
    v_cmp_le_u32 vcc, v5, v7
    s_nop 1
    v_cndmask_b32 v238, v6, v4, vcc
    v_mov_b32 v19, 0x3f803f80
    v_lshl_add_u32 v5, v8, 2, 3
    v_cmp_le_u32 vcc, v5, v7
    s_nop 1
    v_cndmask_b32 v239, v6, v4, vcc
    s_cmp_lg_u32 s14, 0
    s_cbranch_scc1 Lta_ini_d
    v_mov_b32 v5, 160
    s_mov_b32 s16, 0
Lta_ini:
    global_load_dword v6, v5, s[12:13] sc1
    s_add_u32 s16, s16, 1
    s_cmp_gt_u32 s16, 100000
    s_cbranch_scc1 L_role_ta_abort
    s_waitcnt vmcnt(0)
    v_cmp_gt_u32 vcc, 123, v6
    s_nop 0
    s_cbranch_vccz Lta_ini_d
    s_sleep 64
    s_branch Lta_ini
Lta_ini_d:
    s_barrier
    s_cmp_lg_u32 s14, 0
    s_cbranch_scc1 Lta_team_d
    v_mov_b32 v5, s47
    s_mov_b32 s16, 0
Lta_team:
    global_load_dword v6, v5, s[12:13] sc1
    s_add_u32 s16, s16, 1
    s_cmp_gt_u32 s16, 100000
    s_cbranch_scc1 L_role_ta_abort
    s_waitcnt vmcnt(0)
    v_cmp_gt_u32 vcc, 32, v6
    s_nop 0
    s_cbranch_vccz Lta_team_d
    s_sleep 64
    s_branch Lta_team
Lta_team_d:
    s_barrier
    v_mbcnt_lo_u32_b32 v5, -1, 0
    v_mbcnt_hi_u32_b32 v5, -1, v5
    v_and_b32 v6, 1, v5
    v_lshlrev_b32 v6, 7, v6
    v_lshlrev_b32 v5, 1, v5
    v_and_or_b32 v5, v5, 12, v6
    s_mov_b32 s16, 0
Lta_pure:
    global_load_dword v6, v5, s[12:13] sc1
    s_add_u32 s16, s16, 1
    s_cmp_gt_u32 s16, 100000
    s_cbranch_scc1 L_role_ta_abort
    s_mov_b32 s6, 0
    s_waitcnt vmcnt(0)
    v_readlane_b32 s7, v6, 0
    s_nop 0
    s_add_u32 s6, s6, s7
    v_readlane_b32 s7, v6, 1
    s_nop 0
    s_add_u32 s6, s6, s7
    v_readlane_b32 s7, v6, 2
    s_nop 0
    s_add_u32 s6, s6, s7
    v_readlane_b32 s7, v6, 3
    s_nop 0
    s_add_u32 s6, s6, s7
    v_readlane_b32 s7, v6, 4
    s_nop 0
    s_add_u32 s6, s6, s7
    v_readlane_b32 s7, v6, 5
    s_nop 0
    s_add_u32 s6, s6, s7
    v_readlane_b32 s7, v6, 6
    s_nop 0
    s_add_u32 s6, s6, s7
    v_readlane_b32 s7, v6, 7
    s_nop 0
    s_add_u32 s6, s6, s7
    v_readlane_b32 s7, v6, s3
    s_nop 0
    s_cmp_ge_u32 s7, 32
    s_cselect_b32 s61, 1, 0
    s_cselect_b32 s6, 256, s6
    s_cmp_lt_u32 s6, 256
    s_cbranch_scc1 Lta_pure
LtaF0:
    s_sub_u32 s17, s37, 33
    s_mul_i32 s18, s17, 43
    s_lshr_b32 s18, s18, 7
    s_mul_i32 s18, s18, 3
    s_cmp_eq_u32 s18, s17
    s_cselect_b32 s18, 1, 0
    s_cmp_lt_u32 s37, 34
    s_cselect_b32 s18, 1, s18
    s_cmp_eq_u32 s36, 0
    s_cselect_b32 s18, 1, s18
    s_and_b32 s18, s18, s61
    s_cbranch_scc0 LtaS0_in
LtaF0_in:
    s_and_b32 s17, s37, 7
    s_mul_i32 s17, s17, 131072
    s_add_u32 s47, s35, s17
    s_bfe_u32 s34, s37, 65539
    s_cmp_eq_u32 s39, 1
    s_cbranch_scc1 LtaF0_have
    s_waitcnt vmcnt(0)
    s_and_b32 s17, s49, s66
    s_cselect_b64 exec, 1, 0
    buffer_store_dword v3, v4, s[8:11], s43 offen
    s_andn2_b32 s17, s49, s66
    s_cselect_b64 exec, 1, 0
    buffer_store_dword v3, v4, s[8:11], s43 offen sc1
    s_mov_b64 exec, -1
    s_add_u32 s43, s43, s49
    s_mov_b32 s49, 0
    s_mov_b32 s16, 0
LtaF0_f_2:
    buffer_load_dword v2, v1, s[8:11], s42 offen sc1
    s_add_u32 s16, s16, 1
    s_cmp_gt_u32 s16, 100000
    s_cbranch_scc1 L_role_ta_abort
    s_waitcnt vmcnt(0)
    v_cmp_eq_u32 vcc, 0, v2
    s_nop 0
    s_cbranch_vccz LtaF0_fd_3
    s_sleep 4
    s_branch LtaF0_f_2
LtaF0_fd_3:
    s_add_u32 s46, s51, 0
    buffer_load_dwordx4 v[140:143], v0, s[8:11], s46 offen offset:0
    buffer_load_dwordx4 v[144:147], v0, s[8:11], s46 offen offset:1024
    buffer_load_dwordx4 v[148:151], v0, s[8:11], s46 offen offset:2048
    buffer_load_dwordx4 v[152:155], v0, s[8:11], s46 offen offset:3072
    s_add_u32 s46, s51, 4096
    buffer_load_dwordx4 v[156:159], v0, s[8:11], s46 offen offset:0
    buffer_load_dwordx4 v[160:163], v0, s[8:11], s46 offen offset:1024
    buffer_load_dwordx4 v[164:167], v0, s[8:11], s46 offen offset:2048
    buffer_load_dwordx4 v[168:171], v0, s[8:11], s46 offen offset:3072
    s_add_u32 s46, s51, 16777216
    buffer_load_dwordx4 v[172:175], v0, s[8:11], s46 offen offset:0
    buffer_load_dwordx4 v[176:179], v0, s[8:11], s46 offen offset:1024
    buffer_load_dwordx4 v[180:183], v0, s[8:11], s46 offen offset:2048
    buffer_load_dwordx4 v[184:187], v0, s[8:11], s46 offen offset:3072
    s_add_u32 s46, s51, 16781312
    buffer_load_dwordx4 v[188:191], v0, s[8:11], s46 offen offset:0
    buffer_load_dwordx4 v[192:195], v0, s[8:11], s46 offen offset:1024
    buffer_load_dwordx4 v[196:199], v0, s[8:11], s46 offen offset:2048
    buffer_load_dwordx4 v[200:203], v0, s[8:11], s46 offen offset:3072
    s_add_u32 s46, s51, 33554432
    buffer_load_dwordx4 v[204:207], v0, s[8:11], s46 offen offset:0
    buffer_load_dwordx4 v[208:211], v0, s[8:11], s46 offen offset:1024
    buffer_load_dwordx4 v[212:215], v0, s[8:11], s46 offen offset:2048
    buffer_load_dwordx4 v[216:219], v0, s[8:11], s46 offen offset:3072
    s_add_u32 s46, s51, 33558528
    buffer_load_dwordx4 v[220:223], v0, s[8:11], s46 offen offset:0
    buffer_load_dwordx4 v[224:227], v0, s[8:11], s46 offen offset:1024
    buffer_load_dwordx4 v[228:231], v0, s[8:11], s46 offen offset:2048
    buffer_load_dwordx4 v[232:235], v0, s[8:11], s46 offen offset:3072
LtaF0_have:
    s_add_u32 s17, s42, 22528
    buffer_load_dword v15, v1, s[8:11], s17 offen sc1
    buffer_load_dwordx4 v[52:55], v9, s[8:11], s47 offen offset:0 sc1
    buffer_load_dwordx4 v[56:59], v9, s[8:11], s47 offen offset:64 sc1
    buffer_load_dwordx4 v[60:63], v9, s[8:11], s47 offen offset:128 sc1
    buffer_load_dwordx4 v[64:67], v9, s[8:11], s47 offen offset:192 sc1
    buffer_load_dwordx2 v[68:69], v10, s[8:11], s47 offen offset:2048 sc1
    buffer_load_dwordx2 v[70:71], v10, s[8:11], s47 offen offset:2560 sc1
    buffer_load_dwordx2 v[72:73], v10, s[8:11], s47 offen offset:3072 sc1
    buffer_load_dwordx2 v[74:75], v10, s[8:11], s47 offen offset:3584 sc1
    s_waitcnt vmcnt(9)
    s_and_b32 s17, s49, s66
    s_cselect_b64 exec, 1, 0
    buffer_store_dword v3, v4, s[8:11], s43 offen
    s_andn2_b32 s17, s49, s66
    s_cselect_b64 exec, 1, 0
    buffer_store_dword v3, v4, s[8:11], s43 offen sc1
    s_mov_b64 exec, -1
    s_add_u32 s43, s43, s49
    s_mov_b32 s49, 0
    v_mfma_f32_16x16x32_bf16 v[32:35], v[172:175], v[140:143], 0
    v_mfma_f32_16x16x32_bf16 v[36:39], v[172:175], v[144:147], 0
    v_mfma_f32_16x16x32_bf16 v[40:43], v[176:179], v[144:147], 0
    v_mfma_f32_16x16x32_bf16 v[32:35], v[180:183], v[148:151], v[32:35]
    v_mfma_f32_16x16x32_bf16 v[36:39], v[180:183], v[152:155], v[36:39]
    v_mfma_f32_16x16x32_bf16 v[40:43], v[184:187], v[152:155], v[40:43]
    v_mfma_f32_16x16x32_bf16 v[32:35], v[188:191], v[156:159], v[32:35]
    v_mfma_f32_16x16x32_bf16 v[36:39], v[188:191], v[160:163], v[36:39]
    v_mfma_f32_16x16x32_bf16 v[40:43], v[192:195], v[160:163], v[40:43]
    v_mfma_f32_16x16x32_bf16 v[32:35], v[196:199], v[164:167], v[32:35]
    v_mfma_f32_16x16x32_bf16 v[36:39], v[196:199], v[168:171], v[36:39]
    v_mfma_f32_16x16x32_bf16 v[40:43], v[200:203], v[168:171], v[40:43]
    s_waitcnt vmcnt(2)
    v_cmp_eq_u32 vcc, 0, v15
    s_add_u32 s51, s51, 262144
    s_add_u32 s42, s42, 22528
    s_add_u32 s37, s37, 1
    s_cmp_eq_u64 vcc, 0
    s_cselect_b32 s39, 1, 0
    s_cmp_lt_u32 s37, 64
    s_cselect_b32 s39, s39, 0
    s_cmp_eq_u32 s39, 1
    s_cselect_b32 s30, 268435456, 0
    v_fma_f32 v32, v32, s52, v236
    v_fma_f32 v33, v33, s52, v237
    v_fma_f32 v34, v34, s52, v238
    v_fma_f32 v35, v35, s52, v239
    v_mul_f32 v36, s52, v36
    v_mul_f32 v37, s52, v37
    v_mul_f32 v38, s52, v38
    v_mul_f32 v39, s52, v39
    v_fma_f32 v40, v40, s52, v236
    v_fma_f32 v41, v41, s52, v237
    v_fma_f32 v42, v42, s52, v238
    v_fma_f32 v43, v43, s52, v239
    v_xor_b32 v5, s34, v52
    v_xor_b32 v6, s34, v56
    v_or_b32 v5, v5, v6
    v_xor_b32 v6, s34, v60
    v_or_b32 v5, v5, v6
    v_xor_b32 v6, s34, v64
    v_or_b32 v5, v5, v6
    v_xor_b32 v6, s34, v68
    v_or_b32 v5, v5, v6
    v_xor_b32 v6, s34, v70
    v_or_b32 v5, v5, v6
    v_xor_b32 v6, s34, v72
    v_or_b32 v5, v5, v6
    v_xor_b32 v6, s34, v74
    v_or_b32 v5, v5, v6
    v_and_b32 v5, 1, v5
    v_cmp_ne_u32 vcc, 0, v5
    s_nop 0
    s_cbranch_vccz LtaF0_r
    s_mov_b32 s16, 0
LtaF0_rp:
    buffer_load_dwordx4 v[52:55], v9, s[8:11], s47 offen offset:0 sc1
    buffer_load_dwordx4 v[56:59], v9, s[8:11], s47 offen offset:64 sc1
    buffer_load_dwordx4 v[60:63], v9, s[8:11], s47 offen offset:128 sc1
    buffer_load_dwordx4 v[64:67], v9, s[8:11], s47 offen offset:192 sc1
    buffer_load_dwordx2 v[68:69], v10, s[8:11], s47 offen offset:2048 sc1
    buffer_load_dwordx2 v[70:71], v10, s[8:11], s47 offen offset:2560 sc1
    buffer_load_dwordx2 v[72:73], v10, s[8:11], s47 offen offset:3072 sc1
    buffer_load_dwordx2 v[74:75], v10, s[8:11], s47 offen offset:3584 sc1
    s_add_u32 s16, s16, 1
    s_cmp_gt_u32 s16, 100000
    s_cbranch_scc1 L_role_ta_abort
    s_waitcnt vmcnt(0)
    v_xor_b32 v5, s34, v52
    v_xor_b32 v6, s34, v56
    v_or_b32 v5, v5, v6
    v_xor_b32 v6, s34, v60
    v_or_b32 v5, v5, v6
    v_xor_b32 v6, s34, v64
    v_or_b32 v5, v5, v6
    v_xor_b32 v6, s34, v68
    v_or_b32 v5, v5, v6
    v_xor_b32 v6, s34, v70
    v_or_b32 v5, v5, v6
    v_xor_b32 v6, s34, v72
    v_or_b32 v5, v5, v6
    v_xor_b32 v6, s34, v74
    v_or_b32 v5, v5, v6
    v_and_b32 v5, 1, v5
    v_cmp_ne_u32 vcc, 0, v5
    s_nop 0
    s_cbranch_vccz LtaF0_r
    s_sleep 2
    s_branch LtaF0_rp
LtaF0_r:
    s_and_b32 s17, s37, 3
    s_cmp_eq_u32 s17, 0
    s_cselect_b32 s17, s36, 0
    s_cmp_lg_u32 s17, 0
    s_cselect_b64 exec, 1, 0
    s_sub_u32 s17, s42, 22528
    buffer_store_dword v3, v4, s[8:11], s17 offen offset:384 sc1
    s_mov_b64 exec, -1
    s_add_u32 s46, s51, 0
    buffer_load_dwordx4 a[0:3], v0, s[28:31], s46 offen offset:0
    buffer_load_dwordx4 a[4:7], v0, s[28:31], s46 offen offset:1024
    v_mfma_f32_16x16x32_bf16 v[44:47], v[52:55], v[140:143], 0
    v_mfma_f32_16x16x32_bf16 v[48:51], v[52:55], v[144:147], 0
    v_mfma_f32_16x16x32_bf16 v[44:47], v[56:59], v[148:151], v[44:47]
    v_mfma_f32_16x16x32_bf16 v[48:51], v[56:59], v[152:155], v[48:51]
    v_mfma_f32_16x16x32_bf16 v[44:47], v[60:63], v[156:159], v[44:47]
    v_mfma_f32_16x16x32_bf16 v[48:51], v[60:63], v[160:163], v[48:51]
    v_mfma_f32_16x16x32_bf16 v[44:47], v[64:67], v[164:167], v[44:47]
    v_mfma_f32_16x16x32_bf16 v[48:51], v[64:67], v[168:171], v[48:51]
    v_max3_f32 v5, v32, v33, v34
    v_max_f32 v5, v5, v35
    s_nop 4
    v_mul_f32 v44, s52, v44
    v_mul_f32 v45, s52, v45
    v_max3_f32 v5, v5, v44, v45
    v_mov_b32 v6, v5
    buffer_load_dwordx4 a[8:11], v0, s[28:31], s46 offen offset:2048
    s_nop 0
    v_permlane32_swap_b32 v5, v6
    v_max_f32 v5, v5, v6
    v_mov_b32 v6, v5
    buffer_load_dwordx4 a[12:15], v0, s[28:31], s46 offen offset:3072
    s_nop 0
    v_permlane16_swap_b32 v5, v6
    v_max_f32 v5, v5, v6
    v_sub_f32 v32, v32, v5
    v_sub_f32 v33, v33, v5
    v_sub_f32 v34, v34, v5
    v_sub_f32 v35, v35, v5
    v_sub_f32 v44, v44, v5
    v_sub_f32 v45, v45, v5
    v_exp_f32 v32, v32
    v_exp_f32 v33, v33
    v_exp_f32 v34, v34
    v_exp_f32 v35, v35
    v_exp_f32 v44, v44
    v_exp_f32 v45, v45
    v_cvt_pk_bf16_f32 v24, v32, v33
    v_cvt_pk_bf16_f32 v25, v34, v35
    v_mov_b32 v26, 0
    v_mov_b32 v27, 0
    v_cvt_pk_bf16_f32 v20, v44, v45
    v_cvt_pk_bf16_f32 v23, v44, v45
    v_mfma_f32_16x16x32_bf16 v[28:31], v[16:19], v[24:27], 0
    v_mfma_f32_16x16x32_bf16 v[76:79], v[204:207], v[24:27], 0
    v_mfma_f32_16x16x32_bf16 v[80:83], v[208:211], v[24:27], 0
    s_add_u32 s46, s51, 4096
    buffer_load_dwordx4 a[16:19], v0, s[28:31], s46 offen offset:0
    v_mfma_f32_16x16x32_bf16 v[84:87], v[212:215], v[24:27], 0
    v_mfma_f32_16x16x32_bf16 v[88:91], v[216:219], v[24:27], 0
    buffer_load_dwordx4 a[20:23], v0, s[28:31], s46 offen offset:1024
    v_mfma_f32_16x16x32_bf16 v[92:95], v[220:223], v[24:27], 0
    v_mfma_f32_16x16x32_bf16 v[96:99], v[224:227], v[24:27], 0
    buffer_load_dwordx4 a[24:27], v0, s[28:31], s46 offen offset:2048
    v_mfma_f32_16x16x16_bf16 v[28:31], v[16:17], v[20:21], v[28:31]
    v_mfma_f32_16x16x32_bf16 v[100:103], v[228:231], v[24:27], 0
    v_mfma_f32_16x16x32_bf16 v[104:107], v[232:235], v[24:27], 0
    buffer_load_dwordx4 a[28:31], v0, s[28:31], s46 offen offset:3072
    v_mfma_f32_16x16x16_bf16 v[76:79], v[68:69], v[20:21], v[76:79]
    v_mfma_f32_16x16x16_bf16 v[80:83], v[68:69], v[22:23], v[80:83]
    s_nop 2
    v_rcp_f32 v6, v28
    v_mfma_f32_16x16x16_bf16 v[84:87], v[70:71], v[20:21], v[84:87]
    v_mfma_f32_16x16x16_bf16 v[88:91], v[70:71], v[22:23], v[88:91]
    s_nop 0
    v_mul_f32 v76, v6, v76
    v_mul_f32 v80, v6, v80
    v_cvt_pk_bf16_f32 v108, v76, v80
    v_mul_f32 v77, v6, v77
    v_mul_f32 v81, v6, v81
    v_cvt_pk_bf16_f32 v109, v77, v81
    v_mul_f32 v78, v6, v78
    v_mul_f32 v82, v6, v82
    v_cvt_pk_bf16_f32 v110, v78, v82
    v_mul_f32 v79, v6, v79
    v_mul_f32 v83, v6, v83
    v_cvt_pk_bf16_f32 v111, v79, v83
    s_add_u32 s17, s48, 0
    buffer_store_dwordx4 v[108:111], v0, s[8:11], s17 offen offset:0
    s_add_u32 s46, s51, 16777216
    buffer_load_dwordx4 a[32:35], v0, s[28:31], s46 offen offset:0
    v_mfma_f32_16x16x16_bf16 v[92:95], v[72:73], v[20:21], v[92:95]
    v_mfma_f32_16x16x16_bf16 v[96:99], v[72:73], v[22:23], v[96:99]
    v_mul_f32 v84, v6, v84
    v_mul_f32 v88, v6, v88
    v_cvt_pk_bf16_f32 v112, v84, v88
    v_mul_f32 v85, v6, v85
    v_mul_f32 v89, v6, v89
    v_cvt_pk_bf16_f32 v113, v85, v89
    v_mul_f32 v86, v6, v86
    v_mul_f32 v90, v6, v90
    v_cvt_pk_bf16_f32 v114, v86, v90
    v_mul_f32 v87, v6, v87
    v_mul_f32 v91, v6, v91
    v_cvt_pk_bf16_f32 v115, v87, v91
    buffer_store_dwordx4 v[112:115], v0, s[8:11], s17 offen offset:2048
    buffer_load_dwordx4 a[36:39], v0, s[28:31], s46 offen offset:1024
    v_mfma_f32_16x16x16_bf16 v[100:103], v[74:75], v[20:21], v[100:103]
    v_mfma_f32_16x16x16_bf16 v[104:107], v[74:75], v[22:23], v[104:107]
    v_mul_f32 v92, v6, v92
    v_mul_f32 v96, v6, v96
    v_cvt_pk_bf16_f32 v116, v92, v96
    v_mul_f32 v93, v6, v93
    v_mul_f32 v97, v6, v97
    v_cvt_pk_bf16_f32 v117, v93, v97
    v_mul_f32 v94, v6, v94
    v_mul_f32 v98, v6, v98
    v_cvt_pk_bf16_f32 v118, v94, v98
    v_mul_f32 v95, v6, v95
    v_mul_f32 v99, v6, v99
    v_cvt_pk_bf16_f32 v119, v95, v99
    s_add_u32 s17, s48, 4096
    buffer_store_dwordx4 v[116:119], v0, s[8:11], s17 offen offset:0
    buffer_load_dwordx4 a[40:43], v0, s[28:31], s46 offen offset:2048
    v_mul_f32 v100, v6, v100
    v_mul_f32 v104, v6, v104
    v_cvt_pk_bf16_f32 v120, v100, v104
    v_mul_f32 v101, v6, v101
    v_mul_f32 v105, v6, v105
    v_cvt_pk_bf16_f32 v121, v101, v105
    v_mul_f32 v102, v6, v102
    v_mul_f32 v106, v6, v106
    v_cvt_pk_bf16_f32 v122, v102, v106
    v_mul_f32 v103, v6, v103
    v_mul_f32 v107, v6, v107
    v_cvt_pk_bf16_f32 v123, v103, v107
    buffer_store_dwordx4 v[120:123], v0, s[8:11], s17 offen offset:2048
    buffer_load_dwordx4 a[44:47], v0, s[28:31], s46 offen offset:3072
    v_max3_f32 v5, v36, v37, v38
    v_max_f32 v5, v5, v39
    v_max3_f32 v5, v5, v40, v41
    v_max3_f32 v5, v5, v42, v43
    v_mul_f32 v48, s52, v48
    v_mul_f32 v49, s52, v49
    v_max3_f32 v5, v5, v48, v49
    v_mov_b32 v6, v5
    s_add_u32 s46, s51, 16781312
    buffer_load_dwordx4 a[48:51], v0, s[28:31], s46 offen offset:0
    v_permlane32_swap_b32 v5, v6
    v_max_f32 v5, v5, v6
    v_mov_b32 v6, v5
    buffer_load_dwordx4 a[52:55], v0, s[28:31], s46 offen offset:1024
    s_nop 0
    v_permlane16_swap_b32 v5, v6
    v_max_f32 v5, v5, v6
    v_sub_f32 v36, v36, v5
    v_sub_f32 v37, v37, v5
    v_sub_f32 v38, v38, v5
    v_sub_f32 v39, v39, v5
    v_sub_f32 v40, v40, v5
    v_sub_f32 v41, v41, v5
    v_sub_f32 v42, v42, v5
    v_sub_f32 v43, v43, v5
    v_sub_f32 v48, v48, v5
    v_sub_f32 v49, v49, v5
    v_exp_f32 v36, v36
    v_exp_f32 v37, v37
    v_exp_f32 v38, v38
    v_exp_f32 v39, v39
    v_exp_f32 v40, v40
    v_exp_f32 v41, v41
    v_exp_f32 v42, v42
    v_exp_f32 v43, v43
    v_exp_f32 v48, v48
    v_exp_f32 v49, v49
    v_cvt_pk_bf16_f32 v24, v36, v37
    v_cvt_pk_bf16_f32 v25, v38, v39
    v_cvt_pk_bf16_f32 v26, v40, v41
    v_cvt_pk_bf16_f32 v27, v42, v43
    v_cvt_pk_bf16_f32 v20, v48, v49
    v_cvt_pk_bf16_f32 v23, v48, v49
    v_mfma_f32_16x16x32_bf16 v[28:31], v[16:19], v[24:27], 0
    v_mfma_f32_16x16x32_bf16 v[76:79], v[204:207], v[24:27], 0
    v_mfma_f32_16x16x32_bf16 v[80:83], v[208:211], v[24:27], 0
    buffer_load_dwordx4 a[56:59], v0, s[28:31], s46 offen offset:2048
    v_mfma_f32_16x16x32_bf16 v[84:87], v[212:215], v[24:27], 0
    v_mfma_f32_16x16x32_bf16 v[88:91], v[216:219], v[24:27], 0
    buffer_load_dwordx4 a[60:63], v0, s[28:31], s46 offen offset:3072
    v_mfma_f32_16x16x32_bf16 v[92:95], v[220:223], v[24:27], 0
    v_mfma_f32_16x16x32_bf16 v[96:99], v[224:227], v[24:27], 0
    s_add_u32 s46, s51, 33554432
    buffer_load_dwordx4 a[64:67], v0, s[28:31], s46 offen offset:0
    v_mfma_f32_16x16x16_bf16 v[28:31], v[16:17], v[20:21], v[28:31]
    v_mfma_f32_16x16x32_bf16 v[100:103], v[228:231], v[24:27], 0
    v_mfma_f32_16x16x32_bf16 v[104:107], v[232:235], v[24:27], 0
    buffer_load_dwordx4 a[68:71], v0, s[28:31], s46 offen offset:1024
    v_mfma_f32_16x16x16_bf16 v[76:79], v[68:69], v[20:21], v[76:79]
    v_mfma_f32_16x16x16_bf16 v[80:83], v[68:69], v[22:23], v[80:83]
    s_nop 2
    v_rcp_f32 v6, v28
    v_mfma_f32_16x16x16_bf16 v[84:87], v[70:71], v[20:21], v[84:87]
    v_mfma_f32_16x16x16_bf16 v[88:91], v[70:71], v[22:23], v[88:91]
    s_nop 0
    v_mul_f32 v76, v6, v76
    v_mul_f32 v80, v6, v80
    v_cvt_pk_bf16_f32 v124, v76, v80
    v_mul_f32 v77, v6, v77
    v_mul_f32 v81, v6, v81
    v_cvt_pk_bf16_f32 v125, v77, v81
    v_mul_f32 v78, v6, v78
    v_mul_f32 v82, v6, v82
    v_cvt_pk_bf16_f32 v126, v78, v82
    v_mul_f32 v79, v6, v79
    v_mul_f32 v83, v6, v83
    v_cvt_pk_bf16_f32 v127, v79, v83
    s_add_u32 s17, s48, 0
    buffer_store_dwordx4 v[124:127], v0, s[8:11], s17 offen offset:1024
    buffer_load_dwordx4 a[72:75], v0, s[28:31], s46 offen offset:2048
    v_mfma_f32_16x16x16_bf16 v[92:95], v[72:73], v[20:21], v[92:95]
    v_mfma_f32_16x16x16_bf16 v[96:99], v[72:73], v[22:23], v[96:99]
    v_mul_f32 v84, v6, v84
    v_mul_f32 v88, v6, v88
    v_cvt_pk_bf16_f32 v128, v84, v88
    v_mul_f32 v85, v6, v85
    v_mul_f32 v89, v6, v89
    v_cvt_pk_bf16_f32 v129, v85, v89
    v_mul_f32 v86, v6, v86
    v_mul_f32 v90, v6, v90
    v_cvt_pk_bf16_f32 v130, v86, v90
    v_mul_f32 v87, v6, v87
    v_mul_f32 v91, v6, v91
    v_cvt_pk_bf16_f32 v131, v87, v91
    buffer_store_dwordx4 v[128:131], v0, s[8:11], s17 offen offset:3072
    buffer_load_dwordx4 a[76:79], v0, s[28:31], s46 offen offset:3072
    v_mfma_f32_16x16x16_bf16 v[100:103], v[74:75], v[20:21], v[100:103]
    v_mfma_f32_16x16x16_bf16 v[104:107], v[74:75], v[22:23], v[104:107]
    v_mul_f32 v92, v6, v92
    v_mul_f32 v96, v6, v96
    v_cvt_pk_bf16_f32 v132, v92, v96
    v_mul_f32 v93, v6, v93
    v_mul_f32 v97, v6, v97
    v_cvt_pk_bf16_f32 v133, v93, v97
    v_mul_f32 v94, v6, v94
    v_mul_f32 v98, v6, v98
    v_cvt_pk_bf16_f32 v134, v94, v98
    v_mul_f32 v95, v6, v95
    v_mul_f32 v99, v6, v99
    v_cvt_pk_bf16_f32 v135, v95, v99
    s_add_u32 s17, s48, 4096
    buffer_store_dwordx4 v[132:135], v0, s[8:11], s17 offen offset:1024
    s_add_u32 s46, s51, 33558528
    buffer_load_dwordx4 a[80:83], v0, s[28:31], s46 offen offset:0
    v_mul_f32 v100, v6, v100
    v_mul_f32 v104, v6, v104
    v_cvt_pk_bf16_f32 v136, v100, v104
    v_mul_f32 v101, v6, v101
    v_mul_f32 v105, v6, v105
    v_cvt_pk_bf16_f32 v137, v101, v105
    v_mul_f32 v102, v6, v102
    v_mul_f32 v106, v6, v106
    v_cvt_pk_bf16_f32 v138, v102, v106
    v_mul_f32 v103, v6, v103
    v_mul_f32 v107, v6, v107
    v_cvt_pk_bf16_f32 v139, v103, v107
    buffer_store_dwordx4 v[136:139], v0, s[8:11], s17 offen offset:3072
    buffer_load_dwordx4 a[84:87], v0, s[28:31], s46 offen offset:1024
    buffer_load_dwordx4 a[88:91], v0, s[28:31], s46 offen offset:2048
    buffer_load_dwordx4 a[92:95], v0, s[28:31], s46 offen offset:3072
    s_add_u32 s48, s48, 262144
    s_mov_b32 s49, 22528
    s_mov_b32 s66, -1
    s_cmp_ge_u32 s37, 64
    s_cbranch_scc1 LtaF_end
LtaF1:
    s_sub_u32 s17, s37, 33
    s_mul_i32 s18, s17, 43
    s_lshr_b32 s18, s18, 7
    s_mul_i32 s18, s18, 3
    s_cmp_eq_u32 s18, s17
    s_cselect_b32 s18, 1, 0
    s_cmp_lt_u32 s37, 34
    s_cselect_b32 s18, 1, s18
    s_cmp_eq_u32 s36, 0
    s_cselect_b32 s18, 1, s18
    s_and_b32 s18, s18, s61
    s_cbranch_scc0 LtaS1_in
LtaF1_in:
    s_and_b32 s17, s37, 7
    s_mul_i32 s17, s17, 131072
    s_add_u32 s47, s35, s17
    s_bfe_u32 s34, s37, 65539
    s_cmp_eq_u32 s39, 1
    s_cbranch_scc1 LtaF1_have
    s_waitcnt vmcnt(0)
    s_and_b32 s17, s49, s66
    s_cselect_b64 exec, 1, 0
    buffer_store_dword v3, v4, s[8:11], s43 offen
    s_andn2_b32 s17, s49, s66
    s_cselect_b64 exec, 1, 0
    buffer_store_dword v3, v4, s[8:11], s43 offen sc1
    s_mov_b64 exec, -1
    s_add_u32 s43, s43, s49
    s_mov_b32 s49, 0
    s_mov_b32 s16, 0
LtaF1_f_4:
    buffer_load_dword v2, v1, s[8:11], s42 offen sc1
    s_add_u32 s16, s16, 1
    s_cmp_gt_u32 s16, 100000
    s_cbranch_scc1 L_role_ta_abort
    s_waitcnt vmcnt(0)
    v_cmp_eq_u32 vcc, 0, v2
    s_nop 0
    s_cbranch_vccz LtaF1_fd_5
    s_sleep 4
    s_branch LtaF1_f_4
LtaF1_fd_5:
    s_add_u32 s46, s51, 0
    buffer_load_dwordx4 a[0:3], v0, s[8:11], s46 offen offset:0
    buffer_load_dwordx4 a[4:7], v0, s[8:11], s46 offen offset:1024
    buffer_load_dwordx4 a[8:11], v0, s[8:11], s46 offen offset:2048
    buffer_load_dwordx4 a[12:15], v0, s[8:11], s46 offen offset:3072
    s_add_u32 s46, s51, 4096
    buffer_load_dwordx4 a[16:19], v0, s[8:11], s46 offen offset:0
    buffer_load_dwordx4 a[20:23], v0, s[8:11], s46 offen offset:1024
    buffer_load_dwordx4 a[24:27], v0, s[8:11], s46 offen offset:2048
    buffer_load_dwordx4 a[28:31], v0, s[8:11], s46 offen offset:3072
    s_add_u32 s46, s51, 16777216
    buffer_load_dwordx4 a[32:35], v0, s[8:11], s46 offen offset:0
    buffer_load_dwordx4 a[36:39], v0, s[8:11], s46 offen offset:1024
    buffer_load_dwordx4 a[40:43], v0, s[8:11], s46 offen offset:2048
    buffer_load_dwordx4 a[44:47], v0, s[8:11], s46 offen offset:3072
    s_add_u32 s46, s51, 16781312
    buffer_load_dwordx4 a[48:51], v0, s[8:11], s46 offen offset:0
    buffer_load_dwordx4 a[52:55], v0, s[8:11], s46 offen offset:1024
    buffer_load_dwordx4 a[56:59], v0, s[8:11], s46 offen offset:2048
    buffer_load_dwordx4 a[60:63], v0, s[8:11], s46 offen offset:3072
    s_add_u32 s46, s51, 33554432
    buffer_load_dwordx4 a[64:67], v0, s[8:11], s46 offen offset:0
    buffer_load_dwordx4 a[68:71], v0, s[8:11], s46 offen offset:1024
    buffer_load_dwordx4 a[72:75], v0, s[8:11], s46 offen offset:2048
    buffer_load_dwordx4 a[76:79], v0, s[8:11], s46 offen offset:3072
    s_add_u32 s46, s51, 33558528
    buffer_load_dwordx4 a[80:83], v0, s[8:11], s46 offen offset:0
    buffer_load_dwordx4 a[84:87], v0, s[8:11], s46 offen offset:1024
    buffer_load_dwordx4 a[88:91], v0, s[8:11], s46 offen offset:2048
    buffer_load_dwordx4 a[92:95], v0, s[8:11], s46 offen offset:3072
LtaF1_have:
    s_add_u32 s17, s42, 22528
    buffer_load_dword v15, v1, s[8:11], s17 offen sc1
    buffer_load_dwordx4 v[52:55], v9, s[8:11], s47 offen offset:0 sc1
    buffer_load_dwordx4 v[56:59], v9, s[8:11], s47 offen offset:64 sc1
    buffer_load_dwordx4 v[60:63], v9, s[8:11], s47 offen offset:128 sc1
    buffer_load_dwordx4 v[64:67], v9, s[8:11], s47 offen offset:192 sc1
    buffer_load_dwordx2 v[68:69], v10, s[8:11], s47 offen offset:2048 sc1
    buffer_load_dwordx2 v[70:71], v10, s[8:11], s47 offen offset:2560 sc1
    buffer_load_dwordx2 v[72:73], v10, s[8:11], s47 offen offset:3072 sc1
    buffer_load_dwordx2 v[74:75], v10, s[8:11], s47 offen offset:3584 sc1
    s_waitcnt vmcnt(9)
    s_and_b32 s17, s49, s66
    s_cselect_b64 exec, 1, 0
    buffer_store_dword v3, v4, s[8:11], s43 offen
    s_andn2_b32 s17, s49, s66
    s_cselect_b64 exec, 1, 0
    buffer_store_dword v3, v4, s[8:11], s43 offen sc1
    s_mov_b64 exec, -1
    s_add_u32 s43, s43, s49
    s_mov_b32 s49, 0
    v_mfma_f32_16x16x32_bf16 v[32:35], a[32:35], a[0:3], 0
    v_mfma_f32_16x16x32_bf16 v[36:39], a[32:35], a[4:7], 0
    v_mfma_f32_16x16x32_bf16 v[40:43], a[36:39], a[4:7], 0
    v_mfma_f32_16x16x32_bf16 v[32:35], a[40:43], a[8:11], v[32:35]
    v_mfma_f32_16x16x32_bf16 v[36:39], a[40:43], a[12:15], v[36:39]
    v_mfma_f32_16x16x32_bf16 v[40:43], a[44:47], a[12:15], v[40:43]
    v_mfma_f32_16x16x32_bf16 v[32:35], a[48:51], a[16:19], v[32:35]
    v_mfma_f32_16x16x32_bf16 v[36:39], a[48:51], a[20:23], v[36:39]
    v_mfma_f32_16x16x32_bf16 v[40:43], a[52:55], a[20:23], v[40:43]
    v_mfma_f32_16x16x32_bf16 v[32:35], a[56:59], a[24:27], v[32:35]
    v_mfma_f32_16x16x32_bf16 v[36:39], a[56:59], a[28:31], v[36:39]
    v_mfma_f32_16x16x32_bf16 v[40:43], a[60:63], a[28:31], v[40:43]
    s_waitcnt vmcnt(2)
    v_cmp_eq_u32 vcc, 0, v15
    s_add_u32 s51, s51, 262144
    s_add_u32 s42, s42, 22528
    s_add_u32 s37, s37, 1
    s_cmp_eq_u64 vcc, 0
    s_cselect_b32 s39, 1, 0
    s_cmp_lt_u32 s37, 64
    s_cselect_b32 s39, s39, 0
    s_cmp_eq_u32 s39, 1
    s_cselect_b32 s30, 268435456, 0
    v_fma_f32 v32, v32, s52, v236
    v_fma_f32 v33, v33, s52, v237
    v_fma_f32 v34, v34, s52, v238
    v_fma_f32 v35, v35, s52, v239
    v_mul_f32 v36, s52, v36
    v_mul_f32 v37, s52, v37
    v_mul_f32 v38, s52, v38
    v_mul_f32 v39, s52, v39
    v_fma_f32 v40, v40, s52, v236
    v_fma_f32 v41, v41, s52, v237
    v_fma_f32 v42, v42, s52, v238
    v_fma_f32 v43, v43, s52, v239
    v_xor_b32 v5, s34, v52
    v_xor_b32 v6, s34, v56
    v_or_b32 v5, v5, v6
    v_xor_b32 v6, s34, v60
    v_or_b32 v5, v5, v6
    v_xor_b32 v6, s34, v64
    v_or_b32 v5, v5, v6
    v_xor_b32 v6, s34, v68
    v_or_b32 v5, v5, v6
    v_xor_b32 v6, s34, v70
    v_or_b32 v5, v5, v6
    v_xor_b32 v6, s34, v72
    v_or_b32 v5, v5, v6
    v_xor_b32 v6, s34, v74
    v_or_b32 v5, v5, v6
    v_and_b32 v5, 1, v5
    v_cmp_ne_u32 vcc, 0, v5
    s_nop 0
    s_cbranch_vccz LtaF1_r
    s_mov_b32 s16, 0
LtaF1_rp:
    buffer_load_dwordx4 v[52:55], v9, s[8:11], s47 offen offset:0 sc1
    buffer_load_dwordx4 v[56:59], v9, s[8:11], s47 offen offset:64 sc1
    buffer_load_dwordx4 v[60:63], v9, s[8:11], s47 offen offset:128 sc1
    buffer_load_dwordx4 v[64:67], v9, s[8:11], s47 offen offset:192 sc1
    buffer_load_dwordx2 v[68:69], v10, s[8:11], s47 offen offset:2048 sc1
    buffer_load_dwordx2 v[70:71], v10, s[8:11], s47 offen offset:2560 sc1
    buffer_load_dwordx2 v[72:73], v10, s[8:11], s47 offen offset:3072 sc1
    buffer_load_dwordx2 v[74:75], v10, s[8:11], s47 offen offset:3584 sc1
    s_add_u32 s16, s16, 1
    s_cmp_gt_u32 s16, 100000
    s_cbranch_scc1 L_role_ta_abort
    s_waitcnt vmcnt(0)
    v_xor_b32 v5, s34, v52
    v_xor_b32 v6, s34, v56
    v_or_b32 v5, v5, v6
    v_xor_b32 v6, s34, v60
    v_or_b32 v5, v5, v6
    v_xor_b32 v6, s34, v64
    v_or_b32 v5, v5, v6
    v_xor_b32 v6, s34, v68
    v_or_b32 v5, v5, v6
    v_xor_b32 v6, s34, v70
    v_or_b32 v5, v5, v6
    v_xor_b32 v6, s34, v72
    v_or_b32 v5, v5, v6
    v_xor_b32 v6, s34, v74
    v_or_b32 v5, v5, v6
    v_and_b32 v5, 1, v5
    v_cmp_ne_u32 vcc, 0, v5
    s_nop 0
    s_cbranch_vccz LtaF1_r
    s_sleep 2
    s_branch LtaF1_rp
LtaF1_r:
    s_and_b32 s17, s37, 3
    s_cmp_eq_u32 s17, 0
    s_cselect_b32 s17, s36, 0
    s_cmp_lg_u32 s17, 0
    s_cselect_b64 exec, 1, 0
    s_sub_u32 s17, s42, 22528
    buffer_store_dword v3, v4, s[8:11], s17 offen offset:384 sc1
    s_mov_b64 exec, -1
    s_add_u32 s46, s51, 0
    buffer_load_dwordx4 v[140:143], v0, s[28:31], s46 offen offset:0
    buffer_load_dwordx4 v[144:147], v0, s[28:31], s46 offen offset:1024
    v_mfma_f32_16x16x32_bf16 v[44:47], v[52:55], a[0:3], 0
    v_mfma_f32_16x16x32_bf16 v[48:51], v[52:55], a[4:7], 0
    v_mfma_f32_16x16x32_bf16 v[44:47], v[56:59], a[8:11], v[44:47]
    v_mfma_f32_16x16x32_bf16 v[48:51], v[56:59], a[12:15], v[48:51]
    v_mfma_f32_16x16x32_bf16 v[44:47], v[60:63], a[16:19], v[44:47]
    v_mfma_f32_16x16x32_bf16 v[48:51], v[60:63], a[20:23], v[48:51]
    v_mfma_f32_16x16x32_bf16 v[44:47], v[64:67], a[24:27], v[44:47]
    v_mfma_f32_16x16x32_bf16 v[48:51], v[64:67], a[28:31], v[48:51]
    v_max3_f32 v5, v32, v33, v34
    v_max_f32 v5, v5, v35
    s_nop 4
    v_mul_f32 v44, s52, v44
    v_mul_f32 v45, s52, v45
    v_max3_f32 v5, v5, v44, v45
    v_mov_b32 v6, v5
    buffer_load_dwordx4 v[148:151], v0, s[28:31], s46 offen offset:2048
    s_nop 0
    v_permlane32_swap_b32 v5, v6
    v_max_f32 v5, v5, v6
    v_mov_b32 v6, v5
    buffer_load_dwordx4 v[152:155], v0, s[28:31], s46 offen offset:3072
    s_nop 0
    v_permlane16_swap_b32 v5, v6
    v_max_f32 v5, v5, v6
    v_sub_f32 v32, v32, v5
    v_sub_f32 v33, v33, v5
    v_sub_f32 v34, v34, v5
    v_sub_f32 v35, v35, v5
    v_sub_f32 v44, v44, v5
    v_sub_f32 v45, v45, v5
    v_exp_f32 v32, v32
    v_exp_f32 v33, v33
    v_exp_f32 v34, v34
    v_exp_f32 v35, v35
    v_exp_f32 v44, v44
    v_exp_f32 v45, v45
    v_cvt_pk_bf16_f32 v24, v32, v33
    v_cvt_pk_bf16_f32 v25, v34, v35
    v_mov_b32 v26, 0
    v_mov_b32 v27, 0
    v_cvt_pk_bf16_f32 v20, v44, v45
    v_cvt_pk_bf16_f32 v23, v44, v45
    v_mfma_f32_16x16x32_bf16 v[28:31], v[16:19], v[24:27], 0
    v_mfma_f32_16x16x32_bf16 v[76:79], a[64:67], v[24:27], 0
    v_mfma_f32_16x16x32_bf16 v[80:83], a[68:71], v[24:27], 0
    s_add_u32 s46, s51, 4096
    buffer_load_dwordx4 v[156:159], v0, s[28:31], s46 offen offset:0
    v_mfma_f32_16x16x32_bf16 v[84:87], a[72:75], v[24:27], 0
    v_mfma_f32_16x16x32_bf16 v[88:91], a[76:79], v[24:27], 0
    buffer_load_dwordx4 v[160:163], v0, s[28:31], s46 offen offset:1024
    v_mfma_f32_16x16x32_bf16 v[92:95], a[80:83], v[24:27], 0
    v_mfma_f32_16x16x32_bf16 v[96:99], a[84:87], v[24:27], 0
    buffer_load_dwordx4 v[164:167], v0, s[28:31], s46 offen offset:2048
    v_mfma_f32_16x16x16_bf16 v[28:31], v[16:17], v[20:21], v[28:31]
    v_mfma_f32_16x16x32_bf16 v[100:103], a[88:91], v[24:27], 0
    v_mfma_f32_16x16x32_bf16 v[104:107], a[92:95], v[24:27], 0
    buffer_load_dwordx4 v[168:171], v0, s[28:31], s46 offen offset:3072
    v_mfma_f32_16x16x16_bf16 v[76:79], v[68:69], v[20:21], v[76:79]
    v_mfma_f32_16x16x16_bf16 v[80:83], v[68:69], v[22:23], v[80:83]
    s_nop 2
    v_rcp_f32 v6, v28
    v_mfma_f32_16x16x16_bf16 v[84:87], v[70:71], v[20:21], v[84:87]
    v_mfma_f32_16x16x16_bf16 v[88:91], v[70:71], v[22:23], v[88:91]
    s_nop 0
    v_mul_f32 v76, v6, v76
    v_mul_f32 v80, v6, v80
    v_cvt_pk_bf16_f32 v108, v76, v80
    v_mul_f32 v77, v6, v77
    v_mul_f32 v81, v6, v81
    v_cvt_pk_bf16_f32 v109, v77, v81
    v_mul_f32 v78, v6, v78
    v_mul_f32 v82, v6, v82
    v_cvt_pk_bf16_f32 v110, v78, v82
    v_mul_f32 v79, v6, v79
    v_mul_f32 v83, v6, v83
    v_cvt_pk_bf16_f32 v111, v79, v83
    s_add_u32 s17, s48, 0
    buffer_store_dwordx4 v[108:111], v0, s[8:11], s17 offen offset:0
    s_add_u32 s46, s51, 16777216
    buffer_load_dwordx4 v[172:175], v0, s[28:31], s46 offen offset:0
    v_mfma_f32_16x16x16_bf16 v[92:95], v[72:73], v[20:21], v[92:95]
    v_mfma_f32_16x16x16_bf16 v[96:99], v[72:73], v[22:23], v[96:99]
    v_mul_f32 v84, v6, v84
    v_mul_f32 v88, v6, v88
    v_cvt_pk_bf16_f32 v112, v84, v88
    v_mul_f32 v85, v6, v85
    v_mul_f32 v89, v6, v89
    v_cvt_pk_bf16_f32 v113, v85, v89
    v_mul_f32 v86, v6, v86
    v_mul_f32 v90, v6, v90
    v_cvt_pk_bf16_f32 v114, v86, v90
    v_mul_f32 v87, v6, v87
    v_mul_f32 v91, v6, v91
    v_cvt_pk_bf16_f32 v115, v87, v91
    buffer_store_dwordx4 v[112:115], v0, s[8:11], s17 offen offset:2048
    buffer_load_dwordx4 v[176:179], v0, s[28:31], s46 offen offset:1024
    v_mfma_f32_16x16x16_bf16 v[100:103], v[74:75], v[20:21], v[100:103]
    v_mfma_f32_16x16x16_bf16 v[104:107], v[74:75], v[22:23], v[104:107]
    v_mul_f32 v92, v6, v92
    v_mul_f32 v96, v6, v96
    v_cvt_pk_bf16_f32 v116, v92, v96
    v_mul_f32 v93, v6, v93
    v_mul_f32 v97, v6, v97
    v_cvt_pk_bf16_f32 v117, v93, v97
    v_mul_f32 v94, v6, v94
    v_mul_f32 v98, v6, v98
    v_cvt_pk_bf16_f32 v118, v94, v98
    v_mul_f32 v95, v6, v95
    v_mul_f32 v99, v6, v99
    v_cvt_pk_bf16_f32 v119, v95, v99
    s_add_u32 s17, s48, 4096
    buffer_store_dwordx4 v[116:119], v0, s[8:11], s17 offen offset:0
    buffer_load_dwordx4 v[180:183], v0, s[28:31], s46 offen offset:2048
    v_mul_f32 v100, v6, v100
    v_mul_f32 v104, v6, v104
    v_cvt_pk_bf16_f32 v120, v100, v104
    v_mul_f32 v101, v6, v101
    v_mul_f32 v105, v6, v105
    v_cvt_pk_bf16_f32 v121, v101, v105
    v_mul_f32 v102, v6, v102
    v_mul_f32 v106, v6, v106
    v_cvt_pk_bf16_f32 v122, v102, v106
    v_mul_f32 v103, v6, v103
    v_mul_f32 v107, v6, v107
    v_cvt_pk_bf16_f32 v123, v103, v107
    buffer_store_dwordx4 v[120:123], v0, s[8:11], s17 offen offset:2048
    buffer_load_dwordx4 v[184:187], v0, s[28:31], s46 offen offset:3072
    v_max3_f32 v5, v36, v37, v38
    v_max_f32 v5, v5, v39
    v_max3_f32 v5, v5, v40, v41
    v_max3_f32 v5, v5, v42, v43
    v_mul_f32 v48, s52, v48
    v_mul_f32 v49, s52, v49
    v_max3_f32 v5, v5, v48, v49
    v_mov_b32 v6, v5
    s_add_u32 s46, s51, 16781312
    buffer_load_dwordx4 v[188:191], v0, s[28:31], s46 offen offset:0
    v_permlane32_swap_b32 v5, v6
    v_max_f32 v5, v5, v6
    v_mov_b32 v6, v5
    buffer_load_dwordx4 v[192:195], v0, s[28:31], s46 offen offset:1024
    s_nop 0
    v_permlane16_swap_b32 v5, v6
    v_max_f32 v5, v5, v6
    v_sub_f32 v36, v36, v5
    v_sub_f32 v37, v37, v5
    v_sub_f32 v38, v38, v5
    v_sub_f32 v39, v39, v5
    v_sub_f32 v40, v40, v5
    v_sub_f32 v41, v41, v5
    v_sub_f32 v42, v42, v5
    v_sub_f32 v43, v43, v5
    v_sub_f32 v48, v48, v5
    v_sub_f32 v49, v49, v5
    v_exp_f32 v36, v36
    v_exp_f32 v37, v37
    v_exp_f32 v38, v38
    v_exp_f32 v39, v39
    v_exp_f32 v40, v40
    v_exp_f32 v41, v41
    v_exp_f32 v42, v42
    v_exp_f32 v43, v43
    v_exp_f32 v48, v48
    v_exp_f32 v49, v49
    v_cvt_pk_bf16_f32 v24, v36, v37
    v_cvt_pk_bf16_f32 v25, v38, v39
    v_cvt_pk_bf16_f32 v26, v40, v41
    v_cvt_pk_bf16_f32 v27, v42, v43
    v_cvt_pk_bf16_f32 v20, v48, v49
    v_cvt_pk_bf16_f32 v23, v48, v49
    v_mfma_f32_16x16x32_bf16 v[28:31], v[16:19], v[24:27], 0
    v_mfma_f32_16x16x32_bf16 v[76:79], a[64:67], v[24:27], 0
    v_mfma_f32_16x16x32_bf16 v[80:83], a[68:71], v[24:27], 0
    buffer_load_dwordx4 v[196:199], v0, s[28:31], s46 offen offset:2048
    v_mfma_f32_16x16x32_bf16 v[84:87], a[72:75], v[24:27], 0
    v_mfma_f32_16x16x32_bf16 v[88:91], a[76:79], v[24:27], 0
    buffer_load_dwordx4 v[200:203], v0, s[28:31], s46 offen offset:3072
    v_mfma_f32_16x16x32_bf16 v[92:95], a[80:83], v[24:27], 0
    v_mfma_f32_16x16x32_bf16 v[96:99], a[84:87], v[24:27], 0
    s_add_u32 s46, s51, 33554432
    buffer_load_dwordx4 v[204:207], v0, s[28:31], s46 offen offset:0
    v_mfma_f32_16x16x16_bf16 v[28:31], v[16:17], v[20:21], v[28:31]
    v_mfma_f32_16x16x32_bf16 v[100:103], a[88:91], v[24:27], 0
    v_mfma_f32_16x16x32_bf16 v[104:107], a[92:95], v[24:27], 0
    buffer_load_dwordx4 v[208:211], v0, s[28:31], s46 offen offset:1024
    v_mfma_f32_16x16x16_bf16 v[76:79], v[68:69], v[20:21], v[76:79]
    v_mfma_f32_16x16x16_bf16 v[80:83], v[68:69], v[22:23], v[80:83]
    s_nop 2
    v_rcp_f32 v6, v28
    v_mfma_f32_16x16x16_bf16 v[84:87], v[70:71], v[20:21], v[84:87]
    v_mfma_f32_16x16x16_bf16 v[88:91], v[70:71], v[22:23], v[88:91]
    s_nop 0
    v_mul_f32 v76, v6, v76
    v_mul_f32 v80, v6, v80
    v_cvt_pk_bf16_f32 v124, v76, v80
    v_mul_f32 v77, v6, v77
    v_mul_f32 v81, v6, v81
    v_cvt_pk_bf16_f32 v125, v77, v81
    v_mul_f32 v78, v6, v78
    v_mul_f32 v82, v6, v82
    v_cvt_pk_bf16_f32 v126, v78, v82
    v_mul_f32 v79, v6, v79
    v_mul_f32 v83, v6, v83
    v_cvt_pk_bf16_f32 v127, v79, v83
    s_add_u32 s17, s48, 0
    buffer_store_dwordx4 v[124:127], v0, s[8:11], s17 offen offset:1024
    buffer_load_dwordx4 v[212:215], v0, s[28:31], s46 offen offset:2048
    v_mfma_f32_16x16x16_bf16 v[92:95], v[72:73], v[20:21], v[92:95]
    v_mfma_f32_16x16x16_bf16 v[96:99], v[72:73], v[22:23], v[96:99]
    v_mul_f32 v84, v6, v84
    v_mul_f32 v88, v6, v88
    v_cvt_pk_bf16_f32 v128, v84, v88
    v_mul_f32 v85, v6, v85
    v_mul_f32 v89, v6, v89
    v_cvt_pk_bf16_f32 v129, v85, v89
    v_mul_f32 v86, v6, v86
    v_mul_f32 v90, v6, v90
    v_cvt_pk_bf16_f32 v130, v86, v90
    v_mul_f32 v87, v6, v87
    v_mul_f32 v91, v6, v91
    v_cvt_pk_bf16_f32 v131, v87, v91
    buffer_store_dwordx4 v[128:131], v0, s[8:11], s17 offen offset:3072
    buffer_load_dwordx4 v[216:219], v0, s[28:31], s46 offen offset:3072
    v_mfma_f32_16x16x16_bf16 v[100:103], v[74:75], v[20:21], v[100:103]
    v_mfma_f32_16x16x16_bf16 v[104:107], v[74:75], v[22:23], v[104:107]
    v_mul_f32 v92, v6, v92
    v_mul_f32 v96, v6, v96
    v_cvt_pk_bf16_f32 v132, v92, v96
    v_mul_f32 v93, v6, v93
    v_mul_f32 v97, v6, v97
    v_cvt_pk_bf16_f32 v133, v93, v97
    v_mul_f32 v94, v6, v94
    v_mul_f32 v98, v6, v98
    v_cvt_pk_bf16_f32 v134, v94, v98
    v_mul_f32 v95, v6, v95
    v_mul_f32 v99, v6, v99
    v_cvt_pk_bf16_f32 v135, v95, v99
    s_add_u32 s17, s48, 4096
    buffer_store_dwordx4 v[132:135], v0, s[8:11], s17 offen offset:1024
    s_add_u32 s46, s51, 33558528
    buffer_load_dwordx4 v[220:223], v0, s[28:31], s46 offen offset:0
    v_mul_f32 v100, v6, v100
    v_mul_f32 v104, v6, v104
    v_cvt_pk_bf16_f32 v136, v100, v104
    v_mul_f32 v101, v6, v101
    v_mul_f32 v105, v6, v105
    v_cvt_pk_bf16_f32 v137, v101, v105
    v_mul_f32 v102, v6, v102
    v_mul_f32 v106, v6, v106
    v_cvt_pk_bf16_f32 v138, v102, v106
    v_mul_f32 v103, v6, v103
    v_mul_f32 v107, v6, v107
    v_cvt_pk_bf16_f32 v139, v103, v107
    buffer_store_dwordx4 v[136:139], v0, s[8:11], s17 offen offset:3072
    buffer_load_dwordx4 v[224:227], v0, s[28:31], s46 offen offset:1024
    buffer_load_dwordx4 v[228:231], v0, s[28:31], s46 offen offset:2048
    buffer_load_dwordx4 v[232:235], v0, s[28:31], s46 offen offset:3072
    s_add_u32 s48, s48, 262144
    s_mov_b32 s49, 22528
    s_mov_b32 s66, -1
    s_cmp_ge_u32 s37, 64
    s_cbranch_scc1 LtaF_end
    s_branch LtaF0
LtaF_end:
    s_waitcnt vmcnt(0)
    s_and_b32 s17, s49, s66
    s_cselect_b64 exec, 1, 0
    buffer_store_dword v3, v4, s[8:11], s43 offen
    s_andn2_b32 s17, s49, s66
    s_cselect_b64 exec, 1, 0
    buffer_store_dword v3, v4, s[8:11], s43 offen sc1
    s_mov_b64 exec, -1
    s_add_u32 s43, s43, s49
    s_mov_b32 s49, 0
    s_branch L_role_ta_exit
LtaS0:
    s_sub_u32 s17, s37, 33
    s_mul_i32 s18, s17, 43
    s_lshr_b32 s18, s18, 7
    s_mul_i32 s18, s18, 3
    s_cmp_eq_u32 s18, s17
    s_cselect_b32 s18, 1, 0
    s_cmp_lt_u32 s37, 34
    s_cselect_b32 s18, 1, s18
    s_cmp_eq_u32 s36, 0
    s_cselect_b32 s18, 1, s18
    s_and_b32 s18, s18, s61
    s_cbranch_scc1 LtaF0_in
LtaS0_in:
    s_and_b32 s17, s37, 7
    s_mul_i32 s17, s17, 131072
    s_add_u32 s47, s35, s17
    s_bfe_u32 s34, s37, 65539
    s_cmp_eq_u32 s39, 1
    s_cbranch_scc1 LtaS0_have
    s_waitcnt vmcnt(0)
    s_and_b32 s17, s49, s66
    s_cselect_b64 exec, 1, 0
    buffer_store_dword v3, v4, s[8:11], s43 offen
    s_andn2_b32 s17, s49, s66
    s_cselect_b64 exec, 1, 0
    buffer_store_dword v3, v4, s[8:11], s43 offen sc1
    s_mov_b64 exec, -1
    s_add_u32 s43, s43, s49
    s_mov_b32 s49, 0
    s_mov_b32 s16, 0
LtaS0_f_6:
    buffer_load_dword v2, v1, s[8:11], s42 offen sc1
    s_add_u32 s16, s16, 1
    s_cmp_gt_u32 s16, 100000
    s_cbranch_scc1 L_role_ta_abort
    s_waitcnt vmcnt(0)
    v_cmp_eq_u32 vcc, 0, v2
    s_nop 0
    s_cbranch_vccz LtaS0_fd_7
    s_sleep 4
    s_branch LtaS0_f_6
LtaS0_fd_7:
    s_add_u32 s46, s51, 0
    buffer_load_dwordx4 v[140:143], v0, s[8:11], s46 offen offset:0
    buffer_load_dwordx4 v[144:147], v0, s[8:11], s46 offen offset:1024
    buffer_load_dwordx4 v[148:151], v0, s[8:11], s46 offen offset:2048
    buffer_load_dwordx4 v[152:155], v0, s[8:11], s46 offen offset:3072
    s_add_u32 s46, s51, 4096
    buffer_load_dwordx4 v[156:159], v0, s[8:11], s46 offen offset:0
    buffer_load_dwordx4 v[160:163], v0, s[8:11], s46 offen offset:1024
    buffer_load_dwordx4 v[164:167], v0, s[8:11], s46 offen offset:2048
    buffer_load_dwordx4 v[168:171], v0, s[8:11], s46 offen offset:3072
    s_add_u32 s46, s51, 16777216
    buffer_load_dwordx4 v[172:175], v0, s[8:11], s46 offen offset:0
    buffer_load_dwordx4 v[176:179], v0, s[8:11], s46 offen offset:1024
    buffer_load_dwordx4 v[180:183], v0, s[8:11], s46 offen offset:2048
    buffer_load_dwordx4 v[184:187], v0, s[8:11], s46 offen offset:3072
    s_add_u32 s46, s51, 16781312
    buffer_load_dwordx4 v[188:191], v0, s[8:11], s46 offen offset:0
    buffer_load_dwordx4 v[192:195], v0, s[8:11], s46 offen offset:1024
    buffer_load_dwordx4 v[196:199], v0, s[8:11], s46 offen offset:2048
    buffer_load_dwordx4 v[200:203], v0, s[8:11], s46 offen offset:3072
    s_add_u32 s46, s51, 33554432
    buffer_load_dwordx4 v[204:207], v0, s[8:11], s46 offen offset:0
    buffer_load_dwordx4 v[208:211], v0, s[8:11], s46 offen offset:1024
    buffer_load_dwordx4 v[212:215], v0, s[8:11], s46 offen offset:2048
    buffer_load_dwordx4 v[216:219], v0, s[8:11], s46 offen offset:3072
    s_add_u32 s46, s51, 33558528
    buffer_load_dwordx4 v[220:223], v0, s[8:11], s46 offen offset:0
    buffer_load_dwordx4 v[224:227], v0, s[8:11], s46 offen offset:1024
    buffer_load_dwordx4 v[228:231], v0, s[8:11], s46 offen offset:2048
    buffer_load_dwordx4 v[232:235], v0, s[8:11], s46 offen offset:3072
LtaS0_have:
    s_add_u32 s17, s42, 22528
    buffer_load_dword v15, v1, s[8:11], s17 offen sc1
    buffer_load_dwordx4 v[52:55], v9, s[8:11], s47 offen offset:0 sc1
    buffer_load_dwordx4 v[56:59], v9, s[8:11], s47 offen offset:64 sc1
    buffer_load_dwordx4 v[60:63], v9, s[8:11], s47 offen offset:128 sc1
    buffer_load_dwordx4 v[64:67], v9, s[8:11], s47 offen offset:192 sc1
    buffer_load_dwordx2 v[68:69], v10, s[8:11], s47 offen offset:2048 sc1
    buffer_load_dwordx2 v[70:71], v10, s[8:11], s47 offen offset:2560 sc1
    buffer_load_dwordx2 v[72:73], v10, s[8:11], s47 offen offset:3072 sc1
    buffer_load_dwordx2 v[74:75], v10, s[8:11], s47 offen offset:3584 sc1
    s_waitcnt vmcnt(9)
    s_and_b32 s17, s49, s66
    s_cselect_b64 exec, 1, 0
    buffer_store_dword v3, v4, s[8:11], s43 offen
    s_andn2_b32 s17, s49, s66
    s_cselect_b64 exec, 1, 0
    buffer_store_dword v3, v4, s[8:11], s43 offen sc1
    s_mov_b64 exec, -1
    s_add_u32 s43, s43, s49
    s_mov_b32 s49, 0
    v_mfma_f32_16x16x32_bf16 v[32:35], v[172:175], v[140:143], 0
    v_mfma_f32_16x16x32_bf16 v[36:39], v[172:175], v[144:147], 0
    v_mfma_f32_16x16x32_bf16 v[40:43], v[176:179], v[144:147], 0
    v_mfma_f32_16x16x32_bf16 v[32:35], v[180:183], v[148:151], v[32:35]
    v_mfma_f32_16x16x32_bf16 v[36:39], v[180:183], v[152:155], v[36:39]
    v_mfma_f32_16x16x32_bf16 v[40:43], v[184:187], v[152:155], v[40:43]
    v_mfma_f32_16x16x32_bf16 v[32:35], v[188:191], v[156:159], v[32:35]
    v_mfma_f32_16x16x32_bf16 v[36:39], v[188:191], v[160:163], v[36:39]
    v_mfma_f32_16x16x32_bf16 v[40:43], v[192:195], v[160:163], v[40:43]
    v_mfma_f32_16x16x32_bf16 v[32:35], v[196:199], v[164:167], v[32:35]
    v_mfma_f32_16x16x32_bf16 v[36:39], v[196:199], v[168:171], v[36:39]
    v_mfma_f32_16x16x32_bf16 v[40:43], v[200:203], v[168:171], v[40:43]
    s_waitcnt vmcnt(2)
    v_cmp_eq_u32 vcc, 0, v15
    s_add_u32 s51, s51, 262144
    s_add_u32 s42, s42, 22528
    s_add_u32 s37, s37, 1
    s_cmp_eq_u64 vcc, 0
    s_cselect_b32 s39, 1, 0
    s_cmp_lt_u32 s37, 64
    s_cselect_b32 s39, s39, 0
    s_cmp_eq_u32 s39, 1
    s_cselect_b32 s30, 268435456, 0
    v_fma_f32 v32, v32, s52, v236
    v_fma_f32 v33, v33, s52, v237
    v_fma_f32 v34, v34, s52, v238
    v_fma_f32 v35, v35, s52, v239
    v_mul_f32 v36, s52, v36
    v_mul_f32 v37, s52, v37
    v_mul_f32 v38, s52, v38
    v_mul_f32 v39, s52, v39
    v_fma_f32 v40, v40, s52, v236
    v_fma_f32 v41, v41, s52, v237
    v_fma_f32 v42, v42, s52, v238
    v_fma_f32 v43, v43, s52, v239
    v_xor_b32 v5, s34, v52
    v_xor_b32 v6, s34, v56
    v_or_b32 v5, v5, v6
    v_xor_b32 v6, s34, v60
    v_or_b32 v5, v5, v6
    v_xor_b32 v6, s34, v64
    v_or_b32 v5, v5, v6
    v_xor_b32 v6, s34, v68
    v_or_b32 v5, v5, v6
    v_xor_b32 v6, s34, v70
    v_or_b32 v5, v5, v6
    v_xor_b32 v6, s34, v72
    v_or_b32 v5, v5, v6
    v_xor_b32 v6, s34, v74
    v_or_b32 v5, v5, v6
    v_and_b32 v5, 1, v5
    v_cmp_ne_u32 vcc, 0, v5
    s_nop 0
    s_cbranch_vccz LtaS0_r
    s_mov_b32 s16, 0
LtaS0_rp:
    buffer_load_dwordx4 v[52:55], v9, s[8:11], s47 offen offset:0 sc1
    buffer_load_dwordx4 v[56:59], v9, s[8:11], s47 offen offset:64 sc1
    buffer_load_dwordx4 v[60:63], v9, s[8:11], s47 offen offset:128 sc1
    buffer_load_dwordx4 v[64:67], v9, s[8:11], s47 offen offset:192 sc1
    buffer_load_dwordx2 v[68:69], v10, s[8:11], s47 offen offset:2048 sc1
    buffer_load_dwordx2 v[70:71], v10, s[8:11], s47 offen offset:2560 sc1
    buffer_load_dwordx2 v[72:73], v10, s[8:11], s47 offen offset:3072 sc1
    buffer_load_dwordx2 v[74:75], v10, s[8:11], s47 offen offset:3584 sc1
    s_add_u32 s16, s16, 1
    s_cmp_gt_u32 s16, 100000
    s_cbranch_scc1 L_role_ta_abort
    s_waitcnt vmcnt(0)
    v_xor_b32 v5, s34, v52
    v_xor_b32 v6, s34, v56
    v_or_b32 v5, v5, v6
    v_xor_b32 v6, s34, v60
    v_or_b32 v5, v5, v6
    v_xor_b32 v6, s34, v64
    v_or_b32 v5, v5, v6
    v_xor_b32 v6, s34, v68
    v_or_b32 v5, v5, v6
    v_xor_b32 v6, s34, v70
    v_or_b32 v5, v5, v6
    v_xor_b32 v6, s34, v72
    v_or_b32 v5, v5, v6
    v_xor_b32 v6, s34, v74
    v_or_b32 v5, v5, v6
    v_and_b32 v5, 1, v5
    v_cmp_ne_u32 vcc, 0, v5
    s_nop 0
    s_cbranch_vccz LtaS0_r
    s_sleep 2
    s_branch LtaS0_rp
LtaS0_r:
    s_and_b32 s17, s37, 3
    s_cmp_eq_u32 s17, 0
    s_cselect_b32 s17, s36, 0
    s_cmp_lg_u32 s17, 0
    s_cselect_b64 exec, 1, 0
    s_sub_u32 s17, s42, 22528
    buffer_store_dword v3, v4, s[8:11], s17 offen offset:384 sc1
    s_mov_b64 exec, -1
    s_add_u32 s46, s51, 0
    buffer_load_dwordx4 a[0:3], v0, s[28:31], s46 offen offset:0
    buffer_load_dwordx4 a[4:7], v0, s[28:31], s46 offen offset:1024
    v_mfma_f32_16x16x32_bf16 v[44:47], v[52:55], v[140:143], 0
    v_mfma_f32_16x16x32_bf16 v[48:51], v[52:55], v[144:147], 0
    v_mfma_f32_16x16x32_bf16 v[44:47], v[56:59], v[148:151], v[44:47]
    v_mfma_f32_16x16x32_bf16 v[48:51], v[56:59], v[152:155], v[48:51]
    v_mfma_f32_16x16x32_bf16 v[44:47], v[60:63], v[156:159], v[44:47]
    v_mfma_f32_16x16x32_bf16 v[48:51], v[60:63], v[160:163], v[48:51]
    v_mfma_f32_16x16x32_bf16 v[44:47], v[64:67], v[164:167], v[44:47]
    v_mfma_f32_16x16x32_bf16 v[48:51], v[64:67], v[168:171], v[48:51]
    v_max3_f32 v5, v32, v33, v34
    v_max_f32 v5, v5, v35
    s_nop 4
    v_mul_f32 v44, s52, v44
    v_mul_f32 v45, s52, v45
    v_max3_f32 v5, v5, v44, v45
    v_mov_b32 v6, v5
    buffer_load_dwordx4 a[8:11], v0, s[28:31], s46 offen offset:2048
    s_nop 0
    v_permlane32_swap_b32 v5, v6
    v_max_f32 v5, v5, v6
    v_mov_b32 v6, v5
    buffer_load_dwordx4 a[12:15], v0, s[28:31], s46 offen offset:3072
    s_nop 0
    v_permlane16_swap_b32 v5, v6
    v_max_f32 v5, v5, v6
    v_sub_f32 v32, v32, v5
    v_sub_f32 v33, v33, v5
    v_sub_f32 v34, v34, v5
    v_sub_f32 v35, v35, v5
    v_sub_f32 v44, v44, v5
    v_sub_f32 v45, v45, v5
    v_exp_f32 v32, v32
    v_exp_f32 v33, v33
    v_exp_f32 v34, v34
    v_exp_f32 v35, v35
    v_exp_f32 v44, v44
    v_exp_f32 v45, v45
    v_cvt_pk_bf16_f32 v24, v32, v33
    v_cvt_pk_bf16_f32 v25, v34, v35
    v_mov_b32 v26, 0
    v_mov_b32 v27, 0
    v_cvt_pk_bf16_f32 v20, v44, v45
    v_cvt_pk_bf16_f32 v23, v44, v45
    v_mfma_f32_16x16x32_bf16 v[28:31], v[16:19], v[24:27], 0
    v_mfma_f32_16x16x32_bf16 v[76:79], v[204:207], v[24:27], 0
    v_mfma_f32_16x16x32_bf16 v[80:83], v[208:211], v[24:27], 0
    s_add_u32 s46, s51, 4096
    buffer_load_dwordx4 a[16:19], v0, s[28:31], s46 offen offset:0
    v_mfma_f32_16x16x32_bf16 v[84:87], v[212:215], v[24:27], 0
    v_mfma_f32_16x16x32_bf16 v[88:91], v[216:219], v[24:27], 0
    buffer_load_dwordx4 a[20:23], v0, s[28:31], s46 offen offset:1024
    v_mfma_f32_16x16x32_bf16 v[92:95], v[220:223], v[24:27], 0
    v_mfma_f32_16x16x32_bf16 v[96:99], v[224:227], v[24:27], 0
    buffer_load_dwordx4 a[24:27], v0, s[28:31], s46 offen offset:2048
    v_mfma_f32_16x16x16_bf16 v[28:31], v[16:17], v[20:21], v[28:31]
    v_mfma_f32_16x16x32_bf16 v[100:103], v[228:231], v[24:27], 0
    v_mfma_f32_16x16x32_bf16 v[104:107], v[232:235], v[24:27], 0
    buffer_load_dwordx4 a[28:31], v0, s[28:31], s46 offen offset:3072
    v_mfma_f32_16x16x16_bf16 v[76:79], v[68:69], v[20:21], v[76:79]
    v_mfma_f32_16x16x16_bf16 v[80:83], v[68:69], v[22:23], v[80:83]
    s_nop 2
    v_rcp_f32 v6, v28
    v_mfma_f32_16x16x16_bf16 v[84:87], v[70:71], v[20:21], v[84:87]
    v_mfma_f32_16x16x16_bf16 v[88:91], v[70:71], v[22:23], v[88:91]
    s_nop 0
    v_mul_f32 v76, v6, v76
    v_mul_f32 v80, v6, v80
    v_cvt_pk_bf16_f32 v108, v76, v80
    v_mul_f32 v77, v6, v77
    v_mul_f32 v81, v6, v81
    v_cvt_pk_bf16_f32 v109, v77, v81
    v_mul_f32 v78, v6, v78
    v_mul_f32 v82, v6, v82
    v_cvt_pk_bf16_f32 v110, v78, v82
    v_mul_f32 v79, v6, v79
    v_mul_f32 v83, v6, v83
    v_cvt_pk_bf16_f32 v111, v79, v83
    s_add_u32 s17, s48, 0
    buffer_store_dwordx4 v[108:111], v0, s[8:11], s17 offen offset:0 sc1
    s_add_u32 s46, s51, 16777216
    buffer_load_dwordx4 a[32:35], v0, s[28:31], s46 offen offset:0
    v_mfma_f32_16x16x16_bf16 v[92:95], v[72:73], v[20:21], v[92:95]
    v_mfma_f32_16x16x16_bf16 v[96:99], v[72:73], v[22:23], v[96:99]
    v_mul_f32 v84, v6, v84
    v_mul_f32 v88, v6, v88
    v_cvt_pk_bf16_f32 v112, v84, v88
    v_mul_f32 v85, v6, v85
    v_mul_f32 v89, v6, v89
    v_cvt_pk_bf16_f32 v113, v85, v89
    v_mul_f32 v86, v6, v86
    v_mul_f32 v90, v6, v90
    v_cvt_pk_bf16_f32 v114, v86, v90
    v_mul_f32 v87, v6, v87
    v_mul_f32 v91, v6, v91
    v_cvt_pk_bf16_f32 v115, v87, v91
    buffer_store_dwordx4 v[112:115], v0, s[8:11], s17 offen offset:2048 sc1
    buffer_load_dwordx4 a[36:39], v0, s[28:31], s46 offen offset:1024
    v_mfma_f32_16x16x16_bf16 v[100:103], v[74:75], v[20:21], v[100:103]
    v_mfma_f32_16x16x16_bf16 v[104:107], v[74:75], v[22:23], v[104:107]
    v_mul_f32 v92, v6, v92
    v_mul_f32 v96, v6, v96
    v_cvt_pk_bf16_f32 v116, v92, v96
    v_mul_f32 v93, v6, v93
    v_mul_f32 v97, v6, v97
    v_cvt_pk_bf16_f32 v117, v93, v97
    v_mul_f32 v94, v6, v94
    v_mul_f32 v98, v6, v98
    v_cvt_pk_bf16_f32 v118, v94, v98
    v_mul_f32 v95, v6, v95
    v_mul_f32 v99, v6, v99
    v_cvt_pk_bf16_f32 v119, v95, v99
    s_add_u32 s17, s48, 4096
    buffer_store_dwordx4 v[116:119], v0, s[8:11], s17 offen offset:0 sc1
    buffer_load_dwordx4 a[40:43], v0, s[28:31], s46 offen offset:2048
    v_mul_f32 v100, v6, v100
    v_mul_f32 v104, v6, v104
    v_cvt_pk_bf16_f32 v120, v100, v104
    v_mul_f32 v101, v6, v101
    v_mul_f32 v105, v6, v105
    v_cvt_pk_bf16_f32 v121, v101, v105
    v_mul_f32 v102, v6, v102
    v_mul_f32 v106, v6, v106
    v_cvt_pk_bf16_f32 v122, v102, v106
    v_mul_f32 v103, v6, v103
    v_mul_f32 v107, v6, v107
    v_cvt_pk_bf16_f32 v123, v103, v107
    buffer_store_dwordx4 v[120:123], v0, s[8:11], s17 offen offset:2048 sc1
    buffer_load_dwordx4 a[44:47], v0, s[28:31], s46 offen offset:3072
    v_max3_f32 v5, v36, v37, v38
    v_max_f32 v5, v5, v39
    v_max3_f32 v5, v5, v40, v41
    v_max3_f32 v5, v5, v42, v43
    v_mul_f32 v48, s52, v48
    v_mul_f32 v49, s52, v49
    v_max3_f32 v5, v5, v48, v49
    v_mov_b32 v6, v5
    s_add_u32 s46, s51, 16781312
    buffer_load_dwordx4 a[48:51], v0, s[28:31], s46 offen offset:0
    v_permlane32_swap_b32 v5, v6
    v_max_f32 v5, v5, v6
    v_mov_b32 v6, v5
    buffer_load_dwordx4 a[52:55], v0, s[28:31], s46 offen offset:1024
    s_nop 0
    v_permlane16_swap_b32 v5, v6
    v_max_f32 v5, v5, v6
    v_sub_f32 v36, v36, v5
    v_sub_f32 v37, v37, v5
    v_sub_f32 v38, v38, v5
    v_sub_f32 v39, v39, v5
    v_sub_f32 v40, v40, v5
    v_sub_f32 v41, v41, v5
    v_sub_f32 v42, v42, v5
    v_sub_f32 v43, v43, v5
    v_sub_f32 v48, v48, v5
    v_sub_f32 v49, v49, v5
    v_exp_f32 v36, v36
    v_exp_f32 v37, v37
    v_exp_f32 v38, v38
    v_exp_f32 v39, v39
    v_exp_f32 v40, v40
    v_exp_f32 v41, v41
    v_exp_f32 v42, v42
    v_exp_f32 v43, v43
    v_exp_f32 v48, v48
    v_exp_f32 v49, v49
    v_cvt_pk_bf16_f32 v24, v36, v37
    v_cvt_pk_bf16_f32 v25, v38, v39
    v_cvt_pk_bf16_f32 v26, v40, v41
    v_cvt_pk_bf16_f32 v27, v42, v43
    v_cvt_pk_bf16_f32 v20, v48, v49
    v_cvt_pk_bf16_f32 v23, v48, v49
    v_mfma_f32_16x16x32_bf16 v[28:31], v[16:19], v[24:27], 0
    v_mfma_f32_16x16x32_bf16 v[76:79], v[204:207], v[24:27], 0
    v_mfma_f32_16x16x32_bf16 v[80:83], v[208:211], v[24:27], 0
    buffer_load_dwordx4 a[56:59], v0, s[28:31], s46 offen offset:2048
    v_mfma_f32_16x16x32_bf16 v[84:87], v[212:215], v[24:27], 0
    v_mfma_f32_16x16x32_bf16 v[88:91], v[216:219], v[24:27], 0
    buffer_load_dwordx4 a[60:63], v0, s[28:31], s46 offen offset:3072
    v_mfma_f32_16x16x32_bf16 v[92:95], v[220:223], v[24:27], 0
    v_mfma_f32_16x16x32_bf16 v[96:99], v[224:227], v[24:27], 0
    s_add_u32 s46, s51, 33554432
    buffer_load_dwordx4 a[64:67], v0, s[28:31], s46 offen offset:0
    v_mfma_f32_16x16x16_bf16 v[28:31], v[16:17], v[20:21], v[28:31]
    v_mfma_f32_16x16x32_bf16 v[100:103], v[228:231], v[24:27], 0
    v_mfma_f32_16x16x32_bf16 v[104:107], v[232:235], v[24:27], 0
    buffer_load_dwordx4 a[68:71], v0, s[28:31], s46 offen offset:1024
    v_mfma_f32_16x16x16_bf16 v[76:79], v[68:69], v[20:21], v[76:79]
    v_mfma_f32_16x16x16_bf16 v[80:83], v[68:69], v[22:23], v[80:83]
    s_nop 2
    v_rcp_f32 v6, v28
    v_mfma_f32_16x16x16_bf16 v[84:87], v[70:71], v[20:21], v[84:87]
    v_mfma_f32_16x16x16_bf16 v[88:91], v[70:71], v[22:23], v[88:91]
    s_nop 0
    v_mul_f32 v76, v6, v76
    v_mul_f32 v80, v6, v80
    v_cvt_pk_bf16_f32 v124, v76, v80
    v_mul_f32 v77, v6, v77
    v_mul_f32 v81, v6, v81
    v_cvt_pk_bf16_f32 v125, v77, v81
    v_mul_f32 v78, v6, v78
    v_mul_f32 v82, v6, v82
    v_cvt_pk_bf16_f32 v126, v78, v82
    v_mul_f32 v79, v6, v79
    v_mul_f32 v83, v6, v83
    v_cvt_pk_bf16_f32 v127, v79, v83
    s_add_u32 s17, s48, 0
    buffer_store_dwordx4 v[124:127], v0, s[8:11], s17 offen offset:1024 sc1
    buffer_load_dwordx4 a[72:75], v0, s[28:31], s46 offen offset:2048
    v_mfma_f32_16x16x16_bf16 v[92:95], v[72:73], v[20:21], v[92:95]
    v_mfma_f32_16x16x16_bf16 v[96:99], v[72:73], v[22:23], v[96:99]
    v_mul_f32 v84, v6, v84
    v_mul_f32 v88, v6, v88
    v_cvt_pk_bf16_f32 v128, v84, v88
    v_mul_f32 v85, v6, v85
    v_mul_f32 v89, v6, v89
    v_cvt_pk_bf16_f32 v129, v85, v89
    v_mul_f32 v86, v6, v86
    v_mul_f32 v90, v6, v90
    v_cvt_pk_bf16_f32 v130, v86, v90
    v_mul_f32 v87, v6, v87
    v_mul_f32 v91, v6, v91
    v_cvt_pk_bf16_f32 v131, v87, v91
    buffer_store_dwordx4 v[128:131], v0, s[8:11], s17 offen offset:3072 sc1
    buffer_load_dwordx4 a[76:79], v0, s[28:31], s46 offen offset:3072
    v_mfma_f32_16x16x16_bf16 v[100:103], v[74:75], v[20:21], v[100:103]
    v_mfma_f32_16x16x16_bf16 v[104:107], v[74:75], v[22:23], v[104:107]
    v_mul_f32 v92, v6, v92
    v_mul_f32 v96, v6, v96
    v_cvt_pk_bf16_f32 v132, v92, v96
    v_mul_f32 v93, v6, v93
    v_mul_f32 v97, v6, v97
    v_cvt_pk_bf16_f32 v133, v93, v97
    v_mul_f32 v94, v6, v94
    v_mul_f32 v98, v6, v98
    v_cvt_pk_bf16_f32 v134, v94, v98
    v_mul_f32 v95, v6, v95
    v_mul_f32 v99, v6, v99
    v_cvt_pk_bf16_f32 v135, v95, v99
    s_add_u32 s17, s48, 4096
    buffer_store_dwordx4 v[132:135], v0, s[8:11], s17 offen offset:1024 sc1
    s_add_u32 s46, s51, 33558528
    buffer_load_dwordx4 a[80:83], v0, s[28:31], s46 offen offset:0
    v_mul_f32 v100, v6, v100
    v_mul_f32 v104, v6, v104
    v_cvt_pk_bf16_f32 v136, v100, v104
    v_mul_f32 v101, v6, v101
    v_mul_f32 v105, v6, v105
    v_cvt_pk_bf16_f32 v137, v101, v105
    v_mul_f32 v102, v6, v102
    v_mul_f32 v106, v6, v106
    v_cvt_pk_bf16_f32 v138, v102, v106
    v_mul_f32 v103, v6, v103
    v_mul_f32 v107, v6, v107
    v_cvt_pk_bf16_f32 v139, v103, v107
    buffer_store_dwordx4 v[136:139], v0, s[8:11], s17 offen offset:3072 sc1
    buffer_load_dwordx4 a[84:87], v0, s[28:31], s46 offen offset:1024
    buffer_load_dwordx4 a[88:91], v0, s[28:31], s46 offen offset:2048
    buffer_load_dwordx4 a[92:95], v0, s[28:31], s46 offen offset:3072
    s_add_u32 s48, s48, 262144
    s_mov_b32 s49, 22528
    s_mov_b32 s66, 0
    s_cmp_ge_u32 s37, 64
    s_cbranch_scc1 LtaS_end
LtaS1:
    s_sub_u32 s17, s37, 33
    s_mul_i32 s18, s17, 43
    s_lshr_b32 s18, s18, 7
    s_mul_i32 s18, s18, 3
    s_cmp_eq_u32 s18, s17
    s_cselect_b32 s18, 1, 0
    s_cmp_lt_u32 s37, 34
    s_cselect_b32 s18, 1, s18
    s_cmp_eq_u32 s36, 0
    s_cselect_b32 s18, 1, s18
    s_and_b32 s18, s18, s61
    s_cbranch_scc1 LtaF1_in
LtaS1_in:
    s_and_b32 s17, s37, 7
    s_mul_i32 s17, s17, 131072
    s_add_u32 s47, s35, s17
    s_bfe_u32 s34, s37, 65539
    s_cmp_eq_u32 s39, 1
    s_cbranch_scc1 LtaS1_have
    s_waitcnt vmcnt(0)
    s_and_b32 s17, s49, s66
    s_cselect_b64 exec, 1, 0
    buffer_store_dword v3, v4, s[8:11], s43 offen
    s_andn2_b32 s17, s49, s66
    s_cselect_b64 exec, 1, 0
    buffer_store_dword v3, v4, s[8:11], s43 offen sc1
    s_mov_b64 exec, -1
    s_add_u32 s43, s43, s49
    s_mov_b32 s49, 0
    s_mov_b32 s16, 0
LtaS1_f_8:
    buffer_load_dword v2, v1, s[8:11], s42 offen sc1
    s_add_u32 s16, s16, 1
    s_cmp_gt_u32 s16, 100000
    s_cbranch_scc1 L_role_ta_abort
    s_waitcnt vmcnt(0)
    v_cmp_eq_u32 vcc, 0, v2
    s_nop 0
    s_cbranch_vccz LtaS1_fd_9
    s_sleep 4
    s_branch LtaS1_f_8
LtaS1_fd_9:
    s_add_u32 s46, s51, 0
    buffer_load_dwordx4 a[0:3], v0, s[8:11], s46 offen offset:0
    buffer_load_dwordx4 a[4:7], v0, s[8:11], s46 offen offset:1024
    buffer_load_dwordx4 a[8:11], v0, s[8:11], s46 offen offset:2048
    buffer_load_dwordx4 a[12:15], v0, s[8:11], s46 offen offset:3072
    s_add_u32 s46, s51, 4096
    buffer_load_dwordx4 a[16:19], v0, s[8:11], s46 offen offset:0
    buffer_load_dwordx4 a[20:23], v0, s[8:11], s46 offen offset:1024
    buffer_load_dwordx4 a[24:27], v0, s[8:11], s46 offen offset:2048
    buffer_load_dwordx4 a[28:31], v0, s[8:11], s46 offen offset:3072
    s_add_u32 s46, s51, 16777216
    buffer_load_dwordx4 a[32:35], v0, s[8:11], s46 offen offset:0
    buffer_load_dwordx4 a[36:39], v0, s[8:11], s46 offen offset:1024
    buffer_load_dwordx4 a[40:43], v0, s[8:11], s46 offen offset:2048
    buffer_load_dwordx4 a[44:47], v0, s[8:11], s46 offen offset:3072
    s_add_u32 s46, s51, 16781312
    buffer_load_dwordx4 a[48:51], v0, s[8:11], s46 offen offset:0
    buffer_load_dwordx4 a[52:55], v0, s[8:11], s46 offen offset:1024
    buffer_load_dwordx4 a[56:59], v0, s[8:11], s46 offen offset:2048
    buffer_load_dwordx4 a[60:63], v0, s[8:11], s46 offen offset:3072
    s_add_u32 s46, s51, 33554432
    buffer_load_dwordx4 a[64:67], v0, s[8:11], s46 offen offset:0
    buffer_load_dwordx4 a[68:71], v0, s[8:11], s46 offen offset:1024
    buffer_load_dwordx4 a[72:75], v0, s[8:11], s46 offen offset:2048
    buffer_load_dwordx4 a[76:79], v0, s[8:11], s46 offen offset:3072
    s_add_u32 s46, s51, 33558528
    buffer_load_dwordx4 a[80:83], v0, s[8:11], s46 offen offset:0
    buffer_load_dwordx4 a[84:87], v0, s[8:11], s46 offen offset:1024
    buffer_load_dwordx4 a[88:91], v0, s[8:11], s46 offen offset:2048
    buffer_load_dwordx4 a[92:95], v0, s[8:11], s46 offen offset:3072
LtaS1_have:
    s_add_u32 s17, s42, 22528
    buffer_load_dword v15, v1, s[8:11], s17 offen sc1
    buffer_load_dwordx4 v[52:55], v9, s[8:11], s47 offen offset:0 sc1
    buffer_load_dwordx4 v[56:59], v9, s[8:11], s47 offen offset:64 sc1
    buffer_load_dwordx4 v[60:63], v9, s[8:11], s47 offen offset:128 sc1
    buffer_load_dwordx4 v[64:67], v9, s[8:11], s47 offen offset:192 sc1
    buffer_load_dwordx2 v[68:69], v10, s[8:11], s47 offen offset:2048 sc1
    buffer_load_dwordx2 v[70:71], v10, s[8:11], s47 offen offset:2560 sc1
    buffer_load_dwordx2 v[72:73], v10, s[8:11], s47 offen offset:3072 sc1
    buffer_load_dwordx2 v[74:75], v10, s[8:11], s47 offen offset:3584 sc1
    s_waitcnt vmcnt(9)
    s_and_b32 s17, s49, s66
    s_cselect_b64 exec, 1, 0
    buffer_store_dword v3, v4, s[8:11], s43 offen
    s_andn2_b32 s17, s49, s66
    s_cselect_b64 exec, 1, 0
    buffer_store_dword v3, v4, s[8:11], s43 offen sc1
    s_mov_b64 exec, -1
    s_add_u32 s43, s43, s49
    s_mov_b32 s49, 0
    v_mfma_f32_16x16x32_bf16 v[32:35], a[32:35], a[0:3], 0
    v_mfma_f32_16x16x32_bf16 v[36:39], a[32:35], a[4:7], 0
    v_mfma_f32_16x16x32_bf16 v[40:43], a[36:39], a[4:7], 0
    v_mfma_f32_16x16x32_bf16 v[32:35], a[40:43], a[8:11], v[32:35]
    v_mfma_f32_16x16x32_bf16 v[36:39], a[40:43], a[12:15], v[36:39]
    v_mfma_f32_16x16x32_bf16 v[40:43], a[44:47], a[12:15], v[40:43]
    v_mfma_f32_16x16x32_bf16 v[32:35], a[48:51], a[16:19], v[32:35]
    v_mfma_f32_16x16x32_bf16 v[36:39], a[48:51], a[20:23], v[36:39]
    v_mfma_f32_16x16x32_bf16 v[40:43], a[52:55], a[20:23], v[40:43]
    v_mfma_f32_16x16x32_bf16 v[32:35], a[56:59], a[24:27], v[32:35]
    v_mfma_f32_16x16x32_bf16 v[36:39], a[56:59], a[28:31], v[36:39]
    v_mfma_f32_16x16x32_bf16 v[40:43], a[60:63], a[28:31], v[40:43]
    s_waitcnt vmcnt(2)
    v_cmp_eq_u32 vcc, 0, v15
    s_add_u32 s51, s51, 262144
    s_add_u32 s42, s42, 22528
    s_add_u32 s37, s37, 1
    s_cmp_eq_u64 vcc, 0
    s_cselect_b32 s39, 1, 0
    s_cmp_lt_u32 s37, 64
    s_cselect_b32 s39, s39, 0
    s_cmp_eq_u32 s39, 1
    s_cselect_b32 s30, 268435456, 0
    v_fma_f32 v32, v32, s52, v236
    v_fma_f32 v33, v33, s52, v237
    v_fma_f32 v34, v34, s52, v238
    v_fma_f32 v35, v35, s52, v239
    v_mul_f32 v36, s52, v36
    v_mul_f32 v37, s52, v37
    v_mul_f32 v38, s52, v38
    v_mul_f32 v39, s52, v39
    v_fma_f32 v40, v40, s52, v236
    v_fma_f32 v41, v41, s52, v237
    v_fma_f32 v42, v42, s52, v238
    v_fma_f32 v43, v43, s52, v239
    v_xor_b32 v5, s34, v52
    v_xor_b32 v6, s34, v56
    v_or_b32 v5, v5, v6
    v_xor_b32 v6, s34, v60
    v_or_b32 v5, v5, v6
    v_xor_b32 v6, s34, v64
    v_or_b32 v5, v5, v6
    v_xor_b32 v6, s34, v68
    v_or_b32 v5, v5, v6
    v_xor_b32 v6, s34, v70
    v_or_b32 v5, v5, v6
    v_xor_b32 v6, s34, v72
    v_or_b32 v5, v5, v6
    v_xor_b32 v6, s34, v74
    v_or_b32 v5, v5, v6
    v_and_b32 v5, 1, v5
    v_cmp_ne_u32 vcc, 0, v5
    s_nop 0
    s_cbranch_vccz LtaS1_r
    s_mov_b32 s16, 0
LtaS1_rp:
    buffer_load_dwordx4 v[52:55], v9, s[8:11], s47 offen offset:0 sc1
    buffer_load_dwordx4 v[56:59], v9, s[8:11], s47 offen offset:64 sc1
    buffer_load_dwordx4 v[60:63], v9, s[8:11], s47 offen offset:128 sc1
    buffer_load_dwordx4 v[64:67], v9, s[8:11], s47 offen offset:192 sc1
    buffer_load_dwordx2 v[68:69], v10, s[8:11], s47 offen offset:2048 sc1
    buffer_load_dwordx2 v[70:71], v10, s[8:11], s47 offen offset:2560 sc1
    buffer_load_dwordx2 v[72:73], v10, s[8:11], s47 offen offset:3072 sc1
    buffer_load_dwordx2 v[74:75], v10, s[8:11], s47 offen offset:3584 sc1
    s_add_u32 s16, s16, 1
    s_cmp_gt_u32 s16, 100000
    s_cbranch_scc1 L_role_ta_abort
    s_waitcnt vmcnt(0)
    v_xor_b32 v5, s34, v52
    v_xor_b32 v6, s34, v56
    v_or_b32 v5, v5, v6
    v_xor_b32 v6, s34, v60
    v_or_b32 v5, v5, v6
    v_xor_b32 v6, s34, v64
    v_or_b32 v5, v5, v6
    v_xor_b32 v6, s34, v68
    v_or_b32 v5, v5, v6
    v_xor_b32 v6, s34, v70
    v_or_b32 v5, v5, v6
    v_xor_b32 v6, s34, v72
    v_or_b32 v5, v5, v6
    v_xor_b32 v6, s34, v74
    v_or_b32 v5, v5, v6
    v_and_b32 v5, 1, v5
    v_cmp_ne_u32 vcc, 0, v5
    s_nop 0
    s_cbranch_vccz LtaS1_r
    s_sleep 2
    s_branch LtaS1_rp
LtaS1_r:
    s_and_b32 s17, s37, 3
    s_cmp_eq_u32 s17, 0
    s_cselect_b32 s17, s36, 0
    s_cmp_lg_u32 s17, 0
    s_cselect_b64 exec, 1, 0
    s_sub_u32 s17, s42, 22528
    buffer_store_dword v3, v4, s[8:11], s17 offen offset:384 sc1
    s_mov_b64 exec, -1
    s_add_u32 s46, s51, 0
    buffer_load_dwordx4 v[140:143], v0, s[28:31], s46 offen offset:0
    buffer_load_dwordx4 v[144:147], v0, s[28:31], s46 offen offset:1024
    v_mfma_f32_16x16x32_bf16 v[44:47], v[52:55], a[0:3], 0
    v_mfma_f32_16x16x32_bf16 v[48:51], v[52:55], a[4:7], 0
    v_mfma_f32_16x16x32_bf16 v[44:47], v[56:59], a[8:11], v[44:47]
    v_mfma_f32_16x16x32_bf16 v[48:51], v[56:59], a[12:15], v[48:51]
    v_mfma_f32_16x16x32_bf16 v[44:47], v[60:63], a[16:19], v[44:47]
    v_mfma_f32_16x16x32_bf16 v[48:51], v[60:63], a[20:23], v[48:51]
    v_mfma_f32_16x16x32_bf16 v[44:47], v[64:67], a[24:27], v[44:47]
    v_mfma_f32_16x16x32_bf16 v[48:51], v[64:67], a[28:31], v[48:51]
    v_max3_f32 v5, v32, v33, v34
    v_max_f32 v5, v5, v35
    s_nop 4
    v_mul_f32 v44, s52, v44
    v_mul_f32 v45, s52, v45
    v_max3_f32 v5, v5, v44, v45
    v_mov_b32 v6, v5
    buffer_load_dwordx4 v[148:151], v0, s[28:31], s46 offen offset:2048
    s_nop 0
    v_permlane32_swap_b32 v5, v6
    v_max_f32 v5, v5, v6
    v_mov_b32 v6, v5
    buffer_load_dwordx4 v[152:155], v0, s[28:31], s46 offen offset:3072
    s_nop 0
    v_permlane16_swap_b32 v5, v6
    v_max_f32 v5, v5, v6
    v_sub_f32 v32, v32, v5
    v_sub_f32 v33, v33, v5
    v_sub_f32 v34, v34, v5
    v_sub_f32 v35, v35, v5
    v_sub_f32 v44, v44, v5
    v_sub_f32 v45, v45, v5
    v_exp_f32 v32, v32
    v_exp_f32 v33, v33
    v_exp_f32 v34, v34
    v_exp_f32 v35, v35
    v_exp_f32 v44, v44
    v_exp_f32 v45, v45
    v_cvt_pk_bf16_f32 v24, v32, v33
    v_cvt_pk_bf16_f32 v25, v34, v35
    v_mov_b32 v26, 0
    v_mov_b32 v27, 0
    v_cvt_pk_bf16_f32 v20, v44, v45
    v_cvt_pk_bf16_f32 v23, v44, v45
    v_mfma_f32_16x16x32_bf16 v[28:31], v[16:19], v[24:27], 0
    v_mfma_f32_16x16x32_bf16 v[76:79], a[64:67], v[24:27], 0
    v_mfma_f32_16x16x32_bf16 v[80:83], a[68:71], v[24:27], 0
    s_add_u32 s46, s51, 4096
    buffer_load_dwordx4 v[156:159], v0, s[28:31], s46 offen offset:0
    v_mfma_f32_16x16x32_bf16 v[84:87], a[72:75], v[24:27], 0
    v_mfma_f32_16x16x32_bf16 v[88:91], a[76:79], v[24:27], 0
    buffer_load_dwordx4 v[160:163], v0, s[28:31], s46 offen offset:1024
    v_mfma_f32_16x16x32_bf16 v[92:95], a[80:83], v[24:27], 0
    v_mfma_f32_16x16x32_bf16 v[96:99], a[84:87], v[24:27], 0
    buffer_load_dwordx4 v[164:167], v0, s[28:31], s46 offen offset:2048
    v_mfma_f32_16x16x16_bf16 v[28:31], v[16:17], v[20:21], v[28:31]
    v_mfma_f32_16x16x32_bf16 v[100:103], a[88:91], v[24:27], 0
    v_mfma_f32_16x16x32_bf16 v[104:107], a[92:95], v[24:27], 0
    buffer_load_dwordx4 v[168:171], v0, s[28:31], s46 offen offset:3072
    v_mfma_f32_16x16x16_bf16 v[76:79], v[68:69], v[20:21], v[76:79]
    v_mfma_f32_16x16x16_bf16 v[80:83], v[68:69], v[22:23], v[80:83]
    s_nop 2
    v_rcp_f32 v6, v28
    v_mfma_f32_16x16x16_bf16 v[84:87], v[70:71], v[20:21], v[84:87]
    v_mfma_f32_16x16x16_bf16 v[88:91], v[70:71], v[22:23], v[88:91]
    s_nop 0
    v_mul_f32 v76, v6, v76
    v_mul_f32 v80, v6, v80
    v_cvt_pk_bf16_f32 v108, v76, v80
    v_mul_f32 v77, v6, v77
    v_mul_f32 v81, v6, v81
    v_cvt_pk_bf16_f32 v109, v77, v81
    v_mul_f32 v78, v6, v78
    v_mul_f32 v82, v6, v82
    v_cvt_pk_bf16_f32 v110, v78, v82
    v_mul_f32 v79, v6, v79
    v_mul_f32 v83, v6, v83
    v_cvt_pk_bf16_f32 v111, v79, v83
    s_add_u32 s17, s48, 0
    buffer_store_dwordx4 v[108:111], v0, s[8:11], s17 offen offset:0 sc1
    s_add_u32 s46, s51, 16777216
    buffer_load_dwordx4 v[172:175], v0, s[28:31], s46 offen offset:0
    v_mfma_f32_16x16x16_bf16 v[92:95], v[72:73], v[20:21], v[92:95]
    v_mfma_f32_16x16x16_bf16 v[96:99], v[72:73], v[22:23], v[96:99]
    v_mul_f32 v84, v6, v84
    v_mul_f32 v88, v6, v88
    v_cvt_pk_bf16_f32 v112, v84, v88
    v_mul_f32 v85, v6, v85
    v_mul_f32 v89, v6, v89
    v_cvt_pk_bf16_f32 v113, v85, v89
    v_mul_f32 v86, v6, v86
    v_mul_f32 v90, v6, v90
    v_cvt_pk_bf16_f32 v114, v86, v90
    v_mul_f32 v87, v6, v87
    v_mul_f32 v91, v6, v91
    v_cvt_pk_bf16_f32 v115, v87, v91
    buffer_store_dwordx4 v[112:115], v0, s[8:11], s17 offen offset:2048 sc1
    buffer_load_dwordx4 v[176:179], v0, s[28:31], s46 offen offset:1024
    v_mfma_f32_16x16x16_bf16 v[100:103], v[74:75], v[20:21], v[100:103]
    v_mfma_f32_16x16x16_bf16 v[104:107], v[74:75], v[22:23], v[104:107]
    v_mul_f32 v92, v6, v92
    v_mul_f32 v96, v6, v96
    v_cvt_pk_bf16_f32 v116, v92, v96
    v_mul_f32 v93, v6, v93
    v_mul_f32 v97, v6, v97
    v_cvt_pk_bf16_f32 v117, v93, v97
    v_mul_f32 v94, v6, v94
    v_mul_f32 v98, v6, v98
    v_cvt_pk_bf16_f32 v118, v94, v98
    v_mul_f32 v95, v6, v95
    v_mul_f32 v99, v6, v99
    v_cvt_pk_bf16_f32 v119, v95, v99
    s_add_u32 s17, s48, 4096
    buffer_store_dwordx4 v[116:119], v0, s[8:11], s17 offen offset:0 sc1
    buffer_load_dwordx4 v[180:183], v0, s[28:31], s46 offen offset:2048
    v_mul_f32 v100, v6, v100
    v_mul_f32 v104, v6, v104
    v_cvt_pk_bf16_f32 v120, v100, v104
    v_mul_f32 v101, v6, v101
    v_mul_f32 v105, v6, v105
    v_cvt_pk_bf16_f32 v121, v101, v105
    v_mul_f32 v102, v6, v102
    v_mul_f32 v106, v6, v106
    v_cvt_pk_bf16_f32 v122, v102, v106
    v_mul_f32 v103, v6, v103
    v_mul_f32 v107, v6, v107
    v_cvt_pk_bf16_f32 v123, v103, v107
    buffer_store_dwordx4 v[120:123], v0, s[8:11], s17 offen offset:2048 sc1
    buffer_load_dwordx4 v[184:187], v0, s[28:31], s46 offen offset:3072
    v_max3_f32 v5, v36, v37, v38
    v_max_f32 v5, v5, v39
    v_max3_f32 v5, v5, v40, v41
    v_max3_f32 v5, v5, v42, v43
    v_mul_f32 v48, s52, v48
    v_mul_f32 v49, s52, v49
    v_max3_f32 v5, v5, v48, v49
    v_mov_b32 v6, v5
    s_add_u32 s46, s51, 16781312
    buffer_load_dwordx4 v[188:191], v0, s[28:31], s46 offen offset:0
    v_permlane32_swap_b32 v5, v6
    v_max_f32 v5, v5, v6
    v_mov_b32 v6, v5
    buffer_load_dwordx4 v[192:195], v0, s[28:31], s46 offen offset:1024
    s_nop 0
    v_permlane16_swap_b32 v5, v6
    v_max_f32 v5, v5, v6
    v_sub_f32 v36, v36, v5
    v_sub_f32 v37, v37, v5
    v_sub_f32 v38, v38, v5
    v_sub_f32 v39, v39, v5
    v_sub_f32 v40, v40, v5
    v_sub_f32 v41, v41, v5
    v_sub_f32 v42, v42, v5
    v_sub_f32 v43, v43, v5
    v_sub_f32 v48, v48, v5
    v_sub_f32 v49, v49, v5
    v_exp_f32 v36, v36
    v_exp_f32 v37, v37
    v_exp_f32 v38, v38
    v_exp_f32 v39, v39
    v_exp_f32 v40, v40
    v_exp_f32 v41, v41
    v_exp_f32 v42, v42
    v_exp_f32 v43, v43
    v_exp_f32 v48, v48
    v_exp_f32 v49, v49
    v_cvt_pk_bf16_f32 v24, v36, v37
    v_cvt_pk_bf16_f32 v25, v38, v39
    v_cvt_pk_bf16_f32 v26, v40, v41
    v_cvt_pk_bf16_f32 v27, v42, v43
    v_cvt_pk_bf16_f32 v20, v48, v49
    v_cvt_pk_bf16_f32 v23, v48, v49
    v_mfma_f32_16x16x32_bf16 v[28:31], v[16:19], v[24:27], 0
    v_mfma_f32_16x16x32_bf16 v[76:79], a[64:67], v[24:27], 0
    v_mfma_f32_16x16x32_bf16 v[80:83], a[68:71], v[24:27], 0
    buffer_load_dwordx4 v[196:199], v0, s[28:31], s46 offen offset:2048
    v_mfma_f32_16x16x32_bf16 v[84:87], a[72:75], v[24:27], 0
    v_mfma_f32_16x16x32_bf16 v[88:91], a[76:79], v[24:27], 0
    buffer_load_dwordx4 v[200:203], v0, s[28:31], s46 offen offset:3072
    v_mfma_f32_16x16x32_bf16 v[92:95], a[80:83], v[24:27], 0
    v_mfma_f32_16x16x32_bf16 v[96:99], a[84:87], v[24:27], 0
    s_add_u32 s46, s51, 33554432
    buffer_load_dwordx4 v[204:207], v0, s[28:31], s46 offen offset:0
    v_mfma_f32_16x16x16_bf16 v[28:31], v[16:17], v[20:21], v[28:31]
    v_mfma_f32_16x16x32_bf16 v[100:103], a[88:91], v[24:27], 0
    v_mfma_f32_16x16x32_bf16 v[104:107], a[92:95], v[24:27], 0
    buffer_load_dwordx4 v[208:211], v0, s[28:31], s46 offen offset:1024
    v_mfma_f32_16x16x16_bf16 v[76:79], v[68:69], v[20:21], v[76:79]
    v_mfma_f32_16x16x16_bf16 v[80:83], v[68:69], v[22:23], v[80:83]
    s_nop 2
    v_rcp_f32 v6, v28
    v_mfma_f32_16x16x16_bf16 v[84:87], v[70:71], v[20:21], v[84:87]
    v_mfma_f32_16x16x16_bf16 v[88:91], v[70:71], v[22:23], v[88:91]
    s_nop 0
    v_mul_f32 v76, v6, v76
    v_mul_f32 v80, v6, v80
    v_cvt_pk_bf16_f32 v124, v76, v80
    v_mul_f32 v77, v6, v77
    v_mul_f32 v81, v6, v81
    v_cvt_pk_bf16_f32 v125, v77, v81
    v_mul_f32 v78, v6, v78
    v_mul_f32 v82, v6, v82
    v_cvt_pk_bf16_f32 v126, v78, v82
    v_mul_f32 v79, v6, v79
    v_mul_f32 v83, v6, v83
    v_cvt_pk_bf16_f32 v127, v79, v83
    s_add_u32 s17, s48, 0
    buffer_store_dwordx4 v[124:127], v0, s[8:11], s17 offen offset:1024 sc1
    buffer_load_dwordx4 v[212:215], v0, s[28:31], s46 offen offset:2048
    v_mfma_f32_16x16x16_bf16 v[92:95], v[72:73], v[20:21], v[92:95]
    v_mfma_f32_16x16x16_bf16 v[96:99], v[72:73], v[22:23], v[96:99]
    v_mul_f32 v84, v6, v84
    v_mul_f32 v88, v6, v88
    v_cvt_pk_bf16_f32 v128, v84, v88
    v_mul_f32 v85, v6, v85
    v_mul_f32 v89, v6, v89
    v_cvt_pk_bf16_f32 v129, v85, v89
    v_mul_f32 v86, v6, v86
    v_mul_f32 v90, v6, v90
    v_cvt_pk_bf16_f32 v130, v86, v90
    v_mul_f32 v87, v6, v87
    v_mul_f32 v91, v6, v91
    v_cvt_pk_bf16_f32 v131, v87, v91
    buffer_store_dwordx4 v[128:131], v0, s[8:11], s17 offen offset:3072 sc1
    buffer_load_dwordx4 v[216:219], v0, s[28:31], s46 offen offset:3072
    v_mfma_f32_16x16x16_bf16 v[100:103], v[74:75], v[20:21], v[100:103]
    v_mfma_f32_16x16x16_bf16 v[104:107], v[74:75], v[22:23], v[104:107]
    v_mul_f32 v92, v6, v92
    v_mul_f32 v96, v6, v96
    v_cvt_pk_bf16_f32 v132, v92, v96
    v_mul_f32 v93, v6, v93
    v_mul_f32 v97, v6, v97
    v_cvt_pk_bf16_f32 v133, v93, v97
    v_mul_f32 v94, v6, v94
    v_mul_f32 v98, v6, v98
    v_cvt_pk_bf16_f32 v134, v94, v98
    v_mul_f32 v95, v6, v95
    v_mul_f32 v99, v6, v99
    v_cvt_pk_bf16_f32 v135, v95, v99
    s_add_u32 s17, s48, 4096
    buffer_store_dwordx4 v[132:135], v0, s[8:11], s17 offen offset:1024 sc1
    s_add_u32 s46, s51, 33558528
    buffer_load_dwordx4 v[220:223], v0, s[28:31], s46 offen offset:0
    v_mul_f32 v100, v6, v100
    v_mul_f32 v104, v6, v104
    v_cvt_pk_bf16_f32 v136, v100, v104
    v_mul_f32 v101, v6, v101
    v_mul_f32 v105, v6, v105
    v_cvt_pk_bf16_f32 v137, v101, v105
    v_mul_f32 v102, v6, v102
    v_mul_f32 v106, v6, v106
    v_cvt_pk_bf16_f32 v138, v102, v106
    v_mul_f32 v103, v6, v103
    v_mul_f32 v107, v6, v107
    v_cvt_pk_bf16_f32 v139, v103, v107
    buffer_store_dwordx4 v[136:139], v0, s[8:11], s17 offen offset:3072 sc1
    buffer_load_dwordx4 v[224:227], v0, s[28:31], s46 offen offset:1024
    buffer_load_dwordx4 v[228:231], v0, s[28:31], s46 offen offset:2048
    buffer_load_dwordx4 v[232:235], v0, s[28:31], s46 offen offset:3072
    s_add_u32 s48, s48, 262144
    s_mov_b32 s49, 22528
    s_mov_b32 s66, 0
    s_cmp_ge_u32 s37, 64
    s_cbranch_scc1 LtaS_end
    s_branch LtaS0
LtaS_end:
    s_waitcnt vmcnt(0)
    s_and_b32 s17, s49, s66
    s_cselect_b64 exec, 1, 0
    buffer_store_dword v3, v4, s[8:11], s43 offen
    s_andn2_b32 s17, s49, s66
    s_cselect_b64 exec, 1, 0
    buffer_store_dword v3, v4, s[8:11], s43 offen sc1
    s_mov_b64 exec, -1
    s_add_u32 s43, s43, s49
    s_mov_b32 s49, 0
    s_branch L_role_ta_exit
L_role_ta_abort:
    s_waitcnt lgkmcnt(0)
    s_mov_b64 exec, -1
    v_mov_b32 v0, 60
    s_lshl_b32 s5, s3, 8
    s_or_b32 s5, s5, s4
    s_or_b32 s5, s5, 0x10000
    v_mov_b32 v1, s5
    global_store_dword v0, v1, s[12:13]
    s_endpgm
L_role_ta_exit:
    s_and_b32 s6, s15, 7
    s_add_u32 s6, s6, s14
    s_cmp_lg_u32 s6, 0
    s_cbranch_scc1 L_role_ta_nowb
    s_waitcnt vmcnt(0)
    buffer_wbl2 sc1
    s_waitcnt vmcnt(0)
L_role_ta_nowb:
    s_endpgm
.p2align 6
L_role_r:
    s_mov_b32 s32, s3
    s_mov_b32 s15, s4
    v_and_b32 v10, 63, v0
    v_and_b32 v60, 15, v10
    v_lshrrev_b32 v61, 4, v10
    v_lshlrev_b32 v0, 4, v10
    v_lshlrev_b32 v8, 2, v10
    s_mul_i32 s17, s14, 26624
    s_add_u32 s17, s17, 57344
    v_add_u32 v9, s17, v0
    s_mov_b32 s54, 0xfffffffe
    s_mov_b32 s46, 0x3e0293ee
    s_mov_b32 s47, 0x3e0293ee
    s_mov_b32 s50, 0x00ff00ff
    s_mov_b32 s51, 0x00ff00ff
    s_mov_b32 s52, -1
    s_mov_b32 s53, 0
    s_mov_b32 s68, 0x3f803f80
    s_mov_b32 s69, 0x3f803f80
    s_mov_b32 s39, 0
    v_lshrrev_b32 v63, 2, v60
    v_and_b32 v64, 1, v60
    v_lshl_add_u32 v62, v63, 1, v64
    v_bfe_u32 v65, v60, 1, 1
    v_mov_b32 v1, 0x4444
    v_mov_b32 v63, 0xeeee
    v_cmp_eq_u32 vcc, 0, v65
    s_nop 1
    v_cndmask_b32 v1, v63, v1, vcc
    v_mul_u32_u24 v63, 576, v61
    v_lshl_add_u32 v2, v60, 2, v63
    s_lshl_b32 s17, s14, 6
    v_add_u32 v2, s17, v2
    v_mul_u32_u24 v63, 288, v62
    v_lshl_add_u32 v3, v61, 4, v63
    v_lshl_add_u32 v4, v61, 5, v63
    v_lshl_add_u32 v4, v65, 4, v4
    s_cmp_eq_u32 s32, 0
    s_cbranch_scc1 Lr_noord
    s_cmp_lg_u32 s14, 0
    s_cbranch_scc1 Lr_ord_d
    v_mov_b32 v63, 48
    s_mov_b32 s16, 0
Lr_ord:
    global_load_dword v64, v63, s[12:13] sc1
    s_add_u32 s16, s16, 1
    s_cmp_gt_u32 s16, 100000
    s_cbranch_scc1 Lr_abort
    s_waitcnt vmcnt(0)
    v_cmp_gt_u32 vcc, 16, v64
    s_nop 0
    s_cbranch_vccz Lr_ord_d
    s_sleep 32
    s_branch Lr_ord
Lr_ord_d:
    s_barrier
Lr_noord:
    s_load_dwordx2 s[20:21], s[0:1], 40
    s_mov_b32 s22, 4718592
    s_mov_b32 s23, 0x00020000
    s_waitcnt lgkmcnt(0)
    s_and_b32 s21, s21, 0xffff
    s_load_dwordx2 s[24:25], s[0:1], 48
    s_mov_b32 s26, 4718592
    s_mov_b32 s27, 0x00020000
    s_waitcnt lgkmcnt(0)
    s_and_b32 s25, s25, 0xffff
    s_load_dwordx2 s[28:29], s[0:1], 56
    s_mov_b32 s30, 4718592
    s_mov_b32 s31, 0x00020000
    s_waitcnt lgkmcnt(0)
    s_and_b32 s29, s29, 0xffff
    s_load_dwordx2 s[80:81], s[0:1], 64
    s_mov_b32 s82, 4718592
    s_mov_b32 s83, 0x00020000
    s_waitcnt lgkmcnt(0)
    s_and_b32 s81, s81, 0xffff
    v_lshlrev_b32 v71, 1, v61
    v_xor_b32 v71, v71, v60
    v_lshlrev_b32 v71, 4, v71
    v_lshl_add_u32 v62, v61, 13, v71
    v_xor_b32 v63, 128, v62
    v_lshrrev_b32 v64, 1, v61
    v_lshlrev_b32 v64, 3, v64
    v_and_b32 v65, 1, v61
    v_lshl_add_u32 v64, v65, 2, v64
    v_lshl_add_u32 v64, v64, 13, v71
    v_xor_b32 v65, 128, v64
    s_mul_i32 s57, s14, 1179648
    s_lshl_b32 s17, s15, 8
    s_add_u32 s57, s57, s17
    s_lshl_b32 s58, s14, 12
    v_lshrrev_b32 v71, 2, v60
    v_lshl_add_u32 v66, v61, 3, v71
    v_lshlrev_b32 v66, 8, v66
    v_bfe_u32 v67, v60, 1, 1
    s_lshl_b32 s17, s14, 2
    v_add_u32 v67, s17, v67
    v_lshlrev_b32 v71, 1, v71
    v_xor_b32 v67, v67, v71
    v_and_b32 v71, 1, v61
    v_lshlrev_b32 v71, 3, v71
    v_xor_b32 v67, v67, v71
    v_and_b32 v71, 1, v60
    v_lshl_add_u32 v66, v71, 3, v66
    v_xor_b32 v71, 2, v67
    v_lshl_add_u32 v67, v71, 4, v66
    v_xor_b32 v71, 2, v71
    v_lshl_add_u32 v66, v71, 4, v66
    v_lshrrev_b32 v71, 2, v60
    v_lshl_add_u32 v70, v61, 2, v71
    v_mul_u32_u24 v70, 1152, v70
    v_and_b32 v71, 3, v60
    v_lshl_add_u32 v70, v71, 3, v70
    s_mul_i32 s17, s14, 288
    v_add_u32 v70, s17, v70
    v_add_u32 v71, 0, v10
    v_mul_u32_u24 v59, 911, v71
    v_lshrrev_b32 v59, 16, v59
    v_mul_u32_u24 v60, 72, v59
    v_sub_u32 v71, v71, v60
    v_and_b32 v60, 1, v59
    v_lshlrev_b32 v60, 4, v60
    v_lshrrev_b32 v59, 1, v59
    v_lshl_add_u32 v60, v59, 2, v60
    v_mul_u32_u24 v60, 1152, v60
    v_lshl_add_u32 v50, v71, 4, v60
    v_add_u32 v71, 64, v10
    v_mul_u32_u24 v59, 911, v71
    v_lshrrev_b32 v59, 16, v59
    v_mul_u32_u24 v60, 72, v59
    v_sub_u32 v71, v71, v60
    v_and_b32 v60, 1, v59
    v_lshlrev_b32 v60, 4, v60
    v_lshrrev_b32 v59, 1, v59
    v_lshl_add_u32 v60, v59, 2, v60
    v_mul_u32_u24 v60, 1152, v60
    v_lshl_add_u32 v51, v71, 4, v60
    v_add_u32 v71, 128, v10
    v_mul_u32_u24 v59, 911, v71
    v_lshrrev_b32 v59, 16, v59
    v_mul_u32_u24 v60, 72, v59
    v_sub_u32 v71, v71, v60
    v_and_b32 v60, 1, v59
    v_lshlrev_b32 v60, 4, v60
    v_lshrrev_b32 v59, 1, v59
    v_lshl_add_u32 v60, v59, 2, v60
    v_mul_u32_u24 v60, 1152, v60
    v_lshl_add_u32 v52, v71, 4, v60
    v_add_u32 v71, 192, v10
    v_mul_u32_u24 v59, 911, v71
    v_lshrrev_b32 v59, 16, v59
    v_mul_u32_u24 v60, 72, v59
    v_sub_u32 v71, v71, v60
    v_and_b32 v60, 1, v59
    v_lshlrev_b32 v60, 4, v60
    v_lshrrev_b32 v59, 1, v59
    v_lshl_add_u32 v60, v59, 2, v60
    v_mul_u32_u24 v60, 1152, v60
    v_lshl_add_u32 v53, v71, 4, v60
    v_add_u32 v71, 256, v10
    v_mul_u32_u24 v59, 911, v71
    v_lshrrev_b32 v59, 16, v59
    v_mul_u32_u24 v60, 72, v59
    v_sub_u32 v71, v71, v60
    v_and_b32 v60, 1, v59
    v_lshlrev_b32 v60, 4, v60
    v_lshrrev_b32 v59, 1, v59
    v_lshl_add_u32 v60, v59, 2, v60
    v_mul_u32_u24 v60, 1152, v60
    v_lshl_add_u32 v54, v71, 4, v60
    s_lshr_b32 s17, s14, 1
    s_lshl_b32 s17, s17, 3
    s_and_b32 s18, s14, 1
    s_lshl_b32 s18, s18, 1
    s_add_u32 s17, s17, s18
    s_lshl_b32 s18, s15, 7
    s_add_u32 s17, s17, s18
    s_mul_i32 s59, s17, 1152
    s_mul_i32 s60, s14, 4608
    s_add_u32 m0, s58, 49152
    s_add_u32 s17, s57, 0
    buffer_load_dwordx4 v62, s[20:23], s17 offen lds
    s_add_u32 m0, s58, 50176
    s_add_u32 s17, s57, 32768
    buffer_load_dwordx4 v62, s[20:23], s17 offen lds
    s_add_u32 m0, s58, 51200
    s_add_u32 s17, s57, 65536
    buffer_load_dwordx4 v63, s[20:23], s17 offen lds
    s_add_u32 m0, s58, 52224
    s_add_u32 s17, s57, 98304
    buffer_load_dwordx4 v63, s[20:23], s17 offen lds
    s_add_u32 m0, s58, 65536
    s_add_u32 s17, s57, 0
    buffer_load_dwordx4 v62, s[24:27], s17 offen lds
    s_add_u32 m0, s58, 66560
    s_add_u32 s17, s57, 32768
    buffer_load_dwordx4 v62, s[24:27], s17 offen lds
    s_add_u32 m0, s58, 67584
    s_add_u32 s17, s57, 65536
    buffer_load_dwordx4 v63, s[24:27], s17 offen lds
    s_add_u32 m0, s58, 68608
    s_add_u32 s17, s57, 98304
    buffer_load_dwordx4 v63, s[24:27], s17 offen lds
    s_add_u32 m0, s58, 81920
    s_add_u32 s17, s57, 0
    buffer_load_dwordx4 v62, s[28:31], s17 offen lds
    s_add_u32 m0, s58, 82944
    s_add_u32 s17, s57, 32768
    buffer_load_dwordx4 v62, s[28:31], s17 offen lds
    s_add_u32 m0, s58, 83968
    s_add_u32 s17, s57, 65536
    buffer_load_dwordx4 v63, s[28:31], s17 offen lds
    s_add_u32 m0, s58, 84992
    s_add_u32 s17, s57, 98304
    buffer_load_dwordx4 v63, s[28:31], s17 offen lds
    s_add_u32 m0, s58, 98304
    s_add_u32 s17, s57, 131072
    buffer_load_dwordx4 v62, s[20:23], s17 offen lds
    s_add_u32 m0, s58, 99328
    s_add_u32 s17, s57, 163840
    buffer_load_dwordx4 v62, s[20:23], s17 offen lds
    s_add_u32 m0, s58, 100352
    s_add_u32 s17, s57, 196608
    buffer_load_dwordx4 v63, s[20:23], s17 offen lds
    s_add_u32 m0, s58, 101376
    s_add_u32 s17, s57, 229376
    buffer_load_dwordx4 v63, s[20:23], s17 offen lds
    s_add_u32 m0, s58, 114688
    s_add_u32 s17, s57, 131072
    buffer_load_dwordx4 v62, s[24:27], s17 offen lds
    s_add_u32 m0, s58, 115712
    s_add_u32 s17, s57, 163840
    buffer_load_dwordx4 v62, s[24:27], s17 offen lds
    s_add_u32 m0, s58, 116736
    s_add_u32 s17, s57, 196608
    buffer_load_dwordx4 v63, s[24:27], s17 offen lds
    s_add_u32 m0, s58, 117760
    s_add_u32 s17, s57, 229376
    buffer_load_dwordx4 v63, s[24:27], s17 offen lds
    s_add_u32 m0, s58, 131072
    s_add_u32 s17, s57, 131072
    buffer_load_dwordx4 v62, s[28:31], s17 offen lds
    s_add_u32 m0, s58, 132096
    s_add_u32 s17, s57, 163840
    buffer_load_dwordx4 v62, s[28:31], s17 offen lds
    s_add_u32 m0, s58, 133120
    s_add_u32 s17, s57, 196608
    buffer_load_dwordx4 v63, s[28:31], s17 offen lds
    s_add_u32 m0, s58, 134144
    s_add_u32 s17, s57, 229376
    buffer_load_dwordx4 v63, s[28:31], s17 offen lds
    s_add_u32 m0, s58, 147456
    s_add_u32 s17, s57, 262144
    buffer_load_dwordx4 v62, s[20:23], s17 offen lds
    s_add_u32 m0, s58, 148480
    s_add_u32 s17, s57, 294912
    buffer_load_dwordx4 v62, s[20:23], s17 offen lds
    s_add_u32 m0, s58, 149504
    s_add_u32 s17, s57, 327680
    buffer_load_dwordx4 v63, s[20:23], s17 offen lds
    s_add_u32 m0, s58, 150528
    s_add_u32 s17, s57, 360448
    buffer_load_dwordx4 v63, s[20:23], s17 offen lds
    s_add_u32 m0, s58, 0
    s_add_u32 s17, s57, 262144
    buffer_load_dwordx4 v62, s[24:27], s17 offen lds
    s_add_u32 m0, s58, 1024
    s_add_u32 s17, s57, 294912
    buffer_load_dwordx4 v62, s[24:27], s17 offen lds
    s_add_u32 m0, s58, 2048
    s_add_u32 s17, s57, 327680
    buffer_load_dwordx4 v63, s[24:27], s17 offen lds
    s_add_u32 m0, s58, 3072
    s_add_u32 s17, s57, 360448
    buffer_load_dwordx4 v63, s[24:27], s17 offen lds
    s_add_u32 m0, s58, 16384
    s_add_u32 s17, s57, 262144
    buffer_load_dwordx4 v62, s[28:31], s17 offen lds
    s_add_u32 m0, s58, 17408
    s_add_u32 s17, s57, 294912
    buffer_load_dwordx4 v62, s[28:31], s17 offen lds
    s_add_u32 m0, s58, 18432
    s_add_u32 s17, s57, 327680
    buffer_load_dwordx4 v63, s[28:31], s17 offen lds
    s_add_u32 m0, s58, 19456
    s_add_u32 s17, s57, 360448
    buffer_load_dwordx4 v63, s[28:31], s17 offen lds
    v_and_b32 v12, 15, v10
    v_lshrrev_b32 v13, 4, v10
    s_lshr_b32 s84, s15, 3
    s_bfe_u32 s85, s15, 0x20001
    s_and_b32 s86, s15, 1
    s_cmp_lt_u32 s14, 2
    s_cbranch_scc1 Lr_jab
    s_lshr_b32 s84, s15, 1
    s_and_b32 s84, s84, 3
Lr_jab:
    s_cmp_lt_u32 s15, 8
    s_cselect_b32 s62, 1, 0
    v_bfe_u32 v20, v12, 2, 1
    v_lshl_add_u32 v17, v20, 2, v13
    v_mul_u32_u24 v17, 12288, v17
    v_lshrrev_b32 v21, 3, v12
    v_lshlrev_b32 v21, 2, v21
    v_and_b32 v20, 3, v12
    v_add_u32 v21, v21, v20
    v_lshl_add_u32 v6, v21, 4, v17
    s_mul_i32 s17, s84, 2304
    s_lshl_b32 s18, s14, 10
    s_add_u32 s17, s17, s18
    s_lshl_b32 s18, s86, 7
    s_add_u32 s17, s17, s18
    s_lshl_b32 s18, s85, 8
    s_cmp_lt_u32 s14, 2
    s_cselect_b32 s18, s18, 0
    s_add_u32 s17, s17, s18
    v_add_u32 v6, s17, v6
    v_bfe_u32 v24, v12, 1, 2
    v_and_b32 v25, 1, v12
    v_lshrrev_b32 v26, 1, v13
    v_and_b32 v27, 1, v13
    s_cmp_lt_u32 s14, 2
    s_cbranch_scc0 Lr_jc
    s_lshl_b32 s17, s14, 2
    v_add_u32 v18, s17, v24
    v_lshlrev_b32 v7, 10, v18
    v_lshl_add_u32 v19, v27, 1, v25
    s_lshl_b32 s17, s84, 4
    s_lshl_b32 s18, s85, 2
    s_add_u32 s17, s17, s18
    v_add_u32 v19, s17, v19
    v_lshl_add_u32 v7, v19, 4, v7
    s_lshl_b32 s17, s86, 1
    v_add_u32 v19, s17, v26
    v_lshl_add_u32 v7, v19, 2, v7
    s_lshl_b32 s17, s85, 1
    v_add_u32 v19, s17, v25
    v_mul_u32_u24 v19, 576, v19
    v_lshl_add_u32 v19, v18, 4, v19
    v_lshl_add_u32 v19, v13, 1, v19
    s_mul_i32 s17, s84, 144
    s_lshl_b32 s18, s86, 3
    s_add_u32 s17, s17, s18
    v_add_u32 v19, s17, v19
    v_lshlrev_b32 v14, 1, v19
    v_add_u32 v15, 2, v14
    s_branch Lr_jd
Lr_jc:
    s_lshl_b32 s17, s86, 1
    v_add_u32 v18, s17, v26
    v_lshlrev_b32 v19, 2, v18
    v_lshl_add_u32 v19, v27, 1, v19
    v_add_u32 v19, v19, v25
    s_lshl_b32 s17, s84, 4
    v_add_u32 v19, s17, v19
    v_lshlrev_b32 v7, 4, v19
    v_lshl_add_u32 v7, v24, 2, v7
    v_add_u32 v7, 8192, v7
    v_lshl_add_u32 v19, v18, 1, v25
    v_mul_u32_u24 v19, 576, v19
    v_lshl_add_u32 v19, v27, 3, v19
    v_add_u32 v19, v19, v24
    s_mul_i32 s17, s84, 144
    s_add_u32 s17, s17, 128
    v_add_u32 v19, s17, v19
    v_lshlrev_b32 v14, 1, v19
    v_add_u32 v15, 8, v14
Lr_jd:
    s_mul_i32 s48, s32, 1048576
    s_add_u32 s48, s48, 4194304
    s_lshl_b32 s18, s14, 11
    s_lshl_b32 s19, s14, 8
    s_add_u32 s19, s19, 8192
    s_mul_i32 s17, s15, 12288
    s_add_u32 s17, s17, s48
    s_mul_i32 s38, s14, 2304
    s_add_u32 s38, s38, s17
    s_add_u32 s37, s48, 983040
    s_xor_b32 s36, s37, 16384
    s_add_u32 s34, s37, s18
    s_add_u32 s35, s37, s19
    s_mul_i32 s17, s32, 50331648
    s_lshl_b32 s19, s15, 13
    s_add_u32 s17, s17, s19
    s_add_u32 s40, s17, 61079552
    s_add_u32 s17, s17, s18
    s_add_u32 s41, s17, 60817408
    s_add_u32 s42, s17, 77594624
    s_mul_i32 s17, s32, 1048576
    s_lshl_b32 s19, s15, 12
    s_add_u32 s17, s17, s19
    s_lshl_b32 s19, s14, 9
    s_add_u32 s17, s17, s19
    s_add_u32 s45, s17, 27262976
    s_mov_b32 s86, s19
    s_mov_b32 s43, s45
    s_mov_b32 s66, 0
    s_mov_b32 s67, 1464320
    s_mov_b32 s78, 0xff
    s_mov_b32 s79, 0
    s_mul_i32 s17, s32, 1441792
    s_lshl_b32 s19, s15, 9
    s_add_u32 s17, s17, s19
    s_add_u32 s44, s17, 185600
    s_mov_b32 s33, 0
    s_load_dwordx2 s[88:89], s[0:1], 32
    s_mov_b32 s90, 9216
    s_mov_b32 s91, 0x00020000
    s_waitcnt lgkmcnt(0)
    s_and_b32 s89, s89, 0xffff
    s_cmp_eq_u32 s14, 3
    s_cbranch_scc1 Lr_mem0_done
    s_cmp_lt_u32 s14, 2
    s_cselect_b32 s17, 1, s62
    s_cmp_eq_u32 s17, 0
    s_cbranch_scc1 Lr_mem0_done
    s_mov_b64 exec, s[50:51]
    buffer_load_ushort v20, v14, s[88:91], 0 offen
    buffer_load_ushort v21, v15, s[88:91], 0 offen
    s_waitcnt vmcnt(0)
    v_lshl_or_b32 v20, v21, 16, v20
    v_min_u32 v20, s54, v20
    buffer_store_dword v20, v7, s[8:11], s37 offen sc1
    v_mov_b32 v20, -1
    buffer_store_dword v20, v7, s[8:11], s36 offen sc1
    s_mov_b64 exec, -1
Lr_mem0_done:
    v_mov_b32 v20, 1
    v_mov_b32 v21, 1
    v_mov_b32 v22, 1
    v_mov_b32 v23, 1
    s_xor_b32 s17, s38, 524288
    buffer_store_dwordx4 v[20:23], v0, s[8:11], s38 offen offset:0 sc1
    buffer_store_dwordx4 v[20:23], v0, s[8:11], s38 offen offset:1024 sc1
    buffer_store_dword v20, v8, s[8:11], s38 offen offset:2048 sc1
    buffer_store_dwordx4 v[20:23], v0, s[8:11], s17 offen offset:0 sc1
    buffer_store_dwordx4 v[20:23], v0, s[8:11], s17 offen offset:1024 sc1
    buffer_store_dword v20, v8, s[8:11], s17 offen offset:2048 sc1
    v_lshrrev_b32 v17, 1, v0
    s_mov_b32 s17, s45
    buffer_store_dwordx2 v[20:21], v17, s[8:11], s17 offen offset:2048 sc1
    s_mov_b64 exec, s[52:53]
    buffer_store_dwordx4 v[20:23], v0, s[8:11], s17 offen sc1
    s_mov_b64 exec, -1
    s_add_u32 s17, s17, 131072
    buffer_store_dwordx2 v[20:21], v17, s[8:11], s17 offen offset:2048 sc1
    s_mov_b64 exec, s[52:53]
    buffer_store_dwordx4 v[20:23], v0, s[8:11], s17 offen sc1
    s_mov_b64 exec, -1
    s_add_u32 s17, s17, 131072
    buffer_store_dwordx2 v[20:21], v17, s[8:11], s17 offen offset:2048 sc1
    s_mov_b64 exec, s[52:53]
    buffer_store_dwordx4 v[20:23], v0, s[8:11], s17 offen sc1
    s_mov_b64 exec, -1
    s_add_u32 s17, s17, 131072
    buffer_store_dwordx2 v[20:21], v17, s[8:11], s17 offen offset:2048 sc1
    s_mov_b64 exec, s[52:53]
    buffer_store_dwordx4 v[20:23], v0, s[8:11], s17 offen sc1
    s_mov_b64 exec, -1
    s_add_u32 s17, s17, 131072
    buffer_store_dwordx2 v[20:21], v17, s[8:11], s17 offen offset:2048 sc1
    s_mov_b64 exec, s[52:53]
    buffer_store_dwordx4 v[20:23], v0, s[8:11], s17 offen sc1
    s_mov_b64 exec, -1
    s_add_u32 s17, s17, 131072
    buffer_store_dwordx2 v[20:21], v17, s[8:11], s17 offen offset:2048 sc1
    s_mov_b64 exec, s[52:53]
    buffer_store_dwordx4 v[20:23], v0, s[8:11], s17 offen sc1
    s_mov_b64 exec, -1
    s_add_u32 s17, s17, 131072
    buffer_store_dwordx2 v[20:21], v17, s[8:11], s17 offen offset:2048 sc1
    s_mov_b64 exec, s[52:53]
    buffer_store_dwordx4 v[20:23], v0, s[8:11], s17 offen sc1
    s_mov_b64 exec, -1
    s_add_u32 s17, s17, 131072
    buffer_store_dwordx2 v[20:21], v17, s[8:11], s17 offen offset:2048 sc1
    s_mov_b64 exec, s[52:53]
    buffer_store_dwordx4 v[20:23], v0, s[8:11], s17 offen sc1
    s_mov_b64 exec, -1
    s_add_u32 s17, s17, 131072
    s_cmp_lg_u32 s14, 3
    s_cbranch_scc1 Lr_not_w3
    v_and_b32 v7, 12, v8
    v_and_b32 v17, 4, v10
    v_lshl_add_u32 v7, v17, 5, v7
    s_add_u32 s17, s44, 4294877568
    s_cmp_eq_u32 s32, 0
    s_cselect_b32 s67, s67, s17
    s_add_u32 s17, s44, 22656
    s_min_u32 s18, s17, s67
    s_sub_u32 s17, s17, s18
    v_add_u32 v7, s17, v7
    s_sub_u32 s17, s67, s18
    v_mov_b32 v17, s17
    v_cmp_gt_u32 vcc, 8, v10
    s_nop 1
    v_cndmask_b32 v7, v17, v7, vcc
    s_mov_b32 s67, s18
Lr_not_w3:
    v_lshlrev_b32 v5, 3, v0
    s_add_u32 s56, s40, 16777216
    s_waitcnt vmcnt(32)
    s_barrier
    s_cmp_lg_u32 s14, 0
    s_cbranch_scc1 Lr_noadd
    s_lshl_b32 s17, s32, 2
    s_add_u32 s17, s17, 192
    v_mov_b32 v48, s17
    v_mov_b32 v49, 1
    s_mov_b64 exec, 1
    global_atomic_add v48, v49, s[12:13]
    s_mov_b64 exec, -1
Lr_noadd:
    s_add_u32 m0, s58, 32768
    s_add_u32 s17, s57, 393216
    buffer_load_dwordx4 v62, s[20:23], s17 offen lds
    s_add_u32 m0, s58, 33792
    s_add_u32 s17, s57, 425984
    buffer_load_dwordx4 v62, s[20:23], s17 offen lds
    s_add_u32 m0, s58, 34816
    s_add_u32 s17, s57, 458752
    buffer_load_dwordx4 v63, s[20:23], s17 offen lds
    s_add_u32 m0, s58, 35840
    s_add_u32 s17, s57, 491520
    buffer_load_dwordx4 v63, s[20:23], s17 offen lds
    v_add_u32 v68, 49152, v66
    v_add_u32 v69, 49152, v67
    ds_read_b64_tr_b16 v[72:73], v68 offset:0
    ds_read_b64_tr_b16 v[74:75], v68 offset:1024
    ds_read_b64_tr_b16 v[76:77], v68 offset:8192
    ds_read_b64_tr_b16 v[78:79], v68 offset:9216
    ds_read_b64_tr_b16 v[80:81], v69 offset:0
    ds_read_b64_tr_b16 v[82:83], v69 offset:1024
    ds_read_b64_tr_b16 v[84:85], v69 offset:8192
    ds_read_b64_tr_b16 v[86:87], v69 offset:9216
    s_waitcnt lgkmcnt(0)
    s_waitcnt vmcnt(32)
    s_barrier
    s_add_u32 m0, s58, 49152
    s_add_u32 s17, s57, 393216
    buffer_load_dwordx4 v62, s[24:27], s17 offen lds
    s_add_u32 m0, s58, 50176
    s_add_u32 s17, s57, 425984
    buffer_load_dwordx4 v62, s[24:27], s17 offen lds
    s_add_u32 m0, s58, 51200
    s_add_u32 s17, s57, 458752
    buffer_load_dwordx4 v63, s[24:27], s17 offen lds
    s_add_u32 m0, s58, 52224
    s_add_u32 s17, s57, 491520
    buffer_load_dwordx4 v63, s[24:27], s17 offen lds
    v_add_u32 v68, 65536, v66
    v_add_u32 v69, 65536, v67
    ds_read_b64_tr_b16 v[88:89], v68 offset:0
    ds_read_b64_tr_b16 v[90:91], v68 offset:1024
    ds_read_b64_tr_b16 v[92:93], v68 offset:8192
    ds_read_b64_tr_b16 v[94:95], v68 offset:9216
    ds_read_b64_tr_b16 a[176:177], v69 offset:0
    ds_read_b64_tr_b16 a[178:179], v69 offset:1024
    ds_read_b64_tr_b16 a[180:181], v69 offset:8192
    ds_read_b64_tr_b16 a[182:183], v69 offset:9216
    s_waitcnt lgkmcnt(0)
    s_waitcnt vmcnt(32)
    s_barrier
    s_add_u32 m0, s58, 65536
    s_add_u32 s17, s57, 393216
    buffer_load_dwordx4 v62, s[28:31], s17 offen lds
    s_add_u32 m0, s58, 66560
    s_add_u32 s17, s57, 425984
    buffer_load_dwordx4 v62, s[28:31], s17 offen lds
    s_add_u32 m0, s58, 67584
    s_add_u32 s17, s57, 458752
    buffer_load_dwordx4 v63, s[28:31], s17 offen lds
    s_add_u32 m0, s58, 68608
    s_add_u32 s17, s57, 491520
    buffer_load_dwordx4 v63, s[28:31], s17 offen lds
    v_add_u32 v68, 81920, v66
    v_add_u32 v69, 81920, v67
    ds_read_b64_tr_b16 v[96:97], v68 offset:0
    ds_read_b64_tr_b16 v[98:99], v68 offset:1024
    ds_read_b64_tr_b16 v[100:101], v68 offset:8192
    ds_read_b64_tr_b16 v[102:103], v68 offset:9216
    ds_read_b64_tr_b16 v[104:105], v69 offset:0
    ds_read_b64_tr_b16 v[106:107], v69 offset:1024
    ds_read_b64_tr_b16 v[108:109], v69 offset:8192
    ds_read_b64_tr_b16 v[110:111], v69 offset:9216
    s_waitcnt lgkmcnt(0)
    s_waitcnt vmcnt(32)
    s_barrier
    s_add_u32 m0, s58, 81920
    s_add_u32 s17, s57, 524288
    buffer_load_dwordx4 v62, s[20:23], s17 offen lds
    s_add_u32 m0, s58, 82944
    s_add_u32 s17, s57, 557056
    buffer_load_dwordx4 v62, s[20:23], s17 offen lds
    s_add_u32 m0, s58, 83968
    s_add_u32 s17, s57, 589824
    buffer_load_dwordx4 v63, s[20:23], s17 offen lds
    s_add_u32 m0, s58, 84992
    s_add_u32 s17, s57, 622592
    buffer_load_dwordx4 v63, s[20:23], s17 offen lds
    v_add_u32 v68, 98304, v66
    v_add_u32 v69, 98304, v67
    ds_read_b64_tr_b16 v[112:113], v68 offset:0
    ds_read_b64_tr_b16 v[114:115], v68 offset:1024
    ds_read_b64_tr_b16 v[116:117], v68 offset:8192
    ds_read_b64_tr_b16 v[118:119], v68 offset:9216
    ds_read_b64_tr_b16 v[120:121], v69 offset:0
    ds_read_b64_tr_b16 v[122:123], v69 offset:1024
    ds_read_b64_tr_b16 v[124:125], v69 offset:8192
    ds_read_b64_tr_b16 v[126:127], v69 offset:9216
    s_waitcnt lgkmcnt(0)
    s_waitcnt vmcnt(32)
    s_barrier
    s_add_u32 m0, s58, 98304
    s_add_u32 s17, s57, 524288
    buffer_load_dwordx4 v62, s[24:27], s17 offen lds
    s_add_u32 m0, s58, 99328
    s_add_u32 s17, s57, 557056
    buffer_load_dwordx4 v62, s[24:27], s17 offen lds
    s_add_u32 m0, s58, 100352
    s_add_u32 s17, s57, 589824
    buffer_load_dwordx4 v63, s[24:27], s17 offen lds
    s_add_u32 m0, s58, 101376
    s_add_u32 s17, s57, 622592
    buffer_load_dwordx4 v63, s[24:27], s17 offen lds
    v_add_u32 v68, 114688, v66
    v_add_u32 v69, 114688, v67
    ds_read_b64_tr_b16 v[128:129], v68 offset:0
    ds_read_b64_tr_b16 v[130:131], v68 offset:1024
    ds_read_b64_tr_b16 v[132:133], v68 offset:8192
    ds_read_b64_tr_b16 v[134:135], v68 offset:9216
    ds_read_b64_tr_b16 a[184:185], v69 offset:0
    ds_read_b64_tr_b16 a[186:187], v69 offset:1024
    ds_read_b64_tr_b16 a[188:189], v69 offset:8192
    ds_read_b64_tr_b16 a[190:191], v69 offset:9216
    s_waitcnt lgkmcnt(0)
    s_waitcnt vmcnt(32)
    s_barrier
    s_add_u32 m0, s58, 114688
    s_add_u32 s17, s57, 524288
    buffer_load_dwordx4 v62, s[28:31], s17 offen lds
    s_add_u32 m0, s58, 115712
    s_add_u32 s17, s57, 557056
    buffer_load_dwordx4 v62, s[28:31], s17 offen lds
    s_add_u32 m0, s58, 116736
    s_add_u32 s17, s57, 589824
    buffer_load_dwordx4 v63, s[28:31], s17 offen lds
    s_add_u32 m0, s58, 117760
    s_add_u32 s17, s57, 622592
    buffer_load_dwordx4 v63, s[28:31], s17 offen lds
    v_add_u32 v68, 131072, v66
    v_add_u32 v69, 131072, v67
    ds_read_b64_tr_b16 v[136:137], v68 offset:0
    ds_read_b64_tr_b16 v[138:139], v68 offset:1024
    ds_read_b64_tr_b16 v[140:141], v68 offset:8192
    ds_read_b64_tr_b16 v[142:143], v68 offset:9216
    ds_read_b64_tr_b16 v[144:145], v69 offset:0
    ds_read_b64_tr_b16 v[146:147], v69 offset:1024
    ds_read_b64_tr_b16 v[148:149], v69 offset:8192
    ds_read_b64_tr_b16 v[150:151], v69 offset:9216
    s_waitcnt lgkmcnt(0)
    s_waitcnt vmcnt(32)
    s_barrier
    s_add_u32 m0, s58, 131072
    s_add_u32 s17, s57, 655360
    buffer_load_dwordx4 v62, s[20:23], s17 offen lds
    s_add_u32 m0, s58, 132096
    s_add_u32 s17, s57, 688128
    buffer_load_dwordx4 v62, s[20:23], s17 offen lds
    s_add_u32 m0, s58, 133120
    s_add_u32 s17, s57, 720896
    buffer_load_dwordx4 v63, s[20:23], s17 offen lds
    s_add_u32 m0, s58, 134144
    s_add_u32 s17, s57, 753664
    buffer_load_dwordx4 v63, s[20:23], s17 offen lds
    v_add_u32 v68, 147456, v66
    v_add_u32 v69, 147456, v67
    ds_read_b64_tr_b16 v[152:153], v68 offset:0
    ds_read_b64_tr_b16 v[154:155], v68 offset:1024
    ds_read_b64_tr_b16 v[156:157], v68 offset:8192
    ds_read_b64_tr_b16 v[158:159], v68 offset:9216
    ds_read_b64_tr_b16 v[160:161], v69 offset:0
    ds_read_b64_tr_b16 v[162:163], v69 offset:1024
    ds_read_b64_tr_b16 v[164:165], v69 offset:8192
    ds_read_b64_tr_b16 v[166:167], v69 offset:9216
    s_waitcnt lgkmcnt(0)
    s_waitcnt vmcnt(32)
    s_barrier
    s_add_u32 m0, s58, 147456
    s_add_u32 s17, s57, 655360
    buffer_load_dwordx4 v62, s[24:27], s17 offen lds
    s_add_u32 m0, s58, 148480
    s_add_u32 s17, s57, 688128
    buffer_load_dwordx4 v62, s[24:27], s17 offen lds
    s_add_u32 m0, s58, 149504
    s_add_u32 s17, s57, 720896
    buffer_load_dwordx4 v63, s[24:27], s17 offen lds
    s_add_u32 m0, s58, 150528
    s_add_u32 s17, s57, 753664
    buffer_load_dwordx4 v63, s[24:27], s17 offen lds
    v_add_u32 v68, 0, v66
    v_add_u32 v69, 0, v67
    ds_read_b64_tr_b16 v[168:169], v68 offset:0
    ds_read_b64_tr_b16 v[170:171], v68 offset:1024
    ds_read_b64_tr_b16 v[172:173], v68 offset:8192
    ds_read_b64_tr_b16 v[174:175], v68 offset:9216
    ds_read_b64_tr_b16 a[192:193], v69 offset:0
    ds_read_b64_tr_b16 a[194:195], v69 offset:1024
    ds_read_b64_tr_b16 a[196:197], v69 offset:8192
    ds_read_b64_tr_b16 a[198:199], v69 offset:9216
    s_waitcnt lgkmcnt(0)
    s_waitcnt vmcnt(32)
    s_barrier
    s_add_u32 m0, s58, 0
    s_add_u32 s17, s57, 655360
    buffer_load_dwordx4 v62, s[28:31], s17 offen lds
    s_add_u32 m0, s58, 1024
    s_add_u32 s17, s57, 688128
    buffer_load_dwordx4 v62, s[28:31], s17 offen lds
    s_add_u32 m0, s58, 2048
    s_add_u32 s17, s57, 720896
    buffer_load_dwordx4 v63, s[28:31], s17 offen lds
    s_add_u32 m0, s58, 3072
    s_add_u32 s17, s57, 753664
    buffer_load_dwordx4 v63, s[28:31], s17 offen lds
    v_add_u32 v68, 16384, v66
    v_add_u32 v69, 16384, v67
    ds_read_b64_tr_b16 v[176:177], v68 offset:0
    ds_read_b64_tr_b16 v[178:179], v68 offset:1024
    ds_read_b64_tr_b16 v[180:181], v68 offset:8192
    ds_read_b64_tr_b16 v[182:183], v68 offset:9216
    ds_read_b64_tr_b16 v[184:185], v69 offset:0
    ds_read_b64_tr_b16 v[186:187], v69 offset:1024
    ds_read_b64_tr_b16 v[188:189], v69 offset:8192
    ds_read_b64_tr_b16 v[190:191], v69 offset:9216
    s_waitcnt lgkmcnt(0)
    s_waitcnt vmcnt(32)
    s_barrier
    s_add_u32 m0, s58, 16384
    s_add_u32 s17, s57, 786432
    buffer_load_dwordx4 v62, s[20:23], s17 offen lds
    s_add_u32 m0, s58, 17408
    s_add_u32 s17, s57, 819200
    buffer_load_dwordx4 v62, s[20:23], s17 offen lds
    s_add_u32 m0, s58, 18432
    s_add_u32 s17, s57, 851968
    buffer_load_dwordx4 v63, s[20:23], s17 offen lds
    s_add_u32 m0, s58, 19456
    s_add_u32 s17, s57, 884736
    buffer_load_dwordx4 v63, s[20:23], s17 offen lds
    v_add_u32 v68, 32768, v66
    v_add_u32 v69, 32768, v67
    ds_read_b64_tr_b16 v[192:193], v68 offset:0
    ds_read_b64_tr_b16 v[194:195], v68 offset:1024
    ds_read_b64_tr_b16 v[196:197], v68 offset:8192
    ds_read_b64_tr_b16 v[198:199], v68 offset:9216
    ds_read_b64_tr_b16 v[200:201], v69 offset:0
    ds_read_b64_tr_b16 v[202:203], v69 offset:1024
    ds_read_b64_tr_b16 v[204:205], v69 offset:8192
    ds_read_b64_tr_b16 v[206:207], v69 offset:9216
    s_waitcnt lgkmcnt(0)
    s_waitcnt vmcnt(32)
    s_barrier
    s_add_u32 m0, s58, 32768
    s_add_u32 s17, s57, 786432
    buffer_load_dwordx4 v62, s[24:27], s17 offen lds
    s_add_u32 m0, s58, 33792
    s_add_u32 s17, s57, 819200
    buffer_load_dwordx4 v62, s[24:27], s17 offen lds
    s_add_u32 m0, s58, 34816
    s_add_u32 s17, s57, 851968
    buffer_load_dwordx4 v63, s[24:27], s17 offen lds
    s_add_u32 m0, s58, 35840
    s_add_u32 s17, s57, 884736
    buffer_load_dwordx4 v63, s[24:27], s17 offen lds
    v_add_u32 v68, 49152, v66
    v_add_u32 v69, 49152, v67
    ds_read_b64_tr_b16 v[208:209], v68 offset:0
    ds_read_b64_tr_b16 v[210:211], v68 offset:1024
    ds_read_b64_tr_b16 v[212:213], v68 offset:8192
    ds_read_b64_tr_b16 v[214:215], v68 offset:9216
    ds_read_b64_tr_b16 a[200:201], v69 offset:0
    ds_read_b64_tr_b16 a[202:203], v69 offset:1024
    ds_read_b64_tr_b16 a[204:205], v69 offset:8192
    ds_read_b64_tr_b16 a[206:207], v69 offset:9216
    s_waitcnt lgkmcnt(0)
    s_waitcnt vmcnt(32)
    s_barrier
    s_add_u32 m0, s58, 49152
    s_add_u32 s17, s57, 786432
    buffer_load_dwordx4 v62, s[28:31], s17 offen lds
    s_add_u32 m0, s58, 50176
    s_add_u32 s17, s57, 819200
    buffer_load_dwordx4 v62, s[28:31], s17 offen lds
    s_add_u32 m0, s58, 51200
    s_add_u32 s17, s57, 851968
    buffer_load_dwordx4 v63, s[28:31], s17 offen lds
    s_add_u32 m0, s58, 52224
    s_add_u32 s17, s57, 884736
    buffer_load_dwordx4 v63, s[28:31], s17 offen lds
    v_add_u32 v68, 65536, v66
    v_add_u32 v69, 65536, v67
    ds_read_b64_tr_b16 v[216:217], v68 offset:0
    ds_read_b64_tr_b16 v[218:219], v68 offset:1024
    ds_read_b64_tr_b16 v[220:221], v68 offset:8192
    ds_read_b64_tr_b16 v[222:223], v68 offset:9216
    ds_read_b64_tr_b16 v[224:225], v69 offset:0
    ds_read_b64_tr_b16 v[226:227], v69 offset:1024
    ds_read_b64_tr_b16 v[228:229], v69 offset:8192
    ds_read_b64_tr_b16 v[230:231], v69 offset:9216
    s_waitcnt lgkmcnt(0)
    s_waitcnt vmcnt(32)
    s_barrier
    s_add_u32 m0, s58, 65536
    s_add_u32 s17, s57, 917504
    buffer_load_dwordx4 v62, s[20:23], s17 offen lds
    s_add_u32 m0, s58, 66560
    s_add_u32 s17, s57, 950272
    buffer_load_dwordx4 v62, s[20:23], s17 offen lds
    s_add_u32 m0, s58, 67584
    s_add_u32 s17, s57, 983040
    buffer_load_dwordx4 v63, s[20:23], s17 offen lds
    s_add_u32 m0, s58, 68608
    s_add_u32 s17, s57, 1015808
    buffer_load_dwordx4 v63, s[20:23], s17 offen lds
    v_add_u32 v68, 81920, v66
    v_add_u32 v69, 81920, v67
    ds_read_b64_tr_b16 v[232:233], v68 offset:0
    ds_read_b64_tr_b16 v[234:235], v68 offset:1024
    ds_read_b64_tr_b16 v[236:237], v68 offset:8192
    ds_read_b64_tr_b16 v[238:239], v68 offset:9216
    ds_read_b64_tr_b16 v[240:241], v69 offset:0
    ds_read_b64_tr_b16 v[242:243], v69 offset:1024
    ds_read_b64_tr_b16 v[244:245], v69 offset:8192
    ds_read_b64_tr_b16 v[246:247], v69 offset:9216
    s_waitcnt lgkmcnt(0)
    s_waitcnt vmcnt(32)
    s_barrier
    s_add_u32 m0, s58, 81920
    s_add_u32 s17, s57, 917504
    buffer_load_dwordx4 v62, s[24:27], s17 offen lds
    s_add_u32 m0, s58, 82944
    s_add_u32 s17, s57, 950272
    buffer_load_dwordx4 v62, s[24:27], s17 offen lds
    s_add_u32 m0, s58, 83968
    s_add_u32 s17, s57, 983040
    buffer_load_dwordx4 v63, s[24:27], s17 offen lds
    s_add_u32 m0, s58, 84992
    s_add_u32 s17, s57, 1015808
    buffer_load_dwordx4 v63, s[24:27], s17 offen lds
    v_add_u32 v68, 98304, v66
    v_add_u32 v69, 98304, v67
    ds_read_b64_tr_b16 v[248:249], v68 offset:0
    ds_read_b64_tr_b16 v[250:251], v68 offset:1024
    ds_read_b64_tr_b16 v[252:253], v68 offset:8192
    ds_read_b64_tr_b16 v[254:255], v68 offset:9216
    ds_read_b64_tr_b16 a[208:209], v69 offset:0
    ds_read_b64_tr_b16 a[210:211], v69 offset:1024
    ds_read_b64_tr_b16 a[212:213], v69 offset:8192
    ds_read_b64_tr_b16 a[214:215], v69 offset:9216
    s_waitcnt lgkmcnt(0)
    s_waitcnt vmcnt(32)
    s_barrier
    s_add_u32 m0, s58, 98304
    s_add_u32 s17, s57, 917504
    buffer_load_dwordx4 v62, s[28:31], s17 offen lds
    s_add_u32 m0, s58, 99328
    s_add_u32 s17, s57, 950272
    buffer_load_dwordx4 v62, s[28:31], s17 offen lds
    s_add_u32 m0, s58, 100352
    s_add_u32 s17, s57, 983040
    buffer_load_dwordx4 v63, s[28:31], s17 offen lds
    s_add_u32 m0, s58, 101376
    s_add_u32 s17, s57, 1015808
    buffer_load_dwordx4 v63, s[28:31], s17 offen lds
    v_add_u32 v68, 114688, v66
    v_add_u32 v69, 114688, v67
    ds_read_b64_tr_b16 a[0:1], v68 offset:0
    ds_read_b64_tr_b16 a[2:3], v68 offset:1024
    ds_read_b64_tr_b16 a[4:5], v68 offset:8192
    ds_read_b64_tr_b16 a[6:7], v68 offset:9216
    ds_read_b64_tr_b16 a[8:9], v69 offset:0
    ds_read_b64_tr_b16 a[10:11], v69 offset:1024
    ds_read_b64_tr_b16 a[12:13], v69 offset:8192
    ds_read_b64_tr_b16 a[14:15], v69 offset:9216
    s_waitcnt lgkmcnt(0)
    s_waitcnt vmcnt(32)
    s_barrier
    s_add_u32 m0, s58, 114688
    s_add_u32 s17, s57, 1048576
    buffer_load_dwordx4 v64, s[20:23], s17 offen lds
    s_add_u32 m0, s58, 115712
    s_add_u32 s17, s57, 1056768
    buffer_load_dwordx4 v64, s[20:23], s17 offen lds
    s_add_u32 m0, s58, 116736
    s_add_u32 s17, s57, 1064960
    buffer_load_dwordx4 v65, s[20:23], s17 offen lds
    s_add_u32 m0, s58, 117760
    s_add_u32 s17, s57, 1073152
    buffer_load_dwordx4 v65, s[20:23], s17 offen lds
    v_add_u32 v68, 131072, v66
    v_add_u32 v69, 131072, v67
    ds_read_b64_tr_b16 a[16:17], v68 offset:0
    ds_read_b64_tr_b16 a[18:19], v68 offset:1024
    ds_read_b64_tr_b16 a[20:21], v68 offset:8192
    ds_read_b64_tr_b16 a[22:23], v68 offset:9216
    ds_read_b64_tr_b16 a[24:25], v69 offset:0
    ds_read_b64_tr_b16 a[26:27], v69 offset:1024
    ds_read_b64_tr_b16 a[28:29], v69 offset:8192
    ds_read_b64_tr_b16 a[30:31], v69 offset:9216
    s_waitcnt lgkmcnt(0)
    s_waitcnt vmcnt(32)
    s_barrier
    s_add_u32 m0, s58, 131072
    s_add_u32 s17, s57, 1048576
    buffer_load_dwordx4 v64, s[24:27], s17 offen lds
    s_add_u32 m0, s58, 132096
    s_add_u32 s17, s57, 1056768
    buffer_load_dwordx4 v64, s[24:27], s17 offen lds
    s_add_u32 m0, s58, 133120
    s_add_u32 s17, s57, 1064960
    buffer_load_dwordx4 v65, s[24:27], s17 offen lds
    s_add_u32 m0, s58, 134144
    s_add_u32 s17, s57, 1073152
    buffer_load_dwordx4 v65, s[24:27], s17 offen lds
    v_add_u32 v68, 147456, v66
    v_add_u32 v69, 147456, v67
    ds_read_b64_tr_b16 a[32:33], v68 offset:0
    ds_read_b64_tr_b16 a[34:35], v68 offset:1024
    ds_read_b64_tr_b16 a[36:37], v68 offset:8192
    ds_read_b64_tr_b16 a[38:39], v68 offset:9216
    ds_read_b64_tr_b16 a[216:217], v69 offset:0
    ds_read_b64_tr_b16 a[218:219], v69 offset:1024
    ds_read_b64_tr_b16 a[220:221], v69 offset:8192
    ds_read_b64_tr_b16 a[222:223], v69 offset:9216
    s_waitcnt lgkmcnt(0)
    s_waitcnt vmcnt(32)
    s_barrier
    s_add_u32 m0, s58, 147456
    s_add_u32 s17, s57, 1048576
    buffer_load_dwordx4 v64, s[28:31], s17 offen lds
    s_add_u32 m0, s58, 148480
    s_add_u32 s17, s57, 1056768
    buffer_load_dwordx4 v64, s[28:31], s17 offen lds
    s_add_u32 m0, s58, 149504
    s_add_u32 s17, s57, 1064960
    buffer_load_dwordx4 v65, s[28:31], s17 offen lds
    s_add_u32 m0, s58, 150528
    s_add_u32 s17, s57, 1073152
    buffer_load_dwordx4 v65, s[28:31], s17 offen lds
    v_add_u32 v68, 0, v66
    v_add_u32 v69, 0, v67
    ds_read_b64_tr_b16 a[40:41], v68 offset:0
    ds_read_b64_tr_b16 a[42:43], v68 offset:1024
    ds_read_b64_tr_b16 a[44:45], v68 offset:8192
    ds_read_b64_tr_b16 a[46:47], v68 offset:9216
    ds_read_b64_tr_b16 a[48:49], v69 offset:0
    ds_read_b64_tr_b16 a[50:51], v69 offset:1024
    ds_read_b64_tr_b16 a[52:53], v69 offset:8192
    ds_read_b64_tr_b16 a[54:55], v69 offset:9216
    s_waitcnt lgkmcnt(0)
    s_waitcnt vmcnt(32)
    s_barrier
    v_add_u32 v68, 16384, v66
    v_add_u32 v69, 16384, v67
    ds_read_b64_tr_b16 a[56:57], v68 offset:0
    ds_read_b64_tr_b16 a[58:59], v68 offset:1024
    ds_read_b64_tr_b16 a[60:61], v68 offset:8192
    ds_read_b64_tr_b16 a[62:63], v68 offset:9216
    ds_read_b64_tr_b16 a[64:65], v69 offset:0
    ds_read_b64_tr_b16 a[66:67], v69 offset:1024
    ds_read_b64_tr_b16 a[68:69], v69 offset:8192
    ds_read_b64_tr_b16 a[70:71], v69 offset:9216
    s_waitcnt lgkmcnt(0)
    s_waitcnt vmcnt(28)
    s_barrier
    v_add_u32 v68, 32768, v66
    v_add_u32 v69, 32768, v67
    ds_read_b64_tr_b16 a[72:73], v68 offset:0
    ds_read_b64_tr_b16 a[74:75], v68 offset:1024
    ds_read_b64_tr_b16 a[76:77], v68 offset:8192
    ds_read_b64_tr_b16 a[78:79], v68 offset:9216
    ds_read_b64_tr_b16 a[224:225], v69 offset:0
    ds_read_b64_tr_b16 a[226:227], v69 offset:1024
    ds_read_b64_tr_b16 a[228:229], v69 offset:8192
    ds_read_b64_tr_b16 a[230:231], v69 offset:9216
    s_waitcnt lgkmcnt(0)
    s_waitcnt vmcnt(24)
    s_barrier
    v_add_u32 v68, 49152, v66
    v_add_u32 v69, 49152, v67
    ds_read_b64_tr_b16 a[80:81], v68 offset:0
    ds_read_b64_tr_b16 a[82:83], v68 offset:1024
    ds_read_b64_tr_b16 a[84:85], v68 offset:8192
    ds_read_b64_tr_b16 a[86:87], v68 offset:9216
    ds_read_b64_tr_b16 a[88:89], v69 offset:0
    ds_read_b64_tr_b16 a[90:91], v69 offset:1024
    ds_read_b64_tr_b16 a[92:93], v69 offset:8192
    ds_read_b64_tr_b16 a[94:95], v69 offset:9216
    s_waitcnt lgkmcnt(0)
    s_waitcnt vmcnt(20)
    s_barrier
    s_add_u32 s17, s59, 0
    s_add_u32 m0, s60, 0
    s_nop 0
    buffer_load_dwordx4 v50, s[80:83], s17 offen lds
    s_add_u32 m0, s60, 1024
    s_nop 0
    buffer_load_dwordx4 v51, s[80:83], s17 offen lds
    s_add_u32 m0, s60, 2048
    s_nop 0
    buffer_load_dwordx4 v52, s[80:83], s17 offen lds
    s_add_u32 m0, s60, 3072
    s_nop 0
    buffer_load_dwordx4 v53, s[80:83], s17 offen lds
    s_add_u32 m0, s60, 4096
    s_mov_b64 exec, s[52:53]
    buffer_load_dwordx4 v54, s[80:83], s17 offen lds
    s_mov_b64 exec, -1
    v_add_u32 v68, 65536, v66
    v_add_u32 v69, 65536, v67
    ds_read_b64_tr_b16 a[96:97], v68 offset:0
    ds_read_b64_tr_b16 a[98:99], v68 offset:1024
    ds_read_b64_tr_b16 a[100:101], v68 offset:8192
    ds_read_b64_tr_b16 a[102:103], v68 offset:9216
    ds_read_b64_tr_b16 a[104:105], v69 offset:0
    ds_read_b64_tr_b16 a[106:107], v69 offset:1024
    ds_read_b64_tr_b16 a[108:109], v69 offset:8192
    ds_read_b64_tr_b16 a[110:111], v69 offset:9216
    s_waitcnt lgkmcnt(0)
    s_waitcnt vmcnt(21)
    s_barrier
    s_add_u32 s17, s59, 1152
    s_add_u32 m0, s60, 18432
    s_nop 0
    buffer_load_dwordx4 v50, s[80:83], s17 offen lds
    s_add_u32 m0, s60, 19456
    s_nop 0
    buffer_load_dwordx4 v51, s[80:83], s17 offen lds
    s_add_u32 m0, s60, 20480
    s_nop 0
    buffer_load_dwordx4 v52, s[80:83], s17 offen lds
    s_add_u32 m0, s60, 21504
    s_nop 0
    buffer_load_dwordx4 v53, s[80:83], s17 offen lds
    s_add_u32 m0, s60, 22528
    s_mov_b64 exec, s[52:53]
    buffer_load_dwordx4 v54, s[80:83], s17 offen lds
    s_mov_b64 exec, -1
    v_add_u32 v68, 81920, v66
    v_add_u32 v69, 81920, v67
    ds_read_b64_tr_b16 a[112:113], v68 offset:0
    ds_read_b64_tr_b16 a[114:115], v68 offset:1024
    ds_read_b64_tr_b16 a[116:117], v68 offset:8192
    ds_read_b64_tr_b16 a[118:119], v68 offset:9216
    ds_read_b64_tr_b16 a[232:233], v69 offset:0
    ds_read_b64_tr_b16 a[234:235], v69 offset:1024
    ds_read_b64_tr_b16 a[236:237], v69 offset:8192
    ds_read_b64_tr_b16 a[238:239], v69 offset:9216
    s_waitcnt lgkmcnt(0)
    s_waitcnt vmcnt(22)
    s_barrier
    s_add_u32 s17, s59, 36864
    s_add_u32 m0, s60, 36864
    s_nop 0
    buffer_load_dwordx4 v50, s[80:83], s17 offen lds
    s_add_u32 m0, s60, 37888
    s_nop 0
    buffer_load_dwordx4 v51, s[80:83], s17 offen lds
    s_add_u32 m0, s60, 38912
    s_nop 0
    buffer_load_dwordx4 v52, s[80:83], s17 offen lds
    s_add_u32 m0, s60, 39936
    s_nop 0
    buffer_load_dwordx4 v53, s[80:83], s17 offen lds
    s_add_u32 m0, s60, 40960
    s_mov_b64 exec, s[52:53]
    buffer_load_dwordx4 v54, s[80:83], s17 offen lds
    s_mov_b64 exec, -1
    v_add_u32 v68, 98304, v66
    v_add_u32 v69, 98304, v67
    ds_read_b64_tr_b16 a[120:121], v68 offset:0
    ds_read_b64_tr_b16 a[122:123], v68 offset:1024
    ds_read_b64_tr_b16 a[124:125], v68 offset:8192
    ds_read_b64_tr_b16 a[126:127], v68 offset:9216
    ds_read_b64_tr_b16 a[128:129], v69 offset:0
    ds_read_b64_tr_b16 a[130:131], v69 offset:1024
    ds_read_b64_tr_b16 a[132:133], v69 offset:8192
    ds_read_b64_tr_b16 a[134:135], v69 offset:9216
    s_waitcnt lgkmcnt(0)
    s_waitcnt vmcnt(23)
    s_barrier
    v_add_u32 v68, 114688, v66
    v_add_u32 v69, 114688, v67
    ds_read_b64_tr_b16 a[136:137], v68 offset:0
    ds_read_b64_tr_b16 a[138:139], v68 offset:1024
    ds_read_b64_tr_b16 a[140:141], v68 offset:8192
    ds_read_b64_tr_b16 a[142:143], v68 offset:9216
    ds_read_b64_tr_b16 a[144:145], v69 offset:0
    ds_read_b64_tr_b16 a[146:147], v69 offset:1024
    ds_read_b64_tr_b16 a[148:149], v69 offset:8192
    ds_read_b64_tr_b16 a[150:151], v69 offset:9216
    s_waitcnt lgkmcnt(0)
    s_waitcnt vmcnt(19)
    s_barrier
    v_add_u32 v68, 131072, v66
    v_add_u32 v69, 131072, v67
    ds_read_b64_tr_b16 a[152:153], v68 offset:0
    ds_read_b64_tr_b16 a[154:155], v68 offset:1024
    ds_read_b64_tr_b16 a[156:157], v68 offset:8192
    ds_read_b64_tr_b16 a[158:159], v68 offset:9216
    ds_read_b64_tr_b16 a[240:241], v69 offset:0
    ds_read_b64_tr_b16 a[242:243], v69 offset:1024
    ds_read_b64_tr_b16 a[244:245], v69 offset:8192
    ds_read_b64_tr_b16 a[246:247], v69 offset:9216
    s_waitcnt lgkmcnt(0)
    s_waitcnt vmcnt(15)
    s_barrier
    v_add_u32 v68, 147456, v66
    v_add_u32 v69, 147456, v67
    ds_read_b64_tr_b16 a[160:161], v68 offset:0
    ds_read_b64_tr_b16 a[162:163], v68 offset:1024
    ds_read_b64_tr_b16 a[164:165], v68 offset:8192
    ds_read_b64_tr_b16 a[166:167], v68 offset:9216
    ds_read_b64_tr_b16 a[168:169], v69 offset:0
    ds_read_b64_tr_b16 a[170:171], v69 offset:1024
    ds_read_b64_tr_b16 a[172:173], v69 offset:8192
    ds_read_b64_tr_b16 a[174:175], v69 offset:9216
    s_waitcnt lgkmcnt(0)
    s_barrier
    ds_write_b128 v9, a[176:179] offset:0
    ds_write_b128 v9, a[180:183] offset:1024
    ds_write_b128 v9, a[184:187] offset:2048
    ds_write_b128 v9, a[188:191] offset:3072
    ds_write_b128 v9, a[192:195] offset:4096
    ds_write_b128 v9, a[196:199] offset:5120
    ds_write_b128 v9, a[200:203] offset:6144
    ds_write_b128 v9, a[204:207] offset:7168
    ds_write_b128 v9, a[208:211] offset:8192
    ds_write_b128 v9, a[212:215] offset:9216
    ds_write_b128 v9, a[216:219] offset:10240
    ds_write_b128 v9, a[220:223] offset:11264
    ds_write_b128 v9, a[224:227] offset:12288
    ds_write_b128 v9, a[228:231] offset:13312
    ds_write_b128 v9, a[232:235] offset:14336
    ds_write_b128 v9, a[236:239] offset:15360
    ds_write_b128 v9, a[240:243] offset:16384
    ds_write_b128 v9, a[244:247] offset:17408
    s_waitcnt lgkmcnt(0)
    s_waitcnt vmcnt(10)
    s_barrier
    ds_read_b64_tr_b16 a[176:177], v70 offset:0
    ds_read_b64_tr_b16 a[192:193], v70 offset:32
    ds_read_b64_tr_b16 v[12:13], v70 offset:64
    ds_read_b64_tr_b16 a[208:209], v70 offset:96
    ds_read_b64_tr_b16 v[20:21], v70 offset:128
    ds_read_b64_tr_b16 a[224:225], v70 offset:160
    ds_read_b64_tr_b16 a[240:241], v70 offset:192
    ds_read_b64_tr_b16 v[28:29], v70 offset:224
    ds_read_b64_tr_b16 v[36:37], v70 offset:256
    s_waitcnt lgkmcnt(0)
    s_waitcnt vmcnt(5)
    s_barrier
    s_add_u32 s17, s59, 38016
    s_add_u32 m0, s60, 0
    s_nop 0
    buffer_load_dwordx4 v50, s[80:83], s17 offen lds
    s_add_u32 m0, s60, 1024
    s_nop 0
    buffer_load_dwordx4 v51, s[80:83], s17 offen lds
    s_add_u32 m0, s60, 2048
    s_nop 0
    buffer_load_dwordx4 v52, s[80:83], s17 offen lds
    s_add_u32 m0, s60, 3072
    s_nop 0
    buffer_load_dwordx4 v53, s[80:83], s17 offen lds
    s_add_u32 m0, s60, 4096
    s_mov_b64 exec, s[52:53]
    buffer_load_dwordx4 v54, s[80:83], s17 offen lds
    s_mov_b64 exec, -1
    ds_read_b64_tr_b16 a[178:179], v70 offset:18432
    ds_read_b64_tr_b16 a[194:195], v70 offset:18464
    ds_read_b64_tr_b16 v[14:15], v70 offset:18496
    ds_read_b64_tr_b16 a[210:211], v70 offset:18528
    ds_read_b64_tr_b16 v[22:23], v70 offset:18560
    ds_read_b64_tr_b16 a[226:227], v70 offset:18592
    ds_read_b64_tr_b16 a[242:243], v70 offset:18624
    ds_read_b64_tr_b16 v[30:31], v70 offset:18656
    ds_read_b64_tr_b16 v[38:39], v70 offset:18688
    s_waitcnt lgkmcnt(0)
    s_waitcnt vmcnt(5)
    s_barrier
    s_add_u32 s17, s59, 73728
    s_add_u32 m0, s60, 18432
    s_nop 0
    buffer_load_dwordx4 v50, s[80:83], s17 offen lds
    s_add_u32 m0, s60, 19456
    s_nop 0
    buffer_load_dwordx4 v51, s[80:83], s17 offen lds
    s_add_u32 m0, s60, 20480
    s_nop 0
    buffer_load_dwordx4 v52, s[80:83], s17 offen lds
    s_add_u32 m0, s60, 21504
    s_nop 0
    buffer_load_dwordx4 v53, s[80:83], s17 offen lds
    s_add_u32 m0, s60, 22528
    s_mov_b64 exec, s[52:53]
    buffer_load_dwordx4 v54, s[80:83], s17 offen lds
    s_mov_b64 exec, -1
    ds_read_b64_tr_b16 a[180:181], v70 offset:36864
    ds_read_b64_tr_b16 a[196:197], v70 offset:36896
    ds_read_b64_tr_b16 v[16:17], v70 offset:36928
    ds_read_b64_tr_b16 a[212:213], v70 offset:36960
    ds_read_b64_tr_b16 v[24:25], v70 offset:36992
    ds_read_b64_tr_b16 a[228:229], v70 offset:37024
    ds_read_b64_tr_b16 a[244:245], v70 offset:37056
    ds_read_b64_tr_b16 v[32:33], v70 offset:37088
    ds_read_b64_tr_b16 v[40:41], v70 offset:37120
    s_waitcnt lgkmcnt(0)
    s_waitcnt vmcnt(5)
    s_barrier
    s_add_u32 s17, s59, 74880
    s_add_u32 m0, s60, 36864
    s_nop 0
    buffer_load_dwordx4 v50, s[80:83], s17 offen lds
    s_add_u32 m0, s60, 37888
    s_nop 0
    buffer_load_dwordx4 v51, s[80:83], s17 offen lds
    s_add_u32 m0, s60, 38912
    s_nop 0
    buffer_load_dwordx4 v52, s[80:83], s17 offen lds
    s_add_u32 m0, s60, 39936
    s_nop 0
    buffer_load_dwordx4 v53, s[80:83], s17 offen lds
    s_add_u32 m0, s60, 40960
    s_mov_b64 exec, s[52:53]
    buffer_load_dwordx4 v54, s[80:83], s17 offen lds
    s_mov_b64 exec, -1
    ds_read_b64_tr_b16 a[182:183], v70 offset:0
    ds_read_b64_tr_b16 a[198:199], v70 offset:32
    ds_read_b64_tr_b16 v[18:19], v70 offset:64
    ds_read_b64_tr_b16 a[214:215], v70 offset:96
    ds_read_b64_tr_b16 v[26:27], v70 offset:128
    ds_read_b64_tr_b16 a[230:231], v70 offset:160
    ds_read_b64_tr_b16 a[246:247], v70 offset:192
    ds_read_b64_tr_b16 v[34:35], v70 offset:224
    ds_read_b64_tr_b16 v[42:43], v70 offset:256
    s_waitcnt lgkmcnt(0)
    ds_write_b128 v9, v[12:15] offset:18432
    ds_write_b128 v9, v[16:19] offset:19456
    ds_write_b128 v9, v[20:23] offset:20480
    ds_write_b128 v9, v[24:27] offset:21504
    ds_write_b128 v9, v[28:31] offset:22528
    ds_write_b128 v9, v[32:35] offset:23552
    ds_write_b128 v9, v[36:39] offset:24576
    ds_write_b128 v9, v[40:43] offset:25600
    s_waitcnt lgkmcnt(0)
    s_waitcnt vmcnt(5)
    s_barrier
    s_add_u32 s17, s59, 110592
    s_add_u32 m0, s60, 0
    s_nop 0
    buffer_load_dwordx4 v50, s[80:83], s17 offen lds
    s_add_u32 m0, s60, 1024
    s_nop 0
    buffer_load_dwordx4 v51, s[80:83], s17 offen lds
    s_add_u32 m0, s60, 2048
    s_nop 0
    buffer_load_dwordx4 v52, s[80:83], s17 offen lds
    s_add_u32 m0, s60, 3072
    s_nop 0
    buffer_load_dwordx4 v53, s[80:83], s17 offen lds
    s_add_u32 m0, s60, 4096
    s_mov_b64 exec, s[52:53]
    buffer_load_dwordx4 v54, s[80:83], s17 offen lds
    s_mov_b64 exec, -1
    ds_read_b64_tr_b16 a[184:185], v70 offset:18432
    ds_read_b64_tr_b16 v[12:13], v70 offset:18464
    ds_read_b64_tr_b16 a[200:201], v70 offset:18496
    ds_read_b64_tr_b16 a[216:217], v70 offset:18528
    ds_read_b64_tr_b16 v[20:21], v70 offset:18560
    ds_read_b64_tr_b16 a[232:233], v70 offset:18592
    ds_read_b64_tr_b16 v[28:29], v70 offset:18624
    ds_read_b64_tr_b16 a[248:249], v70 offset:18656
    ds_read_b64_tr_b16 v[36:37], v70 offset:18688
    s_waitcnt lgkmcnt(0)
    s_waitcnt vmcnt(5)
    s_barrier
    s_add_u32 s17, s59, 111744
    s_add_u32 m0, s60, 18432
    s_nop 0
    buffer_load_dwordx4 v50, s[80:83], s17 offen lds
    s_add_u32 m0, s60, 19456
    s_nop 0
    buffer_load_dwordx4 v51, s[80:83], s17 offen lds
    s_add_u32 m0, s60, 20480
    s_nop 0
    buffer_load_dwordx4 v52, s[80:83], s17 offen lds
    s_add_u32 m0, s60, 21504
    s_nop 0
    buffer_load_dwordx4 v53, s[80:83], s17 offen lds
    s_add_u32 m0, s60, 22528
    s_mov_b64 exec, s[52:53]
    buffer_load_dwordx4 v54, s[80:83], s17 offen lds
    s_mov_b64 exec, -1
    ds_read_b64_tr_b16 a[186:187], v70 offset:36864
    ds_read_b64_tr_b16 v[14:15], v70 offset:36896
    ds_read_b64_tr_b16 a[202:203], v70 offset:36928
    ds_read_b64_tr_b16 a[218:219], v70 offset:36960
    ds_read_b64_tr_b16 v[22:23], v70 offset:36992
    ds_read_b64_tr_b16 a[234:235], v70 offset:37024
    ds_read_b64_tr_b16 v[30:31], v70 offset:37056
    ds_read_b64_tr_b16 a[250:251], v70 offset:37088
    ds_read_b64_tr_b16 v[38:39], v70 offset:37120
    s_waitcnt lgkmcnt(0)
    s_waitcnt vmcnt(5)
    s_barrier
    ds_read_b64_tr_b16 a[188:189], v70 offset:0
    ds_read_b64_tr_b16 v[16:17], v70 offset:32
    ds_read_b64_tr_b16 a[204:205], v70 offset:64
    ds_read_b64_tr_b16 a[220:221], v70 offset:96
    ds_read_b64_tr_b16 v[24:25], v70 offset:128
    ds_read_b64_tr_b16 a[236:237], v70 offset:160
    ds_read_b64_tr_b16 v[32:33], v70 offset:192
    ds_read_b64_tr_b16 a[252:253], v70 offset:224
    ds_read_b64_tr_b16 v[40:41], v70 offset:256
    s_waitcnt lgkmcnt(0)
    s_waitcnt vmcnt(0)
    s_barrier
    ds_read_b64_tr_b16 a[190:191], v70 offset:18432
    ds_read_b64_tr_b16 v[18:19], v70 offset:18464
    ds_read_b64_tr_b16 a[206:207], v70 offset:18496
    ds_read_b64_tr_b16 a[222:223], v70 offset:18528
    ds_read_b64_tr_b16 v[26:27], v70 offset:18560
    ds_read_b64_tr_b16 a[238:239], v70 offset:18592
    ds_read_b64_tr_b16 v[34:35], v70 offset:18624
    ds_read_b64_tr_b16 a[254:255], v70 offset:18656
    ds_read_b64_tr_b16 v[42:43], v70 offset:18688
    s_waitcnt lgkmcnt(0)
    s_barrier
    s_lshl_b32 s17, s14, 13
    v_add_u32 v71, s17, v0
    ds_write_b128 v71, v[12:15] offset:24576
    ds_write_b128 v71, v[16:19] offset:25600
    ds_write_b128 v71, v[20:23] offset:26624
    ds_write_b128 v71, v[24:27] offset:27648
    ds_write_b128 v71, v[28:31] offset:28672
    ds_write_b128 v71, v[32:35] offset:29696
    ds_write_b128 v71, v[36:39] offset:30720
    ds_write_b128 v71, v[40:43] offset:31744
    s_waitcnt vmcnt(0) lgkmcnt(0)
    s_barrier
    s_add_u32 s17, s32, s14
    s_cmp_lg_u32 s17, 0
    s_cbranch_scc1 Lr_nold
    v_mov_b32 v63, 48
    v_mov_b32 v64, 1
    s_mov_b64 exec, 1
    global_atomic_add v63, v64, s[12:13]
    s_mov_b64 exec, -1
Lr_nold:
    s_add_u32 s57, s48, 0
    s_add_u32 s58, s48, 98304
    s_add_u32 s59, s48, 196608
    s_add_u32 s60, s48, 294912
    s_mov_b64 exec, 0xff
    v_lshlrev_b32 v12, 5, v8
    v_and_b32 v12, 128, v12
    v_lshrrev_b32 v13, 1, v8
    v_and_or_b32 v12, v13, 12, v12
    s_mov_b32 s16, 0
L_pure:
    global_load_dword v13, v12, s[12:13] sc1
    s_add_u32 s16, s16, 1
    s_cmp_gt_u32 s16, 100000
    s_cbranch_scc1 Lr_abort
    s_mov_b32 s6, 0
    s_waitcnt vmcnt(0)
    v_readlane_b32 s7, v13, 0
    s_nop 0
    s_add_u32 s6, s6, s7
    v_readlane_b32 s7, v13, 1
    s_nop 0
    s_add_u32 s6, s6, s7
    v_readlane_b32 s7, v13, 2
    s_nop 0
    s_add_u32 s6, s6, s7
    v_readlane_b32 s7, v13, 3
    s_nop 0
    s_add_u32 s6, s6, s7
    v_readlane_b32 s7, v13, 4
    s_nop 0
    s_add_u32 s6, s6, s7
    v_readlane_b32 s7, v13, 5
    s_nop 0
    s_add_u32 s6, s6, s7
    v_readlane_b32 s7, v13, 6
    s_nop 0
    s_add_u32 s6, s6, s7
    v_readlane_b32 s7, v13, 7
    s_nop 0
    s_add_u32 s6, s6, s7
    v_readlane_b32 s7, v13, s32
    s_nop 0
    s_cmp_ge_u32 s7, 32
    s_cselect_b32 s55, 1, 0
    s_cselect_b32 s6, 256, s6
    s_cmp_lt_u32 s6, 256
    s_cbranch_scc1 L_pure
    s_mov_b64 exec, -1
    s_lshl_b32 s6, s32, 2
    s_add_u32 s6, s6, 192
    s_cmp_lg_u32 s14, 0
    s_cbranch_scc1 L_team_d
    v_mov_b32 v12, s6
    s_mov_b32 s16, 0
L_team:
    global_load_dword v13, v12, s[12:13] sc1
    s_add_u32 s16, s16, 1
    s_cmp_gt_u32 s16, 100000
    s_cbranch_scc1 Lr_abort
    s_waitcnt vmcnt(0)
    v_cmp_gt_u32 vcc, 32, v13
    s_nop 0
    s_cbranch_vccz L_team_d
    s_sleep 8
    s_branch L_team
L_team_d:
    s_barrier
    s_cmp_lg_u32 s14, 0
    s_cbranch_scc1 L_rpool_d
    v_mov_b32 v12, 160
    s_mov_b32 s16, 0
L_rpool:
    global_load_dword v13, v12, s[12:13] sc1
    s_add_u32 s16, s16, 1
    s_cmp_gt_u32 s16, 100000
    s_cbranch_scc1 Lr_abort
    s_waitcnt vmcnt(0)
    v_cmp_gt_u32 vcc, 123, v13
    s_nop 0
    s_cbranch_vccz L_rpool_d
    s_sleep 8
    s_branch L_rpool
L_rpool_d:
    s_barrier
    s_barrier
    s_cmp_eq_u32 s55, 0
    s_cbranch_scc1 L_slow
    s_cmp_lg_u32 s14, 0
    s_cbranch_scc1 L_w1_1
    s_barrier
    s_mov_b32 m0, 9216
    s_nop 0
    buffer_load_dwordx4 v0, s[8:11], s41 offen offset:0 lds
    buffer_load_dwordx4 v0, s[8:11], s41 offen offset:1024 lds
    s_add_u32 s41, s41, 262144
    s_waitcnt vmcnt(0)
    buffer_load_dwordx4 v[44:47], v0, s[8:11], s34 offen sc1
    buffer_load_dwordx4 v[48:51], v0, s[8:11], s34 offen offset:1024 sc1
    buffer_load_dword v10, v8, s[8:11], s35 offen sc1
    ds_read_b128 v[56:59], v9 offset:0
    ds_read_b128 v[60:63], v9 offset:1024
    ds_read_b128 v[64:67], v9 offset:2048
    ds_read_b128 v[68:71], v9 offset:3072
    v_mov_b64 v[12:13], 0
    v_mov_b64 v[14:15], 0
    v_mov_b64 v[16:17], 0
    v_mov_b64 v[18:19], 0
    v_mov_b64 v[20:21], 0
    v_mov_b64 v[22:23], 0
    v_mov_b64 v[24:25], 0
    v_mov_b64 v[26:27], 0
    v_mov_b64 v[28:29], 0
    v_mov_b64 v[30:31], 0
    v_mov_b64 v[32:33], 0
    v_mov_b64 v[34:35], 0
    s_waitcnt lgkmcnt(0)
Lr0f_step:
    s_mov_b32 s16, 0
    s_mov_b64 s[70:71], 0
    s_mov_b64 s[72:73], 0
    s_mov_b64 s[74:75], 0
Lr0f_p2:
    s_mov_b64 exec, s[70:71]
    buffer_load_dwordx4 v[44:47], v0, s[8:11], s34 offen sc1
    s_mov_b64 exec, s[72:73]
    buffer_load_dwordx4 v[48:51], v0, s[8:11], s34 offen offset:1024 sc1
    s_mov_b64 exec, s[74:75]
    buffer_load_dword v10, v8, s[8:11], s35 offen sc1
    s_mov_b64 exec, -1
    s_add_u32 s16, s16, 1
    s_cmp_gt_u32 s16, 100000
    s_cbranch_scc1 Lr_abort
    s_waitcnt vmcnt(5)
    v_max3_u32 v11, v44, v45, v46
    v_max_u32 v11, v11, v47
    v_cmp_eq_u32 s[70:71], -1, v11
    s_waitcnt vmcnt(4)
    v_max3_u32 v11, v48, v49, v50
    v_max_u32 v11, v11, v51
    v_cmp_eq_u32 s[72:73], -1, v11
    s_waitcnt vmcnt(3)
    v_cmp_eq_u32 s[74:75], -1, v10
    s_or_b64 vcc, s[70:71], s[72:73]
    s_or_b64 vcc, vcc, s[74:75]
    s_cbranch_scc1 Lr0f_p2
    v_smfmac_f32_16x16x64_bf16 v[12:15], v[44:47], v[72:79], v1
    ds_write_b128 v0, v[44:47] offset:0
    v_smfmac_f32_16x16x64_bf16 v[16:19], v[44:47], v[80:87], v1
    ds_write_b128 v0, v[48:51] offset:1024
    v_smfmac_f32_16x16x64_bf16 v[20:23], v[44:47], v[88:95], v1
    ds_write_b32 v8, v10 offset:8192
    v_smfmac_f32_16x16x64_bf16 v[24:27], v[44:47], v[56:63], v1
    s_waitcnt lgkmcnt(0)
    s_barrier
    ds_read_b128 v[52:55], v0 offset:2048
    v_smfmac_f32_16x16x64_bf16 v[12:15], v[48:51], v[112:119], v1
    ds_read_b128 v[36:39], v0 offset:3072
    v_smfmac_f32_16x16x64_bf16 v[16:19], v[48:51], v[120:127], v1
    ds_read_b128 v[56:59], v9 offset:4096
    v_smfmac_f32_16x16x64_bf16 v[20:23], v[48:51], v[128:135], v1
    ds_read_b128 v[60:63], v9 offset:5120
    v_smfmac_f32_16x16x64_bf16 v[24:27], v[48:51], v[64:71], v1
    ds_read_b128 v[40:43], v0 offset:4096
    s_waitcnt lgkmcnt(4)
    v_smfmac_f32_16x16x64_bf16 v[12:15], v[52:55], v[152:159], v1
    v_smfmac_f32_16x16x64_bf16 v[16:19], v[52:55], v[160:167], v1
    ds_read_b128 v[64:67], v9 offset:6144
    v_smfmac_f32_16x16x64_bf16 v[20:23], v[52:55], v[168:175], v1
    ds_read_b128 v[68:71], v9 offset:7168
    s_waitcnt lgkmcnt(3)
    v_smfmac_f32_16x16x64_bf16 v[24:27], v[52:55], v[56:63], v1
    v_smfmac_f32_16x16x64_bf16 v[12:15], v[36:39], v[192:199], v1
    ds_read_b128 v[52:55], v0 offset:5120
    v_smfmac_f32_16x16x64_bf16 v[16:19], v[36:39], v[200:207], v1
    ds_read_b128 v[56:59], v9 offset:8192
    v_smfmac_f32_16x16x64_bf16 v[20:23], v[36:39], v[208:215], v1
    ds_read_b128 v[60:63], v9 offset:9216
    s_waitcnt lgkmcnt(3)
    v_smfmac_f32_16x16x64_bf16 v[24:27], v[36:39], v[64:71], v1
    v_smfmac_f32_16x16x64_bf16 v[12:15], v[40:43], v[232:239], v1
    buffer_load_dwordx4 v[36:39], v0, s[8:11], s42 offen
    v_smfmac_f32_16x16x64_bf16 v[16:19], v[40:43], v[240:247], v1
    ds_read_b128 v[64:67], v9 offset:10240
    v_smfmac_f32_16x16x64_bf16 v[20:23], v[40:43], v[248:255], v1
    ds_read_b128 v[68:71], v9 offset:11264
    s_waitcnt lgkmcnt(2)
    v_smfmac_f32_16x16x64_bf16 v[24:27], v[40:43], v[56:63], v1
    s_waitcnt vmcnt(1)
    ds_read_b128 v[44:47], v0 offset:6144
    v_smfmac_f32_16x16x64_bf16 v[12:15], v[52:55], a[16:23], v1
    buffer_load_dwordx4 v[40:43], v0, s[8:11], s42 offen offset:1024
    v_smfmac_f32_16x16x64_bf16 v[16:19], v[52:55], a[24:31], v1
    ds_read_b128 v[56:59], v9 offset:12288
    v_smfmac_f32_16x16x64_bf16 v[20:23], v[52:55], a[32:39], v1
    ds_read_b128 v[60:63], v9 offset:13312
    s_waitcnt lgkmcnt(3)
    v_smfmac_f32_16x16x64_bf16 v[24:27], v[52:55], v[64:71], v1
    ds_read_b128 v[48:51], v0 offset:7168
    s_waitcnt lgkmcnt(3)
    v_smfmac_f32_16x16x64_bf16 v[12:15], v[44:47], a[56:63], v1
    ds_read_b128 v[52:55], v0 offset:8192
    v_smfmac_f32_16x16x64_bf16 v[16:19], v[44:47], a[64:71], v1
    ds_read_b128 v[64:67], v9 offset:14336
    v_smfmac_f32_16x16x64_bf16 v[20:23], v[44:47], a[72:79], v1
    ds_read_b128 v[68:71], v9 offset:15360
    s_waitcnt lgkmcnt(4)
    v_smfmac_f32_16x16x64_bf16 v[24:27], v[44:47], v[56:63], v1
    s_waitcnt lgkmcnt(3)
    v_smfmac_f32_16x16x64_bf16 v[12:15], v[48:51], a[96:103], v1
    v_smfmac_f32_16x16x64_bf16 v[16:19], v[48:51], a[104:111], v1
    ds_read_b128 v[56:59], v9 offset:16384
    s_waitcnt lgkmcnt(3)
    v_smfmac_f32_16x16x64_bf16 v[12:15], v[52:55], a[136:143], v1
    ds_read_b128 v[60:63], v9 offset:17408
    v_smfmac_f32_16x16x64_bf16 v[16:19], v[52:55], a[144:151], v1
    v_smfmac_f32_16x16x64_bf16 v[20:23], v[48:51], a[112:119], v1
    s_waitcnt lgkmcnt(2)
    v_smfmac_f32_16x16x64_bf16 v[24:27], v[48:51], v[64:71], v1
    ds_read_b128 v[64:67], v0 offset:9216
    s_nop 1
    v_add_f32 v12, v12, v14
    v_smfmac_f32_16x16x64_bf16 v[20:23], v[52:55], a[152:159], v1
    ds_read_b128 v[68:71], v0 offset:10240
    v_add_f32 v16, v16, v18
    s_waitcnt lgkmcnt(2)
    v_smfmac_f32_16x16x64_bf16 v[24:27], v[52:55], v[56:63], v1
    ds_read_b128 v[56:59], v0 offset:11264
    v_add_f32 v13, v13, v15
    v_add_f32 v17, v17, v19
    v_cvt_pk_bf16_f32 v14, v12, v16
    v_cvt_pk_bf16_f32 v15, v13, v17
    ds_write_b32 v2, v14 offset:17408
    ds_write_b32 v2, v15 offset:17696
    v_smfmac_f32_16x16x64_bf16 v[28:31], v[52:55], a[160:167], v1
    ds_read_b128 v[60:63], v0 offset:12288
    v_add_f32 v20, v20, v22
    v_add_f32 v24, v24, v26
    v_add_f32 v21, v21, v23
    v_add_f32 v25, v25, v27
    v_smfmac_f32_16x16x64_bf16 v[32:35], v[52:55], a[168:175], v1
    ds_read_b128 v[12:15], v0 offset:0
    v_cvt_pk_bf16_f32 v22, v20, v24
    v_cvt_pk_bf16_f32 v23, v21, v25
    ds_write_b32 v2, v22 offset:19712
    ds_write_b32 v2, v23 offset:20000
    v_smfmac_f32_16x16x64_bf16 v[28:31], v[48:51], a[120:127], v1
    ds_read_b128 v[16:19], v0 offset:1024
    v_smfmac_f32_16x16x64_bf16 v[32:35], v[48:51], a[128:135], v1
    ds_read_b128 v[20:23], v0 offset:2048
    v_smfmac_f32_16x16x64_bf16 v[28:31], v[44:47], a[80:87], v1
    ds_read_b128 v[24:27], v0 offset:3072
    v_smfmac_f32_16x16x64_bf16 v[32:35], v[44:47], a[88:95], v1
    s_waitcnt lgkmcnt(3)
    s_barrier
    ds_read_b128 v[44:47], v3 offset:17408
    v_smfmac_f32_16x16x64_bf16 v[28:31], v[12:15], v[96:103], v1
    ds_read_b128 v[52:55], v0 offset:4096
    v_smfmac_f32_16x16x64_bf16 v[32:35], v[12:15], v[104:111], v1
    ds_read_b128 v[12:15], v3 offset:19712
    s_waitcnt lgkmcnt(5)
    v_smfmac_f32_16x16x64_bf16 v[28:31], v[16:19], v[136:143], v1
    ds_read_b128 v[48:51], v0 offset:5120
    v_smfmac_f32_16x16x64_bf16 v[32:35], v[16:19], v[144:151], v1
    s_waitcnt lgkmcnt(5)
    v_smfmac_f32_16x16x64_bf16 v[28:31], v[20:23], v[176:183], v1
    v_smfmac_f32_16x16x64_bf16 v[32:35], v[20:23], v[184:191], v1
    ds_read_b128 v[20:23], v3 offset:17472
    s_waitcnt lgkmcnt(5)
    v_smfmac_f32_16x16x64_bf16 v[28:31], v[24:27], v[216:223], v1
    v_smfmac_f32_16x16x64_bf16 v[32:35], v[24:27], v[224:231], v1
    s_waitcnt lgkmcnt(3)
    v_smfmac_f32_16x16x64_bf16 v[28:31], v[52:55], a[0:7], v1
    v_smfmac_f32_16x16x64_bf16 v[32:35], v[52:55], a[8:15], v1
    ds_read_b128 v[52:55], v3 offset:19776
    s_waitcnt lgkmcnt(2)
    v_smfmac_f32_16x16x64_bf16 v[28:31], v[48:51], a[40:47], v1
    v_smfmac_f32_16x16x64_bf16 v[32:35], v[48:51], a[48:55], v1
    ds_read_b128 v[48:51], v3 offset:17536
    v_mfma_f32_16x16x32_bf16 v[24:27], v[12:15], v[44:47], 0
    v_mfma_f32_16x16x32_bf16 v[12:15], v[64:67], v[44:47], 0
    ds_read_b128 v[64:67], v0 offset:13312
    v_mfma_f32_16x16x32_bf16 v[16:19], v[68:71], v[44:47], 0
    ds_read_b128 v[68:71], v0 offset:14336
    s_waitcnt lgkmcnt(3)
    v_mfma_f32_16x16x32_bf16 v[24:27], v[52:55], v[20:23], v[24:27]
    ds_read_b128 v[44:47], v3 offset:19840
    v_add_f32 v28, v28, v30
    v_add_f32 v29, v29, v31
    v_mfma_f32_16x16x32_bf16 v[12:15], v[56:59], v[20:23], v[12:15]
    ds_read_b128 v[52:55], v3 offset:17600
    v_add_f32 v32, v32, v34
    v_add_f32 v33, v33, v35
    v_mfma_f32_16x16x32_bf16 v[16:19], v[60:63], v[20:23], v[16:19]
    ds_read_b128 v[56:59], v0 offset:15360
    v_cvt_pk_bf16_f32 v30, v28, v29
    v_cvt_pk_bf16_f32 v31, v32, v33
    s_waitcnt lgkmcnt(2)
    v_mfma_f32_16x16x32_bf16 v[24:27], v[44:47], v[48:51], v[24:27]
    ds_read_b128 v[20:23], v3 offset:19904
    v_lshrrev_b32 v10, 8, v0
    v_mul_u32_u24 v10, 288, v10
    v_mfma_f32_16x16x32_bf16 v[12:15], v[64:67], v[48:51], v[12:15]
    ds_read_b128 v[60:63], v0 offset:16384
    v_and_b32 v11, 0xf0, v0
    v_add_u32 v10, v10, v11
    v_mfma_f32_16x16x32_bf16 v[16:19], v[68:71], v[48:51], v[16:19]
    ds_read_b128 v[32:35], v10 offset:19712
    v_lshrrev_b32 v11, 1, v0
    v_bfi_b32 v30, 1, s66, v30
    s_waitcnt lgkmcnt(2)
    v_mfma_f32_16x16x32_bf16 v[24:27], v[20:23], v[52:55], v[24:27]
    buffer_store_dwordx2 v[30:31], v11, s[8:11], s43 offen offset:2048 sc1
    v_mov_b32 v49, 0
    v_mov_b32 v50, 0
    v_mfma_f32_16x16x32_bf16 v[12:15], v[56:59], v[52:55], v[12:15]
    v_mov_b64 v[64:65], s[68:69]
    v_mov_b64 v[66:67], s[68:69]
    s_waitcnt lgkmcnt(1)
    v_mfma_f32_16x16x32_bf16 v[16:19], v[60:63], v[52:55], v[16:19]
    s_waitcnt lgkmcnt(0)
    v_bfi_b32 v32, 1, s66, v32
    s_mov_b64 exec, s[52:53]
    buffer_store_dwordx4 v[32:35], v0, s[8:11], s43 offen sc1
    s_mov_b64 exec, -1
    v_max3_f32 v10, v24, v25, v12
    v_max3_f32 v10, v10, v13, v14
    s_nop 0
    v_max3_f32 v10, v10, v15, v16
    v_max3_f32 v10, v10, v17, v18
    v_max_f32 v10, v10, v19
    v_mov_b32 v11, v10
    s_nop 1
    v_permlane32_swap_b32 v10, v11
    v_max_f32 v10, v10, v11
    v_mov_b32 v11, v10
    s_nop 1
    v_permlane16_swap_b32 v10, v11
    v_max_f32 v10, v10, v11
    v_mul_f32 v20, s46, v10
    v_pk_fma_f32 v[24:25], v[24:25], s[46:47], v[20:21] op_sel_hi:[1,1,0] neg_lo:[0,0,1] neg_hi:[0,0,1]
    v_pk_fma_f32 v[12:13], v[12:13], s[46:47], v[20:21] op_sel_hi:[1,1,0] neg_lo:[0,0,1] neg_hi:[0,0,1]
    v_exp_f32 v24, v24
    v_exp_f32 v25, v25
    v_pk_fma_f32 v[14:15], v[14:15], s[46:47], v[20:21] op_sel_hi:[1,1,0] neg_lo:[0,0,1] neg_hi:[0,0,1]
    v_exp_f32 v12, v12
    v_exp_f32 v13, v13
    v_pk_fma_f32 v[16:17], v[16:17], s[46:47], v[20:21] op_sel_hi:[1,1,0] neg_lo:[0,0,1] neg_hi:[0,0,1]
    v_cvt_pk_bf16_f32 v48, v24, v25
    v_exp_f32 v14, v14
    v_pk_fma_f32 v[18:19], v[18:19], s[46:47], v[20:21] op_sel_hi:[1,1,0] neg_lo:[0,0,1] neg_hi:[0,0,1]
    v_cvt_pk_bf16_f32 v51, v24, v25
    v_exp_f32 v15, v15
    v_cvt_pk_bf16_f32 v44, v12, v13
    v_exp_f32 v16, v16
    v_exp_f32 v17, v17
    v_cvt_pk_bf16_f32 v45, v14, v15
    v_exp_f32 v18, v18
    v_exp_f32 v19, v19
    v_cvt_pk_bf16_f32 v46, v16, v17
    v_cvt_pk_bf16_f32 v47, v18, v19
    v_mfma_f32_16x16x16_bf16 v[68:71], v[64:65], v[48:49], 0
    v_mfma_f32_16x16x16_bf16 v[52:55], v[30:31], v[48:49], 0
    v_mfma_f32_16x16x16_bf16 v[56:59], v[30:31], v[50:51], 0
    v_mfma_f32_16x16x32_bf16 v[68:71], v[64:67], v[44:47], v[68:71]
    s_waitcnt vmcnt(3)
    v_mfma_f32_16x16x32_bf16 v[52:55], v[36:39], v[44:47], v[52:55]
    s_waitcnt vmcnt(2)
    v_mfma_f32_16x16x32_bf16 v[56:59], v[40:43], v[44:47], v[56:59]
    ds_read_b128 v[36:39], v0 offset:30720
    ds_read_b128 v[40:43], v0 offset:31744
    ds_read_b128 v[60:63], v9 offset:24576
    s_nop 0
    v_rcp_f32 v10, v68
    s_nop 0
    v_pk_mul_f32 v[52:53], v[52:53], v[10:11] op_sel_hi:[1,0]
    s_nop 0
    v_pk_mul_f32 v[56:57], v[56:57], v[10:11] op_sel_hi:[1,0]
    v_cvt_pk_bf16_f32 v16, v52, v56
    v_cvt_pk_bf16_f32 v17, v53, v57
    v_pk_mul_f32 v[54:55], v[54:55], v[10:11] op_sel_hi:[1,0]
    v_pk_mul_f32 v[58:59], v[58:59], v[10:11] op_sel_hi:[1,0]
    v_cvt_pk_bf16_f32 v18, v54, v58
    v_cvt_pk_bf16_f32 v19, v55, v59
    ds_write_b128 v3, v[16:19] offset:22016
    ds_read_b128 v[64:67], v9 offset:25600
    v_mov_b64 v[12:13], 0
    v_mov_b64 v[14:15], 0
    v_mov_b64 v[20:21], 0
    v_mov_b64 v[22:23], 0
    v_mov_b64 v[24:25], 0
    v_mov_b64 v[26:27], 0
    v_mov_b64 v[32:33], 0
    v_mov_b64 v[34:35], 0
    v_mov_b64 v[44:45], 0
    v_mov_b64 v[46:47], 0
    v_mov_b64 v[48:49], 0
    v_mov_b64 v[50:51], 0
    s_waitcnt lgkmcnt(1)
    s_barrier
    ds_read_b128 v[52:55], v4 offset:22016
    ds_read_b128 v[56:59], v4 offset:22144
    v_mov_b64 v[68:69], 0
    v_mov_b64 v[70:71], 0
    v_mov_b64 v[28:29], 0
    v_mov_b64 v[30:31], 0
    v_mov_b64 v[16:17], 0
    v_mov_b64 v[18:19], 0
    s_cmp_eq_u32 s33, 63
    s_cbranch_scc1 Lr0f_last
    s_waitcnt lgkmcnt(1)
    v_smfmac_f32_16x16x64_bf16 v[28:31], v[52:55], v[60:67], v1
    ds_read_b128 v[60:63], v0 offset:24576
    s_waitcnt lgkmcnt(1)
    v_smfmac_f32_16x16x64_bf16 v[28:31], v[56:59], v[36:43], v1
    ds_read_b128 v[64:67], v0 offset:25600
    ds_read_b128 v[36:39], v9 offset:18432
    v_smfmac_f32_16x16x64_bf16 v[12:15], v[52:55], a[176:183], v1
    ds_read_b128 v[40:43], v9 offset:19456
    v_smfmac_f32_16x16x64_bf16 v[12:15], v[56:59], a[184:191], v1
    buffer_load_dwordx4 v0, s[8:11], s41 offen offset:0 lds
    v_smfmac_f32_16x16x64_bf16 v[20:23], v[52:55], a[192:199], v1
    s_nop 0
    v_add_f32 v28, v28, v30
    v_add_f32 v29, v29, v31
    s_waitcnt lgkmcnt(2)
    v_smfmac_f32_16x16x64_bf16 v[20:23], v[56:59], v[60:67], v1
    ds_read_b128 v[60:63], v9 offset:20480
    v_cvt_pk_bf16_f32 v28, v28, v29
    v_bfi_b32 v28, 1, s39, v28
    buffer_store_dword v28, v8, s[8:11], s38 offen offset:2048
    s_waitcnt lgkmcnt(1)
    v_smfmac_f32_16x16x64_bf16 v[24:27], v[52:55], v[36:43], v1
    ds_read_b128 v[64:67], v9 offset:21504
    ds_read_b128 v[36:39], v0 offset:26624
    v_add_f32 v12, v12, v14
    v_add_f32 v13, v13, v15
    v_smfmac_f32_16x16x64_bf16 v[24:27], v[56:59], a[200:207], v1
    ds_read_b128 v[40:43], v0 offset:27648
    v_cvt_pk_bf16_f32 v12, v12, v13
    v_bfi_b32 v12, 1, s39, v12
    v_smfmac_f32_16x16x64_bf16 v[32:35], v[52:55], a[208:215], v1
    buffer_load_dwordx4 v0, s[8:11], s41 offen offset:1024 lds
    v_add_f32 v20, v20, v22
    v_add_f32 v21, v21, v23
    v_smfmac_f32_16x16x64_bf16 v[32:35], v[56:59], a[216:223], v1
    v_cvt_pk_bf16_f32 v13, v20, v21
    s_waitcnt lgkmcnt(2)
    v_smfmac_f32_16x16x64_bf16 v[44:47], v[52:55], v[60:67], v1
    ds_read_b128 v[60:63], v0 offset:28672
    v_add_f32 v24, v24, v26
    v_add_f32 v25, v25, v27
    s_waitcnt lgkmcnt(1)
    v_smfmac_f32_16x16x64_bf16 v[44:47], v[56:59], v[36:43], v1
    ds_read_b128 v[64:67], v0 offset:29696
    ds_read_b128 v[36:39], v9 offset:22528
    v_cvt_pk_bf16_f32 v14, v24, v25
    v_smfmac_f32_16x16x64_bf16 v[48:51], v[52:55], a[224:231], v1
    ds_read_b128 v[40:43], v9 offset:23552
    v_add_f32 v32, v32, v34
    v_add_f32 v33, v33, v35
    v_smfmac_f32_16x16x64_bf16 v[48:51], v[56:59], a[232:239], v1
    v_cvt_pk_bf16_f32 v15, v32, v33
    buffer_store_dwordx4 v[12:15], v0, s[8:11], s38 offen offset:0
    v_smfmac_f32_16x16x64_bf16 v[68:71], v[52:55], a[240:247], v1
    v_add_f32 v44, v44, v46
    v_add_f32 v45, v45, v47
    s_waitcnt lgkmcnt(2)
    v_smfmac_f32_16x16x64_bf16 v[68:71], v[56:59], v[60:67], v1
    v_cvt_pk_bf16_f32 v44, v44, v45
    v_bfi_b32 v44, 1, s39, v44
    s_waitcnt lgkmcnt(0)
    v_smfmac_f32_16x16x64_bf16 v[16:19], v[52:55], v[36:43], v1
    v_add_f32 v48, v48, v50
    v_add_f32 v49, v49, v51
    v_smfmac_f32_16x16x64_bf16 v[16:19], v[56:59], a[248:255], v1
    v_cvt_pk_bf16_f32 v45, v48, v49
    v_add_f32 v68, v68, v70
    v_add_f32 v69, v69, v71
    v_cvt_pk_bf16_f32 v46, v68, v69
    s_nop 3
    v_add_f32 v16, v16, v18
    v_add_f32 v17, v17, v19
    v_cvt_pk_bf16_f32 v47, v16, v17
    buffer_store_dwordx4 v[44:47], v0, s[8:11], s38 offen offset:1024
    s_sleep 6
    buffer_load_dwordx4 v[52:55], v6, s[8:11], s57 offen sc1
    buffer_load_dwordx4 v[56:59], v6, s[8:11], s58 offen sc1
    buffer_load_dwordx4 v[60:63], v6, s[8:11], s59 offen sc1
    buffer_load_dwordx4 v[64:67], v6, s[8:11], s60 offen sc1
    v_bfe_u32 v10, v0, 4, 4
    v_mov_b32 v11, 0x3f80
    v_mov_b32 v40, 0x3f800000
    v_cmp_eq_u32 vcc, 0, v10
    v_cmp_eq_u32 s[48:49], 1, v10
    s_nop 0
    v_cndmask_b32 v36, 0, v11, vcc
    v_cndmask_b32 v36, v36, v40, s[48:49]
    v_cmp_eq_u32 vcc, 2, v10
    v_cmp_eq_u32 s[48:49], 3, v10
    s_nop 0
    v_cndmask_b32 v37, 0, v11, vcc
    v_cndmask_b32 v37, v37, v40, s[48:49]
    v_cmp_eq_u32 vcc, 4, v10
    v_cmp_eq_u32 s[48:49], 5, v10
    s_nop 0
    v_cndmask_b32 v38, 0, v11, vcc
    v_cndmask_b32 v38, v38, v40, s[48:49]
    v_cmp_eq_u32 vcc, 6, v10
    v_cmp_eq_u32 s[48:49], 7, v10
    s_nop 0
    v_cndmask_b32 v39, 0, v11, vcc
    v_cndmask_b32 v39, v39, v40, s[48:49]
    s_mov_b32 s16, 0
    s_mov_b64 s[70:71], 0
    s_mov_b64 s[72:73], 0
    s_mov_b64 s[74:75], 0
    s_mov_b64 s[76:77], 0
Lr0f_p1:
    s_mov_b64 exec, s[70:71]
    buffer_load_dwordx4 v[52:55], v6, s[8:11], s57 offen sc1
    s_mov_b64 exec, s[72:73]
    buffer_load_dwordx4 v[56:59], v6, s[8:11], s58 offen sc1
    s_mov_b64 exec, s[74:75]
    buffer_load_dwordx4 v[60:63], v6, s[8:11], s59 offen sc1
    s_mov_b64 exec, s[76:77]
    buffer_load_dwordx4 v[64:67], v6, s[8:11], s60 offen sc1
    s_mov_b64 exec, -1
    s_add_u32 s16, s16, 1
    s_cmp_gt_u32 s16, 100000
    s_cbranch_scc1 Lr_abort
    s_waitcnt vmcnt(7)
    v_and_b32 v11, 1, v52
    v_cmp_ne_u32 s[70:71], s39, v11
    v_mfma_f32_16x16x32_bf16 v[40:43], v[52:55], v[36:39], 0
    s_waitcnt vmcnt(6)
    v_and_b32 v11, 1, v56
    v_cmp_ne_u32 s[72:73], s39, v11
    v_mfma_f32_16x16x32_bf16 v[40:43], v[56:59], v[36:39], v[40:43]
    s_waitcnt vmcnt(5)
    v_and_b32 v11, 1, v60
    v_cmp_ne_u32 s[74:75], s39, v11
    v_mfma_f32_16x16x32_bf16 v[40:43], v[60:63], v[36:39], v[40:43]
    s_or_b64 vcc, s[70:71], s[72:73]
    s_waitcnt vmcnt(4)
    v_and_b32 v11, 1, v64
    v_cmp_ne_u32 s[76:77], s39, v11
    v_mfma_f32_16x16x32_bf16 v[40:43], v[64:67], v[36:39], v[40:43]
    s_or_b64 vcc, vcc, s[74:75]
    s_or_b64 vcc, vcc, s[76:77]
    s_cbranch_scc1 Lr0f_p1
    s_nop 4
    v_permlane16_swap_b32 v40, v42
    v_permlane16_swap_b32 v41, v43
    s_mov_b64 exec, s[50:51]
    v_add_f32 v40, v40, v42
    v_add_f32 v41, v41, v43
    v_cvt_pk_bf16_f32 v40, v40, v41
    v_min_u32 v40, s54, v40
    buffer_store_dword v40, v7, s[8:11], s36 offen
    v_mov_b32 v41, -1
    buffer_store_dword v41, v7, s[8:11], s37 offen
    s_mov_b64 exec, -1
    s_xor_b32 s34, s34, 16384
    s_xor_b32 s35, s35, 16384
    s_barrier
    s_sleep 2
    buffer_load_dwordx4 v[44:47], v0, s[8:11], s34 offen sc1
    buffer_load_dwordx4 v[48:51], v0, s[8:11], s34 offen offset:1024 sc1
    buffer_load_dword v10, v8, s[8:11], s35 offen sc1
    s_add_u32 s33, s33, 1
    s_bfe_u32 s39, s33, 0x10001
    s_xor_b32 s38, s38, 524288
    s_xor_b32 s57, s57, 524288
    s_xor_b32 s58, s58, 524288
    s_xor_b32 s59, s59, 524288
    s_xor_b32 s60, s60, 524288
    s_xor_b32 s36, s36, 16384
    s_xor_b32 s37, s37, 16384
    s_and_b32 s17, s33, 7
    s_mul_i32 s17, s17, 131072
    s_add_u32 s43, s45, s17
    s_bfe_u32 s66, s33, 65539
    s_add_u32 s67, s67, 22528
    s_add_u32 s42, s42, 262144
    s_add_u32 s41, s41, 262144
    s_add_u32 s40, s40, 262144
    s_add_u32 s44, s44, 22528
    s_waitcnt vmcnt(5)
    ds_read_b128 v[56:59], v9 offset:0
    ds_read_b128 v[60:63], v9 offset:1024
    ds_read_b128 v[64:67], v9 offset:2048
    ds_read_b128 v[68:71], v9 offset:3072
    v_mov_b64 v[12:13], 0
    v_mov_b64 v[14:15], 0
    v_mov_b64 v[16:17], 0
    v_mov_b64 v[18:19], 0
    v_mov_b64 v[20:21], 0
    v_mov_b64 v[22:23], 0
    v_mov_b64 v[24:25], 0
    v_mov_b64 v[26:27], 0
    v_mov_b64 v[28:29], 0
    v_mov_b64 v[30:31], 0
    v_mov_b64 v[32:33], 0
    v_mov_b64 v[34:35], 0
    s_waitcnt lgkmcnt(0)
    s_branch Lr0f_step
Lr0f_last:
    s_waitcnt vmcnt(0) lgkmcnt(0)
    s_branch Lr_exit
L_w1_1:
    s_cmp_lg_u32 s14, 1
    s_cbranch_scc1 L_w2_1
    s_barrier
    s_mov_b32 m0, 11264
    s_nop 0
    buffer_load_dwordx4 v0, s[8:11], s41 offen offset:0 lds
    buffer_load_dwordx4 v0, s[8:11], s41 offen offset:1024 lds
    s_add_u32 s41, s41, 262144
    s_waitcnt vmcnt(0)
    buffer_load_dwordx4 v[44:47], v0, s[8:11], s34 offen sc1
    buffer_load_dwordx4 v[48:51], v0, s[8:11], s34 offen offset:1024 sc1
    buffer_load_dword v10, v8, s[8:11], s35 offen sc1
    ds_read_b128 v[56:59], v9 offset:4096
    ds_read_b128 v[60:63], v9 offset:5120
    ds_read_b128 v[64:67], v9 offset:6144
    ds_read_b128 v[68:71], v9 offset:7168
    v_mov_b64 v[12:13], 0
    v_mov_b64 v[14:15], 0
    v_mov_b64 v[16:17], 0
    v_mov_b64 v[18:19], 0
    v_mov_b64 v[20:21], 0
    v_mov_b64 v[22:23], 0
    v_mov_b64 v[24:25], 0
    v_mov_b64 v[26:27], 0
    v_mov_b64 v[28:29], 0
    v_mov_b64 v[30:31], 0
    v_mov_b64 v[32:33], 0
    v_mov_b64 v[34:35], 0
    s_waitcnt lgkmcnt(0)
Lr1f_step:
    s_mov_b32 s16, 0
    s_mov_b64 s[70:71], 0
    s_mov_b64 s[72:73], 0
    s_mov_b64 s[74:75], 0
Lr1f_p2:
    s_mov_b64 exec, s[70:71]
    buffer_load_dwordx4 v[44:47], v0, s[8:11], s34 offen sc1
    s_mov_b64 exec, s[72:73]
    buffer_load_dwordx4 v[48:51], v0, s[8:11], s34 offen offset:1024 sc1
    s_mov_b64 exec, s[74:75]
    buffer_load_dword v10, v8, s[8:11], s35 offen sc1
    s_mov_b64 exec, -1
    s_add_u32 s16, s16, 1
    s_cmp_gt_u32 s16, 100000
    s_cbranch_scc1 Lr_abort
    s_waitcnt vmcnt(5)
    v_max3_u32 v11, v44, v45, v46
    v_max_u32 v11, v11, v47
    v_cmp_eq_u32 s[70:71], -1, v11
    s_waitcnt vmcnt(4)
    v_max3_u32 v11, v48, v49, v50
    v_max_u32 v11, v11, v51
    v_cmp_eq_u32 s[72:73], -1, v11
    s_waitcnt vmcnt(3)
    v_cmp_eq_u32 s[74:75], -1, v10
    s_or_b64 vcc, s[70:71], s[72:73]
    s_or_b64 vcc, vcc, s[74:75]
    s_cbranch_scc1 Lr1f_p2
    v_smfmac_f32_16x16x64_bf16 v[12:15], v[44:47], v[152:159], v1
    ds_write_b128 v0, v[44:47] offset:2048
    v_smfmac_f32_16x16x64_bf16 v[16:19], v[44:47], v[160:167], v1
    ds_write_b128 v0, v[48:51] offset:3072
    v_smfmac_f32_16x16x64_bf16 v[20:23], v[44:47], v[168:175], v1
    ds_write_b32 v8, v10 offset:8448
    v_smfmac_f32_16x16x64_bf16 v[24:27], v[44:47], v[56:63], v1
    s_waitcnt lgkmcnt(0)
    s_barrier
    ds_read_b128 v[52:55], v0 offset:0
    v_smfmac_f32_16x16x64_bf16 v[12:15], v[48:51], v[192:199], v1
    ds_read_b128 v[36:39], v0 offset:1024
    v_smfmac_f32_16x16x64_bf16 v[16:19], v[48:51], v[200:207], v1
    ds_read_b128 v[56:59], v9 offset:0
    v_smfmac_f32_16x16x64_bf16 v[20:23], v[48:51], v[208:215], v1
    ds_read_b128 v[60:63], v9 offset:1024
    v_smfmac_f32_16x16x64_bf16 v[24:27], v[48:51], v[64:71], v1
    ds_read_b128 v[40:43], v0 offset:4096
    s_waitcnt lgkmcnt(4)
    v_smfmac_f32_16x16x64_bf16 v[12:15], v[52:55], v[72:79], v1
    v_smfmac_f32_16x16x64_bf16 v[16:19], v[52:55], v[80:87], v1
    ds_read_b128 v[64:67], v9 offset:2048
    v_smfmac_f32_16x16x64_bf16 v[20:23], v[52:55], v[88:95], v1
    ds_read_b128 v[68:71], v9 offset:3072
    s_waitcnt lgkmcnt(3)
    v_smfmac_f32_16x16x64_bf16 v[24:27], v[52:55], v[56:63], v1
    v_smfmac_f32_16x16x64_bf16 v[12:15], v[36:39], v[112:119], v1
    ds_read_b128 v[52:55], v0 offset:5120
    v_smfmac_f32_16x16x64_bf16 v[16:19], v[36:39], v[120:127], v1
    ds_read_b128 v[56:59], v9 offset:8192
    v_smfmac_f32_16x16x64_bf16 v[20:23], v[36:39], v[128:135], v1
    ds_read_b128 v[60:63], v9 offset:9216
    s_waitcnt lgkmcnt(3)
    v_smfmac_f32_16x16x64_bf16 v[24:27], v[36:39], v[64:71], v1
    v_smfmac_f32_16x16x64_bf16 v[12:15], v[40:43], v[232:239], v1
    buffer_load_dwordx4 v[36:39], v0, s[8:11], s42 offen
    v_smfmac_f32_16x16x64_bf16 v[16:19], v[40:43], v[240:247], v1
    ds_read_b128 v[64:67], v9 offset:10240
    v_smfmac_f32_16x16x64_bf16 v[20:23], v[40:43], v[248:255], v1
    ds_read_b128 v[68:71], v9 offset:11264
    s_waitcnt lgkmcnt(2)
    v_smfmac_f32_16x16x64_bf16 v[24:27], v[40:43], v[56:63], v1
    s_waitcnt vmcnt(1)
    ds_read_b128 v[44:47], v0 offset:6144
    v_smfmac_f32_16x16x64_bf16 v[12:15], v[52:55], a[16:23], v1
    buffer_load_dwordx4 v[40:43], v0, s[8:11], s42 offen offset:1024
    v_smfmac_f32_16x16x64_bf16 v[16:19], v[52:55], a[24:31], v1
    ds_read_b128 v[56:59], v9 offset:12288
    v_smfmac_f32_16x16x64_bf16 v[20:23], v[52:55], a[32:39], v1
    ds_read_b128 v[60:63], v9 offset:13312
    s_waitcnt lgkmcnt(3)
    v_smfmac_f32_16x16x64_bf16 v[24:27], v[52:55], v[64:71], v1
    ds_read_b128 v[48:51], v0 offset:7168
    s_waitcnt lgkmcnt(3)
    v_smfmac_f32_16x16x64_bf16 v[12:15], v[44:47], a[56:63], v1
    ds_read_b128 v[52:55], v0 offset:8192
    v_smfmac_f32_16x16x64_bf16 v[16:19], v[44:47], a[64:71], v1
    ds_read_b128 v[64:67], v9 offset:14336
    v_smfmac_f32_16x16x64_bf16 v[20:23], v[44:47], a[72:79], v1
    ds_read_b128 v[68:71], v9 offset:15360
    s_waitcnt lgkmcnt(4)
    v_smfmac_f32_16x16x64_bf16 v[24:27], v[44:47], v[56:63], v1
    s_waitcnt lgkmcnt(3)
    v_smfmac_f32_16x16x64_bf16 v[12:15], v[48:51], a[96:103], v1
    v_smfmac_f32_16x16x64_bf16 v[16:19], v[48:51], a[104:111], v1
    ds_read_b128 v[56:59], v9 offset:16384
    s_waitcnt lgkmcnt(3)
    v_smfmac_f32_16x16x64_bf16 v[12:15], v[52:55], a[136:143], v1
    ds_read_b128 v[60:63], v9 offset:17408
    v_smfmac_f32_16x16x64_bf16 v[16:19], v[52:55], a[144:151], v1
    v_smfmac_f32_16x16x64_bf16 v[20:23], v[48:51], a[112:119], v1
    s_waitcnt lgkmcnt(2)
    v_smfmac_f32_16x16x64_bf16 v[24:27], v[48:51], v[64:71], v1
    ds_read_b128 v[64:67], v0 offset:9216
    s_nop 1
    v_add_f32 v12, v12, v14
    v_smfmac_f32_16x16x64_bf16 v[20:23], v[52:55], a[152:159], v1
    ds_read_b128 v[68:71], v0 offset:10240
    v_add_f32 v16, v16, v18
    s_waitcnt lgkmcnt(2)
    v_smfmac_f32_16x16x64_bf16 v[24:27], v[52:55], v[56:63], v1
    ds_read_b128 v[56:59], v0 offset:11264
    v_add_f32 v13, v13, v15
    v_add_f32 v17, v17, v19
    v_cvt_pk_bf16_f32 v14, v12, v16
    v_cvt_pk_bf16_f32 v15, v13, v17
    ds_write_b32 v2, v14 offset:17408
    ds_write_b32 v2, v15 offset:17696
    v_smfmac_f32_16x16x64_bf16 v[28:31], v[52:55], a[160:167], v1
    ds_read_b128 v[60:63], v0 offset:12288
    v_add_f32 v20, v20, v22
    v_add_f32 v24, v24, v26
    v_add_f32 v21, v21, v23
    v_add_f32 v25, v25, v27
    v_smfmac_f32_16x16x64_bf16 v[32:35], v[52:55], a[168:175], v1
    ds_read_b128 v[12:15], v0 offset:2048
    v_cvt_pk_bf16_f32 v22, v20, v24
    v_cvt_pk_bf16_f32 v23, v21, v25
    ds_write_b32 v2, v22 offset:19712
    ds_write_b32 v2, v23 offset:20000
    v_smfmac_f32_16x16x64_bf16 v[28:31], v[48:51], a[120:127], v1
    ds_read_b128 v[16:19], v0 offset:3072
    v_smfmac_f32_16x16x64_bf16 v[32:35], v[48:51], a[128:135], v1
    ds_read_b128 v[20:23], v0 offset:0
    v_smfmac_f32_16x16x64_bf16 v[28:31], v[44:47], a[80:87], v1
    ds_read_b128 v[24:27], v0 offset:1024
    v_smfmac_f32_16x16x64_bf16 v[32:35], v[44:47], a[88:95], v1
    s_waitcnt lgkmcnt(3)
    s_barrier
    ds_read_b128 v[44:47], v3 offset:17408
    v_smfmac_f32_16x16x64_bf16 v[28:31], v[12:15], v[176:183], v1
    ds_read_b128 v[52:55], v0 offset:4096
    v_smfmac_f32_16x16x64_bf16 v[32:35], v[12:15], v[184:191], v1
    ds_read_b128 v[12:15], v3 offset:19712
    s_waitcnt lgkmcnt(5)
    v_smfmac_f32_16x16x64_bf16 v[28:31], v[16:19], v[216:223], v1
    ds_read_b128 v[48:51], v0 offset:5120
    v_smfmac_f32_16x16x64_bf16 v[32:35], v[16:19], v[224:231], v1
    s_waitcnt lgkmcnt(5)
    v_smfmac_f32_16x16x64_bf16 v[28:31], v[20:23], v[96:103], v1
    v_smfmac_f32_16x16x64_bf16 v[32:35], v[20:23], v[104:111], v1
    ds_read_b128 v[20:23], v3 offset:17472
    s_waitcnt lgkmcnt(5)
    v_smfmac_f32_16x16x64_bf16 v[28:31], v[24:27], v[136:143], v1
    v_smfmac_f32_16x16x64_bf16 v[32:35], v[24:27], v[144:151], v1
    s_waitcnt lgkmcnt(3)
    v_smfmac_f32_16x16x64_bf16 v[28:31], v[52:55], a[0:7], v1
    v_smfmac_f32_16x16x64_bf16 v[32:35], v[52:55], a[8:15], v1
    ds_read_b128 v[52:55], v3 offset:19776
    s_waitcnt lgkmcnt(2)
    v_smfmac_f32_16x16x64_bf16 v[28:31], v[48:51], a[40:47], v1
    v_smfmac_f32_16x16x64_bf16 v[32:35], v[48:51], a[48:55], v1
    ds_read_b128 v[48:51], v3 offset:17536
    v_mfma_f32_16x16x32_bf16 v[24:27], v[12:15], v[44:47], 0
    v_mfma_f32_16x16x32_bf16 v[12:15], v[64:67], v[44:47], 0
    ds_read_b128 v[64:67], v0 offset:13312
    v_mfma_f32_16x16x32_bf16 v[16:19], v[68:71], v[44:47], 0
    ds_read_b128 v[68:71], v0 offset:14336
    s_waitcnt lgkmcnt(3)
    v_mfma_f32_16x16x32_bf16 v[24:27], v[52:55], v[20:23], v[24:27]
    ds_read_b128 v[44:47], v3 offset:19840
    v_add_f32 v28, v28, v30
    v_add_f32 v29, v29, v31
    v_mfma_f32_16x16x32_bf16 v[12:15], v[56:59], v[20:23], v[12:15]
    ds_read_b128 v[52:55], v3 offset:17600
    v_add_f32 v32, v32, v34
    v_add_f32 v33, v33, v35
    v_mfma_f32_16x16x32_bf16 v[16:19], v[60:63], v[20:23], v[16:19]
    ds_read_b128 v[56:59], v0 offset:15360
    v_cvt_pk_bf16_f32 v30, v28, v29
    v_cvt_pk_bf16_f32 v31, v32, v33
    s_waitcnt lgkmcnt(2)
    v_mfma_f32_16x16x32_bf16 v[24:27], v[44:47], v[48:51], v[24:27]
    ds_read_b128 v[20:23], v3 offset:19904
    v_lshrrev_b32 v10, 8, v0
    v_mul_u32_u24 v10, 288, v10
    v_mfma_f32_16x16x32_bf16 v[12:15], v[64:67], v[48:51], v[12:15]
    ds_read_b128 v[60:63], v0 offset:16384
    v_and_b32 v11, 0xf0, v0
    v_add_u32 v10, v10, v11
    v_mfma_f32_16x16x32_bf16 v[16:19], v[68:71], v[48:51], v[16:19]
    ds_read_b128 v[32:35], v10 offset:20288
    v_lshrrev_b32 v11, 1, v0
    v_bfi_b32 v30, 1, s66, v30
    s_waitcnt lgkmcnt(2)
    v_mfma_f32_16x16x32_bf16 v[24:27], v[20:23], v[52:55], v[24:27]
    buffer_store_dwordx2 v[30:31], v11, s[8:11], s43 offen offset:2048 sc1
    v_mov_b32 v49, 0
    v_mov_b32 v50, 0
    v_mfma_f32_16x16x32_bf16 v[12:15], v[56:59], v[52:55], v[12:15]
    v_mov_b64 v[64:65], s[68:69]
    v_mov_b64 v[66:67], s[68:69]
    s_waitcnt lgkmcnt(1)
    v_mfma_f32_16x16x32_bf16 v[16:19], v[60:63], v[52:55], v[16:19]
    s_waitcnt lgkmcnt(0)
    v_bfi_b32 v32, 1, s66, v32
    s_mov_b64 exec, s[52:53]
    buffer_store_dwordx4 v[32:35], v0, s[8:11], s43 offen sc1
    s_mov_b64 exec, -1
    v_max3_f32 v10, v24, v25, v12
    v_max3_f32 v10, v10, v13, v14
    s_nop 0
    v_max3_f32 v10, v10, v15, v16
    v_max3_f32 v10, v10, v17, v18
    v_max_f32 v10, v10, v19
    v_mov_b32 v11, v10
    s_nop 1
    v_permlane32_swap_b32 v10, v11
    v_max_f32 v10, v10, v11
    v_mov_b32 v11, v10
    s_nop 1
    v_permlane16_swap_b32 v10, v11
    v_max_f32 v10, v10, v11
    v_mul_f32 v20, s46, v10
    v_pk_fma_f32 v[24:25], v[24:25], s[46:47], v[20:21] op_sel_hi:[1,1,0] neg_lo:[0,0,1] neg_hi:[0,0,1]
    v_pk_fma_f32 v[12:13], v[12:13], s[46:47], v[20:21] op_sel_hi:[1,1,0] neg_lo:[0,0,1] neg_hi:[0,0,1]
    v_exp_f32 v24, v24
    v_exp_f32 v25, v25
    v_pk_fma_f32 v[14:15], v[14:15], s[46:47], v[20:21] op_sel_hi:[1,1,0] neg_lo:[0,0,1] neg_hi:[0,0,1]
    v_exp_f32 v12, v12
    v_exp_f32 v13, v13
    v_pk_fma_f32 v[16:17], v[16:17], s[46:47], v[20:21] op_sel_hi:[1,1,0] neg_lo:[0,0,1] neg_hi:[0,0,1]
    v_cvt_pk_bf16_f32 v48, v24, v25
    v_exp_f32 v14, v14
    v_pk_fma_f32 v[18:19], v[18:19], s[46:47], v[20:21] op_sel_hi:[1,1,0] neg_lo:[0,0,1] neg_hi:[0,0,1]
    v_cvt_pk_bf16_f32 v51, v24, v25
    v_exp_f32 v15, v15
    v_cvt_pk_bf16_f32 v44, v12, v13
    v_exp_f32 v16, v16
    v_exp_f32 v17, v17
    v_cvt_pk_bf16_f32 v45, v14, v15
    v_exp_f32 v18, v18
    v_exp_f32 v19, v19
    v_cvt_pk_bf16_f32 v46, v16, v17
    v_cvt_pk_bf16_f32 v47, v18, v19
    v_mfma_f32_16x16x16_bf16 v[68:71], v[64:65], v[48:49], 0
    v_mfma_f32_16x16x16_bf16 v[52:55], v[30:31], v[48:49], 0
    v_mfma_f32_16x16x16_bf16 v[56:59], v[30:31], v[50:51], 0
    v_mfma_f32_16x16x32_bf16 v[68:71], v[64:67], v[44:47], v[68:71]
    s_waitcnt vmcnt(3)
    v_mfma_f32_16x16x32_bf16 v[52:55], v[36:39], v[44:47], v[52:55]
    s_waitcnt vmcnt(2)
    v_mfma_f32_16x16x32_bf16 v[56:59], v[40:43], v[44:47], v[56:59]
    ds_read_b128 v[36:39], v0 offset:38912
    ds_read_b128 v[40:43], v0 offset:39936
    ds_read_b128 v[60:63], v9 offset:24576
    s_nop 0
    v_rcp_f32 v10, v68
    s_nop 0
    v_pk_mul_f32 v[52:53], v[52:53], v[10:11] op_sel_hi:[1,0]
    s_nop 0
    v_pk_mul_f32 v[56:57], v[56:57], v[10:11] op_sel_hi:[1,0]
    v_cvt_pk_bf16_f32 v16, v52, v56
    v_cvt_pk_bf16_f32 v17, v53, v57
    v_pk_mul_f32 v[54:55], v[54:55], v[10:11] op_sel_hi:[1,0]
    v_pk_mul_f32 v[58:59], v[58:59], v[10:11] op_sel_hi:[1,0]
    v_cvt_pk_bf16_f32 v18, v54, v58
    v_cvt_pk_bf16_f32 v19, v55, v59
    ds_write_b128 v3, v[16:19] offset:22080
    ds_read_b128 v[64:67], v9 offset:25600
    v_mov_b64 v[12:13], 0
    v_mov_b64 v[14:15], 0
    v_mov_b64 v[20:21], 0
    v_mov_b64 v[22:23], 0
    v_mov_b64 v[24:25], 0
    v_mov_b64 v[26:27], 0
    v_mov_b64 v[32:33], 0
    v_mov_b64 v[34:35], 0
    v_mov_b64 v[44:45], 0
    v_mov_b64 v[46:47], 0
    v_mov_b64 v[48:49], 0
    v_mov_b64 v[50:51], 0
    s_waitcnt lgkmcnt(1)
    s_barrier
    ds_read_b128 v[52:55], v4 offset:22016
    ds_read_b128 v[56:59], v4 offset:22144
    v_mov_b64 v[68:69], 0
    v_mov_b64 v[70:71], 0
    v_mov_b64 v[28:29], 0
    v_mov_b64 v[30:31], 0
    v_mov_b64 v[16:17], 0
    v_mov_b64 v[18:19], 0
    s_cmp_eq_u32 s33, 63
    s_cbranch_scc1 Lr1f_last
    s_waitcnt lgkmcnt(1)
    v_smfmac_f32_16x16x64_bf16 v[28:31], v[52:55], v[60:67], v1
    ds_read_b128 v[60:63], v0 offset:32768
    s_waitcnt lgkmcnt(1)
    v_smfmac_f32_16x16x64_bf16 v[28:31], v[56:59], v[36:43], v1
    ds_read_b128 v[64:67], v0 offset:33792
    ds_read_b128 v[36:39], v9 offset:18432
    v_smfmac_f32_16x16x64_bf16 v[12:15], v[52:55], a[176:183], v1
    ds_read_b128 v[40:43], v9 offset:19456
    v_smfmac_f32_16x16x64_bf16 v[12:15], v[56:59], a[184:191], v1
    buffer_load_dwordx4 v0, s[8:11], s41 offen offset:0 lds
    v_smfmac_f32_16x16x64_bf16 v[20:23], v[52:55], a[192:199], v1
    s_nop 0
    v_add_f32 v28, v28, v30
    v_add_f32 v29, v29, v31
    s_waitcnt lgkmcnt(2)
    v_smfmac_f32_16x16x64_bf16 v[20:23], v[56:59], v[60:67], v1
    ds_read_b128 v[60:63], v9 offset:20480
    v_cvt_pk_bf16_f32 v28, v28, v29
    v_bfi_b32 v28, 1, s39, v28
    buffer_store_dword v28, v8, s[8:11], s38 offen offset:2048
    s_waitcnt lgkmcnt(1)
    v_smfmac_f32_16x16x64_bf16 v[24:27], v[52:55], v[36:43], v1
    ds_read_b128 v[64:67], v9 offset:21504
    ds_read_b128 v[36:39], v0 offset:34816
    v_add_f32 v12, v12, v14
    v_add_f32 v13, v13, v15
    v_smfmac_f32_16x16x64_bf16 v[24:27], v[56:59], a[200:207], v1
    ds_read_b128 v[40:43], v0 offset:35840
    v_cvt_pk_bf16_f32 v12, v12, v13
    v_bfi_b32 v12, 1, s39, v12
    v_smfmac_f32_16x16x64_bf16 v[32:35], v[52:55], a[208:215], v1
    buffer_load_dwordx4 v0, s[8:11], s41 offen offset:1024 lds
    v_add_f32 v20, v20, v22
    v_add_f32 v21, v21, v23
    v_smfmac_f32_16x16x64_bf16 v[32:35], v[56:59], a[216:223], v1
    v_cvt_pk_bf16_f32 v13, v20, v21
    s_waitcnt lgkmcnt(2)
    v_smfmac_f32_16x16x64_bf16 v[44:47], v[52:55], v[60:67], v1
    ds_read_b128 v[60:63], v0 offset:36864
    v_add_f32 v24, v24, v26
    v_add_f32 v25, v25, v27
    s_waitcnt lgkmcnt(1)
    v_smfmac_f32_16x16x64_bf16 v[44:47], v[56:59], v[36:43], v1
    ds_read_b128 v[64:67], v0 offset:37888
    ds_read_b128 v[36:39], v9 offset:22528
    v_cvt_pk_bf16_f32 v14, v24, v25
    v_smfmac_f32_16x16x64_bf16 v[48:51], v[52:55], a[224:231], v1
    ds_read_b128 v[40:43], v9 offset:23552
    v_add_f32 v32, v32, v34
    v_add_f32 v33, v33, v35
    v_smfmac_f32_16x16x64_bf16 v[48:51], v[56:59], a[232:239], v1
    v_cvt_pk_bf16_f32 v15, v32, v33
    buffer_store_dwordx4 v[12:15], v0, s[8:11], s38 offen offset:0
    v_smfmac_f32_16x16x64_bf16 v[68:71], v[52:55], a[240:247], v1
    v_add_f32 v44, v44, v46
    v_add_f32 v45, v45, v47
    s_waitcnt lgkmcnt(2)
    v_smfmac_f32_16x16x64_bf16 v[68:71], v[56:59], v[60:67], v1
    v_cvt_pk_bf16_f32 v44, v44, v45
    v_bfi_b32 v44, 1, s39, v44
    s_waitcnt lgkmcnt(0)
    v_smfmac_f32_16x16x64_bf16 v[16:19], v[52:55], v[36:43], v1
    v_add_f32 v48, v48, v50
    v_add_f32 v49, v49, v51
    v_smfmac_f32_16x16x64_bf16 v[16:19], v[56:59], a[248:255], v1
    v_cvt_pk_bf16_f32 v45, v48, v49
    v_add_f32 v68, v68, v70
    v_add_f32 v69, v69, v71
    v_cvt_pk_bf16_f32 v46, v68, v69
    s_nop 3
    v_add_f32 v16, v16, v18
    v_add_f32 v17, v17, v19
    v_cvt_pk_bf16_f32 v47, v16, v17
    buffer_store_dwordx4 v[44:47], v0, s[8:11], s38 offen offset:1024
    s_sleep 6
    buffer_load_dwordx4 v[52:55], v6, s[8:11], s57 offen sc1
    buffer_load_dwordx4 v[56:59], v6, s[8:11], s58 offen sc1
    buffer_load_dwordx4 v[60:63], v6, s[8:11], s59 offen sc1
    buffer_load_dwordx4 v[64:67], v6, s[8:11], s60 offen sc1
    v_bfe_u32 v10, v0, 4, 4
    v_mov_b32 v11, 0x3f80
    v_mov_b32 v40, 0x3f800000
    v_cmp_eq_u32 vcc, 0, v10
    v_cmp_eq_u32 s[48:49], 1, v10
    s_nop 0
    v_cndmask_b32 v36, 0, v11, vcc
    v_cndmask_b32 v36, v36, v40, s[48:49]
    v_cmp_eq_u32 vcc, 2, v10
    v_cmp_eq_u32 s[48:49], 3, v10
    s_nop 0
    v_cndmask_b32 v37, 0, v11, vcc
    v_cndmask_b32 v37, v37, v40, s[48:49]
    v_cmp_eq_u32 vcc, 4, v10
    v_cmp_eq_u32 s[48:49], 5, v10
    s_nop 0
    v_cndmask_b32 v38, 0, v11, vcc
    v_cndmask_b32 v38, v38, v40, s[48:49]
    v_cmp_eq_u32 vcc, 6, v10
    v_cmp_eq_u32 s[48:49], 7, v10
    s_nop 0
    v_cndmask_b32 v39, 0, v11, vcc
    v_cndmask_b32 v39, v39, v40, s[48:49]
    s_mov_b32 s16, 0
    s_mov_b64 s[70:71], 0
    s_mov_b64 s[72:73], 0
    s_mov_b64 s[74:75], 0
    s_mov_b64 s[76:77], 0
Lr1f_p1:
    s_mov_b64 exec, s[70:71]
    buffer_load_dwordx4 v[52:55], v6, s[8:11], s57 offen sc1
    s_mov_b64 exec, s[72:73]
    buffer_load_dwordx4 v[56:59], v6, s[8:11], s58 offen sc1
    s_mov_b64 exec, s[74:75]
    buffer_load_dwordx4 v[60:63], v6, s[8:11], s59 offen sc1
    s_mov_b64 exec, s[76:77]
    buffer_load_dwordx4 v[64:67], v6, s[8:11], s60 offen sc1
    s_mov_b64 exec, -1
    s_add_u32 s16, s16, 1
    s_cmp_gt_u32 s16, 100000
    s_cbranch_scc1 Lr_abort
    s_waitcnt vmcnt(7)
    v_and_b32 v11, 1, v52
    v_cmp_ne_u32 s[70:71], s39, v11
    v_mfma_f32_16x16x32_bf16 v[40:43], v[52:55], v[36:39], 0
    s_waitcnt vmcnt(6)
    v_and_b32 v11, 1, v56
    v_cmp_ne_u32 s[72:73], s39, v11
    v_mfma_f32_16x16x32_bf16 v[40:43], v[56:59], v[36:39], v[40:43]
    s_waitcnt vmcnt(5)
    v_and_b32 v11, 1, v60
    v_cmp_ne_u32 s[74:75], s39, v11
    v_mfma_f32_16x16x32_bf16 v[40:43], v[60:63], v[36:39], v[40:43]
    s_or_b64 vcc, s[70:71], s[72:73]
    s_waitcnt vmcnt(4)
    v_and_b32 v11, 1, v64
    v_cmp_ne_u32 s[76:77], s39, v11
    v_mfma_f32_16x16x32_bf16 v[40:43], v[64:67], v[36:39], v[40:43]
    s_or_b64 vcc, vcc, s[74:75]
    s_or_b64 vcc, vcc, s[76:77]
    s_cbranch_scc1 Lr1f_p1
    s_nop 4
    v_permlane16_swap_b32 v40, v42
    v_permlane16_swap_b32 v41, v43
    s_mov_b64 exec, s[50:51]
    v_add_f32 v40, v40, v42
    v_add_f32 v41, v41, v43
    v_cvt_pk_bf16_f32 v40, v40, v41
    v_min_u32 v40, s54, v40
    buffer_store_dword v40, v7, s[8:11], s36 offen
    v_mov_b32 v41, -1
    buffer_store_dword v41, v7, s[8:11], s37 offen
    s_mov_b64 exec, -1
    s_xor_b32 s34, s34, 16384
    s_xor_b32 s35, s35, 16384
    s_barrier
    s_sleep 2
    buffer_load_dwordx4 v[44:47], v0, s[8:11], s34 offen sc1
    buffer_load_dwordx4 v[48:51], v0, s[8:11], s34 offen offset:1024 sc1
    buffer_load_dword v10, v8, s[8:11], s35 offen sc1
    s_add_u32 s33, s33, 1
    s_bfe_u32 s39, s33, 0x10001
    s_xor_b32 s38, s38, 524288
    s_xor_b32 s57, s57, 524288
    s_xor_b32 s58, s58, 524288
    s_xor_b32 s59, s59, 524288
    s_xor_b32 s60, s60, 524288
    s_xor_b32 s36, s36, 16384
    s_xor_b32 s37, s37, 16384
    s_and_b32 s17, s33, 7
    s_mul_i32 s17, s17, 131072
    s_add_u32 s43, s45, s17
    s_bfe_u32 s66, s33, 65539
    s_add_u32 s67, s67, 22528
    s_add_u32 s42, s42, 262144
    s_add_u32 s41, s41, 262144
    s_add_u32 s40, s40, 262144
    s_add_u32 s44, s44, 22528
    s_waitcnt vmcnt(5)
    ds_read_b128 v[56:59], v9 offset:4096
    ds_read_b128 v[60:63], v9 offset:5120
    ds_read_b128 v[64:67], v9 offset:6144
    ds_read_b128 v[68:71], v9 offset:7168
    v_mov_b64 v[12:13], 0
    v_mov_b64 v[14:15], 0
    v_mov_b64 v[16:17], 0
    v_mov_b64 v[18:19], 0
    v_mov_b64 v[20:21], 0
    v_mov_b64 v[22:23], 0
    v_mov_b64 v[24:25], 0
    v_mov_b64 v[26:27], 0
    v_mov_b64 v[28:29], 0
    v_mov_b64 v[30:31], 0
    v_mov_b64 v[32:33], 0
    v_mov_b64 v[34:35], 0
    s_waitcnt lgkmcnt(0)
    s_branch Lr1f_step
Lr1f_last:
    s_waitcnt vmcnt(0) lgkmcnt(0)
    s_branch Lr_exit
L_w2_1:
    s_cmp_lg_u32 s14, 2
    s_cbranch_scc1 L_w3_1
    s_barrier
    s_mov_b32 m0, 13312
    s_nop 0
    buffer_load_dwordx4 v0, s[8:11], s41 offen offset:0 lds
    buffer_load_dwordx4 v0, s[8:11], s41 offen offset:1024 lds
    s_add_u32 s41, s41, 262144
    s_waitcnt vmcnt(0)
    buffer_load_dwordx4 v[44:47], v0, s[8:11], s34 offen sc1
    buffer_load_dwordx4 v[48:51], v0, s[8:11], s34 offen offset:1024 sc1
    buffer_load_dword v10, v8, s[8:11], s35 offen sc1
    ds_read_b128 v[56:59], v9 offset:8192
    ds_read_b128 v[60:63], v9 offset:9216
    ds_read_b128 v[64:67], v9 offset:10240
    ds_read_b128 v[68:71], v9 offset:11264
    v_mov_b64 v[12:13], 0
    v_mov_b64 v[14:15], 0
    v_mov_b64 v[16:17], 0
    v_mov_b64 v[18:19], 0
    v_mov_b64 v[20:21], 0
    v_mov_b64 v[22:23], 0
    v_mov_b64 v[24:25], 0
    v_mov_b64 v[26:27], 0
    v_mov_b64 v[28:29], 0
    v_mov_b64 v[30:31], 0
    v_mov_b64 v[32:33], 0
    v_mov_b64 v[34:35], 0
    s_waitcnt lgkmcnt(0)
Lr2f_step:
    s_mov_b32 s16, 0
    s_mov_b64 s[70:71], 0
    s_mov_b64 s[72:73], 0
    s_mov_b64 s[74:75], 0
Lr2f_p2:
    s_mov_b64 exec, s[70:71]
    buffer_load_dwordx4 v[44:47], v0, s[8:11], s34 offen sc1
    s_mov_b64 exec, s[72:73]
    buffer_load_dwordx4 v[48:51], v0, s[8:11], s34 offen offset:1024 sc1
    s_mov_b64 exec, s[74:75]
    buffer_load_dword v10, v8, s[8:11], s35 offen sc1
    s_mov_b64 exec, -1
    s_add_u32 s16, s16, 1
    s_cmp_gt_u32 s16, 100000
    s_cbranch_scc1 Lr_abort
    s_waitcnt vmcnt(5)
    v_max3_u32 v11, v44, v45, v46
    v_max_u32 v11, v11, v47
    v_cmp_eq_u32 s[70:71], -1, v11
    s_waitcnt vmcnt(4)
    v_max3_u32 v11, v48, v49, v50
    v_max_u32 v11, v11, v51
    v_cmp_eq_u32 s[72:73], -1, v11
    s_waitcnt vmcnt(3)
    v_cmp_eq_u32 s[74:75], -1, v10
    s_or_b64 vcc, s[70:71], s[72:73]
    s_or_b64 vcc, vcc, s[74:75]
    s_cbranch_scc1 Lr2f_p2
    v_smfmac_f32_16x16x64_bf16 v[12:15], v[44:47], v[232:239], v1
    ds_write_b128 v0, v[44:47] offset:4096
    v_smfmac_f32_16x16x64_bf16 v[16:19], v[44:47], v[240:247], v1
    ds_write_b128 v0, v[48:51] offset:5120
    v_smfmac_f32_16x16x64_bf16 v[20:23], v[44:47], v[248:255], v1
    ds_write_b32 v8, v10 offset:8704
    v_smfmac_f32_16x16x64_bf16 v[24:27], v[44:47], v[56:63], v1
    s_waitcnt lgkmcnt(0)
    s_barrier
    ds_read_b128 v[52:55], v0 offset:0
    v_smfmac_f32_16x16x64_bf16 v[12:15], v[48:51], a[16:23], v1
    ds_read_b128 v[36:39], v0 offset:1024
    v_smfmac_f32_16x16x64_bf16 v[16:19], v[48:51], a[24:31], v1
    ds_read_b128 v[56:59], v9 offset:0
    v_smfmac_f32_16x16x64_bf16 v[20:23], v[48:51], a[32:39], v1
    ds_read_b128 v[60:63], v9 offset:1024
    v_smfmac_f32_16x16x64_bf16 v[24:27], v[48:51], v[64:71], v1
    ds_read_b128 v[40:43], v0 offset:2048
    s_waitcnt lgkmcnt(4)
    v_smfmac_f32_16x16x64_bf16 v[12:15], v[52:55], v[72:79], v1
    v_smfmac_f32_16x16x64_bf16 v[16:19], v[52:55], v[80:87], v1
    ds_read_b128 v[64:67], v9 offset:2048
    v_smfmac_f32_16x16x64_bf16 v[20:23], v[52:55], v[88:95], v1
    ds_read_b128 v[68:71], v9 offset:3072
    s_waitcnt lgkmcnt(3)
    v_smfmac_f32_16x16x64_bf16 v[24:27], v[52:55], v[56:63], v1
    v_smfmac_f32_16x16x64_bf16 v[12:15], v[36:39], v[112:119], v1
    ds_read_b128 v[52:55], v0 offset:3072
    v_smfmac_f32_16x16x64_bf16 v[16:19], v[36:39], v[120:127], v1
    ds_read_b128 v[56:59], v9 offset:4096
    v_smfmac_f32_16x16x64_bf16 v[20:23], v[36:39], v[128:135], v1
    ds_read_b128 v[60:63], v9 offset:5120
    s_waitcnt lgkmcnt(3)
    v_smfmac_f32_16x16x64_bf16 v[24:27], v[36:39], v[64:71], v1
    v_smfmac_f32_16x16x64_bf16 v[12:15], v[40:43], v[152:159], v1
    buffer_load_dwordx4 v[36:39], v0, s[8:11], s42 offen
    v_smfmac_f32_16x16x64_bf16 v[16:19], v[40:43], v[160:167], v1
    ds_read_b128 v[64:67], v9 offset:6144
    v_smfmac_f32_16x16x64_bf16 v[20:23], v[40:43], v[168:175], v1
    ds_read_b128 v[68:71], v9 offset:7168
    s_waitcnt lgkmcnt(2)
    v_smfmac_f32_16x16x64_bf16 v[24:27], v[40:43], v[56:63], v1
    s_waitcnt vmcnt(1)
    ds_read_b128 v[44:47], v0 offset:6144
    v_smfmac_f32_16x16x64_bf16 v[12:15], v[52:55], v[192:199], v1
    buffer_load_dwordx4 v[40:43], v0, s[8:11], s42 offen offset:1024
    v_smfmac_f32_16x16x64_bf16 v[16:19], v[52:55], v[200:207], v1
    ds_read_b128 v[56:59], v9 offset:12288
    v_smfmac_f32_16x16x64_bf16 v[20:23], v[52:55], v[208:215], v1
    ds_read_b128 v[60:63], v9 offset:13312
    s_waitcnt lgkmcnt(3)
    v_smfmac_f32_16x16x64_bf16 v[24:27], v[52:55], v[64:71], v1
    ds_read_b128 v[48:51], v0 offset:7168
    s_waitcnt lgkmcnt(3)
    v_smfmac_f32_16x16x64_bf16 v[12:15], v[44:47], a[56:63], v1
    ds_read_b128 v[52:55], v0 offset:8192
    v_smfmac_f32_16x16x64_bf16 v[16:19], v[44:47], a[64:71], v1
    ds_read_b128 v[64:67], v9 offset:14336
    v_smfmac_f32_16x16x64_bf16 v[20:23], v[44:47], a[72:79], v1
    ds_read_b128 v[68:71], v9 offset:15360
    s_waitcnt lgkmcnt(4)
    v_smfmac_f32_16x16x64_bf16 v[24:27], v[44:47], v[56:63], v1
    s_waitcnt lgkmcnt(3)
    v_smfmac_f32_16x16x64_bf16 v[12:15], v[48:51], a[96:103], v1
    v_smfmac_f32_16x16x64_bf16 v[16:19], v[48:51], a[104:111], v1
    ds_read_b128 v[56:59], v9 offset:16384
    s_waitcnt lgkmcnt(3)
    v_smfmac_f32_16x16x64_bf16 v[12:15], v[52:55], a[136:143], v1
    ds_read_b128 v[60:63], v9 offset:17408
    v_smfmac_f32_16x16x64_bf16 v[16:19], v[52:55], a[144:151], v1
    v_smfmac_f32_16x16x64_bf16 v[20:23], v[48:51], a[112:119], v1
    s_waitcnt lgkmcnt(2)
    v_smfmac_f32_16x16x64_bf16 v[24:27], v[48:51], v[64:71], v1
    ds_read_b128 v[64:67], v0 offset:9216
    s_nop 1
    v_add_f32 v12, v12, v14
    v_smfmac_f32_16x16x64_bf16 v[20:23], v[52:55], a[152:159], v1
    ds_read_b128 v[68:71], v0 offset:10240
    v_add_f32 v16, v16, v18
    s_waitcnt lgkmcnt(2)
    v_smfmac_f32_16x16x64_bf16 v[24:27], v[52:55], v[56:63], v1
    ds_read_b128 v[56:59], v0 offset:11264
    v_add_f32 v13, v13, v15
    v_add_f32 v17, v17, v19
    v_cvt_pk_bf16_f32 v14, v12, v16
    v_cvt_pk_bf16_f32 v15, v13, v17
    ds_write_b32 v2, v14 offset:17408
    ds_write_b32 v2, v15 offset:17696
    v_smfmac_f32_16x16x64_bf16 v[28:31], v[52:55], a[160:167], v1
    ds_read_b128 v[60:63], v0 offset:12288
    v_add_f32 v20, v20, v22
    v_add_f32 v24, v24, v26
    v_add_f32 v21, v21, v23
    v_add_f32 v25, v25, v27
    v_smfmac_f32_16x16x64_bf16 v[32:35], v[52:55], a[168:175], v1
    ds_read_b128 v[12:15], v0 offset:4096
    v_cvt_pk_bf16_f32 v22, v20, v24
    v_cvt_pk_bf16_f32 v23, v21, v25
    ds_write_b32 v2, v22 offset:19712
    ds_write_b32 v2, v23 offset:20000
    v_smfmac_f32_16x16x64_bf16 v[28:31], v[48:51], a[120:127], v1
    ds_read_b128 v[16:19], v0 offset:5120
    v_smfmac_f32_16x16x64_bf16 v[32:35], v[48:51], a[128:135], v1
    ds_read_b128 v[20:23], v0 offset:0
    v_smfmac_f32_16x16x64_bf16 v[28:31], v[44:47], a[80:87], v1
    ds_read_b128 v[24:27], v0 offset:1024
    v_smfmac_f32_16x16x64_bf16 v[32:35], v[44:47], a[88:95], v1
    s_waitcnt lgkmcnt(3)
    s_barrier
    ds_read_b128 v[44:47], v3 offset:17408
    v_smfmac_f32_16x16x64_bf16 v[28:31], v[12:15], a[0:7], v1
    ds_read_b128 v[52:55], v0 offset:2048
    v_smfmac_f32_16x16x64_bf16 v[32:35], v[12:15], a[8:15], v1
    ds_read_b128 v[12:15], v3 offset:19712
    s_waitcnt lgkmcnt(5)
    v_smfmac_f32_16x16x64_bf16 v[28:31], v[16:19], a[40:47], v1
    ds_read_b128 v[48:51], v0 offset:3072
    v_smfmac_f32_16x16x64_bf16 v[32:35], v[16:19], a[48:55], v1
    s_waitcnt lgkmcnt(5)
    v_smfmac_f32_16x16x64_bf16 v[28:31], v[20:23], v[96:103], v1
    v_smfmac_f32_16x16x64_bf16 v[32:35], v[20:23], v[104:111], v1
    ds_read_b128 v[20:23], v3 offset:17472
    s_waitcnt lgkmcnt(5)
    v_smfmac_f32_16x16x64_bf16 v[28:31], v[24:27], v[136:143], v1
    v_smfmac_f32_16x16x64_bf16 v[32:35], v[24:27], v[144:151], v1
    s_waitcnt lgkmcnt(3)
    v_smfmac_f32_16x16x64_bf16 v[28:31], v[52:55], v[176:183], v1
    v_smfmac_f32_16x16x64_bf16 v[32:35], v[52:55], v[184:191], v1
    ds_read_b128 v[52:55], v3 offset:19776
    s_waitcnt lgkmcnt(2)
    v_smfmac_f32_16x16x64_bf16 v[28:31], v[48:51], v[216:223], v1
    v_smfmac_f32_16x16x64_bf16 v[32:35], v[48:51], v[224:231], v1
    ds_read_b128 v[48:51], v3 offset:17536
    v_mfma_f32_16x16x32_bf16 v[24:27], v[12:15], v[44:47], 0
    v_mfma_f32_16x16x32_bf16 v[12:15], v[64:67], v[44:47], 0
    ds_read_b128 v[64:67], v0 offset:13312
    v_mfma_f32_16x16x32_bf16 v[16:19], v[68:71], v[44:47], 0
    ds_read_b128 v[68:71], v0 offset:14336
    s_waitcnt lgkmcnt(3)
    v_mfma_f32_16x16x32_bf16 v[24:27], v[52:55], v[20:23], v[24:27]
    ds_read_b128 v[44:47], v3 offset:19840
    v_add_f32 v28, v28, v30
    v_add_f32 v29, v29, v31
    v_mfma_f32_16x16x32_bf16 v[12:15], v[56:59], v[20:23], v[12:15]
    ds_read_b128 v[52:55], v3 offset:17600
    v_add_f32 v32, v32, v34
    v_add_f32 v33, v33, v35
    v_mfma_f32_16x16x32_bf16 v[16:19], v[60:63], v[20:23], v[16:19]
    ds_read_b128 v[56:59], v0 offset:15360
    v_cvt_pk_bf16_f32 v30, v28, v29
    v_cvt_pk_bf16_f32 v31, v32, v33
    s_waitcnt lgkmcnt(2)
    v_mfma_f32_16x16x32_bf16 v[24:27], v[44:47], v[48:51], v[24:27]
    ds_read_b128 v[20:23], v3 offset:19904
    v_lshrrev_b32 v10, 8, v0
    v_mul_u32_u24 v10, 288, v10
    v_mfma_f32_16x16x32_bf16 v[12:15], v[64:67], v[48:51], v[12:15]
    ds_read_b128 v[60:63], v0 offset:16384
    v_and_b32 v11, 0xf0, v0
    v_add_u32 v10, v10, v11
    v_mfma_f32_16x16x32_bf16 v[16:19], v[68:71], v[48:51], v[16:19]
    ds_read_b128 v[32:35], v10 offset:20864
    v_lshrrev_b32 v11, 1, v0
    v_bfi_b32 v30, 1, s66, v30
    s_waitcnt lgkmcnt(2)
    v_mfma_f32_16x16x32_bf16 v[24:27], v[20:23], v[52:55], v[24:27]
    buffer_store_dwordx2 v[30:31], v11, s[8:11], s43 offen offset:2048 sc1
    v_mov_b32 v49, 0
    v_mov_b32 v50, 0
    v_mfma_f32_16x16x32_bf16 v[12:15], v[56:59], v[52:55], v[12:15]
    v_mov_b64 v[64:65], s[68:69]
    v_mov_b64 v[66:67], s[68:69]
    s_waitcnt lgkmcnt(1)
    v_mfma_f32_16x16x32_bf16 v[16:19], v[60:63], v[52:55], v[16:19]
    s_waitcnt lgkmcnt(0)
    v_bfi_b32 v32, 1, s66, v32
    s_mov_b64 exec, s[52:53]
    buffer_store_dwordx4 v[32:35], v0, s[8:11], s43 offen sc1
    s_mov_b64 exec, -1
    v_max3_f32 v10, v24, v25, v12
    v_max3_f32 v10, v10, v13, v14
    s_nop 0
    v_max3_f32 v10, v10, v15, v16
    v_max3_f32 v10, v10, v17, v18
    v_max_f32 v10, v10, v19
    v_mov_b32 v11, v10
    s_nop 1
    v_permlane32_swap_b32 v10, v11
    v_max_f32 v10, v10, v11
    v_mov_b32 v11, v10
    s_nop 1
    v_permlane16_swap_b32 v10, v11
    v_max_f32 v10, v10, v11
    v_mul_f32 v20, s46, v10
    v_pk_fma_f32 v[24:25], v[24:25], s[46:47], v[20:21] op_sel_hi:[1,1,0] neg_lo:[0,0,1] neg_hi:[0,0,1]
    v_pk_fma_f32 v[12:13], v[12:13], s[46:47], v[20:21] op_sel_hi:[1,1,0] neg_lo:[0,0,1] neg_hi:[0,0,1]
    v_exp_f32 v24, v24
    v_exp_f32 v25, v25
    v_pk_fma_f32 v[14:15], v[14:15], s[46:47], v[20:21] op_sel_hi:[1,1,0] neg_lo:[0,0,1] neg_hi:[0,0,1]
    v_exp_f32 v12, v12
    v_exp_f32 v13, v13
    v_pk_fma_f32 v[16:17], v[16:17], s[46:47], v[20:21] op_sel_hi:[1,1,0] neg_lo:[0,0,1] neg_hi:[0,0,1]
    v_cvt_pk_bf16_f32 v48, v24, v25
    v_exp_f32 v14, v14
    v_pk_fma_f32 v[18:19], v[18:19], s[46:47], v[20:21] op_sel_hi:[1,1,0] neg_lo:[0,0,1] neg_hi:[0,0,1]
    v_cvt_pk_bf16_f32 v51, v24, v25
    v_exp_f32 v15, v15
    v_cvt_pk_bf16_f32 v44, v12, v13
    v_exp_f32 v16, v16
    v_exp_f32 v17, v17
    v_cvt_pk_bf16_f32 v45, v14, v15
    v_exp_f32 v18, v18
    v_exp_f32 v19, v19
    v_cvt_pk_bf16_f32 v46, v16, v17
    v_cvt_pk_bf16_f32 v47, v18, v19
    v_mfma_f32_16x16x16_bf16 v[68:71], v[64:65], v[48:49], 0
    v_mfma_f32_16x16x16_bf16 v[52:55], v[30:31], v[48:49], 0
    v_mfma_f32_16x16x16_bf16 v[56:59], v[30:31], v[50:51], 0
    v_mfma_f32_16x16x32_bf16 v[68:71], v[64:67], v[44:47], v[68:71]
    s_waitcnt vmcnt(3)
    v_mfma_f32_16x16x32_bf16 v[52:55], v[36:39], v[44:47], v[52:55]
    s_waitcnt vmcnt(2)
    v_mfma_f32_16x16x32_bf16 v[56:59], v[40:43], v[44:47], v[56:59]
    ds_read_b128 v[36:39], v0 offset:47104
    ds_read_b128 v[40:43], v0 offset:48128
    ds_read_b128 v[60:63], v9 offset:24576
    s_nop 0
    v_rcp_f32 v10, v68
    s_nop 0
    v_pk_mul_f32 v[52:53], v[52:53], v[10:11] op_sel_hi:[1,0]
    s_nop 0
    v_pk_mul_f32 v[56:57], v[56:57], v[10:11] op_sel_hi:[1,0]
    v_cvt_pk_bf16_f32 v16, v52, v56
    v_cvt_pk_bf16_f32 v17, v53, v57
    v_pk_mul_f32 v[54:55], v[54:55], v[10:11] op_sel_hi:[1,0]
    v_pk_mul_f32 v[58:59], v[58:59], v[10:11] op_sel_hi:[1,0]
    v_cvt_pk_bf16_f32 v18, v54, v58
    v_cvt_pk_bf16_f32 v19, v55, v59
    ds_write_b128 v3, v[16:19] offset:22144
    ds_read_b128 v[64:67], v9 offset:25600
    v_mov_b64 v[12:13], 0
    v_mov_b64 v[14:15], 0
    v_mov_b64 v[20:21], 0
    v_mov_b64 v[22:23], 0
    v_mov_b64 v[24:25], 0
    v_mov_b64 v[26:27], 0
    v_mov_b64 v[32:33], 0
    v_mov_b64 v[34:35], 0
    v_mov_b64 v[44:45], 0
    v_mov_b64 v[46:47], 0
    v_mov_b64 v[48:49], 0
    v_mov_b64 v[50:51], 0
    s_waitcnt lgkmcnt(1)
    s_barrier
    ds_read_b128 v[52:55], v4 offset:22016
    ds_read_b128 v[56:59], v4 offset:22144
    v_mov_b64 v[68:69], 0
    v_mov_b64 v[70:71], 0
    v_mov_b64 v[28:29], 0
    v_mov_b64 v[30:31], 0
    v_mov_b64 v[16:17], 0
    v_mov_b64 v[18:19], 0
    s_cmp_eq_u32 s33, 63
    s_cbranch_scc1 Lr2f_last
    s_waitcnt lgkmcnt(1)
    v_smfmac_f32_16x16x64_bf16 v[28:31], v[52:55], v[60:67], v1
    ds_read_b128 v[60:63], v0 offset:40960
    s_waitcnt lgkmcnt(1)
    v_smfmac_f32_16x16x64_bf16 v[28:31], v[56:59], v[36:43], v1
    ds_read_b128 v[64:67], v0 offset:41984
    ds_read_b128 v[36:39], v9 offset:18432
    v_smfmac_f32_16x16x64_bf16 v[12:15], v[52:55], a[176:183], v1
    ds_read_b128 v[40:43], v9 offset:19456
    v_smfmac_f32_16x16x64_bf16 v[12:15], v[56:59], a[184:191], v1
    buffer_load_dwordx4 v0, s[8:11], s41 offen offset:0 lds
    v_smfmac_f32_16x16x64_bf16 v[20:23], v[52:55], a[192:199], v1
    s_nop 0
    v_add_f32 v28, v28, v30
    v_add_f32 v29, v29, v31
    s_waitcnt lgkmcnt(2)
    v_smfmac_f32_16x16x64_bf16 v[20:23], v[56:59], v[60:67], v1
    ds_read_b128 v[60:63], v9 offset:20480
    v_cvt_pk_bf16_f32 v28, v28, v29
    v_bfi_b32 v28, 1, s39, v28
    buffer_store_dword v28, v8, s[8:11], s38 offen offset:2048
    s_waitcnt lgkmcnt(1)
    v_smfmac_f32_16x16x64_bf16 v[24:27], v[52:55], v[36:43], v1
    ds_read_b128 v[64:67], v9 offset:21504
    ds_read_b128 v[36:39], v0 offset:43008
    v_add_f32 v12, v12, v14
    v_add_f32 v13, v13, v15
    v_smfmac_f32_16x16x64_bf16 v[24:27], v[56:59], a[200:207], v1
    ds_read_b128 v[40:43], v0 offset:44032
    v_cvt_pk_bf16_f32 v12, v12, v13
    v_bfi_b32 v12, 1, s39, v12
    v_smfmac_f32_16x16x64_bf16 v[32:35], v[52:55], a[208:215], v1
    buffer_load_dwordx4 v0, s[8:11], s41 offen offset:1024 lds
    v_add_f32 v20, v20, v22
    v_add_f32 v21, v21, v23
    v_smfmac_f32_16x16x64_bf16 v[32:35], v[56:59], a[216:223], v1
    v_cvt_pk_bf16_f32 v13, v20, v21
    s_waitcnt lgkmcnt(2)
    v_smfmac_f32_16x16x64_bf16 v[44:47], v[52:55], v[60:67], v1
    ds_read_b128 v[60:63], v0 offset:45056
    v_add_f32 v24, v24, v26
    v_add_f32 v25, v25, v27
    s_waitcnt lgkmcnt(1)
    v_smfmac_f32_16x16x64_bf16 v[44:47], v[56:59], v[36:43], v1
    ds_read_b128 v[64:67], v0 offset:46080
    ds_read_b128 v[36:39], v9 offset:22528
    v_cvt_pk_bf16_f32 v14, v24, v25
    v_smfmac_f32_16x16x64_bf16 v[48:51], v[52:55], a[224:231], v1
    ds_read_b128 v[40:43], v9 offset:23552
    v_add_f32 v32, v32, v34
    v_add_f32 v33, v33, v35
    v_smfmac_f32_16x16x64_bf16 v[48:51], v[56:59], a[232:239], v1
    v_cvt_pk_bf16_f32 v15, v32, v33
    buffer_store_dwordx4 v[12:15], v0, s[8:11], s38 offen offset:0
    v_smfmac_f32_16x16x64_bf16 v[68:71], v[52:55], a[240:247], v1
    v_add_f32 v44, v44, v46
    v_add_f32 v45, v45, v47
    s_waitcnt lgkmcnt(2)
    v_smfmac_f32_16x16x64_bf16 v[68:71], v[56:59], v[60:67], v1
    v_cvt_pk_bf16_f32 v44, v44, v45
    v_bfi_b32 v44, 1, s39, v44
    s_waitcnt lgkmcnt(0)
    v_smfmac_f32_16x16x64_bf16 v[16:19], v[52:55], v[36:43], v1
    v_add_f32 v48, v48, v50
    v_add_f32 v49, v49, v51
    v_smfmac_f32_16x16x64_bf16 v[16:19], v[56:59], a[248:255], v1
    v_cvt_pk_bf16_f32 v45, v48, v49
    v_add_f32 v68, v68, v70
    v_add_f32 v69, v69, v71
    v_cvt_pk_bf16_f32 v46, v68, v69
    s_nop 3
    v_add_f32 v16, v16, v18
    v_add_f32 v17, v17, v19
    v_cvt_pk_bf16_f32 v47, v16, v17
    buffer_store_dwordx4 v[44:47], v0, s[8:11], s38 offen offset:1024
    s_cmp_eq_u32 s62, 0
    s_cbranch_scc1 Lr2f_nojob
    s_sleep 6
    buffer_load_dwordx4 v[52:55], v6, s[8:11], s57 offen sc1
    buffer_load_dwordx4 v[56:59], v6, s[8:11], s58 offen sc1
    buffer_load_dwordx4 v[60:63], v6, s[8:11], s59 offen sc1
    buffer_load_dwordx4 v[64:67], v6, s[8:11], s60 offen sc1
    v_bfe_u32 v10, v0, 4, 4
    v_mov_b32 v11, 0x3f80
    v_mov_b32 v40, 0x3f800000
    v_cmp_eq_u32 vcc, 0, v10
    v_cmp_eq_u32 s[48:49], 1, v10
    s_nop 0
    v_cndmask_b32 v36, 0, v11, vcc
    v_cndmask_b32 v36, v36, v40, s[48:49]
    v_cmp_eq_u32 vcc, 2, v10
    v_cmp_eq_u32 s[48:49], 3, v10
    s_nop 0
    v_cndmask_b32 v37, 0, v11, vcc
    v_cndmask_b32 v37, v37, v40, s[48:49]
    v_cmp_eq_u32 vcc, 4, v10
    v_cmp_eq_u32 s[48:49], 5, v10
    s_nop 0
    v_cndmask_b32 v38, 0, v11, vcc
    v_cndmask_b32 v38, v38, v40, s[48:49]
    v_cmp_eq_u32 vcc, 6, v10
    v_cmp_eq_u32 s[48:49], 7, v10
    s_nop 0
    v_cndmask_b32 v39, 0, v11, vcc
    v_cndmask_b32 v39, v39, v40, s[48:49]
    s_mov_b32 s16, 0
    s_mov_b64 s[70:71], 0
    s_mov_b64 s[72:73], 0
    s_mov_b64 s[74:75], 0
    s_mov_b64 s[76:77], 0
Lr2f_p1:
    s_mov_b64 exec, s[70:71]
    buffer_load_dwordx4 v[52:55], v6, s[8:11], s57 offen sc1
    s_mov_b64 exec, s[72:73]
    buffer_load_dwordx4 v[56:59], v6, s[8:11], s58 offen sc1
    s_mov_b64 exec, s[74:75]
    buffer_load_dwordx4 v[60:63], v6, s[8:11], s59 offen sc1
    s_mov_b64 exec, s[76:77]
    buffer_load_dwordx4 v[64:67], v6, s[8:11], s60 offen sc1
    s_mov_b64 exec, -1
    s_add_u32 s16, s16, 1
    s_cmp_gt_u32 s16, 100000
    s_cbranch_scc1 Lr_abort
    s_waitcnt vmcnt(7)
    v_xor_b32 v10, v52, v53
    v_xor_b32 v11, v54, v55
    v_or_b32 v10, v10, v11
    v_xor_b32 v11, v52, v54
    v_or_b32 v10, v10, v11
    v_xor_b32 v11, s39, v52
    v_or_b32 v10, v10, v11
    v_and_b32 v10, 1, v10
    v_cmp_ne_u32 s[70:71], 0, v10
    v_mfma_f32_16x16x32_bf16 v[40:43], v[52:55], v[36:39], 0
    s_waitcnt vmcnt(6)
    v_xor_b32 v10, v56, v57
    v_xor_b32 v11, v58, v59
    v_or_b32 v10, v10, v11
    v_xor_b32 v11, v56, v58
    v_or_b32 v10, v10, v11
    v_xor_b32 v11, s39, v56
    v_or_b32 v10, v10, v11
    v_and_b32 v10, 1, v10
    v_cmp_ne_u32 s[72:73], 0, v10
    v_mfma_f32_16x16x32_bf16 v[40:43], v[56:59], v[36:39], v[40:43]
    s_waitcnt vmcnt(5)
    v_xor_b32 v10, v60, v61
    v_xor_b32 v11, v62, v63
    v_or_b32 v10, v10, v11
    v_xor_b32 v11, v60, v62
    v_or_b32 v10, v10, v11
    v_xor_b32 v11, s39, v60
    v_or_b32 v10, v10, v11
    v_and_b32 v10, 1, v10
    v_cmp_ne_u32 s[74:75], 0, v10
    v_mfma_f32_16x16x32_bf16 v[40:43], v[60:63], v[36:39], v[40:43]
    s_or_b64 vcc, s[70:71], s[72:73]
    s_waitcnt vmcnt(4)
    v_xor_b32 v10, v64, v65
    v_xor_b32 v11, v66, v67
    v_or_b32 v10, v10, v11
    v_xor_b32 v11, v64, v66
    v_or_b32 v10, v10, v11
    v_xor_b32 v11, s39, v64
    v_or_b32 v10, v10, v11
    v_and_b32 v10, 1, v10
    v_cmp_ne_u32 s[76:77], 0, v10
    v_mfma_f32_16x16x32_bf16 v[40:43], v[64:67], v[36:39], v[40:43]
    s_or_b64 vcc, vcc, s[74:75]
    s_or_b64 vcc, vcc, s[76:77]
    s_cbranch_scc1 Lr2f_p1
    s_nop 4
    v_permlane16_swap_b32 v40, v42
    v_permlane16_swap_b32 v41, v43
    s_mov_b64 exec, s[50:51]
    v_add_f32 v40, v40, v42
    v_add_f32 v41, v41, v43
    v_cvt_pk_bf16_f32 v40, v40, v41
    v_min_u32 v40, s54, v40
    buffer_store_dword v40, v7, s[8:11], s36 offen
    v_mov_b32 v41, -1
    buffer_store_dword v41, v7, s[8:11], s37 offen
    s_mov_b64 exec, -1
    s_branch Lr2f_jobdone
Lr2f_nojob:
Lr2f_jobdone:
    s_xor_b32 s34, s34, 16384
    s_xor_b32 s35, s35, 16384
    s_barrier
    s_sleep 2
    buffer_load_dwordx4 v[44:47], v0, s[8:11], s34 offen sc1
    buffer_load_dwordx4 v[48:51], v0, s[8:11], s34 offen offset:1024 sc1
    buffer_load_dword v10, v8, s[8:11], s35 offen sc1
    s_add_u32 s33, s33, 1
    s_bfe_u32 s39, s33, 0x10001
    s_xor_b32 s38, s38, 524288
    s_xor_b32 s57, s57, 524288
    s_xor_b32 s58, s58, 524288
    s_xor_b32 s59, s59, 524288
    s_xor_b32 s60, s60, 524288
    s_xor_b32 s36, s36, 16384
    s_xor_b32 s37, s37, 16384
    s_and_b32 s17, s33, 7
    s_mul_i32 s17, s17, 131072
    s_add_u32 s43, s45, s17
    s_bfe_u32 s66, s33, 65539
    s_add_u32 s67, s67, 22528
    s_add_u32 s42, s42, 262144
    s_add_u32 s41, s41, 262144
    s_add_u32 s40, s40, 262144
    s_add_u32 s44, s44, 22528
    s_waitcnt vmcnt(6)
    ds_read_b128 v[56:59], v9 offset:8192
    ds_read_b128 v[60:63], v9 offset:9216
    ds_read_b128 v[64:67], v9 offset:10240
    ds_read_b128 v[68:71], v9 offset:11264
    v_mov_b64 v[12:13], 0
    v_mov_b64 v[14:15], 0
    v_mov_b64 v[16:17], 0
    v_mov_b64 v[18:19], 0
    v_mov_b64 v[20:21], 0
    v_mov_b64 v[22:23], 0
    v_mov_b64 v[24:25], 0
    v_mov_b64 v[26:27], 0
    v_mov_b64 v[28:29], 0
    v_mov_b64 v[30:31], 0
    v_mov_b64 v[32:33], 0
    v_mov_b64 v[34:35], 0
    s_waitcnt lgkmcnt(0)
    s_branch Lr2f_step
Lr2f_last:
    s_waitcnt vmcnt(0) lgkmcnt(0)
    s_branch Lr_exit
L_w3_1:
    s_mov_b32 s16, 0
    s_add_u32 s17, s44, 128
    v_and_b32 v11, 16, v8
    v_lshlrev_b32 v11, 3, v11
    v_and_or_b32 v11, v8, 12, v11
Lr3f_fw_10:
    buffer_load_dword v10, v11, s[8:11], s17 offen sc1
    s_add_u32 s16, s16, 1
    s_cmp_gt_u32 s16, 100000
    s_cbranch_scc1 Lr_abort
    s_waitcnt vmcnt(0)
    v_cmp_eq_u32 vcc, 0, v10
    s_nop 0
    s_cbranch_vccz Lr3f_fw_10d
    s_sleep 4
    s_branch Lr3f_fw_10
Lr3f_fw_10d:
    s_barrier
    s_mov_b32 m0, 15360
    s_nop 0
    buffer_load_dwordx4 v0, s[8:11], s41 offen offset:0 lds
    buffer_load_dwordx4 v0, s[8:11], s41 offen offset:1024 lds
    s_add_u32 s41, s41, 262144
    s_waitcnt vmcnt(0)
    buffer_load_dwordx4 v[44:47], v0, s[8:11], s34 offen sc1
    buffer_load_dwordx4 v[48:51], v0, s[8:11], s34 offen offset:1024 sc1
    buffer_load_dword v10, v8, s[8:11], s35 offen sc1
    ds_read_b128 v[56:59], v9 offset:12288
    ds_read_b128 v[60:63], v9 offset:13312
    ds_read_b128 v[64:67], v9 offset:14336
    ds_read_b128 v[68:71], v9 offset:15360
    v_mov_b64 v[12:13], 0
    v_mov_b64 v[14:15], 0
    v_mov_b64 v[16:17], 0
    v_mov_b64 v[18:19], 0
    v_mov_b64 v[20:21], 0
    v_mov_b64 v[22:23], 0
    v_mov_b64 v[24:25], 0
    v_mov_b64 v[26:27], 0
    v_mov_b64 v[28:29], 0
    v_mov_b64 v[30:31], 0
    v_mov_b64 v[32:33], 0
    v_mov_b64 v[34:35], 0
    s_waitcnt lgkmcnt(0)
Lr3f_step:
    s_mov_b32 s16, 0
    s_mov_b64 s[70:71], 0
    s_mov_b64 s[72:73], 0
    s_mov_b64 s[74:75], 0
Lr3f_p2:
    s_mov_b64 exec, s[70:71]
    buffer_load_dwordx4 v[44:47], v0, s[8:11], s34 offen sc1
    s_mov_b64 exec, s[72:73]
    buffer_load_dwordx4 v[48:51], v0, s[8:11], s34 offen offset:1024 sc1
    s_mov_b64 exec, s[74:75]
    buffer_load_dword v10, v8, s[8:11], s35 offen sc1
    s_mov_b64 exec, -1
    s_add_u32 s16, s16, 1
    s_cmp_gt_u32 s16, 100000
    s_cbranch_scc1 Lr_abort
    s_waitcnt vmcnt(5)
    v_max3_u32 v11, v44, v45, v46
    v_max_u32 v11, v11, v47
    v_cmp_eq_u32 s[70:71], -1, v11
    s_waitcnt vmcnt(4)
    v_max3_u32 v11, v48, v49, v50
    v_max_u32 v11, v11, v51
    v_cmp_eq_u32 s[72:73], -1, v11
    s_waitcnt vmcnt(3)
    v_cmp_eq_u32 s[74:75], -1, v10
    s_or_b64 vcc, s[70:71], s[72:73]
    s_or_b64 vcc, vcc, s[74:75]
    s_cbranch_scc1 Lr3f_p2
    v_smfmac_f32_16x16x64_bf16 v[12:15], v[44:47], a[56:63], v1
    ds_write_b128 v0, v[44:47] offset:6144
    v_smfmac_f32_16x16x64_bf16 v[16:19], v[44:47], a[64:71], v1
    ds_write_b128 v0, v[48:51] offset:7168
    v_smfmac_f32_16x16x64_bf16 v[20:23], v[44:47], a[72:79], v1
    ds_write_b32 v8, v10 offset:8960
    v_smfmac_f32_16x16x64_bf16 v[24:27], v[44:47], v[56:63], v1
    s_waitcnt lgkmcnt(0)
    s_barrier
    ds_read_b128 v[52:55], v0 offset:0
    v_smfmac_f32_16x16x64_bf16 v[12:15], v[48:51], a[96:103], v1
    ds_read_b128 v[36:39], v0 offset:1024
    v_smfmac_f32_16x16x64_bf16 v[16:19], v[48:51], a[104:111], v1
    ds_read_b128 v[56:59], v9 offset:0
    v_smfmac_f32_16x16x64_bf16 v[20:23], v[48:51], a[112:119], v1
    ds_read_b128 v[60:63], v9 offset:1024
    v_smfmac_f32_16x16x64_bf16 v[24:27], v[48:51], v[64:71], v1
    ds_read_b128 v[40:43], v0 offset:2048
    s_waitcnt lgkmcnt(4)
    v_smfmac_f32_16x16x64_bf16 v[12:15], v[52:55], v[72:79], v1
    buffer_load_dword v6, v7, s[8:11], s67 offen sc1
    v_smfmac_f32_16x16x64_bf16 v[16:19], v[52:55], v[80:87], v1
    ds_read_b128 v[64:67], v9 offset:2048
    v_smfmac_f32_16x16x64_bf16 v[20:23], v[52:55], v[88:95], v1
    ds_read_b128 v[68:71], v9 offset:3072
    s_waitcnt lgkmcnt(3)
    v_smfmac_f32_16x16x64_bf16 v[24:27], v[52:55], v[56:63], v1
    v_smfmac_f32_16x16x64_bf16 v[12:15], v[36:39], v[112:119], v1
    ds_read_b128 v[52:55], v0 offset:3072
    v_smfmac_f32_16x16x64_bf16 v[16:19], v[36:39], v[120:127], v1
    ds_read_b128 v[56:59], v9 offset:4096
    v_smfmac_f32_16x16x64_bf16 v[20:23], v[36:39], v[128:135], v1
    ds_read_b128 v[60:63], v9 offset:5120
    s_waitcnt lgkmcnt(3)
    v_smfmac_f32_16x16x64_bf16 v[24:27], v[36:39], v[64:71], v1
    v_smfmac_f32_16x16x64_bf16 v[12:15], v[40:43], v[152:159], v1
    buffer_load_dwordx4 v[36:39], v0, s[8:11], s42 offen
    v_smfmac_f32_16x16x64_bf16 v[16:19], v[40:43], v[160:167], v1
    ds_read_b128 v[64:67], v9 offset:6144
    v_smfmac_f32_16x16x64_bf16 v[20:23], v[40:43], v[168:175], v1
    ds_read_b128 v[68:71], v9 offset:7168
    s_waitcnt lgkmcnt(2)
    v_smfmac_f32_16x16x64_bf16 v[24:27], v[40:43], v[56:63], v1
    s_waitcnt vmcnt(2)
    ds_read_b128 v[44:47], v0 offset:4096
    v_smfmac_f32_16x16x64_bf16 v[12:15], v[52:55], v[192:199], v1
    buffer_load_dwordx4 v[40:43], v0, s[8:11], s42 offen offset:1024
    v_smfmac_f32_16x16x64_bf16 v[16:19], v[52:55], v[200:207], v1
    ds_read_b128 v[56:59], v9 offset:8192
    v_smfmac_f32_16x16x64_bf16 v[20:23], v[52:55], v[208:215], v1
    ds_read_b128 v[60:63], v9 offset:9216
    s_waitcnt lgkmcnt(3)
    v_smfmac_f32_16x16x64_bf16 v[24:27], v[52:55], v[64:71], v1
    ds_read_b128 v[48:51], v0 offset:5120
    s_waitcnt lgkmcnt(3)
    v_smfmac_f32_16x16x64_bf16 v[12:15], v[44:47], v[232:239], v1
    ds_read_b128 v[52:55], v0 offset:8192
    v_smfmac_f32_16x16x64_bf16 v[16:19], v[44:47], v[240:247], v1
    ds_read_b128 v[64:67], v9 offset:10240
    v_smfmac_f32_16x16x64_bf16 v[20:23], v[44:47], v[248:255], v1
    ds_read_b128 v[68:71], v9 offset:11264
    s_waitcnt lgkmcnt(4)
    v_smfmac_f32_16x16x64_bf16 v[24:27], v[44:47], v[56:63], v1
    s_waitcnt lgkmcnt(3)
    v_smfmac_f32_16x16x64_bf16 v[12:15], v[48:51], a[16:23], v1
    v_smfmac_f32_16x16x64_bf16 v[16:19], v[48:51], a[24:31], v1
    ds_read_b128 v[56:59], v9 offset:16384
    s_waitcnt lgkmcnt(3)
    v_smfmac_f32_16x16x64_bf16 v[12:15], v[52:55], a[136:143], v1
    ds_read_b128 v[60:63], v9 offset:17408
    v_smfmac_f32_16x16x64_bf16 v[16:19], v[52:55], a[144:151], v1
    v_smfmac_f32_16x16x64_bf16 v[20:23], v[48:51], a[32:39], v1
    s_waitcnt lgkmcnt(2)
    v_smfmac_f32_16x16x64_bf16 v[24:27], v[48:51], v[64:71], v1
    ds_read_b128 v[64:67], v0 offset:9216
    s_nop 1
    v_add_f32 v12, v12, v14
    v_smfmac_f32_16x16x64_bf16 v[20:23], v[52:55], a[152:159], v1
    ds_read_b128 v[68:71], v0 offset:10240
    v_add_f32 v16, v16, v18
    s_waitcnt lgkmcnt(2)
    v_smfmac_f32_16x16x64_bf16 v[24:27], v[52:55], v[56:63], v1
    ds_read_b128 v[56:59], v0 offset:11264
    v_add_f32 v13, v13, v15
    v_add_f32 v17, v17, v19
    v_cvt_pk_bf16_f32 v14, v12, v16
    v_cvt_pk_bf16_f32 v15, v13, v17
    ds_write_b32 v2, v14 offset:17408
    ds_write_b32 v2, v15 offset:17696
    v_smfmac_f32_16x16x64_bf16 v[28:31], v[52:55], a[160:167], v1
    ds_read_b128 v[60:63], v0 offset:12288
    v_add_f32 v20, v20, v22
    v_add_f32 v24, v24, v26
    v_add_f32 v21, v21, v23
    v_add_f32 v25, v25, v27
    v_smfmac_f32_16x16x64_bf16 v[32:35], v[52:55], a[168:175], v1
    ds_read_b128 v[12:15], v0 offset:6144
    v_cvt_pk_bf16_f32 v22, v20, v24
    v_cvt_pk_bf16_f32 v23, v21, v25
    ds_write_b32 v2, v22 offset:19712
    ds_write_b32 v2, v23 offset:20000
    v_smfmac_f32_16x16x64_bf16 v[28:31], v[48:51], a[40:47], v1
    ds_read_b128 v[16:19], v0 offset:7168
    v_smfmac_f32_16x16x64_bf16 v[32:35], v[48:51], a[48:55], v1
    ds_read_b128 v[20:23], v0 offset:0
    v_smfmac_f32_16x16x64_bf16 v[28:31], v[44:47], a[0:7], v1
    ds_read_b128 v[24:27], v0 offset:1024
    v_smfmac_f32_16x16x64_bf16 v[32:35], v[44:47], a[8:15], v1
    s_waitcnt lgkmcnt(3)
    s_barrier
    ds_read_b128 v[44:47], v3 offset:17408
    v_smfmac_f32_16x16x64_bf16 v[28:31], v[12:15], a[80:87], v1
    ds_read_b128 v[52:55], v0 offset:2048
    v_smfmac_f32_16x16x64_bf16 v[32:35], v[12:15], a[88:95], v1
    ds_read_b128 v[12:15], v3 offset:19712
    s_waitcnt lgkmcnt(5)
    v_smfmac_f32_16x16x64_bf16 v[28:31], v[16:19], a[120:127], v1
    ds_read_b128 v[48:51], v0 offset:3072
    v_smfmac_f32_16x16x64_bf16 v[32:35], v[16:19], a[128:135], v1
    s_waitcnt lgkmcnt(5)
    v_smfmac_f32_16x16x64_bf16 v[28:31], v[20:23], v[96:103], v1
    v_smfmac_f32_16x16x64_bf16 v[32:35], v[20:23], v[104:111], v1
    ds_read_b128 v[20:23], v3 offset:17472
    s_waitcnt lgkmcnt(5)
    v_smfmac_f32_16x16x64_bf16 v[28:31], v[24:27], v[136:143], v1
    v_smfmac_f32_16x16x64_bf16 v[32:35], v[24:27], v[144:151], v1
    s_waitcnt lgkmcnt(3)
    v_smfmac_f32_16x16x64_bf16 v[28:31], v[52:55], v[176:183], v1
    v_smfmac_f32_16x16x64_bf16 v[32:35], v[52:55], v[184:191], v1
    ds_read_b128 v[52:55], v3 offset:19776
    s_waitcnt lgkmcnt(2)
    v_smfmac_f32_16x16x64_bf16 v[28:31], v[48:51], v[216:223], v1
    v_smfmac_f32_16x16x64_bf16 v[32:35], v[48:51], v[224:231], v1
    ds_read_b128 v[48:51], v3 offset:17536
    v_mfma_f32_16x16x32_bf16 v[24:27], v[12:15], v[44:47], 0
    s_waitcnt vmcnt(2)
    v_cmp_eq_u32 vcc, 0, v6
    s_nop 0
    s_and_b64 vcc, vcc, s[78:79]
    s_cbranch_scc1 Lr3f_flbad
Lr3f_flok:
    s_mov_b32 m0, 24320
    s_nop 0
    buffer_load_dword v5, s[8:11], s40 offen lds
    buffer_load_dword v5, s[8:11], s56 offen lds
    s_mov_b32 m0, 15360
    v_mfma_f32_16x16x32_bf16 v[12:15], v[64:67], v[44:47], 0
    ds_read_b128 v[64:67], v0 offset:13312
    v_mfma_f32_16x16x32_bf16 v[16:19], v[68:71], v[44:47], 0
    ds_read_b128 v[68:71], v0 offset:14336
    s_waitcnt lgkmcnt(3)
    v_mfma_f32_16x16x32_bf16 v[24:27], v[52:55], v[20:23], v[24:27]
    ds_read_b128 v[44:47], v3 offset:19840
    v_add_f32 v28, v28, v30
    v_add_f32 v29, v29, v31
    v_mfma_f32_16x16x32_bf16 v[12:15], v[56:59], v[20:23], v[12:15]
    ds_read_b128 v[52:55], v3 offset:17600
    v_add_f32 v32, v32, v34
    v_add_f32 v33, v33, v35
    v_mfma_f32_16x16x32_bf16 v[16:19], v[60:63], v[20:23], v[16:19]
    ds_read_b128 v[56:59], v0 offset:15360
    v_cvt_pk_bf16_f32 v30, v28, v29
    v_cvt_pk_bf16_f32 v31, v32, v33
    s_waitcnt lgkmcnt(2)
    v_mfma_f32_16x16x32_bf16 v[24:27], v[44:47], v[48:51], v[24:27]
    ds_read_b128 v[20:23], v3 offset:19904
    v_lshrrev_b32 v10, 8, v0
    v_mul_u32_u24 v10, 288, v10
    v_mfma_f32_16x16x32_bf16 v[12:15], v[64:67], v[48:51], v[12:15]
    ds_read_b128 v[60:63], v0 offset:16384
    v_and_b32 v11, 0xf0, v0
    v_add_u32 v10, v10, v11
    v_mfma_f32_16x16x32_bf16 v[16:19], v[68:71], v[48:51], v[16:19]
    ds_read_b128 v[32:35], v10 offset:21440
    v_lshrrev_b32 v11, 1, v0
    v_bfi_b32 v30, 1, s66, v30
    s_waitcnt lgkmcnt(2)
    v_mfma_f32_16x16x32_bf16 v[24:27], v[20:23], v[52:55], v[24:27]
    buffer_store_dwordx2 v[30:31], v11, s[8:11], s43 offen offset:2048 sc1
    v_mov_b32 v49, 0
    v_mov_b32 v50, 0
    v_mfma_f32_16x16x32_bf16 v[12:15], v[56:59], v[52:55], v[12:15]
    v_mov_b64 v[64:65], s[68:69]
    v_mov_b64 v[66:67], s[68:69]
    s_waitcnt lgkmcnt(1)
    v_mfma_f32_16x16x32_bf16 v[16:19], v[60:63], v[52:55], v[16:19]
    s_waitcnt lgkmcnt(0)
    v_bfi_b32 v32, 1, s66, v32
    s_mov_b64 exec, s[52:53]
    buffer_store_dwordx4 v[32:35], v0, s[8:11], s43 offen sc1
    s_mov_b64 exec, -1
    v_max3_f32 v10, v24, v25, v12
    v_max3_f32 v10, v10, v13, v14
    s_nop 0
    v_max3_f32 v10, v10, v15, v16
    v_max3_f32 v10, v10, v17, v18
    v_max_f32 v10, v10, v19
    v_mov_b32 v11, v10
    s_nop 1
    v_permlane32_swap_b32 v10, v11
    v_max_f32 v10, v10, v11
    v_mov_b32 v11, v10
    s_nop 1
    v_permlane16_swap_b32 v10, v11
    v_max_f32 v10, v10, v11
    v_mul_f32 v20, s46, v10
    v_pk_fma_f32 v[24:25], v[24:25], s[46:47], v[20:21] op_sel_hi:[1,1,0] neg_lo:[0,0,1] neg_hi:[0,0,1]
    v_pk_fma_f32 v[12:13], v[12:13], s[46:47], v[20:21] op_sel_hi:[1,1,0] neg_lo:[0,0,1] neg_hi:[0,0,1]
    v_exp_f32 v24, v24
    v_exp_f32 v25, v25
    v_pk_fma_f32 v[14:15], v[14:15], s[46:47], v[20:21] op_sel_hi:[1,1,0] neg_lo:[0,0,1] neg_hi:[0,0,1]
    v_exp_f32 v12, v12
    v_exp_f32 v13, v13
    v_pk_fma_f32 v[16:17], v[16:17], s[46:47], v[20:21] op_sel_hi:[1,1,0] neg_lo:[0,0,1] neg_hi:[0,0,1]
    v_cvt_pk_bf16_f32 v48, v24, v25
    v_exp_f32 v14, v14
    v_pk_fma_f32 v[18:19], v[18:19], s[46:47], v[20:21] op_sel_hi:[1,1,0] neg_lo:[0,0,1] neg_hi:[0,0,1]
    v_cvt_pk_bf16_f32 v51, v24, v25
    v_exp_f32 v15, v15
    v_cvt_pk_bf16_f32 v44, v12, v13
    v_exp_f32 v16, v16
    v_exp_f32 v17, v17
    v_cvt_pk_bf16_f32 v45, v14, v15
    v_exp_f32 v18, v18
    v_exp_f32 v19, v19
    v_cvt_pk_bf16_f32 v46, v16, v17
    v_cvt_pk_bf16_f32 v47, v18, v19
    v_mfma_f32_16x16x16_bf16 v[68:71], v[64:65], v[48:49], 0
    v_mfma_f32_16x16x16_bf16 v[52:55], v[30:31], v[48:49], 0
    v_mfma_f32_16x16x16_bf16 v[56:59], v[30:31], v[50:51], 0
    v_mfma_f32_16x16x32_bf16 v[68:71], v[64:67], v[44:47], v[68:71]
    s_waitcnt vmcnt(5)
    v_mfma_f32_16x16x32_bf16 v[52:55], v[36:39], v[44:47], v[52:55]
    s_waitcnt vmcnt(4)
    v_mfma_f32_16x16x32_bf16 v[56:59], v[40:43], v[44:47], v[56:59]
    ds_read_b128 v[36:39], v0 offset:55296
    ds_read_b128 v[40:43], v0 offset:56320
    ds_read_b128 v[60:63], v9 offset:24576
    s_nop 0
    v_rcp_f32 v10, v68
    s_nop 0
    v_pk_mul_f32 v[52:53], v[52:53], v[10:11] op_sel_hi:[1,0]
    s_nop 0
    v_pk_mul_f32 v[56:57], v[56:57], v[10:11] op_sel_hi:[1,0]
    v_cvt_pk_bf16_f32 v16, v52, v56
    v_cvt_pk_bf16_f32 v17, v53, v57
    v_pk_mul_f32 v[54:55], v[54:55], v[10:11] op_sel_hi:[1,0]
    v_pk_mul_f32 v[58:59], v[58:59], v[10:11] op_sel_hi:[1,0]
    v_cvt_pk_bf16_f32 v18, v54, v58
    v_cvt_pk_bf16_f32 v19, v55, v59
    ds_write_b128 v3, v[16:19] offset:22208
    ds_read_b128 v[64:67], v9 offset:25600
    v_mov_b64 v[12:13], 0
    v_mov_b64 v[14:15], 0
    v_mov_b64 v[20:21], 0
    v_mov_b64 v[22:23], 0
    v_mov_b64 v[24:25], 0
    v_mov_b64 v[26:27], 0
    v_mov_b64 v[32:33], 0
    v_mov_b64 v[34:35], 0
    v_mov_b64 v[44:45], 0
    v_mov_b64 v[46:47], 0
    v_mov_b64 v[48:49], 0
    v_mov_b64 v[50:51], 0
    s_waitcnt lgkmcnt(1)
    s_barrier
    ds_read_b128 v[52:55], v4 offset:22016
    ds_read_b128 v[56:59], v4 offset:22144
    v_mov_b64 v[68:69], 0
    v_mov_b64 v[70:71], 0
    v_mov_b64 v[28:29], 0
    v_mov_b64 v[30:31], 0
    v_mov_b64 v[16:17], 0
    v_mov_b64 v[18:19], 0
    s_cmp_eq_u32 s33, 63
    s_cbranch_scc1 Lr3f_last
    s_waitcnt lgkmcnt(1)
    v_smfmac_f32_16x16x64_bf16 v[28:31], v[52:55], v[60:67], v1
    ds_read_b128 v[60:63], v0 offset:49152
    s_waitcnt lgkmcnt(1)
    v_smfmac_f32_16x16x64_bf16 v[28:31], v[56:59], v[36:43], v1
    ds_read_b128 v[64:67], v0 offset:50176
    ds_read_b128 v[36:39], v9 offset:18432
    v_smfmac_f32_16x16x64_bf16 v[12:15], v[52:55], a[176:183], v1
    ds_read_b128 v[40:43], v9 offset:19456
    v_smfmac_f32_16x16x64_bf16 v[12:15], v[56:59], a[184:191], v1
    buffer_load_dwordx4 v0, s[8:11], s41 offen offset:0 lds
    v_smfmac_f32_16x16x64_bf16 v[20:23], v[52:55], a[192:199], v1
    s_nop 0
    v_add_f32 v28, v28, v30
    v_add_f32 v29, v29, v31
    s_waitcnt lgkmcnt(2)
    v_smfmac_f32_16x16x64_bf16 v[20:23], v[56:59], v[60:67], v1
    ds_read_b128 v[60:63], v9 offset:20480
    v_cvt_pk_bf16_f32 v28, v28, v29
    v_bfi_b32 v28, 1, s39, v28
    buffer_store_dword v28, v8, s[8:11], s38 offen offset:2048
    s_waitcnt lgkmcnt(1)
    v_smfmac_f32_16x16x64_bf16 v[24:27], v[52:55], v[36:43], v1
    ds_read_b128 v[64:67], v9 offset:21504
    ds_read_b128 v[36:39], v0 offset:51200
    v_add_f32 v12, v12, v14
    v_add_f32 v13, v13, v15
    v_smfmac_f32_16x16x64_bf16 v[24:27], v[56:59], a[200:207], v1
    ds_read_b128 v[40:43], v0 offset:52224
    v_cvt_pk_bf16_f32 v12, v12, v13
    v_bfi_b32 v12, 1, s39, v12
    v_smfmac_f32_16x16x64_bf16 v[32:35], v[52:55], a[208:215], v1
    buffer_load_dwordx4 v0, s[8:11], s41 offen offset:1024 lds
    v_add_f32 v20, v20, v22
    v_add_f32 v21, v21, v23
    v_smfmac_f32_16x16x64_bf16 v[32:35], v[56:59], a[216:223], v1
    v_cvt_pk_bf16_f32 v13, v20, v21
    s_waitcnt lgkmcnt(2)
    v_smfmac_f32_16x16x64_bf16 v[44:47], v[52:55], v[60:67], v1
    ds_read_b128 v[60:63], v0 offset:53248
    v_add_f32 v24, v24, v26
    v_add_f32 v25, v25, v27
    s_waitcnt lgkmcnt(1)
    v_smfmac_f32_16x16x64_bf16 v[44:47], v[56:59], v[36:43], v1
    ds_read_b128 v[64:67], v0 offset:54272
    ds_read_b128 v[36:39], v9 offset:22528
    v_cvt_pk_bf16_f32 v14, v24, v25
    v_smfmac_f32_16x16x64_bf16 v[48:51], v[52:55], a[224:231], v1
    ds_read_b128 v[40:43], v9 offset:23552
    v_add_f32 v32, v32, v34
    v_add_f32 v33, v33, v35
    v_smfmac_f32_16x16x64_bf16 v[48:51], v[56:59], a[232:239], v1
    v_cvt_pk_bf16_f32 v15, v32, v33
    buffer_store_dwordx4 v[12:15], v0, s[8:11], s38 offen offset:0
    v_smfmac_f32_16x16x64_bf16 v[68:71], v[52:55], a[240:247], v1
    v_add_f32 v44, v44, v46
    v_add_f32 v45, v45, v47
    s_waitcnt lgkmcnt(2)
    v_smfmac_f32_16x16x64_bf16 v[68:71], v[56:59], v[60:67], v1
    v_cvt_pk_bf16_f32 v44, v44, v45
    v_bfi_b32 v44, 1, s39, v44
    s_waitcnt lgkmcnt(0)
    v_smfmac_f32_16x16x64_bf16 v[16:19], v[52:55], v[36:43], v1
    v_add_f32 v48, v48, v50
    v_add_f32 v49, v49, v51
    v_smfmac_f32_16x16x64_bf16 v[16:19], v[56:59], a[248:255], v1
    v_cvt_pk_bf16_f32 v45, v48, v49
    v_add_f32 v68, v68, v70
    v_add_f32 v69, v69, v71
    v_cvt_pk_bf16_f32 v46, v68, v69
    s_nop 3
    v_add_f32 v16, v16, v18
    v_add_f32 v17, v17, v19
    v_cvt_pk_bf16_f32 v47, v16, v17
    buffer_store_dwordx4 v[44:47], v0, s[8:11], s38 offen offset:1024
    s_xor_b32 s34, s34, 16384
    s_xor_b32 s35, s35, 16384
    s_barrier
    s_sleep 2
    buffer_load_dwordx4 v[44:47], v0, s[8:11], s34 offen sc1
    buffer_load_dwordx4 v[48:51], v0, s[8:11], s34 offen offset:1024 sc1
    buffer_load_dword v10, v8, s[8:11], s35 offen sc1
    s_add_u32 s33, s33, 1
    s_bfe_u32 s39, s33, 0x10001
    s_xor_b32 s38, s38, 524288
    s_and_b32 s17, s33, 7
    s_mul_i32 s17, s17, 131072
    s_add_u32 s43, s45, s17
    s_bfe_u32 s66, s33, 65539
    s_add_u32 s67, s67, 22528
    s_and_b32 s17, s33, 3
    s_cmp_eq_u32 s17, 3
    s_cselect_b32 s17, 1, 0
    s_cmp_eq_u32 s32, 0
    s_cselect_b32 s17, 1, s17
    s_cmp_ge_u32 s33, 7
    s_cselect_b32 s17, s17, 0
    s_cmp_lg_u32 s17, 0
    s_cselect_b64 s[78:79], -1, 0xff
    s_add_u32 s56, s56, 262144
    s_add_u32 s42, s42, 262144
    s_add_u32 s41, s41, 262144
    s_add_u32 s40, s40, 262144
    s_add_u32 s44, s44, 22528
    ds_read_b128 v[56:59], v9 offset:12288
    ds_read_b128 v[60:63], v9 offset:13312
    ds_read_b128 v[64:67], v9 offset:14336
    ds_read_b128 v[68:71], v9 offset:15360
    v_mov_b64 v[12:13], 0
    v_mov_b64 v[14:15], 0
    v_mov_b64 v[16:17], 0
    v_mov_b64 v[18:19], 0
    v_mov_b64 v[20:21], 0
    v_mov_b64 v[22:23], 0
    v_mov_b64 v[24:25], 0
    v_mov_b64 v[26:27], 0
    v_mov_b64 v[28:29], 0
    v_mov_b64 v[30:31], 0
    v_mov_b64 v[32:33], 0
    v_mov_b64 v[34:35], 0
    s_waitcnt lgkmcnt(0)
    s_branch Lr3f_step
Lr3f_flbad:
    s_cmp_eq_u32 s33, 63
    s_cbranch_scc1 Lr3f_flok
    s_mov_b32 s16, 0
Lr3f_flp:
    buffer_load_dword v6, v7, s[8:11], s67 offen sc1
    s_add_u32 s16, s16, 1
    s_cmp_gt_u32 s16, 100000
    s_cbranch_scc1 Lr_abort
    s_waitcnt vmcnt(0)
    v_cmp_eq_u32 vcc, 0, v6
    s_nop 0
    s_and_b64 vcc, vcc, s[78:79]
    s_cbranch_scc1 Lr3f_flp
    s_branch Lr3f_flok
Lr3f_last:
    s_waitcnt vmcnt(0) lgkmcnt(0)
    s_branch Lr_exit
L_slow:
    s_cmp_lg_u32 s14, 0
    s_cbranch_scc1 L_w1_0
    s_barrier
    s_mov_b32 m0, 9216
    s_nop 0
    buffer_load_dwordx4 v0, s[8:11], s41 offen offset:0 lds
    buffer_load_dwordx4 v0, s[8:11], s41 offen offset:1024 lds
    s_add_u32 s41, s41, 262144
    s_waitcnt vmcnt(0)
    buffer_load_dwordx4 v[44:47], v0, s[8:11], s34 offen sc1
    buffer_load_dwordx4 v[48:51], v0, s[8:11], s34 offen offset:1024 sc1
    buffer_load_dword v10, v8, s[8:11], s35 offen sc1
    ds_read_b128 v[56:59], v9 offset:0
    ds_read_b128 v[60:63], v9 offset:1024
    ds_read_b128 v[64:67], v9 offset:2048
    ds_read_b128 v[68:71], v9 offset:3072
    v_mov_b64 v[12:13], 0
    v_mov_b64 v[14:15], 0
    v_mov_b64 v[16:17], 0
    v_mov_b64 v[18:19], 0
    v_mov_b64 v[20:21], 0
    v_mov_b64 v[22:23], 0
    v_mov_b64 v[24:25], 0
    v_mov_b64 v[26:27], 0
    v_mov_b64 v[28:29], 0
    v_mov_b64 v[30:31], 0
    v_mov_b64 v[32:33], 0
    v_mov_b64 v[34:35], 0
    s_waitcnt lgkmcnt(0)
Lr0s_step:
    s_mov_b32 s16, 0
    s_mov_b64 s[70:71], 0
    s_mov_b64 s[72:73], 0
    s_mov_b64 s[74:75], 0
Lr0s_p2:
    s_mov_b64 exec, s[70:71]
    buffer_load_dwordx4 v[44:47], v0, s[8:11], s34 offen sc1
    s_mov_b64 exec, s[72:73]
    buffer_load_dwordx4 v[48:51], v0, s[8:11], s34 offen offset:1024 sc1
    s_mov_b64 exec, s[74:75]
    buffer_load_dword v10, v8, s[8:11], s35 offen sc1
    s_mov_b64 exec, -1
    s_add_u32 s16, s16, 1
    s_cmp_gt_u32 s16, 100000
    s_cbranch_scc1 Lr_abort
    s_waitcnt vmcnt(5)
    v_max3_u32 v11, v44, v45, v46
    v_max_u32 v11, v11, v47
    v_cmp_eq_u32 s[70:71], -1, v11
    s_waitcnt vmcnt(4)
    v_max3_u32 v11, v48, v49, v50
    v_max_u32 v11, v11, v51
    v_cmp_eq_u32 s[72:73], -1, v11
    s_waitcnt vmcnt(3)
    v_cmp_eq_u32 s[74:75], -1, v10
    s_or_b64 vcc, s[70:71], s[72:73]
    s_or_b64 vcc, vcc, s[74:75]
    s_cbranch_scc1 Lr0s_p2
    v_smfmac_f32_16x16x64_bf16 v[12:15], v[44:47], v[72:79], v1
    ds_write_b128 v0, v[44:47] offset:0
    v_smfmac_f32_16x16x64_bf16 v[16:19], v[44:47], v[80:87], v1
    ds_write_b128 v0, v[48:51] offset:1024
    v_smfmac_f32_16x16x64_bf16 v[20:23], v[44:47], v[88:95], v1
    ds_write_b32 v8, v10 offset:8192
    v_smfmac_f32_16x16x64_bf16 v[24:27], v[44:47], v[56:63], v1
    s_waitcnt lgkmcnt(0)
    s_barrier
    ds_read_b128 v[52:55], v0 offset:2048
    v_smfmac_f32_16x16x64_bf16 v[12:15], v[48:51], v[112:119], v1
    ds_read_b128 v[36:39], v0 offset:3072
    v_smfmac_f32_16x16x64_bf16 v[16:19], v[48:51], v[120:127], v1
    ds_read_b128 v[56:59], v9 offset:4096
    v_smfmac_f32_16x16x64_bf16 v[20:23], v[48:51], v[128:135], v1
    ds_read_b128 v[60:63], v9 offset:5120
    v_smfmac_f32_16x16x64_bf16 v[24:27], v[48:51], v[64:71], v1
    ds_read_b128 v[40:43], v0 offset:4096
    s_waitcnt lgkmcnt(4)
    v_smfmac_f32_16x16x64_bf16 v[12:15], v[52:55], v[152:159], v1
    v_smfmac_f32_16x16x64_bf16 v[16:19], v[52:55], v[160:167], v1
    ds_read_b128 v[64:67], v9 offset:6144
    v_smfmac_f32_16x16x64_bf16 v[20:23], v[52:55], v[168:175], v1
    ds_read_b128 v[68:71], v9 offset:7168
    s_waitcnt lgkmcnt(3)
    v_smfmac_f32_16x16x64_bf16 v[24:27], v[52:55], v[56:63], v1
    v_smfmac_f32_16x16x64_bf16 v[12:15], v[36:39], v[192:199], v1
    ds_read_b128 v[52:55], v0 offset:5120
    v_smfmac_f32_16x16x64_bf16 v[16:19], v[36:39], v[200:207], v1
    ds_read_b128 v[56:59], v9 offset:8192
    v_smfmac_f32_16x16x64_bf16 v[20:23], v[36:39], v[208:215], v1
    ds_read_b128 v[60:63], v9 offset:9216
    s_waitcnt lgkmcnt(3)
    v_smfmac_f32_16x16x64_bf16 v[24:27], v[36:39], v[64:71], v1
    v_smfmac_f32_16x16x64_bf16 v[12:15], v[40:43], v[232:239], v1
    buffer_load_dwordx4 v[36:39], v0, s[8:11], s42 offen
    v_smfmac_f32_16x16x64_bf16 v[16:19], v[40:43], v[240:247], v1
    ds_read_b128 v[64:67], v9 offset:10240
    v_smfmac_f32_16x16x64_bf16 v[20:23], v[40:43], v[248:255], v1
    ds_read_b128 v[68:71], v9 offset:11264
    s_waitcnt lgkmcnt(2)
    v_smfmac_f32_16x16x64_bf16 v[24:27], v[40:43], v[56:63], v1
    s_waitcnt vmcnt(1)
    ds_read_b128 v[44:47], v0 offset:6144
    v_smfmac_f32_16x16x64_bf16 v[12:15], v[52:55], a[16:23], v1
    buffer_load_dwordx4 v[40:43], v0, s[8:11], s42 offen offset:1024
    v_smfmac_f32_16x16x64_bf16 v[16:19], v[52:55], a[24:31], v1
    ds_read_b128 v[56:59], v9 offset:12288
    v_smfmac_f32_16x16x64_bf16 v[20:23], v[52:55], a[32:39], v1
    ds_read_b128 v[60:63], v9 offset:13312
    s_waitcnt lgkmcnt(3)
    v_smfmac_f32_16x16x64_bf16 v[24:27], v[52:55], v[64:71], v1
    ds_read_b128 v[48:51], v0 offset:7168
    s_waitcnt lgkmcnt(3)
    v_smfmac_f32_16x16x64_bf16 v[12:15], v[44:47], a[56:63], v1
    ds_read_b128 v[52:55], v0 offset:8192
    v_smfmac_f32_16x16x64_bf16 v[16:19], v[44:47], a[64:71], v1
    ds_read_b128 v[64:67], v9 offset:14336
    v_smfmac_f32_16x16x64_bf16 v[20:23], v[44:47], a[72:79], v1
    ds_read_b128 v[68:71], v9 offset:15360
    s_waitcnt lgkmcnt(4)
    v_smfmac_f32_16x16x64_bf16 v[24:27], v[44:47], v[56:63], v1
    s_waitcnt lgkmcnt(3)
    v_smfmac_f32_16x16x64_bf16 v[12:15], v[48:51], a[96:103], v1
    v_smfmac_f32_16x16x64_bf16 v[16:19], v[48:51], a[104:111], v1
    ds_read_b128 v[56:59], v9 offset:16384
    s_waitcnt lgkmcnt(3)
    v_smfmac_f32_16x16x64_bf16 v[12:15], v[52:55], a[136:143], v1
    ds_read_b128 v[60:63], v9 offset:17408
    v_smfmac_f32_16x16x64_bf16 v[16:19], v[52:55], a[144:151], v1
    v_smfmac_f32_16x16x64_bf16 v[20:23], v[48:51], a[112:119], v1
    s_waitcnt lgkmcnt(2)
    v_smfmac_f32_16x16x64_bf16 v[24:27], v[48:51], v[64:71], v1
    ds_read_b128 v[64:67], v0 offset:9216
    s_nop 1
    v_add_f32 v12, v12, v14
    v_smfmac_f32_16x16x64_bf16 v[20:23], v[52:55], a[152:159], v1
    ds_read_b128 v[68:71], v0 offset:10240
    v_add_f32 v16, v16, v18
    s_waitcnt lgkmcnt(2)
    v_smfmac_f32_16x16x64_bf16 v[24:27], v[52:55], v[56:63], v1
    ds_read_b128 v[56:59], v0 offset:11264
    v_add_f32 v13, v13, v15
    v_add_f32 v17, v17, v19
    v_cvt_pk_bf16_f32 v14, v12, v16
    v_cvt_pk_bf16_f32 v15, v13, v17
    ds_write_b32 v2, v14 offset:17408
    ds_write_b32 v2, v15 offset:17696
    v_smfmac_f32_16x16x64_bf16 v[28:31], v[52:55], a[160:167], v1
    ds_read_b128 v[60:63], v0 offset:12288
    v_add_f32 v20, v20, v22
    v_add_f32 v24, v24, v26
    v_add_f32 v21, v21, v23
    v_add_f32 v25, v25, v27
    v_smfmac_f32_16x16x64_bf16 v[32:35], v[52:55], a[168:175], v1
    ds_read_b128 v[12:15], v0 offset:0
    v_cvt_pk_bf16_f32 v22, v20, v24
    v_cvt_pk_bf16_f32 v23, v21, v25
    ds_write_b32 v2, v22 offset:19712
    ds_write_b32 v2, v23 offset:20000
    v_smfmac_f32_16x16x64_bf16 v[28:31], v[48:51], a[120:127], v1
    ds_read_b128 v[16:19], v0 offset:1024
    v_smfmac_f32_16x16x64_bf16 v[32:35], v[48:51], a[128:135], v1
    ds_read_b128 v[20:23], v0 offset:2048
    v_smfmac_f32_16x16x64_bf16 v[28:31], v[44:47], a[80:87], v1
    ds_read_b128 v[24:27], v0 offset:3072
    v_smfmac_f32_16x16x64_bf16 v[32:35], v[44:47], a[88:95], v1
    s_waitcnt lgkmcnt(3)
    s_barrier
    ds_read_b128 v[44:47], v3 offset:17408
    v_smfmac_f32_16x16x64_bf16 v[28:31], v[12:15], v[96:103], v1
    ds_read_b128 v[52:55], v0 offset:4096
    v_smfmac_f32_16x16x64_bf16 v[32:35], v[12:15], v[104:111], v1
    ds_read_b128 v[12:15], v3 offset:19712
    s_waitcnt lgkmcnt(5)
    v_smfmac_f32_16x16x64_bf16 v[28:31], v[16:19], v[136:143], v1
    ds_read_b128 v[48:51], v0 offset:5120
    v_smfmac_f32_16x16x64_bf16 v[32:35], v[16:19], v[144:151], v1
    s_waitcnt lgkmcnt(5)
    v_smfmac_f32_16x16x64_bf16 v[28:31], v[20:23], v[176:183], v1
    v_smfmac_f32_16x16x64_bf16 v[32:35], v[20:23], v[184:191], v1
    ds_read_b128 v[20:23], v3 offset:17472
    s_waitcnt lgkmcnt(5)
    v_smfmac_f32_16x16x64_bf16 v[28:31], v[24:27], v[216:223], v1
    v_smfmac_f32_16x16x64_bf16 v[32:35], v[24:27], v[224:231], v1
    s_waitcnt lgkmcnt(3)
    v_smfmac_f32_16x16x64_bf16 v[28:31], v[52:55], a[0:7], v1
    v_smfmac_f32_16x16x64_bf16 v[32:35], v[52:55], a[8:15], v1
    ds_read_b128 v[52:55], v3 offset:19776
    s_waitcnt lgkmcnt(2)
    v_smfmac_f32_16x16x64_bf16 v[28:31], v[48:51], a[40:47], v1
    v_smfmac_f32_16x16x64_bf16 v[32:35], v[48:51], a[48:55], v1
    ds_read_b128 v[48:51], v3 offset:17536
    v_mfma_f32_16x16x32_bf16 v[24:27], v[12:15], v[44:47], 0
    v_mfma_f32_16x16x32_bf16 v[12:15], v[64:67], v[44:47], 0
    ds_read_b128 v[64:67], v0 offset:13312
    v_mfma_f32_16x16x32_bf16 v[16:19], v[68:71], v[44:47], 0
    ds_read_b128 v[68:71], v0 offset:14336
    s_waitcnt lgkmcnt(3)
    v_mfma_f32_16x16x32_bf16 v[24:27], v[52:55], v[20:23], v[24:27]
    ds_read_b128 v[44:47], v3 offset:19840
    v_add_f32 v28, v28, v30
    v_add_f32 v29, v29, v31
    v_mfma_f32_16x16x32_bf16 v[12:15], v[56:59], v[20:23], v[12:15]
    ds_read_b128 v[52:55], v3 offset:17600
    v_add_f32 v32, v32, v34
    v_add_f32 v33, v33, v35
    v_mfma_f32_16x16x32_bf16 v[16:19], v[60:63], v[20:23], v[16:19]
    ds_read_b128 v[56:59], v0 offset:15360
    v_cvt_pk_bf16_f32 v30, v28, v29
    v_cvt_pk_bf16_f32 v31, v32, v33
    s_waitcnt lgkmcnt(2)
    v_mfma_f32_16x16x32_bf16 v[24:27], v[44:47], v[48:51], v[24:27]
    ds_read_b128 v[20:23], v3 offset:19904
    v_lshrrev_b32 v10, 8, v0
    v_mul_u32_u24 v10, 288, v10
    v_mfma_f32_16x16x32_bf16 v[12:15], v[64:67], v[48:51], v[12:15]
    ds_read_b128 v[60:63], v0 offset:16384
    v_and_b32 v11, 0xf0, v0
    v_add_u32 v10, v10, v11
    v_mfma_f32_16x16x32_bf16 v[16:19], v[68:71], v[48:51], v[16:19]
    ds_read_b128 v[32:35], v10 offset:19712
    v_lshrrev_b32 v11, 1, v0
    v_bfi_b32 v30, 1, s66, v30
    s_waitcnt lgkmcnt(2)
    v_mfma_f32_16x16x32_bf16 v[24:27], v[20:23], v[52:55], v[24:27]
    buffer_store_dwordx2 v[30:31], v11, s[8:11], s43 offen offset:2048 sc1
    v_mov_b32 v49, 0
    v_mov_b32 v50, 0
    v_mfma_f32_16x16x32_bf16 v[12:15], v[56:59], v[52:55], v[12:15]
    v_mov_b64 v[64:65], s[68:69]
    v_mov_b64 v[66:67], s[68:69]
    s_waitcnt lgkmcnt(1)
    v_mfma_f32_16x16x32_bf16 v[16:19], v[60:63], v[52:55], v[16:19]
    s_waitcnt lgkmcnt(0)
    v_bfi_b32 v32, 1, s66, v32
    s_mov_b64 exec, s[52:53]
    buffer_store_dwordx4 v[32:35], v0, s[8:11], s43 offen sc1
    s_mov_b64 exec, -1
    v_max3_f32 v10, v24, v25, v12
    v_max3_f32 v10, v10, v13, v14
    s_nop 0
    v_max3_f32 v10, v10, v15, v16
    v_max3_f32 v10, v10, v17, v18
    v_max_f32 v10, v10, v19
    v_mov_b32 v11, v10
    s_nop 1
    v_permlane32_swap_b32 v10, v11
    v_max_f32 v10, v10, v11
    v_mov_b32 v11, v10
    s_nop 1
    v_permlane16_swap_b32 v10, v11
    v_max_f32 v10, v10, v11
    v_mul_f32 v20, s46, v10
    v_pk_fma_f32 v[24:25], v[24:25], s[46:47], v[20:21] op_sel_hi:[1,1,0] neg_lo:[0,0,1] neg_hi:[0,0,1]
    v_pk_fma_f32 v[12:13], v[12:13], s[46:47], v[20:21] op_sel_hi:[1,1,0] neg_lo:[0,0,1] neg_hi:[0,0,1]
    v_exp_f32 v24, v24
    v_exp_f32 v25, v25
    v_pk_fma_f32 v[14:15], v[14:15], s[46:47], v[20:21] op_sel_hi:[1,1,0] neg_lo:[0,0,1] neg_hi:[0,0,1]
    v_exp_f32 v12, v12
    v_exp_f32 v13, v13
    v_pk_fma_f32 v[16:17], v[16:17], s[46:47], v[20:21] op_sel_hi:[1,1,0] neg_lo:[0,0,1] neg_hi:[0,0,1]
    v_cvt_pk_bf16_f32 v48, v24, v25
    v_exp_f32 v14, v14
    v_pk_fma_f32 v[18:19], v[18:19], s[46:47], v[20:21] op_sel_hi:[1,1,0] neg_lo:[0,0,1] neg_hi:[0,0,1]
    v_cvt_pk_bf16_f32 v51, v24, v25
    v_exp_f32 v15, v15
    v_cvt_pk_bf16_f32 v44, v12, v13
    v_exp_f32 v16, v16
    v_exp_f32 v17, v17
    v_cvt_pk_bf16_f32 v45, v14, v15
    v_exp_f32 v18, v18
    v_exp_f32 v19, v19
    v_cvt_pk_bf16_f32 v46, v16, v17
    v_cvt_pk_bf16_f32 v47, v18, v19
    v_mfma_f32_16x16x16_bf16 v[68:71], v[64:65], v[48:49], 0
    v_mfma_f32_16x16x16_bf16 v[52:55], v[30:31], v[48:49], 0
    v_mfma_f32_16x16x16_bf16 v[56:59], v[30:31], v[50:51], 0
    v_mfma_f32_16x16x32_bf16 v[68:71], v[64:67], v[44:47], v[68:71]
    s_waitcnt vmcnt(3)
    v_mfma_f32_16x16x32_bf16 v[52:55], v[36:39], v[44:47], v[52:55]
    s_waitcnt vmcnt(2)
    v_mfma_f32_16x16x32_bf16 v[56:59], v[40:43], v[44:47], v[56:59]
    ds_read_b128 v[36:39], v0 offset:30720
    ds_read_b128 v[40:43], v0 offset:31744
    ds_read_b128 v[60:63], v9 offset:24576
    s_nop 0
    v_rcp_f32 v10, v68
    s_nop 0
    v_pk_mul_f32 v[52:53], v[52:53], v[10:11] op_sel_hi:[1,0]
    s_nop 0
    v_pk_mul_f32 v[56:57], v[56:57], v[10:11] op_sel_hi:[1,0]
    v_cvt_pk_bf16_f32 v16, v52, v56
    v_cvt_pk_bf16_f32 v17, v53, v57
    v_pk_mul_f32 v[54:55], v[54:55], v[10:11] op_sel_hi:[1,0]
    v_pk_mul_f32 v[58:59], v[58:59], v[10:11] op_sel_hi:[1,0]
    v_cvt_pk_bf16_f32 v18, v54, v58
    v_cvt_pk_bf16_f32 v19, v55, v59
    ds_write_b128 v3, v[16:19] offset:22016
    ds_read_b128 v[64:67], v9 offset:25600
    v_mov_b64 v[12:13], 0
    v_mov_b64 v[14:15], 0
    v_mov_b64 v[20:21], 0
    v_mov_b64 v[22:23], 0
    v_mov_b64 v[24:25], 0
    v_mov_b64 v[26:27], 0
    v_mov_b64 v[32:33], 0
    v_mov_b64 v[34:35], 0
    v_mov_b64 v[44:45], 0
    v_mov_b64 v[46:47], 0
    v_mov_b64 v[48:49], 0
    v_mov_b64 v[50:51], 0
    s_waitcnt lgkmcnt(1)
    s_barrier
    ds_read_b128 v[52:55], v4 offset:22016
    ds_read_b128 v[56:59], v4 offset:22144
    v_mov_b64 v[68:69], 0
    v_mov_b64 v[70:71], 0
    v_mov_b64 v[28:29], 0
    v_mov_b64 v[30:31], 0
    v_mov_b64 v[16:17], 0
    v_mov_b64 v[18:19], 0
    s_cmp_eq_u32 s33, 63
    s_cbranch_scc1 Lr0s_last
    s_waitcnt lgkmcnt(1)
    v_smfmac_f32_16x16x64_bf16 v[28:31], v[52:55], v[60:67], v1
    ds_read_b128 v[60:63], v0 offset:24576
    s_waitcnt lgkmcnt(1)
    v_smfmac_f32_16x16x64_bf16 v[28:31], v[56:59], v[36:43], v1
    ds_read_b128 v[64:67], v0 offset:25600
    ds_read_b128 v[36:39], v9 offset:18432
    v_smfmac_f32_16x16x64_bf16 v[12:15], v[52:55], a[176:183], v1
    ds_read_b128 v[40:43], v9 offset:19456
    v_smfmac_f32_16x16x64_bf16 v[12:15], v[56:59], a[184:191], v1
    buffer_load_dwordx4 v0, s[8:11], s41 offen offset:0 lds
    v_smfmac_f32_16x16x64_bf16 v[20:23], v[52:55], a[192:199], v1
    s_nop 0
    v_add_f32 v28, v28, v30
    v_add_f32 v29, v29, v31
    s_waitcnt lgkmcnt(2)
    v_smfmac_f32_16x16x64_bf16 v[20:23], v[56:59], v[60:67], v1
    ds_read_b128 v[60:63], v9 offset:20480
    v_cvt_pk_bf16_f32 v28, v28, v29
    v_bfi_b32 v28, 1, s39, v28
    buffer_store_dword v28, v8, s[8:11], s38 offen offset:2048 sc1
    s_waitcnt lgkmcnt(1)
    v_smfmac_f32_16x16x64_bf16 v[24:27], v[52:55], v[36:43], v1
    ds_read_b128 v[64:67], v9 offset:21504
    ds_read_b128 v[36:39], v0 offset:26624
    v_add_f32 v12, v12, v14
    v_add_f32 v13, v13, v15
    v_smfmac_f32_16x16x64_bf16 v[24:27], v[56:59], a[200:207], v1
    ds_read_b128 v[40:43], v0 offset:27648
    v_cvt_pk_bf16_f32 v12, v12, v13
    v_bfi_b32 v12, 1, s39, v12
    v_smfmac_f32_16x16x64_bf16 v[32:35], v[52:55], a[208:215], v1
    buffer_load_dwordx4 v0, s[8:11], s41 offen offset:1024 lds
    v_add_f32 v20, v20, v22
    v_add_f32 v21, v21, v23
    v_smfmac_f32_16x16x64_bf16 v[32:35], v[56:59], a[216:223], v1
    v_cvt_pk_bf16_f32 v13, v20, v21
    s_waitcnt lgkmcnt(2)
    v_smfmac_f32_16x16x64_bf16 v[44:47], v[52:55], v[60:67], v1
    ds_read_b128 v[60:63], v0 offset:28672
    v_add_f32 v24, v24, v26
    v_add_f32 v25, v25, v27
    s_waitcnt lgkmcnt(1)
    v_smfmac_f32_16x16x64_bf16 v[44:47], v[56:59], v[36:43], v1
    ds_read_b128 v[64:67], v0 offset:29696
    ds_read_b128 v[36:39], v9 offset:22528
    v_cvt_pk_bf16_f32 v14, v24, v25
    v_smfmac_f32_16x16x64_bf16 v[48:51], v[52:55], a[224:231], v1
    ds_read_b128 v[40:43], v9 offset:23552
    v_add_f32 v32, v32, v34
    v_add_f32 v33, v33, v35
    v_smfmac_f32_16x16x64_bf16 v[48:51], v[56:59], a[232:239], v1
    v_cvt_pk_bf16_f32 v15, v32, v33
    buffer_store_dwordx4 v[12:15], v0, s[8:11], s38 offen offset:0 sc1
    v_smfmac_f32_16x16x64_bf16 v[68:71], v[52:55], a[240:247], v1
    v_add_f32 v44, v44, v46
    v_add_f32 v45, v45, v47
    s_waitcnt lgkmcnt(2)
    v_smfmac_f32_16x16x64_bf16 v[68:71], v[56:59], v[60:67], v1
    v_cvt_pk_bf16_f32 v44, v44, v45
    v_bfi_b32 v44, 1, s39, v44
    s_waitcnt lgkmcnt(0)
    v_smfmac_f32_16x16x64_bf16 v[16:19], v[52:55], v[36:43], v1
    v_add_f32 v48, v48, v50
    v_add_f32 v49, v49, v51
    v_smfmac_f32_16x16x64_bf16 v[16:19], v[56:59], a[248:255], v1
    v_cvt_pk_bf16_f32 v45, v48, v49
    v_add_f32 v68, v68, v70
    v_add_f32 v69, v69, v71
    v_cvt_pk_bf16_f32 v46, v68, v69
    s_nop 3
    v_add_f32 v16, v16, v18
    v_add_f32 v17, v17, v19
    v_cvt_pk_bf16_f32 v47, v16, v17
    buffer_store_dwordx4 v[44:47], v0, s[8:11], s38 offen offset:1024 sc1
    s_sleep 6
    buffer_load_dwordx4 v[52:55], v6, s[8:11], s57 offen sc1
    buffer_load_dwordx4 v[56:59], v6, s[8:11], s58 offen sc1
    buffer_load_dwordx4 v[60:63], v6, s[8:11], s59 offen sc1
    buffer_load_dwordx4 v[64:67], v6, s[8:11], s60 offen sc1
    v_bfe_u32 v10, v0, 4, 4
    v_mov_b32 v11, 0x3f80
    v_mov_b32 v40, 0x3f800000
    v_cmp_eq_u32 vcc, 0, v10
    v_cmp_eq_u32 s[48:49], 1, v10
    s_nop 0
    v_cndmask_b32 v36, 0, v11, vcc
    v_cndmask_b32 v36, v36, v40, s[48:49]
    v_cmp_eq_u32 vcc, 2, v10
    v_cmp_eq_u32 s[48:49], 3, v10
    s_nop 0
    v_cndmask_b32 v37, 0, v11, vcc
    v_cndmask_b32 v37, v37, v40, s[48:49]
    v_cmp_eq_u32 vcc, 4, v10
    v_cmp_eq_u32 s[48:49], 5, v10
    s_nop 0
    v_cndmask_b32 v38, 0, v11, vcc
    v_cndmask_b32 v38, v38, v40, s[48:49]
    v_cmp_eq_u32 vcc, 6, v10
    v_cmp_eq_u32 s[48:49], 7, v10
    s_nop 0
    v_cndmask_b32 v39, 0, v11, vcc
    v_cndmask_b32 v39, v39, v40, s[48:49]
    s_mov_b32 s16, 0
    s_mov_b64 s[70:71], 0
    s_mov_b64 s[72:73], 0
    s_mov_b64 s[74:75], 0
    s_mov_b64 s[76:77], 0
Lr0s_p1:
    s_mov_b64 exec, s[70:71]
    buffer_load_dwordx4 v[52:55], v6, s[8:11], s57 offen sc1
    s_mov_b64 exec, s[72:73]
    buffer_load_dwordx4 v[56:59], v6, s[8:11], s58 offen sc1
    s_mov_b64 exec, s[74:75]
    buffer_load_dwordx4 v[60:63], v6, s[8:11], s59 offen sc1
    s_mov_b64 exec, s[76:77]
    buffer_load_dwordx4 v[64:67], v6, s[8:11], s60 offen sc1
    s_mov_b64 exec, -1
    s_add_u32 s16, s16, 1
    s_cmp_gt_u32 s16, 100000
    s_cbranch_scc1 Lr_abort
    s_waitcnt vmcnt(7)
    v_and_b32 v11, 1, v52
    v_cmp_ne_u32 s[70:71], s39, v11
    v_mfma_f32_16x16x32_bf16 v[40:43], v[52:55], v[36:39], 0
    s_waitcnt vmcnt(6)
    v_and_b32 v11, 1, v56
    v_cmp_ne_u32 s[72:73], s39, v11
    v_mfma_f32_16x16x32_bf16 v[40:43], v[56:59], v[36:39], v[40:43]
    s_waitcnt vmcnt(5)
    v_and_b32 v11, 1, v60
    v_cmp_ne_u32 s[74:75], s39, v11
    v_mfma_f32_16x16x32_bf16 v[40:43], v[60:63], v[36:39], v[40:43]
    s_or_b64 vcc, s[70:71], s[72:73]
    s_waitcnt vmcnt(4)
    v_and_b32 v11, 1, v64
    v_cmp_ne_u32 s[76:77], s39, v11
    v_mfma_f32_16x16x32_bf16 v[40:43], v[64:67], v[36:39], v[40:43]
    s_or_b64 vcc, vcc, s[74:75]
    s_or_b64 vcc, vcc, s[76:77]
    s_cbranch_scc1 Lr0s_p1
    s_nop 4
    v_permlane16_swap_b32 v40, v42
    v_permlane16_swap_b32 v41, v43
    s_mov_b64 exec, s[50:51]
    v_add_f32 v40, v40, v42
    v_add_f32 v41, v41, v43
    v_cvt_pk_bf16_f32 v40, v40, v41
    v_min_u32 v40, s54, v40
    buffer_store_dword v40, v7, s[8:11], s36 offen sc1
    v_mov_b32 v41, -1
    buffer_store_dword v41, v7, s[8:11], s37 offen sc1
    s_mov_b64 exec, -1
    s_xor_b32 s34, s34, 16384
    s_xor_b32 s35, s35, 16384
    s_barrier
    s_sleep 2
    buffer_load_dwordx4 v[44:47], v0, s[8:11], s34 offen sc1
    buffer_load_dwordx4 v[48:51], v0, s[8:11], s34 offen offset:1024 sc1
    buffer_load_dword v10, v8, s[8:11], s35 offen sc1
    s_add_u32 s33, s33, 1
    s_bfe_u32 s39, s33, 0x10001
    s_xor_b32 s38, s38, 524288
    s_xor_b32 s57, s57, 524288
    s_xor_b32 s58, s58, 524288
    s_xor_b32 s59, s59, 524288
    s_xor_b32 s60, s60, 524288
    s_xor_b32 s36, s36, 16384
    s_xor_b32 s37, s37, 16384
    s_and_b32 s17, s33, 7
    s_mul_i32 s17, s17, 131072
    s_add_u32 s43, s45, s17
    s_bfe_u32 s66, s33, 65539
    s_add_u32 s67, s67, 22528
    s_add_u32 s42, s42, 262144
    s_add_u32 s41, s41, 262144
    s_add_u32 s40, s40, 262144
    s_add_u32 s44, s44, 22528
    s_waitcnt vmcnt(5)
    ds_read_b128 v[56:59], v9 offset:0
    ds_read_b128 v[60:63], v9 offset:1024
    ds_read_b128 v[64:67], v9 offset:2048
    ds_read_b128 v[68:71], v9 offset:3072
    v_mov_b64 v[12:13], 0
    v_mov_b64 v[14:15], 0
    v_mov_b64 v[16:17], 0
    v_mov_b64 v[18:19], 0
    v_mov_b64 v[20:21], 0
    v_mov_b64 v[22:23], 0
    v_mov_b64 v[24:25], 0
    v_mov_b64 v[26:27], 0
    v_mov_b64 v[28:29], 0
    v_mov_b64 v[30:31], 0
    v_mov_b64 v[32:33], 0
    v_mov_b64 v[34:35], 0
    s_waitcnt lgkmcnt(0)
    s_branch Lr0s_step
Lr0s_last:
    s_waitcnt vmcnt(0) lgkmcnt(0)
    s_branch Lr_exit
L_w1_0:
    s_cmp_lg_u32 s14, 1
    s_cbranch_scc1 L_w2_0
    s_barrier
    s_mov_b32 m0, 11264
    s_nop 0
    buffer_load_dwordx4 v0, s[8:11], s41 offen offset:0 lds
    buffer_load_dwordx4 v0, s[8:11], s41 offen offset:1024 lds
    s_add_u32 s41, s41, 262144
    s_waitcnt vmcnt(0)
    buffer_load_dwordx4 v[44:47], v0, s[8:11], s34 offen sc1
    buffer_load_dwordx4 v[48:51], v0, s[8:11], s34 offen offset:1024 sc1
    buffer_load_dword v10, v8, s[8:11], s35 offen sc1
    ds_read_b128 v[56:59], v9 offset:4096
    ds_read_b128 v[60:63], v9 offset:5120
    ds_read_b128 v[64:67], v9 offset:6144
    ds_read_b128 v[68:71], v9 offset:7168
    v_mov_b64 v[12:13], 0
    v_mov_b64 v[14:15], 0
    v_mov_b64 v[16:17], 0
    v_mov_b64 v[18:19], 0
    v_mov_b64 v[20:21], 0
    v_mov_b64 v[22:23], 0
    v_mov_b64 v[24:25], 0
    v_mov_b64 v[26:27], 0
    v_mov_b64 v[28:29], 0
    v_mov_b64 v[30:31], 0
    v_mov_b64 v[32:33], 0
    v_mov_b64 v[34:35], 0
    s_waitcnt lgkmcnt(0)
Lr1s_step:
    s_mov_b32 s16, 0
    s_mov_b64 s[70:71], 0
    s_mov_b64 s[72:73], 0
    s_mov_b64 s[74:75], 0
Lr1s_p2:
    s_mov_b64 exec, s[70:71]
    buffer_load_dwordx4 v[44:47], v0, s[8:11], s34 offen sc1
    s_mov_b64 exec, s[72:73]
    buffer_load_dwordx4 v[48:51], v0, s[8:11], s34 offen offset:1024 sc1
    s_mov_b64 exec, s[74:75]
    buffer_load_dword v10, v8, s[8:11], s35 offen sc1
    s_mov_b64 exec, -1
    s_add_u32 s16, s16, 1
    s_cmp_gt_u32 s16, 100000
    s_cbranch_scc1 Lr_abort
    s_waitcnt vmcnt(5)
    v_max3_u32 v11, v44, v45, v46
    v_max_u32 v11, v11, v47
    v_cmp_eq_u32 s[70:71], -1, v11
    s_waitcnt vmcnt(4)
    v_max3_u32 v11, v48, v49, v50
    v_max_u32 v11, v11, v51
    v_cmp_eq_u32 s[72:73], -1, v11
    s_waitcnt vmcnt(3)
    v_cmp_eq_u32 s[74:75], -1, v10
    s_or_b64 vcc, s[70:71], s[72:73]
    s_or_b64 vcc, vcc, s[74:75]
    s_cbranch_scc1 Lr1s_p2
    v_smfmac_f32_16x16x64_bf16 v[12:15], v[44:47], v[152:159], v1
    ds_write_b128 v0, v[44:47] offset:2048
    v_smfmac_f32_16x16x64_bf16 v[16:19], v[44:47], v[160:167], v1
    ds_write_b128 v0, v[48:51] offset:3072
    v_smfmac_f32_16x16x64_bf16 v[20:23], v[44:47], v[168:175], v1
    ds_write_b32 v8, v10 offset:8448
    v_smfmac_f32_16x16x64_bf16 v[24:27], v[44:47], v[56:63], v1
    s_waitcnt lgkmcnt(0)
    s_barrier
    ds_read_b128 v[52:55], v0 offset:0
    v_smfmac_f32_16x16x64_bf16 v[12:15], v[48:51], v[192:199], v1
    ds_read_b128 v[36:39], v0 offset:1024
    v_smfmac_f32_16x16x64_bf16 v[16:19], v[48:51], v[200:207], v1
    ds_read_b128 v[56:59], v9 offset:0
    v_smfmac_f32_16x16x64_bf16 v[20:23], v[48:51], v[208:215], v1
    ds_read_b128 v[60:63], v9 offset:1024
    v_smfmac_f32_16x16x64_bf16 v[24:27], v[48:51], v[64:71], v1
    ds_read_b128 v[40:43], v0 offset:4096
    s_waitcnt lgkmcnt(4)
    v_smfmac_f32_16x16x64_bf16 v[12:15], v[52:55], v[72:79], v1
    v_smfmac_f32_16x16x64_bf16 v[16:19], v[52:55], v[80:87], v1
    ds_read_b128 v[64:67], v9 offset:2048
    v_smfmac_f32_16x16x64_bf16 v[20:23], v[52:55], v[88:95], v1
    ds_read_b128 v[68:71], v9 offset:3072
    s_waitcnt lgkmcnt(3)
    v_smfmac_f32_16x16x64_bf16 v[24:27], v[52:55], v[56:63], v1
    v_smfmac_f32_16x16x64_bf16 v[12:15], v[36:39], v[112:119], v1
    ds_read_b128 v[52:55], v0 offset:5120
    v_smfmac_f32_16x16x64_bf16 v[16:19], v[36:39], v[120:127], v1
    ds_read_b128 v[56:59], v9 offset:8192
    v_smfmac_f32_16x16x64_bf16 v[20:23], v[36:39], v[128:135], v1
    ds_read_b128 v[60:63], v9 offset:9216
    s_waitcnt lgkmcnt(3)
    v_smfmac_f32_16x16x64_bf16 v[24:27], v[36:39], v[64:71], v1
    v_smfmac_f32_16x16x64_bf16 v[12:15], v[40:43], v[232:239], v1
    buffer_load_dwordx4 v[36:39], v0, s[8:11], s42 offen
    v_smfmac_f32_16x16x64_bf16 v[16:19], v[40:43], v[240:247], v1
    ds_read_b128 v[64:67], v9 offset:10240
    v_smfmac_f32_16x16x64_bf16 v[20:23], v[40:43], v[248:255], v1
    ds_read_b128 v[68:71], v9 offset:11264
    s_waitcnt lgkmcnt(2)
    v_smfmac_f32_16x16x64_bf16 v[24:27], v[40:43], v[56:63], v1
    s_waitcnt vmcnt(1)
    ds_read_b128 v[44:47], v0 offset:6144
    v_smfmac_f32_16x16x64_bf16 v[12:15], v[52:55], a[16:23], v1
    buffer_load_dwordx4 v[40:43], v0, s[8:11], s42 offen offset:1024
    v_smfmac_f32_16x16x64_bf16 v[16:19], v[52:55], a[24:31], v1
    ds_read_b128 v[56:59], v9 offset:12288
    v_smfmac_f32_16x16x64_bf16 v[20:23], v[52:55], a[32:39], v1
    ds_read_b128 v[60:63], v9 offset:13312
    s_waitcnt lgkmcnt(3)
    v_smfmac_f32_16x16x64_bf16 v[24:27], v[52:55], v[64:71], v1
    ds_read_b128 v[48:51], v0 offset:7168
    s_waitcnt lgkmcnt(3)
    v_smfmac_f32_16x16x64_bf16 v[12:15], v[44:47], a[56:63], v1
    ds_read_b128 v[52:55], v0 offset:8192
    v_smfmac_f32_16x16x64_bf16 v[16:19], v[44:47], a[64:71], v1
    ds_read_b128 v[64:67], v9 offset:14336
    v_smfmac_f32_16x16x64_bf16 v[20:23], v[44:47], a[72:79], v1
    ds_read_b128 v[68:71], v9 offset:15360
    s_waitcnt lgkmcnt(4)
    v_smfmac_f32_16x16x64_bf16 v[24:27], v[44:47], v[56:63], v1
    s_waitcnt lgkmcnt(3)
    v_smfmac_f32_16x16x64_bf16 v[12:15], v[48:51], a[96:103], v1
    v_smfmac_f32_16x16x64_bf16 v[16:19], v[48:51], a[104:111], v1
    ds_read_b128 v[56:59], v9 offset:16384
    s_waitcnt lgkmcnt(3)
    v_smfmac_f32_16x16x64_bf16 v[12:15], v[52:55], a[136:143], v1
    ds_read_b128 v[60:63], v9 offset:17408
    v_smfmac_f32_16x16x64_bf16 v[16:19], v[52:55], a[144:151], v1
    v_smfmac_f32_16x16x64_bf16 v[20:23], v[48:51], a[112:119], v1
    s_waitcnt lgkmcnt(2)
    v_smfmac_f32_16x16x64_bf16 v[24:27], v[48:51], v[64:71], v1
    ds_read_b128 v[64:67], v0 offset:9216
    s_nop 1
    v_add_f32 v12, v12, v14
    v_smfmac_f32_16x16x64_bf16 v[20:23], v[52:55], a[152:159], v1
    ds_read_b128 v[68:71], v0 offset:10240
    v_add_f32 v16, v16, v18
    s_waitcnt lgkmcnt(2)
    v_smfmac_f32_16x16x64_bf16 v[24:27], v[52:55], v[56:63], v1
    ds_read_b128 v[56:59], v0 offset:11264
    v_add_f32 v13, v13, v15
    v_add_f32 v17, v17, v19
    v_cvt_pk_bf16_f32 v14, v12, v16
    v_cvt_pk_bf16_f32 v15, v13, v17
    ds_write_b32 v2, v14 offset:17408
    ds_write_b32 v2, v15 offset:17696
    v_smfmac_f32_16x16x64_bf16 v[28:31], v[52:55], a[160:167], v1
    ds_read_b128 v[60:63], v0 offset:12288
    v_add_f32 v20, v20, v22
    v_add_f32 v24, v24, v26
    v_add_f32 v21, v21, v23
    v_add_f32 v25, v25, v27
    v_smfmac_f32_16x16x64_bf16 v[32:35], v[52:55], a[168:175], v1
    ds_read_b128 v[12:15], v0 offset:2048
    v_cvt_pk_bf16_f32 v22, v20, v24
    v_cvt_pk_bf16_f32 v23, v21, v25
    ds_write_b32 v2, v22 offset:19712
    ds_write_b32 v2, v23 offset:20000
    v_smfmac_f32_16x16x64_bf16 v[28:31], v[48:51], a[120:127], v1
    ds_read_b128 v[16:19], v0 offset:3072
    v_smfmac_f32_16x16x64_bf16 v[32:35], v[48:51], a[128:135], v1
    ds_read_b128 v[20:23], v0 offset:0
    v_smfmac_f32_16x16x64_bf16 v[28:31], v[44:47], a[80:87], v1
    ds_read_b128 v[24:27], v0 offset:1024
    v_smfmac_f32_16x16x64_bf16 v[32:35], v[44:47], a[88:95], v1
    s_waitcnt lgkmcnt(3)
    s_barrier
    ds_read_b128 v[44:47], v3 offset:17408
    v_smfmac_f32_16x16x64_bf16 v[28:31], v[12:15], v[176:183], v1
    ds_read_b128 v[52:55], v0 offset:4096
    v_smfmac_f32_16x16x64_bf16 v[32:35], v[12:15], v[184:191], v1
    ds_read_b128 v[12:15], v3 offset:19712
    s_waitcnt lgkmcnt(5)
    v_smfmac_f32_16x16x64_bf16 v[28:31], v[16:19], v[216:223], v1
    ds_read_b128 v[48:51], v0 offset:5120
    v_smfmac_f32_16x16x64_bf16 v[32:35], v[16:19], v[224:231], v1
    s_waitcnt lgkmcnt(5)
    v_smfmac_f32_16x16x64_bf16 v[28:31], v[20:23], v[96:103], v1
    v_smfmac_f32_16x16x64_bf16 v[32:35], v[20:23], v[104:111], v1
    ds_read_b128 v[20:23], v3 offset:17472
    s_waitcnt lgkmcnt(5)
    v_smfmac_f32_16x16x64_bf16 v[28:31], v[24:27], v[136:143], v1
    v_smfmac_f32_16x16x64_bf16 v[32:35], v[24:27], v[144:151], v1
    s_waitcnt lgkmcnt(3)
    v_smfmac_f32_16x16x64_bf16 v[28:31], v[52:55], a[0:7], v1
    v_smfmac_f32_16x16x64_bf16 v[32:35], v[52:55], a[8:15], v1
    ds_read_b128 v[52:55], v3 offset:19776
    s_waitcnt lgkmcnt(2)
    v_smfmac_f32_16x16x64_bf16 v[28:31], v[48:51], a[40:47], v1
    v_smfmac_f32_16x16x64_bf16 v[32:35], v[48:51], a[48:55], v1
    ds_read_b128 v[48:51], v3 offset:17536
    v_mfma_f32_16x16x32_bf16 v[24:27], v[12:15], v[44:47], 0
    v_mfma_f32_16x16x32_bf16 v[12:15], v[64:67], v[44:47], 0
    ds_read_b128 v[64:67], v0 offset:13312
    v_mfma_f32_16x16x32_bf16 v[16:19], v[68:71], v[44:47], 0
    ds_read_b128 v[68:71], v0 offset:14336
    s_waitcnt lgkmcnt(3)
    v_mfma_f32_16x16x32_bf16 v[24:27], v[52:55], v[20:23], v[24:27]
    ds_read_b128 v[44:47], v3 offset:19840
    v_add_f32 v28, v28, v30
    v_add_f32 v29, v29, v31
    v_mfma_f32_16x16x32_bf16 v[12:15], v[56:59], v[20:23], v[12:15]
    ds_read_b128 v[52:55], v3 offset:17600
    v_add_f32 v32, v32, v34
    v_add_f32 v33, v33, v35
    v_mfma_f32_16x16x32_bf16 v[16:19], v[60:63], v[20:23], v[16:19]
    ds_read_b128 v[56:59], v0 offset:15360
    v_cvt_pk_bf16_f32 v30, v28, v29
    v_cvt_pk_bf16_f32 v31, v32, v33
    s_waitcnt lgkmcnt(2)
    v_mfma_f32_16x16x32_bf16 v[24:27], v[44:47], v[48:51], v[24:27]
    ds_read_b128 v[20:23], v3 offset:19904
    v_lshrrev_b32 v10, 8, v0
    v_mul_u32_u24 v10, 288, v10
    v_mfma_f32_16x16x32_bf16 v[12:15], v[64:67], v[48:51], v[12:15]
    ds_read_b128 v[60:63], v0 offset:16384
    v_and_b32 v11, 0xf0, v0
    v_add_u32 v10, v10, v11
    v_mfma_f32_16x16x32_bf16 v[16:19], v[68:71], v[48:51], v[16:19]
    ds_read_b128 v[32:35], v10 offset:20288
    v_lshrrev_b32 v11, 1, v0
    v_bfi_b32 v30, 1, s66, v30
    s_waitcnt lgkmcnt(2)
    v_mfma_f32_16x16x32_bf16 v[24:27], v[20:23], v[52:55], v[24:27]
    buffer_store_dwordx2 v[30:31], v11, s[8:11], s43 offen offset:2048 sc1
    v_mov_b32 v49, 0
    v_mov_b32 v50, 0
    v_mfma_f32_16x16x32_bf16 v[12:15], v[56:59], v[52:55], v[12:15]
    v_mov_b64 v[64:65], s[68:69]
    v_mov_b64 v[66:67], s[68:69]
    s_waitcnt lgkmcnt(1)
    v_mfma_f32_16x16x32_bf16 v[16:19], v[60:63], v[52:55], v[16:19]
    s_waitcnt lgkmcnt(0)
    v_bfi_b32 v32, 1, s66, v32
    s_mov_b64 exec, s[52:53]
    buffer_store_dwordx4 v[32:35], v0, s[8:11], s43 offen sc1
    s_mov_b64 exec, -1
    v_max3_f32 v10, v24, v25, v12
    v_max3_f32 v10, v10, v13, v14
    s_nop 0
    v_max3_f32 v10, v10, v15, v16
    v_max3_f32 v10, v10, v17, v18
    v_max_f32 v10, v10, v19
    v_mov_b32 v11, v10
    s_nop 1
    v_permlane32_swap_b32 v10, v11
    v_max_f32 v10, v10, v11
    v_mov_b32 v11, v10
    s_nop 1
    v_permlane16_swap_b32 v10, v11
    v_max_f32 v10, v10, v11
    v_mul_f32 v20, s46, v10
    v_pk_fma_f32 v[24:25], v[24:25], s[46:47], v[20:21] op_sel_hi:[1,1,0] neg_lo:[0,0,1] neg_hi:[0,0,1]
    v_pk_fma_f32 v[12:13], v[12:13], s[46:47], v[20:21] op_sel_hi:[1,1,0] neg_lo:[0,0,1] neg_hi:[0,0,1]
    v_exp_f32 v24, v24
    v_exp_f32 v25, v25
    v_pk_fma_f32 v[14:15], v[14:15], s[46:47], v[20:21] op_sel_hi:[1,1,0] neg_lo:[0,0,1] neg_hi:[0,0,1]
    v_exp_f32 v12, v12
    v_exp_f32 v13, v13
    v_pk_fma_f32 v[16:17], v[16:17], s[46:47], v[20:21] op_sel_hi:[1,1,0] neg_lo:[0,0,1] neg_hi:[0,0,1]
    v_cvt_pk_bf16_f32 v48, v24, v25
    v_exp_f32 v14, v14
    v_pk_fma_f32 v[18:19], v[18:19], s[46:47], v[20:21] op_sel_hi:[1,1,0] neg_lo:[0,0,1] neg_hi:[0,0,1]
    v_cvt_pk_bf16_f32 v51, v24, v25
    v_exp_f32 v15, v15
    v_cvt_pk_bf16_f32 v44, v12, v13
    v_exp_f32 v16, v16
    v_exp_f32 v17, v17
    v_cvt_pk_bf16_f32 v45, v14, v15
    v_exp_f32 v18, v18
    v_exp_f32 v19, v19
    v_cvt_pk_bf16_f32 v46, v16, v17
    v_cvt_pk_bf16_f32 v47, v18, v19
    v_mfma_f32_16x16x16_bf16 v[68:71], v[64:65], v[48:49], 0
    v_mfma_f32_16x16x16_bf16 v[52:55], v[30:31], v[48:49], 0
    v_mfma_f32_16x16x16_bf16 v[56:59], v[30:31], v[50:51], 0
    v_mfma_f32_16x16x32_bf16 v[68:71], v[64:67], v[44:47], v[68:71]
    s_waitcnt vmcnt(3)
    v_mfma_f32_16x16x32_bf16 v[52:55], v[36:39], v[44:47], v[52:55]
    s_waitcnt vmcnt(2)
    v_mfma_f32_16x16x32_bf16 v[56:59], v[40:43], v[44:47], v[56:59]
    ds_read_b128 v[36:39], v0 offset:38912
    ds_read_b128 v[40:43], v0 offset:39936
    ds_read_b128 v[60:63], v9 offset:24576
    s_nop 0
    v_rcp_f32 v10, v68
    s_nop 0
    v_pk_mul_f32 v[52:53], v[52:53], v[10:11] op_sel_hi:[1,0]
    s_nop 0
    v_pk_mul_f32 v[56:57], v[56:57], v[10:11] op_sel_hi:[1,0]
    v_cvt_pk_bf16_f32 v16, v52, v56
    v_cvt_pk_bf16_f32 v17, v53, v57
    v_pk_mul_f32 v[54:55], v[54:55], v[10:11] op_sel_hi:[1,0]
    v_pk_mul_f32 v[58:59], v[58:59], v[10:11] op_sel_hi:[1,0]
    v_cvt_pk_bf16_f32 v18, v54, v58
    v_cvt_pk_bf16_f32 v19, v55, v59
    ds_write_b128 v3, v[16:19] offset:22080
    ds_read_b128 v[64:67], v9 offset:25600
    v_mov_b64 v[12:13], 0
    v_mov_b64 v[14:15], 0
    v_mov_b64 v[20:21], 0
    v_mov_b64 v[22:23], 0
    v_mov_b64 v[24:25], 0
    v_mov_b64 v[26:27], 0
    v_mov_b64 v[32:33], 0
    v_mov_b64 v[34:35], 0
    v_mov_b64 v[44:45], 0
    v_mov_b64 v[46:47], 0
    v_mov_b64 v[48:49], 0
    v_mov_b64 v[50:51], 0
    s_waitcnt lgkmcnt(1)
    s_barrier
    ds_read_b128 v[52:55], v4 offset:22016
    ds_read_b128 v[56:59], v4 offset:22144
    v_mov_b64 v[68:69], 0
    v_mov_b64 v[70:71], 0
    v_mov_b64 v[28:29], 0
    v_mov_b64 v[30:31], 0
    v_mov_b64 v[16:17], 0
    v_mov_b64 v[18:19], 0
    s_cmp_eq_u32 s33, 63
    s_cbranch_scc1 Lr1s_last
    s_waitcnt lgkmcnt(1)
    v_smfmac_f32_16x16x64_bf16 v[28:31], v[52:55], v[60:67], v1
    ds_read_b128 v[60:63], v0 offset:32768
    s_waitcnt lgkmcnt(1)
    v_smfmac_f32_16x16x64_bf16 v[28:31], v[56:59], v[36:43], v1
    ds_read_b128 v[64:67], v0 offset:33792
    ds_read_b128 v[36:39], v9 offset:18432
    v_smfmac_f32_16x16x64_bf16 v[12:15], v[52:55], a[176:183], v1
    ds_read_b128 v[40:43], v9 offset:19456
    v_smfmac_f32_16x16x64_bf16 v[12:15], v[56:59], a[184:191], v1
    buffer_load_dwordx4 v0, s[8:11], s41 offen offset:0 lds
    v_smfmac_f32_16x16x64_bf16 v[20:23], v[52:55], a[192:199], v1
    s_nop 0
    v_add_f32 v28, v28, v30
    v_add_f32 v29, v29, v31
    s_waitcnt lgkmcnt(2)
    v_smfmac_f32_16x16x64_bf16 v[20:23], v[56:59], v[60:67], v1
    ds_read_b128 v[60:63], v9 offset:20480
    v_cvt_pk_bf16_f32 v28, v28, v29
    v_bfi_b32 v28, 1, s39, v28
    buffer_store_dword v28, v8, s[8:11], s38 offen offset:2048 sc1
    s_waitcnt lgkmcnt(1)
    v_smfmac_f32_16x16x64_bf16 v[24:27], v[52:55], v[36:43], v1
    ds_read_b128 v[64:67], v9 offset:21504
    ds_read_b128 v[36:39], v0 offset:34816
    v_add_f32 v12, v12, v14
    v_add_f32 v13, v13, v15
    v_smfmac_f32_16x16x64_bf16 v[24:27], v[56:59], a[200:207], v1
    ds_read_b128 v[40:43], v0 offset:35840
    v_cvt_pk_bf16_f32 v12, v12, v13
    v_bfi_b32 v12, 1, s39, v12
    v_smfmac_f32_16x16x64_bf16 v[32:35], v[52:55], a[208:215], v1
    buffer_load_dwordx4 v0, s[8:11], s41 offen offset:1024 lds
    v_add_f32 v20, v20, v22
    v_add_f32 v21, v21, v23
    v_smfmac_f32_16x16x64_bf16 v[32:35], v[56:59], a[216:223], v1
    v_cvt_pk_bf16_f32 v13, v20, v21
    s_waitcnt lgkmcnt(2)
    v_smfmac_f32_16x16x64_bf16 v[44:47], v[52:55], v[60:67], v1
    ds_read_b128 v[60:63], v0 offset:36864
    v_add_f32 v24, v24, v26
    v_add_f32 v25, v25, v27
    s_waitcnt lgkmcnt(1)
    v_smfmac_f32_16x16x64_bf16 v[44:47], v[56:59], v[36:43], v1
    ds_read_b128 v[64:67], v0 offset:37888
    ds_read_b128 v[36:39], v9 offset:22528
    v_cvt_pk_bf16_f32 v14, v24, v25
    v_smfmac_f32_16x16x64_bf16 v[48:51], v[52:55], a[224:231], v1
    ds_read_b128 v[40:43], v9 offset:23552
    v_add_f32 v32, v32, v34
    v_add_f32 v33, v33, v35
    v_smfmac_f32_16x16x64_bf16 v[48:51], v[56:59], a[232:239], v1
    v_cvt_pk_bf16_f32 v15, v32, v33
    buffer_store_dwordx4 v[12:15], v0, s[8:11], s38 offen offset:0 sc1
    v_smfmac_f32_16x16x64_bf16 v[68:71], v[52:55], a[240:247], v1
    v_add_f32 v44, v44, v46
    v_add_f32 v45, v45, v47
    s_waitcnt lgkmcnt(2)
    v_smfmac_f32_16x16x64_bf16 v[68:71], v[56:59], v[60:67], v1
    v_cvt_pk_bf16_f32 v44, v44, v45
    v_bfi_b32 v44, 1, s39, v44
    s_waitcnt lgkmcnt(0)
    v_smfmac_f32_16x16x64_bf16 v[16:19], v[52:55], v[36:43], v1
    v_add_f32 v48, v48, v50
    v_add_f32 v49, v49, v51
    v_smfmac_f32_16x16x64_bf16 v[16:19], v[56:59], a[248:255], v1
    v_cvt_pk_bf16_f32 v45, v48, v49
    v_add_f32 v68, v68, v70
    v_add_f32 v69, v69, v71
    v_cvt_pk_bf16_f32 v46, v68, v69
    s_nop 3
    v_add_f32 v16, v16, v18
    v_add_f32 v17, v17, v19
    v_cvt_pk_bf16_f32 v47, v16, v17
    buffer_store_dwordx4 v[44:47], v0, s[8:11], s38 offen offset:1024 sc1
    s_sleep 6
    buffer_load_dwordx4 v[52:55], v6, s[8:11], s57 offen sc1
    buffer_load_dwordx4 v[56:59], v6, s[8:11], s58 offen sc1
    buffer_load_dwordx4 v[60:63], v6, s[8:11], s59 offen sc1
    buffer_load_dwordx4 v[64:67], v6, s[8:11], s60 offen sc1
    v_bfe_u32 v10, v0, 4, 4
    v_mov_b32 v11, 0x3f80
    v_mov_b32 v40, 0x3f800000
    v_cmp_eq_u32 vcc, 0, v10
    v_cmp_eq_u32 s[48:49], 1, v10
    s_nop 0
    v_cndmask_b32 v36, 0, v11, vcc
    v_cndmask_b32 v36, v36, v40, s[48:49]
    v_cmp_eq_u32 vcc, 2, v10
    v_cmp_eq_u32 s[48:49], 3, v10
    s_nop 0
    v_cndmask_b32 v37, 0, v11, vcc
    v_cndmask_b32 v37, v37, v40, s[48:49]
    v_cmp_eq_u32 vcc, 4, v10
    v_cmp_eq_u32 s[48:49], 5, v10
    s_nop 0
    v_cndmask_b32 v38, 0, v11, vcc
    v_cndmask_b32 v38, v38, v40, s[48:49]
    v_cmp_eq_u32 vcc, 6, v10
    v_cmp_eq_u32 s[48:49], 7, v10
    s_nop 0
    v_cndmask_b32 v39, 0, v11, vcc
    v_cndmask_b32 v39, v39, v40, s[48:49]
    s_mov_b32 s16, 0
    s_mov_b64 s[70:71], 0
    s_mov_b64 s[72:73], 0
    s_mov_b64 s[74:75], 0
    s_mov_b64 s[76:77], 0
Lr1s_p1:
    s_mov_b64 exec, s[70:71]
    buffer_load_dwordx4 v[52:55], v6, s[8:11], s57 offen sc1
    s_mov_b64 exec, s[72:73]
    buffer_load_dwordx4 v[56:59], v6, s[8:11], s58 offen sc1
    s_mov_b64 exec, s[74:75]
    buffer_load_dwordx4 v[60:63], v6, s[8:11], s59 offen sc1
    s_mov_b64 exec, s[76:77]
    buffer_load_dwordx4 v[64:67], v6, s[8:11], s60 offen sc1
    s_mov_b64 exec, -1
    s_add_u32 s16, s16, 1
    s_cmp_gt_u32 s16, 100000
    s_cbranch_scc1 Lr_abort
    s_waitcnt vmcnt(7)
    v_and_b32 v11, 1, v52
    v_cmp_ne_u32 s[70:71], s39, v11
    v_mfma_f32_16x16x32_bf16 v[40:43], v[52:55], v[36:39], 0
    s_waitcnt vmcnt(6)
    v_and_b32 v11, 1, v56
    v_cmp_ne_u32 s[72:73], s39, v11
    v_mfma_f32_16x16x32_bf16 v[40:43], v[56:59], v[36:39], v[40:43]
    s_waitcnt vmcnt(5)
    v_and_b32 v11, 1, v60
    v_cmp_ne_u32 s[74:75], s39, v11
    v_mfma_f32_16x16x32_bf16 v[40:43], v[60:63], v[36:39], v[40:43]
    s_or_b64 vcc, s[70:71], s[72:73]
    s_waitcnt vmcnt(4)
    v_and_b32 v11, 1, v64
    v_cmp_ne_u32 s[76:77], s39, v11
    v_mfma_f32_16x16x32_bf16 v[40:43], v[64:67], v[36:39], v[40:43]
    s_or_b64 vcc, vcc, s[74:75]
    s_or_b64 vcc, vcc, s[76:77]
    s_cbranch_scc1 Lr1s_p1
    s_nop 4
    v_permlane16_swap_b32 v40, v42
    v_permlane16_swap_b32 v41, v43
    s_mov_b64 exec, s[50:51]
    v_add_f32 v40, v40, v42
    v_add_f32 v41, v41, v43
    v_cvt_pk_bf16_f32 v40, v40, v41
    v_min_u32 v40, s54, v40
    buffer_store_dword v40, v7, s[8:11], s36 offen sc1
    v_mov_b32 v41, -1
    buffer_store_dword v41, v7, s[8:11], s37 offen sc1
    s_mov_b64 exec, -1
    s_xor_b32 s34, s34, 16384
    s_xor_b32 s35, s35, 16384
    s_barrier
    s_sleep 2
    buffer_load_dwordx4 v[44:47], v0, s[8:11], s34 offen sc1
    buffer_load_dwordx4 v[48:51], v0, s[8:11], s34 offen offset:1024 sc1
    buffer_load_dword v10, v8, s[8:11], s35 offen sc1
    s_add_u32 s33, s33, 1
    s_bfe_u32 s39, s33, 0x10001
    s_xor_b32 s38, s38, 524288
    s_xor_b32 s57, s57, 524288
    s_xor_b32 s58, s58, 524288
    s_xor_b32 s59, s59, 524288
    s_xor_b32 s60, s60, 524288
    s_xor_b32 s36, s36, 16384
    s_xor_b32 s37, s37, 16384
    s_and_b32 s17, s33, 7
    s_mul_i32 s17, s17, 131072
    s_add_u32 s43, s45, s17
    s_bfe_u32 s66, s33, 65539
    s_add_u32 s67, s67, 22528
    s_add_u32 s42, s42, 262144
    s_add_u32 s41, s41, 262144
    s_add_u32 s40, s40, 262144
    s_add_u32 s44, s44, 22528
    s_waitcnt vmcnt(5)
    ds_read_b128 v[56:59], v9 offset:4096
    ds_read_b128 v[60:63], v9 offset:5120
    ds_read_b128 v[64:67], v9 offset:6144
    ds_read_b128 v[68:71], v9 offset:7168
    v_mov_b64 v[12:13], 0
    v_mov_b64 v[14:15], 0
    v_mov_b64 v[16:17], 0
    v_mov_b64 v[18:19], 0
    v_mov_b64 v[20:21], 0
    v_mov_b64 v[22:23], 0
    v_mov_b64 v[24:25], 0
    v_mov_b64 v[26:27], 0
    v_mov_b64 v[28:29], 0
    v_mov_b64 v[30:31], 0
    v_mov_b64 v[32:33], 0
    v_mov_b64 v[34:35], 0
    s_waitcnt lgkmcnt(0)
    s_branch Lr1s_step
Lr1s_last:
    s_waitcnt vmcnt(0) lgkmcnt(0)
    s_branch Lr_exit
L_w2_0:
    s_cmp_lg_u32 s14, 2
    s_cbranch_scc1 L_w3_0
    s_barrier
    s_mov_b32 m0, 13312
    s_nop 0
    buffer_load_dwordx4 v0, s[8:11], s41 offen offset:0 lds
    buffer_load_dwordx4 v0, s[8:11], s41 offen offset:1024 lds
    s_add_u32 s41, s41, 262144
    s_waitcnt vmcnt(0)
    buffer_load_dwordx4 v[44:47], v0, s[8:11], s34 offen sc1
    buffer_load_dwordx4 v[48:51], v0, s[8:11], s34 offen offset:1024 sc1
    buffer_load_dword v10, v8, s[8:11], s35 offen sc1
    ds_read_b128 v[56:59], v9 offset:8192
    ds_read_b128 v[60:63], v9 offset:9216
    ds_read_b128 v[64:67], v9 offset:10240
    ds_read_b128 v[68:71], v9 offset:11264
    v_mov_b64 v[12:13], 0
    v_mov_b64 v[14:15], 0
    v_mov_b64 v[16:17], 0
    v_mov_b64 v[18:19], 0
    v_mov_b64 v[20:21], 0
    v_mov_b64 v[22:23], 0
    v_mov_b64 v[24:25], 0
    v_mov_b64 v[26:27], 0
    v_mov_b64 v[28:29], 0
    v_mov_b64 v[30:31], 0
    v_mov_b64 v[32:33], 0
    v_mov_b64 v[34:35], 0
    s_waitcnt lgkmcnt(0)
Lr2s_step:
    s_mov_b32 s16, 0
    s_mov_b64 s[70:71], 0
    s_mov_b64 s[72:73], 0
    s_mov_b64 s[74:75], 0
Lr2s_p2:
    s_mov_b64 exec, s[70:71]
    buffer_load_dwordx4 v[44:47], v0, s[8:11], s34 offen sc1
    s_mov_b64 exec, s[72:73]
    buffer_load_dwordx4 v[48:51], v0, s[8:11], s34 offen offset:1024 sc1
    s_mov_b64 exec, s[74:75]
    buffer_load_dword v10, v8, s[8:11], s35 offen sc1
    s_mov_b64 exec, -1
    s_add_u32 s16, s16, 1
    s_cmp_gt_u32 s16, 100000
    s_cbranch_scc1 Lr_abort
    s_waitcnt vmcnt(5)
    v_max3_u32 v11, v44, v45, v46
    v_max_u32 v11, v11, v47
    v_cmp_eq_u32 s[70:71], -1, v11
    s_waitcnt vmcnt(4)
    v_max3_u32 v11, v48, v49, v50
    v_max_u32 v11, v11, v51
    v_cmp_eq_u32 s[72:73], -1, v11
    s_waitcnt vmcnt(3)
    v_cmp_eq_u32 s[74:75], -1, v10
    s_or_b64 vcc, s[70:71], s[72:73]
    s_or_b64 vcc, vcc, s[74:75]
    s_cbranch_scc1 Lr2s_p2
    v_smfmac_f32_16x16x64_bf16 v[12:15], v[44:47], v[232:239], v1
    ds_write_b128 v0, v[44:47] offset:4096
    v_smfmac_f32_16x16x64_bf16 v[16:19], v[44:47], v[240:247], v1
    ds_write_b128 v0, v[48:51] offset:5120
    v_smfmac_f32_16x16x64_bf16 v[20:23], v[44:47], v[248:255], v1
    ds_write_b32 v8, v10 offset:8704
    v_smfmac_f32_16x16x64_bf16 v[24:27], v[44:47], v[56:63], v1
    s_waitcnt lgkmcnt(0)
    s_barrier
    ds_read_b128 v[52:55], v0 offset:0
    v_smfmac_f32_16x16x64_bf16 v[12:15], v[48:51], a[16:23], v1
    ds_read_b128 v[36:39], v0 offset:1024
    v_smfmac_f32_16x16x64_bf16 v[16:19], v[48:51], a[24:31], v1
    ds_read_b128 v[56:59], v9 offset:0
    v_smfmac_f32_16x16x64_bf16 v[20:23], v[48:51], a[32:39], v1
    ds_read_b128 v[60:63], v9 offset:1024
    v_smfmac_f32_16x16x64_bf16 v[24:27], v[48:51], v[64:71], v1
    ds_read_b128 v[40:43], v0 offset:2048
    s_waitcnt lgkmcnt(4)
    v_smfmac_f32_16x16x64_bf16 v[12:15], v[52:55], v[72:79], v1
    v_smfmac_f32_16x16x64_bf16 v[16:19], v[52:55], v[80:87], v1
    ds_read_b128 v[64:67], v9 offset:2048
    v_smfmac_f32_16x16x64_bf16 v[20:23], v[52:55], v[88:95], v1
    ds_read_b128 v[68:71], v9 offset:3072
    s_waitcnt lgkmcnt(3)
    v_smfmac_f32_16x16x64_bf16 v[24:27], v[52:55], v[56:63], v1
    v_smfmac_f32_16x16x64_bf16 v[12:15], v[36:39], v[112:119], v1
    ds_read_b128 v[52:55], v0 offset:3072
    v_smfmac_f32_16x16x64_bf16 v[16:19], v[36:39], v[120:127], v1
    ds_read_b128 v[56:59], v9 offset:4096
    v_smfmac_f32_16x16x64_bf16 v[20:23], v[36:39], v[128:135], v1
    ds_read_b128 v[60:63], v9 offset:5120
    s_waitcnt lgkmcnt(3)
    v_smfmac_f32_16x16x64_bf16 v[24:27], v[36:39], v[64:71], v1
    v_smfmac_f32_16x16x64_bf16 v[12:15], v[40:43], v[152:159], v1
    buffer_load_dwordx4 v[36:39], v0, s[8:11], s42 offen
    v_smfmac_f32_16x16x64_bf16 v[16:19], v[40:43], v[160:167], v1
    ds_read_b128 v[64:67], v9 offset:6144
    v_smfmac_f32_16x16x64_bf16 v[20:23], v[40:43], v[168:175], v1
    ds_read_b128 v[68:71], v9 offset:7168
    s_waitcnt lgkmcnt(2)
    v_smfmac_f32_16x16x64_bf16 v[24:27], v[40:43], v[56:63], v1
    s_waitcnt vmcnt(1)
    ds_read_b128 v[44:47], v0 offset:6144
    v_smfmac_f32_16x16x64_bf16 v[12:15], v[52:55], v[192:199], v1
    buffer_load_dwordx4 v[40:43], v0, s[8:11], s42 offen offset:1024
    v_smfmac_f32_16x16x64_bf16 v[16:19], v[52:55], v[200:207], v1
    ds_read_b128 v[56:59], v9 offset:12288
    v_smfmac_f32_16x16x64_bf16 v[20:23], v[52:55], v[208:215], v1
    ds_read_b128 v[60:63], v9 offset:13312
    s_waitcnt lgkmcnt(3)
    v_smfmac_f32_16x16x64_bf16 v[24:27], v[52:55], v[64:71], v1
    ds_read_b128 v[48:51], v0 offset:7168
    s_waitcnt lgkmcnt(3)
    v_smfmac_f32_16x16x64_bf16 v[12:15], v[44:47], a[56:63], v1
    ds_read_b128 v[52:55], v0 offset:8192
    v_smfmac_f32_16x16x64_bf16 v[16:19], v[44:47], a[64:71], v1
    ds_read_b128 v[64:67], v9 offset:14336
    v_smfmac_f32_16x16x64_bf16 v[20:23], v[44:47], a[72:79], v1
    ds_read_b128 v[68:71], v9 offset:15360
    s_waitcnt lgkmcnt(4)
    v_smfmac_f32_16x16x64_bf16 v[24:27], v[44:47], v[56:63], v1
    s_waitcnt lgkmcnt(3)
    v_smfmac_f32_16x16x64_bf16 v[12:15], v[48:51], a[96:103], v1
    v_smfmac_f32_16x16x64_bf16 v[16:19], v[48:51], a[104:111], v1
    ds_read_b128 v[56:59], v9 offset:16384
    s_waitcnt lgkmcnt(3)
    v_smfmac_f32_16x16x64_bf16 v[12:15], v[52:55], a[136:143], v1
    ds_read_b128 v[60:63], v9 offset:17408
    v_smfmac_f32_16x16x64_bf16 v[16:19], v[52:55], a[144:151], v1
    v_smfmac_f32_16x16x64_bf16 v[20:23], v[48:51], a[112:119], v1
    s_waitcnt lgkmcnt(2)
    v_smfmac_f32_16x16x64_bf16 v[24:27], v[48:51], v[64:71], v1
    ds_read_b128 v[64:67], v0 offset:9216
    s_nop 1
    v_add_f32 v12, v12, v14
    v_smfmac_f32_16x16x64_bf16 v[20:23], v[52:55], a[152:159], v1
    ds_read_b128 v[68:71], v0 offset:10240
    v_add_f32 v16, v16, v18
    s_waitcnt lgkmcnt(2)
    v_smfmac_f32_16x16x64_bf16 v[24:27], v[52:55], v[56:63], v1
    ds_read_b128 v[56:59], v0 offset:11264
    v_add_f32 v13, v13, v15
    v_add_f32 v17, v17, v19
    v_cvt_pk_bf16_f32 v14, v12, v16
    v_cvt_pk_bf16_f32 v15, v13, v17
    ds_write_b32 v2, v14 offset:17408
    ds_write_b32 v2, v15 offset:17696
    v_smfmac_f32_16x16x64_bf16 v[28:31], v[52:55], a[160:167], v1
    ds_read_b128 v[60:63], v0 offset:12288
    v_add_f32 v20, v20, v22
    v_add_f32 v24, v24, v26
    v_add_f32 v21, v21, v23
    v_add_f32 v25, v25, v27
    v_smfmac_f32_16x16x64_bf16 v[32:35], v[52:55], a[168:175], v1
    ds_read_b128 v[12:15], v0 offset:4096
    v_cvt_pk_bf16_f32 v22, v20, v24
    v_cvt_pk_bf16_f32 v23, v21, v25
    ds_write_b32 v2, v22 offset:19712
    ds_write_b32 v2, v23 offset:20000
    v_smfmac_f32_16x16x64_bf16 v[28:31], v[48:51], a[120:127], v1
    ds_read_b128 v[16:19], v0 offset:5120
    v_smfmac_f32_16x16x64_bf16 v[32:35], v[48:51], a[128:135], v1
    ds_read_b128 v[20:23], v0 offset:0
    v_smfmac_f32_16x16x64_bf16 v[28:31], v[44:47], a[80:87], v1
    ds_read_b128 v[24:27], v0 offset:1024
    v_smfmac_f32_16x16x64_bf16 v[32:35], v[44:47], a[88:95], v1
    s_waitcnt lgkmcnt(3)
    s_barrier
    ds_read_b128 v[44:47], v3 offset:17408
    v_smfmac_f32_16x16x64_bf16 v[28:31], v[12:15], a[0:7], v1
    ds_read_b128 v[52:55], v0 offset:2048
    v_smfmac_f32_16x16x64_bf16 v[32:35], v[12:15], a[8:15], v1
    ds_read_b128 v[12:15], v3 offset:19712
    s_waitcnt lgkmcnt(5)
    v_smfmac_f32_16x16x64_bf16 v[28:31], v[16:19], a[40:47], v1
    ds_read_b128 v[48:51], v0 offset:3072
    v_smfmac_f32_16x16x64_bf16 v[32:35], v[16:19], a[48:55], v1
    s_waitcnt lgkmcnt(5)
    v_smfmac_f32_16x16x64_bf16 v[28:31], v[20:23], v[96:103], v1
    v_smfmac_f32_16x16x64_bf16 v[32:35], v[20:23], v[104:111], v1
    ds_read_b128 v[20:23], v3 offset:17472
    s_waitcnt lgkmcnt(5)
    v_smfmac_f32_16x16x64_bf16 v[28:31], v[24:27], v[136:143], v1
    v_smfmac_f32_16x16x64_bf16 v[32:35], v[24:27], v[144:151], v1
    s_waitcnt lgkmcnt(3)
    v_smfmac_f32_16x16x64_bf16 v[28:31], v[52:55], v[176:183], v1
    v_smfmac_f32_16x16x64_bf16 v[32:35], v[52:55], v[184:191], v1
    ds_read_b128 v[52:55], v3 offset:19776
    s_waitcnt lgkmcnt(2)
    v_smfmac_f32_16x16x64_bf16 v[28:31], v[48:51], v[216:223], v1
    v_smfmac_f32_16x16x64_bf16 v[32:35], v[48:51], v[224:231], v1
    ds_read_b128 v[48:51], v3 offset:17536
    v_mfma_f32_16x16x32_bf16 v[24:27], v[12:15], v[44:47], 0
    v_mfma_f32_16x16x32_bf16 v[12:15], v[64:67], v[44:47], 0
    ds_read_b128 v[64:67], v0 offset:13312
    v_mfma_f32_16x16x32_bf16 v[16:19], v[68:71], v[44:47], 0
    ds_read_b128 v[68:71], v0 offset:14336
    s_waitcnt lgkmcnt(3)
    v_mfma_f32_16x16x32_bf16 v[24:27], v[52:55], v[20:23], v[24:27]
    ds_read_b128 v[44:47], v3 offset:19840
    v_add_f32 v28, v28, v30
    v_add_f32 v29, v29, v31
    v_mfma_f32_16x16x32_bf16 v[12:15], v[56:59], v[20:23], v[12:15]
    ds_read_b128 v[52:55], v3 offset:17600
    v_add_f32 v32, v32, v34
    v_add_f32 v33, v33, v35
    v_mfma_f32_16x16x32_bf16 v[16:19], v[60:63], v[20:23], v[16:19]
    ds_read_b128 v[56:59], v0 offset:15360
    v_cvt_pk_bf16_f32 v30, v28, v29
    v_cvt_pk_bf16_f32 v31, v32, v33
    s_waitcnt lgkmcnt(2)
    v_mfma_f32_16x16x32_bf16 v[24:27], v[44:47], v[48:51], v[24:27]
    ds_read_b128 v[20:23], v3 offset:19904
    v_lshrrev_b32 v10, 8, v0
    v_mul_u32_u24 v10, 288, v10
    v_mfma_f32_16x16x32_bf16 v[12:15], v[64:67], v[48:51], v[12:15]
    ds_read_b128 v[60:63], v0 offset:16384
    v_and_b32 v11, 0xf0, v0
    v_add_u32 v10, v10, v11
    v_mfma_f32_16x16x32_bf16 v[16:19], v[68:71], v[48:51], v[16:19]
    ds_read_b128 v[32:35], v10 offset:20864
    v_lshrrev_b32 v11, 1, v0
    v_bfi_b32 v30, 1, s66, v30
    s_waitcnt lgkmcnt(2)
    v_mfma_f32_16x16x32_bf16 v[24:27], v[20:23], v[52:55], v[24:27]
    buffer_store_dwordx2 v[30:31], v11, s[8:11], s43 offen offset:2048 sc1
    v_mov_b32 v49, 0
    v_mov_b32 v50, 0
    v_mfma_f32_16x16x32_bf16 v[12:15], v[56:59], v[52:55], v[12:15]
    v_mov_b64 v[64:65], s[68:69]
    v_mov_b64 v[66:67], s[68:69]
    s_waitcnt lgkmcnt(1)
    v_mfma_f32_16x16x32_bf16 v[16:19], v[60:63], v[52:55], v[16:19]
    s_waitcnt lgkmcnt(0)
    v_bfi_b32 v32, 1, s66, v32
    s_mov_b64 exec, s[52:53]
    buffer_store_dwordx4 v[32:35], v0, s[8:11], s43 offen sc1
    s_mov_b64 exec, -1
    v_max3_f32 v10, v24, v25, v12
    v_max3_f32 v10, v10, v13, v14
    s_nop 0
    v_max3_f32 v10, v10, v15, v16
    v_max3_f32 v10, v10, v17, v18
    v_max_f32 v10, v10, v19
    v_mov_b32 v11, v10
    s_nop 1
    v_permlane32_swap_b32 v10, v11
    v_max_f32 v10, v10, v11
    v_mov_b32 v11, v10
    s_nop 1
    v_permlane16_swap_b32 v10, v11
    v_max_f32 v10, v10, v11
    v_mul_f32 v20, s46, v10
    v_pk_fma_f32 v[24:25], v[24:25], s[46:47], v[20:21] op_sel_hi:[1,1,0] neg_lo:[0,0,1] neg_hi:[0,0,1]
    v_pk_fma_f32 v[12:13], v[12:13], s[46:47], v[20:21] op_sel_hi:[1,1,0] neg_lo:[0,0,1] neg_hi:[0,0,1]
    v_exp_f32 v24, v24
    v_exp_f32 v25, v25
    v_pk_fma_f32 v[14:15], v[14:15], s[46:47], v[20:21] op_sel_hi:[1,1,0] neg_lo:[0,0,1] neg_hi:[0,0,1]
    v_exp_f32 v12, v12
    v_exp_f32 v13, v13
    v_pk_fma_f32 v[16:17], v[16:17], s[46:47], v[20:21] op_sel_hi:[1,1,0] neg_lo:[0,0,1] neg_hi:[0,0,1]
    v_cvt_pk_bf16_f32 v48, v24, v25
    v_exp_f32 v14, v14
    v_pk_fma_f32 v[18:19], v[18:19], s[46:47], v[20:21] op_sel_hi:[1,1,0] neg_lo:[0,0,1] neg_hi:[0,0,1]
    v_cvt_pk_bf16_f32 v51, v24, v25
    v_exp_f32 v15, v15
    v_cvt_pk_bf16_f32 v44, v12, v13
    v_exp_f32 v16, v16
    v_exp_f32 v17, v17
    v_cvt_pk_bf16_f32 v45, v14, v15
    v_exp_f32 v18, v18
    v_exp_f32 v19, v19
    v_cvt_pk_bf16_f32 v46, v16, v17
    v_cvt_pk_bf16_f32 v47, v18, v19
    v_mfma_f32_16x16x16_bf16 v[68:71], v[64:65], v[48:49], 0
    v_mfma_f32_16x16x16_bf16 v[52:55], v[30:31], v[48:49], 0
    v_mfma_f32_16x16x16_bf16 v[56:59], v[30:31], v[50:51], 0
    v_mfma_f32_16x16x32_bf16 v[68:71], v[64:67], v[44:47], v[68:71]
    s_waitcnt vmcnt(3)
    v_mfma_f32_16x16x32_bf16 v[52:55], v[36:39], v[44:47], v[52:55]
    s_waitcnt vmcnt(2)
    v_mfma_f32_16x16x32_bf16 v[56:59], v[40:43], v[44:47], v[56:59]
    ds_read_b128 v[36:39], v0 offset:47104
    ds_read_b128 v[40:43], v0 offset:48128
    ds_read_b128 v[60:63], v9 offset:24576
    s_nop 0
    v_rcp_f32 v10, v68
    s_nop 0
    v_pk_mul_f32 v[52:53], v[52:53], v[10:11] op_sel_hi:[1,0]
    s_nop 0
    v_pk_mul_f32 v[56:57], v[56:57], v[10:11] op_sel_hi:[1,0]
    v_cvt_pk_bf16_f32 v16, v52, v56
    v_cvt_pk_bf16_f32 v17, v53, v57
    v_pk_mul_f32 v[54:55], v[54:55], v[10:11] op_sel_hi:[1,0]
    v_pk_mul_f32 v[58:59], v[58:59], v[10:11] op_sel_hi:[1,0]
    v_cvt_pk_bf16_f32 v18, v54, v58
    v_cvt_pk_bf16_f32 v19, v55, v59
    ds_write_b128 v3, v[16:19] offset:22144
    ds_read_b128 v[64:67], v9 offset:25600
    v_mov_b64 v[12:13], 0
    v_mov_b64 v[14:15], 0
    v_mov_b64 v[20:21], 0
    v_mov_b64 v[22:23], 0
    v_mov_b64 v[24:25], 0
    v_mov_b64 v[26:27], 0
    v_mov_b64 v[32:33], 0
    v_mov_b64 v[34:35], 0
    v_mov_b64 v[44:45], 0
    v_mov_b64 v[46:47], 0
    v_mov_b64 v[48:49], 0
    v_mov_b64 v[50:51], 0
    s_waitcnt lgkmcnt(1)
    s_barrier
    ds_read_b128 v[52:55], v4 offset:22016
    ds_read_b128 v[56:59], v4 offset:22144
    v_mov_b64 v[68:69], 0
    v_mov_b64 v[70:71], 0
    v_mov_b64 v[28:29], 0
    v_mov_b64 v[30:31], 0
    v_mov_b64 v[16:17], 0
    v_mov_b64 v[18:19], 0
    s_cmp_eq_u32 s33, 63
    s_cbranch_scc1 Lr2s_last
    s_waitcnt lgkmcnt(1)
    v_smfmac_f32_16x16x64_bf16 v[28:31], v[52:55], v[60:67], v1
    ds_read_b128 v[60:63], v0 offset:40960
    s_waitcnt lgkmcnt(1)
    v_smfmac_f32_16x16x64_bf16 v[28:31], v[56:59], v[36:43], v1
    ds_read_b128 v[64:67], v0 offset:41984
    ds_read_b128 v[36:39], v9 offset:18432
    v_smfmac_f32_16x16x64_bf16 v[12:15], v[52:55], a[176:183], v1
    ds_read_b128 v[40:43], v9 offset:19456
    v_smfmac_f32_16x16x64_bf16 v[12:15], v[56:59], a[184:191], v1
    buffer_load_dwordx4 v0, s[8:11], s41 offen offset:0 lds
    v_smfmac_f32_16x16x64_bf16 v[20:23], v[52:55], a[192:199], v1
    s_nop 0
    v_add_f32 v28, v28, v30
    v_add_f32 v29, v29, v31
    s_waitcnt lgkmcnt(2)
    v_smfmac_f32_16x16x64_bf16 v[20:23], v[56:59], v[60:67], v1
    ds_read_b128 v[60:63], v9 offset:20480
    v_cvt_pk_bf16_f32 v28, v28, v29
    v_bfi_b32 v28, 1, s39, v28
    buffer_store_dword v28, v8, s[8:11], s38 offen offset:2048 sc1
    s_waitcnt lgkmcnt(1)
    v_smfmac_f32_16x16x64_bf16 v[24:27], v[52:55], v[36:43], v1
    ds_read_b128 v[64:67], v9 offset:21504
    ds_read_b128 v[36:39], v0 offset:43008
    v_add_f32 v12, v12, v14
    v_add_f32 v13, v13, v15
    v_smfmac_f32_16x16x64_bf16 v[24:27], v[56:59], a[200:207], v1
    ds_read_b128 v[40:43], v0 offset:44032
    v_cvt_pk_bf16_f32 v12, v12, v13
    v_bfi_b32 v12, 1, s39, v12
    v_smfmac_f32_16x16x64_bf16 v[32:35], v[52:55], a[208:215], v1
    buffer_load_dwordx4 v0, s[8:11], s41 offen offset:1024 lds
    v_add_f32 v20, v20, v22
    v_add_f32 v21, v21, v23
    v_smfmac_f32_16x16x64_bf16 v[32:35], v[56:59], a[216:223], v1
    v_cvt_pk_bf16_f32 v13, v20, v21
    s_waitcnt lgkmcnt(2)
    v_smfmac_f32_16x16x64_bf16 v[44:47], v[52:55], v[60:67], v1
    ds_read_b128 v[60:63], v0 offset:45056
    v_add_f32 v24, v24, v26
    v_add_f32 v25, v25, v27
    s_waitcnt lgkmcnt(1)
    v_smfmac_f32_16x16x64_bf16 v[44:47], v[56:59], v[36:43], v1
    ds_read_b128 v[64:67], v0 offset:46080
    ds_read_b128 v[36:39], v9 offset:22528
    v_cvt_pk_bf16_f32 v14, v24, v25
    v_smfmac_f32_16x16x64_bf16 v[48:51], v[52:55], a[224:231], v1
    ds_read_b128 v[40:43], v9 offset:23552
    v_add_f32 v32, v32, v34
    v_add_f32 v33, v33, v35
    v_smfmac_f32_16x16x64_bf16 v[48:51], v[56:59], a[232:239], v1
    v_cvt_pk_bf16_f32 v15, v32, v33
    buffer_store_dwordx4 v[12:15], v0, s[8:11], s38 offen offset:0 sc1
    v_smfmac_f32_16x16x64_bf16 v[68:71], v[52:55], a[240:247], v1
    v_add_f32 v44, v44, v46
    v_add_f32 v45, v45, v47
    s_waitcnt lgkmcnt(2)
    v_smfmac_f32_16x16x64_bf16 v[68:71], v[56:59], v[60:67], v1
    v_cvt_pk_bf16_f32 v44, v44, v45
    v_bfi_b32 v44, 1, s39, v44
    s_waitcnt lgkmcnt(0)
    v_smfmac_f32_16x16x64_bf16 v[16:19], v[52:55], v[36:43], v1
    v_add_f32 v48, v48, v50
    v_add_f32 v49, v49, v51
    v_smfmac_f32_16x16x64_bf16 v[16:19], v[56:59], a[248:255], v1
    v_cvt_pk_bf16_f32 v45, v48, v49
    v_add_f32 v68, v68, v70
    v_add_f32 v69, v69, v71
    v_cvt_pk_bf16_f32 v46, v68, v69
    s_nop 3
    v_add_f32 v16, v16, v18
    v_add_f32 v17, v17, v19
    v_cvt_pk_bf16_f32 v47, v16, v17
    buffer_store_dwordx4 v[44:47], v0, s[8:11], s38 offen offset:1024 sc1
    s_cmp_eq_u32 s62, 0
    s_cbranch_scc1 Lr2s_nojob
    s_sleep 6
    buffer_load_dwordx4 v[52:55], v6, s[8:11], s57 offen sc1
    buffer_load_dwordx4 v[56:59], v6, s[8:11], s58 offen sc1
    buffer_load_dwordx4 v[60:63], v6, s[8:11], s59 offen sc1
    buffer_load_dwordx4 v[64:67], v6, s[8:11], s60 offen sc1
    v_bfe_u32 v10, v0, 4, 4
    v_mov_b32 v11, 0x3f80
    v_mov_b32 v40, 0x3f800000
    v_cmp_eq_u32 vcc, 0, v10
    v_cmp_eq_u32 s[48:49], 1, v10
    s_nop 0
    v_cndmask_b32 v36, 0, v11, vcc
    v_cndmask_b32 v36, v36, v40, s[48:49]
    v_cmp_eq_u32 vcc, 2, v10
    v_cmp_eq_u32 s[48:49], 3, v10
    s_nop 0
    v_cndmask_b32 v37, 0, v11, vcc
    v_cndmask_b32 v37, v37, v40, s[48:49]
    v_cmp_eq_u32 vcc, 4, v10
    v_cmp_eq_u32 s[48:49], 5, v10
    s_nop 0
    v_cndmask_b32 v38, 0, v11, vcc
    v_cndmask_b32 v38, v38, v40, s[48:49]
    v_cmp_eq_u32 vcc, 6, v10
    v_cmp_eq_u32 s[48:49], 7, v10
    s_nop 0
    v_cndmask_b32 v39, 0, v11, vcc
    v_cndmask_b32 v39, v39, v40, s[48:49]
    s_mov_b32 s16, 0
    s_mov_b64 s[70:71], 0
    s_mov_b64 s[72:73], 0
    s_mov_b64 s[74:75], 0
    s_mov_b64 s[76:77], 0
Lr2s_p1:
    s_mov_b64 exec, s[70:71]
    buffer_load_dwordx4 v[52:55], v6, s[8:11], s57 offen sc1
    s_mov_b64 exec, s[72:73]
    buffer_load_dwordx4 v[56:59], v6, s[8:11], s58 offen sc1
    s_mov_b64 exec, s[74:75]
    buffer_load_dwordx4 v[60:63], v6, s[8:11], s59 offen sc1
    s_mov_b64 exec, s[76:77]
    buffer_load_dwordx4 v[64:67], v6, s[8:11], s60 offen sc1
    s_mov_b64 exec, -1
    s_add_u32 s16, s16, 1
    s_cmp_gt_u32 s16, 100000
    s_cbranch_scc1 Lr_abort
    s_waitcnt vmcnt(7)
    v_xor_b32 v10, v52, v53
    v_xor_b32 v11, v54, v55
    v_or_b32 v10, v10, v11
    v_xor_b32 v11, v52, v54
    v_or_b32 v10, v10, v11
    v_xor_b32 v11, s39, v52
    v_or_b32 v10, v10, v11
    v_and_b32 v10, 1, v10
    v_cmp_ne_u32 s[70:71], 0, v10
    v_mfma_f32_16x16x32_bf16 v[40:43], v[52:55], v[36:39], 0
    s_waitcnt vmcnt(6)
    v_xor_b32 v10, v56, v57
    v_xor_b32 v11, v58, v59
    v_or_b32 v10, v10, v11
    v_xor_b32 v11, v56, v58
    v_or_b32 v10, v10, v11
    v_xor_b32 v11, s39, v56
    v_or_b32 v10, v10, v11
    v_and_b32 v10, 1, v10
    v_cmp_ne_u32 s[72:73], 0, v10
    v_mfma_f32_16x16x32_bf16 v[40:43], v[56:59], v[36:39], v[40:43]
    s_waitcnt vmcnt(5)
    v_xor_b32 v10, v60, v61
    v_xor_b32 v11, v62, v63
    v_or_b32 v10, v10, v11
    v_xor_b32 v11, v60, v62
    v_or_b32 v10, v10, v11
    v_xor_b32 v11, s39, v60
    v_or_b32 v10, v10, v11
    v_and_b32 v10, 1, v10
    v_cmp_ne_u32 s[74:75], 0, v10
    v_mfma_f32_16x16x32_bf16 v[40:43], v[60:63], v[36:39], v[40:43]
    s_or_b64 vcc, s[70:71], s[72:73]
    s_waitcnt vmcnt(4)
    v_xor_b32 v10, v64, v65
    v_xor_b32 v11, v66, v67
    v_or_b32 v10, v10, v11
    v_xor_b32 v11, v64, v66
    v_or_b32 v10, v10, v11
    v_xor_b32 v11, s39, v64
    v_or_b32 v10, v10, v11
    v_and_b32 v10, 1, v10
    v_cmp_ne_u32 s[76:77], 0, v10
    v_mfma_f32_16x16x32_bf16 v[40:43], v[64:67], v[36:39], v[40:43]
    s_or_b64 vcc, vcc, s[74:75]
    s_or_b64 vcc, vcc, s[76:77]
    s_cbranch_scc1 Lr2s_p1
    s_nop 4
    v_permlane16_swap_b32 v40, v42
    v_permlane16_swap_b32 v41, v43
    s_mov_b64 exec, s[50:51]
    v_add_f32 v40, v40, v42
    v_add_f32 v41, v41, v43
    v_cvt_pk_bf16_f32 v40, v40, v41
    v_min_u32 v40, s54, v40
    buffer_store_dword v40, v7, s[8:11], s36 offen sc1
    v_mov_b32 v41, -1
    buffer_store_dword v41, v7, s[8:11], s37 offen sc1
    s_mov_b64 exec, -1
    s_branch Lr2s_jobdone
Lr2s_nojob:
Lr2s_jobdone:
    s_xor_b32 s34, s34, 16384
    s_xor_b32 s35, s35, 16384
    s_barrier
    s_sleep 2
    buffer_load_dwordx4 v[44:47], v0, s[8:11], s34 offen sc1
    buffer_load_dwordx4 v[48:51], v0, s[8:11], s34 offen offset:1024 sc1
    buffer_load_dword v10, v8, s[8:11], s35 offen sc1
    s_add_u32 s33, s33, 1
    s_bfe_u32 s39, s33, 0x10001
    s_xor_b32 s38, s38, 524288
    s_xor_b32 s57, s57, 524288
    s_xor_b32 s58, s58, 524288
    s_xor_b32 s59, s59, 524288
    s_xor_b32 s60, s60, 524288
    s_xor_b32 s36, s36, 16384
    s_xor_b32 s37, s37, 16384
    s_and_b32 s17, s33, 7
    s_mul_i32 s17, s17, 131072
    s_add_u32 s43, s45, s17
    s_bfe_u32 s66, s33, 65539
    s_add_u32 s67, s67, 22528
    s_add_u32 s42, s42, 262144
    s_add_u32 s41, s41, 262144
    s_add_u32 s40, s40, 262144
    s_add_u32 s44, s44, 22528
    s_waitcnt vmcnt(6)
    ds_read_b128 v[56:59], v9 offset:8192
    ds_read_b128 v[60:63], v9 offset:9216
    ds_read_b128 v[64:67], v9 offset:10240
    ds_read_b128 v[68:71], v9 offset:11264
    v_mov_b64 v[12:13], 0
    v_mov_b64 v[14:15], 0
    v_mov_b64 v[16:17], 0
    v_mov_b64 v[18:19], 0
    v_mov_b64 v[20:21], 0
    v_mov_b64 v[22:23], 0
    v_mov_b64 v[24:25], 0
    v_mov_b64 v[26:27], 0
    v_mov_b64 v[28:29], 0
    v_mov_b64 v[30:31], 0
    v_mov_b64 v[32:33], 0
    v_mov_b64 v[34:35], 0
    s_waitcnt lgkmcnt(0)
    s_branch Lr2s_step
Lr2s_last:
    s_waitcnt vmcnt(0) lgkmcnt(0)
    s_branch Lr_exit
L_w3_0:
    s_mov_b32 s16, 0
    s_add_u32 s17, s44, 128
    v_and_b32 v11, 16, v8
    v_lshlrev_b32 v11, 3, v11
    v_and_or_b32 v11, v8, 12, v11
Lr3s_fw_11:
    buffer_load_dword v10, v11, s[8:11], s17 offen sc1
    s_add_u32 s16, s16, 1
    s_cmp_gt_u32 s16, 100000
    s_cbranch_scc1 Lr_abort
    s_waitcnt vmcnt(0)
    v_cmp_eq_u32 vcc, 0, v10
    s_nop 0
    s_cbranch_vccz Lr3s_fw_11d
    s_sleep 4
    s_branch Lr3s_fw_11
Lr3s_fw_11d:
    s_barrier
    s_mov_b32 m0, 15360
    s_nop 0
    buffer_load_dwordx4 v0, s[8:11], s41 offen offset:0 lds
    buffer_load_dwordx4 v0, s[8:11], s41 offen offset:1024 lds
    s_add_u32 s41, s41, 262144
    s_waitcnt vmcnt(0)
    buffer_load_dwordx4 v[44:47], v0, s[8:11], s34 offen sc1
    buffer_load_dwordx4 v[48:51], v0, s[8:11], s34 offen offset:1024 sc1
    buffer_load_dword v10, v8, s[8:11], s35 offen sc1
    ds_read_b128 v[56:59], v9 offset:12288
    ds_read_b128 v[60:63], v9 offset:13312
    ds_read_b128 v[64:67], v9 offset:14336
    ds_read_b128 v[68:71], v9 offset:15360
    v_mov_b64 v[12:13], 0
    v_mov_b64 v[14:15], 0
    v_mov_b64 v[16:17], 0
    v_mov_b64 v[18:19], 0
    v_mov_b64 v[20:21], 0
    v_mov_b64 v[22:23], 0
    v_mov_b64 v[24:25], 0
    v_mov_b64 v[26:27], 0
    v_mov_b64 v[28:29], 0
    v_mov_b64 v[30:31], 0
    v_mov_b64 v[32:33], 0
    v_mov_b64 v[34:35], 0
    s_waitcnt lgkmcnt(0)
Lr3s_step:
    s_mov_b32 s16, 0
    s_mov_b64 s[70:71], 0
    s_mov_b64 s[72:73], 0
    s_mov_b64 s[74:75], 0
Lr3s_p2:
    s_mov_b64 exec, s[70:71]
    buffer_load_dwordx4 v[44:47], v0, s[8:11], s34 offen sc1
    s_mov_b64 exec, s[72:73]
    buffer_load_dwordx4 v[48:51], v0, s[8:11], s34 offen offset:1024 sc1
    s_mov_b64 exec, s[74:75]
    buffer_load_dword v10, v8, s[8:11], s35 offen sc1
    s_mov_b64 exec, -1
    s_add_u32 s16, s16, 1
    s_cmp_gt_u32 s16, 100000
    s_cbranch_scc1 Lr_abort
    s_waitcnt vmcnt(5)
    v_max3_u32 v11, v44, v45, v46
    v_max_u32 v11, v11, v47
    v_cmp_eq_u32 s[70:71], -1, v11
    s_waitcnt vmcnt(4)
    v_max3_u32 v11, v48, v49, v50
    v_max_u32 v11, v11, v51
    v_cmp_eq_u32 s[72:73], -1, v11
    s_waitcnt vmcnt(3)
    v_cmp_eq_u32 s[74:75], -1, v10
    s_or_b64 vcc, s[70:71], s[72:73]
    s_or_b64 vcc, vcc, s[74:75]
    s_cbranch_scc1 Lr3s_p2
    v_smfmac_f32_16x16x64_bf16 v[12:15], v[44:47], a[56:63], v1
    ds_write_b128 v0, v[44:47] offset:6144
    v_smfmac_f32_16x16x64_bf16 v[16:19], v[44:47], a[64:71], v1
    ds_write_b128 v0, v[48:51] offset:7168
    v_smfmac_f32_16x16x64_bf16 v[20:23], v[44:47], a[72:79], v1
    ds_write_b32 v8, v10 offset:8960
    v_smfmac_f32_16x16x64_bf16 v[24:27], v[44:47], v[56:63], v1
    s_waitcnt lgkmcnt(0)
    s_barrier
    ds_read_b128 v[52:55], v0 offset:0
    v_smfmac_f32_16x16x64_bf16 v[12:15], v[48:51], a[96:103], v1
    ds_read_b128 v[36:39], v0 offset:1024
    v_smfmac_f32_16x16x64_bf16 v[16:19], v[48:51], a[104:111], v1
    ds_read_b128 v[56:59], v9 offset:0
    v_smfmac_f32_16x16x64_bf16 v[20:23], v[48:51], a[112:119], v1
    ds_read_b128 v[60:63], v9 offset:1024
    v_smfmac_f32_16x16x64_bf16 v[24:27], v[48:51], v[64:71], v1
    ds_read_b128 v[40:43], v0 offset:2048
    s_waitcnt lgkmcnt(4)
    v_smfmac_f32_16x16x64_bf16 v[12:15], v[52:55], v[72:79], v1
    buffer_load_dword v6, v7, s[8:11], s67 offen sc1
    v_smfmac_f32_16x16x64_bf16 v[16:19], v[52:55], v[80:87], v1
    ds_read_b128 v[64:67], v9 offset:2048
    v_smfmac_f32_16x16x64_bf16 v[20:23], v[52:55], v[88:95], v1
    ds_read_b128 v[68:71], v9 offset:3072
    s_waitcnt lgkmcnt(3)
    v_smfmac_f32_16x16x64_bf16 v[24:27], v[52:55], v[56:63], v1
    v_smfmac_f32_16x16x64_bf16 v[12:15], v[36:39], v[112:119], v1
    ds_read_b128 v[52:55], v0 offset:3072
    v_smfmac_f32_16x16x64_bf16 v[16:19], v[36:39], v[120:127], v1
    ds_read_b128 v[56:59], v9 offset:4096
    v_smfmac_f32_16x16x64_bf16 v[20:23], v[36:39], v[128:135], v1
    ds_read_b128 v[60:63], v9 offset:5120
    s_waitcnt lgkmcnt(3)
    v_smfmac_f32_16x16x64_bf16 v[24:27], v[36:39], v[64:71], v1
    v_smfmac_f32_16x16x64_bf16 v[12:15], v[40:43], v[152:159], v1
    buffer_load_dwordx4 v[36:39], v0, s[8:11], s42 offen
    v_smfmac_f32_16x16x64_bf16 v[16:19], v[40:43], v[160:167], v1
    ds_read_b128 v[64:67], v9 offset:6144
    v_smfmac_f32_16x16x64_bf16 v[20:23], v[40:43], v[168:175], v1
    ds_read_b128 v[68:71], v9 offset:7168
    s_waitcnt lgkmcnt(2)
    v_smfmac_f32_16x16x64_bf16 v[24:27], v[40:43], v[56:63], v1
    s_waitcnt vmcnt(2)
    ds_read_b128 v[44:47], v0 offset:4096
    v_smfmac_f32_16x16x64_bf16 v[12:15], v[52:55], v[192:199], v1
    buffer_load_dwordx4 v[40:43], v0, s[8:11], s42 offen offset:1024
    v_smfmac_f32_16x16x64_bf16 v[16:19], v[52:55], v[200:207], v1
    ds_read_b128 v[56:59], v9 offset:8192
    v_smfmac_f32_16x16x64_bf16 v[20:23], v[52:55], v[208:215], v1
    ds_read_b128 v[60:63], v9 offset:9216
    s_waitcnt lgkmcnt(3)
    v_smfmac_f32_16x16x64_bf16 v[24:27], v[52:55], v[64:71], v1
    ds_read_b128 v[48:51], v0 offset:5120
    s_waitcnt lgkmcnt(3)
    v_smfmac_f32_16x16x64_bf16 v[12:15], v[44:47], v[232:239], v1
    ds_read_b128 v[52:55], v0 offset:8192
    v_smfmac_f32_16x16x64_bf16 v[16:19], v[44:47], v[240:247], v1
    ds_read_b128 v[64:67], v9 offset:10240
    v_smfmac_f32_16x16x64_bf16 v[20:23], v[44:47], v[248:255], v1
    ds_read_b128 v[68:71], v9 offset:11264
    s_waitcnt lgkmcnt(4)
    v_smfmac_f32_16x16x64_bf16 v[24:27], v[44:47], v[56:63], v1
    s_waitcnt lgkmcnt(3)
    v_smfmac_f32_16x16x64_bf16 v[12:15], v[48:51], a[16:23], v1
    v_smfmac_f32_16x16x64_bf16 v[16:19], v[48:51], a[24:31], v1
    ds_read_b128 v[56:59], v9 offset:16384
    s_waitcnt lgkmcnt(3)
    v_smfmac_f32_16x16x64_bf16 v[12:15], v[52:55], a[136:143], v1
    ds_read_b128 v[60:63], v9 offset:17408
    v_smfmac_f32_16x16x64_bf16 v[16:19], v[52:55], a[144:151], v1
    v_smfmac_f32_16x16x64_bf16 v[20:23], v[48:51], a[32:39], v1
    s_waitcnt lgkmcnt(2)
    v_smfmac_f32_16x16x64_bf16 v[24:27], v[48:51], v[64:71], v1
    ds_read_b128 v[64:67], v0 offset:9216
    s_nop 1
    v_add_f32 v12, v12, v14
    v_smfmac_f32_16x16x64_bf16 v[20:23], v[52:55], a[152:159], v1
    ds_read_b128 v[68:71], v0 offset:10240
    v_add_f32 v16, v16, v18
    s_waitcnt lgkmcnt(2)
    v_smfmac_f32_16x16x64_bf16 v[24:27], v[52:55], v[56:63], v1
    ds_read_b128 v[56:59], v0 offset:11264
    v_add_f32 v13, v13, v15
    v_add_f32 v17, v17, v19
    v_cvt_pk_bf16_f32 v14, v12, v16
    v_cvt_pk_bf16_f32 v15, v13, v17
    ds_write_b32 v2, v14 offset:17408
    ds_write_b32 v2, v15 offset:17696
    v_smfmac_f32_16x16x64_bf16 v[28:31], v[52:55], a[160:167], v1
    ds_read_b128 v[60:63], v0 offset:12288
    v_add_f32 v20, v20, v22
    v_add_f32 v24, v24, v26
    v_add_f32 v21, v21, v23
    v_add_f32 v25, v25, v27
    v_smfmac_f32_16x16x64_bf16 v[32:35], v[52:55], a[168:175], v1
    ds_read_b128 v[12:15], v0 offset:6144
    v_cvt_pk_bf16_f32 v22, v20, v24
    v_cvt_pk_bf16_f32 v23, v21, v25
    ds_write_b32 v2, v22 offset:19712
    ds_write_b32 v2, v23 offset:20000
    v_smfmac_f32_16x16x64_bf16 v[28:31], v[48:51], a[40:47], v1
    ds_read_b128 v[16:19], v0 offset:7168
    v_smfmac_f32_16x16x64_bf16 v[32:35], v[48:51], a[48:55], v1
    ds_read_b128 v[20:23], v0 offset:0
    v_smfmac_f32_16x16x64_bf16 v[28:31], v[44:47], a[0:7], v1
    ds_read_b128 v[24:27], v0 offset:1024
    v_smfmac_f32_16x16x64_bf16 v[32:35], v[44:47], a[8:15], v1
    s_waitcnt lgkmcnt(3)
    s_barrier
    ds_read_b128 v[44:47], v3 offset:17408
    v_smfmac_f32_16x16x64_bf16 v[28:31], v[12:15], a[80:87], v1
    ds_read_b128 v[52:55], v0 offset:2048
    v_smfmac_f32_16x16x64_bf16 v[32:35], v[12:15], a[88:95], v1
    ds_read_b128 v[12:15], v3 offset:19712
    s_waitcnt lgkmcnt(5)
    v_smfmac_f32_16x16x64_bf16 v[28:31], v[16:19], a[120:127], v1
    ds_read_b128 v[48:51], v0 offset:3072
    v_smfmac_f32_16x16x64_bf16 v[32:35], v[16:19], a[128:135], v1
    s_waitcnt lgkmcnt(5)
    v_smfmac_f32_16x16x64_bf16 v[28:31], v[20:23], v[96:103], v1
    v_smfmac_f32_16x16x64_bf16 v[32:35], v[20:23], v[104:111], v1
    ds_read_b128 v[20:23], v3 offset:17472
    s_waitcnt lgkmcnt(5)
    v_smfmac_f32_16x16x64_bf16 v[28:31], v[24:27], v[136:143], v1
    v_smfmac_f32_16x16x64_bf16 v[32:35], v[24:27], v[144:151], v1
    s_waitcnt lgkmcnt(3)
    v_smfmac_f32_16x16x64_bf16 v[28:31], v[52:55], v[176:183], v1
    v_smfmac_f32_16x16x64_bf16 v[32:35], v[52:55], v[184:191], v1
    ds_read_b128 v[52:55], v3 offset:19776
    s_waitcnt lgkmcnt(2)
    v_smfmac_f32_16x16x64_bf16 v[28:31], v[48:51], v[216:223], v1
    v_smfmac_f32_16x16x64_bf16 v[32:35], v[48:51], v[224:231], v1
    ds_read_b128 v[48:51], v3 offset:17536
    v_mfma_f32_16x16x32_bf16 v[24:27], v[12:15], v[44:47], 0
    s_waitcnt vmcnt(2)
    v_cmp_eq_u32 vcc, 0, v6
    s_nop 0
    s_and_b64 vcc, vcc, s[78:79]
    s_cbranch_scc1 Lr3s_flbad
Lr3s_flok:
    s_mov_b32 m0, 24320
    s_nop 0
    buffer_load_dword v5, s[8:11], s40 offen lds
    buffer_load_dword v5, s[8:11], s56 offen lds
    s_mov_b32 m0, 15360
    v_mfma_f32_16x16x32_bf16 v[12:15], v[64:67], v[44:47], 0
    ds_read_b128 v[64:67], v0 offset:13312
    v_mfma_f32_16x16x32_bf16 v[16:19], v[68:71], v[44:47], 0
    ds_read_b128 v[68:71], v0 offset:14336
    s_waitcnt lgkmcnt(3)
    v_mfma_f32_16x16x32_bf16 v[24:27], v[52:55], v[20:23], v[24:27]
    ds_read_b128 v[44:47], v3 offset:19840
    v_add_f32 v28, v28, v30
    v_add_f32 v29, v29, v31
    v_mfma_f32_16x16x32_bf16 v[12:15], v[56:59], v[20:23], v[12:15]
    ds_read_b128 v[52:55], v3 offset:17600
    v_add_f32 v32, v32, v34
    v_add_f32 v33, v33, v35
    v_mfma_f32_16x16x32_bf16 v[16:19], v[60:63], v[20:23], v[16:19]
    ds_read_b128 v[56:59], v0 offset:15360
    v_cvt_pk_bf16_f32 v30, v28, v29
    v_cvt_pk_bf16_f32 v31, v32, v33
    s_waitcnt lgkmcnt(2)
    v_mfma_f32_16x16x32_bf16 v[24:27], v[44:47], v[48:51], v[24:27]
    ds_read_b128 v[20:23], v3 offset:19904
    v_lshrrev_b32 v10, 8, v0
    v_mul_u32_u24 v10, 288, v10
    v_mfma_f32_16x16x32_bf16 v[12:15], v[64:67], v[48:51], v[12:15]
    ds_read_b128 v[60:63], v0 offset:16384
    v_and_b32 v11, 0xf0, v0
    v_add_u32 v10, v10, v11
    v_mfma_f32_16x16x32_bf16 v[16:19], v[68:71], v[48:51], v[16:19]
    ds_read_b128 v[32:35], v10 offset:21440
    v_lshrrev_b32 v11, 1, v0
    v_bfi_b32 v30, 1, s66, v30
    s_waitcnt lgkmcnt(2)
    v_mfma_f32_16x16x32_bf16 v[24:27], v[20:23], v[52:55], v[24:27]
    buffer_store_dwordx2 v[30:31], v11, s[8:11], s43 offen offset:2048 sc1
    v_mov_b32 v49, 0
    v_mov_b32 v50, 0
    v_mfma_f32_16x16x32_bf16 v[12:15], v[56:59], v[52:55], v[12:15]
    v_mov_b64 v[64:65], s[68:69]
    v_mov_b64 v[66:67], s[68:69]
    s_waitcnt lgkmcnt(1)
    v_mfma_f32_16x16x32_bf16 v[16:19], v[60:63], v[52:55], v[16:19]
    s_waitcnt lgkmcnt(0)
    v_bfi_b32 v32, 1, s66, v32
    s_mov_b64 exec, s[52:53]
    buffer_store_dwordx4 v[32:35], v0, s[8:11], s43 offen sc1
    s_mov_b64 exec, -1
    v_max3_f32 v10, v24, v25, v12
    v_max3_f32 v10, v10, v13, v14
    s_nop 0
    v_max3_f32 v10, v10, v15, v16
    v_max3_f32 v10, v10, v17, v18
    v_max_f32 v10, v10, v19
    v_mov_b32 v11, v10
    s_nop 1
    v_permlane32_swap_b32 v10, v11
    v_max_f32 v10, v10, v11
    v_mov_b32 v11, v10
    s_nop 1
    v_permlane16_swap_b32 v10, v11
    v_max_f32 v10, v10, v11
    v_mul_f32 v20, s46, v10
    v_pk_fma_f32 v[24:25], v[24:25], s[46:47], v[20:21] op_sel_hi:[1,1,0] neg_lo:[0,0,1] neg_hi:[0,0,1]
    v_pk_fma_f32 v[12:13], v[12:13], s[46:47], v[20:21] op_sel_hi:[1,1,0] neg_lo:[0,0,1] neg_hi:[0,0,1]
    v_exp_f32 v24, v24
    v_exp_f32 v25, v25
    v_pk_fma_f32 v[14:15], v[14:15], s[46:47], v[20:21] op_sel_hi:[1,1,0] neg_lo:[0,0,1] neg_hi:[0,0,1]
    v_exp_f32 v12, v12
    v_exp_f32 v13, v13
    v_pk_fma_f32 v[16:17], v[16:17], s[46:47], v[20:21] op_sel_hi:[1,1,0] neg_lo:[0,0,1] neg_hi:[0,0,1]
    v_cvt_pk_bf16_f32 v48, v24, v25
    v_exp_f32 v14, v14
    v_pk_fma_f32 v[18:19], v[18:19], s[46:47], v[20:21] op_sel_hi:[1,1,0] neg_lo:[0,0,1] neg_hi:[0,0,1]
    v_cvt_pk_bf16_f32 v51, v24, v25
    v_exp_f32 v15, v15
    v_cvt_pk_bf16_f32 v44, v12, v13
    v_exp_f32 v16, v16
    v_exp_f32 v17, v17
    v_cvt_pk_bf16_f32 v45, v14, v15
    v_exp_f32 v18, v18
    v_exp_f32 v19, v19
    v_cvt_pk_bf16_f32 v46, v16, v17
    v_cvt_pk_bf16_f32 v47, v18, v19
    v_mfma_f32_16x16x16_bf16 v[68:71], v[64:65], v[48:49], 0
    v_mfma_f32_16x16x16_bf16 v[52:55], v[30:31], v[48:49], 0
    v_mfma_f32_16x16x16_bf16 v[56:59], v[30:31], v[50:51], 0
    v_mfma_f32_16x16x32_bf16 v[68:71], v[64:67], v[44:47], v[68:71]
    s_waitcnt vmcnt(5)
    v_mfma_f32_16x16x32_bf16 v[52:55], v[36:39], v[44:47], v[52:55]
    s_waitcnt vmcnt(4)
    v_mfma_f32_16x16x32_bf16 v[56:59], v[40:43], v[44:47], v[56:59]
    ds_read_b128 v[36:39], v0 offset:55296
    ds_read_b128 v[40:43], v0 offset:56320
    ds_read_b128 v[60:63], v9 offset:24576
    s_nop 0
    v_rcp_f32 v10, v68
    s_nop 0
    v_pk_mul_f32 v[52:53], v[52:53], v[10:11] op_sel_hi:[1,0]
    s_nop 0
    v_pk_mul_f32 v[56:57], v[56:57], v[10:11] op_sel_hi:[1,0]
    v_cvt_pk_bf16_f32 v16, v52, v56
    v_cvt_pk_bf16_f32 v17, v53, v57
    v_pk_mul_f32 v[54:55], v[54:55], v[10:11] op_sel_hi:[1,0]
    v_pk_mul_f32 v[58:59], v[58:59], v[10:11] op_sel_hi:[1,0]
    v_cvt_pk_bf16_f32 v18, v54, v58
    v_cvt_pk_bf16_f32 v19, v55, v59
    ds_write_b128 v3, v[16:19] offset:22208
    ds_read_b128 v[64:67], v9 offset:25600
    v_mov_b64 v[12:13], 0
    v_mov_b64 v[14:15], 0
    v_mov_b64 v[20:21], 0
    v_mov_b64 v[22:23], 0
    v_mov_b64 v[24:25], 0
    v_mov_b64 v[26:27], 0
    v_mov_b64 v[32:33], 0
    v_mov_b64 v[34:35], 0
    v_mov_b64 v[44:45], 0
    v_mov_b64 v[46:47], 0
    v_mov_b64 v[48:49], 0
    v_mov_b64 v[50:51], 0
    s_waitcnt lgkmcnt(1)
    s_barrier
    ds_read_b128 v[52:55], v4 offset:22016
    ds_read_b128 v[56:59], v4 offset:22144
    v_mov_b64 v[68:69], 0
    v_mov_b64 v[70:71], 0
    v_mov_b64 v[28:29], 0
    v_mov_b64 v[30:31], 0
    v_mov_b64 v[16:17], 0
    v_mov_b64 v[18:19], 0
    s_cmp_eq_u32 s33, 63
    s_cbranch_scc1 Lr3s_last
    s_waitcnt lgkmcnt(1)
    v_smfmac_f32_16x16x64_bf16 v[28:31], v[52:55], v[60:67], v1
    ds_read_b128 v[60:63], v0 offset:49152
    s_waitcnt lgkmcnt(1)
    v_smfmac_f32_16x16x64_bf16 v[28:31], v[56:59], v[36:43], v1
    ds_read_b128 v[64:67], v0 offset:50176
    ds_read_b128 v[36:39], v9 offset:18432
    v_smfmac_f32_16x16x64_bf16 v[12:15], v[52:55], a[176:183], v1
    ds_read_b128 v[40:43], v9 offset:19456
    v_smfmac_f32_16x16x64_bf16 v[12:15], v[56:59], a[184:191], v1
    buffer_load_dwordx4 v0, s[8:11], s41 offen offset:0 lds
    v_smfmac_f32_16x16x64_bf16 v[20:23], v[52:55], a[192:199], v1
    s_nop 0
    v_add_f32 v28, v28, v30
    v_add_f32 v29, v29, v31
    s_waitcnt lgkmcnt(2)
    v_smfmac_f32_16x16x64_bf16 v[20:23], v[56:59], v[60:67], v1
    ds_read_b128 v[60:63], v9 offset:20480
    v_cvt_pk_bf16_f32 v28, v28, v29
    v_bfi_b32 v28, 1, s39, v28
    buffer_store_dword v28, v8, s[8:11], s38 offen offset:2048 sc1
    s_waitcnt lgkmcnt(1)
    v_smfmac_f32_16x16x64_bf16 v[24:27], v[52:55], v[36:43], v1
    ds_read_b128 v[64:67], v9 offset:21504
    ds_read_b128 v[36:39], v0 offset:51200
    v_add_f32 v12, v12, v14
    v_add_f32 v13, v13, v15
    v_smfmac_f32_16x16x64_bf16 v[24:27], v[56:59], a[200:207], v1
    ds_read_b128 v[40:43], v0 offset:52224
    v_cvt_pk_bf16_f32 v12, v12, v13
    v_bfi_b32 v12, 1, s39, v12
    v_smfmac_f32_16x16x64_bf16 v[32:35], v[52:55], a[208:215], v1
    buffer_load_dwordx4 v0, s[8:11], s41 offen offset:1024 lds
    v_add_f32 v20, v20, v22
    v_add_f32 v21, v21, v23
    v_smfmac_f32_16x16x64_bf16 v[32:35], v[56:59], a[216:223], v1
    v_cvt_pk_bf16_f32 v13, v20, v21
    s_waitcnt lgkmcnt(2)
    v_smfmac_f32_16x16x64_bf16 v[44:47], v[52:55], v[60:67], v1
    ds_read_b128 v[60:63], v0 offset:53248
    v_add_f32 v24, v24, v26
    v_add_f32 v25, v25, v27
    s_waitcnt lgkmcnt(1)
    v_smfmac_f32_16x16x64_bf16 v[44:47], v[56:59], v[36:43], v1
    ds_read_b128 v[64:67], v0 offset:54272
    ds_read_b128 v[36:39], v9 offset:22528
    v_cvt_pk_bf16_f32 v14, v24, v25
    v_smfmac_f32_16x16x64_bf16 v[48:51], v[52:55], a[224:231], v1
    ds_read_b128 v[40:43], v9 offset:23552
    v_add_f32 v32, v32, v34
    v_add_f32 v33, v33, v35
    v_smfmac_f32_16x16x64_bf16 v[48:51], v[56:59], a[232:239], v1
    v_cvt_pk_bf16_f32 v15, v32, v33
    buffer_store_dwordx4 v[12:15], v0, s[8:11], s38 offen offset:0 sc1
    v_smfmac_f32_16x16x64_bf16 v[68:71], v[52:55], a[240:247], v1
    v_add_f32 v44, v44, v46
    v_add_f32 v45, v45, v47
    s_waitcnt lgkmcnt(2)
    v_smfmac_f32_16x16x64_bf16 v[68:71], v[56:59], v[60:67], v1
    v_cvt_pk_bf16_f32 v44, v44, v45
    v_bfi_b32 v44, 1, s39, v44
    s_waitcnt lgkmcnt(0)
    v_smfmac_f32_16x16x64_bf16 v[16:19], v[52:55], v[36:43], v1
    v_add_f32 v48, v48, v50
    v_add_f32 v49, v49, v51
    v_smfmac_f32_16x16x64_bf16 v[16:19], v[56:59], a[248:255], v1
    v_cvt_pk_bf16_f32 v45, v48, v49
    v_add_f32 v68, v68, v70
    v_add_f32 v69, v69, v71
    v_cvt_pk_bf16_f32 v46, v68, v69
    s_nop 3
    v_add_f32 v16, v16, v18
    v_add_f32 v17, v17, v19
    v_cvt_pk_bf16_f32 v47, v16, v17
    buffer_store_dwordx4 v[44:47], v0, s[8:11], s38 offen offset:1024 sc1
    s_xor_b32 s34, s34, 16384
    s_xor_b32 s35, s35, 16384
    s_barrier
    s_sleep 2
    buffer_load_dwordx4 v[44:47], v0, s[8:11], s34 offen sc1
    buffer_load_dwordx4 v[48:51], v0, s[8:11], s34 offen offset:1024 sc1
    buffer_load_dword v10, v8, s[8:11], s35 offen sc1
    s_add_u32 s33, s33, 1
    s_bfe_u32 s39, s33, 0x10001
    s_xor_b32 s38, s38, 524288
    s_and_b32 s17, s33, 7
    s_mul_i32 s17, s17, 131072
    s_add_u32 s43, s45, s17
    s_bfe_u32 s66, s33, 65539
    s_add_u32 s67, s67, 22528
    s_and_b32 s17, s33, 3
    s_cmp_eq_u32 s17, 3
    s_cselect_b32 s17, 1, 0
    s_cmp_eq_u32 s32, 0
    s_cselect_b32 s17, 1, s17
    s_cmp_ge_u32 s33, 7
    s_cselect_b32 s17, s17, 0
    s_cmp_lg_u32 s17, 0
    s_cselect_b64 s[78:79], -1, 0xff
    s_add_u32 s56, s56, 262144
    s_add_u32 s42, s42, 262144
    s_add_u32 s41, s41, 262144
    s_add_u32 s40, s40, 262144
    s_add_u32 s44, s44, 22528
    ds_read_b128 v[56:59], v9 offset:12288
    ds_read_b128 v[60:63], v9 offset:13312
    ds_read_b128 v[64:67], v9 offset:14336
    ds_read_b128 v[68:71], v9 offset:15360
    v_mov_b64 v[12:13], 0
    v_mov_b64 v[14:15], 0
    v_mov_b64 v[16:17], 0
    v_mov_b64 v[18:19], 0
    v_mov_b64 v[20:21], 0
    v_mov_b64 v[22:23], 0
    v_mov_b64 v[24:25], 0
    v_mov_b64 v[26:27], 0
    v_mov_b64 v[28:29], 0
    v_mov_b64 v[30:31], 0
    v_mov_b64 v[32:33], 0
    v_mov_b64 v[34:35], 0
    s_waitcnt lgkmcnt(0)
    s_branch Lr3s_step
Lr3s_flbad:
    s_cmp_eq_u32 s33, 63
    s_cbranch_scc1 Lr3s_flok
    s_mov_b32 s16, 0
Lr3s_flp:
    buffer_load_dword v6, v7, s[8:11], s67 offen sc1
    s_add_u32 s16, s16, 1
    s_cmp_gt_u32 s16, 100000
    s_cbranch_scc1 Lr_abort
    s_waitcnt vmcnt(0)
    v_cmp_eq_u32 vcc, 0, v6
    s_nop 0
    s_and_b64 vcc, vcc, s[78:79]
    s_cbranch_scc1 Lr3s_flp
    s_branch Lr3s_flok
Lr3s_last:
    s_waitcnt vmcnt(0) lgkmcnt(0)
    s_branch Lr_exit
Lr_abort:
    s_waitcnt lgkmcnt(0)
    s_mov_b64 exec, -1
    v_mov_b32 v0, 60
    s_lshl_b32 s5, s3, 8
    s_or_b32 s5, s5, s4
    s_or_b32 s5, s5, 0x10000
    v_mov_b32 v1, s5
    global_store_dword v0, v1, s[12:13]
    s_endpgm
Lr_exit:
    s_add_u32 s6, s15, s14
    s_cmp_lg_u32 s6, 0
    s_cbranch_scc1 Lr_nowb
    s_waitcnt vmcnt(0)
    buffer_wbl2 sc1
    s_waitcnt vmcnt(0)
Lr_nowb:
    s_endpgm
.section .rodata,"a"
.p2align 6
.amdhsa_kernel interleave_layers__sliding_local_dilated__memory_aug_recurrent_mem_tr__prompt_kernel
  .amdhsa_next_free_vgpr 512
  .amdhsa_next_free_sgpr 102
  .amdhsa_accum_offset 256
  .amdhsa_group_segment_fixed_size 0
  .amdhsa_kernarg_size 104
  .amdhsa_user_sgpr_count 2
  .amdhsa_user_sgpr_kernarg_segment_ptr 1
  .amdhsa_system_sgpr_workgroup_id_x 1
.end_amdhsa_kernel
```

```asm
; @launch grid=(256,1,1) block=(256,1,1) lds=163840
.amdgcn_target "amdgcn-amd-amdhsa--gfx950"
.text
.globl interleave_layers__sliding_local_dilated__memory_aug_recurrent_mem_tr__prompt_kernel
.p2align 8
.type interleave_layers__sliding_local_dilated__memory_aug_recurrent_mem_tr__prompt_kernel,@function
interleave_layers__sliding_local_dilated__memory_aug_recurrent_mem_tr__prompt_kernel:
    s_cmp_ge_u32 s2, 256
    s_cbranch_scc1 L_exit
    s_load_dwordx2 s[8:9], s[0:1], 96
    s_mov_b32 s10, 268435456
    s_mov_b32 s11, 0x00020000
    s_waitcnt lgkmcnt(0)
    s_and_b32 s9, s9, 0xffff
    s_load_dwordx2 s[12:13], s[0:1], 88
    v_lshrrev_b32 v1, 6, v0
    s_getreg_b32 s3, hwreg(HW_REG_XCC_ID)
    v_readfirstlane_b32 s14, v1
    s_and_b32 s3, s3, 7
    s_and_b32 s17, s3, 1
    s_lshl_b32 s17, s17, 7
    s_lshl_b32 s18, s3, 1
    s_and_b32 s18, s18, 12
    s_add_u32 s17, s17, s18
    v_mov_b32 v2, 0
    v_mov_b32 v3, 1
    v_mov_b32 v4, s17
    s_mov_b32 s33, 0
    s_waitcnt lgkmcnt(0)
    s_cmp_lg_u32 s14, 0
    s_cbranch_scc1 L_tk_wait
    s_mov_b64 exec, 1
    global_atomic_add v3, v4, v3, s[12:13] sc0
    s_waitcnt vmcnt(0)
    v_readfirstlane_b32 s4, v3
    s_nop 0
    s_cmp_lt_u32 s4, 32
    s_cbranch_scc1 L_tk_have
    v_mov_b32 v3, 1
    v_mov_b32 v4, 32
    global_atomic_add v3, v4, v3, s[12:13] sc0
    s_waitcnt vmcnt(0)
    v_readfirstlane_b32 s5, v3
    s_mov_b64 exec, 0xff
    v_and_b32 v4, 1, v0
    v_lshlrev_b32 v4, 7, v4
    v_lshlrev_b32 v5, 1, v0
    v_and_or_b32 v4, v5, 12, v4
    s_mov_b32 s16, 0
L_hl_poll:
    global_load_dword v5, v4, s[12:13] sc1
    s_add_u32 s16, s16, 1
    s_cmp_gt_u32 s16, 100000
    s_cbranch_scc1 L_abort
    s_mov_b32 s6, 0
    s_waitcnt vmcnt(0)
    v_readlane_b32 s40, v5, 0
    s_nop 0
    s_add_u32 s6, s6, s40
    v_readlane_b32 s41, v5, 1
    s_nop 0
    s_add_u32 s6, s6, s41
    v_readlane_b32 s42, v5, 2
    s_nop 0
    s_add_u32 s6, s6, s42
    v_readlane_b32 s43, v5, 3
    s_nop 0
    s_add_u32 s6, s6, s43
    v_readlane_b32 s44, v5, 4
    s_nop 0
    s_add_u32 s6, s6, s44
    v_readlane_b32 s45, v5, 5
    s_nop 0
    s_add_u32 s6, s6, s45
    v_readlane_b32 s46, v5, 6
    s_nop 0
    s_add_u32 s6, s6, s46
    v_readlane_b32 s47, v5, 7
    s_nop 0
    s_add_u32 s6, s6, s47
    s_cmp_lt_u32 s6, 256
    s_cbranch_scc1 L_hl_poll
    s_mov_b32 s3, 0
    s_mov_b32 s4, 0
    s_min_u32 s6, s47, 32
    s_sub_u32 s7, 32, s6
    s_cmp_lt_u32 s5, s7
    s_cselect_b32 s3, 7, s3
    s_add_u32 s6, s6, s5
    s_cmp_lt_u32 s5, s7
    s_cselect_b32 s4, s6, s4
    s_sub_u32 s5, s5, s7
    s_min_u32 s6, s46, 32
    s_sub_u32 s7, 32, s6
    s_cmp_lt_u32 s5, s7
    s_cselect_b32 s3, 6, s3
    s_add_u32 s6, s6, s5
    s_cmp_lt_u32 s5, s7
    s_cselect_b32 s4, s6, s4
    s_sub_u32 s5, s5, s7
    s_min_u32 s6, s45, 32
    s_sub_u32 s7, 32, s6
    s_cmp_lt_u32 s5, s7
    s_cselect_b32 s3, 5, s3
    s_add_u32 s6, s6, s5
    s_cmp_lt_u32 s5, s7
    s_cselect_b32 s4, s6, s4
    s_sub_u32 s5, s5, s7
    s_min_u32 s6, s44, 32
    s_sub_u32 s7, 32, s6
    s_cmp_lt_u32 s5, s7
    s_cselect_b32 s3, 4, s3
    s_add_u32 s6, s6, s5
    s_cmp_lt_u32 s5, s7
    s_cselect_b32 s4, s6, s4
    s_sub_u32 s5, s5, s7
    s_min_u32 s6, s43, 32
    s_sub_u32 s7, 32, s6
    s_cmp_lt_u32 s5, s7
    s_cselect_b32 s3, 3, s3
    s_add_u32 s6, s6, s5
    s_cmp_lt_u32 s5, s7
    s_cselect_b32 s4, s6, s4
    s_sub_u32 s5, s5, s7
    s_min_u32 s6, s42, 32
    s_sub_u32 s7, 32, s6
    s_cmp_lt_u32 s5, s7
    s_cselect_b32 s3, 2, s3
    s_add_u32 s6, s6, s5
    s_cmp_lt_u32 s5, s7
    s_cselect_b32 s4, s6, s4
    s_sub_u32 s5, s5, s7
    s_min_u32 s6, s41, 32
    s_sub_u32 s7, 32, s6
    s_cmp_lt_u32 s5, s7
    s_cselect_b32 s3, 1, s3
    s_add_u32 s6, s6, s5
    s_cmp_lt_u32 s5, s7
    s_cselect_b32 s4, s6, s4
    s_sub_u32 s5, s5, s7
    s_min_u32 s6, s40, 32
    s_sub_u32 s7, 32, s6
    s_cmp_lt_u32 s5, s7
    s_cselect_b32 s3, 0, s3
    s_add_u32 s6, s6, s5
    s_cmp_lt_u32 s5, s7
    s_cselect_b32 s4, s6, s4
    s_sub_u32 s5, s5, s7
L_tk_have:
    s_lshl_b32 s5, s3, 8
    s_or_b32 s5, s5, s4
    v_mov_b32 v3, s5
    s_mov_b64 exec, 1
    ds_write_b32 v2, v3
    s_mov_b64 exec, -1
L_tk_wait:
    s_waitcnt vmcnt(0) lgkmcnt(0)
    s_barrier
    ds_read_b32 v3, v2
    s_waitcnt lgkmcnt(0)
    v_readfirstlane_b32 s5, v3
    s_nop 0
    s_lshr_b32 s3, s5, 8
    s_and_b32 s4, s5, 255
    s_barrier
    s_cmp_lt_u32 s3, 2
    s_cbranch_scc1 L_role_r
    s_cmp_lg_u32 s3, 2
    s_cbranch_scc1 L_ii2_no
    s_cmp_lt_u32 s4, 32
    s_cbranch_scc1 L_noinit
L_ii2_no:
    s_cmp_lg_u32 s3, 3
    s_cbranch_scc1 L_ii3_no
    s_cmp_lt_u32 s4, 16
    s_cbranch_scc1 L_noinit
    s_cmp_lt_u32 s4, 32
    s_add_u32 s6, s4, 4294967280
    s_cmp_lt_u32 s4, 32
    s_cbranch_scc1 L_doinit
L_ii3_no:
    s_cmp_lg_u32 s3, 4
    s_cbranch_scc1 L_ii4_no
    s_cmp_lt_u32 s4, 21
    s_cbranch_scc1 L_noinit
    s_cmp_lt_u32 s4, 32
    s_add_u32 s6, s4, 4294967291
    s_cmp_lt_u32 s4, 32
    s_cbranch_scc1 L_doinit
L_ii4_no:
    s_cmp_lg_u32 s3, 5
    s_cbranch_scc1 L_ii5_no
    s_cmp_lt_u32 s4, 32
    s_add_u32 s6, s4, 27
    s_cmp_lt_u32 s4, 32
    s_cbranch_scc1 L_doinit
L_ii5_no:
    s_cmp_lg_u32 s3, 6
    s_cbranch_scc1 L_ii6_no
    s_cmp_lt_u32 s4, 32
    s_add_u32 s6, s4, 59
    s_cmp_lt_u32 s4, 32
    s_cbranch_scc1 L_doinit
L_ii6_no:
    s_cmp_lg_u32 s3, 7
    s_cbranch_scc1 L_ii7_no
    s_cmp_lt_u32 s4, 32
    s_add_u32 s6, s4, 91
    s_cmp_lt_u32 s4, 32
    s_cbranch_scc1 L_doinit
L_ii7_no:
    s_endpgm
L_doinit:
    s_load_dwordx2 s[20:21], s[0:1], 0
    s_mov_b32 s22, 2359296
    s_mov_b32 s23, 0x00020000
    s_waitcnt lgkmcnt(0)
    s_and_b32 s21, s21, 0xffff
    v_lshlrev_b32 v7, 4, v0
    v_mov_b32 v12, 0
    v_mov_b32 v13, 0
    v_mov_b32 v14, 0
    v_mov_b32 v15, 0
    s_mov_b32 s46, s6
Li_loop:
    s_cmp_ge_u32 s46, 136
    s_cbranch_scc1 Li_nofl
    s_mul_i32 s41, s46, 22528
    s_add_u32 s41, s41, 180224
    s_sub_u32 s42, s46, 128
    s_lshl_b32 s42, s42, 12
    s_add_u32 s42, s42, 3080192
    s_cmp_ge_u32 s46, 128
    s_cselect_b32 s41, s42, s41
    buffer_store_dwordx4 v[12:15], v7, s[8:11], s41 offen sc1
    s_cbranch_scc1 Li_nofl
    s_add_u32 s41, s41, 4096
    buffer_store_dwordx4 v[12:15], v7, s[8:11], s41 offen sc1
    s_add_u32 s41, s41, 4096
    buffer_store_dwordx4 v[12:15], v7, s[8:11], s41 offen sc1
    s_add_u32 s41, s41, 4096
    buffer_store_dwordx4 v[12:15], v7, s[8:11], s41 offen sc1
    s_add_u32 s41, s41, 4096
    buffer_store_dwordx4 v[12:15], v7, s[8:11], s41 offen sc1
    s_add_u32 s41, s41, 4096
    v_cmp_gt_u32 vcc, 128, v0
    s_nop 0
    s_and_saveexec_b64 s[42:43], vcc
    s_cbranch_execz Li_fl5
    buffer_store_dwordx4 v[12:15], v7, s[8:11], s41 offen sc1
Li_fl5:
    s_mov_b64 exec, s[42:43]
Li_nofl:
    s_cmp_ge_u32 s46, 64
    s_cbranch_scc1 Li_rest
    s_mul_i32 s42, s46, 6144
    s_add_u32 s42, s42, 15728640
    s_add_u32 s43, s42, 2048
    buffer_store_dwordx4 v[12:15], v7, s[8:11], s43 offen sc1
    s_branch Li_done
Li_rest:
    s_cmp_ge_u32 s46, 192
    s_cbranch_scc1 Li_done
    s_sub_u32 s41, s46, 64
    s_lshr_b32 s42, s41, 6
    s_and_b32 s41, s41, 63
    s_mul_i32 s42, s42, 786432
    s_mul_i32 s41, s41, 6144
    s_add_u32 s41, s41, s42
    s_add_u32 s41, s41, 16126464
    v_cmp_gt_u32 vcc, 96, v0
    s_nop 0
    s_and_saveexec_b64 s[44:45], vcc
    s_cbranch_execz Li_rest2
    buffer_store_dwordx4 v[12:15], v7, s[8:11], s41 offen sc1
Li_rest2:
    s_mov_b64 exec, s[44:45]
Li_done:
    s_add_u32 s46, s46, 123
    s_cmp_lt_u32 s46, 192
    s_cbranch_scc1 Li_loop
    v_and_b32 v1, 31, v0
    v_lshrrev_b32 v2, 5, v0
    v_mul_u32_u24 v3, 1152, v1
    v_mul_u32_u24 v5, 144, v2
    v_add_u32 v3, v3, v5
    s_sub_u32 s47, s6, 59
    s_mul_i32 s41, s47, 36864
    s_cmp_lt_u32 s6, 59
    s_cselect_b32 s41, 0x7f000000, s41
    buffer_load_dwordx4 v[64:67], v3, s[20:23], s41 offen offset:0
    buffer_load_dwordx4 v[68:71], v3, s[20:23], s41 offen offset:16
    buffer_load_dwordx4 v[72:75], v3, s[20:23], s41 offen offset:32
    buffer_load_dwordx4 v[76:79], v3, s[20:23], s41 offen offset:48
    buffer_load_dwordx4 v[80:83], v3, s[20:23], s41 offen offset:64
    buffer_load_dwordx4 v[84:87], v3, s[20:23], s41 offen offset:80
    buffer_load_dwordx4 v[88:91], v3, s[20:23], s41 offen offset:96
    buffer_load_dwordx4 v[92:95], v3, s[20:23], s41 offen offset:112
    buffer_load_dwordx4 v[96:99], v3, s[20:23], s41 offen offset:128
    s_waitcnt vmcnt(9)
    s_barrier
    s_cmp_lg_u32 s14, 0
    s_cbranch_scc1 Li_mid
    v_mov_b32 v2, 160
    v_mov_b32 v3, 1
    s_mov_b64 exec, 1
    global_atomic_add v2, v3, s[12:13]
    s_mov_b64 exec, -1
Li_mid:
    s_cmp_lt_u32 s6, 59
    s_cbranch_scc1 Li_end
    s_waitcnt vmcnt(0)
    v_and_b32 v1, 31, v0
    v_lshrrev_b32 v2, 5, v0
    v_mul_u32_u24 v4, 4608, v2
    v_lshl_add_u32 v4, v1, 4, v4
    s_mul_i32 s41, s47, 36864
    s_add_u32 s41, s41, 6291456
    s_mul_i32 s42, s47, 6144
    s_add_u32 s42, s42, 15728640
    v_mov_b32 v60, 0
    v_mov_b32 v61, 0
    buffer_store_dwordx4 v[64:67], v4, s[8:11], s41 offen offset:0 sc1
    buffer_store_dwordx4 v[68:71], v4, s[8:11], s41 offen offset:512 sc1
    buffer_store_dwordx4 v[72:75], v4, s[8:11], s41 offen offset:1024 sc1
    buffer_store_dwordx4 v[76:79], v4, s[8:11], s41 offen offset:1536 sc1
    buffer_store_dwordx4 v[80:83], v4, s[8:11], s41 offen offset:2048 sc1
    buffer_store_dwordx4 v[84:87], v4, s[8:11], s41 offen offset:2560 sc1
    buffer_store_dwordx4 v[88:91], v4, s[8:11], s41 offen offset:3072 sc1
    buffer_store_dwordx4 v[92:95], v4, s[8:11], s41 offen offset:3584 sc1
    v_add_u32 v4, 4096, v4
    buffer_store_dwordx4 v[96:99], v4, s[8:11], s41 offen offset:0 sc1
    v_mov_b32 v62, 0x3f803f80
    v_dot2c_f32_bf16 v60, v64, v62
    v_dot2c_f32_bf16 v61, v64, v64
    v_dot2c_f32_bf16 v60, v65, v62
    v_dot2c_f32_bf16 v61, v65, v65
    v_dot2c_f32_bf16 v60, v66, v62
    v_dot2c_f32_bf16 v61, v66, v66
    v_dot2c_f32_bf16 v60, v67, v62
    v_dot2c_f32_bf16 v61, v67, v67
    v_dot2c_f32_bf16 v60, v68, v62
    v_dot2c_f32_bf16 v61, v68, v68
    v_dot2c_f32_bf16 v60, v69, v62
    v_dot2c_f32_bf16 v61, v69, v69
    v_dot2c_f32_bf16 v60, v70, v62
    v_dot2c_f32_bf16 v61, v70, v70
    v_dot2c_f32_bf16 v60, v71, v62
    v_dot2c_f32_bf16 v61, v71, v71
    v_dot2c_f32_bf16 v60, v72, v62
    v_dot2c_f32_bf16 v61, v72, v72
    v_dot2c_f32_bf16 v60, v73, v62
    v_dot2c_f32_bf16 v61, v73, v73
    v_dot2c_f32_bf16 v60, v74, v62
    v_dot2c_f32_bf16 v61, v74, v74
    v_dot2c_f32_bf16 v60, v75, v62
    v_dot2c_f32_bf16 v61, v75, v75
    v_dot2c_f32_bf16 v60, v76, v62
    v_dot2c_f32_bf16 v61, v76, v76
    v_dot2c_f32_bf16 v60, v77, v62
    v_dot2c_f32_bf16 v61, v77, v77
    v_dot2c_f32_bf16 v60, v78, v62
    v_dot2c_f32_bf16 v61, v78, v78
    v_dot2c_f32_bf16 v60, v79, v62
    v_dot2c_f32_bf16 v61, v79, v79
    v_dot2c_f32_bf16 v60, v80, v62
    v_dot2c_f32_bf16 v61, v80, v80
    v_dot2c_f32_bf16 v60, v81, v62
    v_dot2c_f32_bf16 v61, v81, v81
    v_dot2c_f32_bf16 v60, v82, v62
    v_dot2c_f32_bf16 v61, v82, v82
    v_dot2c_f32_bf16 v60, v83, v62
    v_dot2c_f32_bf16 v61, v83, v83
    v_dot2c_f32_bf16 v60, v84, v62
    v_dot2c_f32_bf16 v61, v84, v84
    v_dot2c_f32_bf16 v60, v85, v62
    v_dot2c_f32_bf16 v61, v85, v85
    v_dot2c_f32_bf16 v60, v86, v62
    v_dot2c_f32_bf16 v61, v86, v86
    v_dot2c_f32_bf16 v60, v87, v62
    v_dot2c_f32_bf16 v61, v87, v87
    v_dot2c_f32_bf16 v60, v88, v62
    v_dot2c_f32_bf16 v61, v88, v88
    v_dot2c_f32_bf16 v60, v89, v62
    v_dot2c_f32_bf16 v61, v89, v89
    v_dot2c_f32_bf16 v60, v90, v62
    v_dot2c_f32_bf16 v61, v90, v90
    v_dot2c_f32_bf16 v60, v91, v62
    v_dot2c_f32_bf16 v61, v91, v91
    v_dot2c_f32_bf16 v60, v92, v62
    v_dot2c_f32_bf16 v61, v92, v92
    v_dot2c_f32_bf16 v60, v93, v62
    v_dot2c_f32_bf16 v61, v93, v93
    v_dot2c_f32_bf16 v60, v94, v62
    v_dot2c_f32_bf16 v61, v94, v94
    v_dot2c_f32_bf16 v60, v95, v62
    v_dot2c_f32_bf16 v61, v95, v95
    v_dot2c_f32_bf16 v60, v96, v62
    v_dot2c_f32_bf16 v61, v96, v96
    v_dot2c_f32_bf16 v60, v97, v62
    v_dot2c_f32_bf16 v61, v97, v97
    v_dot2c_f32_bf16 v60, v98, v62
    v_dot2c_f32_bf16 v61, v98, v98
    v_dot2c_f32_bf16 v60, v99, v62
    v_dot2c_f32_bf16 v61, v99, v99
    s_nop 3
    v_lshlrev_b32 v5, 8, v2
    v_lshl_add_u32 v5, v1, 3, v5
    buffer_store_dwordx2 v[60:61], v5, s[8:11], s42 offen sc1
    s_waitcnt vmcnt(0)
    s_cmp_lg_u32 s14, 0
    s_cbranch_scc1 Li_pw_d
    v_mov_b32 v5, 160
    s_mov_b32 s16, 0
Li_pw:
    global_load_dword v6, v5, s[12:13] sc1
    s_add_u32 s16, s16, 1
    s_cmp_gt_u32 s16, 100000
    s_cbranch_scc1 L_abort
    s_waitcnt vmcnt(0)
    v_cmp_gt_u32 vcc, 123, v6
    s_nop 0
    s_cbranch_vccz Li_pw_d
    s_sleep 2
    s_branch Li_pw
Li_pw_d:
    s_barrier
    s_cmp_lg_u32 s14, 0
    s_cbranch_scc1 Li_end
    v_lshrrev_b32 v5, 2, v0
    v_lshlrev_b32 v5, 7, v5
    v_and_b32 v6, 3, v0
    v_lshl_add_u32 v5, v6, 2, v5
    v_mov_b32 v6, 1
    s_mul_i32 s41, s47, 22528
    s_mov_b32 exec_lo, -1
    s_mov_b32 exec_hi, 0xffff
    s_add_u32 s41, s41, 180224
    buffer_store_dword v6, v5, s[8:11], s41 offen offset:0 sc1
    s_mov_b64 exec, -1
Li_end:
L_noinit:
    s_cmp_lg_u32 s3, 2
    s_cbranch_scc1 L_cls2_no
    s_add_u32 s15, s4, 0
    s_cmp_lt_u32 s4, 32
    s_cbranch_scc1 L_role_p
    s_endpgm
L_cls2_no:
    s_cmp_lg_u32 s3, 3
    s_cbranch_scc1 L_cls3_no
    s_add_u32 s15, s4, 32
    s_cmp_lt_u32 s4, 32
    s_cbranch_scc1 L_role_p
    s_endpgm
L_cls3_no:
    s_cmp_lg_u32 s3, 4
    s_cbranch_scc1 L_cls4_no
    s_add_u32 s15, s4, 0
    s_cmp_lt_u32 s4, 16
    s_cbranch_scc1 L_role_aq
    s_add_u32 s15, s4, 4294967280
    s_cmp_lt_u32 s4, 21
    s_cbranch_scc1 L_role_awo
    s_add_u32 s15, s4, 43
    s_cmp_lt_u32 s4, 32
    s_cbranch_scc1 L_role_p
    s_endpgm
L_cls4_no:
    s_cmp_lg_u32 s3, 5
    s_cbranch_scc1 L_cls5_no
    s_add_u32 s15, s4, 16
    s_cmp_lt_u32 s4, 16
    s_cbranch_scc1 L_role_aq
    s_add_u32 s15, s4, 4294967285
    s_cmp_lt_u32 s4, 21
    s_cbranch_scc1 L_role_awo
    s_add_u32 s15, s4, 54
    s_cmp_lt_u32 s4, 32
    s_cbranch_scc1 L_role_p
    s_endpgm
L_cls5_no:
    s_cmp_lg_u32 s3, 6
    s_cbranch_scc1 L_cls6_no
    s_add_u32 s15, s4, 0
    s_cmp_lt_u32 s4, 8
    s_cbranch_scc1 L_role_ta
    s_add_u32 s15, s4, 4294967288
    s_cmp_lt_u32 s4, 32
    s_cbranch_scc1 L_role_tw
    s_endpgm
L_cls6_no:
    s_cmp_lg_u32 s3, 7
    s_cbranch_scc1 L_cls7_no
    s_add_u32 s15, s4, 8
    s_cmp_lt_u32 s4, 8
    s_cbranch_scc1 L_role_ta
    s_add_u32 s15, s4, 16
    s_cmp_lt_u32 s4, 20
    s_cbranch_scc1 L_role_tw
    s_add_u32 s15, s4, 66
    s_cmp_lt_u32 s4, 30
    s_cbranch_scc1 L_role_p
    s_endpgm
L_cls7_no:
L_exit:
    s_endpgm
L_abort:
    s_waitcnt lgkmcnt(0)
    s_mov_b64 exec, -1
    v_mov_b32 v0, 60
    s_lshl_b32 s5, s3, 8
    s_or_b32 s5, s5, s4
    s_or_b32 s5, s5, 0x10000
    v_mov_b32 v1, s5
    global_store_dword v0, v1, s[12:13]
    s_endpgm
.p2align 6
L_role_p:
    v_and_b32 v5, 63, v0
    v_lshlrev_b32 v0, 4, v5
    v_and_b32 v7, 15, v5
    v_lshrrev_b32 v8, 4, v5
    v_min_u32 v1, 17, v5
    v_lshrrev_b32 v6, 2, v1
    v_and_b32 v1, 3, v1
    v_lshlrev_b32 v1, 2, v1
    v_lshl_add_u32 v1, v6, 7, v1
    v_mov_b32 v3, 1
    v_mov_b32 v4, 0
    s_mov_b32 s44, 0x05040100
    s_mov_b32 s45, 0x07060302
    s_cmp_ge_u32 s15, 48
    s_cselect_b32 s63, 1, 0
    s_cselect_b32 s17, 48, 0
    s_sub_u32 s15, s15, s17
    s_lshr_b32 s50, s15, 4
    s_and_b32 s51, s15, 15
    s_lshl_b32 s51, s51, 1
    s_lshr_b32 s17, s14, 1
    s_add_u32 s51, s51, s17
    s_and_b32 s47, s14, 1
    s_lshl_b32 s17, s50, 3
    s_add_u32 s17, s17, 40
    s_load_dwordx2 s[20:21], s[0:1], s17
    s_mov_b32 s22, 4718592
    s_mov_b32 s23, 0x00020000
    s_lshl_b32 s49, s51, 8
    s_lshl_b32 s17, s47, 7
    s_add_u32 s49, s49, s17
    s_cmp_eq_u32 s63, 0
    s_cbranch_scc1 Lp_noord
    s_cmp_lg_u32 s14, 0
    s_cbranch_scc1 Lp_ord_d
    v_mov_b32 v5, 48
    s_mov_b32 s16, 0
Lp_ord:
    global_load_dword v6, v5, s[12:13] sc1
    s_add_u32 s16, s16, 1
    s_cmp_gt_u32 s16, 100000
    s_cbranch_scc1 L_role_p_abort
    s_waitcnt vmcnt(0)
    v_cmp_gt_u32 vcc, 1, v6
    s_nop 0
    s_cbranch_vccz Lp_ord_d
    s_sleep 64
    s_branch Lp_ord
Lp_ord_d:
    s_barrier
Lp_noord:
    v_lshrrev_b32 v5, 4, v0
    v_lshrrev_b32 v211, 3, v5
    v_lshlrev_b32 v211, 13, v211
    v_and_b32 v6, 7, v5
    v_lshl_add_u32 v211, v6, 4, v211
    v_lshrrev_b32 v210, 1, v8
    v_lshlrev_b32 v210, 3, v210
    v_lshrrev_b32 v6, 2, v7
    v_add_u32 v210, v210, v6
    v_lshlrev_b32 v210, 7, v210
    s_lshl_b32 s17, s14, 15
    v_add_u32 v210, s17, v210
    v_and_b32 v13, 1, v8
    v_and_b32 v6, 1, v7
    v_lshlrev_b32 v6, 3, v6
    v_lshl_add_u32 v6, v13, 4, v6
    v_bfe_u32 v9, v7, 1, 1
    v_lshl_add_u32 v6, v9, 5, v6
    v_and_b32 v9, 3, v7
    v_lshlrev_b32 v9, 3, v9
    v_lshl_add_u32 v13, v13, 5, v9
    s_cmp_eq_u32 s50, 2
    s_cselect_b64 vcc, -1, 0
    v_cndmask_b32 v6, v6, v13, vcc
    v_add_u32 v210, v210, v6
    s_waitcnt lgkmcnt(0)
    s_and_b32 s21, s21, 0xffff
    s_lshl_b32 s46, s14, 15
    s_add_u32 m0, s46, 0
    s_add_u32 s17, s49, 0
    buffer_load_dwordx4 v211, s[20:23], s17 offen lds
    s_add_u32 m0, s46, 1024
    s_add_u32 s17, s49, 65536
    buffer_load_dwordx4 v211, s[20:23], s17 offen lds
    s_add_u32 m0, s46, 2048
    s_add_u32 s17, s49, 131072
    buffer_load_dwordx4 v211, s[20:23], s17 offen lds
    s_add_u32 m0, s46, 3072
    s_add_u32 s17, s49, 196608
    buffer_load_dwordx4 v211, s[20:23], s17 offen lds
    s_add_u32 m0, s46, 4096
    s_add_u32 s17, s49, 262144
    buffer_load_dwordx4 v211, s[20:23], s17 offen lds
    s_add_u32 m0, s46, 5120
    s_add_u32 s17, s49, 327680
    buffer_load_dwordx4 v211, s[20:23], s17 offen lds
    s_add_u32 m0, s46, 6144
    s_add_u32 s17, s49, 393216
    buffer_load_dwordx4 v211, s[20:23], s17 offen lds
    s_add_u32 m0, s46, 7168
    s_add_u32 s17, s49, 458752
    buffer_load_dwordx4 v211, s[20:23], s17 offen lds
    s_add_u32 m0, s46, 8192
    s_add_u32 s17, s49, 524288
    buffer_load_dwordx4 v211, s[20:23], s17 offen lds
    s_add_u32 m0, s46, 9216
    s_add_u32 s17, s49, 589824
    buffer_load_dwordx4 v211, s[20:23], s17 offen lds
    s_add_u32 m0, s46, 10240
    s_add_u32 s17, s49, 655360
    buffer_load_dwordx4 v211, s[20:23], s17 offen lds
    s_add_u32 m0, s46, 11264
    s_add_u32 s17, s49, 720896
    buffer_load_dwordx4 v211, s[20:23], s17 offen lds
    s_add_u32 m0, s46, 12288
    s_add_u32 s17, s49, 786432
    buffer_load_dwordx4 v211, s[20:23], s17 offen lds
    s_add_u32 m0, s46, 13312
    s_add_u32 s17, s49, 851968
    buffer_load_dwordx4 v211, s[20:23], s17 offen lds
    s_add_u32 m0, s46, 14336
    s_add_u32 s17, s49, 917504
    buffer_load_dwordx4 v211, s[20:23], s17 offen lds
    s_add_u32 m0, s46, 15360
    s_add_u32 s17, s49, 983040
    buffer_load_dwordx4 v211, s[20:23], s17 offen lds
    s_add_u32 m0, s46, 16384
    s_add_u32 s17, s49, 1048576
    buffer_load_dwordx4 v211, s[20:23], s17 offen lds
    s_add_u32 m0, s46, 17408
    s_add_u32 s17, s49, 1114112
    buffer_load_dwordx4 v211, s[20:23], s17 offen lds
    s_add_u32 m0, s46, 18432
    s_add_u32 s17, s49, 1179648
    buffer_load_dwordx4 v211, s[20:23], s17 offen lds
    s_add_u32 m0, s46, 19456
    s_add_u32 s17, s49, 1245184
    buffer_load_dwordx4 v211, s[20:23], s17 offen lds
    s_add_u32 m0, s46, 20480
    s_add_u32 s17, s49, 1310720
    buffer_load_dwordx4 v211, s[20:23], s17 offen lds
    s_add_u32 m0, s46, 21504
    s_add_u32 s17, s49, 1376256
    buffer_load_dwordx4 v211, s[20:23], s17 offen lds
    s_add_u32 m0, s46, 22528
    s_add_u32 s17, s49, 1441792
    buffer_load_dwordx4 v211, s[20:23], s17 offen lds
    s_add_u32 m0, s46, 23552
    s_add_u32 s17, s49, 1507328
    buffer_load_dwordx4 v211, s[20:23], s17 offen lds
    s_add_u32 m0, s46, 24576
    s_add_u32 s17, s49, 1572864
    buffer_load_dwordx4 v211, s[20:23], s17 offen lds
    s_add_u32 m0, s46, 25600
    s_add_u32 s17, s49, 1638400
    buffer_load_dwordx4 v211, s[20:23], s17 offen lds
    s_add_u32 m0, s46, 26624
    s_add_u32 s17, s49, 1703936
    buffer_load_dwordx4 v211, s[20:23], s17 offen lds
    s_add_u32 m0, s46, 27648
    s_add_u32 s17, s49, 1769472
    buffer_load_dwordx4 v211, s[20:23], s17 offen lds
    s_add_u32 m0, s46, 28672
    s_add_u32 s17, s49, 1835008
    buffer_load_dwordx4 v211, s[20:23], s17 offen lds
    s_add_u32 m0, s46, 29696
    s_add_u32 s17, s49, 1900544
    buffer_load_dwordx4 v211, s[20:23], s17 offen lds
    s_add_u32 m0, s46, 30720
    s_add_u32 s17, s49, 1966080
    buffer_load_dwordx4 v211, s[20:23], s17 offen lds
    s_add_u32 m0, s46, 31744
    s_add_u32 s17, s49, 2031616
    buffer_load_dwordx4 v211, s[20:23], s17 offen lds
    s_waitcnt vmcnt(30)
    ds_read_b64_tr_b16 a[0:1], v210 offset:0
    ds_read_b64_tr_b16 a[2:3], v210 offset:512
    ds_read_b64_tr_b16 a[144:145], v210 offset:64
    ds_read_b64_tr_b16 a[146:147], v210 offset:576
    s_waitcnt lgkmcnt(0)
    s_add_u32 m0, s46, 0
    s_add_u32 s17, s49, 2097152
    buffer_load_dwordx4 v211, s[20:23], s17 offen lds
    s_add_u32 m0, s46, 1024
    s_add_u32 s17, s49, 2162688
    buffer_load_dwordx4 v211, s[20:23], s17 offen lds
    s_waitcnt vmcnt(30)
    ds_read_b64_tr_b16 a[4:5], v210 offset:2048
    ds_read_b64_tr_b16 a[6:7], v210 offset:2560
    ds_read_b64_tr_b16 a[148:149], v210 offset:2112
    ds_read_b64_tr_b16 a[150:151], v210 offset:2624
    s_waitcnt lgkmcnt(0)
    s_add_u32 m0, s46, 2048
    s_add_u32 s17, s49, 2228224
    buffer_load_dwordx4 v211, s[20:23], s17 offen lds
    s_add_u32 m0, s46, 3072
    s_add_u32 s17, s49, 2293760
    buffer_load_dwordx4 v211, s[20:23], s17 offen lds
    s_waitcnt vmcnt(30)
    ds_read_b64_tr_b16 a[8:9], v210 offset:4096
    ds_read_b64_tr_b16 a[10:11], v210 offset:4608
    ds_read_b64_tr_b16 a[152:153], v210 offset:4160
    ds_read_b64_tr_b16 a[154:155], v210 offset:4672
    s_waitcnt lgkmcnt(0)
    s_add_u32 m0, s46, 4096
    s_add_u32 s17, s49, 2359296
    buffer_load_dwordx4 v211, s[20:23], s17 offen lds
    s_add_u32 m0, s46, 5120
    s_add_u32 s17, s49, 2424832
    buffer_load_dwordx4 v211, s[20:23], s17 offen lds
    s_waitcnt vmcnt(30)
    ds_read_b64_tr_b16 a[12:13], v210 offset:6144
    ds_read_b64_tr_b16 a[14:15], v210 offset:6656
    ds_read_b64_tr_b16 a[156:157], v210 offset:6208
    ds_read_b64_tr_b16 a[158:159], v210 offset:6720
    s_waitcnt lgkmcnt(0)
    s_add_u32 m0, s46, 6144
    s_add_u32 s17, s49, 2490368
    buffer_load_dwordx4 v211, s[20:23], s17 offen lds
    s_add_u32 m0, s46, 7168
    s_add_u32 s17, s49, 2555904
    buffer_load_dwordx4 v211, s[20:23], s17 offen lds
    s_waitcnt vmcnt(30)
    ds_read_b64_tr_b16 a[16:17], v210 offset:8192
    ds_read_b64_tr_b16 a[18:19], v210 offset:8704
    ds_read_b64_tr_b16 a[160:161], v210 offset:8256
    ds_read_b64_tr_b16 a[162:163], v210 offset:8768
    s_waitcnt lgkmcnt(0)
    s_add_u32 m0, s46, 8192
    s_add_u32 s17, s49, 2621440
    buffer_load_dwordx4 v211, s[20:23], s17 offen lds
    s_add_u32 m0, s46, 9216
    s_add_u32 s17, s49, 2686976
    buffer_load_dwordx4 v211, s[20:23], s17 offen lds
    s_waitcnt vmcnt(30)
    ds_read_b64_tr_b16 a[20:21], v210 offset:10240
    ds_read_b64_tr_b16 a[22:23], v210 offset:10752
    ds_read_b64_tr_b16 a[164:165], v210 offset:10304
    ds_read_b64_tr_b16 a[166:167], v210 offset:10816
    s_waitcnt lgkmcnt(0)
    s_add_u32 m0, s46, 10240
    s_add_u32 s17, s49, 2752512
    buffer_load_dwordx4 v211, s[20:23], s17 offen lds
    s_add_u32 m0, s46, 11264
    s_add_u32 s17, s49, 2818048
    buffer_load_dwordx4 v211, s[20:23], s17 offen lds
    s_waitcnt vmcnt(30)
    ds_read_b64_tr_b16 a[24:25], v210 offset:12288
    ds_read_b64_tr_b16 a[26:27], v210 offset:12800
    ds_read_b64_tr_b16 a[168:169], v210 offset:12352
    ds_read_b64_tr_b16 a[170:171], v210 offset:12864
    s_waitcnt lgkmcnt(0)
    s_add_u32 m0, s46, 12288
    s_add_u32 s17, s49, 2883584
    buffer_load_dwordx4 v211, s[20:23], s17 offen lds
    s_add_u32 m0, s46, 13312
    s_add_u32 s17, s49, 2949120
    buffer_load_dwordx4 v211, s[20:23], s17 offen lds
    s_waitcnt vmcnt(30)
    ds_read_b64_tr_b16 a[28:29], v210 offset:14336
    ds_read_b64_tr_b16 a[30:31], v210 offset:14848
    ds_read_b64_tr_b16 a[172:173], v210 offset:14400
    ds_read_b64_tr_b16 a[174:175], v210 offset:14912
    s_waitcnt lgkmcnt(0)
    s_add_u32 m0, s46, 14336
    s_add_u32 s17, s49, 3014656
    buffer_load_dwordx4 v211, s[20:23], s17 offen lds
    s_add_u32 m0, s46, 15360
    s_add_u32 s17, s49, 3080192
    buffer_load_dwordx4 v211, s[20:23], s17 offen lds
    s_waitcnt vmcnt(30)
    ds_read_b64_tr_b16 a[32:33], v210 offset:16384
    ds_read_b64_tr_b16 a[34:35], v210 offset:16896
    ds_read_b64_tr_b16 a[176:177], v210 offset:16448
    ds_read_b64_tr_b16 a[178:179], v210 offset:16960
    s_waitcnt lgkmcnt(0)
    s_add_u32 m0, s46, 16384
    s_add_u32 s17, s49, 3145728
    buffer_load_dwordx4 v211, s[20:23], s17 offen lds
    s_add_u32 m0, s46, 17408
    s_add_u32 s17, s49, 3211264
    buffer_load_dwordx4 v211, s[20:23], s17 offen lds
    s_waitcnt vmcnt(30)
    ds_read_b64_tr_b16 a[36:37], v210 offset:18432
    ds_read_b64_tr_b16 a[38:39], v210 offset:18944
    ds_read_b64_tr_b16 a[180:181], v210 offset:18496
    ds_read_b64_tr_b16 a[182:183], v210 offset:19008
    s_waitcnt lgkmcnt(0)
    s_add_u32 m0, s46, 18432
    s_add_u32 s17, s49, 3276800
    buffer_load_dwordx4 v211, s[20:23], s17 offen lds
    s_add_u32 m0, s46, 19456
    s_add_u32 s17, s49, 3342336
    buffer_load_dwordx4 v211, s[20:23], s17 offen lds
    s_waitcnt vmcnt(30)
    ds_read_b64_tr_b16 a[40:41], v210 offset:20480
    ds_read_b64_tr_b16 a[42:43], v210 offset:20992
    ds_read_b64_tr_b16 a[184:185], v210 offset:20544
    ds_read_b64_tr_b16 a[186:187], v210 offset:21056
    s_waitcnt lgkmcnt(0)
    s_add_u32 m0, s46, 20480
    s_add_u32 s17, s49, 3407872
    buffer_load_dwordx4 v211, s[20:23], s17 offen lds
    s_add_u32 m0, s46, 21504
    s_add_u32 s17, s49, 3473408
    buffer_load_dwordx4 v211, s[20:23], s17 offen lds
    s_waitcnt vmcnt(30)
    ds_read_b64_tr_b16 a[44:45], v210 offset:22528
    ds_read_b64_tr_b16 a[46:47], v210 offset:23040
    ds_read_b64_tr_b16 a[188:189], v210 offset:22592
    ds_read_b64_tr_b16 a[190:191], v210 offset:23104
    s_waitcnt lgkmcnt(0)
    s_add_u32 m0, s46, 22528
    s_add_u32 s17, s49, 3538944
    buffer_load_dwordx4 v211, s[20:23], s17 offen lds
    s_add_u32 m0, s46, 23552
    s_add_u32 s17, s49, 3604480
    buffer_load_dwordx4 v211, s[20:23], s17 offen lds
    s_waitcnt vmcnt(30)
    ds_read_b64_tr_b16 a[48:49], v210 offset:24576
    ds_read_b64_tr_b16 a[50:51], v210 offset:25088
    ds_read_b64_tr_b16 a[192:193], v210 offset:24640
    ds_read_b64_tr_b16 a[194:195], v210 offset:25152
    s_waitcnt lgkmcnt(0)
    s_add_u32 m0, s46, 24576
    s_add_u32 s17, s49, 3670016
    buffer_load_dwordx4 v211, s[20:23], s17 offen lds
    s_add_u32 m0, s46, 25600
    s_add_u32 s17, s49, 3735552
    buffer_load_dwordx4 v211, s[20:23], s17 offen lds
    s_waitcnt vmcnt(30)
    ds_read_b64_tr_b16 a[52:53], v210 offset:26624
    ds_read_b64_tr_b16 a[54:55], v210 offset:27136
    ds_read_b64_tr_b16 a[196:197], v210 offset:26688
    ds_read_b64_tr_b16 a[198:199], v210 offset:27200
    s_waitcnt lgkmcnt(0)
    s_add_u32 m0, s46, 26624
    s_add_u32 s17, s49, 3801088
    buffer_load_dwordx4 v211, s[20:23], s17 offen lds
    s_add_u32 m0, s46, 27648
    s_add_u32 s17, s49, 3866624
    buffer_load_dwordx4 v211, s[20:23], s17 offen lds
    s_waitcnt vmcnt(30)
    ds_read_b64_tr_b16 a[56:57], v210 offset:28672
    ds_read_b64_tr_b16 a[58:59], v210 offset:29184
    ds_read_b64_tr_b16 a[200:201], v210 offset:28736
    ds_read_b64_tr_b16 a[202:203], v210 offset:29248
    s_waitcnt lgkmcnt(0)
    s_add_u32 m0, s46, 28672
    s_add_u32 s17, s49, 3932160
    buffer_load_dwordx4 v211, s[20:23], s17 offen lds
    s_add_u32 m0, s46, 29696
    s_add_u32 s17, s49, 3997696
    buffer_load_dwordx4 v211, s[20:23], s17 offen lds
    s_waitcnt vmcnt(30)
    ds_read_b64_tr_b16 a[60:61], v210 offset:30720
    ds_read_b64_tr_b16 a[62:63], v210 offset:31232
    ds_read_b64_tr_b16 a[204:205], v210 offset:30784
    ds_read_b64_tr_b16 a[206:207], v210 offset:31296
    s_waitcnt lgkmcnt(0)
    s_add_u32 m0, s46, 30720
    s_add_u32 s17, s49, 4063232
    buffer_load_dwordx4 v211, s[20:23], s17 offen lds
    s_add_u32 m0, s46, 31744
    s_add_u32 s17, s49, 4128768
    buffer_load_dwordx4 v211, s[20:23], s17 offen lds
    s_waitcnt vmcnt(30)
    ds_read_b64_tr_b16 a[64:65], v210 offset:0
    ds_read_b64_tr_b16 a[66:67], v210 offset:512
    ds_read_b64_tr_b16 a[208:209], v210 offset:64
    ds_read_b64_tr_b16 a[210:211], v210 offset:576
    s_waitcnt lgkmcnt(0)
    s_add_u32 m0, s46, 0
    s_add_u32 s17, s49, 4194304
    buffer_load_dwordx4 v211, s[20:23], s17 offen lds
    s_add_u32 m0, s46, 1024
    s_add_u32 s17, s49, 4259840
    buffer_load_dwordx4 v211, s[20:23], s17 offen lds
    s_waitcnt vmcnt(30)
    ds_read_b64_tr_b16 a[68:69], v210 offset:2048
    ds_read_b64_tr_b16 a[70:71], v210 offset:2560
    ds_read_b64_tr_b16 a[212:213], v210 offset:2112
    ds_read_b64_tr_b16 a[214:215], v210 offset:2624
    s_waitcnt lgkmcnt(0)
    s_add_u32 m0, s46, 2048
    s_add_u32 s17, s49, 4325376
    buffer_load_dwordx4 v211, s[20:23], s17 offen lds
    s_add_u32 m0, s46, 3072
    s_add_u32 s17, s49, 4390912
    buffer_load_dwordx4 v211, s[20:23], s17 offen lds
    s_waitcnt vmcnt(30)
    ds_read_b64_tr_b16 a[72:73], v210 offset:4096
    ds_read_b64_tr_b16 a[74:75], v210 offset:4608
    ds_read_b64_tr_b16 a[216:217], v210 offset:4160
    ds_read_b64_tr_b16 a[218:219], v210 offset:4672
    s_waitcnt lgkmcnt(0)
    s_add_u32 m0, s46, 4096
    s_add_u32 s17, s49, 4456448
    buffer_load_dwordx4 v211, s[20:23], s17 offen lds
    s_add_u32 m0, s46, 5120
    s_add_u32 s17, s49, 4521984
    buffer_load_dwordx4 v211, s[20:23], s17 offen lds
    s_waitcnt vmcnt(30)
    ds_read_b64_tr_b16 a[76:77], v210 offset:6144
    ds_read_b64_tr_b16 a[78:79], v210 offset:6656
    ds_read_b64_tr_b16 a[220:221], v210 offset:6208
    ds_read_b64_tr_b16 a[222:223], v210 offset:6720
    s_waitcnt lgkmcnt(0)
    s_add_u32 m0, s46, 6144
    s_add_u32 s17, s49, 4587520
    buffer_load_dwordx4 v211, s[20:23], s17 offen lds
    s_add_u32 m0, s46, 7168
    s_add_u32 s17, s49, 4653056
    buffer_load_dwordx4 v211, s[20:23], s17 offen lds
    s_waitcnt vmcnt(30)
    ds_read_b64_tr_b16 a[80:81], v210 offset:8192
    ds_read_b64_tr_b16 a[82:83], v210 offset:8704
    ds_read_b64_tr_b16 a[224:225], v210 offset:8256
    ds_read_b64_tr_b16 a[226:227], v210 offset:8768
    s_waitcnt vmcnt(28)
    ds_read_b64_tr_b16 a[84:85], v210 offset:10240
    ds_read_b64_tr_b16 a[86:87], v210 offset:10752
    ds_read_b64_tr_b16 a[228:229], v210 offset:10304
    ds_read_b64_tr_b16 a[230:231], v210 offset:10816
    s_waitcnt vmcnt(26)
    ds_read_b64_tr_b16 a[88:89], v210 offset:12288
    ds_read_b64_tr_b16 a[90:91], v210 offset:12800
    ds_read_b64_tr_b16 a[232:233], v210 offset:12352
    ds_read_b64_tr_b16 a[234:235], v210 offset:12864
    s_waitcnt vmcnt(24)
    ds_read_b64_tr_b16 a[92:93], v210 offset:14336
    ds_read_b64_tr_b16 a[94:95], v210 offset:14848
    ds_read_b64_tr_b16 a[236:237], v210 offset:14400
    ds_read_b64_tr_b16 a[238:239], v210 offset:14912
    s_waitcnt vmcnt(22)
    ds_read_b64_tr_b16 a[96:97], v210 offset:16384
    ds_read_b64_tr_b16 a[98:99], v210 offset:16896
    ds_read_b64_tr_b16 a[240:241], v210 offset:16448
    ds_read_b64_tr_b16 a[242:243], v210 offset:16960
    s_waitcnt vmcnt(20)
    ds_read_b64_tr_b16 a[100:101], v210 offset:18432
    ds_read_b64_tr_b16 a[102:103], v210 offset:18944
    ds_read_b64_tr_b16 a[244:245], v210 offset:18496
    ds_read_b64_tr_b16 a[246:247], v210 offset:19008
    s_waitcnt vmcnt(18)
    ds_read_b64_tr_b16 a[104:105], v210 offset:20480
    ds_read_b64_tr_b16 a[106:107], v210 offset:20992
    ds_read_b64_tr_b16 a[248:249], v210 offset:20544
    ds_read_b64_tr_b16 a[250:251], v210 offset:21056
    s_waitcnt vmcnt(16)
    ds_read_b64_tr_b16 a[108:109], v210 offset:22528
    ds_read_b64_tr_b16 a[110:111], v210 offset:23040
    ds_read_b64_tr_b16 a[252:253], v210 offset:22592
    ds_read_b64_tr_b16 a[254:255], v210 offset:23104
    s_waitcnt vmcnt(14)
    ds_read_b64_tr_b16 a[112:113], v210 offset:24576
    ds_read_b64_tr_b16 a[114:115], v210 offset:25088
    ds_read_b64_tr_b16 v[224:225], v210 offset:24640
    ds_read_b64_tr_b16 v[226:227], v210 offset:25152
    s_waitcnt vmcnt(12)
    ds_read_b64_tr_b16 a[116:117], v210 offset:26624
    ds_read_b64_tr_b16 a[118:119], v210 offset:27136
    ds_read_b64_tr_b16 v[228:229], v210 offset:26688
    ds_read_b64_tr_b16 v[230:231], v210 offset:27200
    s_waitcnt vmcnt(10)
    ds_read_b64_tr_b16 a[120:121], v210 offset:28672
    ds_read_b64_tr_b16 a[122:123], v210 offset:29184
    ds_read_b64_tr_b16 v[232:233], v210 offset:28736
    ds_read_b64_tr_b16 v[234:235], v210 offset:29248
    s_waitcnt vmcnt(8)
    ds_read_b64_tr_b16 a[124:125], v210 offset:30720
    ds_read_b64_tr_b16 a[126:127], v210 offset:31232
    ds_read_b64_tr_b16 v[236:237], v210 offset:30784
    ds_read_b64_tr_b16 v[238:239], v210 offset:31296
    s_waitcnt vmcnt(6)
    ds_read_b64_tr_b16 a[128:129], v210 offset:0
    ds_read_b64_tr_b16 a[130:131], v210 offset:512
    ds_read_b64_tr_b16 v[240:241], v210 offset:64
    ds_read_b64_tr_b16 v[242:243], v210 offset:576
    s_waitcnt vmcnt(4)
    ds_read_b64_tr_b16 a[132:133], v210 offset:2048
    ds_read_b64_tr_b16 a[134:135], v210 offset:2560
    ds_read_b64_tr_b16 v[244:245], v210 offset:2112
    ds_read_b64_tr_b16 v[246:247], v210 offset:2624
    s_waitcnt vmcnt(2)
    ds_read_b64_tr_b16 a[136:137], v210 offset:4096
    ds_read_b64_tr_b16 a[138:139], v210 offset:4608
    ds_read_b64_tr_b16 v[248:249], v210 offset:4160
    ds_read_b64_tr_b16 v[250:251], v210 offset:4672
    s_waitcnt vmcnt(0)
    ds_read_b64_tr_b16 a[140:141], v210 offset:6144
    ds_read_b64_tr_b16 a[142:143], v210 offset:6656
    ds_read_b64_tr_b16 v[252:253], v210 offset:6208
    ds_read_b64_tr_b16 v[254:255], v210 offset:6720
    s_waitcnt vmcnt(0) lgkmcnt(0)
    v_bfe_u32 v10, v0, 4, 5
    v_lshrrev_b32 v5, 9, v0
    v_lshlrev_b32 v10, 3, v10
    v_mul_u32_u24 v6, 2304, v5
    v_add_u32 v10, v10, v6
    v_add_u32 v10, 114688, v10
    s_lshl_b32 s67, s14, 10
    v_bfe_u32 v6, v0, 8, 1
    v_lshlrev_b32 v13, 10, v6
    v_lshl_add_u32 v13, v7, 4, v13
    v_lshl_add_u32 v13, v5, 8, v13
    v_lshlrev_b32 v215, 3, v0
    v_mov_b32 v212, 1
    v_mov_b32 v213, 1
    s_mul_i32 s52, s50, 16777216
    s_lshl_b32 s17, s51, 13
    s_add_u32 s52, s52, s17
    s_lshl_b32 s17, s47, 12
    s_add_u32 s52, s52, s17
    s_add_u32 s52, s52, 44040192
    s_lshl_b32 s49, s51, 9
    s_lshl_b32 s17, s50, 7
    s_add_u32 s49, s49, s17
    s_lshl_b32 s17, s47, 3
    s_add_u32 s49, s49, s17
    s_add_u32 s49, s49, 185600
    v_mov_b32 v48, 0x3f803f80
    v_mov_b32 v49, 0x3f803f80
    v_mov_b32 v50, 0x3f803f80
    v_mov_b32 v51, 0x3f803f80
    s_lshl_b32 s17, s14, 8
    s_add_u32 s17, s17, 110592
    v_bfe_u32 v5, v0, 4, 5
    v_lshl_add_u32 v14, v5, 2, s17
    v_lshrrev_b32 v5, 9, v0
    v_lshl_add_u32 v214, v5, 4, s17
    s_cmp_eq_u32 s50, 2
    s_cbranch_scc1 Lp_v
    v_mfma_f32_32x32x16_bf16 v[148:163], a[0:3], v[48:51], 0
    v_mfma_f32_32x32x16_bf16 v[148:163], a[4:7], v[48:51], v[148:163]
    v_mfma_f32_32x32x16_bf16 v[148:163], a[8:11], v[48:51], v[148:163]
    v_mfma_f32_32x32x16_bf16 v[148:163], a[12:15], v[48:51], v[148:163]
    v_mfma_f32_32x32x16_bf16 v[148:163], a[16:19], v[48:51], v[148:163]
    v_mfma_f32_32x32x16_bf16 v[148:163], a[20:23], v[48:51], v[148:163]
    v_mfma_f32_32x32x16_bf16 v[148:163], a[24:27], v[48:51], v[148:163]
    v_mfma_f32_32x32x16_bf16 v[148:163], a[28:31], v[48:51], v[148:163]
    v_mfma_f32_32x32x16_bf16 v[148:163], a[32:35], v[48:51], v[148:163]
    v_mfma_f32_32x32x16_bf16 v[148:163], a[36:39], v[48:51], v[148:163]
    v_mfma_f32_32x32x16_bf16 v[148:163], a[40:43], v[48:51], v[148:163]
    v_mfma_f32_32x32x16_bf16 v[148:163], a[44:47], v[48:51], v[148:163]
    v_mfma_f32_32x32x16_bf16 v[148:163], a[48:51], v[48:51], v[148:163]
    v_mfma_f32_32x32x16_bf16 v[148:163], a[52:55], v[48:51], v[148:163]
    v_mfma_f32_32x32x16_bf16 v[148:163], a[56:59], v[48:51], v[148:163]
    v_mfma_f32_32x32x16_bf16 v[148:163], a[60:63], v[48:51], v[148:163]
    v_mfma_f32_32x32x16_bf16 v[148:163], a[64:67], v[48:51], v[148:163]
    v_mfma_f32_32x32x16_bf16 v[148:163], a[68:71], v[48:51], v[148:163]
    v_mfma_f32_32x32x16_bf16 v[148:163], a[72:75], v[48:51], v[148:163]
    v_mfma_f32_32x32x16_bf16 v[148:163], a[76:79], v[48:51], v[148:163]
    v_mfma_f32_32x32x16_bf16 v[148:163], a[80:83], v[48:51], v[148:163]
    v_mfma_f32_32x32x16_bf16 v[148:163], a[84:87], v[48:51], v[148:163]
    v_mfma_f32_32x32x16_bf16 v[148:163], a[88:91], v[48:51], v[148:163]
    v_mfma_f32_32x32x16_bf16 v[148:163], a[92:95], v[48:51], v[148:163]
    v_mfma_f32_32x32x16_bf16 v[148:163], a[96:99], v[48:51], v[148:163]
    v_mfma_f32_32x32x16_bf16 v[148:163], a[100:103], v[48:51], v[148:163]
    v_mfma_f32_32x32x16_bf16 v[148:163], a[104:107], v[48:51], v[148:163]
    v_mfma_f32_32x32x16_bf16 v[148:163], a[108:111], v[48:51], v[148:163]
    v_mfma_f32_32x32x16_bf16 v[148:163], a[112:115], v[48:51], v[148:163]
    v_mfma_f32_32x32x16_bf16 v[148:163], a[116:119], v[48:51], v[148:163]
    v_mfma_f32_32x32x16_bf16 v[148:163], a[120:123], v[48:51], v[148:163]
    v_mfma_f32_32x32x16_bf16 v[148:163], a[124:127], v[48:51], v[148:163]
    v_mfma_f32_32x32x16_bf16 v[148:163], a[128:131], v[48:51], v[148:163]
    v_mfma_f32_32x32x16_bf16 v[148:163], a[132:135], v[48:51], v[148:163]
    v_mfma_f32_32x32x16_bf16 v[148:163], a[136:139], v[48:51], v[148:163]
    v_mfma_f32_32x32x16_bf16 v[148:163], a[140:143], v[48:51], v[148:163]
    v_mfma_f32_32x32x16_bf16 v[164:179], a[144:147], v[48:51], 0
    v_mfma_f32_32x32x16_bf16 v[164:179], a[148:151], v[48:51], v[164:179]
    v_mfma_f32_32x32x16_bf16 v[164:179], a[152:155], v[48:51], v[164:179]
    v_mfma_f32_32x32x16_bf16 v[164:179], a[156:159], v[48:51], v[164:179]
    v_mfma_f32_32x32x16_bf16 v[164:179], a[160:163], v[48:51], v[164:179]
    v_mfma_f32_32x32x16_bf16 v[164:179], a[164:167], v[48:51], v[164:179]
    v_mfma_f32_32x32x16_bf16 v[164:179], a[168:171], v[48:51], v[164:179]
    v_mfma_f32_32x32x16_bf16 v[164:179], a[172:175], v[48:51], v[164:179]
    v_mfma_f32_32x32x16_bf16 v[164:179], a[176:179], v[48:51], v[164:179]
    v_mfma_f32_32x32x16_bf16 v[164:179], a[180:183], v[48:51], v[164:179]
    v_mfma_f32_32x32x16_bf16 v[164:179], a[184:187], v[48:51], v[164:179]
    v_mfma_f32_32x32x16_bf16 v[164:179], a[188:191], v[48:51], v[164:179]
    v_mfma_f32_32x32x16_bf16 v[164:179], a[192:195], v[48:51], v[164:179]
    v_mfma_f32_32x32x16_bf16 v[164:179], a[196:199], v[48:51], v[164:179]
    v_mfma_f32_32x32x16_bf16 v[164:179], a[200:203], v[48:51], v[164:179]
    v_mfma_f32_32x32x16_bf16 v[164:179], a[204:207], v[48:51], v[164:179]
    v_mfma_f32_32x32x16_bf16 v[164:179], a[208:211], v[48:51], v[164:179]
    v_mfma_f32_32x32x16_bf16 v[164:179], a[212:215], v[48:51], v[164:179]
    v_mfma_f32_32x32x16_bf16 v[164:179], a[216:219], v[48:51], v[164:179]
    v_mfma_f32_32x32x16_bf16 v[164:179], a[220:223], v[48:51], v[164:179]
    v_mfma_f32_32x32x16_bf16 v[164:179], a[224:227], v[48:51], v[164:179]
    v_mfma_f32_32x32x16_bf16 v[164:179], a[228:231], v[48:51], v[164:179]
    v_mfma_f32_32x32x16_bf16 v[164:179], a[232:235], v[48:51], v[164:179]
    v_mfma_f32_32x32x16_bf16 v[164:179], a[236:239], v[48:51], v[164:179]
    v_mfma_f32_32x32x16_bf16 v[164:179], a[240:243], v[48:51], v[164:179]
    v_mfma_f32_32x32x16_bf16 v[164:179], a[244:247], v[48:51], v[164:179]
    v_mfma_f32_32x32x16_bf16 v[164:179], a[248:251], v[48:51], v[164:179]
    v_mfma_f32_32x32x16_bf16 v[164:179], a[252:255], v[48:51], v[164:179]
    v_mfma_f32_32x32x16_bf16 v[164:179], v[224:227], v[48:51], v[164:179]
    v_mfma_f32_32x32x16_bf16 v[164:179], v[228:231], v[48:51], v[164:179]
    v_mfma_f32_32x32x16_bf16 v[164:179], v[232:235], v[48:51], v[164:179]
    v_mfma_f32_32x32x16_bf16 v[164:179], v[236:239], v[48:51], v[164:179]
    v_mfma_f32_32x32x16_bf16 v[164:179], v[240:243], v[48:51], v[164:179]
    v_mfma_f32_32x32x16_bf16 v[164:179], v[244:247], v[48:51], v[164:179]
    v_mfma_f32_32x32x16_bf16 v[164:179], v[248:251], v[48:51], v[164:179]
    v_mfma_f32_32x32x16_bf16 v[164:179], v[252:255], v[48:51], v[164:179]
    s_mov_b32 s66, 114688
    s_mov_b32 s71, 0x2000
    s_mov_b32 s36, s63
    s_mov_b32 s34, s63
    s_mov_b32 s37, 0
    s_lshl_b32 s56, s63, 6
    s_mul_i32 s58, s14, 9216
    s_mov_b32 s40, 36864
    s_mov_b32 s59, s58
    s_mov_b32 s43, 0
    s_mov_b32 s28, s8
    s_mov_b32 s29, s9
    s_mov_b32 s30, 0
    s_mov_b32 s31, 0x00020000
    s_mul_i32 s41, s63, 4718592
    s_add_u32 s41, s41, s58
    s_add_u32 s41, s41, 8650752
    s_mul_i32 s42, s56, 22528
    s_add_u32 s42, s42, 183808
    s_cmp_lg_u32 s14, 0
    s_cbranch_scc1 LpQ_ini_d
    v_mov_b32 v5, 160
    s_mov_b32 s16, 0
LpQ_ini:
    global_load_dword v6, v5, s[12:13] sc1
    s_add_u32 s16, s16, 1
    s_cmp_gt_u32 s16, 100000
    s_cbranch_scc1 L_role_p_abort
    s_waitcnt vmcnt(0)
    v_cmp_gt_u32 vcc, 123, v6
    s_nop 0
    s_cbranch_vccz LpQ_ini_d
    s_sleep 8
    s_branch LpQ_ini
LpQ_ini_d:
    s_barrier
    s_branch LpQ_poll
LpQ_item:
    s_waitcnt vmcnt(4)
LpQ_go:
    s_barrier
    s_xor_b32 s40, s40, 36864
    s_xor_b32 s59, s59, 36864
    s_xor_b32 s66, s66, 0x2000
    s_xor_b32 s71, s71, 0x2000
    s_mov_b32 s35, s37
    s_mov_b32 s57, s56
    s_add_u32 s37, s37, 1
    s_add_u32 s56, s56, 1
    s_add_u32 s41, s41, 36864
    s_add_u32 s42, s42, 22528
    s_mov_b32 s62, 0
    v_add_u32 v9, s40, v0
    v_add_u32 v5, s71, v10
    ds_read_b128 v[48:51], v9 offset:0
    ds_read_b128 v[52:55], v9 offset:1024
    ds_read_b128 v[56:59], v9 offset:2048
    s_waitcnt lgkmcnt(2)
    v_mfma_f32_32x32x16_bf16 v[16:31], a[0:3], v[48:51], 0
    ds_read_b128 v[60:63], v9 offset:3072
    ds_read_b64 v[96:97], v5 offset:0
    ds_read_b64 v[98:99], v5 offset:256
    s_waitcnt lgkmcnt(4)
    v_mfma_f32_32x32x16_bf16 v[16:31], a[4:7], v[52:55], v[16:31]
    ds_read_b128 v[64:67], v9 offset:4096
    ds_read_b64 v[100:101], v5 offset:512
    ds_read_b64 v[102:103], v5 offset:768
    s_waitcnt lgkmcnt(6)
    v_mfma_f32_32x32x16_bf16 v[16:31], a[8:11], v[56:59], v[16:31]
    ds_read_b128 v[68:71], v9 offset:5120
    ds_read_b64 v[104:105], v5 offset:1024
    ds_read_b64 v[106:107], v5 offset:1280
    s_waitcnt lgkmcnt(8)
    v_mfma_f32_32x32x16_bf16 v[16:31], a[12:15], v[60:63], v[16:31]
    ds_read_b128 v[72:75], v9 offset:6144
    ds_read_b64 v[108:109], v5 offset:1536
    ds_read_b64 v[110:111], v5 offset:1792
    s_waitcnt lgkmcnt(8)
    v_mfma_f32_32x32x16_bf16 v[16:31], a[16:19], v[64:67], v[16:31]
    ds_read_b128 v[76:79], v9 offset:7168
    ds_read_b64 v[112:113], v5 offset:2048
    s_waitcnt lgkmcnt(7)
    v_mfma_f32_32x32x16_bf16 v[16:31], a[20:23], v[68:71], v[16:31]
    ds_read_b128 v[80:83], v9 offset:8192
    v_add_f32 v96, v96, v98
    s_waitcnt lgkmcnt(5)
    v_mfma_f32_32x32x16_bf16 v[16:31], a[24:27], v[72:75], v[16:31]
    ds_read_b128 v[84:87], v9 offset:9216
    v_add_f32 v97, v97, v99
    v_add_f32 v96, v96, v100
    s_waitcnt lgkmcnt(3)
    v_mfma_f32_32x32x16_bf16 v[16:31], a[28:31], v[76:79], v[16:31]
    ds_read_b128 v[88:91], v9 offset:10240
    v_add_f32 v97, v97, v101
    v_add_f32 v96, v96, v102
    s_waitcnt lgkmcnt(2)
    v_mfma_f32_32x32x16_bf16 v[16:31], a[32:35], v[80:83], v[16:31]
    ds_read_b128 v[92:95], v9 offset:11264
    v_add_f32 v97, v97, v103
    v_add_f32 v96, v96, v104
    v_mfma_f32_32x32x16_bf16 v[32:47], a[144:147], v[48:51], 0
    v_add_f32 v97, v97, v105
    v_add_f32 v96, v96, v106
    s_waitcnt lgkmcnt(2)
    v_mfma_f32_32x32x16_bf16 v[16:31], a[36:39], v[84:87], v[16:31]
    ds_read_b128 v[48:51], v9 offset:12288
    v_add_f32 v97, v97, v107
    v_add_f32 v96, v96, v108
    v_mfma_f32_32x32x16_bf16 v[32:47], a[148:151], v[52:55], v[32:47]
    v_add_f32 v97, v97, v109
    v_add_f32 v96, v96, v110
    s_waitcnt lgkmcnt(2)
    v_mfma_f32_32x32x16_bf16 v[16:31], a[40:43], v[88:91], v[16:31]
    ds_read_b128 v[52:55], v9 offset:13312
    v_add_f32 v97, v97, v111
    v_add_f32 v96, v96, v112
    v_mfma_f32_32x32x16_bf16 v[32:47], a[152:155], v[56:59], v[32:47]
    v_add_f32 v97, v97, v113
    v_mov_b32 v98, v96
    s_waitcnt lgkmcnt(2)
    v_mfma_f32_32x32x16_bf16 v[16:31], a[44:47], v[92:95], v[16:31]
    ds_read_b128 v[56:59], v9 offset:14336
    v_mov_b32 v99, v97
    v_permlane32_swap_b32 v96, v98
    v_mfma_f32_32x32x16_bf16 v[32:47], a[156:159], v[60:63], v[32:47]
    v_permlane32_swap_b32 v97, v99
    v_add_f32 v96, v96, v98
    s_waitcnt lgkmcnt(2)
    v_mfma_f32_32x32x16_bf16 v[16:31], a[48:51], v[48:51], v[16:31]
    ds_read_b128 v[60:63], v9 offset:15360
    v_add_f32 v97, v97, v99
    v_mul_f32 v96, 0x3ae38e39, v96
    v_mfma_f32_32x32x16_bf16 v[32:47], a[160:163], v[64:67], v[32:47]
    v_mul_f32 v97, 0x3ae38e39, v97
    v_fma_f32 v97, -v96, v96, v97
    s_waitcnt lgkmcnt(2)
    v_mfma_f32_32x32x16_bf16 v[16:31], a[52:55], v[52:55], v[16:31]
    ds_read_b128 v[64:67], v9 offset:16384
    v_max_f32 v97, 0, v97
    v_add_f32 v97, 0x3727c5ac, v97
    v_mfma_f32_32x32x16_bf16 v[32:47], a[164:167], v[68:71], v[32:47]
    v_rsq_f32 v116, v97
    s_nop 0
    v_mul_f32 v117, v96, v116
    s_waitcnt lgkmcnt(2)
    v_mfma_f32_32x32x16_bf16 v[16:31], a[56:59], v[56:59], v[16:31]
    ds_read_b128 v[68:71], v9 offset:17408
    s_waitcnt vmcnt(0)
    buffer_load_dword v2, v1, s[8:11], s42 offen sc1
    s_cmp_lg_u32 s43, 0
    s_cselect_b64 exec, 1, 0
    buffer_store_dwordx2 v[212:213], v4, s[8:11], s43 offen sc1
    s_mov_b64 exec, -1
    s_mov_b32 s43, 0
    v_mfma_f32_32x32x16_bf16 v[32:47], a[168:171], v[72:75], v[32:47]
    s_mul_i32 s46, s34, 50331648
    s_lshl_b32 s19, s35, 18
    s_waitcnt lgkmcnt(2)
    v_mfma_f32_32x32x16_bf16 v[16:31], a[60:63], v[60:63], v[16:31]
    ds_read_b128 v[72:75], v9 offset:18432
    s_add_u32 s46, s46, s19
    s_add_u32 s46, s46, s52
    v_mfma_f32_32x32x16_bf16 v[32:47], a[172:175], v[76:79], v[32:47]
    s_waitcnt lgkmcnt(2)
    v_mfma_f32_32x32x16_bf16 v[16:31], a[64:67], v[64:67], v[16:31]
    ds_read_b128 v[76:79], v9 offset:19456
    v_mfma_f32_32x32x16_bf16 v[32:47], a[176:179], v[80:83], v[32:47]
    s_waitcnt lgkmcnt(2)
    v_mfma_f32_32x32x16_bf16 v[16:31], a[68:71], v[68:71], v[16:31]
    ds_read_b128 v[80:83], v9 offset:20480
    v_mfma_f32_32x32x16_bf16 v[32:47], a[180:183], v[84:87], v[32:47]
    s_waitcnt lgkmcnt(2)
    v_mfma_f32_32x32x16_bf16 v[16:31], a[72:75], v[72:75], v[16:31]
    ds_read_b128 v[84:87], v9 offset:21504
    v_mfma_f32_32x32x16_bf16 v[32:47], a[184:187], v[88:91], v[32:47]
    s_waitcnt lgkmcnt(2)
    v_mfma_f32_32x32x16_bf16 v[16:31], a[76:79], v[76:79], v[16:31]
    ds_read_b128 v[88:91], v9 offset:22528
    v_mfma_f32_32x32x16_bf16 v[32:47], a[188:191], v[92:95], v[32:47]
    s_waitcnt lgkmcnt(2)
    v_mfma_f32_32x32x16_bf16 v[16:31], a[80:83], v[80:83], v[16:31]
    ds_read_b128 v[92:95], v9 offset:23552
    v_mfma_f32_32x32x16_bf16 v[32:47], a[192:195], v[48:51], v[32:47]
    s_waitcnt lgkmcnt(2)
    v_mfma_f32_32x32x16_bf16 v[16:31], a[84:87], v[84:87], v[16:31]
    ds_read_b128 v[48:51], v9 offset:24576
    v_mfma_f32_32x32x16_bf16 v[32:47], a[196:199], v[52:55], v[32:47]
    s_waitcnt lgkmcnt(2)
    v_mfma_f32_32x32x16_bf16 v[16:31], a[88:91], v[88:91], v[16:31]
    ds_read_b128 v[52:55], v9 offset:25600
    v_mfma_f32_32x32x16_bf16 v[32:47], a[200:203], v[56:59], v[32:47]
    s_waitcnt lgkmcnt(2)
    v_mfma_f32_32x32x16_bf16 v[16:31], a[92:95], v[92:95], v[16:31]
    ds_read_b128 v[56:59], v9 offset:26624
    v_mfma_f32_32x32x16_bf16 v[32:47], a[204:207], v[60:63], v[32:47]
    s_waitcnt lgkmcnt(2)
    v_mfma_f32_32x32x16_bf16 v[16:31], a[96:99], v[48:51], v[16:31]
    ds_read_b128 v[60:63], v9 offset:27648
    v_mfma_f32_32x32x16_bf16 v[32:47], a[208:211], v[64:67], v[32:47]
    s_waitcnt lgkmcnt(2)
    v_mfma_f32_32x32x16_bf16 v[16:31], a[100:103], v[52:55], v[16:31]
    ds_read_b128 v[64:67], v9 offset:28672
    s_waitcnt vmcnt(1)
    v_cmp_eq_u32 vcc, 0, v2
    s_nop 0
    s_cmp_eq_u64 vcc, 0
    s_cselect_b32 s62, 1, 0
    s_cmp_lt_u32 s37, 64
    s_cselect_b32 s62, s62, 0
    s_cmp_lg_u32 s62, 0
    s_cselect_b32 s30, 268435456, 0
    v_mfma_f32_32x32x16_bf16 v[32:47], a[212:215], v[68:71], v[32:47]
    s_waitcnt lgkmcnt(2)
    v_mfma_f32_32x32x16_bf16 v[16:31], a[104:107], v[56:59], v[16:31]
    ds_read_b128 v[68:71], v9 offset:29696
    s_add_u32 m0, s59, 0
    s_add_u32 s47, s41, 0
    buffer_load_dwordx4 v0, s[28:31], s47 offen offset:0 lds
    v_mfma_f32_32x32x16_bf16 v[32:47], a[216:219], v[72:75], v[32:47]
    s_waitcnt lgkmcnt(2)
    v_mfma_f32_32x32x16_bf16 v[16:31], a[108:111], v[60:63], v[16:31]
    ds_read_b128 v[72:75], v9 offset:30720
    buffer_load_dwordx4 v0, s[28:31], s47 offen offset:1024 lds
    v_mfma_f32_32x32x16_bf16 v[32:47], a[220:223], v[76:79], v[32:47]
    s_waitcnt lgkmcnt(2)
    v_mfma_f32_32x32x16_bf16 v[16:31], a[112:115], v[64:67], v[16:31]
    ds_read_b128 v[76:79], v9 offset:31744
    buffer_load_dwordx4 v0, s[28:31], s47 offen offset:2048 lds
    v_mfma_f32_32x32x16_bf16 v[32:47], a[224:227], v[80:83], v[32:47]
    s_waitcnt lgkmcnt(2)
    v_mfma_f32_32x32x16_bf16 v[16:31], a[116:119], v[68:71], v[16:31]
    ds_read_b128 v[80:83], v9 offset:32768
    buffer_load_dwordx4 v0, s[28:31], s47 offen offset:3072 lds
    v_mfma_f32_32x32x16_bf16 v[32:47], a[228:231], v[84:87], v[32:47]
    s_waitcnt lgkmcnt(2)
    v_mfma_f32_32x32x16_bf16 v[16:31], a[120:123], v[72:75], v[16:31]
    ds_read_b128 v[84:87], v9 offset:33792
    s_add_u32 m0, s59, 4096
    s_add_u32 s47, s41, 4096
    buffer_load_dwordx4 v0, s[28:31], s47 offen offset:0 lds
    v_mfma_f32_32x32x16_bf16 v[32:47], a[232:235], v[88:91], v[32:47]
    s_waitcnt lgkmcnt(2)
    v_mfma_f32_32x32x16_bf16 v[16:31], a[124:127], v[76:79], v[16:31]
    ds_read_b128 v[88:91], v9 offset:34816
    buffer_load_dwordx4 v0, s[28:31], s47 offen offset:1024 lds
    v_mfma_f32_32x32x16_bf16 v[32:47], a[236:239], v[92:95], v[32:47]
    s_waitcnt lgkmcnt(2)
    v_mfma_f32_32x32x16_bf16 v[16:31], a[128:131], v[80:83], v[16:31]
    ds_read_b128 v[92:95], v9 offset:35840
    buffer_load_dwordx4 v0, s[28:31], s47 offen offset:2048 lds
    v_mfma_f32_32x32x16_bf16 v[32:47], a[240:243], v[48:51], v[32:47]
    s_waitcnt lgkmcnt(2)
    v_mfma_f32_32x32x16_bf16 v[16:31], a[132:135], v[84:87], v[16:31]
    buffer_load_dwordx4 v0, s[28:31], s47 offen offset:3072 lds
    v_mfma_f32_32x32x16_bf16 v[32:47], a[244:247], v[52:55], v[32:47]
    s_waitcnt lgkmcnt(1)
    v_mfma_f32_32x32x16_bf16 v[16:31], a[136:139], v[88:91], v[16:31]
    s_add_u32 m0, s59, 8192
    s_add_u32 s47, s41, 8192
    buffer_load_dwordx4 v0, s[28:31], s47 offen offset:0 lds
    v_mfma_f32_32x32x16_bf16 v[32:47], a[248:251], v[56:59], v[32:47]
    s_waitcnt lgkmcnt(0)
    v_mfma_f32_32x32x16_bf16 v[16:31], a[140:143], v[92:95], v[16:31]
    s_mul_i32 s48, s36, 786432
    s_mul_i32 s18, s37, 6144
    s_add_u32 s48, s48, s18
    s_add_u32 s48, s48, 16125952
    s_add_u32 m0, s66, 4096
    s_nop 0
    buffer_load_dwordx4 v0, s[28:31], s48 offen lds
    v_mfma_f32_32x32x16_bf16 v[32:47], a[252:255], v[60:63], v[32:47]
    v_mfma_f32_32x32x16_bf16 v[32:47], v[224:227], v[64:67], v[32:47]
    s_add_u32 m0, s66, s67
    s_sub_u32 s48, s48, 4096
    s_add_u32 s48, s48, s67
    buffer_load_dwordx4 v0, s[28:31], s48 offen lds
    v_mfma_f32_32x32x16_bf16 v[32:47], v[228:231], v[68:71], v[32:47]
    v_mul_f32 v180, v117, v148
    v_fma_f32 v16, v16, v116, -v180
    v_mul_f32 v184, v117, v152
    v_fma_f32 v20, v20, v116, -v184
    v_cvt_pk_bf16_f32 v196, v16, v20
    v_mfma_f32_32x32x16_bf16 v[32:47], v[232:235], v[72:75], v[32:47]
    v_mul_f32 v181, v117, v149
    v_fma_f32 v17, v17, v116, -v181
    v_mul_f32 v185, v117, v153
    v_fma_f32 v21, v21, v116, -v185
    v_cvt_pk_bf16_f32 v197, v17, v21
    v_mfma_f32_32x32x16_bf16 v[32:47], v[236:239], v[76:79], v[32:47]
    v_mul_f32 v182, v117, v150
    v_fma_f32 v18, v18, v116, -v182
    v_mul_f32 v186, v117, v154
    v_fma_f32 v22, v22, v116, -v186
    v_cvt_pk_bf16_f32 v198, v18, v22
    v_mfma_f32_32x32x16_bf16 v[32:47], v[240:243], v[80:83], v[32:47]
    v_mul_f32 v183, v117, v151
    v_fma_f32 v19, v19, v116, -v183
    v_mul_f32 v187, v117, v155
    v_fma_f32 v23, v23, v116, -v187
    v_cvt_pk_bf16_f32 v199, v19, v23
    v_mfma_f32_32x32x16_bf16 v[32:47], v[244:247], v[84:87], v[32:47]
    buffer_store_dwordx4 v[196:199], v13, s[8:11], s46 offen offset:0 sc1
    v_mul_f32 v188, v117, v156
    v_fma_f32 v24, v24, v116, -v188
    v_mul_f32 v192, v117, v160
    v_fma_f32 v28, v28, v116, -v192
    v_mfma_f32_32x32x16_bf16 v[32:47], v[248:251], v[88:91], v[32:47]
    v_cvt_pk_bf16_f32 v200, v24, v28
    v_mul_f32 v189, v117, v157
    v_fma_f32 v25, v25, v116, -v189
    v_mul_f32 v193, v117, v161
    v_fma_f32 v29, v29, v116, -v193
    v_mfma_f32_32x32x16_bf16 v[32:47], v[252:255], v[92:95], v[32:47]
    v_cvt_pk_bf16_f32 v201, v25, v29
    v_mul_f32 v190, v117, v158
    v_fma_f32 v26, v26, v116, -v190
    v_mul_f32 v194, v117, v162
    v_fma_f32 v30, v30, v116, -v194
    v_cvt_pk_bf16_f32 v202, v26, v30
    v_mul_f32 v191, v117, v159
    v_fma_f32 v27, v27, v116, -v191
    v_mul_f32 v195, v117, v163
    v_fma_f32 v31, v31, v116, -v195
    v_cvt_pk_bf16_f32 v203, v27, v31
    buffer_store_dwordx4 v[200:203], v13, s[8:11], s46 offen offset:512 sc1
    v_mul_f32 v180, v117, v164
    v_fma_f32 v32, v32, v116, -v180
    v_mul_f32 v184, v117, v168
    v_fma_f32 v36, v36, v116, -v184
    v_cvt_pk_bf16_f32 v196, v32, v36
    v_mul_f32 v181, v117, v165
    v_fma_f32 v33, v33, v116, -v181
    v_mul_f32 v185, v117, v169
    v_fma_f32 v37, v37, v116, -v185
    v_cvt_pk_bf16_f32 v197, v33, v37
    v_mul_f32 v182, v117, v166
    v_fma_f32 v34, v34, v116, -v182
    v_mul_f32 v186, v117, v170
    v_fma_f32 v38, v38, v116, -v186
    v_cvt_pk_bf16_f32 v198, v34, v38
    v_mul_f32 v183, v117, v167
    v_fma_f32 v35, v35, v116, -v183
    v_mul_f32 v187, v117, v171
    v_fma_f32 v39, v39, v116, -v187
    v_cvt_pk_bf16_f32 v199, v35, v39
    buffer_store_dwordx4 v[196:199], v13, s[8:11], s46 offen offset:2048 sc1
    v_mul_f32 v188, v117, v172
    v_fma_f32 v40, v40, v116, -v188
    v_mul_f32 v192, v117, v176
    v_fma_f32 v44, v44, v116, -v192
    v_cvt_pk_bf16_f32 v200, v40, v44
    v_mul_f32 v189, v117, v173
    v_fma_f32 v41, v41, v116, -v189
    v_mul_f32 v193, v117, v177
    v_fma_f32 v45, v45, v116, -v193
    v_cvt_pk_bf16_f32 v201, v41, v45
    v_mul_f32 v190, v117, v174
    v_fma_f32 v42, v42, v116, -v190
    v_mul_f32 v194, v117, v178
    v_fma_f32 v46, v46, v116, -v194
    v_cvt_pk_bf16_f32 v202, v42, v46
    v_mul_f32 v191, v117, v175
    v_fma_f32 v43, v43, v116, -v191
    v_mul_f32 v195, v117, v179
    v_fma_f32 v47, v47, v116, -v195
    v_cvt_pk_bf16_f32 v203, v43, v47
    buffer_store_dwordx4 v[200:203], v13, s[8:11], s46 offen offset:2560 sc1
    s_mul_i32 s43, s57, 22528
    s_add_u32 s43, s43, s49
    s_cmp_lg_u32 s62, 0
    s_cbranch_scc1 LpQ_item
    buffer_load_dword v2, v1, s[8:11], s42 offen sc1
    s_waitcnt vmcnt(0)
    s_cmp_ge_u32 s37, 64
    s_cbranch_scc1 LpQ_fin
    v_cmp_eq_u32 vcc, 0, v2
    s_nop 0
    s_cmp_lg_u64 vcc, 0
    s_cbranch_scc1 LpQ_pub
    s_add_u32 m0, s59, 0
    s_add_u32 s47, s41, 0
    buffer_load_dwordx4 v0, s[8:11], s47 offen offset:0 lds
    buffer_load_dwordx4 v0, s[8:11], s47 offen offset:1024 lds
    buffer_load_dwordx4 v0, s[8:11], s47 offen offset:2048 lds
    buffer_load_dwordx4 v0, s[8:11], s47 offen offset:3072 lds
    s_add_u32 m0, s59, 4096
    s_add_u32 s47, s41, 4096
    buffer_load_dwordx4 v0, s[8:11], s47 offen offset:0 lds
    buffer_load_dwordx4 v0, s[8:11], s47 offen offset:1024 lds
    buffer_load_dwordx4 v0, s[8:11], s47 offen offset:2048 lds
    buffer_load_dwordx4 v0, s[8:11], s47 offen offset:3072 lds
    s_add_u32 m0, s59, 8192
    s_add_u32 s47, s41, 8192
    buffer_load_dwordx4 v0, s[8:11], s47 offen offset:0 lds
    s_mul_i32 s48, s36, 786432
    s_mul_i32 s18, s37, 6144
    s_add_u32 s48, s48, s18
    s_add_u32 s48, s48, 16125952
    s_add_u32 m0, s66, 4096
    s_nop 0
    buffer_load_dwordx4 v0, s[8:11], s48 offen lds
    s_add_u32 m0, s66, s67
    s_sub_u32 s48, s48, 4096
    s_add_u32 s48, s48, s67
    buffer_load_dwordx4 v0, s[8:11], s48 offen lds
    s_cmp_lg_u32 s43, 0
    s_cselect_b64 exec, 1, 0
    buffer_store_dwordx2 v[212:213], v4, s[8:11], s43 offen sc1
    s_mov_b64 exec, -1
    s_mov_b32 s43, 0
    s_waitcnt vmcnt(1)
    s_branch LpQ_go
LpQ_fin:
    s_cmp_lg_u32 s43, 0
    s_cselect_b64 exec, 1, 0
    buffer_store_dwordx2 v[212:213], v4, s[8:11], s43 offen sc1
    s_mov_b64 exec, -1
    s_mov_b32 s43, 0
    s_branch L_role_p_exit
LpQ_pub:
    s_cmp_lg_u32 s43, 0
    s_cselect_b64 exec, 1, 0
    buffer_store_dwordx2 v[212:213], v4, s[8:11], s43 offen sc1
    s_mov_b64 exec, -1
    s_mov_b32 s43, 0
LpQ_poll:
    s_mov_b32 s16, 0
LpQ_pl:
    buffer_load_dword v2, v1, s[8:11], s42 offen sc1
    s_add_u32 s16, s16, 1
    s_cmp_gt_u32 s16, 100000
    s_cbranch_scc1 L_role_p_abort
    s_waitcnt vmcnt(0)
    v_cmp_eq_u32 vcc, 0, v2
    s_nop 0
    s_cmp_eq_u64 vcc, 0
    s_cbranch_scc1 LpQ_pld
    s_sleep 4
    s_branch LpQ_pl
LpQ_pld:
    s_add_u32 m0, s59, 0
    s_add_u32 s47, s41, 0
    buffer_load_dwordx4 v0, s[8:11], s47 offen offset:0 lds
    buffer_load_dwordx4 v0, s[8:11], s47 offen offset:1024 lds
    buffer_load_dwordx4 v0, s[8:11], s47 offen offset:2048 lds
    buffer_load_dwordx4 v0, s[8:11], s47 offen offset:3072 lds
    s_add_u32 m0, s59, 4096
    s_add_u32 s47, s41, 4096
    buffer_load_dwordx4 v0, s[8:11], s47 offen offset:0 lds
    buffer_load_dwordx4 v0, s[8:11], s47 offen offset:1024 lds
    buffer_load_dwordx4 v0, s[8:11], s47 offen offset:2048 lds
    buffer_load_dwordx4 v0, s[8:11], s47 offen offset:3072 lds
    s_add_u32 m0, s59, 8192
    s_add_u32 s47, s41, 8192
    buffer_load_dwordx4 v0, s[8:11], s47 offen offset:0 lds
    s_mul_i32 s48, s36, 786432
    s_mul_i32 s18, s37, 6144
    s_add_u32 s48, s48, s18
    s_add_u32 s48, s48, 16125952
    s_add_u32 m0, s66, 4096
    s_nop 0
    buffer_load_dwordx4 v0, s[8:11], s48 offen lds
    s_add_u32 m0, s66, s67
    s_sub_u32 s48, s48, 4096
    s_add_u32 s48, s48, s67
    buffer_load_dwordx4 v0, s[8:11], s48 offen lds
    s_waitcnt vmcnt(0)
    s_branch LpQ_go
Lp_v:
    v_mfma_f32_32x32x16_bf16 v[16:31], v[48:51], a[0:3], 0
    v_mfma_f32_32x32x16_bf16 v[16:31], v[48:51], a[4:7], v[16:31]
    v_mfma_f32_32x32x16_bf16 v[16:31], v[48:51], a[8:11], v[16:31]
    v_mfma_f32_32x32x16_bf16 v[16:31], v[48:51], a[12:15], v[16:31]
    v_mfma_f32_32x32x16_bf16 v[16:31], v[48:51], a[16:19], v[16:31]
    v_mfma_f32_32x32x16_bf16 v[16:31], v[48:51], a[20:23], v[16:31]
    v_mfma_f32_32x32x16_bf16 v[16:31], v[48:51], a[24:27], v[16:31]
    v_mfma_f32_32x32x16_bf16 v[16:31], v[48:51], a[28:31], v[16:31]
    v_mfma_f32_32x32x16_bf16 v[16:31], v[48:51], a[32:35], v[16:31]
    v_mfma_f32_32x32x16_bf16 v[16:31], v[48:51], a[36:39], v[16:31]
    v_mfma_f32_32x32x16_bf16 v[16:31], v[48:51], a[40:43], v[16:31]
    v_mfma_f32_32x32x16_bf16 v[16:31], v[48:51], a[44:47], v[16:31]
    v_mfma_f32_32x32x16_bf16 v[16:31], v[48:51], a[48:51], v[16:31]
    v_mfma_f32_32x32x16_bf16 v[16:31], v[48:51], a[52:55], v[16:31]
    v_mfma_f32_32x32x16_bf16 v[16:31], v[48:51], a[56:59], v[16:31]
    v_mfma_f32_32x32x16_bf16 v[16:31], v[48:51], a[60:63], v[16:31]
    v_mfma_f32_32x32x16_bf16 v[16:31], v[48:51], a[64:67], v[16:31]
    v_mfma_f32_32x32x16_bf16 v[16:31], v[48:51], a[68:71], v[16:31]
    v_mfma_f32_32x32x16_bf16 v[16:31], v[48:51], a[72:75], v[16:31]
    v_mfma_f32_32x32x16_bf16 v[16:31], v[48:51], a[76:79], v[16:31]
    v_mfma_f32_32x32x16_bf16 v[16:31], v[48:51], a[80:83], v[16:31]
    v_mfma_f32_32x32x16_bf16 v[16:31], v[48:51], a[84:87], v[16:31]
    v_mfma_f32_32x32x16_bf16 v[16:31], v[48:51], a[88:91], v[16:31]
    v_mfma_f32_32x32x16_bf16 v[16:31], v[48:51], a[92:95], v[16:31]
    v_mfma_f32_32x32x16_bf16 v[16:31], v[48:51], a[96:99], v[16:31]
    v_mfma_f32_32x32x16_bf16 v[16:31], v[48:51], a[100:103], v[16:31]
    v_mfma_f32_32x32x16_bf16 v[16:31], v[48:51], a[104:107], v[16:31]
    v_mfma_f32_32x32x16_bf16 v[16:31], v[48:51], a[108:111], v[16:31]
    v_mfma_f32_32x32x16_bf16 v[16:31], v[48:51], a[112:115], v[16:31]
    v_mfma_f32_32x32x16_bf16 v[16:31], v[48:51], a[116:119], v[16:31]
    v_mfma_f32_32x32x16_bf16 v[16:31], v[48:51], a[120:123], v[16:31]
    v_mfma_f32_32x32x16_bf16 v[16:31], v[48:51], a[124:127], v[16:31]
    v_mfma_f32_32x32x16_bf16 v[16:31], v[48:51], a[128:131], v[16:31]
    v_mfma_f32_32x32x16_bf16 v[16:31], v[48:51], a[132:135], v[16:31]
    v_mfma_f32_32x32x16_bf16 v[16:31], v[48:51], a[136:139], v[16:31]
    v_mfma_f32_32x32x16_bf16 v[16:31], v[48:51], a[140:143], v[16:31]
    v_mfma_f32_32x32x16_bf16 v[32:47], v[48:51], a[144:147], 0
    v_mfma_f32_32x32x16_bf16 v[32:47], v[48:51], a[148:151], v[32:47]
    v_mfma_f32_32x32x16_bf16 v[32:47], v[48:51], a[152:155], v[32:47]
    v_mfma_f32_32x32x16_bf16 v[32:47], v[48:51], a[156:159], v[32:47]
    v_mfma_f32_32x32x16_bf16 v[32:47], v[48:51], a[160:163], v[32:47]
    v_mfma_f32_32x32x16_bf16 v[32:47], v[48:51], a[164:167], v[32:47]
    v_mfma_f32_32x32x16_bf16 v[32:47], v[48:51], a[168:171], v[32:47]
    v_mfma_f32_32x32x16_bf16 v[32:47], v[48:51], a[172:175], v[32:47]
    v_mfma_f32_32x32x16_bf16 v[32:47], v[48:51], a[176:179], v[32:47]
    v_mfma_f32_32x32x16_bf16 v[32:47], v[48:51], a[180:183], v[32:47]
    v_mfma_f32_32x32x16_bf16 v[32:47], v[48:51], a[184:187], v[32:47]
    v_mfma_f32_32x32x16_bf16 v[32:47], v[48:51], a[188:191], v[32:47]
    v_mfma_f32_32x32x16_bf16 v[32:47], v[48:51], a[192:195], v[32:47]
    v_mfma_f32_32x32x16_bf16 v[32:47], v[48:51], a[196:199], v[32:47]
    v_mfma_f32_32x32x16_bf16 v[32:47], v[48:51], a[200:203], v[32:47]
    v_mfma_f32_32x32x16_bf16 v[32:47], v[48:51], a[204:207], v[32:47]
    v_mfma_f32_32x32x16_bf16 v[32:47], v[48:51], a[208:211], v[32:47]
    v_mfma_f32_32x32x16_bf16 v[32:47], v[48:51], a[212:215], v[32:47]
    v_mfma_f32_32x32x16_bf16 v[32:47], v[48:51], a[216:219], v[32:47]
    v_mfma_f32_32x32x16_bf16 v[32:47], v[48:51], a[220:223], v[32:47]
    v_mfma_f32_32x32x16_bf16 v[32:47], v[48:51], a[224:227], v[32:47]
    v_mfma_f32_32x32x16_bf16 v[32:47], v[48:51], a[228:231], v[32:47]
    v_mfma_f32_32x32x16_bf16 v[32:47], v[48:51], a[232:235], v[32:47]
    v_mfma_f32_32x32x16_bf16 v[32:47], v[48:51], a[236:239], v[32:47]
    v_mfma_f32_32x32x16_bf16 v[32:47], v[48:51], a[240:243], v[32:47]
    v_mfma_f32_32x32x16_bf16 v[32:47], v[48:51], a[244:247], v[32:47]
    v_mfma_f32_32x32x16_bf16 v[32:47], v[48:51], a[248:251], v[32:47]
    v_mfma_f32_32x32x16_bf16 v[32:47], v[48:51], a[252:255], v[32:47]
    v_mfma_f32_32x32x16_bf16 v[32:47], v[48:51], v[224:227], v[32:47]
    v_mfma_f32_32x32x16_bf16 v[32:47], v[48:51], v[228:231], v[32:47]
    v_mfma_f32_32x32x16_bf16 v[32:47], v[48:51], v[232:235], v[32:47]
    v_mfma_f32_32x32x16_bf16 v[32:47], v[48:51], v[236:239], v[32:47]
    v_mfma_f32_32x32x16_bf16 v[32:47], v[48:51], v[240:243], v[32:47]
    v_mfma_f32_32x32x16_bf16 v[32:47], v[48:51], v[244:247], v[32:47]
    v_mfma_f32_32x32x16_bf16 v[32:47], v[48:51], v[248:251], v[32:47]
    v_mfma_f32_32x32x16_bf16 v[32:47], v[48:51], v[252:255], v[32:47]
    v_mov_b32 v11, v16
    s_nop 10
    v_mov_b32 v12, v32
    s_mov_b32 s66, 114688
    s_mov_b32 s71, 0x2000
    s_mov_b32 s36, s63
    s_mov_b32 s34, s63
    s_mov_b32 s37, 0
    s_lshl_b32 s56, s63, 6
    s_mul_i32 s58, s14, 9216
    s_mov_b32 s40, 36864
    s_mov_b32 s59, s58
    s_mov_b32 s43, 0
    s_mov_b32 s28, s8
    s_mov_b32 s29, s9
    s_mov_b32 s30, 0
    s_mov_b32 s31, 0x00020000
    s_mul_i32 s41, s63, 4718592
    s_add_u32 s41, s41, s58
    s_add_u32 s41, s41, 8650752
    s_mul_i32 s42, s56, 22528
    s_add_u32 s42, s42, 183808
    s_cmp_lg_u32 s14, 0
    s_cbranch_scc1 LpV_ini_d
    v_mov_b32 v5, 160
    s_mov_b32 s16, 0
LpV_ini:
    global_load_dword v6, v5, s[12:13] sc1
    s_add_u32 s16, s16, 1
    s_cmp_gt_u32 s16, 100000
    s_cbranch_scc1 L_role_p_abort
    s_waitcnt vmcnt(0)
    v_cmp_gt_u32 vcc, 123, v6
    s_nop 0
    s_cbranch_vccz LpV_ini_d
    s_sleep 8
    s_branch LpV_ini
LpV_ini_d:
    s_barrier
    s_branch LpV_poll
LpV_item:
    s_waitcnt vmcnt(4)
LpV_go:
    s_barrier
    s_xor_b32 s40, s40, 36864
    s_xor_b32 s59, s59, 36864
    s_xor_b32 s66, s66, 0x2000
    s_xor_b32 s71, s71, 0x2000
    s_mov_b32 s35, s37
    s_mov_b32 s57, s56
    s_add_u32 s37, s37, 1
    s_add_u32 s56, s56, 1
    s_add_u32 s41, s41, 36864
    s_add_u32 s42, s42, 22528
    s_mov_b32 s62, 0
    v_add_u32 v9, s40, v0
    v_add_u32 v5, s71, v10
    ds_read_b128 v[48:51], v9 offset:0
    ds_read_b128 v[52:55], v9 offset:1024
    ds_read_b128 v[56:59], v9 offset:2048
    s_waitcnt lgkmcnt(2)
    v_mfma_f32_32x32x16_bf16 v[16:31], v[48:51], a[0:3], 0
    ds_read_b128 v[60:63], v9 offset:3072
    ds_read_b64 v[96:97], v5 offset:0
    ds_read_b64 v[98:99], v5 offset:256
    s_waitcnt lgkmcnt(4)
    v_mfma_f32_32x32x16_bf16 v[16:31], v[52:55], a[4:7], v[16:31]
    ds_read_b128 v[64:67], v9 offset:4096
    ds_read_b64 v[100:101], v5 offset:512
    ds_read_b64 v[102:103], v5 offset:768
    s_waitcnt lgkmcnt(6)
    v_mfma_f32_32x32x16_bf16 v[16:31], v[56:59], a[8:11], v[16:31]
    ds_read_b128 v[68:71], v9 offset:5120
    ds_read_b64 v[104:105], v5 offset:1024
    ds_read_b64 v[106:107], v5 offset:1280
    s_waitcnt lgkmcnt(8)
    v_mfma_f32_32x32x16_bf16 v[16:31], v[60:63], a[12:15], v[16:31]
    ds_read_b128 v[72:75], v9 offset:6144
    ds_read_b64 v[108:109], v5 offset:1536
    ds_read_b64 v[110:111], v5 offset:1792
    s_waitcnt lgkmcnt(8)
    v_mfma_f32_32x32x16_bf16 v[16:31], v[64:67], a[16:19], v[16:31]
    ds_read_b128 v[76:79], v9 offset:7168
    ds_read_b64 v[112:113], v5 offset:2048
    s_waitcnt lgkmcnt(7)
    v_mfma_f32_32x32x16_bf16 v[16:31], v[68:71], a[20:23], v[16:31]
    ds_read_b128 v[80:83], v9 offset:8192
    v_add_f32 v96, v96, v98
    s_waitcnt lgkmcnt(5)
    v_mfma_f32_32x32x16_bf16 v[16:31], v[72:75], a[24:27], v[16:31]
    ds_read_b128 v[84:87], v9 offset:9216
    v_add_f32 v97, v97, v99
    v_add_f32 v96, v96, v100
    s_waitcnt lgkmcnt(3)
    v_mfma_f32_32x32x16_bf16 v[16:31], v[76:79], a[28:31], v[16:31]
    ds_read_b128 v[88:91], v9 offset:10240
    v_add_f32 v97, v97, v101
    v_add_f32 v96, v96, v102
    s_waitcnt lgkmcnt(2)
    v_mfma_f32_32x32x16_bf16 v[16:31], v[80:83], a[32:35], v[16:31]
    ds_read_b128 v[92:95], v9 offset:11264
    v_add_f32 v97, v97, v103
    v_add_f32 v96, v96, v104
    v_mfma_f32_32x32x16_bf16 v[32:47], v[48:51], a[144:147], 0
    v_add_f32 v97, v97, v105
    v_add_f32 v96, v96, v106
    s_waitcnt lgkmcnt(2)
    v_mfma_f32_32x32x16_bf16 v[16:31], v[84:87], a[36:39], v[16:31]
    ds_read_b128 v[48:51], v9 offset:12288
    v_add_f32 v97, v97, v107
    v_add_f32 v96, v96, v108
    v_mfma_f32_32x32x16_bf16 v[32:47], v[52:55], a[148:151], v[32:47]
    v_add_f32 v97, v97, v109
    v_add_f32 v96, v96, v110
    s_waitcnt lgkmcnt(2)
    v_mfma_f32_32x32x16_bf16 v[16:31], v[88:91], a[40:43], v[16:31]
    ds_read_b128 v[52:55], v9 offset:13312
    v_add_f32 v97, v97, v111
    v_add_f32 v96, v96, v112
    v_mfma_f32_32x32x16_bf16 v[32:47], v[56:59], a[152:155], v[32:47]
    v_add_f32 v97, v97, v113
    v_mov_b32 v98, v96
    s_waitcnt lgkmcnt(2)
    v_mfma_f32_32x32x16_bf16 v[16:31], v[92:95], a[44:47], v[16:31]
    ds_read_b128 v[56:59], v9 offset:14336
    v_mov_b32 v99, v97
    v_permlane32_swap_b32 v96, v98
    v_mfma_f32_32x32x16_bf16 v[32:47], v[60:63], a[156:159], v[32:47]
    v_permlane32_swap_b32 v97, v99
    v_add_f32 v96, v96, v98
    s_waitcnt lgkmcnt(2)
    v_mfma_f32_32x32x16_bf16 v[16:31], v[48:51], a[48:51], v[16:31]
    ds_read_b128 v[60:63], v9 offset:15360
    v_add_f32 v97, v97, v99
    v_mul_f32 v96, 0x3ae38e39, v96
    v_mfma_f32_32x32x16_bf16 v[32:47], v[64:67], a[160:163], v[32:47]
    v_mul_f32 v97, 0x3ae38e39, v97
    v_fma_f32 v97, -v96, v96, v97
    s_waitcnt lgkmcnt(2)
    v_mfma_f32_32x32x16_bf16 v[16:31], v[52:55], a[52:55], v[16:31]
    ds_read_b128 v[64:67], v9 offset:16384
    v_max_f32 v97, 0, v97
    v_add_f32 v97, 0x3727c5ac, v97
    v_mfma_f32_32x32x16_bf16 v[32:47], v[68:71], a[164:167], v[32:47]
    v_rsq_f32 v116, v97
    s_nop 0
    v_mul_f32 v117, v96, v116
    s_waitcnt lgkmcnt(2)
    v_mfma_f32_32x32x16_bf16 v[16:31], v[56:59], a[56:59], v[16:31]
    ds_read_b128 v[68:71], v9 offset:17408
    s_waitcnt vmcnt(0)
    buffer_load_dword v2, v1, s[8:11], s42 offen sc1
    s_cmp_lg_u32 s43, 0
    s_cselect_b64 exec, 1, 0
    buffer_store_dwordx2 v[212:213], v4, s[8:11], s43 offen sc1
    s_mov_b64 exec, -1
    s_mov_b32 s43, 0
    v_mfma_f32_32x32x16_bf16 v[32:47], v[72:75], a[168:171], v[32:47]
    ds_write2_b32 v14, v116, v117 offset0:0 offset1:32
    ds_read_b128 v[116:119], v214 offset:0
    s_waitcnt lgkmcnt(4)
    v_mfma_f32_32x32x16_bf16 v[16:31], v[60:63], a[60:63], v[16:31]
    ds_read_b128 v[72:75], v9 offset:18432
    ds_read_b128 v[120:123], v214 offset:32
    ds_read_b128 v[124:127], v214 offset:64
    v_mfma_f32_32x32x16_bf16 v[32:47], v[76:79], a[172:175], v[32:47]
    ds_read_b128 v[128:131], v214 offset:96
    ds_read_b128 v[132:135], v214 offset:128
    s_waitcnt lgkmcnt(8)
    v_mfma_f32_32x32x16_bf16 v[16:31], v[64:67], a[64:67], v[16:31]
    ds_read_b128 v[76:79], v9 offset:19456
    ds_read_b128 v[136:139], v214 offset:160
    ds_read_b128 v[140:143], v214 offset:192
    v_mfma_f32_32x32x16_bf16 v[32:47], v[80:83], a[176:179], v[32:47]
    ds_read_b128 v[144:147], v214 offset:224
    s_mul_i32 s46, s34, 50331648
    s_waitcnt lgkmcnt(11)
    v_mfma_f32_32x32x16_bf16 v[16:31], v[68:71], a[68:71], v[16:31]
    ds_read_b128 v[80:83], v9 offset:20480
    s_lshl_b32 s19, s35, 18
    s_add_u32 s46, s46, s19
    v_mfma_f32_32x32x16_bf16 v[32:47], v[84:87], a[180:183], v[32:47]
    s_add_u32 s46, s46, s52
    s_waitcnt lgkmcnt(9)
    v_mfma_f32_32x32x16_bf16 v[16:31], v[72:75], a[72:75], v[16:31]
    ds_read_b128 v[84:87], v9 offset:21504
    v_mfma_f32_32x32x16_bf16 v[32:47], v[88:91], a[184:187], v[32:47]
    s_waitcnt lgkmcnt(5)
    v_mfma_f32_32x32x16_bf16 v[16:31], v[76:79], a[76:79], v[16:31]
    ds_read_b128 v[88:91], v9 offset:22528
    v_mfma_f32_32x32x16_bf16 v[32:47], v[92:95], a[188:191], v[32:47]
    s_waitcnt lgkmcnt(2)
    v_mfma_f32_32x32x16_bf16 v[16:31], v[80:83], a[80:83], v[16:31]
    ds_read_b128 v[92:95], v9 offset:23552
    v_mfma_f32_32x32x16_bf16 v[32:47], v[48:51], a[192:195], v[32:47]
    s_waitcnt lgkmcnt(2)
    v_mfma_f32_32x32x16_bf16 v[16:31], v[84:87], a[84:87], v[16:31]
    ds_read_b128 v[48:51], v9 offset:24576
    v_mfma_f32_32x32x16_bf16 v[32:47], v[52:55], a[196:199], v[32:47]
    s_waitcnt lgkmcnt(2)
    v_mfma_f32_32x32x16_bf16 v[16:31], v[88:91], a[88:91], v[16:31]
    ds_read_b128 v[52:55], v9 offset:25600
    v_mfma_f32_32x32x16_bf16 v[32:47], v[56:59], a[200:203], v[32:47]
    s_waitcnt lgkmcnt(2)
    v_mfma_f32_32x32x16_bf16 v[16:31], v[92:95], a[92:95], v[16:31]
    ds_read_b128 v[56:59], v9 offset:26624
    v_mfma_f32_32x32x16_bf16 v[32:47], v[60:63], a[204:207], v[32:47]
    s_waitcnt lgkmcnt(2)
    v_mfma_f32_32x32x16_bf16 v[16:31], v[48:51], a[96:99], v[16:31]
    ds_read_b128 v[60:63], v9 offset:27648
    v_mfma_f32_32x32x16_bf16 v[32:47], v[64:67], a[208:211], v[32:47]
    s_waitcnt lgkmcnt(2)
    v_mfma_f32_32x32x16_bf16 v[16:31], v[52:55], a[100:103], v[16:31]
    ds_read_b128 v[64:67], v9 offset:28672
    s_waitcnt vmcnt(1)
    v_cmp_eq_u32 vcc, 0, v2
    s_nop 0
    s_cmp_eq_u64 vcc, 0
    s_cselect_b32 s62, 1, 0
    s_cmp_lt_u32 s37, 64
    s_cselect_b32 s62, s62, 0
    s_cmp_lg_u32 s62, 0
    s_cselect_b32 s30, 268435456, 0
    v_mfma_f32_32x32x16_bf16 v[32:47], v[68:71], a[212:215], v[32:47]
    s_waitcnt lgkmcnt(2)
    v_mfma_f32_32x32x16_bf16 v[16:31], v[56:59], a[104:107], v[16:31]
    ds_read_b128 v[68:71], v9 offset:29696
    s_add_u32 m0, s59, 0
    s_add_u32 s47, s41, 0
    buffer_load_dwordx4 v0, s[28:31], s47 offen offset:0 lds
    v_mfma_f32_32x32x16_bf16 v[32:47], v[72:75], a[216:219], v[32:47]
    s_waitcnt lgkmcnt(2)
    v_mfma_f32_32x32x16_bf16 v[16:31], v[60:63], a[108:111], v[16:31]
    ds_read_b128 v[72:75], v9 offset:30720
    buffer_load_dwordx4 v0, s[28:31], s47 offen offset:1024 lds
    v_mfma_f32_32x32x16_bf16 v[32:47], v[76:79], a[220:223], v[32:47]
    s_waitcnt lgkmcnt(2)
    v_mfma_f32_32x32x16_bf16 v[16:31], v[64:67], a[112:115], v[16:31]
    ds_read_b128 v[76:79], v9 offset:31744
    buffer_load_dwordx4 v0, s[28:31], s47 offen offset:2048 lds
    v_mfma_f32_32x32x16_bf16 v[32:47], v[80:83], a[224:227], v[32:47]
    s_waitcnt lgkmcnt(2)
    v_mfma_f32_32x32x16_bf16 v[16:31], v[68:71], a[116:119], v[16:31]
    ds_read_b128 v[80:83], v9 offset:32768
    buffer_load_dwordx4 v0, s[28:31], s47 offen offset:3072 lds
    v_mfma_f32_32x32x16_bf16 v[32:47], v[84:87], a[228:231], v[32:47]
    s_waitcnt lgkmcnt(2)
    v_mfma_f32_32x32x16_bf16 v[16:31], v[72:75], a[120:123], v[16:31]
    ds_read_b128 v[84:87], v9 offset:33792
    s_add_u32 m0, s59, 4096
    s_add_u32 s47, s41, 4096
    buffer_load_dwordx4 v0, s[28:31], s47 offen offset:0 lds
    v_mfma_f32_32x32x16_bf16 v[32:47], v[88:91], a[232:235], v[32:47]
    s_waitcnt lgkmcnt(2)
    v_mfma_f32_32x32x16_bf16 v[16:31], v[76:79], a[124:127], v[16:31]
    ds_read_b128 v[88:91], v9 offset:34816
    buffer_load_dwordx4 v0, s[28:31], s47 offen offset:1024 lds
    v_mfma_f32_32x32x16_bf16 v[32:47], v[92:95], a[236:239], v[32:47]
    s_waitcnt lgkmcnt(2)
    v_mfma_f32_32x32x16_bf16 v[16:31], v[80:83], a[128:131], v[16:31]
    ds_read_b128 v[92:95], v9 offset:35840
    buffer_load_dwordx4 v0, s[28:31], s47 offen offset:2048 lds
    v_mfma_f32_32x32x16_bf16 v[32:47], v[48:51], a[240:243], v[32:47]
    s_waitcnt lgkmcnt(2)
    v_mfma_f32_32x32x16_bf16 v[16:31], v[84:87], a[132:135], v[16:31]
    buffer_load_dwordx4 v0, s[28:31], s47 offen offset:3072 lds
    v_mfma_f32_32x32x16_bf16 v[32:47], v[52:55], a[244:247], v[32:47]
    s_waitcnt lgkmcnt(1)
    v_mfma_f32_32x32x16_bf16 v[16:31], v[88:91], a[136:139], v[16:31]
    s_add_u32 m0, s59, 8192
    s_add_u32 s47, s41, 8192
    buffer_load_dwordx4 v0, s[28:31], s47 offen offset:0 lds
    v_mfma_f32_32x32x16_bf16 v[32:47], v[56:59], a[248:251], v[32:47]
    s_waitcnt lgkmcnt(0)
    v_mfma_f32_32x32x16_bf16 v[16:31], v[92:95], a[140:143], v[16:31]
    s_mul_i32 s48, s36, 786432
    s_mul_i32 s18, s37, 6144
    s_add_u32 s48, s48, s18
    s_add_u32 s48, s48, 16125952
    s_add_u32 m0, s66, 4096
    s_nop 0
    buffer_load_dwordx4 v0, s[28:31], s48 offen lds
    v_mfma_f32_32x32x16_bf16 v[32:47], v[60:63], a[252:255], v[32:47]
    v_mfma_f32_32x32x16_bf16 v[32:47], v[64:67], v[224:227], v[32:47]
    s_add_u32 m0, s66, s67
    s_sub_u32 s48, s48, 4096
    s_add_u32 s48, s48, s67
    buffer_load_dwordx4 v0, s[28:31], s48 offen lds
    v_mfma_f32_32x32x16_bf16 v[32:47], v[68:71], v[228:231], v[32:47]
    v_mul_f32 v180, v11, v132
    v_fma_f32 v16, v16, v116, -v180
    v_mul_f32 v181, v11, v133
    v_fma_f32 v17, v17, v117, -v181
    v_cvt_pk_bf16_f32 v196, v16, v17
    v_mfma_f32_32x32x16_bf16 v[32:47], v[72:75], v[232:235], v[32:47]
    v_mul_f32 v182, v11, v134
    v_fma_f32 v18, v18, v118, -v182
    v_mul_f32 v183, v11, v135
    v_fma_f32 v19, v19, v119, -v183
    v_cvt_pk_bf16_f32 v197, v18, v19
    v_mfma_f32_32x32x16_bf16 v[32:47], v[76:79], v[236:239], v[32:47]
    v_mul_f32 v188, v11, v140
    v_fma_f32 v24, v24, v124, -v188
    v_mul_f32 v189, v11, v141
    v_fma_f32 v25, v25, v125, -v189
    v_cvt_pk_bf16_f32 v198, v24, v25
    v_mfma_f32_32x32x16_bf16 v[32:47], v[80:83], v[240:243], v[32:47]
    v_mul_f32 v190, v11, v142
    v_fma_f32 v26, v26, v126, -v190
    v_mul_f32 v191, v11, v143
    v_fma_f32 v27, v27, v127, -v191
    v_cvt_pk_bf16_f32 v199, v26, v27
    v_mfma_f32_32x32x16_bf16 v[32:47], v[84:87], v[244:247], v[32:47]
    buffer_store_dwordx4 v[196:199], v13, s[8:11], s46 offen offset:0 sc1
    v_mul_f32 v184, v11, v136
    v_fma_f32 v20, v20, v120, -v184
    v_mul_f32 v185, v11, v137
    v_fma_f32 v21, v21, v121, -v185
    v_mfma_f32_32x32x16_bf16 v[32:47], v[88:91], v[248:251], v[32:47]
    v_cvt_pk_bf16_f32 v200, v20, v21
    v_mul_f32 v186, v11, v138
    v_fma_f32 v22, v22, v122, -v186
    v_mul_f32 v187, v11, v139
    v_fma_f32 v23, v23, v123, -v187
    v_mfma_f32_32x32x16_bf16 v[32:47], v[92:95], v[252:255], v[32:47]
    v_cvt_pk_bf16_f32 v201, v22, v23
    v_mul_f32 v192, v11, v144
    v_fma_f32 v28, v28, v128, -v192
    v_mul_f32 v193, v11, v145
    v_fma_f32 v29, v29, v129, -v193
    v_cvt_pk_bf16_f32 v202, v28, v29
    v_mul_f32 v194, v11, v146
    v_fma_f32 v30, v30, v130, -v194
    v_mul_f32 v195, v11, v147
    v_fma_f32 v31, v31, v131, -v195
    v_cvt_pk_bf16_f32 v203, v30, v31
    buffer_store_dwordx4 v[200:203], v13, s[8:11], s46 offen offset:512 sc1
    v_mul_f32 v180, v12, v132
    v_fma_f32 v32, v32, v116, -v180
    v_mul_f32 v181, v12, v133
    v_fma_f32 v33, v33, v117, -v181
    v_cvt_pk_bf16_f32 v196, v32, v33
    v_mul_f32 v182, v12, v134
    v_fma_f32 v34, v34, v118, -v182
    v_mul_f32 v183, v12, v135
    v_fma_f32 v35, v35, v119, -v183
    v_cvt_pk_bf16_f32 v197, v34, v35
    v_mul_f32 v188, v12, v140
    v_fma_f32 v40, v40, v124, -v188
    v_mul_f32 v189, v12, v141
    v_fma_f32 v41, v41, v125, -v189
    v_cvt_pk_bf16_f32 v198, v40, v41
    v_mul_f32 v190, v12, v142
    v_fma_f32 v42, v42, v126, -v190
    v_mul_f32 v191, v12, v143
    v_fma_f32 v43, v43, v127, -v191
    v_cvt_pk_bf16_f32 v199, v42, v43
    buffer_store_dwordx4 v[196:199], v13, s[8:11], s46 offen offset:2048 sc1
    v_mul_f32 v184, v12, v136
    v_fma_f32 v36, v36, v120, -v184
    v_mul_f32 v185, v12, v137
    v_fma_f32 v37, v37, v121, -v185
    v_cvt_pk_bf16_f32 v200, v36, v37
    v_mul_f32 v186, v12, v138
    v_fma_f32 v38, v38, v122, -v186
    v_mul_f32 v187, v12, v139
    v_fma_f32 v39, v39, v123, -v187
    v_cvt_pk_bf16_f32 v201, v38, v39
    v_mul_f32 v192, v12, v144
    v_fma_f32 v44, v44, v128, -v192
    v_mul_f32 v193, v12, v145
    v_fma_f32 v45, v45, v129, -v193
    v_cvt_pk_bf16_f32 v202, v44, v45
    v_mul_f32 v194, v12, v146
    v_fma_f32 v46, v46, v130, -v194
    v_mul_f32 v195, v12, v147
    v_fma_f32 v47, v47, v131, -v195
    v_cvt_pk_bf16_f32 v203, v46, v47
    buffer_store_dwordx4 v[200:203], v13, s[8:11], s46 offen offset:2560 sc1
    s_mul_i32 s43, s57, 22528
    s_add_u32 s43, s43, s49
    s_cmp_lg_u32 s62, 0
    s_cbranch_scc1 LpV_item
    buffer_load_dword v2, v1, s[8:11], s42 offen sc1
    s_waitcnt vmcnt(0)
    s_cmp_ge_u32 s37, 64
    s_cbranch_scc1 LpV_fin
    v_cmp_eq_u32 vcc, 0, v2
    s_nop 0
    s_cmp_lg_u64 vcc, 0
    s_cbranch_scc1 LpV_pub
    s_add_u32 m0, s59, 0
    s_add_u32 s47, s41, 0
    buffer_load_dwordx4 v0, s[8:11], s47 offen offset:0 lds
    buffer_load_dwordx4 v0, s[8:11], s47 offen offset:1024 lds
    buffer_load_dwordx4 v0, s[8:11], s47 offen offset:2048 lds
    buffer_load_dwordx4 v0, s[8:11], s47 offen offset:3072 lds
    s_add_u32 m0, s59, 4096
    s_add_u32 s47, s41, 4096
    buffer_load_dwordx4 v0, s[8:11], s47 offen offset:0 lds
    buffer_load_dwordx4 v0, s[8:11], s47 offen offset:1024 lds
    buffer_load_dwordx4 v0, s[8:11], s47 offen offset:2048 lds
    buffer_load_dwordx4 v0, s[8:11], s47 offen offset:3072 lds
    s_add_u32 m0, s59, 8192
    s_add_u32 s47, s41, 8192
    buffer_load_dwordx4 v0, s[8:11], s47 offen offset:0 lds
    s_mul_i32 s48, s36, 786432
    s_mul_i32 s18, s37, 6144
    s_add_u32 s48, s48, s18
    s_add_u32 s48, s48, 16125952
    s_add_u32 m0, s66, 4096
    s_nop 0
    buffer_load_dwordx4 v0, s[8:11], s48 offen lds
    s_add_u32 m0, s66, s67
    s_sub_u32 s48, s48, 4096
    s_add_u32 s48, s48, s67
    buffer_load_dwordx4 v0, s[8:11], s48 offen lds
    s_cmp_lg_u32 s43, 0
    s_cselect_b64 exec, 1, 0
    buffer_store_dwordx2 v[212:213], v4, s[8:11], s43 offen sc1
    s_mov_b64 exec, -1
    s_mov_b32 s43, 0
    s_waitcnt vmcnt(1)
    s_branch LpV_go
LpV_fin:
    s_cmp_lg_u32 s43, 0
    s_cselect_b64 exec, 1, 0
    buffer_store_dwordx2 v[212:213], v4, s[8:11], s43 offen sc1
    s_mov_b64 exec, -1
    s_mov_b32 s43, 0
    s_branch L_role_p_exit
LpV_pub:
    s_cmp_lg_u32 s43, 0
    s_cselect_b64 exec, 1, 0
    buffer_store_dwordx2 v[212:213], v4, s[8:11], s43 offen sc1
    s_mov_b64 exec, -1
    s_mov_b32 s43, 0
LpV_poll:
    s_mov_b32 s16, 0
LpV_pl:
    buffer_load_dword v2, v1, s[8:11], s42 offen sc1
    s_add_u32 s16, s16, 1
    s_cmp_gt_u32 s16, 100000
    s_cbranch_scc1 L_role_p_abort
    s_waitcnt vmcnt(0)
    v_cmp_eq_u32 vcc, 0, v2
    s_nop 0
    s_cmp_eq_u64 vcc, 0
    s_cbranch_scc1 LpV_pld
    s_sleep 4
    s_branch LpV_pl
LpV_pld:
    s_add_u32 m0, s59, 0
    s_add_u32 s47, s41, 0
    buffer_load_dwordx4 v0, s[8:11], s47 offen offset:0 lds
    buffer_load_dwordx4 v0, s[8:11], s47 offen offset:1024 lds
    buffer_load_dwordx4 v0, s[8:11], s47 offen offset:2048 lds
    buffer_load_dwordx4 v0, s[8:11], s47 offen offset:3072 lds
    s_add_u32 m0, s59, 4096
    s_add_u32 s47, s41, 4096
    buffer_load_dwordx4 v0, s[8:11], s47 offen offset:0 lds
    buffer_load_dwordx4 v0, s[8:11], s47 offen offset:1024 lds
    buffer_load_dwordx4 v0, s[8:11], s47 offen offset:2048 lds
    buffer_load_dwordx4 v0, s[8:11], s47 offen offset:3072 lds
    s_add_u32 m0, s59, 8192
    s_add_u32 s47, s41, 8192
    buffer_load_dwordx4 v0, s[8:11], s47 offen offset:0 lds
    s_mul_i32 s48, s36, 786432
    s_mul_i32 s18, s37, 6144
    s_add_u32 s48, s48, s18
    s_add_u32 s48, s48, 16125952
    s_add_u32 m0, s66, 4096
    s_nop 0
    buffer_load_dwordx4 v0, s[8:11], s48 offen lds
    s_add_u32 m0, s66, s67
    s_sub_u32 s48, s48, 4096
    s_add_u32 s48, s48, s67
    buffer_load_dwordx4 v0, s[8:11], s48 offen lds
    s_waitcnt vmcnt(0)
    s_branch LpV_go
L_role_p_abort:
    s_waitcnt lgkmcnt(0)
    s_mov_b64 exec, -1
    v_mov_b32 v0, 60
    s_lshl_b32 s5, s3, 8
    s_or_b32 s5, s5, s4
    s_or_b32 s5, s5, 0x10000
    v_mov_b32 v1, s5
    global_store_dword v0, v1, s[12:13]
    s_endpgm
L_role_p_exit:
    s_cmp_lg_u32 s63, 0
    s_cbranch_scc1 L_p_end
    s_cmp_ge_u32 s15, 24
    s_cbranch_scc1 L_p_end
    s_add_u32 s15, s15, 36
    v_lshrrev_b32 v0, 4, v0
    s_waitcnt vmcnt(0) lgkmcnt(0)
    s_barrier
    s_branch L_role_tw
L_p_end:
    s_endpgm
.p2align 6
L_role_tw:
    v_and_b32 v5, 63, v0
    v_lshlrev_b32 v0, 4, v5
    v_and_b32 v7, 15, v5
    v_lshrrev_b32 v8, 4, v5
    v_min_u32 v1, 31, v5
    v_lshrrev_b32 v6, 2, v1
    v_and_b32 v1, 3, v1
    v_lshlrev_b32 v1, 2, v1
    v_lshl_add_u32 v1, v6, 7, v1
    v_mov_b32 v3, 1
    v_mov_b32 v4, 0
    s_mov_b32 s44, 0x05040100
    s_mov_b32 s45, 0x07060302
    s_cmp_lt_u32 s15, 24
    s_cbranch_scc1 Ltw_noord
    s_cmp_lg_u32 s14, 0
    s_cbranch_scc1 Ltw_ord_d
    v_mov_b32 v5, 48
    s_mov_b32 s16, 0
Ltw_ord:
    global_load_dword v6, v5, s[12:13] sc1
    s_add_u32 s16, s16, 1
    s_cmp_gt_u32 s16, 100000
    s_cbranch_scc1 L_role_tw_abort
    s_waitcnt vmcnt(0)
    v_cmp_gt_u32 vcc, 1, v6
    s_nop 0
    s_cbranch_vccz Ltw_ord_d
    s_sleep 64
    s_branch Ltw_ord
Ltw_ord_d:
    s_barrier
Ltw_noord:
    s_load_dwordx2 s[20:21], s[0:1], 64
    s_mov_b32 s22, 4718592
    s_mov_b32 s23, 0x00020000
    s_waitcnt lgkmcnt(0)
    s_and_b32 s21, s21, 0xffff
    s_load_dwordx2 s[24:25], s[0:1], 80
    s_mov_b32 s26, 2359296
    s_mov_b32 s27, 0x00020000
    s_waitcnt lgkmcnt(0)
    s_and_b32 s25, s25, 0xffff
    s_mul_i32 s17, s15, 43
    s_lshr_b32 s32, s17, 9
    s_mul_i32 s17, s32, 12
    s_sub_u32 s50, s15, s17
    s_add_u32 s33, s32, 31
    s_cmp_eq_u32 s32, 2
    s_cselect_b32 s33, 0, s33
    s_cmp_lt_u32 s32, 2
    s_cselect_b32 s33, 64, s33
    s_cselect_b32 s32, s32, 64
    s_mul_i32 s49, s50, 96
    s_mul_i32 s17, s14, 1179648
    s_add_u32 s49, s49, s17
    v_mul_u32_u24 v5, 4608, v8
    v_lshl_add_u32 v9, v7, 2, v5
    v_add_u32 v10, 18432, v9
    v_and_b32 v6, 14, v7
    v_lshl_add_u32 v12, v6, 1, v5
    v_add_u32 v12, 64, v12
    v_add_u32 v13, 18432, v12
    v_and_b32 v5, 1, v7
    v_mov_b32 v11, s44
    v_mov_b32 v6, s45
    v_cmp_eq_u32 vcc, 1, v5
    s_nop 1
    v_cndmask_b32 v11, v11, v6, vcc
    s_add_u32 s17, s49, 0
    buffer_load_dword v16, v9, s[20:23], s17 offen
    buffer_load_dword v17, v10, s[20:23], s17 offen
    buffer_load_dword v18, v12, s[20:23], s17 offen
    buffer_load_dword v19, v13, s[20:23], s17 offen
    s_add_u32 s17, s49, 1152
    buffer_load_dword v20, v9, s[20:23], s17 offen
    buffer_load_dword v21, v10, s[20:23], s17 offen
    buffer_load_dword v22, v12, s[20:23], s17 offen
    buffer_load_dword v23, v13, s[20:23], s17 offen
    s_add_u32 s17, s49, 2304
    buffer_load_dword v24, v9, s[20:23], s17 offen
    buffer_load_dword v25, v10, s[20:23], s17 offen
    buffer_load_dword v26, v12, s[20:23], s17 offen
    buffer_load_dword v27, v13, s[20:23], s17 offen
    s_add_u32 s17, s49, 3456
    buffer_load_dword v28, v9, s[20:23], s17 offen
    buffer_load_dword v29, v10, s[20:23], s17 offen
    buffer_load_dword v30, v12, s[20:23], s17 offen
    buffer_load_dword v31, v13, s[20:23], s17 offen
    s_add_u32 s17, s49, 36864
    buffer_load_dword v32, v9, s[20:23], s17 offen
    buffer_load_dword v33, v10, s[20:23], s17 offen
    buffer_load_dword v34, v12, s[20:23], s17 offen
    buffer_load_dword v35, v13, s[20:23], s17 offen
    s_add_u32 s17, s49, 38016
    buffer_load_dword v36, v9, s[20:23], s17 offen
    buffer_load_dword v37, v10, s[20:23], s17 offen
    buffer_load_dword v38, v12, s[20:23], s17 offen
    buffer_load_dword v39, v13, s[20:23], s17 offen
    s_add_u32 s17, s49, 39168
    buffer_load_dword v40, v9, s[20:23], s17 offen
    buffer_load_dword v41, v10, s[20:23], s17 offen
    buffer_load_dword v42, v12, s[20:23], s17 offen
    buffer_load_dword v43, v13, s[20:23], s17 offen
    s_add_u32 s17, s49, 40320
    buffer_load_dword v44, v9, s[20:23], s17 offen
    buffer_load_dword v45, v10, s[20:23], s17 offen
    buffer_load_dword v46, v12, s[20:23], s17 offen
    buffer_load_dword v47, v13, s[20:23], s17 offen
    s_add_u32 s17, s49, 73728
    buffer_load_dword v48, v9, s[20:23], s17 offen
    buffer_load_dword v49, v10, s[20:23], s17 offen
    buffer_load_dword v50, v12, s[20:23], s17 offen
    buffer_load_dword v51, v13, s[20:23], s17 offen
    s_add_u32 s17, s49, 74880
    buffer_load_dword v52, v9, s[20:23], s17 offen
    buffer_load_dword v53, v10, s[20:23], s17 offen
    buffer_load_dword v54, v12, s[20:23], s17 offen
    buffer_load_dword v55, v13, s[20:23], s17 offen
    s_add_u32 s17, s49, 76032
    buffer_load_dword v56, v9, s[20:23], s17 offen
    buffer_load_dword v57, v10, s[20:23], s17 offen
    buffer_load_dword v58, v12, s[20:23], s17 offen
    buffer_load_dword v59, v13, s[20:23], s17 offen
    s_add_u32 s17, s49, 77184
    buffer_load_dword v60, v9, s[20:23], s17 offen
    buffer_load_dword v61, v10, s[20:23], s17 offen
    buffer_load_dword v62, v12, s[20:23], s17 offen
    buffer_load_dword v63, v13, s[20:23], s17 offen
    s_add_u32 s17, s49, 110592
    buffer_load_dword v64, v9, s[20:23], s17 offen
    buffer_load_dword v65, v10, s[20:23], s17 offen
    buffer_load_dword v66, v12, s[20:23], s17 offen
    buffer_load_dword v67, v13, s[20:23], s17 offen
    s_add_u32 s17, s49, 111744
    buffer_load_dword v68, v9, s[20:23], s17 offen
    buffer_load_dword v69, v10, s[20:23], s17 offen
    buffer_load_dword v70, v12, s[20:23], s17 offen
    buffer_load_dword v71, v13, s[20:23], s17 offen
    s_add_u32 s17, s49, 112896
    buffer_load_dword v72, v9, s[20:23], s17 offen
    buffer_load_dword v73, v10, s[20:23], s17 offen
    buffer_load_dword v74, v12, s[20:23], s17 offen
    buffer_load_dword v75, v13, s[20:23], s17 offen
    s_waitcnt vmcnt(58)
    v_perm_b32 v5, v17, v16, s44
    v_perm_b32 v6, v17, v16, s45
    s_waitcnt vmcnt(56)
    v_perm_b32 v128, v19, v18, v11
    v_accvgpr_write_b32 a0, v5
    v_accvgpr_write_b32 a4, v6
    s_add_u32 s17, s49, 114048
    buffer_load_dword v76, v9, s[20:23], s17 offen
    buffer_load_dword v77, v10, s[20:23], s17 offen
    buffer_load_dword v78, v12, s[20:23], s17 offen
    buffer_load_dword v79, v13, s[20:23], s17 offen
    s_waitcnt vmcnt(58)
    v_perm_b32 v5, v21, v20, s44
    v_perm_b32 v6, v21, v20, s45
    s_waitcnt vmcnt(56)
    v_perm_b32 v129, v23, v22, v11
    v_accvgpr_write_b32 a1, v5
    v_accvgpr_write_b32 a5, v6
    s_add_u32 s17, s49, 147456
    buffer_load_dword v80, v9, s[20:23], s17 offen
    buffer_load_dword v81, v10, s[20:23], s17 offen
    buffer_load_dword v82, v12, s[20:23], s17 offen
    buffer_load_dword v83, v13, s[20:23], s17 offen
    s_waitcnt vmcnt(58)
    v_perm_b32 v5, v25, v24, s44
    v_perm_b32 v6, v25, v24, s45
    s_waitcnt vmcnt(56)
    v_perm_b32 v130, v27, v26, v11
    v_accvgpr_write_b32 a2, v5
    v_accvgpr_write_b32 a6, v6
    s_add_u32 s17, s49, 148608
    buffer_load_dword v84, v9, s[20:23], s17 offen
    buffer_load_dword v85, v10, s[20:23], s17 offen
    buffer_load_dword v86, v12, s[20:23], s17 offen
    buffer_load_dword v87, v13, s[20:23], s17 offen
    s_waitcnt vmcnt(58)
    v_perm_b32 v5, v29, v28, s44
    v_perm_b32 v6, v29, v28, s45
    s_waitcnt vmcnt(56)
    v_perm_b32 v131, v31, v30, v11
    v_accvgpr_write_b32 a3, v5
    v_accvgpr_write_b32 a7, v6
    s_add_u32 s17, s49, 149760
    buffer_load_dword v88, v9, s[20:23], s17 offen
    buffer_load_dword v89, v10, s[20:23], s17 offen
    buffer_load_dword v90, v12, s[20:23], s17 offen
    buffer_load_dword v91, v13, s[20:23], s17 offen
    s_waitcnt vmcnt(58)
    v_perm_b32 v5, v33, v32, s44
    v_perm_b32 v6, v33, v32, s45
    s_waitcnt vmcnt(56)
    v_perm_b32 v132, v35, v34, v11
    v_accvgpr_write_b32 a8, v5
    v_accvgpr_write_b32 a12, v6
    s_add_u32 s17, s49, 150912
    buffer_load_dword v92, v9, s[20:23], s17 offen
    buffer_load_dword v93, v10, s[20:23], s17 offen
    buffer_load_dword v94, v12, s[20:23], s17 offen
    buffer_load_dword v95, v13, s[20:23], s17 offen
    s_waitcnt vmcnt(58)
    v_perm_b32 v5, v37, v36, s44
    v_perm_b32 v6, v37, v36, s45
    s_waitcnt vmcnt(56)
    v_perm_b32 v133, v39, v38, v11
    v_accvgpr_write_b32 a9, v5
    v_accvgpr_write_b32 a13, v6
    s_add_u32 s17, s49, 184320
    buffer_load_dword v96, v9, s[20:23], s17 offen
    buffer_load_dword v97, v10, s[20:23], s17 offen
    buffer_load_dword v98, v12, s[20:23], s17 offen
    buffer_load_dword v99, v13, s[20:23], s17 offen
    s_waitcnt vmcnt(58)
    v_perm_b32 v5, v41, v40, s44
    v_perm_b32 v6, v41, v40, s45
    s_waitcnt vmcnt(56)
    v_perm_b32 v134, v43, v42, v11
    v_accvgpr_write_b32 a10, v5
    v_accvgpr_write_b32 a14, v6
    s_add_u32 s17, s49, 185472
    buffer_load_dword v100, v9, s[20:23], s17 offen
    buffer_load_dword v101, v10, s[20:23], s17 offen
    buffer_load_dword v102, v12, s[20:23], s17 offen
    buffer_load_dword v103, v13, s[20:23], s17 offen
    s_waitcnt vmcnt(58)
    v_perm_b32 v5, v45, v44, s44
    v_perm_b32 v6, v45, v44, s45
    s_waitcnt vmcnt(56)
    v_perm_b32 v135, v47, v46, v11
    v_accvgpr_write_b32 a11, v5
    v_accvgpr_write_b32 a15, v6
    s_add_u32 s17, s49, 186624
    buffer_load_dword v104, v9, s[20:23], s17 offen
    buffer_load_dword v105, v10, s[20:23], s17 offen
    buffer_load_dword v106, v12, s[20:23], s17 offen
    buffer_load_dword v107, v13, s[20:23], s17 offen
    s_waitcnt vmcnt(58)
    v_perm_b32 v5, v49, v48, s44
    v_perm_b32 v6, v49, v48, s45
    s_waitcnt vmcnt(56)
    v_perm_b32 v136, v51, v50, v11
    v_accvgpr_write_b32 a16, v5
    v_accvgpr_write_b32 a20, v6
    s_add_u32 s17, s49, 187776
    buffer_load_dword v108, v9, s[20:23], s17 offen
    buffer_load_dword v109, v10, s[20:23], s17 offen
    buffer_load_dword v110, v12, s[20:23], s17 offen
    buffer_load_dword v111, v13, s[20:23], s17 offen
    s_waitcnt vmcnt(58)
    v_perm_b32 v5, v53, v52, s44
    v_perm_b32 v6, v53, v52, s45
    s_waitcnt vmcnt(56)
    v_perm_b32 v137, v55, v54, v11
    v_accvgpr_write_b32 a17, v5
    v_accvgpr_write_b32 a21, v6
    s_add_u32 s17, s49, 221184
    buffer_load_dword v112, v9, s[20:23], s17 offen
    buffer_load_dword v113, v10, s[20:23], s17 offen
    buffer_load_dword v114, v12, s[20:23], s17 offen
    buffer_load_dword v115, v13, s[20:23], s17 offen
    s_waitcnt vmcnt(58)
    v_perm_b32 v5, v57, v56, s44
    v_perm_b32 v6, v57, v56, s45
    s_waitcnt vmcnt(56)
    v_perm_b32 v138, v59, v58, v11
    v_accvgpr_write_b32 a18, v5
    v_accvgpr_write_b32 a22, v6
    s_add_u32 s17, s49, 222336
    buffer_load_dword v116, v9, s[20:23], s17 offen
    buffer_load_dword v117, v10, s[20:23], s17 offen
    buffer_load_dword v118, v12, s[20:23], s17 offen
    buffer_load_dword v119, v13, s[20:23], s17 offen
    s_waitcnt vmcnt(58)
    v_perm_b32 v5, v61, v60, s44
    v_perm_b32 v6, v61, v60, s45
    s_waitcnt vmcnt(56)
    v_perm_b32 v139, v63, v62, v11
    v_accvgpr_write_b32 a19, v5
    v_accvgpr_write_b32 a23, v6
    s_add_u32 s17, s49, 223488
    buffer_load_dword v120, v9, s[20:23], s17 offen
    buffer_load_dword v121, v10, s[20:23], s17 offen
    buffer_load_dword v122, v12, s[20:23], s17 offen
    buffer_load_dword v123, v13, s[20:23], s17 offen
    s_waitcnt vmcnt(58)
    v_perm_b32 v5, v65, v64, s44
    v_perm_b32 v6, v65, v64, s45
    s_waitcnt vmcnt(56)
    v_perm_b32 v140, v67, v66, v11
    v_accvgpr_write_b32 a24, v5
    v_accvgpr_write_b32 a28, v6
    s_add_u32 s17, s49, 224640
    buffer_load_dword v124, v9, s[20:23], s17 offen
    buffer_load_dword v125, v10, s[20:23], s17 offen
    buffer_load_dword v126, v12, s[20:23], s17 offen
    buffer_load_dword v127, v13, s[20:23], s17 offen
    s_waitcnt vmcnt(58)
    v_perm_b32 v5, v69, v68, s44
    v_perm_b32 v6, v69, v68, s45
    s_waitcnt vmcnt(56)
    v_perm_b32 v141, v71, v70, v11
    v_accvgpr_write_b32 a25, v5
    v_accvgpr_write_b32 a29, v6
    s_add_u32 s17, s49, 258048
    buffer_load_dword v16, v9, s[20:23], s17 offen
    buffer_load_dword v17, v10, s[20:23], s17 offen
    buffer_load_dword v18, v12, s[20:23], s17 offen
    buffer_load_dword v19, v13, s[20:23], s17 offen
    s_waitcnt vmcnt(58)
    v_perm_b32 v5, v73, v72, s44
    v_perm_b32 v6, v73, v72, s45
    s_waitcnt vmcnt(56)
    v_perm_b32 v142, v75, v74, v11
    v_accvgpr_write_b32 a26, v5
    v_accvgpr_write_b32 a30, v6
    s_add_u32 s17, s49, 259200
    buffer_load_dword v20, v9, s[20:23], s17 offen
    buffer_load_dword v21, v10, s[20:23], s17 offen
    buffer_load_dword v22, v12, s[20:23], s17 offen
    buffer_load_dword v23, v13, s[20:23], s17 offen
    s_waitcnt vmcnt(58)
    v_perm_b32 v5, v77, v76, s44
    v_perm_b32 v6, v77, v76, s45
    s_waitcnt vmcnt(56)
    v_perm_b32 v143, v79, v78, v11
    v_accvgpr_write_b32 a27, v5
    v_accvgpr_write_b32 a31, v6
    s_add_u32 s17, s49, 260352
    buffer_load_dword v24, v9, s[20:23], s17 offen
    buffer_load_dword v25, v10, s[20:23], s17 offen
    buffer_load_dword v26, v12, s[20:23], s17 offen
    buffer_load_dword v27, v13, s[20:23], s17 offen
    s_waitcnt vmcnt(58)
    v_perm_b32 v5, v81, v80, s44
    v_perm_b32 v6, v81, v80, s45
    s_waitcnt vmcnt(56)
    v_perm_b32 v144, v83, v82, v11
    v_accvgpr_write_b32 a32, v5
    v_accvgpr_write_b32 a36, v6
    s_add_u32 s17, s49, 261504
    buffer_load_dword v28, v9, s[20:23], s17 offen
    buffer_load_dword v29, v10, s[20:23], s17 offen
    buffer_load_dword v30, v12, s[20:23], s17 offen
    buffer_load_dword v31, v13, s[20:23], s17 offen
    s_waitcnt vmcnt(58)
    v_perm_b32 v5, v85, v84, s44
    v_perm_b32 v6, v85, v84, s45
    s_waitcnt vmcnt(56)
    v_perm_b32 v145, v87, v86, v11
    v_accvgpr_write_b32 a33, v5
    v_accvgpr_write_b32 a37, v6
    s_add_u32 s17, s49, 294912
    buffer_load_dword v32, v9, s[20:23], s17 offen
    buffer_load_dword v33, v10, s[20:23], s17 offen
    buffer_load_dword v34, v12, s[20:23], s17 offen
    buffer_load_dword v35, v13, s[20:23], s17 offen
    s_waitcnt vmcnt(58)
    v_perm_b32 v5, v89, v88, s44
    v_perm_b32 v6, v89, v88, s45
    s_waitcnt vmcnt(56)
    v_perm_b32 v146, v91, v90, v11
    v_accvgpr_write_b32 a34, v5
    v_accvgpr_write_b32 a38, v6
    s_add_u32 s17, s49, 296064
    buffer_load_dword v36, v9, s[20:23], s17 offen
    buffer_load_dword v37, v10, s[20:23], s17 offen
    buffer_load_dword v38, v12, s[20:23], s17 offen
    buffer_load_dword v39, v13, s[20:23], s17 offen
    s_waitcnt vmcnt(58)
    v_perm_b32 v5, v93, v92, s44
    v_perm_b32 v6, v93, v92, s45
    s_waitcnt vmcnt(56)
    v_perm_b32 v147, v95, v94, v11
    v_accvgpr_write_b32 a35, v5
    v_accvgpr_write_b32 a39, v6
    s_add_u32 s17, s49, 297216
    buffer_load_dword v40, v9, s[20:23], s17 offen
    buffer_load_dword v41, v10, s[20:23], s17 offen
    buffer_load_dword v42, v12, s[20:23], s17 offen
    buffer_load_dword v43, v13, s[20:23], s17 offen
    s_waitcnt vmcnt(58)
    v_perm_b32 v5, v97, v96, s44
    v_perm_b32 v6, v97, v96, s45
    s_waitcnt vmcnt(56)
    v_perm_b32 v148, v99, v98, v11
    v_accvgpr_write_b32 a40, v5
    v_accvgpr_write_b32 a44, v6
    s_add_u32 s17, s49, 298368
    buffer_load_dword v44, v9, s[20:23], s17 offen
    buffer_load_dword v45, v10, s[20:23], s17 offen
    buffer_load_dword v46, v12, s[20:23], s17 offen
    buffer_load_dword v47, v13, s[20:23], s17 offen
    s_waitcnt vmcnt(58)
    v_perm_b32 v5, v101, v100, s44
    v_perm_b32 v6, v101, v100, s45
    s_waitcnt vmcnt(56)
    v_perm_b32 v149, v103, v102, v11
    v_accvgpr_write_b32 a41, v5
    v_accvgpr_write_b32 a45, v6
    s_add_u32 s17, s49, 331776
    buffer_load_dword v48, v9, s[20:23], s17 offen
    buffer_load_dword v49, v10, s[20:23], s17 offen
    buffer_load_dword v50, v12, s[20:23], s17 offen
    buffer_load_dword v51, v13, s[20:23], s17 offen
    s_waitcnt vmcnt(58)
    v_perm_b32 v5, v105, v104, s44
    v_perm_b32 v6, v105, v104, s45
    s_waitcnt vmcnt(56)
    v_perm_b32 v150, v107, v106, v11
    v_accvgpr_write_b32 a42, v5
    v_accvgpr_write_b32 a46, v6
    s_add_u32 s17, s49, 332928
    buffer_load_dword v52, v9, s[20:23], s17 offen
    buffer_load_dword v53, v10, s[20:23], s17 offen
    buffer_load_dword v54, v12, s[20:23], s17 offen
    buffer_load_dword v55, v13, s[20:23], s17 offen
    s_waitcnt vmcnt(58)
    v_perm_b32 v5, v109, v108, s44
    v_perm_b32 v6, v109, v108, s45
    s_waitcnt vmcnt(56)
    v_perm_b32 v151, v111, v110, v11
    v_accvgpr_write_b32 a43, v5
    v_accvgpr_write_b32 a47, v6
    s_add_u32 s17, s49, 334080
    buffer_load_dword v56, v9, s[20:23], s17 offen
    buffer_load_dword v57, v10, s[20:23], s17 offen
    buffer_load_dword v58, v12, s[20:23], s17 offen
    buffer_load_dword v59, v13, s[20:23], s17 offen
    s_waitcnt vmcnt(58)
    v_perm_b32 v5, v113, v112, s44
    v_perm_b32 v6, v113, v112, s45
    s_waitcnt vmcnt(56)
    v_perm_b32 v152, v115, v114, v11
    v_accvgpr_write_b32 a48, v5
    v_accvgpr_write_b32 a52, v6
    s_add_u32 s17, s49, 335232
    buffer_load_dword v60, v9, s[20:23], s17 offen
    buffer_load_dword v61, v10, s[20:23], s17 offen
    buffer_load_dword v62, v12, s[20:23], s17 offen
    buffer_load_dword v63, v13, s[20:23], s17 offen
    s_waitcnt vmcnt(58)
    v_perm_b32 v5, v117, v116, s44
    v_perm_b32 v6, v117, v116, s45
    s_waitcnt vmcnt(56)
    v_perm_b32 v153, v119, v118, v11
    v_accvgpr_write_b32 a49, v5
    v_accvgpr_write_b32 a53, v6
    s_add_u32 s17, s49, 368640
    buffer_load_dword v64, v9, s[20:23], s17 offen
    buffer_load_dword v65, v10, s[20:23], s17 offen
    buffer_load_dword v66, v12, s[20:23], s17 offen
    buffer_load_dword v67, v13, s[20:23], s17 offen
    s_waitcnt vmcnt(58)
    v_perm_b32 v5, v121, v120, s44
    v_perm_b32 v6, v121, v120, s45
    s_waitcnt vmcnt(56)
    v_perm_b32 v154, v123, v122, v11
    v_accvgpr_write_b32 a50, v5
    v_accvgpr_write_b32 a54, v6
    s_add_u32 s17, s49, 369792
    buffer_load_dword v68, v9, s[20:23], s17 offen
    buffer_load_dword v69, v10, s[20:23], s17 offen
    buffer_load_dword v70, v12, s[20:23], s17 offen
    buffer_load_dword v71, v13, s[20:23], s17 offen
    s_waitcnt vmcnt(58)
    v_perm_b32 v5, v125, v124, s44
    v_perm_b32 v6, v125, v124, s45
    s_waitcnt vmcnt(56)
    v_perm_b32 v155, v127, v126, v11
    v_accvgpr_write_b32 a51, v5
    v_accvgpr_write_b32 a55, v6
    s_add_u32 s17, s49, 370944
    buffer_load_dword v72, v9, s[20:23], s17 offen
    buffer_load_dword v73, v10, s[20:23], s17 offen
    buffer_load_dword v74, v12, s[20:23], s17 offen
    buffer_load_dword v75, v13, s[20:23], s17 offen
    s_waitcnt vmcnt(58)
    v_perm_b32 v5, v17, v16, s44
    v_perm_b32 v6, v17, v16, s45
    s_waitcnt vmcnt(56)
    v_perm_b32 v156, v19, v18, v11
    v_accvgpr_write_b32 a56, v5
    v_accvgpr_write_b32 a60, v6
    s_add_u32 s17, s49, 372096
    buffer_load_dword v76, v9, s[20:23], s17 offen
    buffer_load_dword v77, v10, s[20:23], s17 offen
    buffer_load_dword v78, v12, s[20:23], s17 offen
    buffer_load_dword v79, v13, s[20:23], s17 offen
    s_waitcnt vmcnt(58)
    v_perm_b32 v5, v21, v20, s44
    v_perm_b32 v6, v21, v20, s45
    s_waitcnt vmcnt(56)
    v_perm_b32 v157, v23, v22, v11
    v_accvgpr_write_b32 a57, v5
    v_accvgpr_write_b32 a61, v6
    s_add_u32 s17, s49, 405504
    buffer_load_dword v80, v9, s[20:23], s17 offen
    buffer_load_dword v81, v10, s[20:23], s17 offen
    buffer_load_dword v82, v12, s[20:23], s17 offen
    buffer_load_dword v83, v13, s[20:23], s17 offen
    s_waitcnt vmcnt(58)
    v_perm_b32 v5, v25, v24, s44
    v_perm_b32 v6, v25, v24, s45
    s_waitcnt vmcnt(56)
    v_perm_b32 v158, v27, v26, v11
    v_accvgpr_write_b32 a58, v5
    v_accvgpr_write_b32 a62, v6
    s_add_u32 s17, s49, 406656
    buffer_load_dword v84, v9, s[20:23], s17 offen
    buffer_load_dword v85, v10, s[20:23], s17 offen
    buffer_load_dword v86, v12, s[20:23], s17 offen
    buffer_load_dword v87, v13, s[20:23], s17 offen
    s_waitcnt vmcnt(58)
    v_perm_b32 v5, v29, v28, s44
    v_perm_b32 v6, v29, v28, s45
    s_waitcnt vmcnt(56)
    v_perm_b32 v159, v31, v30, v11
    v_accvgpr_write_b32 a59, v5
    v_accvgpr_write_b32 a63, v6
    s_add_u32 s17, s49, 407808
    buffer_load_dword v88, v9, s[20:23], s17 offen
    buffer_load_dword v89, v10, s[20:23], s17 offen
    buffer_load_dword v90, v12, s[20:23], s17 offen
    buffer_load_dword v91, v13, s[20:23], s17 offen
    s_waitcnt vmcnt(58)
    v_perm_b32 v5, v33, v32, s44
    v_perm_b32 v6, v33, v32, s45
    s_waitcnt vmcnt(56)
    v_perm_b32 v160, v35, v34, v11
    v_accvgpr_write_b32 a64, v5
    v_accvgpr_write_b32 a68, v6
    s_add_u32 s17, s49, 408960
    buffer_load_dword v92, v9, s[20:23], s17 offen
    buffer_load_dword v93, v10, s[20:23], s17 offen
    buffer_load_dword v94, v12, s[20:23], s17 offen
    buffer_load_dword v95, v13, s[20:23], s17 offen
    s_waitcnt vmcnt(58)
    v_perm_b32 v5, v37, v36, s44
    v_perm_b32 v6, v37, v36, s45
    s_waitcnt vmcnt(56)
    v_perm_b32 v161, v39, v38, v11
    v_accvgpr_write_b32 a65, v5
    v_accvgpr_write_b32 a69, v6
    s_add_u32 s17, s49, 442368
    buffer_load_dword v96, v9, s[20:23], s17 offen
    buffer_load_dword v97, v10, s[20:23], s17 offen
    buffer_load_dword v98, v12, s[20:23], s17 offen
    buffer_load_dword v99, v13, s[20:23], s17 offen
    s_waitcnt vmcnt(58)
    v_perm_b32 v5, v41, v40, s44
    v_perm_b32 v6, v41, v40, s45
    s_waitcnt vmcnt(56)
    v_perm_b32 v162, v43, v42, v11
    v_accvgpr_write_b32 a66, v5
    v_accvgpr_write_b32 a70, v6
    s_add_u32 s17, s49, 443520
    buffer_load_dword v100, v9, s[20:23], s17 offen
    buffer_load_dword v101, v10, s[20:23], s17 offen
    buffer_load_dword v102, v12, s[20:23], s17 offen
    buffer_load_dword v103, v13, s[20:23], s17 offen
    s_waitcnt vmcnt(58)
    v_perm_b32 v5, v45, v44, s44
    v_perm_b32 v6, v45, v44, s45
    s_waitcnt vmcnt(56)
    v_perm_b32 v163, v47, v46, v11
    v_accvgpr_write_b32 a67, v5
    v_accvgpr_write_b32 a71, v6
    s_add_u32 s17, s49, 444672
    buffer_load_dword v104, v9, s[20:23], s17 offen
    buffer_load_dword v105, v10, s[20:23], s17 offen
    buffer_load_dword v106, v12, s[20:23], s17 offen
    buffer_load_dword v107, v13, s[20:23], s17 offen
    s_waitcnt vmcnt(58)
    v_perm_b32 v5, v49, v48, s44
    v_perm_b32 v6, v49, v48, s45
    s_waitcnt vmcnt(56)
    v_perm_b32 v164, v51, v50, v11
    v_accvgpr_write_b32 a72, v5
    v_accvgpr_write_b32 a76, v6
    s_add_u32 s17, s49, 445824
    buffer_load_dword v108, v9, s[20:23], s17 offen
    buffer_load_dword v109, v10, s[20:23], s17 offen
    buffer_load_dword v110, v12, s[20:23], s17 offen
    buffer_load_dword v111, v13, s[20:23], s17 offen
    s_waitcnt vmcnt(58)
    v_perm_b32 v5, v53, v52, s44
    v_perm_b32 v6, v53, v52, s45
    s_waitcnt vmcnt(56)
    v_perm_b32 v165, v55, v54, v11
    v_accvgpr_write_b32 a73, v5
    v_accvgpr_write_b32 a77, v6
    s_add_u32 s17, s49, 479232
    buffer_load_dword v112, v9, s[20:23], s17 offen
    buffer_load_dword v113, v10, s[20:23], s17 offen
    buffer_load_dword v114, v12, s[20:23], s17 offen
    buffer_load_dword v115, v13, s[20:23], s17 offen
    s_waitcnt vmcnt(58)
    v_perm_b32 v5, v57, v56, s44
    v_perm_b32 v6, v57, v56, s45
    s_waitcnt vmcnt(56)
    v_perm_b32 v166, v59, v58, v11
    v_accvgpr_write_b32 a74, v5
    v_accvgpr_write_b32 a78, v6
    s_add_u32 s17, s49, 480384
    buffer_load_dword v116, v9, s[20:23], s17 offen
    buffer_load_dword v117, v10, s[20:23], s17 offen
    buffer_load_dword v118, v12, s[20:23], s17 offen
    buffer_load_dword v119, v13, s[20:23], s17 offen
    s_waitcnt vmcnt(58)
    v_perm_b32 v5, v61, v60, s44
    v_perm_b32 v6, v61, v60, s45
    s_waitcnt vmcnt(56)
    v_perm_b32 v167, v63, v62, v11
    v_accvgpr_write_b32 a75, v5
    v_accvgpr_write_b32 a79, v6
    s_add_u32 s17, s49, 481536
    buffer_load_dword v120, v9, s[20:23], s17 offen
    buffer_load_dword v121, v10, s[20:23], s17 offen
    buffer_load_dword v122, v12, s[20:23], s17 offen
    buffer_load_dword v123, v13, s[20:23], s17 offen
    s_waitcnt vmcnt(58)
    v_perm_b32 v5, v65, v64, s44
    v_perm_b32 v6, v65, v64, s45
    s_waitcnt vmcnt(56)
    v_perm_b32 v168, v67, v66, v11
    v_accvgpr_write_b32 a80, v5
    v_accvgpr_write_b32 a84, v6
    s_add_u32 s17, s49, 482688
    buffer_load_dword v124, v9, s[20:23], s17 offen
    buffer_load_dword v125, v10, s[20:23], s17 offen
    buffer_load_dword v126, v12, s[20:23], s17 offen
    buffer_load_dword v127, v13, s[20:23], s17 offen
    s_waitcnt vmcnt(58)
    v_perm_b32 v5, v69, v68, s44
    v_perm_b32 v6, v69, v68, s45
    s_waitcnt vmcnt(56)
    v_perm_b32 v169, v71, v70, v11
    v_accvgpr_write_b32 a81, v5
    v_accvgpr_write_b32 a85, v6
    s_add_u32 s17, s49, 516096
    buffer_load_dword v16, v9, s[20:23], s17 offen
    buffer_load_dword v17, v10, s[20:23], s17 offen
    buffer_load_dword v18, v12, s[20:23], s17 offen
    buffer_load_dword v19, v13, s[20:23], s17 offen
    s_waitcnt vmcnt(58)
    v_perm_b32 v5, v73, v72, s44
    v_perm_b32 v6, v73, v72, s45
    s_waitcnt vmcnt(56)
    v_perm_b32 v170, v75, v74, v11
    v_accvgpr_write_b32 a82, v5
    v_accvgpr_write_b32 a86, v6
    s_add_u32 s17, s49, 517248
    buffer_load_dword v20, v9, s[20:23], s17 offen
    buffer_load_dword v21, v10, s[20:23], s17 offen
    buffer_load_dword v22, v12, s[20:23], s17 offen
    buffer_load_dword v23, v13, s[20:23], s17 offen
    s_waitcnt vmcnt(58)
    v_perm_b32 v5, v77, v76, s44
    v_perm_b32 v6, v77, v76, s45
    s_waitcnt vmcnt(56)
    v_perm_b32 v171, v79, v78, v11
    v_accvgpr_write_b32 a83, v5
    v_accvgpr_write_b32 a87, v6
    s_add_u32 s17, s49, 518400
    buffer_load_dword v24, v9, s[20:23], s17 offen
    buffer_load_dword v25, v10, s[20:23], s17 offen
    buffer_load_dword v26, v12, s[20:23], s17 offen
    buffer_load_dword v27, v13, s[20:23], s17 offen
    s_waitcnt vmcnt(58)
    v_perm_b32 v5, v81, v80, s44
    v_perm_b32 v6, v81, v80, s45
    s_waitcnt vmcnt(56)
    v_perm_b32 v172, v83, v82, v11
    v_accvgpr_write_b32 a88, v5
    v_accvgpr_write_b32 a92, v6
    s_add_u32 s17, s49, 519552
    buffer_load_dword v28, v9, s[20:23], s17 offen
    buffer_load_dword v29, v10, s[20:23], s17 offen
    buffer_load_dword v30, v12, s[20:23], s17 offen
    buffer_load_dword v31, v13, s[20:23], s17 offen
    s_waitcnt vmcnt(58)
    v_perm_b32 v5, v85, v84, s44
    v_perm_b32 v6, v85, v84, s45
    s_waitcnt vmcnt(56)
    v_perm_b32 v173, v87, v86, v11
    v_accvgpr_write_b32 a89, v5
    v_accvgpr_write_b32 a93, v6
    s_add_u32 s17, s49, 552960
    buffer_load_dword v32, v9, s[20:23], s17 offen
    buffer_load_dword v33, v10, s[20:23], s17 offen
    buffer_load_dword v34, v12, s[20:23], s17 offen
    buffer_load_dword v35, v13, s[20:23], s17 offen
    s_waitcnt vmcnt(58)
    v_perm_b32 v5, v89, v88, s44
    v_perm_b32 v6, v89, v88, s45
    s_waitcnt vmcnt(56)
    v_perm_b32 v174, v91, v90, v11
    v_accvgpr_write_b32 a90, v5
    v_accvgpr_write_b32 a94, v6
    s_add_u32 s17, s49, 554112
    buffer_load_dword v36, v9, s[20:23], s17 offen
    buffer_load_dword v37, v10, s[20:23], s17 offen
    buffer_load_dword v38, v12, s[20:23], s17 offen
    buffer_load_dword v39, v13, s[20:23], s17 offen
    s_waitcnt vmcnt(58)
    v_perm_b32 v5, v93, v92, s44
    v_perm_b32 v6, v93, v92, s45
    s_waitcnt vmcnt(56)
    v_perm_b32 v175, v95, v94, v11
    v_accvgpr_write_b32 a91, v5
    v_accvgpr_write_b32 a95, v6
    s_add_u32 s17, s49, 555264
    buffer_load_dword v40, v9, s[20:23], s17 offen
    buffer_load_dword v41, v10, s[20:23], s17 offen
    buffer_load_dword v42, v12, s[20:23], s17 offen
    buffer_load_dword v43, v13, s[20:23], s17 offen
    s_waitcnt vmcnt(58)
    v_perm_b32 v5, v97, v96, s44
    v_perm_b32 v6, v97, v96, s45
    s_waitcnt vmcnt(56)
    v_perm_b32 v176, v99, v98, v11
    v_accvgpr_write_b32 a96, v5
    v_accvgpr_write_b32 a100, v6
    s_add_u32 s17, s49, 556416
    buffer_load_dword v44, v9, s[20:23], s17 offen
    buffer_load_dword v45, v10, s[20:23], s17 offen
    buffer_load_dword v46, v12, s[20:23], s17 offen
    buffer_load_dword v47, v13, s[20:23], s17 offen
    s_waitcnt vmcnt(58)
    v_perm_b32 v5, v101, v100, s44
    v_perm_b32 v6, v101, v100, s45
    s_waitcnt vmcnt(56)
    v_perm_b32 v177, v103, v102, v11
    v_accvgpr_write_b32 a97, v5
    v_accvgpr_write_b32 a101, v6
    s_add_u32 s17, s49, 589824
    buffer_load_dword v48, v9, s[20:23], s17 offen
    buffer_load_dword v49, v10, s[20:23], s17 offen
    buffer_load_dword v50, v12, s[20:23], s17 offen
    buffer_load_dword v51, v13, s[20:23], s17 offen
    s_waitcnt vmcnt(58)
    v_perm_b32 v5, v105, v104, s44
    v_perm_b32 v6, v105, v104, s45
    s_waitcnt vmcnt(56)
    v_perm_b32 v178, v107, v106, v11
    v_accvgpr_write_b32 a98, v5
    v_accvgpr_write_b32 a102, v6
    s_add_u32 s17, s49, 590976
    buffer_load_dword v52, v9, s[20:23], s17 offen
    buffer_load_dword v53, v10, s[20:23], s17 offen
    buffer_load_dword v54, v12, s[20:23], s17 offen
    buffer_load_dword v55, v13, s[20:23], s17 offen
    s_waitcnt vmcnt(58)
    v_perm_b32 v5, v109, v108, s44
    v_perm_b32 v6, v109, v108, s45
    s_waitcnt vmcnt(56)
    v_perm_b32 v179, v111, v110, v11
    v_accvgpr_write_b32 a99, v5
    v_accvgpr_write_b32 a103, v6
    s_add_u32 s17, s49, 592128
    buffer_load_dword v56, v9, s[20:23], s17 offen
    buffer_load_dword v57, v10, s[20:23], s17 offen
    buffer_load_dword v58, v12, s[20:23], s17 offen
    buffer_load_dword v59, v13, s[20:23], s17 offen
    s_waitcnt vmcnt(58)
    v_perm_b32 v5, v113, v112, s44
    v_perm_b32 v6, v113, v112, s45
    s_waitcnt vmcnt(56)
    v_perm_b32 v180, v115, v114, v11
    v_accvgpr_write_b32 a104, v5
    v_accvgpr_write_b32 a108, v6
    s_add_u32 s17, s49, 593280
    buffer_load_dword v60, v9, s[20:23], s17 offen
    buffer_load_dword v61, v10, s[20:23], s17 offen
    buffer_load_dword v62, v12, s[20:23], s17 offen
    buffer_load_dword v63, v13, s[20:23], s17 offen
    s_waitcnt vmcnt(58)
    v_perm_b32 v5, v117, v116, s44
    v_perm_b32 v6, v117, v116, s45
    s_waitcnt vmcnt(56)
    v_perm_b32 v181, v119, v118, v11
    v_accvgpr_write_b32 a105, v5
    v_accvgpr_write_b32 a109, v6
    s_add_u32 s17, s49, 626688
    buffer_load_dword v64, v9, s[20:23], s17 offen
    buffer_load_dword v65, v10, s[20:23], s17 offen
    buffer_load_dword v66, v12, s[20:23], s17 offen
    buffer_load_dword v67, v13, s[20:23], s17 offen
    s_waitcnt vmcnt(58)
    v_perm_b32 v5, v121, v120, s44
    v_perm_b32 v6, v121, v120, s45
    s_waitcnt vmcnt(56)
    v_perm_b32 v182, v123, v122, v11
    v_accvgpr_write_b32 a106, v5
    v_accvgpr_write_b32 a110, v6
    s_add_u32 s17, s49, 627840
    buffer_load_dword v68, v9, s[20:23], s17 offen
    buffer_load_dword v69, v10, s[20:23], s17 offen
    buffer_load_dword v70, v12, s[20:23], s17 offen
    buffer_load_dword v71, v13, s[20:23], s17 offen
    s_waitcnt vmcnt(58)
    v_perm_b32 v5, v125, v124, s44
    v_perm_b32 v6, v125, v124, s45
    s_waitcnt vmcnt(56)
    v_perm_b32 v183, v127, v126, v11
    v_accvgpr_write_b32 a107, v5
    v_accvgpr_write_b32 a111, v6
    s_add_u32 s17, s49, 628992
    buffer_load_dword v72, v9, s[20:23], s17 offen
    buffer_load_dword v73, v10, s[20:23], s17 offen
    buffer_load_dword v74, v12, s[20:23], s17 offen
    buffer_load_dword v75, v13, s[20:23], s17 offen
    s_waitcnt vmcnt(58)
    v_perm_b32 v5, v17, v16, s44
    v_perm_b32 v6, v17, v16, s45
    s_waitcnt vmcnt(56)
    v_perm_b32 v184, v19, v18, v11
    v_accvgpr_write_b32 a112, v5
    v_accvgpr_write_b32 a116, v6
    s_add_u32 s17, s49, 630144
    buffer_load_dword v76, v9, s[20:23], s17 offen
    buffer_load_dword v77, v10, s[20:23], s17 offen
    buffer_load_dword v78, v12, s[20:23], s17 offen
    buffer_load_dword v79, v13, s[20:23], s17 offen
    s_waitcnt vmcnt(58)
    v_perm_b32 v5, v21, v20, s44
    v_perm_b32 v6, v21, v20, s45
    s_waitcnt vmcnt(56)
    v_perm_b32 v185, v23, v22, v11
    v_accvgpr_write_b32 a113, v5
    v_accvgpr_write_b32 a117, v6
    s_add_u32 s17, s49, 663552
    buffer_load_dword v80, v9, s[20:23], s17 offen
    buffer_load_dword v81, v10, s[20:23], s17 offen
    buffer_load_dword v82, v12, s[20:23], s17 offen
    buffer_load_dword v83, v13, s[20:23], s17 offen
    s_waitcnt vmcnt(58)
    v_perm_b32 v5, v25, v24, s44
    v_perm_b32 v6, v25, v24, s45
    s_waitcnt vmcnt(56)
    v_perm_b32 v186, v27, v26, v11
    v_accvgpr_write_b32 a114, v5
    v_accvgpr_write_b32 a118, v6
    s_add_u32 s17, s49, 664704
    buffer_load_dword v84, v9, s[20:23], s17 offen
    buffer_load_dword v85, v10, s[20:23], s17 offen
    buffer_load_dword v86, v12, s[20:23], s17 offen
    buffer_load_dword v87, v13, s[20:23], s17 offen
    s_waitcnt vmcnt(58)
    v_perm_b32 v5, v29, v28, s44
    v_perm_b32 v6, v29, v28, s45
    s_waitcnt vmcnt(56)
    v_perm_b32 v187, v31, v30, v11
    v_accvgpr_write_b32 a115, v5
    v_accvgpr_write_b32 a119, v6
    s_add_u32 s17, s49, 665856
    buffer_load_dword v88, v9, s[20:23], s17 offen
    buffer_load_dword v89, v10, s[20:23], s17 offen
    buffer_load_dword v90, v12, s[20:23], s17 offen
    buffer_load_dword v91, v13, s[20:23], s17 offen
    s_waitcnt vmcnt(58)
    v_perm_b32 v5, v33, v32, s44
    v_perm_b32 v6, v33, v32, s45
    s_waitcnt vmcnt(56)
    v_perm_b32 v188, v35, v34, v11
    v_accvgpr_write_b32 a120, v5
    v_accvgpr_write_b32 a124, v6
    s_add_u32 s17, s49, 667008
    buffer_load_dword v92, v9, s[20:23], s17 offen
    buffer_load_dword v93, v10, s[20:23], s17 offen
    buffer_load_dword v94, v12, s[20:23], s17 offen
    buffer_load_dword v95, v13, s[20:23], s17 offen
    s_waitcnt vmcnt(58)
    v_perm_b32 v5, v37, v36, s44
    v_perm_b32 v6, v37, v36, s45
    s_waitcnt vmcnt(56)
    v_perm_b32 v189, v39, v38, v11
    v_accvgpr_write_b32 a121, v5
    v_accvgpr_write_b32 a125, v6
    s_add_u32 s17, s49, 700416
    buffer_load_dword v96, v9, s[20:23], s17 offen
    buffer_load_dword v97, v10, s[20:23], s17 offen
    buffer_load_dword v98, v12, s[20:23], s17 offen
    buffer_load_dword v99, v13, s[20:23], s17 offen
    s_waitcnt vmcnt(58)
    v_perm_b32 v5, v41, v40, s44
    v_perm_b32 v6, v41, v40, s45
    s_waitcnt vmcnt(56)
    v_perm_b32 v190, v43, v42, v11
    v_accvgpr_write_b32 a122, v5
    v_accvgpr_write_b32 a126, v6
    s_add_u32 s17, s49, 701568
    buffer_load_dword v100, v9, s[20:23], s17 offen
    buffer_load_dword v101, v10, s[20:23], s17 offen
    buffer_load_dword v102, v12, s[20:23], s17 offen
    buffer_load_dword v103, v13, s[20:23], s17 offen
    s_waitcnt vmcnt(58)
    v_perm_b32 v5, v45, v44, s44
    v_perm_b32 v6, v45, v44, s45
    s_waitcnt vmcnt(56)
    v_perm_b32 v191, v47, v46, v11
    v_accvgpr_write_b32 a123, v5
    v_accvgpr_write_b32 a127, v6
    s_add_u32 s17, s49, 702720
    buffer_load_dword v104, v9, s[20:23], s17 offen
    buffer_load_dword v105, v10, s[20:23], s17 offen
    buffer_load_dword v106, v12, s[20:23], s17 offen
    buffer_load_dword v107, v13, s[20:23], s17 offen
    s_waitcnt vmcnt(58)
    v_perm_b32 v5, v49, v48, s44
    v_perm_b32 v6, v49, v48, s45
    s_waitcnt vmcnt(56)
    v_perm_b32 v192, v51, v50, v11
    v_accvgpr_write_b32 a128, v5
    v_accvgpr_write_b32 a132, v6
    s_add_u32 s17, s49, 703872
    buffer_load_dword v108, v9, s[20:23], s17 offen
    buffer_load_dword v109, v10, s[20:23], s17 offen
    buffer_load_dword v110, v12, s[20:23], s17 offen
    buffer_load_dword v111, v13, s[20:23], s17 offen
    s_waitcnt vmcnt(58)
    v_perm_b32 v5, v53, v52, s44
    v_perm_b32 v6, v53, v52, s45
    s_waitcnt vmcnt(56)
    v_perm_b32 v193, v55, v54, v11
    v_accvgpr_write_b32 a129, v5
    v_accvgpr_write_b32 a133, v6
    s_add_u32 s17, s49, 737280
    buffer_load_dword v112, v9, s[20:23], s17 offen
    buffer_load_dword v113, v10, s[20:23], s17 offen
    buffer_load_dword v114, v12, s[20:23], s17 offen
    buffer_load_dword v115, v13, s[20:23], s17 offen
    s_waitcnt vmcnt(58)
    v_perm_b32 v5, v57, v56, s44
    v_perm_b32 v6, v57, v56, s45
    s_waitcnt vmcnt(56)
    v_perm_b32 v194, v59, v58, v11
    v_accvgpr_write_b32 a130, v5
    v_accvgpr_write_b32 a134, v6
    s_add_u32 s17, s49, 738432
    buffer_load_dword v116, v9, s[20:23], s17 offen
    buffer_load_dword v117, v10, s[20:23], s17 offen
    buffer_load_dword v118, v12, s[20:23], s17 offen
    buffer_load_dword v119, v13, s[20:23], s17 offen
    s_waitcnt vmcnt(58)
    v_perm_b32 v5, v61, v60, s44
    v_perm_b32 v6, v61, v60, s45
    s_waitcnt vmcnt(56)
    v_perm_b32 v195, v63, v62, v11
    v_accvgpr_write_b32 a131, v5
    v_accvgpr_write_b32 a135, v6
    s_add_u32 s17, s49, 739584
    buffer_load_dword v120, v9, s[20:23], s17 offen
    buffer_load_dword v121, v10, s[20:23], s17 offen
    buffer_load_dword v122, v12, s[20:23], s17 offen
    buffer_load_dword v123, v13, s[20:23], s17 offen
    s_waitcnt vmcnt(58)
    v_perm_b32 v5, v65, v64, s44
    v_perm_b32 v6, v65, v64, s45
    s_waitcnt vmcnt(56)
    v_perm_b32 v196, v67, v66, v11
    v_accvgpr_write_b32 a136, v5
    v_accvgpr_write_b32 a140, v6
    s_add_u32 s17, s49, 740736
    buffer_load_dword v124, v9, s[20:23], s17 offen
    buffer_load_dword v125, v10, s[20:23], s17 offen
    buffer_load_dword v126, v12, s[20:23], s17 offen
    buffer_load_dword v127, v13, s[20:23], s17 offen
    s_waitcnt vmcnt(58)
    v_perm_b32 v5, v69, v68, s44
    v_perm_b32 v6, v69, v68, s45
    s_waitcnt vmcnt(56)
    v_perm_b32 v197, v71, v70, v11
    v_accvgpr_write_b32 a137, v5
    v_accvgpr_write_b32 a141, v6
    s_add_u32 s17, s49, 774144
    buffer_load_dword v16, v9, s[20:23], s17 offen
    buffer_load_dword v17, v10, s[20:23], s17 offen
    buffer_load_dword v18, v12, s[20:23], s17 offen
    buffer_load_dword v19, v13, s[20:23], s17 offen
    s_waitcnt vmcnt(58)
    v_perm_b32 v5, v73, v72, s44
    v_perm_b32 v6, v73, v72, s45
    s_waitcnt vmcnt(56)
    v_perm_b32 v198, v75, v74, v11
    v_accvgpr_write_b32 a138, v5
    v_accvgpr_write_b32 a142, v6
    s_add_u32 s17, s49, 775296
    buffer_load_dword v20, v9, s[20:23], s17 offen
    buffer_load_dword v21, v10, s[20:23], s17 offen
    buffer_load_dword v22, v12, s[20:23], s17 offen
    buffer_load_dword v23, v13, s[20:23], s17 offen
    s_waitcnt vmcnt(58)
    v_perm_b32 v5, v77, v76, s44
    v_perm_b32 v6, v77, v76, s45
    s_waitcnt vmcnt(56)
    v_perm_b32 v199, v79, v78, v11
    v_accvgpr_write_b32 a139, v5
    v_accvgpr_write_b32 a143, v6
    s_add_u32 s17, s49, 776448
    buffer_load_dword v24, v9, s[20:23], s17 offen
    buffer_load_dword v25, v10, s[20:23], s17 offen
    buffer_load_dword v26, v12, s[20:23], s17 offen
    buffer_load_dword v27, v13, s[20:23], s17 offen
    s_waitcnt vmcnt(58)
    v_perm_b32 v5, v81, v80, s44
    v_perm_b32 v6, v81, v80, s45
    s_waitcnt vmcnt(56)
    v_perm_b32 v200, v83, v82, v11
    v_accvgpr_write_b32 a144, v5
    v_accvgpr_write_b32 a148, v6
    s_add_u32 s17, s49, 777600
    buffer_load_dword v28, v9, s[20:23], s17 offen
    buffer_load_dword v29, v10, s[20:23], s17 offen
    buffer_load_dword v30, v12, s[20:23], s17 offen
    buffer_load_dword v31, v13, s[20:23], s17 offen
    s_waitcnt vmcnt(58)
    v_perm_b32 v5, v85, v84, s44
    v_perm_b32 v6, v85, v84, s45
    s_waitcnt vmcnt(56)
    v_perm_b32 v201, v87, v86, v11
    v_accvgpr_write_b32 a145, v5
    v_accvgpr_write_b32 a149, v6
    s_add_u32 s17, s49, 811008
    buffer_load_dword v32, v9, s[20:23], s17 offen
    buffer_load_dword v33, v10, s[20:23], s17 offen
    buffer_load_dword v34, v12, s[20:23], s17 offen
    buffer_load_dword v35, v13, s[20:23], s17 offen
    s_waitcnt vmcnt(58)
    v_perm_b32 v5, v89, v88, s44
    v_perm_b32 v6, v89, v88, s45
    s_waitcnt vmcnt(56)
    v_perm_b32 v202, v91, v90, v11
    v_accvgpr_write_b32 a146, v5
    v_accvgpr_write_b32 a150, v6
    s_add_u32 s17, s49, 812160
    buffer_load_dword v36, v9, s[20:23], s17 offen
    buffer_load_dword v37, v10, s[20:23], s17 offen
    buffer_load_dword v38, v12, s[20:23], s17 offen
    buffer_load_dword v39, v13, s[20:23], s17 offen
    s_waitcnt vmcnt(58)
    v_perm_b32 v5, v93, v92, s44
    v_perm_b32 v6, v93, v92, s45
    s_waitcnt vmcnt(56)
    v_perm_b32 v203, v95, v94, v11
    v_accvgpr_write_b32 a147, v5
    v_accvgpr_write_b32 a151, v6
    s_add_u32 s17, s49, 813312
    buffer_load_dword v40, v9, s[20:23], s17 offen
    buffer_load_dword v41, v10, s[20:23], s17 offen
    buffer_load_dword v42, v12, s[20:23], s17 offen
    buffer_load_dword v43, v13, s[20:23], s17 offen
    s_waitcnt vmcnt(58)
    v_perm_b32 v5, v97, v96, s44
    v_perm_b32 v6, v97, v96, s45
    s_waitcnt vmcnt(56)
    v_perm_b32 v204, v99, v98, v11
    v_accvgpr_write_b32 a152, v5
    v_accvgpr_write_b32 a156, v6
    s_add_u32 s17, s49, 814464
    buffer_load_dword v44, v9, s[20:23], s17 offen
    buffer_load_dword v45, v10, s[20:23], s17 offen
    buffer_load_dword v46, v12, s[20:23], s17 offen
    buffer_load_dword v47, v13, s[20:23], s17 offen
    s_waitcnt vmcnt(58)
    v_perm_b32 v5, v101, v100, s44
    v_perm_b32 v6, v101, v100, s45
    s_waitcnt vmcnt(56)
    v_perm_b32 v205, v103, v102, v11
    v_accvgpr_write_b32 a153, v5
    v_accvgpr_write_b32 a157, v6
    s_add_u32 s17, s49, 847872
    buffer_load_dword v48, v9, s[20:23], s17 offen
    buffer_load_dword v49, v10, s[20:23], s17 offen
    buffer_load_dword v50, v12, s[20:23], s17 offen
    buffer_load_dword v51, v13, s[20:23], s17 offen
    s_waitcnt vmcnt(58)
    v_perm_b32 v5, v105, v104, s44
    v_perm_b32 v6, v105, v104, s45
    s_waitcnt vmcnt(56)
    v_perm_b32 v206, v107, v106, v11
    v_accvgpr_write_b32 a154, v5
    v_accvgpr_write_b32 a158, v6
    s_add_u32 s17, s49, 849024
    buffer_load_dword v52, v9, s[20:23], s17 offen
    buffer_load_dword v53, v10, s[20:23], s17 offen
    buffer_load_dword v54, v12, s[20:23], s17 offen
    buffer_load_dword v55, v13, s[20:23], s17 offen
    s_waitcnt vmcnt(58)
    v_perm_b32 v5, v109, v108, s44
    v_perm_b32 v6, v109, v108, s45
    s_waitcnt vmcnt(56)
    v_perm_b32 v207, v111, v110, v11
    v_accvgpr_write_b32 a155, v5
    v_accvgpr_write_b32 a159, v6
    s_add_u32 s17, s49, 850176
    buffer_load_dword v56, v9, s[20:23], s17 offen
    buffer_load_dword v57, v10, s[20:23], s17 offen
    buffer_load_dword v58, v12, s[20:23], s17 offen
    buffer_load_dword v59, v13, s[20:23], s17 offen
    s_waitcnt vmcnt(58)
    v_perm_b32 v5, v113, v112, s44
    v_perm_b32 v6, v113, v112, s45
    s_waitcnt vmcnt(56)
    v_perm_b32 v208, v115, v114, v11
    v_accvgpr_write_b32 a160, v5
    v_accvgpr_write_b32 a164, v6
    s_add_u32 s17, s49, 851328
    buffer_load_dword v60, v9, s[20:23], s17 offen
    buffer_load_dword v61, v10, s[20:23], s17 offen
    buffer_load_dword v62, v12, s[20:23], s17 offen
    buffer_load_dword v63, v13, s[20:23], s17 offen
    s_waitcnt vmcnt(58)
    v_perm_b32 v5, v117, v116, s44
    v_perm_b32 v6, v117, v116, s45
    s_waitcnt vmcnt(56)
    v_perm_b32 v209, v119, v118, v11
    v_accvgpr_write_b32 a161, v5
    v_accvgpr_write_b32 a165, v6
    s_add_u32 s17, s49, 884736
    buffer_load_dword v64, v9, s[20:23], s17 offen
    buffer_load_dword v65, v10, s[20:23], s17 offen
    buffer_load_dword v66, v12, s[20:23], s17 offen
    buffer_load_dword v67, v13, s[20:23], s17 offen
    s_waitcnt vmcnt(58)
    v_perm_b32 v5, v121, v120, s44
    v_perm_b32 v6, v121, v120, s45
    s_waitcnt vmcnt(56)
    v_perm_b32 v210, v123, v122, v11
    v_accvgpr_write_b32 a162, v5
    v_accvgpr_write_b32 a166, v6
    s_add_u32 s17, s49, 885888
    buffer_load_dword v68, v9, s[20:23], s17 offen
    buffer_load_dword v69, v10, s[20:23], s17 offen
    buffer_load_dword v70, v12, s[20:23], s17 offen
    buffer_load_dword v71, v13, s[20:23], s17 offen
    s_waitcnt vmcnt(58)
    v_perm_b32 v5, v125, v124, s44
    v_perm_b32 v6, v125, v124, s45
    s_waitcnt vmcnt(56)
    v_perm_b32 v211, v127, v126, v11
    v_accvgpr_write_b32 a163, v5
    v_accvgpr_write_b32 a167, v6
    s_add_u32 s17, s49, 887040
    buffer_load_dword v72, v9, s[20:23], s17 offen
    buffer_load_dword v73, v10, s[20:23], s17 offen
    buffer_load_dword v74, v12, s[20:23], s17 offen
    buffer_load_dword v75, v13, s[20:23], s17 offen
    s_waitcnt vmcnt(58)
    v_perm_b32 v5, v17, v16, s44
    v_perm_b32 v6, v17, v16, s45
    s_waitcnt vmcnt(56)
    v_perm_b32 v212, v19, v18, v11
    v_accvgpr_write_b32 a168, v5
    v_accvgpr_write_b32 a172, v6
    s_add_u32 s17, s49, 888192
    buffer_load_dword v76, v9, s[20:23], s17 offen
    buffer_load_dword v77, v10, s[20:23], s17 offen
    buffer_load_dword v78, v12, s[20:23], s17 offen
    buffer_load_dword v79, v13, s[20:23], s17 offen
    s_waitcnt vmcnt(58)
    v_perm_b32 v5, v21, v20, s44
    v_perm_b32 v6, v21, v20, s45
    s_waitcnt vmcnt(56)
    v_perm_b32 v213, v23, v22, v11
    v_accvgpr_write_b32 a169, v5
    v_accvgpr_write_b32 a173, v6
    s_add_u32 s17, s49, 921600
    buffer_load_dword v80, v9, s[20:23], s17 offen
    buffer_load_dword v81, v10, s[20:23], s17 offen
    buffer_load_dword v82, v12, s[20:23], s17 offen
    buffer_load_dword v83, v13, s[20:23], s17 offen
    s_waitcnt vmcnt(58)
    v_perm_b32 v5, v25, v24, s44
    v_perm_b32 v6, v25, v24, s45
    s_waitcnt vmcnt(56)
    v_perm_b32 v214, v27, v26, v11
    v_accvgpr_write_b32 a170, v5
    v_accvgpr_write_b32 a174, v6
    s_add_u32 s17, s49, 922752
    buffer_load_dword v84, v9, s[20:23], s17 offen
    buffer_load_dword v85, v10, s[20:23], s17 offen
    buffer_load_dword v86, v12, s[20:23], s17 offen
    buffer_load_dword v87, v13, s[20:23], s17 offen
    s_waitcnt vmcnt(58)
    v_perm_b32 v5, v29, v28, s44
    v_perm_b32 v6, v29, v28, s45
    s_waitcnt vmcnt(56)
    v_perm_b32 v215, v31, v30, v11
    v_accvgpr_write_b32 a171, v5
    v_accvgpr_write_b32 a175, v6
    s_add_u32 s17, s49, 923904
    buffer_load_dword v88, v9, s[20:23], s17 offen
    buffer_load_dword v89, v10, s[20:23], s17 offen
    buffer_load_dword v90, v12, s[20:23], s17 offen
    buffer_load_dword v91, v13, s[20:23], s17 offen
    s_waitcnt vmcnt(58)
    v_perm_b32 v5, v33, v32, s44
    v_perm_b32 v6, v33, v32, s45
    s_waitcnt vmcnt(56)
    v_perm_b32 v216, v35, v34, v11
    v_accvgpr_write_b32 a176, v5
    v_accvgpr_write_b32 a180, v6
    s_add_u32 s17, s49, 925056
    buffer_load_dword v92, v9, s[20:23], s17 offen
    buffer_load_dword v93, v10, s[20:23], s17 offen
    buffer_load_dword v94, v12, s[20:23], s17 offen
    buffer_load_dword v95, v13, s[20:23], s17 offen
    s_waitcnt vmcnt(58)
    v_perm_b32 v5, v37, v36, s44
    v_perm_b32 v6, v37, v36, s45
    s_waitcnt vmcnt(56)
    v_perm_b32 v217, v39, v38, v11
    v_accvgpr_write_b32 a177, v5
    v_accvgpr_write_b32 a181, v6
    s_add_u32 s17, s49, 958464
    buffer_load_dword v96, v9, s[20:23], s17 offen
    buffer_load_dword v97, v10, s[20:23], s17 offen
    buffer_load_dword v98, v12, s[20:23], s17 offen
    buffer_load_dword v99, v13, s[20:23], s17 offen
    s_waitcnt vmcnt(58)
    v_perm_b32 v5, v41, v40, s44
    v_perm_b32 v6, v41, v40, s45
    s_waitcnt vmcnt(56)
    v_perm_b32 v218, v43, v42, v11
    v_accvgpr_write_b32 a178, v5
    v_accvgpr_write_b32 a182, v6
    s_add_u32 s17, s49, 959616
    buffer_load_dword v100, v9, s[20:23], s17 offen
    buffer_load_dword v101, v10, s[20:23], s17 offen
    buffer_load_dword v102, v12, s[20:23], s17 offen
    buffer_load_dword v103, v13, s[20:23], s17 offen
    s_waitcnt vmcnt(58)
    v_perm_b32 v5, v45, v44, s44
    v_perm_b32 v6, v45, v44, s45
    s_waitcnt vmcnt(56)
    v_perm_b32 v219, v47, v46, v11
    v_accvgpr_write_b32 a179, v5
    v_accvgpr_write_b32 a183, v6
    s_add_u32 s17, s49, 960768
    buffer_load_dword v104, v9, s[20:23], s17 offen
    buffer_load_dword v105, v10, s[20:23], s17 offen
    buffer_load_dword v106, v12, s[20:23], s17 offen
    buffer_load_dword v107, v13, s[20:23], s17 offen
    s_waitcnt vmcnt(58)
    v_perm_b32 v5, v49, v48, s44
    v_perm_b32 v6, v49, v48, s45
    s_waitcnt vmcnt(56)
    v_perm_b32 v220, v51, v50, v11
    v_accvgpr_write_b32 a184, v5
    v_accvgpr_write_b32 a188, v6
    s_add_u32 s17, s49, 961920
    buffer_load_dword v108, v9, s[20:23], s17 offen
    buffer_load_dword v109, v10, s[20:23], s17 offen
    buffer_load_dword v110, v12, s[20:23], s17 offen
    buffer_load_dword v111, v13, s[20:23], s17 offen
    s_waitcnt vmcnt(58)
    v_perm_b32 v5, v53, v52, s44
    v_perm_b32 v6, v53, v52, s45
    s_waitcnt vmcnt(56)
    v_perm_b32 v221, v55, v54, v11
    v_accvgpr_write_b32 a185, v5
    v_accvgpr_write_b32 a189, v6
    s_add_u32 s17, s49, 995328
    buffer_load_dword v112, v9, s[20:23], s17 offen
    buffer_load_dword v113, v10, s[20:23], s17 offen
    buffer_load_dword v114, v12, s[20:23], s17 offen
    buffer_load_dword v115, v13, s[20:23], s17 offen
    s_waitcnt vmcnt(58)
    v_perm_b32 v5, v57, v56, s44
    v_perm_b32 v6, v57, v56, s45
    s_waitcnt vmcnt(56)
    v_perm_b32 v222, v59, v58, v11
    v_accvgpr_write_b32 a186, v5
    v_accvgpr_write_b32 a190, v6
    s_add_u32 s17, s49, 996480
    buffer_load_dword v116, v9, s[20:23], s17 offen
    buffer_load_dword v117, v10, s[20:23], s17 offen
    buffer_load_dword v118, v12, s[20:23], s17 offen
    buffer_load_dword v119, v13, s[20:23], s17 offen
    s_waitcnt vmcnt(58)
    v_perm_b32 v5, v61, v60, s44
    v_perm_b32 v6, v61, v60, s45
    s_waitcnt vmcnt(56)
    v_perm_b32 v223, v63, v62, v11
    v_accvgpr_write_b32 a187, v5
    v_accvgpr_write_b32 a191, v6
    s_add_u32 s17, s49, 997632
    buffer_load_dword v120, v9, s[20:23], s17 offen
    buffer_load_dword v121, v10, s[20:23], s17 offen
    buffer_load_dword v122, v12, s[20:23], s17 offen
    buffer_load_dword v123, v13, s[20:23], s17 offen
    s_waitcnt vmcnt(58)
    v_perm_b32 v5, v65, v64, s44
    v_perm_b32 v6, v65, v64, s45
    s_waitcnt vmcnt(56)
    v_perm_b32 v224, v67, v66, v11
    v_accvgpr_write_b32 a192, v5
    v_accvgpr_write_b32 a196, v6
    s_add_u32 s17, s49, 998784
    buffer_load_dword v124, v9, s[20:23], s17 offen
    buffer_load_dword v125, v10, s[20:23], s17 offen
    buffer_load_dword v126, v12, s[20:23], s17 offen
    buffer_load_dword v127, v13, s[20:23], s17 offen
    s_waitcnt vmcnt(58)
    v_perm_b32 v5, v69, v68, s44
    v_perm_b32 v6, v69, v68, s45
    s_waitcnt vmcnt(56)
    v_perm_b32 v225, v71, v70, v11
    v_accvgpr_write_b32 a193, v5
    v_accvgpr_write_b32 a197, v6
    s_add_u32 s17, s49, 1032192
    buffer_load_dword v16, v9, s[20:23], s17 offen
    buffer_load_dword v17, v10, s[20:23], s17 offen
    buffer_load_dword v18, v12, s[20:23], s17 offen
    buffer_load_dword v19, v13, s[20:23], s17 offen
    s_waitcnt vmcnt(58)
    v_perm_b32 v5, v73, v72, s44
    v_perm_b32 v6, v73, v72, s45
    s_waitcnt vmcnt(56)
    v_perm_b32 v226, v75, v74, v11
    v_accvgpr_write_b32 a194, v5
    v_accvgpr_write_b32 a198, v6
    s_add_u32 s17, s49, 1033344
    buffer_load_dword v20, v9, s[20:23], s17 offen
    buffer_load_dword v21, v10, s[20:23], s17 offen
    buffer_load_dword v22, v12, s[20:23], s17 offen
    buffer_load_dword v23, v13, s[20:23], s17 offen
    s_waitcnt vmcnt(58)
    v_perm_b32 v5, v77, v76, s44
    v_perm_b32 v6, v77, v76, s45
    s_waitcnt vmcnt(56)
    v_perm_b32 v227, v79, v78, v11
    v_accvgpr_write_b32 a195, v5
    v_accvgpr_write_b32 a199, v6
    s_add_u32 s17, s49, 1034496
    buffer_load_dword v24, v9, s[20:23], s17 offen
    buffer_load_dword v25, v10, s[20:23], s17 offen
    buffer_load_dword v26, v12, s[20:23], s17 offen
    buffer_load_dword v27, v13, s[20:23], s17 offen
    s_waitcnt vmcnt(58)
    v_perm_b32 v5, v81, v80, s44
    v_perm_b32 v6, v81, v80, s45
    s_waitcnt vmcnt(56)
    v_perm_b32 v228, v83, v82, v11
    v_accvgpr_write_b32 a200, v5
    v_accvgpr_write_b32 a204, v6
    s_add_u32 s17, s49, 1035648
    buffer_load_dword v28, v9, s[20:23], s17 offen
    buffer_load_dword v29, v10, s[20:23], s17 offen
    buffer_load_dword v30, v12, s[20:23], s17 offen
    buffer_load_dword v31, v13, s[20:23], s17 offen
    s_waitcnt vmcnt(58)
    v_perm_b32 v5, v85, v84, s44
    v_perm_b32 v6, v85, v84, s45
    s_waitcnt vmcnt(56)
    v_perm_b32 v229, v87, v86, v11
    v_accvgpr_write_b32 a201, v5
    v_accvgpr_write_b32 a205, v6
    s_add_u32 s17, s49, 1069056
    buffer_load_dword v32, v9, s[20:23], s17 offen
    buffer_load_dword v33, v10, s[20:23], s17 offen
    buffer_load_dword v34, v12, s[20:23], s17 offen
    buffer_load_dword v35, v13, s[20:23], s17 offen
    s_waitcnt vmcnt(58)
    v_perm_b32 v5, v89, v88, s44
    v_perm_b32 v6, v89, v88, s45
    s_waitcnt vmcnt(56)
    v_perm_b32 v230, v91, v90, v11
    v_accvgpr_write_b32 a202, v5
    v_accvgpr_write_b32 a206, v6
    s_add_u32 s17, s49, 1070208
    buffer_load_dword v36, v9, s[20:23], s17 offen
    buffer_load_dword v37, v10, s[20:23], s17 offen
    buffer_load_dword v38, v12, s[20:23], s17 offen
    buffer_load_dword v39, v13, s[20:23], s17 offen
    s_waitcnt vmcnt(58)
    v_perm_b32 v5, v93, v92, s44
    v_perm_b32 v6, v93, v92, s45
    s_waitcnt vmcnt(56)
    v_perm_b32 v231, v95, v94, v11
    v_accvgpr_write_b32 a203, v5
    v_accvgpr_write_b32 a207, v6
    s_add_u32 s17, s49, 1071360
    buffer_load_dword v40, v9, s[20:23], s17 offen
    buffer_load_dword v41, v10, s[20:23], s17 offen
    buffer_load_dword v42, v12, s[20:23], s17 offen
    buffer_load_dword v43, v13, s[20:23], s17 offen
    s_waitcnt vmcnt(58)
    v_perm_b32 v5, v97, v96, s44
    v_perm_b32 v6, v97, v96, s45
    s_waitcnt vmcnt(56)
    v_perm_b32 v232, v99, v98, v11
    v_accvgpr_write_b32 a208, v5
    v_accvgpr_write_b32 a212, v6
    s_add_u32 s17, s49, 1072512
    buffer_load_dword v44, v9, s[20:23], s17 offen
    buffer_load_dword v45, v10, s[20:23], s17 offen
    buffer_load_dword v46, v12, s[20:23], s17 offen
    buffer_load_dword v47, v13, s[20:23], s17 offen
    s_waitcnt vmcnt(58)
    v_perm_b32 v5, v101, v100, s44
    v_perm_b32 v6, v101, v100, s45
    s_waitcnt vmcnt(56)
    v_perm_b32 v233, v103, v102, v11
    v_accvgpr_write_b32 a209, v5
    v_accvgpr_write_b32 a213, v6
    s_add_u32 s17, s49, 1105920
    buffer_load_dword v48, v9, s[20:23], s17 offen
    buffer_load_dword v49, v10, s[20:23], s17 offen
    buffer_load_dword v50, v12, s[20:23], s17 offen
    buffer_load_dword v51, v13, s[20:23], s17 offen
    s_waitcnt vmcnt(58)
    v_perm_b32 v5, v105, v104, s44
    v_perm_b32 v6, v105, v104, s45
    s_waitcnt vmcnt(56)
    v_perm_b32 v234, v107, v106, v11
    v_accvgpr_write_b32 a210, v5
    v_accvgpr_write_b32 a214, v6
    s_add_u32 s17, s49, 1107072
    buffer_load_dword v52, v9, s[20:23], s17 offen
    buffer_load_dword v53, v10, s[20:23], s17 offen
    buffer_load_dword v54, v12, s[20:23], s17 offen
    buffer_load_dword v55, v13, s[20:23], s17 offen
    s_waitcnt vmcnt(58)
    v_perm_b32 v5, v109, v108, s44
    v_perm_b32 v6, v109, v108, s45
    s_waitcnt vmcnt(56)
    v_perm_b32 v235, v111, v110, v11
    v_accvgpr_write_b32 a211, v5
    v_accvgpr_write_b32 a215, v6
    s_add_u32 s17, s49, 1108224
    buffer_load_dword v56, v9, s[20:23], s17 offen
    buffer_load_dword v57, v10, s[20:23], s17 offen
    buffer_load_dword v58, v12, s[20:23], s17 offen
    buffer_load_dword v59, v13, s[20:23], s17 offen
    s_waitcnt vmcnt(58)
    v_perm_b32 v5, v113, v112, s44
    v_perm_b32 v6, v113, v112, s45
    s_waitcnt vmcnt(56)
    v_perm_b32 v236, v115, v114, v11
    v_accvgpr_write_b32 a216, v5
    v_accvgpr_write_b32 a220, v6
    s_add_u32 s17, s49, 1109376
    buffer_load_dword v60, v9, s[20:23], s17 offen
    buffer_load_dword v61, v10, s[20:23], s17 offen
    buffer_load_dword v62, v12, s[20:23], s17 offen
    buffer_load_dword v63, v13, s[20:23], s17 offen
    s_waitcnt vmcnt(58)
    v_perm_b32 v5, v117, v116, s44
    v_perm_b32 v6, v117, v116, s45
    s_waitcnt vmcnt(56)
    v_perm_b32 v237, v119, v118, v11
    v_accvgpr_write_b32 a217, v5
    v_accvgpr_write_b32 a221, v6
    s_add_u32 s17, s49, 1142784
    buffer_load_dword v64, v9, s[20:23], s17 offen
    buffer_load_dword v65, v10, s[20:23], s17 offen
    buffer_load_dword v66, v12, s[20:23], s17 offen
    buffer_load_dword v67, v13, s[20:23], s17 offen
    s_waitcnt vmcnt(58)
    v_perm_b32 v5, v121, v120, s44
    v_perm_b32 v6, v121, v120, s45
    s_waitcnt vmcnt(56)
    v_perm_b32 v238, v123, v122, v11
    v_accvgpr_write_b32 a218, v5
    v_accvgpr_write_b32 a222, v6
    s_add_u32 s17, s49, 1143936
    buffer_load_dword v68, v9, s[20:23], s17 offen
    buffer_load_dword v69, v10, s[20:23], s17 offen
    buffer_load_dword v70, v12, s[20:23], s17 offen
    buffer_load_dword v71, v13, s[20:23], s17 offen
    s_waitcnt vmcnt(58)
    v_perm_b32 v5, v125, v124, s44
    v_perm_b32 v6, v125, v124, s45
    s_waitcnt vmcnt(56)
    v_perm_b32 v239, v127, v126, v11
    v_accvgpr_write_b32 a219, v5
    v_accvgpr_write_b32 a223, v6
    s_add_u32 s17, s49, 1145088
    buffer_load_dword v72, v9, s[20:23], s17 offen
    buffer_load_dword v73, v10, s[20:23], s17 offen
    buffer_load_dword v74, v12, s[20:23], s17 offen
    buffer_load_dword v75, v13, s[20:23], s17 offen
    s_waitcnt vmcnt(58)
    v_perm_b32 v5, v17, v16, s44
    v_perm_b32 v6, v17, v16, s45
    s_waitcnt vmcnt(56)
    v_perm_b32 v240, v19, v18, v11
    v_accvgpr_write_b32 a224, v5
    v_accvgpr_write_b32 a228, v6
    s_add_u32 s17, s49, 1146240
    buffer_load_dword v76, v9, s[20:23], s17 offen
    buffer_load_dword v77, v10, s[20:23], s17 offen
    buffer_load_dword v78, v12, s[20:23], s17 offen
    buffer_load_dword v79, v13, s[20:23], s17 offen
    s_waitcnt vmcnt(58)
    v_perm_b32 v5, v21, v20, s44
    v_perm_b32 v6, v21, v20, s45
    s_waitcnt vmcnt(56)
    v_perm_b32 v241, v23, v22, v11
    v_accvgpr_write_b32 a225, v5
    v_accvgpr_write_b32 a229, v6
    s_waitcnt vmcnt(54)
    v_perm_b32 v5, v25, v24, s44
    v_perm_b32 v6, v25, v24, s45
    s_waitcnt vmcnt(52)
    v_perm_b32 v242, v27, v26, v11
    v_accvgpr_write_b32 a226, v5
    v_accvgpr_write_b32 a230, v6
    s_waitcnt vmcnt(50)
    v_perm_b32 v5, v29, v28, s44
    v_perm_b32 v6, v29, v28, s45
    s_waitcnt vmcnt(48)
    v_perm_b32 v243, v31, v30, v11
    v_accvgpr_write_b32 a227, v5
    v_accvgpr_write_b32 a231, v6
    s_waitcnt vmcnt(46)
    v_perm_b32 v5, v33, v32, s44
    v_perm_b32 v6, v33, v32, s45
    s_waitcnt vmcnt(44)
    v_perm_b32 v244, v35, v34, v11
    v_accvgpr_write_b32 a232, v5
    v_accvgpr_write_b32 a236, v6
    s_waitcnt vmcnt(42)
    v_perm_b32 v5, v37, v36, s44
    v_perm_b32 v6, v37, v36, s45
    s_waitcnt vmcnt(40)
    v_perm_b32 v245, v39, v38, v11
    v_accvgpr_write_b32 a233, v5
    v_accvgpr_write_b32 a237, v6
    s_waitcnt vmcnt(38)
    v_perm_b32 v5, v41, v40, s44
    v_perm_b32 v6, v41, v40, s45
    s_waitcnt vmcnt(36)
    v_perm_b32 v246, v43, v42, v11
    v_accvgpr_write_b32 a234, v5
    v_accvgpr_write_b32 a238, v6
    s_waitcnt vmcnt(34)
    v_perm_b32 v5, v45, v44, s44
    v_perm_b32 v6, v45, v44, s45
    s_waitcnt vmcnt(32)
    v_perm_b32 v247, v47, v46, v11
    v_accvgpr_write_b32 a235, v5
    v_accvgpr_write_b32 a239, v6
    s_waitcnt vmcnt(30)
    v_perm_b32 v5, v49, v48, s44
    v_perm_b32 v6, v49, v48, s45
    s_waitcnt vmcnt(28)
    v_perm_b32 v248, v51, v50, v11
    v_accvgpr_write_b32 a240, v5
    v_accvgpr_write_b32 a244, v6
    s_waitcnt vmcnt(26)
    v_perm_b32 v5, v53, v52, s44
    v_perm_b32 v6, v53, v52, s45
    s_waitcnt vmcnt(24)
    v_perm_b32 v249, v55, v54, v11
    v_accvgpr_write_b32 a241, v5
    v_accvgpr_write_b32 a245, v6
    s_waitcnt vmcnt(22)
    v_perm_b32 v5, v57, v56, s44
    v_perm_b32 v6, v57, v56, s45
    s_waitcnt vmcnt(20)
    v_perm_b32 v250, v59, v58, v11
    v_accvgpr_write_b32 a242, v5
    v_accvgpr_write_b32 a246, v6
    s_waitcnt vmcnt(18)
    v_perm_b32 v5, v61, v60, s44
    v_perm_b32 v6, v61, v60, s45
    s_waitcnt vmcnt(16)
    v_perm_b32 v251, v63, v62, v11
    v_accvgpr_write_b32 a243, v5
    v_accvgpr_write_b32 a247, v6
    s_waitcnt vmcnt(14)
    v_perm_b32 v5, v65, v64, s44
    v_perm_b32 v6, v65, v64, s45
    s_waitcnt vmcnt(12)
    v_perm_b32 v252, v67, v66, v11
    v_accvgpr_write_b32 a248, v5
    v_accvgpr_write_b32 a252, v6
    s_waitcnt vmcnt(10)
    v_perm_b32 v5, v69, v68, s44
    v_perm_b32 v6, v69, v68, s45
    s_waitcnt vmcnt(8)
    v_perm_b32 v253, v71, v70, v11
    v_accvgpr_write_b32 a249, v5
    v_accvgpr_write_b32 a253, v6
    s_waitcnt vmcnt(6)
    v_perm_b32 v5, v73, v72, s44
    v_perm_b32 v6, v73, v72, s45
    s_waitcnt vmcnt(4)
    v_perm_b32 v254, v75, v74, v11
    v_accvgpr_write_b32 a250, v5
    v_accvgpr_write_b32 a254, v6
    s_waitcnt vmcnt(2)
    v_perm_b32 v5, v77, v76, s44
    v_perm_b32 v6, v77, v76, s45
    s_waitcnt vmcnt(0)
    v_perm_b32 v255, v79, v78, v11
    v_accvgpr_write_b32 a251, v5
    v_accvgpr_write_b32 a255, v6
    s_and_b32 s51, s14, 1
    s_lshl_b32 s17, s51, 4
    v_add_u32 v5, s17, v7
    v_lshlrev_b32 v14, 4, v5
    v_mul_u32_u24 v13, 1152, v5
    s_mul_i32 s17, s50, 96
    v_add_u32 v13, s17, v13
    s_mul_i32 s17, s50, 3072
    v_add_u32 v12, s17, v14
    v_lshrrev_b32 v14, 1, v14
    s_lshl_b32 s17, s50, 9
    v_add_u32 v14, s17, v14
    s_lshl_b32 s49, s50, 7
    s_lshl_b32 s17, s14, 2
    s_add_u32 s49, s49, s17
    s_add_u32 s49, s49, 1622016
    s_mul_i32 s17, s14, 6144
    v_add_u32 v48, s17, v0
    v_mov_b32 v49, 0x10000
    v_lshrrev_b32 v51, 4, v0
    v_min_u32 v51, 42, v51
    s_mul_i32 s17, s50, 43
    v_add_u32 v51, s17, v51
    v_lshlrev_b32 v51, 7, v51
    s_cmp_gt_u32 s14, 1
    s_cbranch_scc1 Ltw_z
    v_lshl_add_u32 v12, v8, 9, v12
    v_lshl_add_u32 v13, v8, 4, v13
    s_lshl_b32 s58, s14, 16
    s_add_u32 s58, s58, 144703488
    s_mov_b32 s43, 0
    s_mov_b32 s28, s8
    s_mov_b32 s29, s9
    s_mov_b32 s30, 0
    s_mov_b32 s31, 0x00020000
    s_mul_i32 s17, s51, 3072
    v_add_u32 v50, s17, v0
    ds_write2_b32 v49, v4, v4 offset0:0 offset1:1
    s_waitcnt lgkmcnt(0)
    s_cmp_lg_u32 s14, 0
    s_cbranch_scc1 LtwX_ini_d
    v_mov_b32 v5, 160
    s_mov_b32 s16, 0
LtwX_ini:
    global_load_dword v6, v5, s[12:13] sc1
    s_add_u32 s16, s16, 1
    s_cmp_gt_u32 s16, 100000
    s_cbranch_scc1 L_role_tw_abort
    s_waitcnt vmcnt(0)
    v_cmp_gt_u32 vcc, 123, v6
    s_nop 0
    s_cbranch_vccz LtwX_ini_d
    s_sleep 8
    s_branch LtwX_ini
LtwX_ini_d:
    s_barrier
LtwX_idle:
    s_cmp_lg_u32 s14, 0
    s_cbranch_scc1 LtwX_nw0
    s_mul_i32 s60, s32, 22528
    s_add_u32 s60, s60, 184448
    s_cmp_lt_u32 s32, 64
    s_cselect_b32 s60, s60, 3080192
    s_mul_i32 s61, s33, 22528
    s_add_u32 s61, s61, 1626240
    s_cmp_lt_u32 s33, 64
    s_cselect_b32 s61, s61, 3080192
    s_mov_b32 s16, 0
LtwX_p_1:
    buffer_load_dword v2, v1, s[8:11], s60 offen sc1
    buffer_load_dword v15, v1, s[8:11], s61 offen sc1
    s_add_u32 s16, s16, 1
    s_cmp_gt_u32 s16, 100000
    s_cbranch_scc1 L_role_tw_abort
    s_waitcnt vmcnt(1)
    v_cmp_eq_u32 vcc, 0, v2
    s_waitcnt vmcnt(0)
    v_cmp_eq_u32 s[54:55], 0, v15
    s_nop 0
    s_cmp_eq_u64 s[54:55], 0
    s_cselect_b32 s62, 2, 0
    s_cmp_eq_u64 vcc, 0
    s_cselect_b32 s62, 1, s62
    s_cmp_lg_u32 s62, 0
    s_cbranch_scc1 LtwX_p_1d
    s_sleep 4
    s_branch LtwX_p_1
LtwX_p_1d:
    v_mov_b32 v5, s62
    ds_write_b32 v49, v5
    s_waitcnt lgkmcnt(0)
LtwX_nw0:
    s_barrier
    ds_read_b32 v6, v49
    v_xor_b32 v49, 4, v49
    s_waitcnt lgkmcnt(0)
    v_readfirstlane_b32 s62, v6
    s_nop 0
    s_cmp_eq_u32 s62, 0
    s_cbranch_scc1 L_role_tw_abort
    s_cmp_lt_u32 s33, 33
    s_cselect_b32 s38, 1, 3
    s_cmp_eq_u32 s62, 2
    s_cselect_b32 s36, 1, 0
    s_cselect_b32 s37, s33, s32
    s_cselect_b32 s17, s38, 0
    s_add_u32 s33, s33, s17
    s_cmp_eq_u32 s62, 1
    s_cselect_b32 s17, 2, 0
    s_add_u32 s32, s32, s17
    s_lshl_b32 s56, s36, 6
    s_add_u32 s56, s56, s37
    s_lshl_b32 s46, s56, 18
    s_add_u32 s46, s46, s58
    s_mul_i32 s41, s36, 4718592
    s_mul_i32 s17, s37, 36864
    s_add_u32 s41, s41, s17
    s_add_u32 s41, s41, 8650752
    s_cmp_ge_u32 s37, 64
    s_cbranch_scc1 L_role_tw_abort
    buffer_load_dword v10, v51, s[8:11], s46 offen
    s_add_u32 s48, s46, 0
    buffer_load_dwordx4 v[64:67], v0, s[8:11], s48 offen offset:0
    buffer_load_dwordx4 v[68:71], v0, s[8:11], s48 offen offset:1024
    buffer_load_dwordx4 v[72:75], v0, s[8:11], s48 offen offset:2048
    buffer_load_dwordx4 v[76:79], v0, s[8:11], s48 offen offset:3072
    s_add_u32 s48, s46, 4096
    buffer_load_dwordx4 v[80:83], v0, s[8:11], s48 offen offset:0
    buffer_load_dwordx4 v[84:87], v0, s[8:11], s48 offen offset:1024
    buffer_load_dwordx4 v[88:91], v0, s[8:11], s48 offen offset:2048
    buffer_load_dwordx4 v[92:95], v0, s[8:11], s48 offen offset:3072
    s_add_u32 s48, s46, 8192
    buffer_load_dwordx4 v[96:99], v0, s[8:11], s48 offen offset:0
    buffer_load_dwordx4 v[100:103], v0, s[8:11], s48 offen offset:1024
    buffer_load_dwordx4 v[104:107], v0, s[8:11], s48 offen offset:2048
    buffer_load_dwordx4 v[108:111], v0, s[8:11], s48 offen offset:3072
    s_add_u32 s48, s46, 12288
    buffer_load_dwordx4 v[112:115], v0, s[8:11], s48 offen offset:0
    buffer_load_dwordx4 v[116:119], v0, s[8:11], s48 offen offset:1024
    buffer_load_dwordx4 v[120:123], v0, s[8:11], s48 offen offset:2048
    buffer_load_dwordx4 v[40:43], v12, s[8:11], s41 offen
LtwX_item:
    s_mov_b32 s34, s36
    s_mov_b32 s35, s37
    s_mov_b32 s47, s41
    buffer_load_dwordx4 v[124:127], v0, s[8:11], s48 offen offset:3072
    s_waitcnt vmcnt(16)
    v_mfma_f32_16x16x32_bf16 v[16:19], a[0:3], v[64:67], 0
    v_mfma_f32_16x16x32_bf16 v[20:23], a[4:7], v[64:67], 0
    v_mfma_f32_16x16x32_bf16 v[24:27], v[128:131], v[64:67], 0
    s_add_u32 s48, s46, 16384
    buffer_load_dwordx4 v[64:67], v0, s[8:11], s48 offen offset:0
    s_waitcnt vmcnt(16)
    v_mfma_f32_16x16x32_bf16 v[28:31], a[0:3], v[68:71], 0
    v_mfma_f32_16x16x32_bf16 v[32:35], a[4:7], v[68:71], 0
    v_mfma_f32_16x16x32_bf16 v[36:39], v[128:131], v[68:71], 0
    buffer_load_dwordx4 v[68:71], v0, s[8:11], s48 offen offset:1024
    s_waitcnt vmcnt(16)
    v_mfma_f32_16x16x32_bf16 v[16:19], a[8:11], v[72:75], v[16:19]
    v_mfma_f32_16x16x32_bf16 v[20:23], a[12:15], v[72:75], v[20:23]
    v_mfma_f32_16x16x32_bf16 v[24:27], v[132:135], v[72:75], v[24:27]
    buffer_load_dwordx4 v[72:75], v0, s[8:11], s48 offen offset:2048
    s_waitcnt vmcnt(16)
    v_mfma_f32_16x16x32_bf16 v[28:31], a[8:11], v[76:79], v[28:31]
    v_mfma_f32_16x16x32_bf16 v[32:35], a[12:15], v[76:79], v[32:35]
    v_mfma_f32_16x16x32_bf16 v[36:39], v[132:135], v[76:79], v[36:39]
    buffer_load_dwordx4 v[76:79], v0, s[8:11], s48 offen offset:3072
    s_waitcnt vmcnt(16)
    v_mfma_f32_16x16x32_bf16 v[16:19], a[16:19], v[80:83], v[16:19]
    v_mfma_f32_16x16x32_bf16 v[20:23], a[20:23], v[80:83], v[20:23]
    v_mfma_f32_16x16x32_bf16 v[24:27], v[136:139], v[80:83], v[24:27]
    s_add_u32 s48, s46, 20480
    buffer_load_dwordx4 v[80:83], v0, s[8:11], s48 offen offset:0
    s_waitcnt vmcnt(16)
    v_mfma_f32_16x16x32_bf16 v[28:31], a[16:19], v[84:87], v[28:31]
    v_mfma_f32_16x16x32_bf16 v[32:35], a[20:23], v[84:87], v[32:35]
    v_mfma_f32_16x16x32_bf16 v[36:39], v[136:139], v[84:87], v[36:39]
    buffer_load_dwordx4 v[84:87], v0, s[8:11], s48 offen offset:1024
    s_waitcnt vmcnt(16)
    v_mfma_f32_16x16x32_bf16 v[16:19], a[24:27], v[88:91], v[16:19]
    v_mfma_f32_16x16x32_bf16 v[20:23], a[28:31], v[88:91], v[20:23]
    v_mfma_f32_16x16x32_bf16 v[24:27], v[140:143], v[88:91], v[24:27]
    buffer_load_dwordx4 v[88:91], v0, s[8:11], s48 offen offset:2048
    s_waitcnt vmcnt(16)
    v_mfma_f32_16x16x32_bf16 v[28:31], a[24:27], v[92:95], v[28:31]
    v_mfma_f32_16x16x32_bf16 v[32:35], a[28:31], v[92:95], v[32:35]
    v_mfma_f32_16x16x32_bf16 v[36:39], v[140:143], v[92:95], v[36:39]
    buffer_load_dwordx4 v[92:95], v0, s[8:11], s48 offen offset:3072
    s_waitcnt vmcnt(16)
    v_mfma_f32_16x16x32_bf16 v[16:19], a[32:35], v[96:99], v[16:19]
    v_mfma_f32_16x16x32_bf16 v[20:23], a[36:39], v[96:99], v[20:23]
    v_mfma_f32_16x16x32_bf16 v[24:27], v[144:147], v[96:99], v[24:27]
    s_add_u32 s48, s46, 24576
    buffer_load_dwordx4 v[96:99], v0, s[8:11], s48 offen offset:0
    s_waitcnt vmcnt(16)
    v_mfma_f32_16x16x32_bf16 v[28:31], a[32:35], v[100:103], v[28:31]
    v_mfma_f32_16x16x32_bf16 v[32:35], a[36:39], v[100:103], v[32:35]
    v_mfma_f32_16x16x32_bf16 v[36:39], v[144:147], v[100:103], v[36:39]
    buffer_load_dwordx4 v[100:103], v0, s[8:11], s48 offen offset:1024
    s_waitcnt vmcnt(16)
    v_mfma_f32_16x16x32_bf16 v[16:19], a[40:43], v[104:107], v[16:19]
    v_mfma_f32_16x16x32_bf16 v[20:23], a[44:47], v[104:107], v[20:23]
    v_mfma_f32_16x16x32_bf16 v[24:27], v[148:151], v[104:107], v[24:27]
    buffer_load_dwordx4 v[104:107], v0, s[8:11], s48 offen offset:2048
    s_waitcnt vmcnt(16)
    v_mfma_f32_16x16x32_bf16 v[28:31], a[40:43], v[108:111], v[28:31]
    v_mfma_f32_16x16x32_bf16 v[32:35], a[44:47], v[108:111], v[32:35]
    v_mfma_f32_16x16x32_bf16 v[36:39], v[148:151], v[108:111], v[36:39]
    buffer_load_dwordx4 v[108:111], v0, s[8:11], s48 offen offset:3072
    s_waitcnt vmcnt(16)
    v_mfma_f32_16x16x32_bf16 v[16:19], a[48:51], v[112:115], v[16:19]
    v_mfma_f32_16x16x32_bf16 v[20:23], a[52:55], v[112:115], v[20:23]
    v_mfma_f32_16x16x32_bf16 v[24:27], v[152:155], v[112:115], v[24:27]
    s_add_u32 s48, s46, 28672
    buffer_load_dwordx4 v[112:115], v0, s[8:11], s48 offen offset:0
    s_waitcnt vmcnt(16)
    v_mfma_f32_16x16x32_bf16 v[28:31], a[48:51], v[116:119], v[28:31]
    v_mfma_f32_16x16x32_bf16 v[32:35], a[52:55], v[116:119], v[32:35]
    v_mfma_f32_16x16x32_bf16 v[36:39], v[152:155], v[116:119], v[36:39]
    buffer_load_dwordx4 v[116:119], v0, s[8:11], s48 offen offset:1024
    s_waitcnt vmcnt(16)
    v_mfma_f32_16x16x32_bf16 v[16:19], a[56:59], v[120:123], v[16:19]
    v_mfma_f32_16x16x32_bf16 v[20:23], a[60:63], v[120:123], v[20:23]
    v_mfma_f32_16x16x32_bf16 v[24:27], v[156:159], v[120:123], v[24:27]
    buffer_load_dwordx4 v[120:123], v0, s[8:11], s48 offen offset:2048
    s_waitcnt vmcnt(15)
    v_mfma_f32_16x16x32_bf16 v[28:31], a[56:59], v[124:127], v[28:31]
    v_mfma_f32_16x16x32_bf16 v[32:35], a[60:63], v[124:127], v[32:35]
    v_mfma_f32_16x16x32_bf16 v[36:39], v[156:159], v[124:127], v[36:39]
    buffer_load_dwordx4 v[124:127], v0, s[8:11], s48 offen offset:3072
    s_waitcnt vmcnt(15)
    v_mfma_f32_16x16x32_bf16 v[16:19], a[64:67], v[64:67], v[16:19]
    v_mfma_f32_16x16x32_bf16 v[20:23], a[68:71], v[64:67], v[20:23]
    v_mfma_f32_16x16x32_bf16 v[24:27], v[160:163], v[64:67], v[24:27]
    s_add_u32 s48, s46, 32768
    buffer_load_dwordx4 v[64:67], v0, s[8:11], s48 offen offset:0
    s_waitcnt vmcnt(15)
    v_mfma_f32_16x16x32_bf16 v[28:31], a[64:67], v[68:71], v[28:31]
    v_mfma_f32_16x16x32_bf16 v[32:35], a[68:71], v[68:71], v[32:35]
    v_mfma_f32_16x16x32_bf16 v[36:39], v[160:163], v[68:71], v[36:39]
    s_cmp_lg_u32 s43, 0
    s_cselect_b64 exec, 1, 0
    buffer_store_dword v3, v4, s[8:11], s43 offen sc1
    s_mov_b64 exec, -1
    s_mov_b32 s43, 0
    buffer_load_dwordx4 v[68:71], v0, s[8:11], s48 offen offset:1024
    s_waitcnt vmcnt(16)
    v_mfma_f32_16x16x32_bf16 v[16:19], a[72:75], v[72:75], v[16:19]
    v_mfma_f32_16x16x32_bf16 v[20:23], a[76:79], v[72:75], v[20:23]
    v_mfma_f32_16x16x32_bf16 v[24:27], v[164:167], v[72:75], v[24:27]
    buffer_load_dwordx4 v[72:75], v0, s[8:11], s48 offen offset:2048
    s_waitcnt vmcnt(16)
    v_mfma_f32_16x16x32_bf16 v[28:31], a[72:75], v[76:79], v[28:31]
    v_mfma_f32_16x16x32_bf16 v[32:35], a[76:79], v[76:79], v[32:35]
    v_mfma_f32_16x16x32_bf16 v[36:39], v[164:167], v[76:79], v[36:39]
    buffer_load_dwordx4 v[76:79], v0, s[8:11], s48 offen offset:3072
    s_waitcnt vmcnt(16)
    v_mfma_f32_16x16x32_bf16 v[16:19], a[80:83], v[80:83], v[16:19]
    v_mfma_f32_16x16x32_bf16 v[20:23], a[84:87], v[80:83], v[20:23]
    v_mfma_f32_16x16x32_bf16 v[24:27], v[168:171], v[80:83], v[24:27]
    s_add_u32 s48, s46, 36864
    buffer_load_dwordx4 v[80:83], v0, s[8:11], s48 offen offset:0
    s_waitcnt vmcnt(16)
    v_mfma_f32_16x16x32_bf16 v[28:31], a[80:83], v[84:87], v[28:31]
    v_mfma_f32_16x16x32_bf16 v[32:35], a[84:87], v[84:87], v[32:35]
    v_mfma_f32_16x16x32_bf16 v[36:39], v[168:171], v[84:87], v[36:39]
    buffer_load_dwordx4 v[84:87], v0, s[8:11], s48 offen offset:1024
    s_waitcnt vmcnt(16)
    v_mfma_f32_16x16x32_bf16 v[16:19], a[88:91], v[88:91], v[16:19]
    v_mfma_f32_16x16x32_bf16 v[20:23], a[92:95], v[88:91], v[20:23]
    v_mfma_f32_16x16x32_bf16 v[24:27], v[172:175], v[88:91], v[24:27]
    buffer_load_dwordx4 v[88:91], v0, s[8:11], s48 offen offset:2048
    s_waitcnt vmcnt(16)
    v_mfma_f32_16x16x32_bf16 v[28:31], a[88:91], v[92:95], v[28:31]
    v_mfma_f32_16x16x32_bf16 v[32:35], a[92:95], v[92:95], v[32:35]
    v_mfma_f32_16x16x32_bf16 v[36:39], v[172:175], v[92:95], v[36:39]
    buffer_load_dwordx4 v[92:95], v0, s[8:11], s48 offen offset:3072
    s_waitcnt vmcnt(16)
    v_mfma_f32_16x16x32_bf16 v[16:19], a[96:99], v[96:99], v[16:19]
    v_mfma_f32_16x16x32_bf16 v[20:23], a[100:103], v[96:99], v[20:23]
    v_mfma_f32_16x16x32_bf16 v[24:27], v[176:179], v[96:99], v[24:27]
    s_add_u32 s48, s46, 40960
    buffer_load_dwordx4 v[96:99], v0, s[8:11], s48 offen offset:0
    s_waitcnt vmcnt(16)
    v_mfma_f32_16x16x32_bf16 v[28:31], a[96:99], v[100:103], v[28:31]
    v_mfma_f32_16x16x32_bf16 v[32:35], a[100:103], v[100:103], v[32:35]
    v_mfma_f32_16x16x32_bf16 v[36:39], v[176:179], v[100:103], v[36:39]
    buffer_load_dwordx4 v[100:103], v0, s[8:11], s48 offen offset:1024
    s_waitcnt vmcnt(16)
    v_mfma_f32_16x16x32_bf16 v[16:19], a[104:107], v[104:107], v[16:19]
    v_mfma_f32_16x16x32_bf16 v[20:23], a[108:111], v[104:107], v[20:23]
    v_mfma_f32_16x16x32_bf16 v[24:27], v[180:183], v[104:107], v[24:27]
    s_cmp_lg_u32 s14, 0
    s_cbranch_scc1 LtwX_nw1
    s_mul_i32 s60, s32, 22528
    s_add_u32 s60, s60, 184448
    s_cmp_lt_u32 s32, 64
    s_cselect_b32 s60, s60, 3080192
    s_mul_i32 s61, s33, 22528
    s_add_u32 s61, s61, 1626240
    s_cmp_lt_u32 s33, 64
    s_cselect_b32 s61, s61, 3080192
    buffer_load_dword v2, v1, s[8:11], s60 offen sc1
    buffer_load_dword v15, v1, s[8:11], s61 offen sc1
LtwX_nw1:
    buffer_load_dwordx4 v[104:107], v0, s[8:11], s48 offen offset:2048
    s_waitcnt vmcnt(16)
    v_mfma_f32_16x16x32_bf16 v[28:31], a[104:107], v[108:111], v[28:31]
    v_mfma_f32_16x16x32_bf16 v[32:35], a[108:111], v[108:111], v[32:35]
    v_mfma_f32_16x16x32_bf16 v[36:39], v[180:183], v[108:111], v[36:39]
    buffer_load_dwordx4 v[108:111], v0, s[8:11], s48 offen offset:3072
    s_waitcnt vmcnt(16)
    v_mfma_f32_16x16x32_bf16 v[16:19], a[112:115], v[112:115], v[16:19]
    v_mfma_f32_16x16x32_bf16 v[20:23], a[116:119], v[112:115], v[20:23]
    v_mfma_f32_16x16x32_bf16 v[24:27], v[184:187], v[112:115], v[24:27]
    s_add_u32 s48, s46, 45056
    buffer_load_dwordx4 v[112:115], v0, s[8:11], s48 offen offset:0
    s_waitcnt vmcnt(16)
    v_mfma_f32_16x16x32_bf16 v[28:31], a[112:115], v[116:119], v[28:31]
    v_mfma_f32_16x16x32_bf16 v[32:35], a[116:119], v[116:119], v[32:35]
    v_mfma_f32_16x16x32_bf16 v[36:39], v[184:187], v[116:119], v[36:39]
    buffer_load_dwordx4 v[116:119], v0, s[8:11], s48 offen offset:1024
    s_waitcnt vmcnt(16)
    v_mfma_f32_16x16x32_bf16 v[16:19], a[120:123], v[120:123], v[16:19]
    v_mfma_f32_16x16x32_bf16 v[20:23], a[124:127], v[120:123], v[20:23]
    v_mfma_f32_16x16x32_bf16 v[24:27], v[188:191], v[120:123], v[24:27]
    buffer_load_dwordx4 v[120:123], v0, s[8:11], s48 offen offset:2048
    s_waitcnt vmcnt(16)
    v_mfma_f32_16x16x32_bf16 v[28:31], a[120:123], v[124:127], v[28:31]
    v_mfma_f32_16x16x32_bf16 v[32:35], a[124:127], v[124:127], v[32:35]
    v_mfma_f32_16x16x32_bf16 v[36:39], v[188:191], v[124:127], v[36:39]
    buffer_load_dwordx4 v[124:127], v0, s[8:11], s48 offen offset:3072
    s_waitcnt vmcnt(16)
    v_mfma_f32_16x16x32_bf16 v[16:19], a[128:131], v[64:67], v[16:19]
    v_mfma_f32_16x16x32_bf16 v[20:23], a[132:135], v[64:67], v[20:23]
    v_mfma_f32_16x16x32_bf16 v[24:27], v[192:195], v[64:67], v[24:27]
    s_add_u32 s48, s46, 49152
    buffer_load_dwordx4 v[64:67], v0, s[8:11], s48 offen offset:0
    s_waitcnt vmcnt(15)
    v_mfma_f32_16x16x32_bf16 v[28:31], a[128:131], v[68:71], v[28:31]
    v_mfma_f32_16x16x32_bf16 v[32:35], a[132:135], v[68:71], v[32:35]
    v_mfma_f32_16x16x32_bf16 v[36:39], v[192:195], v[68:71], v[36:39]
    buffer_load_dwordx4 v[68:71], v0, s[8:11], s48 offen offset:1024
    s_waitcnt vmcnt(15)
    v_mfma_f32_16x16x32_bf16 v[16:19], a[136:139], v[72:75], v[16:19]
    v_mfma_f32_16x16x32_bf16 v[20:23], a[140:143], v[72:75], v[20:23]
    v_mfma_f32_16x16x32_bf16 v[24:27], v[196:199], v[72:75], v[24:27]
    buffer_load_dwordx4 v[72:75], v0, s[8:11], s48 offen offset:2048
    s_waitcnt vmcnt(15)
    v_mfma_f32_16x16x32_bf16 v[28:31], a[136:139], v[76:79], v[28:31]
    v_mfma_f32_16x16x32_bf16 v[32:35], a[140:143], v[76:79], v[32:35]
    v_mfma_f32_16x16x32_bf16 v[36:39], v[196:199], v[76:79], v[36:39]
    buffer_load_dwordx4 v[76:79], v0, s[8:11], s48 offen offset:3072
    s_waitcnt vmcnt(15)
    v_mfma_f32_16x16x32_bf16 v[16:19], a[144:147], v[80:83], v[16:19]
    v_mfma_f32_16x16x32_bf16 v[20:23], a[148:151], v[80:83], v[20:23]
    v_mfma_f32_16x16x32_bf16 v[24:27], v[200:203], v[80:83], v[24:27]
    s_add_u32 s48, s46, 53248
    buffer_load_dwordx4 v[80:83], v0, s[8:11], s48 offen offset:0
    s_waitcnt vmcnt(15)
    v_mfma_f32_16x16x32_bf16 v[28:31], a[144:147], v[84:87], v[28:31]
    v_mfma_f32_16x16x32_bf16 v[32:35], a[148:151], v[84:87], v[32:35]
    v_mfma_f32_16x16x32_bf16 v[36:39], v[200:203], v[84:87], v[36:39]
    buffer_load_dwordx4 v[84:87], v0, s[8:11], s48 offen offset:1024
    s_waitcnt vmcnt(15)
    v_mfma_f32_16x16x32_bf16 v[16:19], a[152:155], v[88:91], v[16:19]
    v_mfma_f32_16x16x32_bf16 v[20:23], a[156:159], v[88:91], v[20:23]
    v_mfma_f32_16x16x32_bf16 v[24:27], v[204:207], v[88:91], v[24:27]
    buffer_load_dwordx4 v[88:91], v0, s[8:11], s48 offen offset:2048
    s_waitcnt vmcnt(15)
    v_mfma_f32_16x16x32_bf16 v[28:31], a[152:155], v[92:95], v[28:31]
    v_mfma_f32_16x16x32_bf16 v[32:35], a[156:159], v[92:95], v[32:35]
    v_mfma_f32_16x16x32_bf16 v[36:39], v[204:207], v[92:95], v[36:39]
    buffer_load_dwordx4 v[92:95], v0, s[8:11], s48 offen offset:3072
    s_waitcnt vmcnt(15)
    v_mfma_f32_16x16x32_bf16 v[16:19], a[160:163], v[96:99], v[16:19]
    v_mfma_f32_16x16x32_bf16 v[20:23], a[164:167], v[96:99], v[20:23]
    v_mfma_f32_16x16x32_bf16 v[24:27], v[208:211], v[96:99], v[24:27]
    s_add_u32 s48, s46, 57344
    buffer_load_dwordx4 v[96:99], v0, s[8:11], s48 offen offset:0
    s_waitcnt vmcnt(15)
    v_mfma_f32_16x16x32_bf16 v[28:31], a[160:163], v[100:103], v[28:31]
    v_mfma_f32_16x16x32_bf16 v[32:35], a[164:167], v[100:103], v[32:35]
    v_mfma_f32_16x16x32_bf16 v[36:39], v[208:211], v[100:103], v[36:39]
    buffer_load_dwordx4 v[100:103], v0, s[8:11], s48 offen offset:1024
    s_waitcnt vmcnt(15)
    v_mfma_f32_16x16x32_bf16 v[16:19], a[168:171], v[104:107], v[16:19]
    v_mfma_f32_16x16x32_bf16 v[20:23], a[172:175], v[104:107], v[20:23]
    v_mfma_f32_16x16x32_bf16 v[24:27], v[212:215], v[104:107], v[24:27]
    buffer_load_dwordx4 v[104:107], v0, s[8:11], s48 offen offset:2048
    s_waitcnt vmcnt(15)
    v_mfma_f32_16x16x32_bf16 v[28:31], a[168:171], v[108:111], v[28:31]
    v_mfma_f32_16x16x32_bf16 v[32:35], a[172:175], v[108:111], v[32:35]
    v_mfma_f32_16x16x32_bf16 v[36:39], v[212:215], v[108:111], v[36:39]
    buffer_load_dwordx4 v[108:111], v0, s[8:11], s48 offen offset:3072
    s_waitcnt vmcnt(15)
    v_mfma_f32_16x16x32_bf16 v[16:19], a[176:179], v[112:115], v[16:19]
    v_mfma_f32_16x16x32_bf16 v[20:23], a[180:183], v[112:115], v[20:23]
    v_mfma_f32_16x16x32_bf16 v[24:27], v[216:219], v[112:115], v[24:27]
    s_cmp_lg_u32 s14, 0
    s_cbranch_scc1 LtwX_nw2
    v_cmp_eq_u32 vcc, 0, v2
    v_cmp_eq_u32 s[54:55], 0, v15
    s_nop 0
    s_cmp_eq_u64 s[54:55], 0
    s_cselect_b32 s62, 2, 0
    s_cmp_eq_u64 vcc, 0
    s_cselect_b32 s62, 1, s62
    v_mov_b32 v5, s62
    ds_write_b32 v49, v5
    s_waitcnt lgkmcnt(0)
LtwX_nw2:
    s_barrier
    ds_read_b32 v6, v49
    v_xor_b32 v49, 4, v49
    s_add_u32 s48, s46, 61440
    buffer_load_dwordx4 v[112:115], v0, s[8:11], s48 offen offset:0
    s_waitcnt vmcnt(15)
    v_mfma_f32_16x16x32_bf16 v[28:31], a[176:179], v[116:119], v[28:31]
    v_mfma_f32_16x16x32_bf16 v[32:35], a[180:183], v[116:119], v[32:35]
    v_mfma_f32_16x16x32_bf16 v[36:39], v[216:219], v[116:119], v[36:39]
    buffer_load_dwordx4 v[116:119], v0, s[8:11], s48 offen offset:1024
    s_waitcnt vmcnt(15)
    v_mfma_f32_16x16x32_bf16 v[16:19], a[184:187], v[120:123], v[16:19]
    v_mfma_f32_16x16x32_bf16 v[20:23], a[188:191], v[120:123], v[20:23]
    v_mfma_f32_16x16x32_bf16 v[24:27], v[220:223], v[120:123], v[24:27]
    buffer_load_dwordx4 v[120:123], v0, s[8:11], s48 offen offset:2048
    s_waitcnt vmcnt(15)
    v_mfma_f32_16x16x32_bf16 v[28:31], a[184:187], v[124:127], v[28:31]
    v_mfma_f32_16x16x32_bf16 v[32:35], a[188:191], v[124:127], v[32:35]
    v_mfma_f32_16x16x32_bf16 v[36:39], v[220:223], v[124:127], v[36:39]
    s_waitcnt lgkmcnt(0)
    v_readfirstlane_b32 s62, v6
    s_cmp_lt_u32 s33, 33
    s_cselect_b32 s38, 1, 3
    s_cmp_eq_u32 s62, 2
    s_cselect_b32 s36, 1, 0
    s_cselect_b32 s37, s33, s32
    s_cselect_b32 s17, s38, 0
    s_add_u32 s33, s33, s17
    s_cmp_eq_u32 s62, 1
    s_cselect_b32 s17, 2, 0
    s_add_u32 s32, s32, s17
    s_lshl_b32 s56, s36, 6
    s_add_u32 s56, s56, s37
    buffer_load_dwordx4 v[124:127], v0, s[8:11], s48 offen offset:3072
    s_waitcnt vmcnt(15)
    v_mfma_f32_16x16x32_bf16 v[16:19], a[192:195], v[64:67], v[16:19]
    v_mfma_f32_16x16x32_bf16 v[20:23], a[196:199], v[64:67], v[20:23]
    v_mfma_f32_16x16x32_bf16 v[24:27], v[224:227], v[64:67], v[24:27]
    s_cmp_lt_u32 s37, 64
    s_cselect_b32 s62, s62, 0
    s_lshl_b32 s46, s56, 18
    s_add_u32 s46, s46, s58
    s_mul_i32 s41, s36, 4718592
    s_mul_i32 s17, s37, 36864
    s_add_u32 s41, s41, s17
    s_add_u32 s41, s41, 8650752
    s_cmp_lg_u32 s62, 0
    s_cselect_b32 s30, 268435456, 0
    buffer_load_dword v10, v51, s[28:31], s46 offen
    s_add_u32 s48, s46, 0
    buffer_load_dwordx4 v[64:67], v0, s[28:31], s48 offen offset:0
    s_waitcnt vmcnt(15)
    v_mfma_f32_16x16x32_bf16 v[28:31], a[192:195], v[68:71], v[28:31]
    v_mfma_f32_16x16x32_bf16 v[32:35], a[196:199], v[68:71], v[32:35]
    v_mfma_f32_16x16x32_bf16 v[36:39], v[224:227], v[68:71], v[36:39]
    buffer_load_dwordx4 v[68:71], v0, s[28:31], s48 offen offset:1024
    s_waitcnt vmcnt(15)
    v_mfma_f32_16x16x32_bf16 v[16:19], a[200:203], v[72:75], v[16:19]
    v_mfma_f32_16x16x32_bf16 v[20:23], a[204:207], v[72:75], v[20:23]
    v_mfma_f32_16x16x32_bf16 v[24:27], v[228:231], v[72:75], v[24:27]
    buffer_load_dwordx4 v[72:75], v0, s[28:31], s48 offen offset:2048
    s_waitcnt vmcnt(15)
    v_mfma_f32_16x16x32_bf16 v[28:31], a[200:203], v[76:79], v[28:31]
    v_mfma_f32_16x16x32_bf16 v[32:35], a[204:207], v[76:79], v[32:35]
    v_mfma_f32_16x16x32_bf16 v[36:39], v[228:231], v[76:79], v[36:39]
    buffer_load_dwordx4 v[76:79], v0, s[28:31], s48 offen offset:3072
    s_waitcnt vmcnt(15)
    v_mfma_f32_16x16x32_bf16 v[16:19], a[208:211], v[80:83], v[16:19]
    v_mfma_f32_16x16x32_bf16 v[20:23], a[212:215], v[80:83], v[20:23]
    v_mfma_f32_16x16x32_bf16 v[24:27], v[232:235], v[80:83], v[24:27]
    s_add_u32 s48, s46, 4096
    buffer_load_dwordx4 v[80:83], v0, s[28:31], s48 offen offset:0
    s_waitcnt vmcnt(15)
    v_mfma_f32_16x16x32_bf16 v[28:31], a[208:211], v[84:87], v[28:31]
    v_mfma_f32_16x16x32_bf16 v[32:35], a[212:215], v[84:87], v[32:35]
    v_mfma_f32_16x16x32_bf16 v[36:39], v[232:235], v[84:87], v[36:39]
    buffer_load_dwordx4 v[84:87], v0, s[28:31], s48 offen offset:1024
    s_waitcnt vmcnt(15)
    v_mfma_f32_16x16x32_bf16 v[16:19], a[216:219], v[88:91], v[16:19]
    v_mfma_f32_16x16x32_bf16 v[20:23], a[220:223], v[88:91], v[20:23]
    v_mfma_f32_16x16x32_bf16 v[24:27], v[236:239], v[88:91], v[24:27]
    buffer_load_dwordx4 v[88:91], v0, s[28:31], s48 offen offset:2048
    s_waitcnt vmcnt(15)
    v_mfma_f32_16x16x32_bf16 v[28:31], a[216:219], v[92:95], v[28:31]
    v_mfma_f32_16x16x32_bf16 v[32:35], a[220:223], v[92:95], v[32:35]
    v_mfma_f32_16x16x32_bf16 v[36:39], v[236:239], v[92:95], v[36:39]
    buffer_load_dwordx4 v[92:95], v0, s[28:31], s48 offen offset:3072
    s_waitcnt vmcnt(15)
    v_mfma_f32_16x16x32_bf16 v[16:19], a[224:227], v[96:99], v[16:19]
    v_mfma_f32_16x16x32_bf16 v[20:23], a[228:231], v[96:99], v[20:23]
    v_mfma_f32_16x16x32_bf16 v[24:27], v[240:243], v[96:99], v[24:27]
    s_add_u32 s48, s46, 8192
    buffer_load_dwordx4 v[96:99], v0, s[28:31], s48 offen offset:0
    s_waitcnt vmcnt(15)
    v_mfma_f32_16x16x32_bf16 v[28:31], a[224:227], v[100:103], v[28:31]
    v_mfma_f32_16x16x32_bf16 v[32:35], a[228:231], v[100:103], v[32:35]
    v_mfma_f32_16x16x32_bf16 v[36:39], v[240:243], v[100:103], v[36:39]
    buffer_load_dwordx4 v[100:103], v0, s[28:31], s48 offen offset:1024
    s_waitcnt vmcnt(15)
    v_mfma_f32_16x16x32_bf16 v[16:19], a[232:235], v[104:107], v[16:19]
    v_mfma_f32_16x16x32_bf16 v[20:23], a[236:239], v[104:107], v[20:23]
    v_mfma_f32_16x16x32_bf16 v[24:27], v[244:247], v[104:107], v[24:27]
    buffer_load_dwordx4 v[104:107], v0, s[28:31], s48 offen offset:2048
    s_waitcnt vmcnt(15)
    v_mfma_f32_16x16x32_bf16 v[28:31], a[232:235], v[108:111], v[28:31]
    v_mfma_f32_16x16x32_bf16 v[32:35], a[236:239], v[108:111], v[32:35]
    v_mfma_f32_16x16x32_bf16 v[36:39], v[244:247], v[108:111], v[36:39]
    buffer_load_dwordx4 v[108:111], v0, s[28:31], s48 offen offset:3072
    s_waitcnt vmcnt(15)
    v_mfma_f32_16x16x32_bf16 v[16:19], a[240:243], v[112:115], v[16:19]
    v_mfma_f32_16x16x32_bf16 v[20:23], a[244:247], v[112:115], v[20:23]
    v_mfma_f32_16x16x32_bf16 v[24:27], v[248:251], v[112:115], v[24:27]
    s_add_u32 s48, s46, 12288
    buffer_load_dwordx4 v[112:115], v0, s[28:31], s48 offen offset:0
    s_waitcnt vmcnt(15)
    v_mfma_f32_16x16x32_bf16 v[28:31], a[240:243], v[116:119], v[28:31]
    v_mfma_f32_16x16x32_bf16 v[32:35], a[244:247], v[116:119], v[32:35]
    v_mfma_f32_16x16x32_bf16 v[36:39], v[248:251], v[116:119], v[36:39]
    buffer_load_dwordx4 v[116:119], v0, s[28:31], s48 offen offset:1024
    s_waitcnt vmcnt(15)
    v_mfma_f32_16x16x32_bf16 v[16:19], a[248:251], v[120:123], v[16:19]
    v_mfma_f32_16x16x32_bf16 v[20:23], a[252:255], v[120:123], v[20:23]
    v_mfma_f32_16x16x32_bf16 v[24:27], v[252:255], v[120:123], v[24:27]
    buffer_load_dwordx4 v[120:123], v0, s[28:31], s48 offen offset:2048
    s_waitcnt vmcnt(15)
    v_mfma_f32_16x16x32_bf16 v[28:31], a[248:251], v[124:127], v[28:31]
    v_mfma_f32_16x16x32_bf16 v[32:35], a[252:255], v[124:127], v[32:35]
    v_mfma_f32_16x16x32_bf16 v[36:39], v[252:255], v[124:127], v[36:39]
    s_nop 5
    ds_write_b128 v48, v[16:19] offset:0
    ds_write_b128 v48, v[20:23] offset:1024
    ds_write_b128 v48, v[24:27] offset:2048
    ds_write_b128 v48, v[28:31] offset:3072
    ds_write_b128 v48, v[32:35] offset:4096
    ds_write_b128 v48, v[36:39] offset:5120
    s_waitcnt lgkmcnt(0)
    s_barrier
    ds_read_b128 v[24:27], v50 offset:0
    ds_read_b128 v[28:31], v50 offset:1024
    ds_read_b128 v[32:35], v50 offset:6144
    ds_read_b128 v[36:39], v50 offset:7168
    ds_read_b128 v[56:59], v50 offset:12288
    ds_read_b128 v[60:63], v50 offset:13312
    ds_read_b128 v[124:127], v50 offset:18432
    ds_read_b128 v[52:55], v50 offset:19456
    v_xor_b32 v48, 0x8000, v48
    v_xor_b32 v50, 0x8000, v50
    v_lshlrev_b32 v16, 16, v40
    v_and_b32 v20, 0xffff0000, v40
    v_lshlrev_b32 v17, 16, v41
    v_and_b32 v21, 0xffff0000, v41
    v_lshlrev_b32 v18, 16, v42
    v_and_b32 v22, 0xffff0000, v42
    v_lshlrev_b32 v19, 16, v43
    v_and_b32 v23, 0xffff0000, v43
    buffer_load_dwordx4 v[40:43], v12, s[28:31], s41 offen
    s_waitcnt lgkmcnt(7)
    v_add_f32 v16, v16, v24
    v_add_f32 v17, v17, v25
    v_add_f32 v18, v18, v26
    v_add_f32 v19, v19, v27
    s_waitcnt lgkmcnt(6)
    v_add_f32 v20, v20, v28
    v_add_f32 v21, v21, v29
    v_add_f32 v22, v22, v30
    v_add_f32 v23, v23, v31
    s_waitcnt lgkmcnt(5)
    v_add_f32 v16, v16, v32
    v_add_f32 v17, v17, v33
    v_add_f32 v18, v18, v34
    v_add_f32 v19, v19, v35
    s_waitcnt lgkmcnt(4)
    v_add_f32 v20, v20, v36
    v_add_f32 v21, v21, v37
    v_add_f32 v22, v22, v38
    v_add_f32 v23, v23, v39
    s_waitcnt lgkmcnt(3)
    v_add_f32 v16, v16, v56
    v_add_f32 v17, v17, v57
    v_add_f32 v18, v18, v58
    v_add_f32 v19, v19, v59
    s_waitcnt lgkmcnt(2)
    v_add_f32 v20, v20, v60
    v_add_f32 v21, v21, v61
    v_add_f32 v22, v22, v62
    v_add_f32 v23, v23, v63
    s_waitcnt lgkmcnt(1)
    v_add_f32 v16, v16, v124
    v_add_f32 v17, v17, v125
    v_add_f32 v18, v18, v126
    v_add_f32 v19, v19, v127
    s_waitcnt lgkmcnt(0)
    v_add_f32 v20, v20, v52
    v_add_f32 v21, v21, v53
    v_add_f32 v22, v22, v54
    v_add_f32 v23, v23, v55
    v_cvt_pk_bf16_f32 v52, v16, v20
    v_cvt_pk_bf16_f32 v53, v17, v21
    v_cvt_pk_bf16_f32 v54, v18, v22
    v_cvt_pk_bf16_f32 v55, v19, v23
    s_cmp_eq_u32 s34, 0
    s_cbranch_scc1 LtwX_l0
    s_mul_i32 s17, s35, 36864
    buffer_store_dwordx4 v[52:55], v13, s[24:27], s17 offen
    s_cmp_lg_u32 s62, 0
    s_cbranch_scc1 LtwX_item
LtwX_chk:
    s_min_u32 s17, s32, s33
    s_cmp_lt_u32 s17, 64
    s_cbranch_scc1 LtwX_idle
    s_branch L_role_tw_exit
LtwX_l0:
    s_add_u32 s47, s47, 2359296
    buffer_store_dwordx4 v[52:55], v12, s[8:11], s47 offen sc1
    v_add_f32 v44, v16, v17
    v_mul_f32 v45, v16, v16
    v_fmac_f32 v45, v17, v17
    v_add_f32 v44, v44, v18
    v_fmac_f32 v45, v18, v18
    v_add_f32 v44, v44, v19
    v_fmac_f32 v45, v19, v19
    v_add_f32 v44, v44, v20
    v_fmac_f32 v45, v20, v20
    v_add_f32 v44, v44, v21
    v_fmac_f32 v45, v21, v21
    v_add_f32 v44, v44, v22
    v_fmac_f32 v45, v22, v22
    v_add_f32 v44, v44, v23
    v_fmac_f32 v45, v23, v23
    v_mov_b32 v46, v44
    v_mov_b32 v47, v45
    s_nop 0
    v_permlane32_swap_b32 v44, v46
    v_permlane32_swap_b32 v45, v47
    v_add_f32 v44, v44, v46
    v_add_f32 v45, v45, v47
    v_mov_b32 v46, v44
    v_mov_b32 v47, v45
    s_nop 0
    v_permlane16_swap_b32 v44, v46
    v_permlane16_swap_b32 v45, v47
    v_add_f32 v44, v44, v46
    v_add_f32 v45, v45, v47
    s_mul_i32 s17, s35, 6144
    s_add_u32 s17, s17, 16515072
    s_mov_b64 exec, 0xffff
    buffer_store_dwordx2 v[44:45], v14, s[8:11], s17 offen sc1
    s_mov_b64 exec, -1
    s_mul_i32 s43, s35, 22528
    s_add_u32 s43, s43, s49
    s_cmp_lg_u32 s62, 0
    s_cbranch_scc1 LtwX_item
    s_cmp_lg_u32 s14, 0
    s_cbranch_scc1 LtwX_nw3
    s_mul_i32 s60, s32, 22528
    s_add_u32 s60, s60, 184448
    s_cmp_lt_u32 s32, 64
    s_cselect_b32 s60, s60, 3080192
    s_mul_i32 s61, s33, 22528
    s_add_u32 s61, s61, 1626240
    s_cmp_lt_u32 s33, 64
    s_cselect_b32 s61, s61, 3080192
    buffer_load_dword v2, v1, s[8:11], s60 offen sc1
    buffer_load_dword v15, v1, s[8:11], s61 offen sc1
LtwX_nw3:
    s_waitcnt vmcnt(0)
    s_mov_b64 exec, 1
    buffer_store_dword v3, v4, s[8:11], s43 offen sc1
    s_mov_b64 exec, -1
    s_mov_b32 s43, 0
    s_min_u32 s17, s32, s33
    s_cmp_lt_u32 s17, 64
    s_cbranch_scc0 LtwX_chk
    s_cmp_lg_u32 s14, 0
    s_cbranch_scc1 LtwX_nw0
    v_cmp_eq_u32 vcc, 0, v2
    v_cmp_eq_u32 s[54:55], 0, v15
    s_nop 0
    s_cmp_eq_u64 s[54:55], 0
    s_cselect_b32 s62, 2, 0
    s_cmp_eq_u64 vcc, 0
    s_cselect_b32 s62, 1, s62
    s_cmp_eq_u32 s62, 0
    s_cbranch_scc1 LtwX_idle
    v_mov_b32 v5, s62
    ds_write_b32 v49, v5
    s_waitcnt lgkmcnt(0)
    s_branch LtwX_nw0
Ltw_z:
    v_lshrrev_b32 v5, 1, v8
    v_lshl_add_u32 v12, v5, 9, v12
    v_and_b32 v5, 1, v8
    v_lshl_add_u32 v12, v5, 3, v12
    v_add_u32 v12, 2048, v12
    v_lshl_add_u32 v13, v8, 3, v13
    v_add_u32 v13, 64, v13
    v_add_u32 v14, 256, v14
    s_lshl_b32 s58, s14, 16
    s_add_u32 s58, s58, 144703488
    s_mov_b32 s43, 0
    s_mov_b32 s28, s8
    s_mov_b32 s29, s9
    s_mov_b32 s30, 0
    s_mov_b32 s31, 0x00020000
    s_mul_i32 s17, s51, 3072
    v_add_u32 v50, s17, v0
    ds_write2_b32 v49, v4, v4 offset0:0 offset1:1
    s_waitcnt lgkmcnt(0)
    s_cmp_lg_u32 s14, 0
    s_cbranch_scc1 LtwZ_ini_d
    v_mov_b32 v5, 160
    s_mov_b32 s16, 0
LtwZ_ini:
    global_load_dword v6, v5, s[12:13] sc1
    s_add_u32 s16, s16, 1
    s_cmp_gt_u32 s16, 100000
    s_cbranch_scc1 L_role_tw_abort
    s_waitcnt vmcnt(0)
    v_cmp_gt_u32 vcc, 123, v6
    s_nop 0
    s_cbranch_vccz LtwZ_ini_d
    s_sleep 8
    s_branch LtwZ_ini
LtwZ_ini_d:
    s_barrier
LtwZ_idle:
    s_barrier
    ds_read_b32 v6, v49
    v_xor_b32 v49, 4, v49
    s_waitcnt lgkmcnt(0)
    v_readfirstlane_b32 s62, v6
    s_nop 0
    s_cmp_eq_u32 s62, 0
    s_cbranch_scc1 L_role_tw_abort
    s_cmp_lt_u32 s33, 33
    s_cselect_b32 s38, 1, 3
    s_cmp_eq_u32 s62, 2
    s_cselect_b32 s36, 1, 0
    s_cselect_b32 s37, s33, s32
    s_cselect_b32 s17, s38, 0
    s_add_u32 s33, s33, s17
    s_cmp_eq_u32 s62, 1
    s_cselect_b32 s17, 2, 0
    s_add_u32 s32, s32, s17
    s_lshl_b32 s56, s36, 6
    s_add_u32 s56, s56, s37
    s_lshl_b32 s46, s56, 18
    s_add_u32 s46, s46, s58
    s_mul_i32 s41, s36, 4718592
    s_mul_i32 s17, s37, 36864
    s_add_u32 s41, s41, s17
    s_add_u32 s41, s41, 8650752
    s_cmp_ge_u32 s37, 64
    s_cbranch_scc1 L_role_tw_abort
    buffer_load_dword v10, v51, s[8:11], s46 offen
    s_add_u32 s48, s46, 0
    buffer_load_dwordx4 v[64:67], v0, s[8:11], s48 offen offset:0
    buffer_load_dwordx4 v[68:71], v0, s[8:11], s48 offen offset:1024
    buffer_load_dwordx4 v[72:75], v0, s[8:11], s48 offen offset:2048
    buffer_load_dwordx4 v[76:79], v0, s[8:11], s48 offen offset:3072
    s_add_u32 s48, s46, 4096
    buffer_load_dwordx4 v[80:83], v0, s[8:11], s48 offen offset:0
    buffer_load_dwordx4 v[84:87], v0, s[8:11], s48 offen offset:1024
    buffer_load_dwordx4 v[88:91], v0, s[8:11], s48 offen offset:2048
    buffer_load_dwordx4 v[92:95], v0, s[8:11], s48 offen offset:3072
    s_add_u32 s48, s46, 8192
    buffer_load_dwordx4 v[96:99], v0, s[8:11], s48 offen offset:0
    buffer_load_dwordx4 v[100:103], v0, s[8:11], s48 offen offset:1024
    buffer_load_dwordx4 v[104:107], v0, s[8:11], s48 offen offset:2048
    buffer_load_dwordx4 v[108:111], v0, s[8:11], s48 offen offset:3072
    s_add_u32 s48, s46, 12288
    buffer_load_dwordx4 v[112:115], v0, s[8:11], s48 offen offset:0
    buffer_load_dwordx4 v[116:119], v0, s[8:11], s48 offen offset:1024
    buffer_load_dwordx4 v[120:123], v0, s[8:11], s48 offen offset:2048
    buffer_load_dwordx2 v[40:41], v12, s[8:11], s41 offen
LtwZ_item:
    s_mov_b32 s34, s36
    s_mov_b32 s35, s37
    s_mov_b32 s47, s41
    buffer_load_dwordx4 v[124:127], v0, s[8:11], s48 offen offset:3072
    s_waitcnt vmcnt(16)
    v_mfma_f32_16x16x32_bf16 v[16:19], a[0:3], v[64:67], 0
    v_mfma_f32_16x16x32_bf16 v[20:23], a[4:7], v[64:67], 0
    v_mfma_f32_16x16x32_bf16 v[24:27], v[128:131], v[64:67], 0
    s_add_u32 s48, s46, 16384
    buffer_load_dwordx4 v[64:67], v0, s[8:11], s48 offen offset:0
    s_waitcnt vmcnt(16)
    v_mfma_f32_16x16x32_bf16 v[28:31], a[0:3], v[68:71], 0
    v_mfma_f32_16x16x32_bf16 v[32:35], a[4:7], v[68:71], 0
    v_mfma_f32_16x16x32_bf16 v[36:39], v[128:131], v[68:71], 0
    buffer_load_dwordx4 v[68:71], v0, s[8:11], s48 offen offset:1024
    s_waitcnt vmcnt(16)
    v_mfma_f32_16x16x32_bf16 v[16:19], a[8:11], v[72:75], v[16:19]
    v_mfma_f32_16x16x32_bf16 v[20:23], a[12:15], v[72:75], v[20:23]
    v_mfma_f32_16x16x32_bf16 v[24:27], v[132:135], v[72:75], v[24:27]
    buffer_load_dwordx4 v[72:75], v0, s[8:11], s48 offen offset:2048
    s_waitcnt vmcnt(16)
    v_mfma_f32_16x16x32_bf16 v[28:31], a[8:11], v[76:79], v[28:31]
    v_mfma_f32_16x16x32_bf16 v[32:35], a[12:15], v[76:79], v[32:35]
    v_mfma_f32_16x16x32_bf16 v[36:39], v[132:135], v[76:79], v[36:39]
    buffer_load_dwordx4 v[76:79], v0, s[8:11], s48 offen offset:3072
    s_waitcnt vmcnt(16)
    v_mfma_f32_16x16x32_bf16 v[16:19], a[16:19], v[80:83], v[16:19]
    v_mfma_f32_16x16x32_bf16 v[20:23], a[20:23], v[80:83], v[20:23]
    v_mfma_f32_16x16x32_bf16 v[24:27], v[136:139], v[80:83], v[24:27]
    s_add_u32 s48, s46, 20480
    buffer_load_dwordx4 v[80:83], v0, s[8:11], s48 offen offset:0
    s_waitcnt vmcnt(16)
    v_mfma_f32_16x16x32_bf16 v[28:31], a[16:19], v[84:87], v[28:31]
    v_mfma_f32_16x16x32_bf16 v[32:35], a[20:23], v[84:87], v[32:35]
    v_mfma_f32_16x16x32_bf16 v[36:39], v[136:139], v[84:87], v[36:39]
    buffer_load_dwordx4 v[84:87], v0, s[8:11], s48 offen offset:1024
    s_waitcnt vmcnt(16)
    v_mfma_f32_16x16x32_bf16 v[16:19], a[24:27], v[88:91], v[16:19]
    v_mfma_f32_16x16x32_bf16 v[20:23], a[28:31], v[88:91], v[20:23]
    v_mfma_f32_16x16x32_bf16 v[24:27], v[140:143], v[88:91], v[24:27]
    buffer_load_dwordx4 v[88:91], v0, s[8:11], s48 offen offset:2048
    s_waitcnt vmcnt(16)
    v_mfma_f32_16x16x32_bf16 v[28:31], a[24:27], v[92:95], v[28:31]
    v_mfma_f32_16x16x32_bf16 v[32:35], a[28:31], v[92:95], v[32:35]
    v_mfma_f32_16x16x32_bf16 v[36:39], v[140:143], v[92:95], v[36:39]
    buffer_load_dwordx4 v[92:95], v0, s[8:11], s48 offen offset:3072
    s_waitcnt vmcnt(16)
    v_mfma_f32_16x16x32_bf16 v[16:19], a[32:35], v[96:99], v[16:19]
    v_mfma_f32_16x16x32_bf16 v[20:23], a[36:39], v[96:99], v[20:23]
    v_mfma_f32_16x16x32_bf16 v[24:27], v[144:147], v[96:99], v[24:27]
    s_add_u32 s48, s46, 24576
    buffer_load_dwordx4 v[96:99], v0, s[8:11], s48 offen offset:0
    s_waitcnt vmcnt(16)
    v_mfma_f32_16x16x32_bf16 v[28:31], a[32:35], v[100:103], v[28:31]
    v_mfma_f32_16x16x32_bf16 v[32:35], a[36:39], v[100:103], v[32:35]
    v_mfma_f32_16x16x32_bf16 v[36:39], v[144:147], v[100:103], v[36:39]
    buffer_load_dwordx4 v[100:103], v0, s[8:11], s48 offen offset:1024
    s_waitcnt vmcnt(16)
    v_mfma_f32_16x16x32_bf16 v[16:19], a[40:43], v[104:107], v[16:19]
    v_mfma_f32_16x16x32_bf16 v[20:23], a[44:47], v[104:107], v[20:23]
    v_mfma_f32_16x16x32_bf16 v[24:27], v[148:151], v[104:107], v[24:27]
    buffer_load_dwordx4 v[104:107], v0, s[8:11], s48 offen offset:2048
    s_waitcnt vmcnt(16)
    v_mfma_f32_16x16x32_bf16 v[28:31], a[40:43], v[108:111], v[28:31]
    v_mfma_f32_16x16x32_bf16 v[32:35], a[44:47], v[108:111], v[32:35]
    v_mfma_f32_16x16x32_bf16 v[36:39], v[148:151], v[108:111], v[36:39]
    buffer_load_dwordx4 v[108:111], v0, s[8:11], s48 offen offset:3072
    s_waitcnt vmcnt(16)
    v_mfma_f32_16x16x32_bf16 v[16:19], a[48:51], v[112:115], v[16:19]
    v_mfma_f32_16x16x32_bf16 v[20:23], a[52:55], v[112:115], v[20:23]
    v_mfma_f32_16x16x32_bf16 v[24:27], v[152:155], v[112:115], v[24:27]
    s_add_u32 s48, s46, 28672
    buffer_load_dwordx4 v[112:115], v0, s[8:11], s48 offen offset:0
    s_waitcnt vmcnt(16)
    v_mfma_f32_16x16x32_bf16 v[28:31], a[48:51], v[116:119], v[28:31]
    v_mfma_f32_16x16x32_bf16 v[32:35], a[52:55], v[116:119], v[32:35]
    v_mfma_f32_16x16x32_bf16 v[36:39], v[152:155], v[116:119], v[36:39]
    buffer_load_dwordx4 v[116:119], v0, s[8:11], s48 offen offset:1024
    s_waitcnt vmcnt(16)
    v_mfma_f32_16x16x32_bf16 v[16:19], a[56:59], v[120:123], v[16:19]
    v_mfma_f32_16x16x32_bf16 v[20:23], a[60:63], v[120:123], v[20:23]
    v_mfma_f32_16x16x32_bf16 v[24:27], v[156:159], v[120:123], v[24:27]
    buffer_load_dwordx4 v[120:123], v0, s[8:11], s48 offen offset:2048
    s_waitcnt vmcnt(15)
    v_mfma_f32_16x16x32_bf16 v[28:31], a[56:59], v[124:127], v[28:31]
    v_mfma_f32_16x16x32_bf16 v[32:35], a[60:63], v[124:127], v[32:35]
    v_mfma_f32_16x16x32_bf16 v[36:39], v[156:159], v[124:127], v[36:39]
    buffer_load_dwordx4 v[124:127], v0, s[8:11], s48 offen offset:3072
    s_waitcnt vmcnt(15)
    v_mfma_f32_16x16x32_bf16 v[16:19], a[64:67], v[64:67], v[16:19]
    v_mfma_f32_16x16x32_bf16 v[20:23], a[68:71], v[64:67], v[20:23]
    v_mfma_f32_16x16x32_bf16 v[24:27], v[160:163], v[64:67], v[24:27]
    s_add_u32 s48, s46, 32768
    buffer_load_dwordx4 v[64:67], v0, s[8:11], s48 offen offset:0
    s_waitcnt vmcnt(15)
    v_mfma_f32_16x16x32_bf16 v[28:31], a[64:67], v[68:71], v[28:31]
    v_mfma_f32_16x16x32_bf16 v[32:35], a[68:71], v[68:71], v[32:35]
    v_mfma_f32_16x16x32_bf16 v[36:39], v[160:163], v[68:71], v[36:39]
    s_cmp_lg_u32 s43, 0
    s_cselect_b64 exec, 1, 0
    buffer_store_dword v3, v4, s[8:11], s43 offen sc1
    s_mov_b64 exec, -1
    s_mov_b32 s43, 0
    buffer_load_dwordx4 v[68:71], v0, s[8:11], s48 offen offset:1024
    s_waitcnt vmcnt(16)
    v_mfma_f32_16x16x32_bf16 v[16:19], a[72:75], v[72:75], v[16:19]
    v_mfma_f32_16x16x32_bf16 v[20:23], a[76:79], v[72:75], v[20:23]
    v_mfma_f32_16x16x32_bf16 v[24:27], v[164:167], v[72:75], v[24:27]
    buffer_load_dwordx4 v[72:75], v0, s[8:11], s48 offen offset:2048
    s_waitcnt vmcnt(16)
    v_mfma_f32_16x16x32_bf16 v[28:31], a[72:75], v[76:79], v[28:31]
    v_mfma_f32_16x16x32_bf16 v[32:35], a[76:79], v[76:79], v[32:35]
    v_mfma_f32_16x16x32_bf16 v[36:39], v[164:167], v[76:79], v[36:39]
    buffer_load_dwordx4 v[76:79], v0, s[8:11], s48 offen offset:3072
    s_waitcnt vmcnt(16)
    v_mfma_f32_16x16x32_bf16 v[16:19], a[80:83], v[80:83], v[16:19]
    v_mfma_f32_16x16x32_bf16 v[20:23], a[84:87], v[80:83], v[20:23]
    v_mfma_f32_16x16x32_bf16 v[24:27], v[168:171], v[80:83], v[24:27]
    s_add_u32 s48, s46, 36864
    buffer_load_dwordx4 v[80:83], v0, s[8:11], s48 offen offset:0
    s_waitcnt vmcnt(16)
    v_mfma_f32_16x16x32_bf16 v[28:31], a[80:83], v[84:87], v[28:31]
    v_mfma_f32_16x16x32_bf16 v[32:35], a[84:87], v[84:87], v[32:35]
    v_mfma_f32_16x16x32_bf16 v[36:39], v[168:171], v[84:87], v[36:39]
    buffer_load_dwordx4 v[84:87], v0, s[8:11], s48 offen offset:1024
    s_waitcnt vmcnt(16)
    v_mfma_f32_16x16x32_bf16 v[16:19], a[88:91], v[88:91], v[16:19]
    v_mfma_f32_16x16x32_bf16 v[20:23], a[92:95], v[88:91], v[20:23]
    v_mfma_f32_16x16x32_bf16 v[24:27], v[172:175], v[88:91], v[24:27]
    buffer_load_dwordx4 v[88:91], v0, s[8:11], s48 offen offset:2048
    s_waitcnt vmcnt(16)
    v_mfma_f32_16x16x32_bf16 v[28:31], a[88:91], v[92:95], v[28:31]
    v_mfma_f32_16x16x32_bf16 v[32:35], a[92:95], v[92:95], v[32:35]
    v_mfma_f32_16x16x32_bf16 v[36:39], v[172:175], v[92:95], v[36:39]
    buffer_load_dwordx4 v[92:95], v0, s[8:11], s48 offen offset:3072
    s_waitcnt vmcnt(16)
    v_mfma_f32_16x16x32_bf16 v[16:19], a[96:99], v[96:99], v[16:19]
    v_mfma_f32_16x16x32_bf16 v[20:23], a[100:103], v[96:99], v[20:23]
    v_mfma_f32_16x16x32_bf16 v[24:27], v[176:179], v[96:99], v[24:27]
    s_add_u32 s48, s46, 40960
    buffer_load_dwordx4 v[96:99], v0, s[8:11], s48 offen offset:0
    s_waitcnt vmcnt(16)
    v_mfma_f32_16x16x32_bf16 v[28:31], a[96:99], v[100:103], v[28:31]
    v_mfma_f32_16x16x32_bf16 v[32:35], a[100:103], v[100:103], v[32:35]
    v_mfma_f32_16x16x32_bf16 v[36:39], v[176:179], v[100:103], v[36:39]
    buffer_load_dwordx4 v[100:103], v0, s[8:11], s48 offen offset:1024
    s_waitcnt vmcnt(16)
    v_mfma_f32_16x16x32_bf16 v[16:19], a[104:107], v[104:107], v[16:19]
    v_mfma_f32_16x16x32_bf16 v[20:23], a[108:111], v[104:107], v[20:23]
    v_mfma_f32_16x16x32_bf16 v[24:27], v[180:183], v[104:107], v[24:27]
    buffer_load_dwordx4 v[104:107], v0, s[8:11], s48 offen offset:2048
    s_waitcnt vmcnt(16)
    v_mfma_f32_16x16x32_bf16 v[28:31], a[104:107], v[108:111], v[28:31]
    v_mfma_f32_16x16x32_bf16 v[32:35], a[108:111], v[108:111], v[32:35]
    v_mfma_f32_16x16x32_bf16 v[36:39], v[180:183], v[108:111], v[36:39]
    buffer_load_dwordx4 v[108:111], v0, s[8:11], s48 offen offset:3072
    s_waitcnt vmcnt(16)
    v_mfma_f32_16x16x32_bf16 v[16:19], a[112:115], v[112:115], v[16:19]
    v_mfma_f32_16x16x32_bf16 v[20:23], a[116:119], v[112:115], v[20:23]
    v_mfma_f32_16x16x32_bf16 v[24:27], v[184:187], v[112:115], v[24:27]
    s_add_u32 s48, s46, 45056
    buffer_load_dwordx4 v[112:115], v0, s[8:11], s48 offen offset:0
    s_waitcnt vmcnt(16)
    v_mfma_f32_16x16x32_bf16 v[28:31], a[112:115], v[116:119], v[28:31]
    v_mfma_f32_16x16x32_bf16 v[32:35], a[116:119], v[116:119], v[32:35]
    v_mfma_f32_16x16x32_bf16 v[36:39], v[184:187], v[116:119], v[36:39]
    buffer_load_dwordx4 v[116:119], v0, s[8:11], s48 offen offset:1024
    s_waitcnt vmcnt(16)
    v_mfma_f32_16x16x32_bf16 v[16:19], a[120:123], v[120:123], v[16:19]
    v_mfma_f32_16x16x32_bf16 v[20:23], a[124:127], v[120:123], v[20:23]
    v_mfma_f32_16x16x32_bf16 v[24:27], v[188:191], v[120:123], v[24:27]
    buffer_load_dwordx4 v[120:123], v0, s[8:11], s48 offen offset:2048
    s_waitcnt vmcnt(16)
    v_mfma_f32_16x16x32_bf16 v[28:31], a[120:123], v[124:127], v[28:31]
    v_mfma_f32_16x16x32_bf16 v[32:35], a[124:127], v[124:127], v[32:35]
    v_mfma_f32_16x16x32_bf16 v[36:39], v[188:191], v[124:127], v[36:39]
    buffer_load_dwordx4 v[124:127], v0, s[8:11], s48 offen offset:3072
    s_waitcnt vmcnt(16)
    v_mfma_f32_16x16x32_bf16 v[16:19], a[128:131], v[64:67], v[16:19]
    v_mfma_f32_16x16x32_bf16 v[20:23], a[132:135], v[64:67], v[20:23]
    v_mfma_f32_16x16x32_bf16 v[24:27], v[192:195], v[64:67], v[24:27]
    s_add_u32 s48, s46, 49152
    buffer_load_dwordx4 v[64:67], v0, s[8:11], s48 offen offset:0
    s_waitcnt vmcnt(15)
    v_mfma_f32_16x16x32_bf16 v[28:31], a[128:131], v[68:71], v[28:31]
    v_mfma_f32_16x16x32_bf16 v[32:35], a[132:135], v[68:71], v[32:35]
    v_mfma_f32_16x16x32_bf16 v[36:39], v[192:195], v[68:71], v[36:39]
    buffer_load_dwordx4 v[68:71], v0, s[8:11], s48 offen offset:1024
    s_waitcnt vmcnt(15)
    v_mfma_f32_16x16x32_bf16 v[16:19], a[136:139], v[72:75], v[16:19]
    v_mfma_f32_16x16x32_bf16 v[20:23], a[140:143], v[72:75], v[20:23]
    v_mfma_f32_16x16x32_bf16 v[24:27], v[196:199], v[72:75], v[24:27]
    buffer_load_dwordx4 v[72:75], v0, s[8:11], s48 offen offset:2048
    s_waitcnt vmcnt(15)
    v_mfma_f32_16x16x32_bf16 v[28:31], a[136:139], v[76:79], v[28:31]
    v_mfma_f32_16x16x32_bf16 v[32:35], a[140:143], v[76:79], v[32:35]
    v_mfma_f32_16x16x32_bf16 v[36:39], v[196:199], v[76:79], v[36:39]
    buffer_load_dwordx4 v[76:79], v0, s[8:11], s48 offen offset:3072
    s_waitcnt vmcnt(15)
    v_mfma_f32_16x16x32_bf16 v[16:19], a[144:147], v[80:83], v[16:19]
    v_mfma_f32_16x16x32_bf16 v[20:23], a[148:151], v[80:83], v[20:23]
    v_mfma_f32_16x16x32_bf16 v[24:27], v[200:203], v[80:83], v[24:27]
    s_add_u32 s48, s46, 53248
    buffer_load_dwordx4 v[80:83], v0, s[8:11], s48 offen offset:0
    s_waitcnt vmcnt(15)
    v_mfma_f32_16x16x32_bf16 v[28:31], a[144:147], v[84:87], v[28:31]
    v_mfma_f32_16x16x32_bf16 v[32:35], a[148:151], v[84:87], v[32:35]
    v_mfma_f32_16x16x32_bf16 v[36:39], v[200:203], v[84:87], v[36:39]
    buffer_load_dwordx4 v[84:87], v0, s[8:11], s48 offen offset:1024
    s_waitcnt vmcnt(15)
    v_mfma_f32_16x16x32_bf16 v[16:19], a[152:155], v[88:91], v[16:19]
    v_mfma_f32_16x16x32_bf16 v[20:23], a[156:159], v[88:91], v[20:23]
    v_mfma_f32_16x16x32_bf16 v[24:27], v[204:207], v[88:91], v[24:27]
    buffer_load_dwordx4 v[88:91], v0, s[8:11], s48 offen offset:2048
    s_waitcnt vmcnt(15)
    v_mfma_f32_16x16x32_bf16 v[28:31], a[152:155], v[92:95], v[28:31]
    v_mfma_f32_16x16x32_bf16 v[32:35], a[156:159], v[92:95], v[32:35]
    v_mfma_f32_16x16x32_bf16 v[36:39], v[204:207], v[92:95], v[36:39]
    buffer_load_dwordx4 v[92:95], v0, s[8:11], s48 offen offset:3072
    s_waitcnt vmcnt(15)
    v_mfma_f32_16x16x32_bf16 v[16:19], a[160:163], v[96:99], v[16:19]
    v_mfma_f32_16x16x32_bf16 v[20:23], a[164:167], v[96:99], v[20:23]
    v_mfma_f32_16x16x32_bf16 v[24:27], v[208:211], v[96:99], v[24:27]
    s_add_u32 s48, s46, 57344
    buffer_load_dwordx4 v[96:99], v0, s[8:11], s48 offen offset:0
    s_waitcnt vmcnt(15)
    v_mfma_f32_16x16x32_bf16 v[28:31], a[160:163], v[100:103], v[28:31]
    v_mfma_f32_16x16x32_bf16 v[32:35], a[164:167], v[100:103], v[32:35]
    v_mfma_f32_16x16x32_bf16 v[36:39], v[208:211], v[100:103], v[36:39]
    buffer_load_dwordx4 v[100:103], v0, s[8:11], s48 offen offset:1024
    s_waitcnt vmcnt(15)
    v_mfma_f32_16x16x32_bf16 v[16:19], a[168:171], v[104:107], v[16:19]
    v_mfma_f32_16x16x32_bf16 v[20:23], a[172:175], v[104:107], v[20:23]
    v_mfma_f32_16x16x32_bf16 v[24:27], v[212:215], v[104:107], v[24:27]
    buffer_load_dwordx4 v[104:107], v0, s[8:11], s48 offen offset:2048
    s_waitcnt vmcnt(15)
    v_mfma_f32_16x16x32_bf16 v[28:31], a[168:171], v[108:111], v[28:31]
    v_mfma_f32_16x16x32_bf16 v[32:35], a[172:175], v[108:111], v[32:35]
    v_mfma_f32_16x16x32_bf16 v[36:39], v[212:215], v[108:111], v[36:39]
    buffer_load_dwordx4 v[108:111], v0, s[8:11], s48 offen offset:3072
    s_waitcnt vmcnt(15)
    v_mfma_f32_16x16x32_bf16 v[16:19], a[176:179], v[112:115], v[16:19]
    v_mfma_f32_16x16x32_bf16 v[20:23], a[180:183], v[112:115], v[20:23]
    v_mfma_f32_16x16x32_bf16 v[24:27], v[216:219], v[112:115], v[24:27]
    s_barrier
    ds_read_b32 v6, v49
    v_xor_b32 v49, 4, v49
    s_add_u32 s48, s46, 61440
    buffer_load_dwordx4 v[112:115], v0, s[8:11], s48 offen offset:0
    s_waitcnt vmcnt(15)
    v_mfma_f32_16x16x32_bf16 v[28:31], a[176:179], v[116:119], v[28:31]
    v_mfma_f32_16x16x32_bf16 v[32:35], a[180:183], v[116:119], v[32:35]
    v_mfma_f32_16x16x32_bf16 v[36:39], v[216:219], v[116:119], v[36:39]
    buffer_load_dwordx4 v[116:119], v0, s[8:11], s48 offen offset:1024
    s_waitcnt vmcnt(15)
    v_mfma_f32_16x16x32_bf16 v[16:19], a[184:187], v[120:123], v[16:19]
    v_mfma_f32_16x16x32_bf16 v[20:23], a[188:191], v[120:123], v[20:23]
    v_mfma_f32_16x16x32_bf16 v[24:27], v[220:223], v[120:123], v[24:27]
    buffer_load_dwordx4 v[120:123], v0, s[8:11], s48 offen offset:2048
    s_waitcnt vmcnt(15)
    v_mfma_f32_16x16x32_bf16 v[28:31], a[184:187], v[124:127], v[28:31]
    v_mfma_f32_16x16x32_bf16 v[32:35], a[188:191], v[124:127], v[32:35]
    v_mfma_f32_16x16x32_bf16 v[36:39], v[220:223], v[124:127], v[36:39]
    s_waitcnt lgkmcnt(0)
    v_readfirstlane_b32 s62, v6
    s_cmp_lt_u32 s33, 33
    s_cselect_b32 s38, 1, 3
    s_cmp_eq_u32 s62, 2
    s_cselect_b32 s36, 1, 0
    s_cselect_b32 s37, s33, s32
    s_cselect_b32 s17, s38, 0
    s_add_u32 s33, s33, s17
    s_cmp_eq_u32 s62, 1
    s_cselect_b32 s17, 2, 0
    s_add_u32 s32, s32, s17
    s_lshl_b32 s56, s36, 6
    s_add_u32 s56, s56, s37
    buffer_load_dwordx4 v[124:127], v0, s[8:11], s48 offen offset:3072
    s_waitcnt vmcnt(15)
    v_mfma_f32_16x16x32_bf16 v[16:19], a[192:195], v[64:67], v[16:19]
    v_mfma_f32_16x16x32_bf16 v[20:23], a[196:199], v[64:67], v[20:23]
    v_mfma_f32_16x16x32_bf16 v[24:27], v[224:227], v[64:67], v[24:27]
    s_cmp_lt_u32 s37, 64
    s_cselect_b32 s62, s62, 0
    s_lshl_b32 s46, s56, 18
    s_add_u32 s46, s46, s58
    s_mul_i32 s41, s36, 4718592
    s_mul_i32 s17, s37, 36864
    s_add_u32 s41, s41, s17
    s_add_u32 s41, s41, 8650752
    s_cmp_lg_u32 s62, 0
    s_cselect_b32 s30, 268435456, 0
    buffer_load_dword v10, v51, s[28:31], s46 offen
    s_add_u32 s48, s46, 0
    buffer_load_dwordx4 v[64:67], v0, s[28:31], s48 offen offset:0
    s_waitcnt vmcnt(15)
    v_mfma_f32_16x16x32_bf16 v[28:31], a[192:195], v[68:71], v[28:31]
    v_mfma_f32_16x16x32_bf16 v[32:35], a[196:199], v[68:71], v[32:35]
    v_mfma_f32_16x16x32_bf16 v[36:39], v[224:227], v[68:71], v[36:39]
    buffer_load_dwordx4 v[68:71], v0, s[28:31], s48 offen offset:1024
    s_waitcnt vmcnt(15)
    v_mfma_f32_16x16x32_bf16 v[16:19], a[200:203], v[72:75], v[16:19]
    v_mfma_f32_16x16x32_bf16 v[20:23], a[204:207], v[72:75], v[20:23]
    v_mfma_f32_16x16x32_bf16 v[24:27], v[228:231], v[72:75], v[24:27]
    buffer_load_dwordx4 v[72:75], v0, s[28:31], s48 offen offset:2048
    s_waitcnt vmcnt(15)
    v_mfma_f32_16x16x32_bf16 v[28:31], a[200:203], v[76:79], v[28:31]
    v_mfma_f32_16x16x32_bf16 v[32:35], a[204:207], v[76:79], v[32:35]
    v_mfma_f32_16x16x32_bf16 v[36:39], v[228:231], v[76:79], v[36:39]
    buffer_load_dwordx4 v[76:79], v0, s[28:31], s48 offen offset:3072
    s_waitcnt vmcnt(15)
    v_mfma_f32_16x16x32_bf16 v[16:19], a[208:211], v[80:83], v[16:19]
    v_mfma_f32_16x16x32_bf16 v[20:23], a[212:215], v[80:83], v[20:23]
    v_mfma_f32_16x16x32_bf16 v[24:27], v[232:235], v[80:83], v[24:27]
    s_add_u32 s48, s46, 4096
    buffer_load_dwordx4 v[80:83], v0, s[28:31], s48 offen offset:0
    s_waitcnt vmcnt(15)
    v_mfma_f32_16x16x32_bf16 v[28:31], a[208:211], v[84:87], v[28:31]
    v_mfma_f32_16x16x32_bf16 v[32:35], a[212:215], v[84:87], v[32:35]
    v_mfma_f32_16x16x32_bf16 v[36:39], v[232:235], v[84:87], v[36:39]
    buffer_load_dwordx4 v[84:87], v0, s[28:31], s48 offen offset:1024
    s_waitcnt vmcnt(15)
    v_mfma_f32_16x16x32_bf16 v[16:19], a[216:219], v[88:91], v[16:19]
    v_mfma_f32_16x16x32_bf16 v[20:23], a[220:223], v[88:91], v[20:23]
    v_mfma_f32_16x16x32_bf16 v[24:27], v[236:239], v[88:91], v[24:27]
    buffer_load_dwordx4 v[88:91], v0, s[28:31], s48 offen offset:2048
    s_waitcnt vmcnt(15)
    v_mfma_f32_16x16x32_bf16 v[28:31], a[216:219], v[92:95], v[28:31]
    v_mfma_f32_16x16x32_bf16 v[32:35], a[220:223], v[92:95], v[32:35]
    v_mfma_f32_16x16x32_bf16 v[36:39], v[236:239], v[92:95], v[36:39]
    buffer_load_dwordx4 v[92:95], v0, s[28:31], s48 offen offset:3072
    s_waitcnt vmcnt(15)
    v_mfma_f32_16x16x32_bf16 v[16:19], a[224:227], v[96:99], v[16:19]
    v_mfma_f32_16x16x32_bf16 v[20:23], a[228:231], v[96:99], v[20:23]
    v_mfma_f32_16x16x32_bf16 v[24:27], v[240:243], v[96:99], v[24:27]
    s_add_u32 s48, s46, 8192
    buffer_load_dwordx4 v[96:99], v0, s[28:31], s48 offen offset:0
    s_waitcnt vmcnt(15)
    v_mfma_f32_16x16x32_bf16 v[28:31], a[224:227], v[100:103], v[28:31]
    v_mfma_f32_16x16x32_bf16 v[32:35], a[228:231], v[100:103], v[32:35]
    v_mfma_f32_16x16x32_bf16 v[36:39], v[240:243], v[100:103], v[36:39]
    buffer_load_dwordx4 v[100:103], v0, s[28:31], s48 offen offset:1024
    s_waitcnt vmcnt(15)
    v_mfma_f32_16x16x32_bf16 v[16:19], a[232:235], v[104:107], v[16:19]
    v_mfma_f32_16x16x32_bf16 v[20:23], a[236:239], v[104:107], v[20:23]
    v_mfma_f32_16x16x32_bf16 v[24:27], v[244:247], v[104:107], v[24:27]
    buffer_load_dwordx4 v[104:107], v0, s[28:31], s48 offen offset:2048
    s_waitcnt vmcnt(15)
    v_mfma_f32_16x16x32_bf16 v[28:31], a[232:235], v[108:111], v[28:31]
    v_mfma_f32_16x16x32_bf16 v[32:35], a[236:239], v[108:111], v[32:35]
    v_mfma_f32_16x16x32_bf16 v[36:39], v[244:247], v[108:111], v[36:39]
    buffer_load_dwordx4 v[108:111], v0, s[28:31], s48 offen offset:3072
    s_waitcnt vmcnt(15)
    v_mfma_f32_16x16x32_bf16 v[16:19], a[240:243], v[112:115], v[16:19]
    v_mfma_f32_16x16x32_bf16 v[20:23], a[244:247], v[112:115], v[20:23]
    v_mfma_f32_16x16x32_bf16 v[24:27], v[248:251], v[112:115], v[24:27]
    s_add_u32 s48, s46, 12288
    buffer_load_dwordx4 v[112:115], v0, s[28:31], s48 offen offset:0
    s_waitcnt vmcnt(15)
    v_mfma_f32_16x16x32_bf16 v[28:31], a[240:243], v[116:119], v[28:31]
    v_mfma_f32_16x16x32_bf16 v[32:35], a[244:247], v[116:119], v[32:35]
    v_mfma_f32_16x16x32_bf16 v[36:39], v[248:251], v[116:119], v[36:39]
    buffer_load_dwordx4 v[116:119], v0, s[28:31], s48 offen offset:1024
    s_waitcnt vmcnt(15)
    v_mfma_f32_16x16x32_bf16 v[16:19], a[248:251], v[120:123], v[16:19]
    v_mfma_f32_16x16x32_bf16 v[20:23], a[252:255], v[120:123], v[20:23]
    v_mfma_f32_16x16x32_bf16 v[24:27], v[252:255], v[120:123], v[24:27]
    buffer_load_dwordx4 v[120:123], v0, s[28:31], s48 offen offset:2048
    s_waitcnt vmcnt(15)
    v_mfma_f32_16x16x32_bf16 v[28:31], a[248:251], v[124:127], v[28:31]
    v_mfma_f32_16x16x32_bf16 v[32:35], a[252:255], v[124:127], v[32:35]
    v_mfma_f32_16x16x32_bf16 v[36:39], v[252:255], v[124:127], v[36:39]
    s_nop 5
    ds_write_b128 v48, v[16:19] offset:0
    ds_write_b128 v48, v[20:23] offset:1024
    ds_write_b128 v48, v[24:27] offset:2048
    ds_write_b128 v48, v[28:31] offset:3072
    ds_write_b128 v48, v[32:35] offset:4096
    ds_write_b128 v48, v[36:39] offset:5120
    s_waitcnt lgkmcnt(0)
    s_barrier
    ds_read_b128 v[24:27], v50 offset:2048
    ds_read_b128 v[28:31], v50 offset:8192
    ds_read_b128 v[32:35], v50 offset:14336
    ds_read_b128 v[36:39], v50 offset:20480
    v_xor_b32 v48, 0x8000, v48
    v_xor_b32 v50, 0x8000, v50
    v_lshlrev_b32 v16, 16, v40
    v_and_b32 v17, 0xffff0000, v40
    v_lshlrev_b32 v18, 16, v41
    v_and_b32 v19, 0xffff0000, v41
    buffer_load_dwordx2 v[40:41], v12, s[28:31], s41 offen
    s_waitcnt lgkmcnt(3)
    v_add_f32 v16, v16, v24
    v_add_f32 v17, v17, v25
    v_add_f32 v18, v18, v26
    v_add_f32 v19, v19, v27
    s_waitcnt lgkmcnt(2)
    v_add_f32 v16, v16, v28
    v_add_f32 v17, v17, v29
    v_add_f32 v18, v18, v30
    v_add_f32 v19, v19, v31
    s_waitcnt lgkmcnt(1)
    v_add_f32 v16, v16, v32
    v_add_f32 v17, v17, v33
    v_add_f32 v18, v18, v34
    v_add_f32 v19, v19, v35
    s_waitcnt lgkmcnt(0)
    v_add_f32 v16, v16, v36
    v_add_f32 v17, v17, v37
    v_add_f32 v18, v18, v38
    v_add_f32 v19, v19, v39
    v_cvt_pk_bf16_f32 v52, v16, v17
    v_cvt_pk_bf16_f32 v53, v18, v19
    s_cmp_eq_u32 s34, 0
    s_cbranch_scc1 LtwZ_l0
    s_mul_i32 s17, s35, 36864
    buffer_store_dwordx2 v[52:53], v13, s[24:27], s17 offen
    s_cmp_lg_u32 s62, 0
    s_cbranch_scc1 LtwZ_item
LtwZ_chk:
    s_min_u32 s17, s32, s33
    s_cmp_lt_u32 s17, 64
    s_cbranch_scc1 LtwZ_idle
    s_branch L_role_tw_exit
LtwZ_l0:
    s_add_u32 s47, s47, 2359296
    buffer_store_dwordx2 v[52:53], v12, s[8:11], s47 offen sc1
    v_add_f32 v44, v16, v17
    v_mul_f32 v45, v16, v16
    v_fmac_f32 v45, v17, v17
    v_add_f32 v44, v44, v18
    v_fmac_f32 v45, v18, v18
    v_add_f32 v44, v44, v19
    v_fmac_f32 v45, v19, v19
    v_mov_b32 v46, v44
    v_mov_b32 v47, v45
    s_nop 0
    v_permlane32_swap_b32 v44, v46
    v_permlane32_swap_b32 v45, v47
    v_add_f32 v44, v44, v46
    v_add_f32 v45, v45, v47
    v_mov_b32 v46, v44
    v_mov_b32 v47, v45
    s_nop 0
    v_permlane16_swap_b32 v44, v46
    v_permlane16_swap_b32 v45, v47
    v_add_f32 v44, v44, v46
    v_add_f32 v45, v45, v47
    s_mul_i32 s17, s35, 6144
    s_add_u32 s17, s17, 16515072
    s_mov_b64 exec, 0xffff
    buffer_store_dwordx2 v[44:45], v14, s[8:11], s17 offen sc1
    s_mov_b64 exec, -1
    s_mul_i32 s43, s35, 22528
    s_add_u32 s43, s43, s49
    s_cmp_lg_u32 s62, 0
    s_cbranch_scc1 LtwZ_item
    s_waitcnt vmcnt(0)
    s_mov_b64 exec, 1
    buffer_store_dword v3, v4, s[8:11], s43 offen sc1
    s_mov_b64 exec, -1
    s_mov_b32 s43, 0
    s_min_u32 s17, s32, s33
    s_cmp_lt_u32 s17, 64
    s_cbranch_scc0 LtwZ_chk
    s_branch LtwZ_idle
L_role_tw_abort:
    s_waitcnt lgkmcnt(0)
    s_mov_b64 exec, -1
    v_mov_b32 v0, 60
    s_lshl_b32 s5, s3, 8
    s_or_b32 s5, s5, s4
    s_or_b32 s5, s5, 0x10000
    v_mov_b32 v1, s5
    global_store_dword v0, v1, s[12:13]
    s_endpgm
L_role_tw_exit:
    s_endpgm
.p2align 6
L_role_awo:
    v_and_b32 v5, 63, v0
    v_lshlrev_b32 v0, 4, v5
    v_and_b32 v7, 15, v5
    v_lshrrev_b32 v8, 4, v5
    v_min_u32 v1, 63, v5
    v_lshrrev_b32 v6, 2, v1
    v_and_b32 v1, 3, v1
    v_lshlrev_b32 v1, 2, v1
    v_lshl_add_u32 v1, v6, 7, v1
    v_mov_b32 v3, 1
    v_mov_b32 v4, 0
    s_mov_b32 s44, 0x05040100
    s_mov_b32 s45, 0x07060302
    s_cmp_lt_u32 s15, 5
    s_cbranch_scc1 Lawo_noord
    s_cmp_lg_u32 s14, 0
    s_cbranch_scc1 Lawo_ord_d
    v_mov_b32 v5, 48
    s_mov_b32 s16, 0
Lawo_ord:
    global_load_dword v6, v5, s[12:13] sc1
    s_add_u32 s16, s16, 1
    s_cmp_gt_u32 s16, 100000
    s_cbranch_scc1 L_role_awo_abort
    s_waitcnt vmcnt(0)
    v_cmp_gt_u32 vcc, 1, v6
    s_nop 0
    s_cbranch_vccz Lawo_ord_d
    s_sleep 64
    s_branch Lawo_ord
Lawo_ord_d:
    s_barrier
Lawo_noord:
    s_load_dwordx2 s[20:21], s[0:1], 16
    s_mov_b32 s22, 663552
    s_mov_b32 s23, 0x00020000
    s_waitcnt lgkmcnt(0)
    s_and_b32 s21, s21, 0xffff
    s_cmp_ge_u32 s15, 5
    s_cselect_b32 s63, 1, 0
    s_cselect_b32 s17, 5, 0
    s_sub_u32 s15, s15, s17
    s_lshl_b32 s50, s15, 2
    s_add_u32 s50, s50, s14
    s_min_u32 s50, s50, 17
    s_lshl_b32 s49, s50, 6
    v_bfe_u32 v10, v0, 4, 5
    v_and_b32 v14, 19, v10
    v_bfe_u32 v5, v10, 2, 1
    v_lshl_add_u32 v14, v5, 3, v14
    v_bfe_u32 v5, v10, 3, 1
    v_lshl_add_u32 v14, v5, 2, v14
    v_and_b32 v5, 1, v14
    v_mov_b32 v11, s44
    v_mov_b32 v6, s45
    v_cmp_eq_u32 vcc, 1, v5
    s_nop 1
    v_cndmask_b32 v11, v11, v6, vcc
    v_and_b32 v14, 30, v14
    v_lshlrev_b32 v14, 1, v14
    v_lshrrev_b32 v9, 9, v0
    v_mul_u32_u24 v5, 9216, v9
    v_add_u32 v12, v5, v14
    v_add_u32 v13, 1152, v12
    s_add_u32 s17, s49, 0
    buffer_load_dword v16, v12, s[20:23], s17 offen
    buffer_load_dword v17, v13, s[20:23], s17 offen
    s_add_u32 s17, s49, 2304
    buffer_load_dword v18, v12, s[20:23], s17 offen
    buffer_load_dword v19, v13, s[20:23], s17 offen
    s_add_u32 s17, s49, 4608
    buffer_load_dword v20, v12, s[20:23], s17 offen
    buffer_load_dword v21, v13, s[20:23], s17 offen
    s_add_u32 s17, s49, 6912
    buffer_load_dword v22, v12, s[20:23], s17 offen
    buffer_load_dword v23, v13, s[20:23], s17 offen
    s_add_u32 s17, s49, 23040
    buffer_load_dword v24, v12, s[20:23], s17 offen
    buffer_load_dword v25, v13, s[20:23], s17 offen
    s_add_u32 s17, s49, 25344
    buffer_load_dword v26, v12, s[20:23], s17 offen
    buffer_load_dword v27, v13, s[20:23], s17 offen
    s_add_u32 s17, s49, 27648
    buffer_load_dword v28, v12, s[20:23], s17 offen
    buffer_load_dword v29, v13, s[20:23], s17 offen
    s_add_u32 s17, s49, 29952
    buffer_load_dword v30, v12, s[20:23], s17 offen
    buffer_load_dword v31, v13, s[20:23], s17 offen
    s_add_u32 s17, s49, 41472
    buffer_load_dword v32, v12, s[20:23], s17 offen
    buffer_load_dword v33, v13, s[20:23], s17 offen
    s_add_u32 s17, s49, 43776
    buffer_load_dword v34, v12, s[20:23], s17 offen
    buffer_load_dword v35, v13, s[20:23], s17 offen
    s_add_u32 s17, s49, 46080
    buffer_load_dword v36, v12, s[20:23], s17 offen
    buffer_load_dword v37, v13, s[20:23], s17 offen
    s_add_u32 s17, s49, 48384
    buffer_load_dword v38, v12, s[20:23], s17 offen
    buffer_load_dword v39, v13, s[20:23], s17 offen
    s_add_u32 s17, s49, 64512
    buffer_load_dword v40, v12, s[20:23], s17 offen
    buffer_load_dword v41, v13, s[20:23], s17 offen
    s_add_u32 s17, s49, 66816
    buffer_load_dword v42, v12, s[20:23], s17 offen
    buffer_load_dword v43, v13, s[20:23], s17 offen
    s_add_u32 s17, s49, 69120
    buffer_load_dword v44, v12, s[20:23], s17 offen
    buffer_load_dword v45, v13, s[20:23], s17 offen
    s_add_u32 s17, s49, 71424
    buffer_load_dword v46, v12, s[20:23], s17 offen
    buffer_load_dword v47, v13, s[20:23], s17 offen
    s_add_u32 s17, s49, 82944
    buffer_load_dword v48, v12, s[20:23], s17 offen
    buffer_load_dword v49, v13, s[20:23], s17 offen
    s_add_u32 s17, s49, 85248
    buffer_load_dword v50, v12, s[20:23], s17 offen
    buffer_load_dword v51, v13, s[20:23], s17 offen
    s_add_u32 s17, s49, 87552
    buffer_load_dword v52, v12, s[20:23], s17 offen
    buffer_load_dword v53, v13, s[20:23], s17 offen
    s_add_u32 s17, s49, 89856
    buffer_load_dword v54, v12, s[20:23], s17 offen
    buffer_load_dword v55, v13, s[20:23], s17 offen
    s_add_u32 s17, s49, 105984
    buffer_load_dword v56, v12, s[20:23], s17 offen
    buffer_load_dword v57, v13, s[20:23], s17 offen
    s_add_u32 s17, s49, 108288
    buffer_load_dword v58, v12, s[20:23], s17 offen
    buffer_load_dword v59, v13, s[20:23], s17 offen
    s_add_u32 s17, s49, 110592
    buffer_load_dword v60, v12, s[20:23], s17 offen
    buffer_load_dword v61, v13, s[20:23], s17 offen
    s_add_u32 s17, s49, 112896
    buffer_load_dword v62, v12, s[20:23], s17 offen
    buffer_load_dword v63, v13, s[20:23], s17 offen
    s_add_u32 s17, s49, 124416
    buffer_load_dword v64, v12, s[20:23], s17 offen
    buffer_load_dword v65, v13, s[20:23], s17 offen
    s_add_u32 s17, s49, 126720
    buffer_load_dword v66, v12, s[20:23], s17 offen
    buffer_load_dword v67, v13, s[20:23], s17 offen
    s_add_u32 s17, s49, 129024
    buffer_load_dword v68, v12, s[20:23], s17 offen
    buffer_load_dword v69, v13, s[20:23], s17 offen
    s_add_u32 s17, s49, 131328
    buffer_load_dword v70, v12, s[20:23], s17 offen
    buffer_load_dword v71, v13, s[20:23], s17 offen
    s_add_u32 s17, s49, 147456
    buffer_load_dword v72, v12, s[20:23], s17 offen
    buffer_load_dword v73, v13, s[20:23], s17 offen
    s_waitcnt vmcnt(56)
    v_perm_b32 v112, v17, v16, v11
    s_add_u32 s17, s49, 149760
    buffer_load_dword v74, v12, s[20:23], s17 offen
    buffer_load_dword v75, v13, s[20:23], s17 offen
    s_waitcnt vmcnt(56)
    v_perm_b32 v113, v19, v18, v11
    s_add_u32 s17, s49, 152064
    buffer_load_dword v76, v12, s[20:23], s17 offen
    buffer_load_dword v77, v13, s[20:23], s17 offen
    s_waitcnt vmcnt(56)
    v_perm_b32 v114, v21, v20, v11
    s_add_u32 s17, s49, 154368
    buffer_load_dword v78, v12, s[20:23], s17 offen
    buffer_load_dword v79, v13, s[20:23], s17 offen
    s_waitcnt vmcnt(56)
    v_perm_b32 v115, v23, v22, v11
    s_add_u32 s17, s49, 165888
    buffer_load_dword v80, v12, s[20:23], s17 offen
    buffer_load_dword v81, v13, s[20:23], s17 offen
    s_waitcnt vmcnt(56)
    v_perm_b32 v116, v25, v24, v11
    s_add_u32 s17, s49, 168192
    buffer_load_dword v82, v12, s[20:23], s17 offen
    buffer_load_dword v83, v13, s[20:23], s17 offen
    s_waitcnt vmcnt(56)
    v_perm_b32 v117, v27, v26, v11
    s_add_u32 s17, s49, 170496
    buffer_load_dword v84, v12, s[20:23], s17 offen
    buffer_load_dword v85, v13, s[20:23], s17 offen
    s_waitcnt vmcnt(56)
    v_perm_b32 v118, v29, v28, v11
    s_add_u32 s17, s49, 172800
    buffer_load_dword v86, v12, s[20:23], s17 offen
    buffer_load_dword v87, v13, s[20:23], s17 offen
    s_waitcnt vmcnt(56)
    v_perm_b32 v119, v31, v30, v11
    s_add_u32 s17, s49, 188928
    buffer_load_dword v88, v12, s[20:23], s17 offen
    buffer_load_dword v89, v13, s[20:23], s17 offen
    s_waitcnt vmcnt(56)
    v_perm_b32 v120, v33, v32, v11
    s_add_u32 s17, s49, 191232
    buffer_load_dword v90, v12, s[20:23], s17 offen
    buffer_load_dword v91, v13, s[20:23], s17 offen
    s_waitcnt vmcnt(56)
    v_perm_b32 v121, v35, v34, v11
    s_add_u32 s17, s49, 193536
    buffer_load_dword v92, v12, s[20:23], s17 offen
    buffer_load_dword v93, v13, s[20:23], s17 offen
    s_waitcnt vmcnt(56)
    v_perm_b32 v122, v37, v36, v11
    s_add_u32 s17, s49, 195840
    buffer_load_dword v94, v12, s[20:23], s17 offen
    buffer_load_dword v95, v13, s[20:23], s17 offen
    s_waitcnt vmcnt(56)
    v_perm_b32 v123, v39, v38, v11
    s_add_u32 s17, s49, 207360
    buffer_load_dword v96, v12, s[20:23], s17 offen
    buffer_load_dword v97, v13, s[20:23], s17 offen
    s_waitcnt vmcnt(56)
    v_perm_b32 v124, v41, v40, v11
    s_add_u32 s17, s49, 209664
    buffer_load_dword v98, v12, s[20:23], s17 offen
    buffer_load_dword v99, v13, s[20:23], s17 offen
    s_waitcnt vmcnt(56)
    v_perm_b32 v125, v43, v42, v11
    s_add_u32 s17, s49, 211968
    buffer_load_dword v100, v12, s[20:23], s17 offen
    buffer_load_dword v101, v13, s[20:23], s17 offen
    s_waitcnt vmcnt(56)
    v_perm_b32 v126, v45, v44, v11
    s_add_u32 s17, s49, 214272
    buffer_load_dword v102, v12, s[20:23], s17 offen
    buffer_load_dword v103, v13, s[20:23], s17 offen
    s_waitcnt vmcnt(56)
    v_perm_b32 v127, v47, v46, v11
    s_add_u32 s17, s49, 230400
    buffer_load_dword v104, v12, s[20:23], s17 offen
    buffer_load_dword v105, v13, s[20:23], s17 offen
    s_waitcnt vmcnt(56)
    v_perm_b32 v128, v49, v48, v11
    s_add_u32 s17, s49, 232704
    buffer_load_dword v106, v12, s[20:23], s17 offen
    buffer_load_dword v107, v13, s[20:23], s17 offen
    s_waitcnt vmcnt(56)
    v_perm_b32 v129, v51, v50, v11
    s_add_u32 s17, s49, 235008
    buffer_load_dword v108, v12, s[20:23], s17 offen
    buffer_load_dword v109, v13, s[20:23], s17 offen
    s_waitcnt vmcnt(56)
    v_perm_b32 v130, v53, v52, v11
    s_add_u32 s17, s49, 237312
    buffer_load_dword v110, v12, s[20:23], s17 offen
    buffer_load_dword v111, v13, s[20:23], s17 offen
    s_waitcnt vmcnt(56)
    v_perm_b32 v131, v55, v54, v11
    s_add_u32 s17, s49, 248832
    buffer_load_dword v16, v12, s[20:23], s17 offen
    buffer_load_dword v17, v13, s[20:23], s17 offen
    s_waitcnt vmcnt(56)
    v_perm_b32 v132, v57, v56, v11
    s_add_u32 s17, s49, 251136
    buffer_load_dword v18, v12, s[20:23], s17 offen
    buffer_load_dword v19, v13, s[20:23], s17 offen
    s_waitcnt vmcnt(56)
    v_perm_b32 v133, v59, v58, v11
    s_add_u32 s17, s49, 253440
    buffer_load_dword v20, v12, s[20:23], s17 offen
    buffer_load_dword v21, v13, s[20:23], s17 offen
    s_waitcnt vmcnt(56)
    v_perm_b32 v134, v61, v60, v11
    s_add_u32 s17, s49, 255744
    buffer_load_dword v22, v12, s[20:23], s17 offen
    buffer_load_dword v23, v13, s[20:23], s17 offen
    s_waitcnt vmcnt(56)
    v_perm_b32 v135, v63, v62, v11
    s_add_u32 s17, s49, 271872
    buffer_load_dword v24, v12, s[20:23], s17 offen
    buffer_load_dword v25, v13, s[20:23], s17 offen
    s_waitcnt vmcnt(56)
    v_perm_b32 v136, v65, v64, v11
    s_add_u32 s17, s49, 274176
    buffer_load_dword v26, v12, s[20:23], s17 offen
    buffer_load_dword v27, v13, s[20:23], s17 offen
    s_waitcnt vmcnt(56)
    v_perm_b32 v137, v67, v66, v11
    s_add_u32 s17, s49, 276480
    buffer_load_dword v28, v12, s[20:23], s17 offen
    buffer_load_dword v29, v13, s[20:23], s17 offen
    s_waitcnt vmcnt(56)
    v_perm_b32 v138, v69, v68, v11
    s_add_u32 s17, s49, 278784
    buffer_load_dword v30, v12, s[20:23], s17 offen
    buffer_load_dword v31, v13, s[20:23], s17 offen
    s_waitcnt vmcnt(56)
    v_perm_b32 v139, v71, v70, v11
    s_add_u32 s17, s49, 290304
    buffer_load_dword v32, v12, s[20:23], s17 offen
    buffer_load_dword v33, v13, s[20:23], s17 offen
    s_waitcnt vmcnt(56)
    v_perm_b32 v140, v73, v72, v11
    s_add_u32 s17, s49, 292608
    buffer_load_dword v34, v12, s[20:23], s17 offen
    buffer_load_dword v35, v13, s[20:23], s17 offen
    s_waitcnt vmcnt(56)
    v_perm_b32 v141, v75, v74, v11
    s_add_u32 s17, s49, 294912
    buffer_load_dword v36, v12, s[20:23], s17 offen
    buffer_load_dword v37, v13, s[20:23], s17 offen
    s_waitcnt vmcnt(56)
    v_perm_b32 v142, v77, v76, v11
    s_add_u32 s17, s49, 297216
    buffer_load_dword v38, v12, s[20:23], s17 offen
    buffer_load_dword v39, v13, s[20:23], s17 offen
    s_waitcnt vmcnt(56)
    v_perm_b32 v143, v79, v78, v11
    s_add_u32 s17, s49, 313344
    buffer_load_dword v40, v12, s[20:23], s17 offen
    buffer_load_dword v41, v13, s[20:23], s17 offen
    s_waitcnt vmcnt(56)
    v_perm_b32 v144, v81, v80, v11
    s_add_u32 s17, s49, 315648
    buffer_load_dword v42, v12, s[20:23], s17 offen
    buffer_load_dword v43, v13, s[20:23], s17 offen
    s_waitcnt vmcnt(56)
    v_perm_b32 v145, v83, v82, v11
    s_add_u32 s17, s49, 317952
    buffer_load_dword v44, v12, s[20:23], s17 offen
    buffer_load_dword v45, v13, s[20:23], s17 offen
    s_waitcnt vmcnt(56)
    v_perm_b32 v146, v85, v84, v11
    s_add_u32 s17, s49, 320256
    buffer_load_dword v46, v12, s[20:23], s17 offen
    buffer_load_dword v47, v13, s[20:23], s17 offen
    s_waitcnt vmcnt(56)
    v_perm_b32 v147, v87, v86, v11
    s_add_u32 s17, s49, 331776
    buffer_load_dword v48, v12, s[20:23], s17 offen
    buffer_load_dword v49, v13, s[20:23], s17 offen
    s_waitcnt vmcnt(56)
    v_perm_b32 v148, v89, v88, v11
    s_add_u32 s17, s49, 334080
    buffer_load_dword v50, v12, s[20:23], s17 offen
    buffer_load_dword v51, v13, s[20:23], s17 offen
    s_waitcnt vmcnt(56)
    v_perm_b32 v149, v91, v90, v11
    s_add_u32 s17, s49, 336384
    buffer_load_dword v52, v12, s[20:23], s17 offen
    buffer_load_dword v53, v13, s[20:23], s17 offen
    s_waitcnt vmcnt(56)
    v_perm_b32 v150, v93, v92, v11
    s_add_u32 s17, s49, 338688
    buffer_load_dword v54, v12, s[20:23], s17 offen
    buffer_load_dword v55, v13, s[20:23], s17 offen
    s_waitcnt vmcnt(56)
    v_perm_b32 v151, v95, v94, v11
    s_add_u32 s17, s49, 354816
    buffer_load_dword v56, v12, s[20:23], s17 offen
    buffer_load_dword v57, v13, s[20:23], s17 offen
    s_waitcnt vmcnt(56)
    v_perm_b32 v152, v97, v96, v11
    s_add_u32 s17, s49, 357120
    buffer_load_dword v58, v12, s[20:23], s17 offen
    buffer_load_dword v59, v13, s[20:23], s17 offen
    s_waitcnt vmcnt(56)
    v_perm_b32 v153, v99, v98, v11
    s_add_u32 s17, s49, 359424
    buffer_load_dword v60, v12, s[20:23], s17 offen
    buffer_load_dword v61, v13, s[20:23], s17 offen
    s_waitcnt vmcnt(56)
    v_perm_b32 v154, v101, v100, v11
    s_add_u32 s17, s49, 361728
    buffer_load_dword v62, v12, s[20:23], s17 offen
    buffer_load_dword v63, v13, s[20:23], s17 offen
    s_waitcnt vmcnt(56)
    v_perm_b32 v155, v103, v102, v11
    s_add_u32 s17, s49, 373248
    buffer_load_dword v64, v12, s[20:23], s17 offen
    buffer_load_dword v65, v13, s[20:23], s17 offen
    s_waitcnt vmcnt(56)
    v_perm_b32 v156, v105, v104, v11
    s_add_u32 s17, s49, 375552
    buffer_load_dword v66, v12, s[20:23], s17 offen
    buffer_load_dword v67, v13, s[20:23], s17 offen
    s_waitcnt vmcnt(56)
    v_perm_b32 v157, v107, v106, v11
    s_add_u32 s17, s49, 377856
    buffer_load_dword v68, v12, s[20:23], s17 offen
    buffer_load_dword v69, v13, s[20:23], s17 offen
    s_waitcnt vmcnt(56)
    v_perm_b32 v158, v109, v108, v11
    s_add_u32 s17, s49, 380160
    buffer_load_dword v70, v12, s[20:23], s17 offen
    buffer_load_dword v71, v13, s[20:23], s17 offen
    s_waitcnt vmcnt(56)
    v_perm_b32 v159, v111, v110, v11
    s_add_u32 s17, s49, 396288
    buffer_load_dword v72, v12, s[20:23], s17 offen
    buffer_load_dword v73, v13, s[20:23], s17 offen
    s_waitcnt vmcnt(56)
    v_perm_b32 v160, v17, v16, v11
    s_add_u32 s17, s49, 398592
    buffer_load_dword v74, v12, s[20:23], s17 offen
    buffer_load_dword v75, v13, s[20:23], s17 offen
    s_waitcnt vmcnt(56)
    v_perm_b32 v161, v19, v18, v11
    s_add_u32 s17, s49, 400896
    buffer_load_dword v76, v12, s[20:23], s17 offen
    buffer_load_dword v77, v13, s[20:23], s17 offen
    s_waitcnt vmcnt(56)
    v_perm_b32 v162, v21, v20, v11
    s_add_u32 s17, s49, 403200
    buffer_load_dword v78, v12, s[20:23], s17 offen
    buffer_load_dword v79, v13, s[20:23], s17 offen
    s_waitcnt vmcnt(56)
    v_perm_b32 v163, v23, v22, v11
    s_add_u32 s17, s49, 414720
    buffer_load_dword v80, v12, s[20:23], s17 offen
    buffer_load_dword v81, v13, s[20:23], s17 offen
    s_waitcnt vmcnt(56)
    v_perm_b32 v164, v25, v24, v11
    s_add_u32 s17, s49, 417024
    buffer_load_dword v82, v12, s[20:23], s17 offen
    buffer_load_dword v83, v13, s[20:23], s17 offen
    s_waitcnt vmcnt(56)
    v_perm_b32 v165, v27, v26, v11
    s_add_u32 s17, s49, 419328
    buffer_load_dword v84, v12, s[20:23], s17 offen
    buffer_load_dword v85, v13, s[20:23], s17 offen
    s_waitcnt vmcnt(56)
    v_perm_b32 v166, v29, v28, v11
    s_add_u32 s17, s49, 421632
    buffer_load_dword v86, v12, s[20:23], s17 offen
    buffer_load_dword v87, v13, s[20:23], s17 offen
    s_waitcnt vmcnt(56)
    v_perm_b32 v167, v31, v30, v11
    s_add_u32 s17, s49, 437760
    buffer_load_dword v88, v12, s[20:23], s17 offen
    buffer_load_dword v89, v13, s[20:23], s17 offen
    s_waitcnt vmcnt(56)
    v_perm_b32 v168, v33, v32, v11
    s_add_u32 s17, s49, 440064
    buffer_load_dword v90, v12, s[20:23], s17 offen
    buffer_load_dword v91, v13, s[20:23], s17 offen
    s_waitcnt vmcnt(56)
    v_perm_b32 v169, v35, v34, v11
    s_add_u32 s17, s49, 442368
    buffer_load_dword v92, v12, s[20:23], s17 offen
    buffer_load_dword v93, v13, s[20:23], s17 offen
    s_waitcnt vmcnt(56)
    v_perm_b32 v170, v37, v36, v11
    s_add_u32 s17, s49, 444672
    buffer_load_dword v94, v12, s[20:23], s17 offen
    buffer_load_dword v95, v13, s[20:23], s17 offen
    s_waitcnt vmcnt(56)
    v_perm_b32 v171, v39, v38, v11
    s_add_u32 s17, s49, 456192
    buffer_load_dword v96, v12, s[20:23], s17 offen
    buffer_load_dword v97, v13, s[20:23], s17 offen
    s_waitcnt vmcnt(56)
    v_perm_b32 v172, v41, v40, v11
    s_add_u32 s17, s49, 458496
    buffer_load_dword v98, v12, s[20:23], s17 offen
    buffer_load_dword v99, v13, s[20:23], s17 offen
    s_waitcnt vmcnt(56)
    v_perm_b32 v173, v43, v42, v11
    s_add_u32 s17, s49, 460800
    buffer_load_dword v100, v12, s[20:23], s17 offen
    buffer_load_dword v101, v13, s[20:23], s17 offen
    s_waitcnt vmcnt(56)
    v_perm_b32 v174, v45, v44, v11
    s_add_u32 s17, s49, 463104
    buffer_load_dword v102, v12, s[20:23], s17 offen
    buffer_load_dword v103, v13, s[20:23], s17 offen
    s_waitcnt vmcnt(56)
    v_perm_b32 v175, v47, v46, v11
    s_add_u32 s17, s49, 479232
    buffer_load_dword v104, v12, s[20:23], s17 offen
    buffer_load_dword v105, v13, s[20:23], s17 offen
    s_waitcnt vmcnt(56)
    v_perm_b32 v176, v49, v48, v11
    s_add_u32 s17, s49, 481536
    buffer_load_dword v106, v12, s[20:23], s17 offen
    buffer_load_dword v107, v13, s[20:23], s17 offen
    s_waitcnt vmcnt(56)
    v_perm_b32 v177, v51, v50, v11
    s_add_u32 s17, s49, 483840
    buffer_load_dword v108, v12, s[20:23], s17 offen
    buffer_load_dword v109, v13, s[20:23], s17 offen
    s_waitcnt vmcnt(56)
    v_perm_b32 v178, v53, v52, v11
    s_add_u32 s17, s49, 486144
    buffer_load_dword v110, v12, s[20:23], s17 offen
    buffer_load_dword v111, v13, s[20:23], s17 offen
    s_waitcnt vmcnt(56)
    v_perm_b32 v179, v55, v54, v11
    s_add_u32 s17, s49, 497664
    buffer_load_dword v16, v12, s[20:23], s17 offen
    buffer_load_dword v17, v13, s[20:23], s17 offen
    s_waitcnt vmcnt(56)
    v_perm_b32 v180, v57, v56, v11
    s_add_u32 s17, s49, 499968
    buffer_load_dword v18, v12, s[20:23], s17 offen
    buffer_load_dword v19, v13, s[20:23], s17 offen
    s_waitcnt vmcnt(56)
    v_perm_b32 v181, v59, v58, v11
    s_add_u32 s17, s49, 502272
    buffer_load_dword v20, v12, s[20:23], s17 offen
    buffer_load_dword v21, v13, s[20:23], s17 offen
    s_waitcnt vmcnt(56)
    v_perm_b32 v182, v61, v60, v11
    s_add_u32 s17, s49, 504576
    buffer_load_dword v22, v12, s[20:23], s17 offen
    buffer_load_dword v23, v13, s[20:23], s17 offen
    s_waitcnt vmcnt(56)
    v_perm_b32 v183, v63, v62, v11
    s_add_u32 s17, s49, 520704
    buffer_load_dword v24, v12, s[20:23], s17 offen
    buffer_load_dword v25, v13, s[20:23], s17 offen
    s_waitcnt vmcnt(56)
    v_perm_b32 v184, v65, v64, v11
    s_add_u32 s17, s49, 523008
    buffer_load_dword v26, v12, s[20:23], s17 offen
    buffer_load_dword v27, v13, s[20:23], s17 offen
    s_waitcnt vmcnt(56)
    v_perm_b32 v185, v67, v66, v11
    s_add_u32 s17, s49, 525312
    buffer_load_dword v28, v12, s[20:23], s17 offen
    buffer_load_dword v29, v13, s[20:23], s17 offen
    s_waitcnt vmcnt(56)
    v_perm_b32 v186, v69, v68, v11
    s_add_u32 s17, s49, 527616
    buffer_load_dword v30, v12, s[20:23], s17 offen
    buffer_load_dword v31, v13, s[20:23], s17 offen
    s_waitcnt vmcnt(56)
    v_perm_b32 v187, v71, v70, v11
    s_add_u32 s17, s49, 539136
    buffer_load_dword v32, v12, s[20:23], s17 offen
    buffer_load_dword v33, v13, s[20:23], s17 offen
    s_waitcnt vmcnt(56)
    v_perm_b32 v188, v73, v72, v11
    s_add_u32 s17, s49, 541440
    buffer_load_dword v34, v12, s[20:23], s17 offen
    buffer_load_dword v35, v13, s[20:23], s17 offen
    s_waitcnt vmcnt(56)
    v_perm_b32 v189, v75, v74, v11
    s_add_u32 s17, s49, 543744
    buffer_load_dword v36, v12, s[20:23], s17 offen
    buffer_load_dword v37, v13, s[20:23], s17 offen
    s_waitcnt vmcnt(56)
    v_perm_b32 v190, v77, v76, v11
    s_add_u32 s17, s49, 546048
    buffer_load_dword v38, v12, s[20:23], s17 offen
    buffer_load_dword v39, v13, s[20:23], s17 offen
    s_waitcnt vmcnt(56)
    v_perm_b32 v191, v79, v78, v11
    s_add_u32 s17, s49, 562176
    buffer_load_dword v40, v12, s[20:23], s17 offen
    buffer_load_dword v41, v13, s[20:23], s17 offen
    s_waitcnt vmcnt(56)
    v_perm_b32 v192, v81, v80, v11
    s_add_u32 s17, s49, 564480
    buffer_load_dword v42, v12, s[20:23], s17 offen
    buffer_load_dword v43, v13, s[20:23], s17 offen
    s_waitcnt vmcnt(56)
    v_perm_b32 v193, v83, v82, v11
    s_add_u32 s17, s49, 566784
    buffer_load_dword v44, v12, s[20:23], s17 offen
    buffer_load_dword v45, v13, s[20:23], s17 offen
    s_waitcnt vmcnt(56)
    v_perm_b32 v194, v85, v84, v11
    s_add_u32 s17, s49, 569088
    buffer_load_dword v46, v12, s[20:23], s17 offen
    buffer_load_dword v47, v13, s[20:23], s17 offen
    s_waitcnt vmcnt(56)
    v_perm_b32 v195, v87, v86, v11
    s_add_u32 s17, s49, 580608
    buffer_load_dword v48, v12, s[20:23], s17 offen
    buffer_load_dword v49, v13, s[20:23], s17 offen
    s_waitcnt vmcnt(56)
    v_perm_b32 v196, v89, v88, v11
    s_add_u32 s17, s49, 582912
    buffer_load_dword v50, v12, s[20:23], s17 offen
    buffer_load_dword v51, v13, s[20:23], s17 offen
    s_waitcnt vmcnt(56)
    v_perm_b32 v197, v91, v90, v11
    s_add_u32 s17, s49, 585216
    buffer_load_dword v52, v12, s[20:23], s17 offen
    buffer_load_dword v53, v13, s[20:23], s17 offen
    s_waitcnt vmcnt(56)
    v_perm_b32 v198, v93, v92, v11
    s_add_u32 s17, s49, 587520
    buffer_load_dword v54, v12, s[20:23], s17 offen
    buffer_load_dword v55, v13, s[20:23], s17 offen
    s_waitcnt vmcnt(56)
    v_perm_b32 v199, v95, v94, v11
    s_add_u32 s17, s49, 603648
    buffer_load_dword v56, v12, s[20:23], s17 offen
    buffer_load_dword v57, v13, s[20:23], s17 offen
    s_waitcnt vmcnt(56)
    v_perm_b32 v200, v97, v96, v11
    s_add_u32 s17, s49, 605952
    buffer_load_dword v58, v12, s[20:23], s17 offen
    buffer_load_dword v59, v13, s[20:23], s17 offen
    s_waitcnt vmcnt(56)
    v_perm_b32 v201, v99, v98, v11
    s_add_u32 s17, s49, 608256
    buffer_load_dword v60, v12, s[20:23], s17 offen
    buffer_load_dword v61, v13, s[20:23], s17 offen
    s_waitcnt vmcnt(56)
    v_perm_b32 v202, v101, v100, v11
    s_add_u32 s17, s49, 610560
    buffer_load_dword v62, v12, s[20:23], s17 offen
    buffer_load_dword v63, v13, s[20:23], s17 offen
    s_waitcnt vmcnt(56)
    v_perm_b32 v203, v103, v102, v11
    s_add_u32 s17, s49, 622080
    buffer_load_dword v64, v12, s[20:23], s17 offen
    buffer_load_dword v65, v13, s[20:23], s17 offen
    s_waitcnt vmcnt(56)
    v_perm_b32 v204, v105, v104, v11
    s_add_u32 s17, s49, 624384
    buffer_load_dword v66, v12, s[20:23], s17 offen
    buffer_load_dword v67, v13, s[20:23], s17 offen
    s_waitcnt vmcnt(56)
    v_perm_b32 v205, v107, v106, v11
    s_add_u32 s17, s49, 626688
    buffer_load_dword v68, v12, s[20:23], s17 offen
    buffer_load_dword v69, v13, s[20:23], s17 offen
    s_waitcnt vmcnt(56)
    v_perm_b32 v206, v109, v108, v11
    s_add_u32 s17, s49, 628992
    buffer_load_dword v70, v12, s[20:23], s17 offen
    buffer_load_dword v71, v13, s[20:23], s17 offen
    s_waitcnt vmcnt(56)
    v_perm_b32 v207, v111, v110, v11
    s_add_u32 s17, s49, 645120
    buffer_load_dword v72, v12, s[20:23], s17 offen
    buffer_load_dword v73, v13, s[20:23], s17 offen
    s_waitcnt vmcnt(56)
    v_perm_b32 v208, v17, v16, v11
    s_add_u32 s17, s49, 647424
    buffer_load_dword v74, v12, s[20:23], s17 offen
    buffer_load_dword v75, v13, s[20:23], s17 offen
    s_waitcnt vmcnt(56)
    v_perm_b32 v209, v19, v18, v11
    s_add_u32 s17, s49, 649728
    buffer_load_dword v76, v12, s[20:23], s17 offen
    buffer_load_dword v77, v13, s[20:23], s17 offen
    s_waitcnt vmcnt(56)
    v_perm_b32 v210, v21, v20, v11
    s_add_u32 s17, s49, 652032
    buffer_load_dword v78, v12, s[20:23], s17 offen
    buffer_load_dword v79, v13, s[20:23], s17 offen
    s_waitcnt vmcnt(56)
    v_perm_b32 v211, v23, v22, v11
    s_waitcnt vmcnt(54)
    v_perm_b32 v212, v25, v24, v11
    s_waitcnt vmcnt(52)
    v_perm_b32 v213, v27, v26, v11
    s_waitcnt vmcnt(50)
    v_perm_b32 v214, v29, v28, v11
    s_waitcnt vmcnt(48)
    v_perm_b32 v215, v31, v30, v11
    s_waitcnt vmcnt(46)
    v_perm_b32 v216, v33, v32, v11
    s_waitcnt vmcnt(44)
    v_perm_b32 v217, v35, v34, v11
    s_waitcnt vmcnt(42)
    v_perm_b32 v218, v37, v36, v11
    s_waitcnt vmcnt(40)
    v_perm_b32 v219, v39, v38, v11
    s_waitcnt vmcnt(38)
    v_perm_b32 v220, v41, v40, v11
    s_waitcnt vmcnt(36)
    v_perm_b32 v221, v43, v42, v11
    s_waitcnt vmcnt(34)
    v_perm_b32 v222, v45, v44, v11
    s_waitcnt vmcnt(32)
    v_perm_b32 v223, v47, v46, v11
    s_waitcnt vmcnt(30)
    v_perm_b32 v224, v49, v48, v11
    s_waitcnt vmcnt(28)
    v_perm_b32 v225, v51, v50, v11
    s_waitcnt vmcnt(26)
    v_perm_b32 v226, v53, v52, v11
    s_waitcnt vmcnt(24)
    v_perm_b32 v227, v55, v54, v11
    s_waitcnt vmcnt(22)
    v_perm_b32 v228, v57, v56, v11
    s_waitcnt vmcnt(20)
    v_perm_b32 v229, v59, v58, v11
    s_waitcnt vmcnt(18)
    v_perm_b32 v230, v61, v60, v11
    s_waitcnt vmcnt(16)
    v_perm_b32 v231, v63, v62, v11
    s_waitcnt vmcnt(14)
    v_perm_b32 v232, v65, v64, v11
    s_waitcnt vmcnt(12)
    v_perm_b32 v233, v67, v66, v11
    s_waitcnt vmcnt(10)
    v_perm_b32 v234, v69, v68, v11
    s_waitcnt vmcnt(8)
    v_perm_b32 v235, v71, v70, v11
    s_waitcnt vmcnt(6)
    v_perm_b32 v236, v73, v72, v11
    s_waitcnt vmcnt(4)
    v_perm_b32 v237, v75, v74, v11
    s_waitcnt vmcnt(2)
    v_perm_b32 v238, v77, v76, v11
    s_waitcnt vmcnt(0)
    v_perm_b32 v239, v79, v78, v11
    v_mul_u32_u24 v5, 82944, v9
    v_add_u32 v12, v5, v14
    v_add_u32 v13, 1152, v12
    s_add_u32 s17, s49, 18432
    buffer_load_dword v16, v12, s[20:23], s17 offen
    buffer_load_dword v17, v13, s[20:23], s17 offen
    s_add_u32 s17, s49, 20736
    buffer_load_dword v18, v12, s[20:23], s17 offen
    buffer_load_dword v19, v13, s[20:23], s17 offen
    s_add_u32 s17, s49, 59904
    buffer_load_dword v20, v12, s[20:23], s17 offen
    buffer_load_dword v21, v13, s[20:23], s17 offen
    s_add_u32 s17, s49, 62208
    buffer_load_dword v22, v12, s[20:23], s17 offen
    buffer_load_dword v23, v13, s[20:23], s17 offen
    s_add_u32 s17, s49, 184320
    buffer_load_dword v24, v12, s[20:23], s17 offen
    buffer_load_dword v25, v13, s[20:23], s17 offen
    s_add_u32 s17, s49, 186624
    buffer_load_dword v26, v12, s[20:23], s17 offen
    buffer_load_dword v27, v13, s[20:23], s17 offen
    s_add_u32 s17, s49, 225792
    buffer_load_dword v28, v12, s[20:23], s17 offen
    buffer_load_dword v29, v13, s[20:23], s17 offen
    s_add_u32 s17, s49, 228096
    buffer_load_dword v30, v12, s[20:23], s17 offen
    buffer_load_dword v31, v13, s[20:23], s17 offen
    s_add_u32 s17, s49, 350208
    buffer_load_dword v32, v12, s[20:23], s17 offen
    buffer_load_dword v33, v13, s[20:23], s17 offen
    s_add_u32 s17, s49, 352512
    buffer_load_dword v34, v12, s[20:23], s17 offen
    buffer_load_dword v35, v13, s[20:23], s17 offen
    s_add_u32 s17, s49, 391680
    buffer_load_dword v36, v12, s[20:23], s17 offen
    buffer_load_dword v37, v13, s[20:23], s17 offen
    s_add_u32 s17, s49, 393984
    buffer_load_dword v38, v12, s[20:23], s17 offen
    buffer_load_dword v39, v13, s[20:23], s17 offen
    s_add_u32 s17, s49, 516096
    buffer_load_dword v40, v12, s[20:23], s17 offen
    buffer_load_dword v41, v13, s[20:23], s17 offen
    s_add_u32 s17, s49, 518400
    buffer_load_dword v42, v12, s[20:23], s17 offen
    buffer_load_dword v43, v13, s[20:23], s17 offen
    s_add_u32 s17, s49, 557568
    buffer_load_dword v44, v12, s[20:23], s17 offen
    buffer_load_dword v45, v13, s[20:23], s17 offen
    s_add_u32 s17, s49, 559872
    buffer_load_dword v46, v12, s[20:23], s17 offen
    buffer_load_dword v47, v13, s[20:23], s17 offen
    s_waitcnt vmcnt(30)
    v_perm_b32 v240, v17, v16, v11
    s_waitcnt vmcnt(28)
    v_perm_b32 v241, v19, v18, v11
    s_waitcnt vmcnt(26)
    v_perm_b32 v242, v21, v20, v11
    s_waitcnt vmcnt(24)
    v_perm_b32 v243, v23, v22, v11
    s_waitcnt vmcnt(22)
    v_perm_b32 v244, v25, v24, v11
    s_waitcnt vmcnt(20)
    v_perm_b32 v245, v27, v26, v11
    s_waitcnt vmcnt(18)
    v_perm_b32 v246, v29, v28, v11
    s_waitcnt vmcnt(16)
    v_perm_b32 v247, v31, v30, v11
    s_waitcnt vmcnt(14)
    v_perm_b32 v248, v33, v32, v11
    s_waitcnt vmcnt(12)
    v_perm_b32 v249, v35, v34, v11
    s_waitcnt vmcnt(10)
    v_perm_b32 v250, v37, v36, v11
    s_waitcnt vmcnt(8)
    v_perm_b32 v251, v39, v38, v11
    s_waitcnt vmcnt(6)
    v_perm_b32 v252, v41, v40, v11
    s_waitcnt vmcnt(4)
    v_perm_b32 v253, v43, v42, v11
    s_waitcnt vmcnt(2)
    v_perm_b32 v254, v45, v44, v11
    s_waitcnt vmcnt(0)
    v_perm_b32 v255, v47, v46, v11
    v_lshlrev_b32 v10, 4, v10
    v_lshl_add_u32 v14, v9, 9, v10
    s_lshl_b32 s17, s50, 11
    v_add_u32 v14, s17, v14
    v_lshrrev_b32 v10, 1, v10
    s_lshl_b32 s17, s50, 8
    v_add_u32 v10, s17, v10
    s_lshr_b32 s49, s50, 2
    s_lshl_b32 s49, s49, 7
    s_and_b32 s17, s50, 3
    s_lshl_b32 s17, s17, 2
    s_add_u32 s49, s49, s17
    s_add_u32 s49, s49, 183808
    s_mov_b32 s36, s63
    s_mov_b32 s34, s63
    s_mov_b32 s37, 0
    s_lshl_b32 s56, s63, 6
    s_mul_i32 s58, s14, 9216
    s_mov_b32 s40, 36864
    s_mov_b32 s59, s58
    s_mov_b32 s43, 0
    s_mov_b32 s28, s8
    s_mov_b32 s29, s9
    s_mov_b32 s30, 0
    s_mov_b32 s31, 0x00020000
    s_mul_i32 s41, s63, 2359296
    s_add_u32 s41, s41, s58
    s_add_u32 s41, s41, 17301504
    s_mul_i32 s42, s56, 22528
    s_add_u32 s42, s42, 181760
    s_cmp_lg_u32 s14, 0
    s_cbranch_scc1 Lawo_ini_d
    v_mov_b32 v5, 160
    s_mov_b32 s16, 0
Lawo_ini:
    global_load_dword v6, v5, s[12:13] sc1
    s_add_u32 s16, s16, 1
    s_cmp_gt_u32 s16, 100000
    s_cbranch_scc1 L_role_awo_abort
    s_waitcnt vmcnt(0)
    v_cmp_gt_u32 vcc, 123, v6
    s_nop 0
    s_cbranch_vccz Lawo_ini_d
    s_sleep 8
    s_branch Lawo_ini
Lawo_ini_d:
    s_barrier
    s_branch Lawo_poll
Lawo_item:
    s_waitcnt vmcnt(3)
Lawo_go:
    s_barrier
    s_xor_b32 s40, s40, 36864
    s_xor_b32 s59, s59, 36864
    s_xor_b32 s66, s66, 0x2000
    s_xor_b32 s71, s71, 0x2000
    s_mov_b32 s35, s37
    s_mov_b32 s57, s56
    s_add_u32 s37, s37, 1
    s_add_u32 s56, s56, 1
    s_add_u32 s41, s41, 36864
    s_add_u32 s42, s42, 22528
    s_mov_b32 s62, 0
    v_add_u32 v9, s40, v0
    ds_read_b128 v[32:35], v9 offset:0
    ds_read_b128 v[36:39], v9 offset:1024
    ds_read_b128 v[40:43], v9 offset:2048
    ds_read_b128 v[44:47], v9 offset:3072
    ds_read_b128 v[48:51], v9 offset:4096
    ds_read_b128 v[52:55], v9 offset:5120
    ds_read_b128 v[56:59], v9 offset:6144
    v_lshlrev_b32 v16, 16, v64
    v_and_b32 v17, 0xffff0000, v64
    v_lshlrev_b32 v18, 16, v65
    v_and_b32 v19, 0xffff0000, v65
    v_lshlrev_b32 v20, 16, v66
    v_and_b32 v21, 0xffff0000, v66
    v_lshlrev_b32 v22, 16, v67
    v_and_b32 v23, 0xffff0000, v67
    v_lshlrev_b32 v24, 16, v68
    v_and_b32 v25, 0xffff0000, v68
    v_lshlrev_b32 v26, 16, v69
    v_and_b32 v27, 0xffff0000, v69
    v_lshlrev_b32 v28, 16, v70
    v_and_b32 v29, 0xffff0000, v70
    v_lshlrev_b32 v30, 16, v71
    v_and_b32 v31, 0xffff0000, v71
    s_waitcnt lgkmcnt(6)
    s_nop 0
    v_mfma_f32_32x32x16_bf16 v[16:31], v[112:115], v[32:35], v[16:31]
    ds_read_b128 v[60:63], v9 offset:7168
    s_mul_i32 s46, s34, 4718592
    s_waitcnt lgkmcnt(6)
    v_mfma_f32_32x32x16_bf16 v[16:31], v[116:119], v[36:39], v[16:31]
    ds_read_b128 v[32:35], v9 offset:8192
    s_mul_i32 s51, s35, 36864
    s_waitcnt lgkmcnt(6)
    v_mfma_f32_32x32x16_bf16 v[16:31], v[120:123], v[40:43], v[16:31]
    ds_read_b128 v[36:39], v9 offset:9216
    s_add_u32 s46, s46, s51
    s_waitcnt lgkmcnt(6)
    v_mfma_f32_32x32x16_bf16 v[16:31], v[124:127], v[44:47], v[16:31]
    ds_read_b128 v[40:43], v9 offset:10240
    s_add_u32 s46, s46, 8650752
    s_waitcnt lgkmcnt(6)
    v_mfma_f32_32x32x16_bf16 v[16:31], v[128:131], v[48:51], v[16:31]
    ds_read_b128 v[44:47], v9 offset:11264
    s_mul_i32 s52, s34, 786432
    s_waitcnt lgkmcnt(6)
    v_mfma_f32_32x32x16_bf16 v[16:31], v[132:135], v[52:55], v[16:31]
    ds_read_b128 v[48:51], v9 offset:12288
    s_mul_i32 s51, s35, 6144
    s_waitcnt lgkmcnt(6)
    v_mfma_f32_32x32x16_bf16 v[16:31], v[136:139], v[56:59], v[16:31]
    ds_read_b128 v[52:55], v9 offset:13312
    s_add_u32 s52, s52, s51
    s_waitcnt lgkmcnt(6)
    v_mfma_f32_32x32x16_bf16 v[16:31], v[140:143], v[60:63], v[16:31]
    ds_read_b128 v[56:59], v9 offset:14336
    s_add_u32 s52, s52, 16121856
    s_waitcnt lgkmcnt(6)
    v_mfma_f32_32x32x16_bf16 v[16:31], v[144:147], v[32:35], v[16:31]
    ds_read_b128 v[60:63], v9 offset:15360
    s_waitcnt lgkmcnt(6)
    v_mfma_f32_32x32x16_bf16 v[16:31], v[148:151], v[36:39], v[16:31]
    ds_read_b128 v[32:35], v9 offset:16384
    s_waitcnt lgkmcnt(6)
    v_mfma_f32_32x32x16_bf16 v[16:31], v[152:155], v[40:43], v[16:31]
    ds_read_b128 v[36:39], v9 offset:17408
    s_waitcnt lgkmcnt(6)
    v_mfma_f32_32x32x16_bf16 v[16:31], v[156:159], v[44:47], v[16:31]
    ds_read_b128 v[40:43], v9 offset:18432
    s_waitcnt lgkmcnt(6)
    v_mfma_f32_32x32x16_bf16 v[16:31], v[160:163], v[48:51], v[16:31]
    ds_read_b128 v[44:47], v9 offset:19456
    s_waitcnt lgkmcnt(6)
    v_mfma_f32_32x32x16_bf16 v[16:31], v[164:167], v[52:55], v[16:31]
    ds_read_b128 v[48:51], v9 offset:20480
    s_waitcnt lgkmcnt(6)
    v_mfma_f32_32x32x16_bf16 v[16:31], v[168:171], v[56:59], v[16:31]
    ds_read_b128 v[52:55], v9 offset:21504
    s_waitcnt vmcnt(0)
    buffer_load_dword v2, v1, s[8:11], s42 offen sc1
    s_cmp_lg_u32 s43, 0
    s_cselect_b64 exec, 1, 0
    buffer_store_dword v3, v4, s[8:11], s43 offen sc1
    s_mov_b64 exec, -1
    s_mov_b32 s43, 0
    s_waitcnt lgkmcnt(6)
    v_mfma_f32_32x32x16_bf16 v[16:31], v[172:175], v[60:63], v[16:31]
    ds_read_b128 v[56:59], v9 offset:22528
    s_waitcnt lgkmcnt(6)
    v_mfma_f32_32x32x16_bf16 v[16:31], v[176:179], v[32:35], v[16:31]
    ds_read_b128 v[60:63], v9 offset:23552
    s_waitcnt lgkmcnt(6)
    v_mfma_f32_32x32x16_bf16 v[16:31], v[180:183], v[36:39], v[16:31]
    ds_read_b128 v[32:35], v9 offset:24576
    s_waitcnt lgkmcnt(6)
    v_mfma_f32_32x32x16_bf16 v[16:31], v[184:187], v[40:43], v[16:31]
    ds_read_b128 v[36:39], v9 offset:25600
    s_waitcnt lgkmcnt(6)
    v_mfma_f32_32x32x16_bf16 v[16:31], v[188:191], v[44:47], v[16:31]
    ds_read_b128 v[40:43], v9 offset:26624
    s_waitcnt lgkmcnt(6)
    v_mfma_f32_32x32x16_bf16 v[16:31], v[192:195], v[48:51], v[16:31]
    ds_read_b128 v[44:47], v9 offset:27648
    s_waitcnt lgkmcnt(6)
    v_mfma_f32_32x32x16_bf16 v[16:31], v[196:199], v[52:55], v[16:31]
    ds_read_b128 v[48:51], v9 offset:28672
    s_waitcnt lgkmcnt(6)
    v_mfma_f32_32x32x16_bf16 v[16:31], v[200:203], v[56:59], v[16:31]
    ds_read_b128 v[52:55], v9 offset:29696
    s_waitcnt lgkmcnt(6)
    v_mfma_f32_32x32x16_bf16 v[16:31], v[204:207], v[60:63], v[16:31]
    ds_read_b128 v[56:59], v9 offset:30720
    s_waitcnt lgkmcnt(6)
    v_mfma_f32_32x32x16_bf16 v[16:31], v[208:211], v[32:35], v[16:31]
    ds_read_b128 v[60:63], v9 offset:31744
    s_waitcnt lgkmcnt(6)
    v_mfma_f32_32x32x16_bf16 v[16:31], v[212:215], v[36:39], v[16:31]
    ds_read_b128 v[32:35], v9 offset:32768
    s_waitcnt lgkmcnt(6)
    v_mfma_f32_32x32x16_bf16 v[16:31], v[216:219], v[40:43], v[16:31]
    ds_read_b128 v[36:39], v9 offset:33792
    s_waitcnt lgkmcnt(6)
    v_mfma_f32_32x32x16_bf16 v[16:31], v[220:223], v[44:47], v[16:31]
    ds_read_b128 v[40:43], v9 offset:34816
    s_waitcnt lgkmcnt(6)
    v_mfma_f32_32x32x16_bf16 v[16:31], v[224:227], v[48:51], v[16:31]
    ds_read_b128 v[44:47], v9 offset:35840
    s_waitcnt lgkmcnt(6)
    v_mfma_f32_32x32x16_bf16 v[16:31], v[228:231], v[52:55], v[16:31]
    s_waitcnt lgkmcnt(5)
    v_mfma_f32_32x32x16_bf16 v[16:31], v[232:235], v[56:59], v[16:31]
    s_waitcnt lgkmcnt(4)
    v_mfma_f32_32x32x16_bf16 v[16:31], v[236:239], v[60:63], v[16:31]
    s_waitcnt lgkmcnt(3)
    v_mfma_f32_32x32x16_bf16 v[16:31], v[240:243], v[32:35], v[16:31]
    s_waitcnt vmcnt(1)
    v_cmp_eq_u32 vcc, 0, v2
    s_nop 0
    s_cmp_eq_u64 vcc, 0
    s_cselect_b32 s62, 1, 0
    s_cmp_lt_u32 s37, 64
    s_cselect_b32 s62, s62, 0
    s_cmp_lg_u32 s62, 0
    s_cselect_b32 s30, 268435456, 0
    s_waitcnt lgkmcnt(2)
    v_mfma_f32_32x32x16_bf16 v[16:31], v[244:247], v[36:39], v[16:31]
    s_add_u32 m0, s59, 0
    s_add_u32 s47, s41, 0
    buffer_load_dwordx4 v0, s[28:31], s47 offen offset:0 lds
    buffer_load_dwordx4 v0, s[28:31], s47 offen offset:1024 lds
    s_waitcnt lgkmcnt(1)
    v_mfma_f32_32x32x16_bf16 v[16:31], v[248:251], v[40:43], v[16:31]
    buffer_load_dwordx4 v0, s[28:31], s47 offen offset:2048 lds
    buffer_load_dwordx4 v0, s[28:31], s47 offen offset:3072 lds
    s_waitcnt lgkmcnt(0)
    v_mfma_f32_32x32x16_bf16 v[16:31], v[252:255], v[44:47], v[16:31]
    s_add_u32 m0, s59, 4096
    s_add_u32 s47, s41, 4096
    buffer_load_dwordx4 v0, s[28:31], s47 offen offset:0 lds
    buffer_load_dwordx4 v0, s[28:31], s47 offen offset:1024 lds
    buffer_load_dwordx4 v0, s[28:31], s47 offen offset:2048 lds
    buffer_load_dwordx4 v0, s[28:31], s47 offen offset:3072 lds
    s_add_u32 m0, s59, 8192
    s_add_u32 s47, s41, 8192
    buffer_load_dwordx4 v0, s[28:31], s47 offen offset:0 lds
    s_mul_i32 s48, s36, 4718592
    s_mul_i32 s18, s37, 36864
    s_add_u32 s48, s48, s18
    s_add_u32 s48, s48, 6291456
    buffer_load_dwordx4 v[64:67], v14, s[28:31], s48 offen offset:0
    buffer_load_dwordx4 v[68:71], v14, s[28:31], s48 offen offset:1024
    v_cvt_pk_bf16_f32 v32, v16, v17
    v_cvt_pk_bf16_f32 v33, v18, v19
    v_cvt_pk_bf16_f32 v34, v20, v21
    v_cvt_pk_bf16_f32 v35, v22, v23
    buffer_store_dwordx4 v[32:35], v14, s[8:11], s46 offen offset:0 sc1
    v_cvt_pk_bf16_f32 v36, v24, v25
    v_cvt_pk_bf16_f32 v37, v26, v27
    v_cvt_pk_bf16_f32 v38, v28, v29
    v_cvt_pk_bf16_f32 v39, v30, v31
    buffer_store_dwordx4 v[36:39], v14, s[8:11], s46 offen offset:1024 sc1
    v_add_f32 v72, v16, v17
    v_mul_f32 v73, v16, v16
    v_fmac_f32 v73, v17, v17
    v_add_f32 v72, v72, v18
    v_fmac_f32 v73, v18, v18
    v_add_f32 v72, v72, v19
    v_fmac_f32 v73, v19, v19
    v_add_f32 v72, v72, v20
    v_fmac_f32 v73, v20, v20
    v_add_f32 v72, v72, v21
    v_fmac_f32 v73, v21, v21
    v_add_f32 v72, v72, v22
    v_fmac_f32 v73, v22, v22
    v_add_f32 v72, v72, v23
    v_fmac_f32 v73, v23, v23
    v_add_f32 v72, v72, v24
    v_fmac_f32 v73, v24, v24
    v_add_f32 v72, v72, v25
    v_fmac_f32 v73, v25, v25
    v_add_f32 v72, v72, v26
    v_fmac_f32 v73, v26, v26
    v_add_f32 v72, v72, v27
    v_fmac_f32 v73, v27, v27
    v_add_f32 v72, v72, v28
    v_fmac_f32 v73, v28, v28
    v_add_f32 v72, v72, v29
    v_fmac_f32 v73, v29, v29
    v_add_f32 v72, v72, v30
    v_fmac_f32 v73, v30, v30
    v_add_f32 v72, v72, v31
    v_fmac_f32 v73, v31, v31
    v_mov_b32 v74, v72
    v_mov_b32 v75, v73
    s_nop 0
    v_permlane32_swap_b32 v72, v74
    v_permlane32_swap_b32 v73, v75
    v_add_f32 v72, v72, v74
    v_add_f32 v73, v73, v75
    buffer_store_dwordx2 v[72:73], v10, s[8:11], s52 offen sc1
    s_mul_i32 s43, s57, 22528
    s_add_u32 s43, s43, s49
    s_cmp_lg_u32 s62, 0
    s_cbranch_scc1 Lawo_item
    buffer_load_dword v2, v1, s[8:11], s42 offen sc1
    s_waitcnt vmcnt(0)
    s_cmp_ge_u32 s37, 64
    s_cbranch_scc1 Lawo_fin
    v_cmp_eq_u32 vcc, 0, v2
    s_nop 0
    s_cmp_lg_u64 vcc, 0
    s_cbranch_scc1 Lawo_pub
    s_add_u32 m0, s59, 0
    s_add_u32 s47, s41, 0
    buffer_load_dwordx4 v0, s[8:11], s47 offen offset:0 lds
    buffer_load_dwordx4 v0, s[8:11], s47 offen offset:1024 lds
    buffer_load_dwordx4 v0, s[8:11], s47 offen offset:2048 lds
    buffer_load_dwordx4 v0, s[8:11], s47 offen offset:3072 lds
    s_add_u32 m0, s59, 4096
    s_add_u32 s47, s41, 4096
    buffer_load_dwordx4 v0, s[8:11], s47 offen offset:0 lds
    buffer_load_dwordx4 v0, s[8:11], s47 offen offset:1024 lds
    buffer_load_dwordx4 v0, s[8:11], s47 offen offset:2048 lds
    buffer_load_dwordx4 v0, s[8:11], s47 offen offset:3072 lds
    s_add_u32 m0, s59, 8192
    s_add_u32 s47, s41, 8192
    buffer_load_dwordx4 v0, s[8:11], s47 offen offset:0 lds
    s_mul_i32 s48, s36, 4718592
    s_mul_i32 s18, s37, 36864
    s_add_u32 s48, s48, s18
    s_add_u32 s48, s48, 6291456
    buffer_load_dwordx4 v[64:67], v14, s[8:11], s48 offen offset:0
    buffer_load_dwordx4 v[68:71], v14, s[8:11], s48 offen offset:1024
    s_cmp_lg_u32 s43, 0
    s_cselect_b64 exec, 1, 0
    buffer_store_dword v3, v4, s[8:11], s43 offen sc1
    s_mov_b64 exec, -1
    s_mov_b32 s43, 0
    s_waitcnt vmcnt(1)
    s_branch Lawo_go
Lawo_fin:
    s_cmp_lg_u32 s43, 0
    s_cselect_b64 exec, 1, 0
    buffer_store_dword v3, v4, s[8:11], s43 offen sc1
    s_mov_b64 exec, -1
    s_mov_b32 s43, 0
    s_branch L_role_awo_exit
Lawo_pub:
    s_cmp_lg_u32 s43, 0
    s_cselect_b64 exec, 1, 0
    buffer_store_dword v3, v4, s[8:11], s43 offen sc1
    s_mov_b64 exec, -1
    s_mov_b32 s43, 0
Lawo_poll:
    s_mov_b32 s16, 0
Lawo_pl:
    buffer_load_dword v2, v1, s[8:11], s42 offen sc1
    s_add_u32 s16, s16, 1
    s_cmp_gt_u32 s16, 100000
    s_cbranch_scc1 L_role_awo_abort
    s_waitcnt vmcnt(0)
    v_cmp_eq_u32 vcc, 0, v2
    s_nop 0
    s_cmp_eq_u64 vcc, 0
    s_cbranch_scc1 Lawo_pld
    s_sleep 2
    s_branch Lawo_pl
Lawo_pld:
    s_add_u32 m0, s59, 0
    s_add_u32 s47, s41, 0
    buffer_load_dwordx4 v0, s[8:11], s47 offen offset:0 lds
    buffer_load_dwordx4 v0, s[8:11], s47 offen offset:1024 lds
    buffer_load_dwordx4 v0, s[8:11], s47 offen offset:2048 lds
    buffer_load_dwordx4 v0, s[8:11], s47 offen offset:3072 lds
    s_add_u32 m0, s59, 4096
    s_add_u32 s47, s41, 4096
    buffer_load_dwordx4 v0, s[8:11], s47 offen offset:0 lds
    buffer_load_dwordx4 v0, s[8:11], s47 offen offset:1024 lds
    buffer_load_dwordx4 v0, s[8:11], s47 offen offset:2048 lds
    buffer_load_dwordx4 v0, s[8:11], s47 offen offset:3072 lds
    s_add_u32 m0, s59, 8192
    s_add_u32 s47, s41, 8192
    buffer_load_dwordx4 v0, s[8:11], s47 offen offset:0 lds
    s_mul_i32 s48, s36, 4718592
    s_mul_i32 s18, s37, 36864
    s_add_u32 s48, s48, s18
    s_add_u32 s48, s48, 6291456
    buffer_load_dwordx4 v[64:67], v14, s[8:11], s48 offen offset:0
    buffer_load_dwordx4 v[68:71], v14, s[8:11], s48 offen offset:1024
    s_waitcnt vmcnt(0)
    s_branch Lawo_go
L_role_awo_abort:
    s_waitcnt lgkmcnt(0)
    s_mov_b64 exec, -1
    v_mov_b32 v0, 60
    s_lshl_b32 s5, s3, 8
    s_or_b32 s5, s5, s4
    s_or_b32 s5, s5, 0x10000
    v_mov_b32 v1, s5
    global_store_dword v0, v1, s[12:13]
    s_endpgm
L_role_awo_exit:
    s_endpgm
.p2align 6
L_role_aq:
    v_and_b32 v5, 63, v0
    v_lshlrev_b32 v0, 4, v5
    v_and_b32 v7, 15, v5
    v_lshrrev_b32 v8, 4, v5
    v_min_u32 v1, 47, v5
    v_lshrrev_b32 v6, 2, v1
    v_and_b32 v1, 3, v1
    v_lshlrev_b32 v1, 2, v1
    v_lshl_add_u32 v1, v6, 7, v1
    v_mov_b32 v3, 1
    v_mov_b32 v4, 0
    s_mov_b32 s44, 0x05040100
    s_mov_b32 s45, 0x07060302
    s_lshr_b32 s63, s15, 4
    s_and_b32 s15, s15, 15
    s_lshl_b32 s50, s15, 1
    s_lshr_b32 s17, s14, 1
    s_add_u32 s50, s50, s17
    s_and_b32 s51, s14, 1
    s_mul_i32 s49, s50, 36
    s_cmp_eq_u32 s63, 0
    s_cbranch_scc1 Laq_noord
    s_cmp_lg_u32 s14, 0
    s_cbranch_scc1 Laq_ord_d
    v_mov_b32 v5, 48
    s_mov_b32 s16, 0
Laq_ord:
    global_load_dword v6, v5, s[12:13] sc1
    s_add_u32 s16, s16, 1
    s_cmp_gt_u32 s16, 100000
    s_cbranch_scc1 L_role_aq_abort
    s_waitcnt vmcnt(0)
    v_cmp_gt_u32 vcc, 1, v6
    s_nop 0
    s_cbranch_vccz Laq_ord_d
    s_sleep 64
    s_branch Laq_ord
Laq_ord_d:
    s_barrier
Laq_noord:
    s_load_dwordx2 s[20:21], s[0:1], 8
    s_mov_b32 s22, 1990656
    s_mov_b32 s23, 0x00020000
    s_waitcnt lgkmcnt(0)
    s_and_b32 s21, s21, 0xffff
    v_lshrrev_b32 v24, 4, v0
    v_add_u32 v24, 0, v24
    v_mul_u32_u24 v25, 4370, v24
    v_lshrrev_b32 v25, 16, v25
    v_mul_u32_u24 v26, 15, v25
    v_sub_u32 v24, v24, v26
    v_mul_u32_u24 v16, 3456, v25
    v_mul_u32_u24 v25, 13108, v24
    v_lshrrev_b32 v25, 16, v25
    v_mul_u32_u24 v26, 5, v25
    v_sub_u32 v24, v24, v26
    v_mul_u32_u24 v25, 1152, v25
    v_lshlrev_b32 v24, 4, v24
    v_add3_u32 v16, v16, v24, v25
    v_lshrrev_b32 v24, 4, v0
    v_add_u32 v24, 64, v24
    v_mul_u32_u24 v25, 4370, v24
    v_lshrrev_b32 v25, 16, v25
    v_mul_u32_u24 v26, 15, v25
    v_sub_u32 v24, v24, v26
    v_mul_u32_u24 v17, 3456, v25
    v_mul_u32_u24 v25, 13108, v24
    v_lshrrev_b32 v25, 16, v25
    v_mul_u32_u24 v26, 5, v25
    v_sub_u32 v24, v24, v26
    v_mul_u32_u24 v25, 1152, v25
    v_lshlrev_b32 v24, 4, v24
    v_add3_u32 v17, v17, v24, v25
    s_mul_i32 s49, s15, 72
    s_and_b32 s48, s49, 15
    s_and_b32 s49, s49, -16
    s_mul_i32 s17, s14, 27648
    s_add_u32 s49, s49, s17
    s_mul_i32 s46, s14, 1920
    s_mov_b32 s54, -1
    s_mov_b32 s55, 0x00ffffff
    s_add_u32 s17, s49, 0
    s_add_u32 m0, s46, 0
    s_nop 0
    buffer_load_dwordx4 v16, s[20:23], s17 offen lds
    s_add_u32 m0, s46, 1024
    s_mov_b64 exec, s[54:55]
    buffer_load_dwordx4 v17, s[20:23], s17 offen lds
    s_mov_b64 exec, -1
    s_add_u32 s17, s49, 110592
    s_add_u32 m0, s46, 7680
    s_nop 0
    buffer_load_dwordx4 v16, s[20:23], s17 offen lds
    s_add_u32 m0, s46, 8704
    s_mov_b64 exec, s[54:55]
    buffer_load_dwordx4 v17, s[20:23], s17 offen lds
    s_mov_b64 exec, -1
    s_add_u32 s17, s49, 221184
    s_add_u32 m0, s46, 15360
    s_nop 0
    buffer_load_dwordx4 v16, s[20:23], s17 offen lds
    s_add_u32 m0, s46, 16384
    s_mov_b64 exec, s[54:55]
    buffer_load_dwordx4 v17, s[20:23], s17 offen lds
    s_mov_b64 exec, -1
    s_add_u32 s17, s49, 331776
    s_add_u32 m0, s46, 23040
    s_nop 0
    buffer_load_dwordx4 v16, s[20:23], s17 offen lds
    s_add_u32 m0, s46, 24064
    s_mov_b64 exec, s[54:55]
    buffer_load_dwordx4 v17, s[20:23], s17 offen lds
    s_mov_b64 exec, -1
    s_add_u32 s17, s49, 442368
    s_add_u32 m0, s46, 30720
    s_nop 0
    buffer_load_dwordx4 v16, s[20:23], s17 offen lds
    s_add_u32 m0, s46, 31744
    s_mov_b64 exec, s[54:55]
    buffer_load_dwordx4 v17, s[20:23], s17 offen lds
    s_mov_b64 exec, -1
    s_add_u32 s17, s49, 552960
    s_add_u32 m0, s46, 38400
    s_nop 0
    buffer_load_dwordx4 v16, s[20:23], s17 offen lds
    s_add_u32 m0, s46, 39424
    s_mov_b64 exec, s[54:55]
    buffer_load_dwordx4 v17, s[20:23], s17 offen lds
    s_mov_b64 exec, -1
    s_add_u32 s17, s49, 663552
    s_add_u32 m0, s46, 46080
    s_nop 0
    buffer_load_dwordx4 v16, s[20:23], s17 offen lds
    s_add_u32 m0, s46, 47104
    s_mov_b64 exec, s[54:55]
    buffer_load_dwordx4 v17, s[20:23], s17 offen lds
    s_mov_b64 exec, -1
    s_add_u32 s17, s49, 774144
    s_add_u32 m0, s46, 53760
    s_nop 0
    buffer_load_dwordx4 v16, s[20:23], s17 offen lds
    s_add_u32 m0, s46, 54784
    s_mov_b64 exec, s[54:55]
    buffer_load_dwordx4 v17, s[20:23], s17 offen lds
    s_mov_b64 exec, -1
    s_add_u32 s17, s49, 884736
    s_add_u32 m0, s46, 61440
    s_nop 0
    buffer_load_dwordx4 v16, s[20:23], s17 offen lds
    s_add_u32 m0, s46, 62464
    s_mov_b64 exec, s[54:55]
    buffer_load_dwordx4 v17, s[20:23], s17 offen lds
    s_mov_b64 exec, -1
    s_add_u32 s17, s49, 995328
    s_add_u32 m0, s46, 69120
    s_nop 0
    buffer_load_dwordx4 v16, s[20:23], s17 offen lds
    s_add_u32 m0, s46, 70144
    s_mov_b64 exec, s[54:55]
    buffer_load_dwordx4 v17, s[20:23], s17 offen lds
    s_mov_b64 exec, -1
    s_add_u32 s17, s49, 1105920
    s_add_u32 m0, s46, 76800
    s_nop 0
    buffer_load_dwordx4 v16, s[20:23], s17 offen lds
    s_add_u32 m0, s46, 77824
    s_mov_b64 exec, s[54:55]
    buffer_load_dwordx4 v17, s[20:23], s17 offen lds
    s_mov_b64 exec, -1
    s_add_u32 s17, s49, 1216512
    s_add_u32 m0, s46, 84480
    s_nop 0
    buffer_load_dwordx4 v16, s[20:23], s17 offen lds
    s_add_u32 m0, s46, 85504
    s_mov_b64 exec, s[54:55]
    buffer_load_dwordx4 v17, s[20:23], s17 offen lds
    s_mov_b64 exec, -1
    s_lshr_b32 s47, s14, 1
    s_mul_i32 s17, s47, 40
    s_add_u32 s17, s17, s48
    s_mul_i32 s18, s47, 4
    s_add_u32 s18, s18, s48
    s_add_u32 s18, s18, 32
    s_lshl_b32 s19, s47, 4
    s_add_u32 s19, s19, 138240
    v_lshrrev_b32 v5, 2, v7
    v_lshl_add_u32 v5, v8, 3, v5
    v_and_b32 v6, 3, v7
    v_mul_u32_u24 v19, 240, v5
    v_add_u32 v19, s17, v19
    v_lshl_add_u32 v19, v6, 3, v19
    v_lshlrev_b32 v20, 5, v5
    v_add_u32 v20, s19, v20
    v_mov_b32 v22, 156672
    v_cmp_eq_u32 vcc, 0, v6
    s_nop 1
    v_cndmask_b32 v20, v22, v20, vcc
    v_cndmask_b32 v21, 0, -1, vcc
    v_bfe_u32 v5, v0, 4, 5
    v_mul_u32_u24 v23, 240, v5
    v_add_u32 v23, s18, v23
    v_lshlrev_b32 v28, 5, v5
    v_add_u32 v28, s19, v28
    v_mov_b32 v24, 0
    v_mov_b32 v25, 0
    v_mov_b32 v26, 0
    v_mov_b32 v27, 0
    v_lshlrev_b32 v22, 4, v7
    v_add_u32 v22, 156672, v22
    ds_write_b128 v22, v[24:27]
    v_mov_b32 v104, 0x3f803f80
    v_mov_b32 v105, 0x3f803f80
    v_mov_b32 v106, 0x3f803f80
    v_mov_b32 v107, 0x3f803f80
    s_waitcnt vmcnt(12) lgkmcnt(0)
    s_barrier
    v_add_u32 v60, 0, v23
    v_mov_b32 v59, 0
    ds_read_b32 v56, v60
    ds_read_b32 v57, v60 offset:80
    ds_read_b32 v58, v60 offset:160
    v_add_u32 v68, 7680, v23
    v_mov_b32 v67, 0
    ds_read_b32 v64, v68
    ds_read_b32 v65, v68 offset:80
    ds_read_b32 v66, v68 offset:160
    v_add_u32 v76, 15360, v23
    v_mov_b32 v75, 0
    ds_read_b32 v72, v76
    ds_read_b32 v73, v76 offset:80
    ds_read_b32 v74, v76 offset:160
    v_add_u32 v84, 23040, v23
    v_mov_b32 v83, 0
    ds_read_b32 v80, v84
    ds_read_b32 v81, v84 offset:80
    ds_read_b32 v82, v84 offset:160
    v_add_u32 v92, 30720, v23
    v_mov_b32 v91, 0
    ds_read_b32 v88, v92
    ds_read_b32 v89, v92 offset:80
    ds_read_b32 v90, v92 offset:160
    v_add_u32 v100, 38400, v23
    v_mov_b32 v99, 0
    ds_read_b32 v96, v100
    ds_read_b32 v97, v100 offset:80
    ds_read_b32 v98, v100 offset:160
    v_add_u32 v61, 0, v19
    ds_read_b64_tr_b16 v[152:153], v61 offset:0
    ds_read_b64_tr_b16 v[224:225], v61 offset:80
    ds_read_b64_tr_b16 a[112:113], v61 offset:160
    ds_read_b64_tr_b16 v[154:155], v61 offset:960
    ds_read_b64_tr_b16 v[226:227], v61 offset:1040
    ds_read_b64_tr_b16 a[114:115], v61 offset:1120
    v_add_u32 v69, 7680, v19
    ds_read_b64_tr_b16 v[156:157], v69 offset:0
    ds_read_b64_tr_b16 v[228:229], v69 offset:80
    ds_read_b64_tr_b16 a[116:117], v69 offset:160
    ds_read_b64_tr_b16 v[158:159], v69 offset:960
    ds_read_b64_tr_b16 v[230:231], v69 offset:1040
    ds_read_b64_tr_b16 a[118:119], v69 offset:1120
    v_add_u32 v77, 15360, v19
    ds_read_b64_tr_b16 v[160:161], v77 offset:0
    ds_read_b64_tr_b16 v[232:233], v77 offset:80
    ds_read_b64_tr_b16 a[120:121], v77 offset:160
    ds_read_b64_tr_b16 v[162:163], v77 offset:960
    ds_read_b64_tr_b16 v[234:235], v77 offset:1040
    ds_read_b64_tr_b16 a[122:123], v77 offset:1120
    v_add_u32 v85, 23040, v19
    ds_read_b64_tr_b16 v[164:165], v85 offset:0
    ds_read_b64_tr_b16 v[236:237], v85 offset:80
    ds_read_b64_tr_b16 a[124:125], v85 offset:160
    ds_read_b64_tr_b16 v[166:167], v85 offset:960
    ds_read_b64_tr_b16 v[238:239], v85 offset:1040
    ds_read_b64_tr_b16 a[126:127], v85 offset:1120
    v_add_u32 v93, 30720, v19
    ds_read_b64_tr_b16 v[168:169], v93 offset:0
    ds_read_b64_tr_b16 v[240:241], v93 offset:80
    ds_read_b64_tr_b16 a[128:129], v93 offset:160
    ds_read_b64_tr_b16 v[170:171], v93 offset:960
    ds_read_b64_tr_b16 v[242:243], v93 offset:1040
    ds_read_b64_tr_b16 a[130:131], v93 offset:1120
    v_add_u32 v101, 38400, v19
    ds_read_b64_tr_b16 v[172:173], v101 offset:0
    ds_read_b64_tr_b16 v[244:245], v101 offset:80
    ds_read_b64_tr_b16 a[132:133], v101 offset:160
    ds_read_b64_tr_b16 v[174:175], v101 offset:960
    ds_read_b64_tr_b16 v[246:247], v101 offset:1040
    ds_read_b64_tr_b16 a[134:135], v101 offset:1120
    s_waitcnt lgkmcnt(15)
    ds_write_b64 v28, v[56:57] offset:0
    ds_write_b64 v28, v[58:59] offset:8
    ds_write_b64 v28, v[64:65] offset:1024
    ds_write_b64 v28, v[66:67] offset:1032
    ds_write_b64 v28, v[72:73] offset:2048
    ds_write_b64 v28, v[74:75] offset:2056
    ds_write_b64 v28, v[80:81] offset:3072
    ds_write_b64 v28, v[82:83] offset:3080
    ds_write_b64 v28, v[88:89] offset:4096
    ds_write_b64 v28, v[90:91] offset:4104
    ds_write_b64 v28, v[96:97] offset:5120
    ds_write_b64 v28, v[98:99] offset:5128
    s_waitcnt lgkmcnt(0)
    v_and_b32 v56, 0, v21
    v_add_u32 v56, v56, v20
    ds_read_b64_tr_b16 a[40:41], v56 offset:0
    ds_read_b64_tr_b16 a[42:43], v56 offset:128
    v_and_b32 v57, 8, v21
    v_add_u32 v57, v57, v20
    ds_read_b64_tr_b16 a[184:185], v57 offset:0
    ds_read_b64_tr_b16 a[186:187], v57 offset:128
    v_and_b32 v64, 1024, v21
    v_add_u32 v64, v64, v20
    ds_read_b64_tr_b16 a[44:45], v64 offset:0
    ds_read_b64_tr_b16 a[46:47], v64 offset:128
    v_and_b32 v65, 1032, v21
    v_add_u32 v65, v65, v20
    ds_read_b64_tr_b16 a[188:189], v65 offset:0
    ds_read_b64_tr_b16 a[190:191], v65 offset:128
    v_and_b32 v72, 2048, v21
    v_add_u32 v72, v72, v20
    ds_read_b64_tr_b16 a[48:49], v72 offset:0
    ds_read_b64_tr_b16 a[50:51], v72 offset:128
    v_and_b32 v73, 2056, v21
    v_add_u32 v73, v73, v20
    ds_read_b64_tr_b16 a[192:193], v73 offset:0
    ds_read_b64_tr_b16 a[194:195], v73 offset:128
    v_and_b32 v80, 3072, v21
    v_add_u32 v80, v80, v20
    ds_read_b64_tr_b16 a[52:53], v80 offset:0
    ds_read_b64_tr_b16 a[54:55], v80 offset:128
    v_and_b32 v81, 3080, v21
    v_add_u32 v81, v81, v20
    ds_read_b64_tr_b16 a[196:197], v81 offset:0
    ds_read_b64_tr_b16 a[198:199], v81 offset:128
    v_and_b32 v88, 4096, v21
    v_add_u32 v88, v88, v20
    ds_read_b64_tr_b16 a[56:57], v88 offset:0
    ds_read_b64_tr_b16 a[58:59], v88 offset:128
    v_and_b32 v89, 4104, v21
    v_add_u32 v89, v89, v20
    ds_read_b64_tr_b16 a[200:201], v89 offset:0
    ds_read_b64_tr_b16 a[202:203], v89 offset:128
    v_and_b32 v96, 5120, v21
    v_add_u32 v96, v96, v20
    ds_read_b64_tr_b16 a[60:61], v96 offset:0
    ds_read_b64_tr_b16 a[62:63], v96 offset:128
    v_and_b32 v97, 5128, v21
    v_add_u32 v97, v97, v20
    ds_read_b64_tr_b16 a[204:205], v97 offset:0
    ds_read_b64_tr_b16 a[206:207], v97 offset:128
    s_waitcnt lgkmcnt(0)
    s_add_u32 s17, s49, 1327104
    s_add_u32 m0, s46, 92160
    s_nop 0
    buffer_load_dwordx4 v16, s[20:23], s17 offen lds
    s_add_u32 m0, s46, 93184
    s_mov_b64 exec, s[54:55]
    buffer_load_dwordx4 v17, s[20:23], s17 offen lds
    s_mov_b64 exec, -1
    s_add_u32 s17, s49, 1437696
    s_add_u32 m0, s46, 99840
    s_nop 0
    buffer_load_dwordx4 v16, s[20:23], s17 offen lds
    s_add_u32 m0, s46, 100864
    s_mov_b64 exec, s[54:55]
    buffer_load_dwordx4 v17, s[20:23], s17 offen lds
    s_mov_b64 exec, -1
    s_add_u32 s17, s49, 1548288
    s_add_u32 m0, s46, 107520
    s_nop 0
    buffer_load_dwordx4 v16, s[20:23], s17 offen lds
    s_add_u32 m0, s46, 108544
    s_mov_b64 exec, s[54:55]
    buffer_load_dwordx4 v17, s[20:23], s17 offen lds
    s_mov_b64 exec, -1
    s_add_u32 s17, s49, 1658880
    s_add_u32 m0, s46, 115200
    s_nop 0
    buffer_load_dwordx4 v16, s[20:23], s17 offen lds
    s_add_u32 m0, s46, 116224
    s_mov_b64 exec, s[54:55]
    buffer_load_dwordx4 v17, s[20:23], s17 offen lds
    s_mov_b64 exec, -1
    s_add_u32 s17, s49, 1769472
    s_add_u32 m0, s46, 122880
    s_nop 0
    buffer_load_dwordx4 v16, s[20:23], s17 offen lds
    s_add_u32 m0, s46, 123904
    s_mov_b64 exec, s[54:55]
    buffer_load_dwordx4 v17, s[20:23], s17 offen lds
    s_mov_b64 exec, -1
    s_add_u32 s17, s49, 1880064
    s_add_u32 m0, s46, 130560
    s_nop 0
    buffer_load_dwordx4 v16, s[20:23], s17 offen lds
    s_add_u32 m0, s46, 131584
    s_mov_b64 exec, s[54:55]
    buffer_load_dwordx4 v17, s[20:23], s17 offen lds
    s_mov_b64 exec, -1
    v_mfma_f32_16x16x32_bf16 v[36:39], v[152:155], v[104:107], 0
    v_mfma_f32_16x16x32_bf16 v[40:43], v[224:227], v[104:107], 0
    v_mfma_f32_16x16x32_bf16 v[44:47], a[40:43], v[104:107], 0
    v_mfma_f32_16x16x32_bf16 v[48:51], v[104:107], a[112:115], 0
    v_mfma_f32_16x16x32_bf16 v[52:55], v[104:107], a[184:187], 0
    v_mfma_f32_16x16x32_bf16 v[36:39], v[156:159], v[104:107], v[36:39]
    v_mfma_f32_16x16x32_bf16 v[40:43], v[228:231], v[104:107], v[40:43]
    v_mfma_f32_16x16x32_bf16 v[44:47], a[44:47], v[104:107], v[44:47]
    v_mfma_f32_16x16x32_bf16 v[48:51], v[104:107], a[116:119], v[48:51]
    v_mfma_f32_16x16x32_bf16 v[52:55], v[104:107], a[188:191], v[52:55]
    v_mfma_f32_16x16x32_bf16 v[36:39], v[160:163], v[104:107], v[36:39]
    v_mfma_f32_16x16x32_bf16 v[40:43], v[232:235], v[104:107], v[40:43]
    v_mfma_f32_16x16x32_bf16 v[44:47], a[48:51], v[104:107], v[44:47]
    v_mfma_f32_16x16x32_bf16 v[48:51], v[104:107], a[120:123], v[48:51]
    v_mfma_f32_16x16x32_bf16 v[52:55], v[104:107], a[192:195], v[52:55]
    v_mfma_f32_16x16x32_bf16 v[36:39], v[164:167], v[104:107], v[36:39]
    v_mfma_f32_16x16x32_bf16 v[40:43], v[236:239], v[104:107], v[40:43]
    v_mfma_f32_16x16x32_bf16 v[44:47], a[52:55], v[104:107], v[44:47]
    v_mfma_f32_16x16x32_bf16 v[48:51], v[104:107], a[124:127], v[48:51]
    v_mfma_f32_16x16x32_bf16 v[52:55], v[104:107], a[196:199], v[52:55]
    v_mfma_f32_16x16x32_bf16 v[36:39], v[168:171], v[104:107], v[36:39]
    v_mfma_f32_16x16x32_bf16 v[40:43], v[240:243], v[104:107], v[40:43]
    v_mfma_f32_16x16x32_bf16 v[44:47], a[56:59], v[104:107], v[44:47]
    v_mfma_f32_16x16x32_bf16 v[48:51], v[104:107], a[128:131], v[48:51]
    v_mfma_f32_16x16x32_bf16 v[52:55], v[104:107], a[200:203], v[52:55]
    v_mfma_f32_16x16x32_bf16 v[36:39], v[172:175], v[104:107], v[36:39]
    v_mfma_f32_16x16x32_bf16 v[40:43], v[244:247], v[104:107], v[40:43]
    v_mfma_f32_16x16x32_bf16 v[44:47], a[60:63], v[104:107], v[44:47]
    v_mfma_f32_16x16x32_bf16 v[48:51], v[104:107], a[132:135], v[48:51]
    v_mfma_f32_16x16x32_bf16 v[52:55], v[104:107], a[204:207], v[52:55]
    s_waitcnt vmcnt(12)
    s_barrier
    v_add_u32 v60, 46080, v23
    v_mov_b32 v59, 0
    ds_read_b32 v56, v60
    ds_read_b32 v57, v60 offset:80
    ds_read_b32 v58, v60 offset:160
    v_add_u32 v68, 53760, v23
    v_mov_b32 v67, 0
    ds_read_b32 v64, v68
    ds_read_b32 v65, v68 offset:80
    ds_read_b32 v66, v68 offset:160
    v_add_u32 v76, 61440, v23
    v_mov_b32 v75, 0
    ds_read_b32 v72, v76
    ds_read_b32 v73, v76 offset:80
    ds_read_b32 v74, v76 offset:160
    v_add_u32 v84, 69120, v23
    v_mov_b32 v83, 0
    ds_read_b32 v80, v84
    ds_read_b32 v81, v84 offset:80
    ds_read_b32 v82, v84 offset:160
    v_add_u32 v92, 76800, v23
    v_mov_b32 v91, 0
    ds_read_b32 v88, v92
    ds_read_b32 v89, v92 offset:80
    ds_read_b32 v90, v92 offset:160
    v_add_u32 v100, 84480, v23
    v_mov_b32 v99, 0
    ds_read_b32 v96, v100
    ds_read_b32 v97, v100 offset:80
    ds_read_b32 v98, v100 offset:160
    v_add_u32 v61, 46080, v19
    ds_read_b64_tr_b16 v[176:177], v61 offset:0
    ds_read_b64_tr_b16 v[248:249], v61 offset:80
    ds_read_b64_tr_b16 a[136:137], v61 offset:160
    ds_read_b64_tr_b16 v[178:179], v61 offset:960
    ds_read_b64_tr_b16 v[250:251], v61 offset:1040
    ds_read_b64_tr_b16 a[138:139], v61 offset:1120
    v_add_u32 v69, 53760, v19
    ds_read_b64_tr_b16 v[180:181], v69 offset:0
    ds_read_b64_tr_b16 v[252:253], v69 offset:80
    ds_read_b64_tr_b16 a[140:141], v69 offset:160
    ds_read_b64_tr_b16 v[182:183], v69 offset:960
    ds_read_b64_tr_b16 v[254:255], v69 offset:1040
    ds_read_b64_tr_b16 a[142:143], v69 offset:1120
    v_add_u32 v77, 61440, v19
    ds_read_b64_tr_b16 v[184:185], v77 offset:0
    ds_read_b64_tr_b16 a[0:1], v77 offset:80
    ds_read_b64_tr_b16 a[144:145], v77 offset:160
    ds_read_b64_tr_b16 v[186:187], v77 offset:960
    ds_read_b64_tr_b16 a[2:3], v77 offset:1040
    ds_read_b64_tr_b16 a[146:147], v77 offset:1120
    v_add_u32 v85, 69120, v19
    ds_read_b64_tr_b16 v[188:189], v85 offset:0
    ds_read_b64_tr_b16 a[4:5], v85 offset:80
    ds_read_b64_tr_b16 a[148:149], v85 offset:160
    ds_read_b64_tr_b16 v[190:191], v85 offset:960
    ds_read_b64_tr_b16 a[6:7], v85 offset:1040
    ds_read_b64_tr_b16 a[150:151], v85 offset:1120
    v_add_u32 v93, 76800, v19
    ds_read_b64_tr_b16 v[192:193], v93 offset:0
    ds_read_b64_tr_b16 a[8:9], v93 offset:80
    ds_read_b64_tr_b16 a[152:153], v93 offset:160
    ds_read_b64_tr_b16 v[194:195], v93 offset:960
    ds_read_b64_tr_b16 a[10:11], v93 offset:1040
    ds_read_b64_tr_b16 a[154:155], v93 offset:1120
    v_add_u32 v101, 84480, v19
    ds_read_b64_tr_b16 v[196:197], v101 offset:0
    ds_read_b64_tr_b16 a[12:13], v101 offset:80
    ds_read_b64_tr_b16 a[156:157], v101 offset:160
    ds_read_b64_tr_b16 v[198:199], v101 offset:960
    ds_read_b64_tr_b16 a[14:15], v101 offset:1040
    ds_read_b64_tr_b16 a[158:159], v101 offset:1120
    s_waitcnt lgkmcnt(15)
    ds_write_b64 v28, v[56:57] offset:6144
    ds_write_b64 v28, v[58:59] offset:6152
    ds_write_b64 v28, v[64:65] offset:7168
    ds_write_b64 v28, v[66:67] offset:7176
    ds_write_b64 v28, v[72:73] offset:8192
    ds_write_b64 v28, v[74:75] offset:8200
    ds_write_b64 v28, v[80:81] offset:9216
    ds_write_b64 v28, v[82:83] offset:9224
    ds_write_b64 v28, v[88:89] offset:10240
    ds_write_b64 v28, v[90:91] offset:10248
    ds_write_b64 v28, v[96:97] offset:11264
    ds_write_b64 v28, v[98:99] offset:11272
    s_waitcnt lgkmcnt(0)
    v_and_b32 v56, 6144, v21
    v_add_u32 v56, v56, v20
    ds_read_b64_tr_b16 a[64:65], v56 offset:0
    ds_read_b64_tr_b16 a[66:67], v56 offset:128
    v_and_b32 v57, 6152, v21
    v_add_u32 v57, v57, v20
    ds_read_b64_tr_b16 a[208:209], v57 offset:0
    ds_read_b64_tr_b16 a[210:211], v57 offset:128
    v_and_b32 v64, 7168, v21
    v_add_u32 v64, v64, v20
    ds_read_b64_tr_b16 a[68:69], v64 offset:0
    ds_read_b64_tr_b16 a[70:71], v64 offset:128
    v_and_b32 v65, 7176, v21
    v_add_u32 v65, v65, v20
    ds_read_b64_tr_b16 a[212:213], v65 offset:0
    ds_read_b64_tr_b16 a[214:215], v65 offset:128
    v_and_b32 v72, 8192, v21
    v_add_u32 v72, v72, v20
    ds_read_b64_tr_b16 a[72:73], v72 offset:0
    ds_read_b64_tr_b16 a[74:75], v72 offset:128
    v_and_b32 v73, 8200, v21
    v_add_u32 v73, v73, v20
    ds_read_b64_tr_b16 a[216:217], v73 offset:0
    ds_read_b64_tr_b16 a[218:219], v73 offset:128
    v_and_b32 v80, 9216, v21
    v_add_u32 v80, v80, v20
    ds_read_b64_tr_b16 a[76:77], v80 offset:0
    ds_read_b64_tr_b16 a[78:79], v80 offset:128
    v_and_b32 v81, 9224, v21
    v_add_u32 v81, v81, v20
    ds_read_b64_tr_b16 a[220:221], v81 offset:0
    ds_read_b64_tr_b16 a[222:223], v81 offset:128
    v_and_b32 v88, 10240, v21
    v_add_u32 v88, v88, v20
    ds_read_b64_tr_b16 a[80:81], v88 offset:0
    ds_read_b64_tr_b16 a[82:83], v88 offset:128
    v_and_b32 v89, 10248, v21
    v_add_u32 v89, v89, v20
    ds_read_b64_tr_b16 a[224:225], v89 offset:0
    ds_read_b64_tr_b16 a[226:227], v89 offset:128
    v_and_b32 v96, 11264, v21
    v_add_u32 v96, v96, v20
    ds_read_b64_tr_b16 a[84:85], v96 offset:0
    ds_read_b64_tr_b16 a[86:87], v96 offset:128
    v_and_b32 v97, 11272, v21
    v_add_u32 v97, v97, v20
    ds_read_b64_tr_b16 a[228:229], v97 offset:0
    ds_read_b64_tr_b16 a[230:231], v97 offset:128
    s_waitcnt lgkmcnt(0)
    v_mfma_f32_16x16x32_bf16 v[36:39], v[176:179], v[104:107], v[36:39]
    v_mfma_f32_16x16x32_bf16 v[40:43], v[248:251], v[104:107], v[40:43]
    v_mfma_f32_16x16x32_bf16 v[44:47], a[64:67], v[104:107], v[44:47]
    v_mfma_f32_16x16x32_bf16 v[48:51], v[104:107], a[136:139], v[48:51]
    v_mfma_f32_16x16x32_bf16 v[52:55], v[104:107], a[208:211], v[52:55]
    v_mfma_f32_16x16x32_bf16 v[36:39], v[180:183], v[104:107], v[36:39]
    v_mfma_f32_16x16x32_bf16 v[40:43], v[252:255], v[104:107], v[40:43]
    v_mfma_f32_16x16x32_bf16 v[44:47], a[68:71], v[104:107], v[44:47]
    v_mfma_f32_16x16x32_bf16 v[48:51], v[104:107], a[140:143], v[48:51]
    v_mfma_f32_16x16x32_bf16 v[52:55], v[104:107], a[212:215], v[52:55]
    v_mfma_f32_16x16x32_bf16 v[36:39], v[184:187], v[104:107], v[36:39]
    v_mfma_f32_16x16x32_bf16 v[40:43], a[0:3], v[104:107], v[40:43]
    v_mfma_f32_16x16x32_bf16 v[44:47], a[72:75], v[104:107], v[44:47]
    v_mfma_f32_16x16x32_bf16 v[48:51], v[104:107], a[144:147], v[48:51]
    v_mfma_f32_16x16x32_bf16 v[52:55], v[104:107], a[216:219], v[52:55]
    v_mfma_f32_16x16x32_bf16 v[36:39], v[188:191], v[104:107], v[36:39]
    v_mfma_f32_16x16x32_bf16 v[40:43], a[4:7], v[104:107], v[40:43]
    v_mfma_f32_16x16x32_bf16 v[44:47], a[76:79], v[104:107], v[44:47]
    v_mfma_f32_16x16x32_bf16 v[48:51], v[104:107], a[148:151], v[48:51]
    v_mfma_f32_16x16x32_bf16 v[52:55], v[104:107], a[220:223], v[52:55]
    v_mfma_f32_16x16x32_bf16 v[36:39], v[192:195], v[104:107], v[36:39]
    v_mfma_f32_16x16x32_bf16 v[40:43], a[8:11], v[104:107], v[40:43]
    v_mfma_f32_16x16x32_bf16 v[44:47], a[80:83], v[104:107], v[44:47]
    v_mfma_f32_16x16x32_bf16 v[48:51], v[104:107], a[152:155], v[48:51]
    v_mfma_f32_16x16x32_bf16 v[52:55], v[104:107], a[224:227], v[52:55]
    v_mfma_f32_16x16x32_bf16 v[36:39], v[196:199], v[104:107], v[36:39]
    v_mfma_f32_16x16x32_bf16 v[40:43], a[12:15], v[104:107], v[40:43]
    v_mfma_f32_16x16x32_bf16 v[44:47], a[84:87], v[104:107], v[44:47]
    v_mfma_f32_16x16x32_bf16 v[48:51], v[104:107], a[156:159], v[48:51]
    v_mfma_f32_16x16x32_bf16 v[52:55], v[104:107], a[228:231], v[52:55]
    s_waitcnt vmcnt(0)
    s_barrier
    v_add_u32 v60, 92160, v23
    v_mov_b32 v59, 0
    ds_read_b32 v56, v60
    ds_read_b32 v57, v60 offset:80
    ds_read_b32 v58, v60 offset:160
    v_add_u32 v68, 99840, v23
    v_mov_b32 v67, 0
    ds_read_b32 v64, v68
    ds_read_b32 v65, v68 offset:80
    ds_read_b32 v66, v68 offset:160
    v_add_u32 v76, 107520, v23
    v_mov_b32 v75, 0
    ds_read_b32 v72, v76
    ds_read_b32 v73, v76 offset:80
    ds_read_b32 v74, v76 offset:160
    v_add_u32 v84, 115200, v23
    v_mov_b32 v83, 0
    ds_read_b32 v80, v84
    ds_read_b32 v81, v84 offset:80
    ds_read_b32 v82, v84 offset:160
    v_add_u32 v92, 122880, v23
    v_mov_b32 v91, 0
    ds_read_b32 v88, v92
    ds_read_b32 v89, v92 offset:80
    ds_read_b32 v90, v92 offset:160
    v_add_u32 v100, 130560, v23
    v_mov_b32 v99, 0
    ds_read_b32 v96, v100
    ds_read_b32 v97, v100 offset:80
    ds_read_b32 v98, v100 offset:160
    v_add_u32 v61, 92160, v19
    ds_read_b64_tr_b16 v[200:201], v61 offset:0
    ds_read_b64_tr_b16 a[16:17], v61 offset:80
    ds_read_b64_tr_b16 a[160:161], v61 offset:160
    ds_read_b64_tr_b16 v[202:203], v61 offset:960
    ds_read_b64_tr_b16 a[18:19], v61 offset:1040
    ds_read_b64_tr_b16 a[162:163], v61 offset:1120
    v_add_u32 v69, 99840, v19
    ds_read_b64_tr_b16 v[204:205], v69 offset:0
    ds_read_b64_tr_b16 a[20:21], v69 offset:80
    ds_read_b64_tr_b16 a[164:165], v69 offset:160
    ds_read_b64_tr_b16 v[206:207], v69 offset:960
    ds_read_b64_tr_b16 a[22:23], v69 offset:1040
    ds_read_b64_tr_b16 a[166:167], v69 offset:1120
    v_add_u32 v77, 107520, v19
    ds_read_b64_tr_b16 v[208:209], v77 offset:0
    ds_read_b64_tr_b16 a[24:25], v77 offset:80
    ds_read_b64_tr_b16 a[168:169], v77 offset:160
    ds_read_b64_tr_b16 v[210:211], v77 offset:960
    ds_read_b64_tr_b16 a[26:27], v77 offset:1040
    ds_read_b64_tr_b16 a[170:171], v77 offset:1120
    v_add_u32 v85, 115200, v19
    ds_read_b64_tr_b16 v[212:213], v85 offset:0
    ds_read_b64_tr_b16 a[28:29], v85 offset:80
    ds_read_b64_tr_b16 a[172:173], v85 offset:160
    ds_read_b64_tr_b16 v[214:215], v85 offset:960
    ds_read_b64_tr_b16 a[30:31], v85 offset:1040
    ds_read_b64_tr_b16 a[174:175], v85 offset:1120
    v_add_u32 v93, 122880, v19
    ds_read_b64_tr_b16 v[216:217], v93 offset:0
    ds_read_b64_tr_b16 a[32:33], v93 offset:80
    ds_read_b64_tr_b16 a[176:177], v93 offset:160
    ds_read_b64_tr_b16 v[218:219], v93 offset:960
    ds_read_b64_tr_b16 a[34:35], v93 offset:1040
    ds_read_b64_tr_b16 a[178:179], v93 offset:1120
    v_add_u32 v101, 130560, v19
    ds_read_b64_tr_b16 v[220:221], v101 offset:0
    ds_read_b64_tr_b16 a[36:37], v101 offset:80
    ds_read_b64_tr_b16 a[180:181], v101 offset:160
    ds_read_b64_tr_b16 v[222:223], v101 offset:960
    ds_read_b64_tr_b16 a[38:39], v101 offset:1040
    ds_read_b64_tr_b16 a[182:183], v101 offset:1120
    s_waitcnt lgkmcnt(15)
    ds_write_b64 v28, v[56:57] offset:12288
    ds_write_b64 v28, v[58:59] offset:12296
    ds_write_b64 v28, v[64:65] offset:13312
    ds_write_b64 v28, v[66:67] offset:13320
    ds_write_b64 v28, v[72:73] offset:14336
    ds_write_b64 v28, v[74:75] offset:14344
    ds_write_b64 v28, v[80:81] offset:15360
    ds_write_b64 v28, v[82:83] offset:15368
    ds_write_b64 v28, v[88:89] offset:16384
    ds_write_b64 v28, v[90:91] offset:16392
    ds_write_b64 v28, v[96:97] offset:17408
    ds_write_b64 v28, v[98:99] offset:17416
    s_waitcnt lgkmcnt(0)
    v_and_b32 v56, 12288, v21
    v_add_u32 v56, v56, v20
    ds_read_b64_tr_b16 a[88:89], v56 offset:0
    ds_read_b64_tr_b16 a[90:91], v56 offset:128
    v_and_b32 v57, 12296, v21
    v_add_u32 v57, v57, v20
    ds_read_b64_tr_b16 a[232:233], v57 offset:0
    ds_read_b64_tr_b16 a[234:235], v57 offset:128
    v_and_b32 v64, 13312, v21
    v_add_u32 v64, v64, v20
    ds_read_b64_tr_b16 a[92:93], v64 offset:0
    ds_read_b64_tr_b16 a[94:95], v64 offset:128
    v_and_b32 v65, 13320, v21
    v_add_u32 v65, v65, v20
    ds_read_b64_tr_b16 a[236:237], v65 offset:0
    ds_read_b64_tr_b16 a[238:239], v65 offset:128
    v_and_b32 v72, 14336, v21
    v_add_u32 v72, v72, v20
    ds_read_b64_tr_b16 a[96:97], v72 offset:0
    ds_read_b64_tr_b16 a[98:99], v72 offset:128
    v_and_b32 v73, 14344, v21
    v_add_u32 v73, v73, v20
    ds_read_b64_tr_b16 a[240:241], v73 offset:0
    ds_read_b64_tr_b16 a[242:243], v73 offset:128
    v_and_b32 v80, 15360, v21
    v_add_u32 v80, v80, v20
    ds_read_b64_tr_b16 a[100:101], v80 offset:0
    ds_read_b64_tr_b16 a[102:103], v80 offset:128
    v_and_b32 v81, 15368, v21
    v_add_u32 v81, v81, v20
    ds_read_b64_tr_b16 a[244:245], v81 offset:0
    ds_read_b64_tr_b16 a[246:247], v81 offset:128
    v_and_b32 v88, 16384, v21
    v_add_u32 v88, v88, v20
    ds_read_b64_tr_b16 a[104:105], v88 offset:0
    ds_read_b64_tr_b16 a[106:107], v88 offset:128
    v_and_b32 v89, 16392, v21
    v_add_u32 v89, v89, v20
    ds_read_b64_tr_b16 a[248:249], v89 offset:0
    ds_read_b64_tr_b16 a[250:251], v89 offset:128
    v_and_b32 v96, 17408, v21
    v_add_u32 v96, v96, v20
    ds_read_b64_tr_b16 a[108:109], v96 offset:0
    ds_read_b64_tr_b16 a[110:111], v96 offset:128
    v_and_b32 v97, 17416, v21
    v_add_u32 v97, v97, v20
    ds_read_b64_tr_b16 a[252:253], v97 offset:0
    ds_read_b64_tr_b16 a[254:255], v97 offset:128
    s_waitcnt lgkmcnt(0)
    v_mfma_f32_16x16x32_bf16 v[36:39], v[200:203], v[104:107], v[36:39]
    v_mfma_f32_16x16x32_bf16 v[40:43], a[16:19], v[104:107], v[40:43]
    v_mfma_f32_16x16x32_bf16 v[44:47], a[88:91], v[104:107], v[44:47]
    v_mfma_f32_16x16x32_bf16 v[48:51], v[104:107], a[160:163], v[48:51]
    v_mfma_f32_16x16x32_bf16 v[52:55], v[104:107], a[232:235], v[52:55]
    v_mfma_f32_16x16x32_bf16 v[36:39], v[204:207], v[104:107], v[36:39]
    v_mfma_f32_16x16x32_bf16 v[40:43], a[20:23], v[104:107], v[40:43]
    v_mfma_f32_16x16x32_bf16 v[44:47], a[92:95], v[104:107], v[44:47]
    v_mfma_f32_16x16x32_bf16 v[48:51], v[104:107], a[164:167], v[48:51]
    v_mfma_f32_16x16x32_bf16 v[52:55], v[104:107], a[236:239], v[52:55]
    v_mfma_f32_16x16x32_bf16 v[36:39], v[208:211], v[104:107], v[36:39]
    v_mfma_f32_16x16x32_bf16 v[40:43], a[24:27], v[104:107], v[40:43]
    v_mfma_f32_16x16x32_bf16 v[44:47], a[96:99], v[104:107], v[44:47]
    v_mfma_f32_16x16x32_bf16 v[48:51], v[104:107], a[168:171], v[48:51]
    v_mfma_f32_16x16x32_bf16 v[52:55], v[104:107], a[240:243], v[52:55]
    v_mfma_f32_16x16x32_bf16 v[36:39], v[212:215], v[104:107], v[36:39]
    v_mfma_f32_16x16x32_bf16 v[40:43], a[28:31], v[104:107], v[40:43]
    v_mfma_f32_16x16x32_bf16 v[44:47], a[100:103], v[104:107], v[44:47]
    v_mfma_f32_16x16x32_bf16 v[48:51], v[104:107], a[172:175], v[48:51]
    v_mfma_f32_16x16x32_bf16 v[52:55], v[104:107], a[244:247], v[52:55]
    v_mfma_f32_16x16x32_bf16 v[36:39], v[216:219], v[104:107], v[36:39]
    v_mfma_f32_16x16x32_bf16 v[40:43], a[32:35], v[104:107], v[40:43]
    v_mfma_f32_16x16x32_bf16 v[44:47], a[104:107], v[104:107], v[44:47]
    v_mfma_f32_16x16x32_bf16 v[48:51], v[104:107], a[176:179], v[48:51]
    v_mfma_f32_16x16x32_bf16 v[52:55], v[104:107], a[248:251], v[52:55]
    v_mfma_f32_16x16x32_bf16 v[36:39], v[220:223], v[104:107], v[36:39]
    v_mfma_f32_16x16x32_bf16 v[40:43], a[36:39], v[104:107], v[40:43]
    v_mfma_f32_16x16x32_bf16 v[44:47], a[108:111], v[104:107], v[44:47]
    v_mfma_f32_16x16x32_bf16 v[48:51], v[104:107], a[180:183], v[48:51]
    v_mfma_f32_16x16x32_bf16 v[52:55], v[104:107], a[252:255], v[52:55]
    s_barrier
    v_lshlrev_b32 v10, 4, v7
    s_lshl_b32 s17, s51, 3
    v_add_u32 v10, s17, v10
    v_mul_u32_u24 v6, 1536, v8
    v_add_u32 v10, v10, v6
    s_lshl_b32 s17, s14, 7
    s_add_u32 s17, s17, 73728
    v_lshl_add_u32 v11, v7, 3, s17
    v_lshl_add_u32 v12, v8, 5, s17
    v_lshlrev_b32 v13, 5, v7
    s_lshl_b32 s17, s51, 4
    v_add_u32 v13, s17, v13
    s_lshr_b32 s17, s50, 2
    s_add_u32 s17, s17, 64
    s_lshl_b32 s17, s17, 9
    s_and_b32 s18, s50, 3
    s_lshl_b32 s18, s18, 2
    s_add_u32 s17, s17, s18
    v_add_u32 v14, s17, v13
    v_lshrrev_b32 v5, 1, v8
    v_lshl_add_u32 v13, v5, 9, v13
    v_and_b32 v5, 1, v8
    v_lshl_add_u32 v13, v5, 3, v13
    s_lshl_b32 s17, s50, 10
    v_add_u32 v13, s17, v13
    s_lshl_b32 s49, s15, 7
    s_lshl_b32 s17, s14, 2
    s_add_u32 s49, s49, s17
    s_add_u32 s49, s49, 181760
    s_mov_b32 s52, 0x3eae1a93
    v_mov_b32 v6, 0xf149f2ca
    v_lshl_add_u32 v5, v8, 2, 0
    v_sub_u32 v5, v5, v7
    v_cmp_le_i32 vcc, 9, v5
    s_nop 1
    v_cndmask_b32 v72, v6, v4, vcc
    v_add_u32 v5, 7, v5
    v_cmp_ge_u32 vcc, 7, v5
    s_nop 1
    v_cndmask_b32 v76, v6, v4, vcc
    v_lshl_add_u32 v5, v8, 2, 1
    v_sub_u32 v5, v5, v7
    v_cmp_le_i32 vcc, 9, v5
    s_nop 1
    v_cndmask_b32 v73, v6, v4, vcc
    v_add_u32 v5, 7, v5
    v_cmp_ge_u32 vcc, 7, v5
    s_nop 1
    v_cndmask_b32 v77, v6, v4, vcc
    v_lshl_add_u32 v5, v8, 2, 2
    v_sub_u32 v5, v5, v7
    v_cmp_le_i32 vcc, 9, v5
    s_nop 1
    v_cndmask_b32 v74, v6, v4, vcc
    v_add_u32 v5, 7, v5
    v_cmp_ge_u32 vcc, 7, v5
    s_nop 1
    v_cndmask_b32 v78, v6, v4, vcc
    v_lshl_add_u32 v5, v8, 2, 3
    v_sub_u32 v5, v5, v7
    v_cmp_le_i32 vcc, 9, v5
    s_nop 1
    v_cndmask_b32 v75, v6, v4, vcc
    v_add_u32 v5, 7, v5
    v_cmp_ge_u32 vcc, 7, v5
    s_nop 1
    v_cndmask_b32 v79, v6, v4, vcc
    v_and_b32 v111, 0x200, v0
    v_lshl_add_u32 v111, v7, 5, v111
    v_and_b32 v5, 1, v8
    v_lshl_add_u32 v111, v5, 4, v111
    v_mov_b32 v112, 0
    v_mov_b32 v113, 0
    v_mov_b32 v114, 0
    v_mov_b32 v115, 0
    v_mov_b32 v136, 0
    v_mov_b32 v137, 0
    v_mov_b32 v138, 0
    v_mov_b32 v139, 0
    v_mov_b32 v140, 0
    v_mov_b32 v141, 0
    v_mov_b32 v142, 0
    v_mov_b32 v143, 0
    v_mov_b32 v116, 0x3f803f80
    v_mov_b32 v117, 0x3f803f80
    v_mov_b32 v118, 0x3f803f80
    v_mov_b32 v119, 0x3f803f80
    v_mov_b32 v131, 0
    v_mov_b32 v135, 0
    v_mbcnt_lo_u32_b32 v24, -1, 0
    v_mbcnt_hi_u32_b32 v24, -1, v24
    v_and_b32 v25, 1, v24
    v_lshlrev_b32 v25, 7, v25
    v_lshlrev_b32 v24, 1, v24
    v_and_or_b32 v24, v24, 12, v25
    s_mov_b32 s16, 0
Laq_pure:
    global_load_dword v25, v24, s[12:13] sc1
    s_add_u32 s16, s16, 1
    s_cmp_gt_u32 s16, 100000
    s_cbranch_scc1 L_role_aq_abort
    s_mov_b32 s6, 0
    s_waitcnt vmcnt(0)
    v_readlane_b32 s7, v25, 0
    s_nop 0
    s_add_u32 s6, s6, s7
    v_readlane_b32 s7, v25, 1
    s_nop 0
    s_add_u32 s6, s6, s7
    v_readlane_b32 s7, v25, 2
    s_nop 0
    s_add_u32 s6, s6, s7
    v_readlane_b32 s7, v25, 3
    s_nop 0
    s_add_u32 s6, s6, s7
    v_readlane_b32 s7, v25, 4
    s_nop 0
    s_add_u32 s6, s6, s7
    v_readlane_b32 s7, v25, 5
    s_nop 0
    s_add_u32 s6, s6, s7
    v_readlane_b32 s7, v25, 6
    s_nop 0
    s_add_u32 s6, s6, s7
    v_readlane_b32 s7, v25, 7
    s_nop 0
    s_add_u32 s6, s6, s7
    v_readlane_b32 s7, v25, s3
    s_nop 0
    s_cmp_ge_u32 s7, 32
    s_cselect_b32 s61, 1, 0
    s_cselect_b32 s6, 256, s6
    s_cmp_lt_u32 s6, 256
    s_cbranch_scc1 Laq_pure
    s_cmp_eq_u32 s61, 0
    s_cbranch_scc1 Laq_slow
    s_mov_b32 s36, s63
    s_mov_b32 s34, s63
    s_mov_b32 s37, 0
    s_lshl_b32 s56, s63, 6
    s_mul_i32 s58, s14, 9216
    s_mov_b32 s40, 36864
    s_mov_b32 s59, s58
    s_mov_b32 s43, 0
    s_mov_b32 s28, s8
    s_mov_b32 s29, s9
    s_mov_b32 s30, 0
    s_mov_b32 s31, 0x00020000
    s_mul_i32 s41, s63, 4718592
    s_add_u32 s41, s41, s58
    s_add_u32 s41, s41, 6291456
    s_mul_i32 s42, s56, 22528
    s_add_u32 s42, s42, 180224
    s_cmp_lg_u32 s14, 0
    s_cbranch_scc1 Laqf_ini_d
    v_mov_b32 v5, 160
    s_mov_b32 s16, 0
Laqf_ini:
    global_load_dword v6, v5, s[12:13] sc1
    s_add_u32 s16, s16, 1
    s_cmp_gt_u32 s16, 100000
    s_cbranch_scc1 L_role_aq_abort
    s_waitcnt vmcnt(0)
    v_cmp_gt_u32 vcc, 123, v6
    s_nop 0
    s_cbranch_vccz Laqf_ini_d
    s_sleep 8
    s_branch Laqf_ini
Laqf_ini_d:
    s_barrier
    s_branch Laqf_poll
Laqf_item:
    s_waitcnt vmcnt(2)
Laqf_go:
    s_barrier
    s_xor_b32 s40, s40, 36864
    s_xor_b32 s59, s59, 36864
    s_xor_b32 s66, s66, 0x2000
    s_xor_b32 s71, s71, 0x2000
    s_mov_b32 s35, s37
    s_mov_b32 s57, s56
    s_add_u32 s37, s37, 1
    s_add_u32 s56, s56, 1
    s_add_u32 s41, s41, 36864
    s_add_u32 s42, s42, 22528
    s_mov_b32 s62, 0
    v_lshlrev_b32 v9, 9, v8
    v_lshl_add_u32 v9, v7, 4, v9
    s_lshl_b32 s17, s51, 8
    s_add_u32 s17, s17, s40
    v_add_u32 v9, s17, v9
    ds_read_b128 v[56:59], v9 offset:0
    ds_read_b128 v[60:63], v9 offset:2048
    ds_read_b128 v[64:67], v9 offset:4096
    ds_read_b128 v[104:107], v9 offset:6144
    s_waitcnt lgkmcnt(3)
    v_mfma_f32_16x16x32_bf16 v[16:19], v[152:155], v[56:59], 0
    v_add_f32 v80, v80, v82
    v_mfma_f32_16x16x32_bf16 v[20:23], v[224:227], v[56:59], 0
    v_add_f32 v81, v81, v83
    v_mfma_f32_16x16x32_bf16 v[24:27], a[40:43], v[56:59], 0
    v_add_f32 v80, v80, v84
    v_mfma_f32_16x16x32_bf16 v[28:31], v[56:59], a[112:115], 0
    v_add_f32 v81, v81, v85
    v_mfma_f32_16x16x32_bf16 v[32:35], v[56:59], a[184:187], 0
    ds_read_b128 v[56:59], v9 offset:8192
    s_waitcnt lgkmcnt(3)
    v_mfma_f32_16x16x32_bf16 v[16:19], v[156:159], v[60:63], v[16:19]
    v_add_f32 v80, v80, v86
    v_mfma_f32_16x16x32_bf16 v[20:23], v[228:231], v[60:63], v[20:23]
    v_add_f32 v81, v81, v87
    v_mfma_f32_16x16x32_bf16 v[24:27], a[44:47], v[60:63], v[24:27]
    v_add_f32 v80, v80, v88
    v_mfma_f32_16x16x32_bf16 v[28:31], v[60:63], a[116:119], v[28:31]
    v_add_f32 v81, v81, v89
    v_mfma_f32_16x16x32_bf16 v[32:35], v[60:63], a[188:191], v[32:35]
    s_waitcnt vmcnt(0)
    buffer_load_dword v2, v1, s[8:11], s42 offen sc1
    s_cmp_lg_u32 s43, 0
    s_cselect_b64 exec, 1, 0
    buffer_store_dword v3, v4, s[8:11], s43 offen
    s_mov_b64 exec, -1
    s_mov_b32 s43, 0
    ds_read_b128 v[60:63], v9 offset:10240
    s_waitcnt lgkmcnt(3)
    v_mfma_f32_16x16x32_bf16 v[16:19], v[160:163], v[64:67], v[16:19]
    v_add_f32 v80, v80, v90
    v_mfma_f32_16x16x32_bf16 v[20:23], v[232:235], v[64:67], v[20:23]
    v_add_f32 v81, v81, v91
    v_mfma_f32_16x16x32_bf16 v[24:27], a[48:51], v[64:67], v[24:27]
    v_mov_b32 v82, v80
    v_mfma_f32_16x16x32_bf16 v[28:31], v[64:67], a[120:123], v[28:31]
    v_mov_b32 v83, v81
    v_mfma_f32_16x16x32_bf16 v[32:35], v[64:67], a[192:195], v[32:35]
    ds_read_b128 v[64:67], v9 offset:12288
    s_waitcnt lgkmcnt(3)
    v_mfma_f32_16x16x32_bf16 v[16:19], v[164:167], v[104:107], v[16:19]
    v_permlane32_swap_b32 v80, v82
    v_mfma_f32_16x16x32_bf16 v[20:23], v[236:239], v[104:107], v[20:23]
    v_permlane32_swap_b32 v81, v83
    v_mfma_f32_16x16x32_bf16 v[24:27], a[52:55], v[104:107], v[24:27]
    v_add_f32 v80, v80, v82
    v_mfma_f32_16x16x32_bf16 v[28:31], v[104:107], a[124:127], v[28:31]
    v_add_f32 v81, v81, v83
    v_mfma_f32_16x16x32_bf16 v[32:35], v[104:107], a[196:199], v[32:35]
    ds_read_b128 v[104:107], v9 offset:14336
    s_waitcnt lgkmcnt(3)
    v_mfma_f32_16x16x32_bf16 v[16:19], v[168:171], v[56:59], v[16:19]
    v_mov_b32 v82, v80
    v_mfma_f32_16x16x32_bf16 v[20:23], v[240:243], v[56:59], v[20:23]
    v_mov_b32 v83, v81
    v_mfma_f32_16x16x32_bf16 v[24:27], a[56:59], v[56:59], v[24:27]
    v_permlane16_swap_b32 v80, v82
    v_mfma_f32_16x16x32_bf16 v[28:31], v[56:59], a[128:131], v[28:31]
    v_permlane16_swap_b32 v81, v83
    v_mfma_f32_16x16x32_bf16 v[32:35], v[56:59], a[200:203], v[32:35]
    ds_read_b128 v[56:59], v9 offset:16384
    s_waitcnt lgkmcnt(3)
    v_mfma_f32_16x16x32_bf16 v[16:19], v[172:175], v[60:63], v[16:19]
    v_add_f32 v80, v80, v82
    v_mfma_f32_16x16x32_bf16 v[20:23], v[244:247], v[60:63], v[20:23]
    v_add_f32 v81, v81, v83
    v_mfma_f32_16x16x32_bf16 v[24:27], a[60:63], v[60:63], v[24:27]
    v_mul_f32 v80, 0x3ae38e39, v80
    v_mfma_f32_16x16x32_bf16 v[28:31], v[60:63], a[132:135], v[28:31]
    v_mul_f32 v81, 0x3ae38e39, v81
    v_mfma_f32_16x16x32_bf16 v[32:35], v[60:63], a[204:207], v[32:35]
    ds_read_b128 v[60:63], v9 offset:18432
    s_waitcnt lgkmcnt(3)
    v_mfma_f32_16x16x32_bf16 v[16:19], v[176:179], v[64:67], v[16:19]
    v_fma_f32 v81, -v80, v80, v81
    v_mfma_f32_16x16x32_bf16 v[20:23], v[248:251], v[64:67], v[20:23]
    v_max_f32 v81, 0, v81
    v_mfma_f32_16x16x32_bf16 v[24:27], a[64:67], v[64:67], v[24:27]
    v_add_f32 v81, 0x3727c5ac, v81
    v_mfma_f32_16x16x32_bf16 v[28:31], v[64:67], a[136:139], v[28:31]
    v_rsq_f32 v92, v81
    v_mfma_f32_16x16x32_bf16 v[32:35], v[64:67], a[208:211], v[32:35]
    ds_read_b128 v[64:67], v9 offset:20480
    s_waitcnt lgkmcnt(3)
    v_mfma_f32_16x16x32_bf16 v[16:19], v[180:183], v[104:107], v[16:19]
    v_mul_f32 v93, v80, v92
    v_mfma_f32_16x16x32_bf16 v[20:23], v[252:255], v[104:107], v[20:23]
    ds_write_b64 v11, v[92:93]
    v_mfma_f32_16x16x32_bf16 v[24:27], a[68:71], v[104:107], v[24:27]
    ds_read_b128 v[96:99], v12
    v_mfma_f32_16x16x32_bf16 v[28:31], v[104:107], a[140:143], v[28:31]
    ds_read_b128 v[100:103], v12 offset:16
    v_mfma_f32_16x16x32_bf16 v[32:35], v[104:107], a[212:215], v[32:35]
    ds_read_b128 v[104:107], v9 offset:22528
    s_waitcnt lgkmcnt(6)
    v_mfma_f32_16x16x32_bf16 v[16:19], v[184:187], v[56:59], v[16:19]
    v_mfma_f32_16x16x32_bf16 v[20:23], a[0:3], v[56:59], v[20:23]
    v_mfma_f32_16x16x32_bf16 v[24:27], a[72:75], v[56:59], v[24:27]
    v_mfma_f32_16x16x32_bf16 v[28:31], v[56:59], a[144:147], v[28:31]
    v_mfma_f32_16x16x32_bf16 v[32:35], v[56:59], a[216:219], v[32:35]
    ds_read_b128 v[56:59], v9 offset:24576
    s_waitcnt lgkmcnt(6)
    v_mfma_f32_16x16x32_bf16 v[16:19], v[188:191], v[60:63], v[16:19]
    v_mfma_f32_16x16x32_bf16 v[20:23], a[4:7], v[60:63], v[20:23]
    v_mfma_f32_16x16x32_bf16 v[24:27], a[76:79], v[60:63], v[24:27]
    v_mfma_f32_16x16x32_bf16 v[28:31], v[60:63], a[148:151], v[28:31]
    v_mfma_f32_16x16x32_bf16 v[32:35], v[60:63], a[220:223], v[32:35]
    ds_read_b128 v[60:63], v9 offset:26624
    s_waitcnt lgkmcnt(6)
    v_mfma_f32_16x16x32_bf16 v[16:19], v[192:195], v[64:67], v[16:19]
    v_mfma_f32_16x16x32_bf16 v[20:23], a[8:11], v[64:67], v[20:23]
    v_mfma_f32_16x16x32_bf16 v[24:27], a[80:83], v[64:67], v[24:27]
    v_mfma_f32_16x16x32_bf16 v[28:31], v[64:67], a[152:155], v[28:31]
    v_mfma_f32_16x16x32_bf16 v[32:35], v[64:67], a[224:227], v[32:35]
    ds_read_b128 v[64:67], v9 offset:28672
    s_waitcnt lgkmcnt(3)
    v_mfma_f32_16x16x32_bf16 v[16:19], v[196:199], v[104:107], v[16:19]
    v_mfma_f32_16x16x32_bf16 v[20:23], a[12:15], v[104:107], v[20:23]
    v_mfma_f32_16x16x32_bf16 v[24:27], a[84:87], v[104:107], v[24:27]
    v_mfma_f32_16x16x32_bf16 v[28:31], v[104:107], a[156:159], v[28:31]
    v_mfma_f32_16x16x32_bf16 v[32:35], v[104:107], a[228:231], v[32:35]
    s_waitcnt vmcnt(1)
    v_cmp_eq_u32 vcc, 0, v2
    s_nop 0
    s_cmp_eq_u64 vcc, 0
    s_cselect_b32 s62, 1, 0
    s_cmp_lt_u32 s37, 64
    s_cselect_b32 s62, s62, 0
    s_cmp_lg_u32 s62, 0
    s_cselect_b32 s30, 268435456, 0
    ds_read_b128 v[104:107], v9 offset:30720
    s_waitcnt lgkmcnt(3)
    v_mfma_f32_16x16x32_bf16 v[16:19], v[200:203], v[56:59], v[16:19]
    v_mfma_f32_16x16x32_bf16 v[20:23], a[16:19], v[56:59], v[20:23]
    v_mfma_f32_16x16x32_bf16 v[24:27], a[88:91], v[56:59], v[24:27]
    s_add_u32 m0, s59, 0
    s_add_u32 s47, s41, 0
    buffer_load_dwordx4 v111, s[28:31], s47 offen offset:0 lds
    v_mfma_f32_16x16x32_bf16 v[28:31], v[56:59], a[160:163], v[28:31]
    v_mfma_f32_16x16x32_bf16 v[32:35], v[56:59], a[232:235], v[32:35]
    buffer_load_dwordx4 v111, s[28:31], s47 offen offset:1024 lds
    ds_read_b128 v[56:59], v9 offset:32768
    s_waitcnt lgkmcnt(3)
    v_mfma_f32_16x16x32_bf16 v[16:19], v[204:207], v[60:63], v[16:19]
    v_mfma_f32_16x16x32_bf16 v[20:23], a[20:23], v[60:63], v[20:23]
    v_mfma_f32_16x16x32_bf16 v[24:27], a[92:95], v[60:63], v[24:27]
    buffer_load_dwordx4 v111, s[28:31], s47 offen offset:2048 lds
    v_mfma_f32_16x16x32_bf16 v[28:31], v[60:63], a[164:167], v[28:31]
    v_mfma_f32_16x16x32_bf16 v[32:35], v[60:63], a[236:239], v[32:35]
    buffer_load_dwordx4 v111, s[28:31], s47 offen offset:3072 lds
    ds_read_b128 v[60:63], v9 offset:34816
    s_waitcnt lgkmcnt(3)
    v_mfma_f32_16x16x32_bf16 v[16:19], v[208:211], v[64:67], v[16:19]
    v_mfma_f32_16x16x32_bf16 v[20:23], a[24:27], v[64:67], v[20:23]
    v_mfma_f32_16x16x32_bf16 v[24:27], a[96:99], v[64:67], v[24:27]
    s_add_u32 m0, s59, 4096
    s_add_u32 s47, s41, 4096
    buffer_load_dwordx4 v111, s[28:31], s47 offen offset:0 lds
    v_mfma_f32_16x16x32_bf16 v[28:31], v[64:67], a[168:171], v[28:31]
    v_mfma_f32_16x16x32_bf16 v[32:35], v[64:67], a[240:243], v[32:35]
    buffer_load_dwordx4 v111, s[28:31], s47 offen offset:1024 lds
    s_waitcnt lgkmcnt(2)
    v_mfma_f32_16x16x32_bf16 v[16:19], v[212:215], v[104:107], v[16:19]
    v_mfma_f32_16x16x32_bf16 v[20:23], a[28:31], v[104:107], v[20:23]
    v_mfma_f32_16x16x32_bf16 v[24:27], a[100:103], v[104:107], v[24:27]
    buffer_load_dwordx4 v111, s[28:31], s47 offen offset:2048 lds
    v_mfma_f32_16x16x32_bf16 v[28:31], v[104:107], a[172:175], v[28:31]
    v_mfma_f32_16x16x32_bf16 v[32:35], v[104:107], a[244:247], v[32:35]
    buffer_load_dwordx4 v111, s[28:31], s47 offen offset:3072 lds
    s_waitcnt lgkmcnt(1)
    v_mfma_f32_16x16x32_bf16 v[16:19], v[216:219], v[56:59], v[16:19]
    v_mfma_f32_16x16x32_bf16 v[20:23], a[32:35], v[56:59], v[20:23]
    v_mfma_f32_16x16x32_bf16 v[24:27], a[104:107], v[56:59], v[24:27]
    s_add_u32 m0, s59, 8192
    s_add_u32 s47, s41, 8192
    buffer_load_dwordx4 v111, s[28:31], s47 offen offset:0 lds
    v_mfma_f32_16x16x32_bf16 v[28:31], v[56:59], a[176:179], v[28:31]
    v_mfma_f32_16x16x32_bf16 v[32:35], v[56:59], a[248:251], v[32:35]
    s_mul_i32 s48, s36, 786432
    s_mul_i32 s18, s37, 6144
    s_add_u32 s48, s48, s18
    s_add_u32 s48, s48, 15728640
    buffer_load_dwordx2 v[80:81], v10, s[28:31], s48 offen offset:0
    s_waitcnt lgkmcnt(0)
    v_mfma_f32_16x16x32_bf16 v[16:19], v[220:223], v[60:63], v[16:19]
    v_mfma_f32_16x16x32_bf16 v[20:23], a[36:39], v[60:63], v[20:23]
    v_mfma_f32_16x16x32_bf16 v[24:27], a[108:111], v[60:63], v[24:27]
    buffer_load_dwordx2 v[82:83], v10, s[28:31], s48 offen offset:256
    v_mfma_f32_16x16x32_bf16 v[28:31], v[60:63], a[180:183], v[28:31]
    v_mfma_f32_16x16x32_bf16 v[32:35], v[60:63], a[252:255], v[32:35]
    buffer_load_dwordx2 v[84:85], v10, s[28:31], s48 offen offset:512
    buffer_load_dwordx2 v[86:87], v10, s[28:31], s48 offen offset:768
    buffer_load_dwordx2 v[88:89], v10, s[28:31], s48 offen offset:1024
    buffer_load_dwordx2 v[90:91], v10, s[28:31], s48 offen offset:1280
    v_mul_f32 v94, v93, v36
    v_fma_f32 v16, v16, v92, -v94
    v_mul_f32 v94, v93, v37
    v_fma_f32 v17, v17, v92, -v94
    v_mul_f32 v94, v93, v38
    v_fma_f32 v18, v18, v92, -v94
    v_mul_f32 v94, v93, v39
    v_fma_f32 v19, v19, v92, -v94
    v_mul_f32 v94, v93, v44
    v_fma_f32 v24, v24, v92, -v94
    v_mul_f32 v94, v93, v45
    v_fma_f32 v25, v25, v92, -v94
    v_mul_f32 v94, v93, v46
    v_fma_f32 v26, v26, v92, -v94
    v_mul_f32 v94, v93, v47
    v_fma_f32 v27, v27, v92, -v94
    v_mul_f32 v94, v93, v40
    v_fma_f32 v20, v20, v92, -v94
    v_mul_f32 v94, v93, v41
    v_fma_f32 v21, v21, v92, -v94
    v_mul_f32 v94, v93, v42
    v_fma_f32 v22, v22, v92, -v94
    v_mul_f32 v94, v93, v43
    v_fma_f32 v23, v23, v92, -v94
    v_cvt_pk_bf16_f32 v128, v16, v17
    v_cvt_pk_bf16_f32 v129, v18, v19
    v_cvt_pk_bf16_f32 v130, v24, v25
    v_cvt_pk_bf16_f32 v132, v20, v21
    v_cvt_pk_bf16_f32 v133, v22, v23
    v_cvt_pk_bf16_f32 v134, v26, v27
    s_cmp_eq_u32 s35, 0
    s_cselect_b32 s46, 0xf149f2ca, 0
    v_mul_f32 v94, v97, v48
    v_fma_f32 v28, v28, v96, -v94
    v_mfma_f32_16x16x32_bf16 v[144:147], v[112:115], v[128:131], 0
    v_mul_f32 v94, v99, v49
    v_fma_f32 v29, v29, v98, -v94
    v_mfma_f32_16x16x32_bf16 v[148:151], v[132:135], v[128:131], 0
    v_mul_f32 v94, v101, v50
    v_fma_f32 v30, v30, v100, -v94
    v_mul_f32 v94, v103, v51
    v_fma_f32 v31, v31, v102, -v94
    v_mov_b32 v112, v132
    v_mov_b32 v113, v133
    v_mov_b32 v114, v134
    v_mul_f32 v94, v97, v52
    v_fma_f32 v32, v32, v96, -v94
    v_mul_f32 v94, v99, v53
    v_fma_f32 v33, v33, v98, -v94
    v_mul_f32 v94, v101, v54
    v_fma_f32 v34, v34, v100, -v94
    v_fma_f32 v144, v144, s52, v72
    v_fma_f32 v145, v145, s52, v73
    v_fma_f32 v146, v146, s52, v74
    v_fma_f32 v147, v147, s52, v75
    v_fma_f32 v148, v148, s52, v76
    v_fma_f32 v149, v149, s52, v77
    v_fma_f32 v150, v150, s52, v78
    v_fma_f32 v151, v151, s52, v79
    v_add_f32 v144, s46, v144
    v_add_f32 v145, s46, v145
    v_add_f32 v146, s46, v146
    v_add_f32 v147, s46, v147
    v_max3_f32 v5, v144, v145, v146
    v_max3_f32 v5, v5, v147, v148
    v_max3_f32 v5, v5, v149, v150
    v_max_f32 v5, v5, v151
    v_mov_b32 v6, v5
    v_mul_f32 v94, v103, v55
    v_fma_f32 v35, v35, v102, -v94
    v_permlane32_swap_b32 v5, v6
    v_max_f32 v5, v5, v6
    v_mov_b32 v6, v5
    s_nop 1
    v_permlane16_swap_b32 v5, v6
    v_max_f32 v5, v5, v6
    v_sub_f32 v144, v144, v5
    v_sub_f32 v145, v145, v5
    v_sub_f32 v146, v146, v5
    v_sub_f32 v147, v147, v5
    v_sub_f32 v148, v148, v5
    v_sub_f32 v149, v149, v5
    v_sub_f32 v150, v150, v5
    v_sub_f32 v151, v151, v5
    v_exp_f32 v144, v144
    v_exp_f32 v145, v145
    v_exp_f32 v146, v146
    v_exp_f32 v147, v147
    v_exp_f32 v148, v148
    v_exp_f32 v149, v149
    v_exp_f32 v150, v150
    v_exp_f32 v151, v151
    v_cvt_pk_bf16_f32 v68, v144, v145
    v_cvt_pk_bf16_f32 v69, v146, v147
    v_cvt_pk_bf16_f32 v70, v148, v149
    v_cvt_pk_bf16_f32 v71, v150, v151
    s_nop 1
    v_mfma_f32_16x16x32_bf16 v[16:19], v[116:119], v[68:71], 0
    s_mul_i32 s46, s57, 36864
    s_add_u32 s46, s46, 17301504
    s_nop 5
    v_rcp_f32 v6, v16
    v_cvt_pk_bf16_f32 v138, v28, v29
    v_cvt_pk_bf16_f32 v139, v30, v31
    s_nop 1
    v_mfma_f32_16x16x32_bf16 v[20:23], v[136:139], v[68:71], 0
    v_cvt_pk_bf16_f32 v142, v32, v33
    v_cvt_pk_bf16_f32 v143, v34, v35
    v_mov_b32 v136, v138
    v_mov_b32 v137, v139
    v_mfma_f32_16x16x32_bf16 v[24:27], v[140:143], v[68:71], 0
    s_nop 2
    v_mul_f32 v20, v6, v20
    v_mul_f32 v21, v6, v21
    v_mul_f32 v22, v6, v22
    v_mul_f32 v23, v6, v23
    v_cvt_pk_bf16_f32 v20, v20, v21
    v_cvt_pk_bf16_f32 v21, v22, v23
    buffer_store_dwordx2 v[20:21], v13, s[8:11], s46 offen
    v_mov_b32 v140, v142
    v_mov_b32 v141, v143
    v_mul_f32 v24, v6, v24
    v_mul_f32 v25, v6, v25
    v_cvt_pk_bf16_f32 v24, v24, v25
    s_mov_b64 exec, 0xffff
    buffer_store_dword v24, v14, s[8:11], s46 offen
    s_mov_b64 exec, -1
    s_mul_i32 s43, s57, 22528
    s_add_u32 s43, s43, s49
    s_cmp_lg_u32 s62, 0
    s_cbranch_scc1 Laqf_item
    buffer_load_dword v2, v1, s[8:11], s42 offen sc1
    s_waitcnt vmcnt(0)
    s_cmp_ge_u32 s37, 64
    s_cbranch_scc1 Laqf_fin
    v_cmp_eq_u32 vcc, 0, v2
    s_nop 0
    s_cmp_lg_u64 vcc, 0
    s_cbranch_scc1 Laqf_pub
    s_add_u32 m0, s59, 0
    s_add_u32 s47, s41, 0
    buffer_load_dwordx4 v111, s[8:11], s47 offen offset:0 lds
    buffer_load_dwordx4 v111, s[8:11], s47 offen offset:1024 lds
    buffer_load_dwordx4 v111, s[8:11], s47 offen offset:2048 lds
    buffer_load_dwordx4 v111, s[8:11], s47 offen offset:3072 lds
    s_add_u32 m0, s59, 4096
    s_add_u32 s47, s41, 4096
    buffer_load_dwordx4 v111, s[8:11], s47 offen offset:0 lds
    buffer_load_dwordx4 v111, s[8:11], s47 offen offset:1024 lds
    buffer_load_dwordx4 v111, s[8:11], s47 offen offset:2048 lds
    buffer_load_dwordx4 v111, s[8:11], s47 offen offset:3072 lds
    s_add_u32 m0, s59, 8192
    s_add_u32 s47, s41, 8192
    buffer_load_dwordx4 v111, s[8:11], s47 offen offset:0 lds
    s_mul_i32 s48, s36, 786432
    s_mul_i32 s18, s37, 6144
    s_add_u32 s48, s48, s18
    s_add_u32 s48, s48, 15728640
    buffer_load_dwordx2 v[80:81], v10, s[8:11], s48 offen offset:0
    buffer_load_dwordx2 v[82:83], v10, s[8:11], s48 offen offset:256
    buffer_load_dwordx2 v[84:85], v10, s[8:11], s48 offen offset:512
    buffer_load_dwordx2 v[86:87], v10, s[8:11], s48 offen offset:768
    buffer_load_dwordx2 v[88:89], v10, s[8:11], s48 offen offset:1024
    buffer_load_dwordx2 v[90:91], v10, s[8:11], s48 offen offset:1280
    s_cmp_lg_u32 s43, 0
    s_cselect_b64 exec, 1, 0
    buffer_store_dword v3, v4, s[8:11], s43 offen
    s_mov_b64 exec, -1
    s_mov_b32 s43, 0
    s_waitcnt vmcnt(1)
    s_branch Laqf_go
Laqf_fin:
    s_cmp_lg_u32 s43, 0
    s_cselect_b64 exec, 1, 0
    buffer_store_dword v3, v4, s[8:11], s43 offen
    s_mov_b64 exec, -1
    s_mov_b32 s43, 0
    s_branch L_role_aq_exit
Laqf_pub:
    s_cmp_lg_u32 s43, 0
    s_cselect_b64 exec, 1, 0
    buffer_store_dword v3, v4, s[8:11], s43 offen
    s_mov_b64 exec, -1
    s_mov_b32 s43, 0
Laqf_poll:
    s_mov_b32 s16, 0
Laqf_pl:
    buffer_load_dword v2, v1, s[8:11], s42 offen sc1
    s_add_u32 s16, s16, 1
    s_cmp_gt_u32 s16, 100000
    s_cbranch_scc1 L_role_aq_abort
    s_waitcnt vmcnt(0)
    v_cmp_eq_u32 vcc, 0, v2
    s_nop 0
    s_cmp_eq_u64 vcc, 0
    s_cbranch_scc1 Laqf_pld
    s_sleep 4
    s_branch Laqf_pl
Laqf_pld:
    s_add_u32 m0, s59, 0
    s_add_u32 s47, s41, 0
    buffer_load_dwordx4 v111, s[8:11], s47 offen offset:0 lds
    buffer_load_dwordx4 v111, s[8:11], s47 offen offset:1024 lds
    buffer_load_dwordx4 v111, s[8:11], s47 offen offset:2048 lds
    buffer_load_dwordx4 v111, s[8:11], s47 offen offset:3072 lds
    s_add_u32 m0, s59, 4096
    s_add_u32 s47, s41, 4096
    buffer_load_dwordx4 v111, s[8:11], s47 offen offset:0 lds
    buffer_load_dwordx4 v111, s[8:11], s47 offen offset:1024 lds
    buffer_load_dwordx4 v111, s[8:11], s47 offen offset:2048 lds
    buffer_load_dwordx4 v111, s[8:11], s47 offen offset:3072 lds
    s_add_u32 m0, s59, 8192
    s_add_u32 s47, s41, 8192
    buffer_load_dwordx4 v111, s[8:11], s47 offen offset:0 lds
    s_mul_i32 s48, s36, 786432
    s_mul_i32 s18, s37, 6144
    s_add_u32 s48, s48, s18
    s_add_u32 s48, s48, 15728640
    buffer_load_dwordx2 v[80:81], v10, s[8:11], s48 offen offset:0
    buffer_load_dwordx2 v[82:83], v10, s[8:11], s48 offen offset:256
    buffer_load_dwordx2 v[84:85], v10, s[8:11], s48 offen offset:512
    buffer_load_dwordx2 v[86:87], v10, s[8:11], s48 offen offset:768
    buffer_load_dwordx2 v[88:89], v10, s[8:11], s48 offen offset:1024
    buffer_load_dwordx2 v[90:91], v10, s[8:11], s48 offen offset:1280
    s_waitcnt vmcnt(0)
    s_branch Laqf_go
Laq_slow:
    s_mov_b32 s36, s63
    s_mov_b32 s34, s63
    s_mov_b32 s37, 0
    s_lshl_b32 s56, s63, 6
    s_mul_i32 s58, s14, 9216
    s_mov_b32 s40, 36864
    s_mov_b32 s59, s58
    s_mov_b32 s43, 0
    s_mov_b32 s28, s8
    s_mov_b32 s29, s9
    s_mov_b32 s30, 0
    s_mov_b32 s31, 0x00020000
    s_mul_i32 s41, s63, 4718592
    s_add_u32 s41, s41, s58
    s_add_u32 s41, s41, 6291456
    s_mul_i32 s42, s56, 22528
    s_add_u32 s42, s42, 180224
    s_cmp_lg_u32 s14, 0
    s_cbranch_scc1 Laq_ini_d
    v_mov_b32 v5, 160
    s_mov_b32 s16, 0
Laq_ini:
    global_load_dword v6, v5, s[12:13] sc1
    s_add_u32 s16, s16, 1
    s_cmp_gt_u32 s16, 100000
    s_cbranch_scc1 L_role_aq_abort
    s_waitcnt vmcnt(0)
    v_cmp_gt_u32 vcc, 123, v6
    s_nop 0
    s_cbranch_vccz Laq_ini_d
    s_sleep 8
    s_branch Laq_ini
Laq_ini_d:
    s_barrier
    s_branch Laq_poll
Laq_item:
    s_waitcnt vmcnt(2)
Laq_go:
    s_barrier
    s_xor_b32 s40, s40, 36864
    s_xor_b32 s59, s59, 36864
    s_xor_b32 s66, s66, 0x2000
    s_xor_b32 s71, s71, 0x2000
    s_mov_b32 s35, s37
    s_mov_b32 s57, s56
    s_add_u32 s37, s37, 1
    s_add_u32 s56, s56, 1
    s_add_u32 s41, s41, 36864
    s_add_u32 s42, s42, 22528
    s_mov_b32 s62, 0
    v_lshlrev_b32 v9, 9, v8
    v_lshl_add_u32 v9, v7, 4, v9
    s_lshl_b32 s17, s51, 8
    s_add_u32 s17, s17, s40
    v_add_u32 v9, s17, v9
    ds_read_b128 v[56:59], v9 offset:0
    ds_read_b128 v[60:63], v9 offset:2048
    ds_read_b128 v[64:67], v9 offset:4096
    ds_read_b128 v[104:107], v9 offset:6144
    s_waitcnt lgkmcnt(3)
    v_mfma_f32_16x16x32_bf16 v[16:19], v[152:155], v[56:59], 0
    v_add_f32 v80, v80, v82
    v_mfma_f32_16x16x32_bf16 v[20:23], v[224:227], v[56:59], 0
    v_add_f32 v81, v81, v83
    v_mfma_f32_16x16x32_bf16 v[24:27], a[40:43], v[56:59], 0
    v_add_f32 v80, v80, v84
    v_mfma_f32_16x16x32_bf16 v[28:31], v[56:59], a[112:115], 0
    v_add_f32 v81, v81, v85
    v_mfma_f32_16x16x32_bf16 v[32:35], v[56:59], a[184:187], 0
    ds_read_b128 v[56:59], v9 offset:8192
    s_waitcnt lgkmcnt(3)
    v_mfma_f32_16x16x32_bf16 v[16:19], v[156:159], v[60:63], v[16:19]
    v_add_f32 v80, v80, v86
    v_mfma_f32_16x16x32_bf16 v[20:23], v[228:231], v[60:63], v[20:23]
    v_add_f32 v81, v81, v87
    v_mfma_f32_16x16x32_bf16 v[24:27], a[44:47], v[60:63], v[24:27]
    v_add_f32 v80, v80, v88
    v_mfma_f32_16x16x32_bf16 v[28:31], v[60:63], a[116:119], v[28:31]
    v_add_f32 v81, v81, v89
    v_mfma_f32_16x16x32_bf16 v[32:35], v[60:63], a[188:191], v[32:35]
    ds_read_b128 v[60:63], v9 offset:10240
    s_waitcnt lgkmcnt(3)
    v_mfma_f32_16x16x32_bf16 v[16:19], v[160:163], v[64:67], v[16:19]
    v_add_f32 v80, v80, v90
    v_mfma_f32_16x16x32_bf16 v[20:23], v[232:235], v[64:67], v[20:23]
    v_add_f32 v81, v81, v91
    v_mfma_f32_16x16x32_bf16 v[24:27], a[48:51], v[64:67], v[24:27]
    v_mov_b32 v82, v80
    v_mfma_f32_16x16x32_bf16 v[28:31], v[64:67], a[120:123], v[28:31]
    v_mov_b32 v83, v81
    v_mfma_f32_16x16x32_bf16 v[32:35], v[64:67], a[192:195], v[32:35]
    ds_read_b128 v[64:67], v9 offset:12288
    s_waitcnt lgkmcnt(3)
    v_mfma_f32_16x16x32_bf16 v[16:19], v[164:167], v[104:107], v[16:19]
    v_permlane32_swap_b32 v80, v82
    v_mfma_f32_16x16x32_bf16 v[20:23], v[236:239], v[104:107], v[20:23]
    v_permlane32_swap_b32 v81, v83
    v_mfma_f32_16x16x32_bf16 v[24:27], a[52:55], v[104:107], v[24:27]
    v_add_f32 v80, v80, v82
    v_mfma_f32_16x16x32_bf16 v[28:31], v[104:107], a[124:127], v[28:31]
    v_add_f32 v81, v81, v83
    v_mfma_f32_16x16x32_bf16 v[32:35], v[104:107], a[196:199], v[32:35]
    ds_read_b128 v[104:107], v9 offset:14336
    s_waitcnt lgkmcnt(3)
    v_mfma_f32_16x16x32_bf16 v[16:19], v[168:171], v[56:59], v[16:19]
    v_mov_b32 v82, v80
    v_mfma_f32_16x16x32_bf16 v[20:23], v[240:243], v[56:59], v[20:23]
    v_mov_b32 v83, v81
    v_mfma_f32_16x16x32_bf16 v[24:27], a[56:59], v[56:59], v[24:27]
    v_permlane16_swap_b32 v80, v82
    v_mfma_f32_16x16x32_bf16 v[28:31], v[56:59], a[128:131], v[28:31]
    v_permlane16_swap_b32 v81, v83
    v_mfma_f32_16x16x32_bf16 v[32:35], v[56:59], a[200:203], v[32:35]
    ds_read_b128 v[56:59], v9 offset:16384
    s_waitcnt lgkmcnt(3)
    v_mfma_f32_16x16x32_bf16 v[16:19], v[172:175], v[60:63], v[16:19]
    v_add_f32 v80, v80, v82
    v_mfma_f32_16x16x32_bf16 v[20:23], v[244:247], v[60:63], v[20:23]
    v_add_f32 v81, v81, v83
    v_mfma_f32_16x16x32_bf16 v[24:27], a[60:63], v[60:63], v[24:27]
    v_mul_f32 v80, 0x3ae38e39, v80
    v_mfma_f32_16x16x32_bf16 v[28:31], v[60:63], a[132:135], v[28:31]
    v_mul_f32 v81, 0x3ae38e39, v81
    v_mfma_f32_16x16x32_bf16 v[32:35], v[60:63], a[204:207], v[32:35]
    ds_read_b128 v[60:63], v9 offset:18432
    s_waitcnt lgkmcnt(3)
    v_mfma_f32_16x16x32_bf16 v[16:19], v[176:179], v[64:67], v[16:19]
    v_fma_f32 v81, -v80, v80, v81
    v_mfma_f32_16x16x32_bf16 v[20:23], v[248:251], v[64:67], v[20:23]
    v_max_f32 v81, 0, v81
    v_mfma_f32_16x16x32_bf16 v[24:27], a[64:67], v[64:67], v[24:27]
    v_add_f32 v81, 0x3727c5ac, v81
    v_mfma_f32_16x16x32_bf16 v[28:31], v[64:67], a[136:139], v[28:31]
    v_rsq_f32 v92, v81
    v_mfma_f32_16x16x32_bf16 v[32:35], v[64:67], a[208:211], v[32:35]
    ds_read_b128 v[64:67], v9 offset:20480
    s_waitcnt lgkmcnt(3)
    v_mfma_f32_16x16x32_bf16 v[16:19], v[180:183], v[104:107], v[16:19]
    v_mul_f32 v93, v80, v92
    v_mfma_f32_16x16x32_bf16 v[20:23], v[252:255], v[104:107], v[20:23]
    ds_write_b64 v11, v[92:93]
    v_mfma_f32_16x16x32_bf16 v[24:27], a[68:71], v[104:107], v[24:27]
    ds_read_b128 v[96:99], v12
    v_mfma_f32_16x16x32_bf16 v[28:31], v[104:107], a[140:143], v[28:31]
    ds_read_b128 v[100:103], v12 offset:16
    v_mfma_f32_16x16x32_bf16 v[32:35], v[104:107], a[212:215], v[32:35]
    ds_read_b128 v[104:107], v9 offset:22528
    s_waitcnt lgkmcnt(6)
    v_mfma_f32_16x16x32_bf16 v[16:19], v[184:187], v[56:59], v[16:19]
    v_mfma_f32_16x16x32_bf16 v[20:23], a[0:3], v[56:59], v[20:23]
    v_mfma_f32_16x16x32_bf16 v[24:27], a[72:75], v[56:59], v[24:27]
    v_mfma_f32_16x16x32_bf16 v[28:31], v[56:59], a[144:147], v[28:31]
    v_mfma_f32_16x16x32_bf16 v[32:35], v[56:59], a[216:219], v[32:35]
    ds_read_b128 v[56:59], v9 offset:24576
    s_waitcnt lgkmcnt(6)
    v_mfma_f32_16x16x32_bf16 v[16:19], v[188:191], v[60:63], v[16:19]
    v_mfma_f32_16x16x32_bf16 v[20:23], a[4:7], v[60:63], v[20:23]
    v_mfma_f32_16x16x32_bf16 v[24:27], a[76:79], v[60:63], v[24:27]
    v_mfma_f32_16x16x32_bf16 v[28:31], v[60:63], a[148:151], v[28:31]
    v_mfma_f32_16x16x32_bf16 v[32:35], v[60:63], a[220:223], v[32:35]
    ds_read_b128 v[60:63], v9 offset:26624
    s_waitcnt lgkmcnt(6)
    v_mfma_f32_16x16x32_bf16 v[16:19], v[192:195], v[64:67], v[16:19]
    v_mfma_f32_16x16x32_bf16 v[20:23], a[8:11], v[64:67], v[20:23]
    v_mfma_f32_16x16x32_bf16 v[24:27], a[80:83], v[64:67], v[24:27]
    v_mfma_f32_16x16x32_bf16 v[28:31], v[64:67], a[152:155], v[28:31]
    v_mfma_f32_16x16x32_bf16 v[32:35], v[64:67], a[224:227], v[32:35]
    s_waitcnt vmcnt(0)
    buffer_load_dword v2, v1, s[8:11], s42 offen sc1
    s_cmp_lg_u32 s43, 0
    s_cselect_b64 exec, 1, 0
    buffer_store_dword v3, v4, s[8:11], s43 offen sc1
    s_mov_b64 exec, -1
    s_mov_b32 s43, 0
    ds_read_b128 v[64:67], v9 offset:28672
    s_waitcnt lgkmcnt(3)
    v_mfma_f32_16x16x32_bf16 v[16:19], v[196:199], v[104:107], v[16:19]
    v_mfma_f32_16x16x32_bf16 v[20:23], a[12:15], v[104:107], v[20:23]
    v_mfma_f32_16x16x32_bf16 v[24:27], a[84:87], v[104:107], v[24:27]
    v_mfma_f32_16x16x32_bf16 v[28:31], v[104:107], a[156:159], v[28:31]
    v_mfma_f32_16x16x32_bf16 v[32:35], v[104:107], a[228:231], v[32:35]
    ds_read_b128 v[104:107], v9 offset:30720
    s_waitcnt lgkmcnt(3)
    v_mfma_f32_16x16x32_bf16 v[16:19], v[200:203], v[56:59], v[16:19]
    v_mfma_f32_16x16x32_bf16 v[20:23], a[16:19], v[56:59], v[20:23]
    v_mfma_f32_16x16x32_bf16 v[24:27], a[88:91], v[56:59], v[24:27]
    v_mfma_f32_16x16x32_bf16 v[28:31], v[56:59], a[160:163], v[28:31]
    v_mfma_f32_16x16x32_bf16 v[32:35], v[56:59], a[232:235], v[32:35]
    ds_read_b128 v[56:59], v9 offset:32768
    s_waitcnt lgkmcnt(3)
    v_mfma_f32_16x16x32_bf16 v[16:19], v[204:207], v[60:63], v[16:19]
    v_mfma_f32_16x16x32_bf16 v[20:23], a[20:23], v[60:63], v[20:23]
    v_mfma_f32_16x16x32_bf16 v[24:27], a[92:95], v[60:63], v[24:27]
    v_mfma_f32_16x16x32_bf16 v[28:31], v[60:63], a[164:167], v[28:31]
    v_mfma_f32_16x16x32_bf16 v[32:35], v[60:63], a[236:239], v[32:35]
    ds_read_b128 v[60:63], v9 offset:34816
    s_waitcnt lgkmcnt(3)
    v_mfma_f32_16x16x32_bf16 v[16:19], v[208:211], v[64:67], v[16:19]
    v_mfma_f32_16x16x32_bf16 v[20:23], a[24:27], v[64:67], v[20:23]
    v_mfma_f32_16x16x32_bf16 v[24:27], a[96:99], v[64:67], v[24:27]
    v_mfma_f32_16x16x32_bf16 v[28:31], v[64:67], a[168:171], v[28:31]
    v_mfma_f32_16x16x32_bf16 v[32:35], v[64:67], a[240:243], v[32:35]
    s_waitcnt vmcnt(1)
    v_cmp_eq_u32 vcc, 0, v2
    s_nop 0
    s_cmp_eq_u64 vcc, 0
    s_cselect_b32 s62, 1, 0
    s_cmp_lt_u32 s37, 64
    s_cselect_b32 s62, s62, 0
    s_cmp_lg_u32 s62, 0
    s_cselect_b32 s30, 268435456, 0
    s_waitcnt lgkmcnt(2)
    v_mfma_f32_16x16x32_bf16 v[16:19], v[212:215], v[104:107], v[16:19]
    v_mfma_f32_16x16x32_bf16 v[20:23], a[28:31], v[104:107], v[20:23]
    v_mfma_f32_16x16x32_bf16 v[24:27], a[100:103], v[104:107], v[24:27]
    s_add_u32 m0, s59, 0
    s_add_u32 s47, s41, 0
    buffer_load_dwordx4 v111, s[28:31], s47 offen offset:0 lds
    v_mfma_f32_16x16x32_bf16 v[28:31], v[104:107], a[172:175], v[28:31]
    v_mfma_f32_16x16x32_bf16 v[32:35], v[104:107], a[244:247], v[32:35]
    buffer_load_dwordx4 v111, s[28:31], s47 offen offset:1024 lds
    s_waitcnt lgkmcnt(1)
    v_mfma_f32_16x16x32_bf16 v[16:19], v[216:219], v[56:59], v[16:19]
    v_mfma_f32_16x16x32_bf16 v[20:23], a[32:35], v[56:59], v[20:23]
    v_mfma_f32_16x16x32_bf16 v[24:27], a[104:107], v[56:59], v[24:27]
    buffer_load_dwordx4 v111, s[28:31], s47 offen offset:2048 lds
    v_mfma_f32_16x16x32_bf16 v[28:31], v[56:59], a[176:179], v[28:31]
    v_mfma_f32_16x16x32_bf16 v[32:35], v[56:59], a[248:251], v[32:35]
    buffer_load_dwordx4 v111, s[28:31], s47 offen offset:3072 lds
    s_waitcnt lgkmcnt(0)
    v_mfma_f32_16x16x32_bf16 v[16:19], v[220:223], v[60:63], v[16:19]
    v_mfma_f32_16x16x32_bf16 v[20:23], a[36:39], v[60:63], v[20:23]
    v_mfma_f32_16x16x32_bf16 v[24:27], a[108:111], v[60:63], v[24:27]
    s_add_u32 m0, s59, 4096
    s_add_u32 s47, s41, 4096
    buffer_load_dwordx4 v111, s[28:31], s47 offen offset:0 lds
    v_mfma_f32_16x16x32_bf16 v[28:31], v[60:63], a[180:183], v[28:31]
    v_mfma_f32_16x16x32_bf16 v[32:35], v[60:63], a[252:255], v[32:35]
    buffer_load_dwordx4 v111, s[28:31], s47 offen offset:1024 lds
    buffer_load_dwordx4 v111, s[28:31], s47 offen offset:2048 lds
    buffer_load_dwordx4 v111, s[28:31], s47 offen offset:3072 lds
    s_add_u32 m0, s59, 8192
    s_add_u32 s47, s41, 8192
    buffer_load_dwordx4 v111, s[28:31], s47 offen offset:0 lds
    s_mul_i32 s48, s36, 786432
    s_mul_i32 s18, s37, 6144
    s_add_u32 s48, s48, s18
    s_add_u32 s48, s48, 15728640
    buffer_load_dwordx2 v[80:81], v10, s[28:31], s48 offen offset:0
    buffer_load_dwordx2 v[82:83], v10, s[28:31], s48 offen offset:256
    buffer_load_dwordx2 v[84:85], v10, s[28:31], s48 offen offset:512
    buffer_load_dwordx2 v[86:87], v10, s[28:31], s48 offen offset:768
    buffer_load_dwordx2 v[88:89], v10, s[28:31], s48 offen offset:1024
    buffer_load_dwordx2 v[90:91], v10, s[28:31], s48 offen offset:1280
    v_mul_f32 v94, v93, v36
    v_fma_f32 v16, v16, v92, -v94
    v_mul_f32 v94, v93, v37
    v_fma_f32 v17, v17, v92, -v94
    v_mul_f32 v94, v93, v38
    v_fma_f32 v18, v18, v92, -v94
    v_mul_f32 v94, v93, v39
    v_fma_f32 v19, v19, v92, -v94
    v_mul_f32 v94, v93, v44
    v_fma_f32 v24, v24, v92, -v94
    v_mul_f32 v94, v93, v45
    v_fma_f32 v25, v25, v92, -v94
    v_mul_f32 v94, v93, v46
    v_fma_f32 v26, v26, v92, -v94
    v_mul_f32 v94, v93, v47
    v_fma_f32 v27, v27, v92, -v94
    v_mul_f32 v94, v93, v40
    v_fma_f32 v20, v20, v92, -v94
    v_mul_f32 v94, v93, v41
    v_fma_f32 v21, v21, v92, -v94
    v_mul_f32 v94, v93, v42
    v_fma_f32 v22, v22, v92, -v94
    v_mul_f32 v94, v93, v43
    v_fma_f32 v23, v23, v92, -v94
    v_cvt_pk_bf16_f32 v128, v16, v17
    v_cvt_pk_bf16_f32 v129, v18, v19
    v_cvt_pk_bf16_f32 v130, v24, v25
    v_cvt_pk_bf16_f32 v132, v20, v21
    v_cvt_pk_bf16_f32 v133, v22, v23
    v_cvt_pk_bf16_f32 v134, v26, v27
    s_cmp_eq_u32 s35, 0
    s_cselect_b32 s46, 0xf149f2ca, 0
    v_mul_f32 v94, v97, v48
    v_fma_f32 v28, v28, v96, -v94
    v_mfma_f32_16x16x32_bf16 v[144:147], v[112:115], v[128:131], 0
    v_mul_f32 v94, v99, v49
    v_fma_f32 v29, v29, v98, -v94
    v_mfma_f32_16x16x32_bf16 v[148:151], v[132:135], v[128:131], 0
    v_mul_f32 v94, v101, v50
    v_fma_f32 v30, v30, v100, -v94
    v_mul_f32 v94, v103, v51
    v_fma_f32 v31, v31, v102, -v94
    v_mov_b32 v112, v132
    v_mov_b32 v113, v133
    v_mov_b32 v114, v134
    v_mul_f32 v94, v97, v52
    v_fma_f32 v32, v32, v96, -v94
    v_mul_f32 v94, v99, v53
    v_fma_f32 v33, v33, v98, -v94
    v_mul_f32 v94, v101, v54
    v_fma_f32 v34, v34, v100, -v94
    v_fma_f32 v144, v144, s52, v72
    v_fma_f32 v145, v145, s52, v73
    v_fma_f32 v146, v146, s52, v74
    v_fma_f32 v147, v147, s52, v75
    v_fma_f32 v148, v148, s52, v76
    v_fma_f32 v149, v149, s52, v77
    v_fma_f32 v150, v150, s52, v78
    v_fma_f32 v151, v151, s52, v79
    v_add_f32 v144, s46, v144
    v_add_f32 v145, s46, v145
    v_add_f32 v146, s46, v146
    v_add_f32 v147, s46, v147
    v_max3_f32 v5, v144, v145, v146
    v_max3_f32 v5, v5, v147, v148
    v_max3_f32 v5, v5, v149, v150
    v_max_f32 v5, v5, v151
    v_mov_b32 v6, v5
    v_mul_f32 v94, v103, v55
    v_fma_f32 v35, v35, v102, -v94
    v_permlane32_swap_b32 v5, v6
    v_max_f32 v5, v5, v6
    v_mov_b32 v6, v5
    s_nop 1
    v_permlane16_swap_b32 v5, v6
    v_max_f32 v5, v5, v6
    v_sub_f32 v144, v144, v5
    v_sub_f32 v145, v145, v5
    v_sub_f32 v146, v146, v5
    v_sub_f32 v147, v147, v5
    v_sub_f32 v148, v148, v5
    v_sub_f32 v149, v149, v5
    v_sub_f32 v150, v150, v5
    v_sub_f32 v151, v151, v5
    v_exp_f32 v144, v144
    v_exp_f32 v145, v145
    v_exp_f32 v146, v146
    v_exp_f32 v147, v147
    v_exp_f32 v148, v148
    v_exp_f32 v149, v149
    v_exp_f32 v150, v150
    v_exp_f32 v151, v151
    v_cvt_pk_bf16_f32 v68, v144, v145
    v_cvt_pk_bf16_f32 v69, v146, v147
    v_cvt_pk_bf16_f32 v70, v148, v149
    v_cvt_pk_bf16_f32 v71, v150, v151
    s_nop 1
    v_mfma_f32_16x16x32_bf16 v[16:19], v[116:119], v[68:71], 0
    s_mul_i32 s46, s57, 36864
    s_add_u32 s46, s46, 17301504
    s_nop 5
    v_rcp_f32 v6, v16
    v_cvt_pk_bf16_f32 v138, v28, v29
    v_cvt_pk_bf16_f32 v139, v30, v31
    s_nop 1
    v_mfma_f32_16x16x32_bf16 v[20:23], v[136:139], v[68:71], 0
    v_cvt_pk_bf16_f32 v142, v32, v33
    v_cvt_pk_bf16_f32 v143, v34, v35
    v_mov_b32 v136, v138
    v_mov_b32 v137, v139
    v_mfma_f32_16x16x32_bf16 v[24:27], v[140:143], v[68:71], 0
    s_nop 2
    v_mul_f32 v20, v6, v20
    v_mul_f32 v21, v6, v21
    v_mul_f32 v22, v6, v22
    v_mul_f32 v23, v6, v23
    v_cvt_pk_bf16_f32 v20, v20, v21
    v_cvt_pk_bf16_f32 v21, v22, v23
    buffer_store_dwordx2 v[20:21], v13, s[8:11], s46 offen sc1
    v_mov_b32 v140, v142
    v_mov_b32 v141, v143
    v_mul_f32 v24, v6, v24
    v_mul_f32 v25, v6, v25
    v_cvt_pk_bf16_f32 v24, v24, v25
    s_mov_b64 exec, 0xffff
    buffer_store_dword v24, v14, s[8:11], s46 offen sc1
    s_mov_b64 exec, -1
    s_mul_i32 s43, s57, 22528
    s_add_u32 s43, s43, s49
    s_cmp_lg_u32 s62, 0
    s_cbranch_scc1 Laq_item
    buffer_load_dword v2, v1, s[8:11], s42 offen sc1
    s_waitcnt vmcnt(0)
    s_cmp_ge_u32 s37, 64
    s_cbranch_scc1 Laq_fin
    v_cmp_eq_u32 vcc, 0, v2
    s_nop 0
    s_cmp_lg_u64 vcc, 0
    s_cbranch_scc1 Laq_pub
    s_add_u32 m0, s59, 0
    s_add_u32 s47, s41, 0
    buffer_load_dwordx4 v111, s[8:11], s47 offen offset:0 lds
    buffer_load_dwordx4 v111, s[8:11], s47 offen offset:1024 lds
    buffer_load_dwordx4 v111, s[8:11], s47 offen offset:2048 lds
    buffer_load_dwordx4 v111, s[8:11], s47 offen offset:3072 lds
    s_add_u32 m0, s59, 4096
    s_add_u32 s47, s41, 4096
    buffer_load_dwordx4 v111, s[8:11], s47 offen offset:0 lds
    buffer_load_dwordx4 v111, s[8:11], s47 offen offset:1024 lds
    buffer_load_dwordx4 v111, s[8:11], s47 offen offset:2048 lds
    buffer_load_dwordx4 v111, s[8:11], s47 offen offset:3072 lds
    s_add_u32 m0, s59, 8192
    s_add_u32 s47, s41, 8192
    buffer_load_dwordx4 v111, s[8:11], s47 offen offset:0 lds
    s_mul_i32 s48, s36, 786432
    s_mul_i32 s18, s37, 6144
    s_add_u32 s48, s48, s18
    s_add_u32 s48, s48, 15728640
    buffer_load_dwordx2 v[80:81], v10, s[8:11], s48 offen offset:0
    buffer_load_dwordx2 v[82:83], v10, s[8:11], s48 offen offset:256
    buffer_load_dwordx2 v[84:85], v10, s[8:11], s48 offen offset:512
    buffer_load_dwordx2 v[86:87], v10, s[8:11], s48 offen offset:768
    buffer_load_dwordx2 v[88:89], v10, s[8:11], s48 offen offset:1024
    buffer_load_dwordx2 v[90:91], v10, s[8:11], s48 offen offset:1280
    s_cmp_lg_u32 s43, 0
    s_cselect_b64 exec, 1, 0
    buffer_store_dword v3, v4, s[8:11], s43 offen sc1
    s_mov_b64 exec, -1
    s_mov_b32 s43, 0
    s_waitcnt vmcnt(1)
    s_branch Laq_go
Laq_fin:
    s_cmp_lg_u32 s43, 0
    s_cselect_b64 exec, 1, 0
    buffer_store_dword v3, v4, s[8:11], s43 offen sc1
    s_mov_b64 exec, -1
    s_mov_b32 s43, 0
    s_branch L_role_aq_exit
Laq_pub:
    s_cmp_lg_u32 s43, 0
    s_cselect_b64 exec, 1, 0
    buffer_store_dword v3, v4, s[8:11], s43 offen sc1
    s_mov_b64 exec, -1
    s_mov_b32 s43, 0
Laq_poll:
    s_mov_b32 s16, 0
Laq_pl:
    buffer_load_dword v2, v1, s[8:11], s42 offen sc1
    s_add_u32 s16, s16, 1
    s_cmp_gt_u32 s16, 100000
    s_cbranch_scc1 L_role_aq_abort
    s_waitcnt vmcnt(0)
    v_cmp_eq_u32 vcc, 0, v2
    s_nop 0
    s_cmp_eq_u64 vcc, 0
    s_cbranch_scc1 Laq_pld
    s_sleep 4
    s_branch Laq_pl
Laq_pld:
    s_add_u32 m0, s59, 0
    s_add_u32 s47, s41, 0
    buffer_load_dwordx4 v111, s[8:11], s47 offen offset:0 lds
    buffer_load_dwordx4 v111, s[8:11], s47 offen offset:1024 lds
    buffer_load_dwordx4 v111, s[8:11], s47 offen offset:2048 lds
    buffer_load_dwordx4 v111, s[8:11], s47 offen offset:3072 lds
    s_add_u32 m0, s59, 4096
    s_add_u32 s47, s41, 4096
    buffer_load_dwordx4 v111, s[8:11], s47 offen offset:0 lds
    buffer_load_dwordx4 v111, s[8:11], s47 offen offset:1024 lds
    buffer_load_dwordx4 v111, s[8:11], s47 offen offset:2048 lds
    buffer_load_dwordx4 v111, s[8:11], s47 offen offset:3072 lds
    s_add_u32 m0, s59, 8192
    s_add_u32 s47, s41, 8192
    buffer_load_dwordx4 v111, s[8:11], s47 offen offset:0 lds
    s_mul_i32 s48, s36, 786432
    s_mul_i32 s18, s37, 6144
    s_add_u32 s48, s48, s18
    s_add_u32 s48, s48, 15728640
    buffer_load_dwordx2 v[80:81], v10, s[8:11], s48 offen offset:0
    buffer_load_dwordx2 v[82:83], v10, s[8:11], s48 offen offset:256
    buffer_load_dwordx2 v[84:85], v10, s[8:11], s48 offen offset:512
    buffer_load_dwordx2 v[86:87], v10, s[8:11], s48 offen offset:768
    buffer_load_dwordx2 v[88:89], v10, s[8:11], s48 offen offset:1024
    buffer_load_dwordx2 v[90:91], v10, s[8:11], s48 offen offset:1280
    s_waitcnt vmcnt(0)
    s_branch Laq_go
L_role_aq_abort:
    s_waitcnt lgkmcnt(0)
    s_mov_b64 exec, -1
    v_mov_b32 v0, 60
    s_lshl_b32 s5, s3, 8
    s_or_b32 s5, s5, s4
    s_or_b32 s5, s5, 0x10000
    v_mov_b32 v1, s5
    global_store_dword v0, v1, s[12:13]
    s_endpgm
L_role_aq_exit:
    s_and_b32 s6, s15, 15
    s_add_u32 s6, s6, s14
    s_cmp_lg_u32 s6, 0
    s_cbranch_scc1 L_role_aq_nowb
    s_waitcnt vmcnt(0)
    buffer_wbl2 sc1
    s_waitcnt vmcnt(0)
L_role_aq_nowb:
    s_endpgm
.p2align 6
L_role_ta:
    v_and_b32 v5, 63, v0
    v_lshlrev_b32 v0, 4, v5
    v_and_b32 v7, 15, v5
    v_lshrrev_b32 v8, 4, v5
    v_min_u32 v1, 11, v5
    v_lshrrev_b32 v6, 2, v1
    v_and_b32 v1, 3, v1
    v_lshlrev_b32 v1, 2, v1
    v_lshl_add_u32 v1, v6, 7, v1
    v_mov_b32 v3, 1
    v_mov_b32 v4, 0
    s_mov_b32 s44, 0x05040100
    s_mov_b32 s45, 0x07060302
    s_lshl_b32 s17, s15, 2
    s_add_u32 s17, s17, s14
    s_lshr_b32 s36, s17, 5
    s_and_b32 s50, s17, 31
    s_mov_b32 s37, 0
    s_mov_b32 s52, 0x3e0293ee
    v_lshrrev_b32 v5, 2, v7
    v_and_b32 v6, 1, v7
    v_lshl_add_u32 v5, v5, 1, v6
    v_lshlrev_b32 v9, 8, v5
    v_lshl_add_u32 v9, v8, 4, v9
    v_lshrrev_b32 v10, 1, v0
    v_mov_b32 v6, 0xf149f2ca
    v_mov_b32 v21, 0
    v_mov_b32 v22, 0
    s_mul_i32 s42, s36, 1441792
    s_lshl_b32 s17, s50, 9
    s_add_u32 s42, s42, s17
    s_add_u32 s42, s42, 185600
    s_mul_i32 s51, s36, 50331648
    s_lshl_b32 s17, s50, 13
    s_add_u32 s51, s51, s17
    s_add_u32 s51, s51, 44040192
    s_lshl_b32 s47, s36, 11
    s_add_u32 s47, s47, s50
    s_lshl_b32 s48, s47, 13
    s_add_u32 s48, s48, 144703488
    s_mul_i32 s35, s36, 256
    s_add_u32 s35, s35, s50
    s_lshl_b32 s35, s35, 12
    s_add_u32 s35, s35, 27262976
    s_mul_i32 s43, s36, 1441792
    s_lshr_b32 s17, s50, 2
    s_lshl_b32 s17, s17, 7
    s_add_u32 s43, s43, s17
    s_lshl_b32 s17, s14, 2
    s_add_u32 s43, s43, s17
    s_add_u32 s43, s43, 184448
    s_mov_b32 s28, s8
    s_mov_b32 s29, s9
    s_mov_b32 s30, 0
    s_mov_b32 s31, 0x00020000
    s_mov_b32 s39, 0
    s_mov_b32 s49, 0
    s_mov_b32 s66, 0
    s_lshl_b32 s47, s36, 2
    s_add_u32 s47, s47, 192
    v_mov_b32 v16, 0x3f803f80
    v_lshl_add_u32 v5, v8, 2, 0
    v_cmp_le_u32 vcc, v5, v7
    s_nop 1
    v_cndmask_b32 v236, v6, v4, vcc
    v_mov_b32 v17, 0x3f803f80
    v_lshl_add_u32 v5, v8, 2, 1
    v_cmp_le_u32 vcc, v5, v7
    s_nop 1
    v_cndmask_b32 v237, v6, v4, vcc
    v_mov_b32 v18, 0x3f803f80
    v_lshl_add_u32 v5, v8, 2, 2
    v_cmp_le_u32 vcc, v5, v7
    s_nop 1
    v_cndmask_b32 v238, v6, v4, vcc
    v_mov_b32 v19, 0x3f803f80
    v_lshl_add_u32 v5, v8, 2, 3
    v_cmp_le_u32 vcc, v5, v7
    s_nop 1
    v_cndmask_b32 v239, v6, v4, vcc
    s_cmp_lg_u32 s14, 0
    s_cbranch_scc1 Lta_ini_d
    v_mov_b32 v5, 160
    s_mov_b32 s16, 0
Lta_ini:
    global_load_dword v6, v5, s[12:13] sc1
    s_add_u32 s16, s16, 1
    s_cmp_gt_u32 s16, 100000
    s_cbranch_scc1 L_role_ta_abort
    s_waitcnt vmcnt(0)
    v_cmp_gt_u32 vcc, 123, v6
    s_nop 0
    s_cbranch_vccz Lta_ini_d
    s_sleep 64
    s_branch Lta_ini
Lta_ini_d:
    s_barrier
    s_cmp_lg_u32 s14, 0
    s_cbranch_scc1 Lta_team_d
    v_mov_b32 v5, s47
    s_mov_b32 s16, 0
Lta_team:
    global_load_dword v6, v5, s[12:13] sc1
    s_add_u32 s16, s16, 1
    s_cmp_gt_u32 s16, 100000
    s_cbranch_scc1 L_role_ta_abort
    s_waitcnt vmcnt(0)
    v_cmp_gt_u32 vcc, 32, v6
    s_nop 0
    s_cbranch_vccz Lta_team_d
    s_sleep 64
    s_branch Lta_team
Lta_team_d:
    s_barrier
    v_mbcnt_lo_u32_b32 v5, -1, 0
    v_mbcnt_hi_u32_b32 v5, -1, v5
    v_and_b32 v6, 1, v5
    v_lshlrev_b32 v6, 7, v6
    v_lshlrev_b32 v5, 1, v5
    v_and_or_b32 v5, v5, 12, v6
    s_mov_b32 s16, 0
Lta_pure:
    global_load_dword v6, v5, s[12:13] sc1
    s_add_u32 s16, s16, 1
    s_cmp_gt_u32 s16, 100000
    s_cbranch_scc1 L_role_ta_abort
    s_mov_b32 s6, 0
    s_waitcnt vmcnt(0)
    v_readlane_b32 s7, v6, 0
    s_nop 0
    s_add_u32 s6, s6, s7
    v_readlane_b32 s7, v6, 1
    s_nop 0
    s_add_u32 s6, s6, s7
    v_readlane_b32 s7, v6, 2
    s_nop 0
    s_add_u32 s6, s6, s7
    v_readlane_b32 s7, v6, 3
    s_nop 0
    s_add_u32 s6, s6, s7
    v_readlane_b32 s7, v6, 4
    s_nop 0
    s_add_u32 s6, s6, s7
    v_readlane_b32 s7, v6, 5
    s_nop 0
    s_add_u32 s6, s6, s7
    v_readlane_b32 s7, v6, 6
    s_nop 0
    s_add_u32 s6, s6, s7
    v_readlane_b32 s7, v6, 7
    s_nop 0
    s_add_u32 s6, s6, s7
    v_readlane_b32 s7, v6, s3
    s_nop 0
    s_cmp_ge_u32 s7, 32
    s_cselect_b32 s61, 1, 0
    s_cselect_b32 s6, 256, s6
    s_cmp_lt_u32 s6, 256
    s_cbranch_scc1 Lta_pure
LtaF0:
    s_sub_u32 s17, s37, 33
    s_mul_i32 s18, s17, 43
    s_lshr_b32 s18, s18, 7
    s_mul_i32 s18, s18, 3
    s_cmp_eq_u32 s18, s17
    s_cselect_b32 s18, 1, 0
    s_cmp_lt_u32 s37, 34
    s_cselect_b32 s18, 1, s18
    s_cmp_eq_u32 s36, 0
    s_cselect_b32 s18, 1, s18
    s_and_b32 s18, s18, s61
    s_cbranch_scc0 LtaS0_in
LtaF0_in:
    s_and_b32 s17, s37, 7
    s_mul_i32 s17, s17, 131072
    s_add_u32 s47, s35, s17
    s_bfe_u32 s34, s37, 65539
    s_cmp_eq_u32 s39, 1
    s_cbranch_scc1 LtaF0_have
    s_waitcnt vmcnt(0)
    s_and_b32 s17, s49, s66
    s_cselect_b64 exec, 1, 0
    buffer_store_dword v3, v4, s[8:11], s43 offen
    s_andn2_b32 s17, s49, s66
    s_cselect_b64 exec, 1, 0
    buffer_store_dword v3, v4, s[8:11], s43 offen sc1
    s_mov_b64 exec, -1
    s_add_u32 s43, s43, s49
    s_mov_b32 s49, 0
    s_mov_b32 s16, 0
LtaF0_f_2:
    buffer_load_dword v2, v1, s[8:11], s42 offen sc1
    s_add_u32 s16, s16, 1
    s_cmp_gt_u32 s16, 100000
    s_cbranch_scc1 L_role_ta_abort
    s_waitcnt vmcnt(0)
    v_cmp_eq_u32 vcc, 0, v2
    s_nop 0
    s_cbranch_vccz LtaF0_fd_3
    s_sleep 4
    s_branch LtaF0_f_2
LtaF0_fd_3:
    s_add_u32 s46, s51, 0
    buffer_load_dwordx4 v[140:143], v0, s[8:11], s46 offen offset:0
    buffer_load_dwordx4 v[144:147], v0, s[8:11], s46 offen offset:1024
    buffer_load_dwordx4 v[148:151], v0, s[8:11], s46 offen offset:2048
    buffer_load_dwordx4 v[152:155], v0, s[8:11], s46 offen offset:3072
    s_add_u32 s46, s51, 4096
    buffer_load_dwordx4 v[156:159], v0, s[8:11], s46 offen offset:0
    buffer_load_dwordx4 v[160:163], v0, s[8:11], s46 offen offset:1024
    buffer_load_dwordx4 v[164:167], v0, s[8:11], s46 offen offset:2048
    buffer_load_dwordx4 v[168:171], v0, s[8:11], s46 offen offset:3072
    s_add_u32 s46, s51, 16777216
    buffer_load_dwordx4 v[172:175], v0, s[8:11], s46 offen offset:0
    buffer_load_dwordx4 v[176:179], v0, s[8:11], s46 offen offset:1024
    buffer_load_dwordx4 v[180:183], v0, s[8:11], s46 offen offset:2048
    buffer_load_dwordx4 v[184:187], v0, s[8:11], s46 offen offset:3072
    s_add_u32 s46, s51, 16781312
    buffer_load_dwordx4 v[188:191], v0, s[8:11], s46 offen offset:0
    buffer_load_dwordx4 v[192:195], v0, s[8:11], s46 offen offset:1024
    buffer_load_dwordx4 v[196:199], v0, s[8:11], s46 offen offset:2048
    buffer_load_dwordx4 v[200:203], v0, s[8:11], s46 offen offset:3072
    s_add_u32 s46, s51, 33554432
    buffer_load_dwordx4 v[204:207], v0, s[8:11], s46 offen offset:0
    buffer_load_dwordx4 v[208:211], v0, s[8:11], s46 offen offset:1024
    buffer_load_dwordx4 v[212:215], v0, s[8:11], s46 offen offset:2048
    buffer_load_dwordx4 v[216:219], v0, s[8:11], s46 offen offset:3072
    s_add_u32 s46, s51, 33558528
    buffer_load_dwordx4 v[220:223], v0, s[8:11], s46 offen offset:0
    buffer_load_dwordx4 v[224:227], v0, s[8:11], s46 offen offset:1024
    buffer_load_dwordx4 v[228:231], v0, s[8:11], s46 offen offset:2048
    buffer_load_dwordx4 v[232:235], v0, s[8:11], s46 offen offset:3072
LtaF0_have:
    s_add_u32 s17, s42, 22528
    buffer_load_dword v15, v1, s[8:11], s17 offen sc1
    buffer_load_dwordx4 v[52:55], v9, s[8:11], s47 offen offset:0 sc1
    buffer_load_dwordx4 v[56:59], v9, s[8:11], s47 offen offset:64 sc1
    buffer_load_dwordx4 v[60:63], v9, s[8:11], s47 offen offset:128 sc1
    buffer_load_dwordx4 v[64:67], v9, s[8:11], s47 offen offset:192 sc1
    buffer_load_dwordx2 v[68:69], v10, s[8:11], s47 offen offset:2048 sc1
    buffer_load_dwordx2 v[70:71], v10, s[8:11], s47 offen offset:2560 sc1
    buffer_load_dwordx2 v[72:73], v10, s[8:11], s47 offen offset:3072 sc1
    buffer_load_dwordx2 v[74:75], v10, s[8:11], s47 offen offset:3584 sc1
    s_waitcnt vmcnt(9)
    s_and_b32 s17, s49, s66
    s_cselect_b64 exec, 1, 0
    buffer_store_dword v3, v4, s[8:11], s43 offen
    s_andn2_b32 s17, s49, s66
    s_cselect_b64 exec, 1, 0
    buffer_store_dword v3, v4, s[8:11], s43 offen sc1
    s_mov_b64 exec, -1
    s_add_u32 s43, s43, s49
    s_mov_b32 s49, 0
    v_mfma_f32_16x16x32_bf16 v[32:35], v[172:175], v[140:143], 0
    v_mfma_f32_16x16x32_bf16 v[36:39], v[172:175], v[144:147], 0
    v_mfma_f32_16x16x32_bf16 v[40:43], v[176:179], v[144:147], 0
    v_mfma_f32_16x16x32_bf16 v[32:35], v[180:183], v[148:151], v[32:35]
    v_mfma_f32_16x16x32_bf16 v[36:39], v[180:183], v[152:155], v[36:39]
    v_mfma_f32_16x16x32_bf16 v[40:43], v[184:187], v[152:155], v[40:43]
    v_mfma_f32_16x16x32_bf16 v[32:35], v[188:191], v[156:159], v[32:35]
    v_mfma_f32_16x16x32_bf16 v[36:39], v[188:191], v[160:163], v[36:39]
    v_mfma_f32_16x16x32_bf16 v[40:43], v[192:195], v[160:163], v[40:43]
    v_mfma_f32_16x16x32_bf16 v[32:35], v[196:199], v[164:167], v[32:35]
    v_mfma_f32_16x16x32_bf16 v[36:39], v[196:199], v[168:171], v[36:39]
    v_mfma_f32_16x16x32_bf16 v[40:43], v[200:203], v[168:171], v[40:43]
    s_waitcnt vmcnt(2)
    v_cmp_eq_u32 vcc, 0, v15
    s_add_u32 s51, s51, 262144
    s_add_u32 s42, s42, 22528
    s_add_u32 s37, s37, 1
    s_cmp_eq_u64 vcc, 0
    s_cselect_b32 s39, 1, 0
    s_cmp_lt_u32 s37, 64
    s_cselect_b32 s39, s39, 0
    s_cmp_eq_u32 s39, 1
    s_cselect_b32 s30, 268435456, 0
    v_fma_f32 v32, v32, s52, v236
    v_fma_f32 v33, v33, s52, v237
    v_fma_f32 v34, v34, s52, v238
    v_fma_f32 v35, v35, s52, v239
    v_mul_f32 v36, s52, v36
    v_mul_f32 v37, s52, v37
    v_mul_f32 v38, s52, v38
    v_mul_f32 v39, s52, v39
    v_fma_f32 v40, v40, s52, v236
    v_fma_f32 v41, v41, s52, v237
    v_fma_f32 v42, v42, s52, v238
    v_fma_f32 v43, v43, s52, v239
    v_xor_b32 v5, s34, v52
    v_xor_b32 v6, s34, v56
    v_or_b32 v5, v5, v6
    v_xor_b32 v6, s34, v60
    v_or_b32 v5, v5, v6
    v_xor_b32 v6, s34, v64
    v_or_b32 v5, v5, v6
    v_xor_b32 v6, s34, v68
    v_or_b32 v5, v5, v6
    v_xor_b32 v6, s34, v70
    v_or_b32 v5, v5, v6
    v_xor_b32 v6, s34, v72
    v_or_b32 v5, v5, v6
    v_xor_b32 v6, s34, v74
    v_or_b32 v5, v5, v6
    v_and_b32 v5, 1, v5
    v_cmp_ne_u32 vcc, 0, v5
    s_nop 0
    s_cbranch_vccz LtaF0_r
    s_mov_b32 s16, 0
LtaF0_rp:
    buffer_load_dwordx4 v[52:55], v9, s[8:11], s47 offen offset:0 sc1
    buffer_load_dwordx4 v[56:59], v9, s[8:11], s47 offen offset:64 sc1
    buffer_load_dwordx4 v[60:63], v9, s[8:11], s47 offen offset:128 sc1
    buffer_load_dwordx4 v[64:67], v9, s[8:11], s47 offen offset:192 sc1
    buffer_load_dwordx2 v[68:69], v10, s[8:11], s47 offen offset:2048 sc1
    buffer_load_dwordx2 v[70:71], v10, s[8:11], s47 offen offset:2560 sc1
    buffer_load_dwordx2 v[72:73], v10, s[8:11], s47 offen offset:3072 sc1
    buffer_load_dwordx2 v[74:75], v10, s[8:11], s47 offen offset:3584 sc1
    s_add_u32 s16, s16, 1
    s_cmp_gt_u32 s16, 100000
    s_cbranch_scc1 L_role_ta_abort
    s_waitcnt vmcnt(0)
    v_xor_b32 v5, s34, v52
    v_xor_b32 v6, s34, v56
    v_or_b32 v5, v5, v6
    v_xor_b32 v6, s34, v60
    v_or_b32 v5, v5, v6
    v_xor_b32 v6, s34, v64
    v_or_b32 v5, v5, v6
    v_xor_b32 v6, s34, v68
    v_or_b32 v5, v5, v6
    v_xor_b32 v6, s34, v70
    v_or_b32 v5, v5, v6
    v_xor_b32 v6, s34, v72
    v_or_b32 v5, v5, v6
    v_xor_b32 v6, s34, v74
    v_or_b32 v5, v5, v6
    v_and_b32 v5, 1, v5
    v_cmp_ne_u32 vcc, 0, v5
    s_nop 0
    s_cbranch_vccz LtaF0_r
    s_sleep 2
    s_branch LtaF0_rp
LtaF0_r:
    s_and_b32 s17, s37, 3
    s_cmp_eq_u32 s17, 0
    s_cselect_b32 s17, s36, 0
    s_cmp_lg_u32 s17, 0
    s_cselect_b64 exec, 1, 0
    s_sub_u32 s17, s42, 22528
    buffer_store_dword v3, v4, s[8:11], s17 offen offset:384 sc1
    s_mov_b64 exec, -1
    s_add_u32 s46, s51, 0
    buffer_load_dwordx4 a[0:3], v0, s[28:31], s46 offen offset:0
    buffer_load_dwordx4 a[4:7], v0, s[28:31], s46 offen offset:1024
    v_mfma_f32_16x16x32_bf16 v[44:47], v[52:55], v[140:143], 0
    v_mfma_f32_16x16x32_bf16 v[48:51], v[52:55], v[144:147], 0
    v_mfma_f32_16x16x32_bf16 v[44:47], v[56:59], v[148:151], v[44:47]
    v_mfma_f32_16x16x32_bf16 v[48:51], v[56:59], v[152:155], v[48:51]
    v_mfma_f32_16x16x32_bf16 v[44:47], v[60:63], v[156:159], v[44:47]
    v_mfma_f32_16x16x32_bf16 v[48:51], v[60:63], v[160:163], v[48:51]
    v_mfma_f32_16x16x32_bf16 v[44:47], v[64:67], v[164:167], v[44:47]
    v_mfma_f32_16x16x32_bf16 v[48:51], v[64:67], v[168:171], v[48:51]
    v_max3_f32 v5, v32, v33, v34
    v_max_f32 v5, v5, v35
    s_nop 4
    v_mul_f32 v44, s52, v44
    v_mul_f32 v45, s52, v45
    v_max3_f32 v5, v5, v44, v45
    v_mov_b32 v6, v5
    buffer_load_dwordx4 a[8:11], v0, s[28:31], s46 offen offset:2048
    s_nop 0
    v_permlane32_swap_b32 v5, v6
    v_max_f32 v5, v5, v6
    v_mov_b32 v6, v5
    buffer_load_dwordx4 a[12:15], v0, s[28:31], s46 offen offset:3072
    s_nop 0
    v_permlane16_swap_b32 v5, v6
    v_max_f32 v5, v5, v6
    v_sub_f32 v32, v32, v5
    v_sub_f32 v33, v33, v5
    v_sub_f32 v34, v34, v5
    v_sub_f32 v35, v35, v5
    v_sub_f32 v44, v44, v5
    v_sub_f32 v45, v45, v5
    v_exp_f32 v32, v32
    v_exp_f32 v33, v33
    v_exp_f32 v34, v34
    v_exp_f32 v35, v35
    v_exp_f32 v44, v44
    v_exp_f32 v45, v45
    v_cvt_pk_bf16_f32 v24, v32, v33
    v_cvt_pk_bf16_f32 v25, v34, v35
    v_mov_b32 v26, 0
    v_mov_b32 v27, 0
    v_cvt_pk_bf16_f32 v20, v44, v45
    v_cvt_pk_bf16_f32 v23, v44, v45
    v_mfma_f32_16x16x32_bf16 v[28:31], v[16:19], v[24:27], 0
    v_mfma_f32_16x16x32_bf16 v[76:79], v[204:207], v[24:27], 0
    v_mfma_f32_16x16x32_bf16 v[80:83], v[208:211], v[24:27], 0
    s_add_u32 s46, s51, 4096
    buffer_load_dwordx4 a[16:19], v0, s[28:31], s46 offen offset:0
    v_mfma_f32_16x16x32_bf16 v[84:87], v[212:215], v[24:27], 0
    v_mfma_f32_16x16x32_bf16 v[88:91], v[216:219], v[24:27], 0
    buffer_load_dwordx4 a[20:23], v0, s[28:31], s46 offen offset:1024
    v_mfma_f32_16x16x32_bf16 v[92:95], v[220:223], v[24:27], 0
    v_mfma_f32_16x16x32_bf16 v[96:99], v[224:227], v[24:27], 0
    buffer_load_dwordx4 a[24:27], v0, s[28:31], s46 offen offset:2048
    v_mfma_f32_16x16x16_bf16 v[28:31], v[16:17], v[20:21], v[28:31]
    v_mfma_f32_16x16x32_bf16 v[100:103], v[228:231], v[24:27], 0
    v_mfma_f32_16x16x32_bf16 v[104:107], v[232:235], v[24:27], 0
    buffer_load_dwordx4 a[28:31], v0, s[28:31], s46 offen offset:3072
    v_mfma_f32_16x16x16_bf16 v[76:79], v[68:69], v[20:21], v[76:79]
    v_mfma_f32_16x16x16_bf16 v[80:83], v[68:69], v[22:23], v[80:83]
    s_nop 2
    v_rcp_f32 v6, v28
    v_mfma_f32_16x16x16_bf16 v[84:87], v[70:71], v[20:21], v[84:87]
    v_mfma_f32_16x16x16_bf16 v[88:91], v[70:71], v[22:23], v[88:91]
    s_nop 0
    v_mul_f32 v76, v6, v76
    v_mul_f32 v80, v6, v80
    v_cvt_pk_bf16_f32 v108, v76, v80
    v_mul_f32 v77, v6, v77
    v_mul_f32 v81, v6, v81
    v_cvt_pk_bf16_f32 v109, v77, v81
    v_mul_f32 v78, v6, v78
    v_mul_f32 v82, v6, v82
    v_cvt_pk_bf16_f32 v110, v78, v82
    v_mul_f32 v79, v6, v79
    v_mul_f32 v83, v6, v83
    v_cvt_pk_bf16_f32 v111, v79, v83
    s_add_u32 s17, s48, 0
    buffer_store_dwordx4 v[108:111], v0, s[8:11], s17 offen offset:0
    s_add_u32 s46, s51, 16777216
    buffer_load_dwordx4 a[32:35], v0, s[28:31], s46 offen offset:0
    v_mfma_f32_16x16x16_bf16 v[92:95], v[72:73], v[20:21], v[92:95]
    v_mfma_f32_16x16x16_bf16 v[96:99], v[72:73], v[22:23], v[96:99]
    v_mul_f32 v84, v6, v84
    v_mul_f32 v88, v6, v88
    v_cvt_pk_bf16_f32 v112, v84, v88
    v_mul_f32 v85, v6, v85
    v_mul_f32 v89, v6, v89
    v_cvt_pk_bf16_f32 v113, v85, v89
    v_mul_f32 v86, v6, v86
    v_mul_f32 v90, v6, v90
    v_cvt_pk_bf16_f32 v114, v86, v90
    v_mul_f32 v87, v6, v87
    v_mul_f32 v91, v6, v91
    v_cvt_pk_bf16_f32 v115, v87, v91
    buffer_store_dwordx4 v[112:115], v0, s[8:11], s17 offen offset:2048
    buffer_load_dwordx4 a[36:39], v0, s[28:31], s46 offen offset:1024
    v_mfma_f32_16x16x16_bf16 v[100:103], v[74:75], v[20:21], v[100:103]
    v_mfma_f32_16x16x16_bf16 v[104:107], v[74:75], v[22:23], v[104:107]
    v_mul_f32 v92, v6, v92
    v_mul_f32 v96, v6, v96
    v_cvt_pk_bf16_f32 v116, v92, v96
    v_mul_f32 v93, v6, v93
    v_mul_f32 v97, v6, v97
    v_cvt_pk_bf16_f32 v117, v93, v97
    v_mul_f32 v94, v6, v94
    v_mul_f32 v98, v6, v98
    v_cvt_pk_bf16_f32 v118, v94, v98
    v_mul_f32 v95, v6, v95
    v_mul_f32 v99, v6, v99
    v_cvt_pk_bf16_f32 v119, v95, v99
    s_add_u32 s17, s48, 4096
    buffer_store_dwordx4 v[116:119], v0, s[8:11], s17 offen offset:0
    buffer_load_dwordx4 a[40:43], v0, s[28:31], s46 offen offset:2048
    v_mul_f32 v100, v6, v100
    v_mul_f32 v104, v6, v104
    v_cvt_pk_bf16_f32 v120, v100, v104
    v_mul_f32 v101, v6, v101
    v_mul_f32 v105, v6, v105
    v_cvt_pk_bf16_f32 v121, v101, v105
    v_mul_f32 v102, v6, v102
    v_mul_f32 v106, v6, v106
    v_cvt_pk_bf16_f32 v122, v102, v106
    v_mul_f32 v103, v6, v103
    v_mul_f32 v107, v6, v107
    v_cvt_pk_bf16_f32 v123, v103, v107
    buffer_store_dwordx4 v[120:123], v0, s[8:11], s17 offen offset:2048
    buffer_load_dwordx4 a[44:47], v0, s[28:31], s46 offen offset:3072
    v_max3_f32 v5, v36, v37, v38
    v_max_f32 v5, v5, v39
    v_max3_f32 v5, v5, v40, v41
    v_max3_f32 v5, v5, v42, v43
    v_mul_f32 v48, s52, v48
    v_mul_f32 v49, s52, v49
    v_max3_f32 v5, v5, v48, v49
    v_mov_b32 v6, v5
    s_add_u32 s46, s51, 16781312
    buffer_load_dwordx4 a[48:51], v0, s[28:31], s46 offen offset:0
    v_permlane32_swap_b32 v5, v6
    v_max_f32 v5, v5, v6
    v_mov_b32 v6, v5
    buffer_load_dwordx4 a[52:55], v0, s[28:31], s46 offen offset:1024
    s_nop 0
    v_permlane16_swap_b32 v5, v6
    v_max_f32 v5, v5, v6
    v_sub_f32 v36, v36, v5
    v_sub_f32 v37, v37, v5
    v_sub_f32 v38, v38, v5
    v_sub_f32 v39, v39, v5
    v_sub_f32 v40, v40, v5
    v_sub_f32 v41, v41, v5
    v_sub_f32 v42, v42, v5
    v_sub_f32 v43, v43, v5
    v_sub_f32 v48, v48, v5
    v_sub_f32 v49, v49, v5
    v_exp_f32 v36, v36
    v_exp_f32 v37, v37
    v_exp_f32 v38, v38
    v_exp_f32 v39, v39
    v_exp_f32 v40, v40
    v_exp_f32 v41, v41
    v_exp_f32 v42, v42
    v_exp_f32 v43, v43
    v_exp_f32 v48, v48
    v_exp_f32 v49, v49
    v_cvt_pk_bf16_f32 v24, v36, v37
    v_cvt_pk_bf16_f32 v25, v38, v39
    v_cvt_pk_bf16_f32 v26, v40, v41
    v_cvt_pk_bf16_f32 v27, v42, v43
    v_cvt_pk_bf16_f32 v20, v48, v49
    v_cvt_pk_bf16_f32 v23, v48, v49
    v_mfma_f32_16x16x32_bf16 v[28:31], v[16:19], v[24:27], 0
    v_mfma_f32_16x16x32_bf16 v[76:79], v[204:207], v[24:27], 0
    v_mfma_f32_16x16x32_bf16 v[80:83], v[208:211], v[24:27], 0
    buffer_load_dwordx4 a[56:59], v0, s[28:31], s46 offen offset:2048
    v_mfma_f32_16x16x32_bf16 v[84:87], v[212:215], v[24:27], 0
    v_mfma_f32_16x16x32_bf16 v[88:91], v[216:219], v[24:27], 0
    buffer_load_dwordx4 a[60:63], v0, s[28:31], s46 offen offset:3072
    v_mfma_f32_16x16x32_bf16 v[92:95], v[220:223], v[24:27], 0
    v_mfma_f32_16x16x32_bf16 v[96:99], v[224:227], v[24:27], 0
    s_add_u32 s46, s51, 33554432
    buffer_load_dwordx4 a[64:67], v0, s[28:31], s46 offen offset:0
    v_mfma_f32_16x16x16_bf16 v[28:31], v[16:17], v[20:21], v[28:31]
    v_mfma_f32_16x16x32_bf16 v[100:103], v[228:231], v[24:27], 0
    v_mfma_f32_16x16x32_bf16 v[104:107], v[232:235], v[24:27], 0
    buffer_load_dwordx4 a[68:71], v0, s[28:31], s46 offen offset:1024
    v_mfma_f32_16x16x16_bf16 v[76:79], v[68:69], v[20:21], v[76:79]
    v_mfma_f32_16x16x16_bf16 v[80:83], v[68:69], v[22:23], v[80:83]
    s_nop 2
    v_rcp_f32 v6, v28
    v_mfma_f32_16x16x16_bf16 v[84:87], v[70:71], v[20:21], v[84:87]
    v_mfma_f32_16x16x16_bf16 v[88:91], v[70:71], v[22:23], v[88:91]
    s_nop 0
    v_mul_f32 v76, v6, v76
    v_mul_f32 v80, v6, v80
    v_cvt_pk_bf16_f32 v124, v76, v80
    v_mul_f32 v77, v6, v77
    v_mul_f32 v81, v6, v81
    v_cvt_pk_bf16_f32 v125, v77, v81
    v_mul_f32 v78, v6, v78
    v_mul_f32 v82, v6, v82
    v_cvt_pk_bf16_f32 v126, v78, v82
    v_mul_f32 v79, v6, v79
    v_mul_f32 v83, v6, v83
    v_cvt_pk_bf16_f32 v127, v79, v83
    s_add_u32 s17, s48, 0
    buffer_store_dwordx4 v[124:127], v0, s[8:11], s17 offen offset:1024
    buffer_load_dwordx4 a[72:75], v0, s[28:31], s46 offen offset:2048
    v_mfma_f32_16x16x16_bf16 v[92:95], v[72:73], v[20:21], v[92:95]
    v_mfma_f32_16x16x16_bf16 v[96:99], v[72:73], v[22:23], v[96:99]
    v_mul_f32 v84, v6, v84
    v_mul_f32 v88, v6, v88
    v_cvt_pk_bf16_f32 v128, v84, v88
    v_mul_f32 v85, v6, v85
    v_mul_f32 v89, v6, v89
    v_cvt_pk_bf16_f32 v129, v85, v89
    v_mul_f32 v86, v6, v86
    v_mul_f32 v90, v6, v90
    v_cvt_pk_bf16_f32 v130, v86, v90
    v_mul_f32 v87, v6, v87
    v_mul_f32 v91, v6, v91
    v_cvt_pk_bf16_f32 v131, v87, v91
    buffer_store_dwordx4 v[128:131], v0, s[8:11], s17 offen offset:3072
    buffer_load_dwordx4 a[76:79], v0, s[28:31], s46 offen offset:3072
    v_mfma_f32_16x16x16_bf16 v[100:103], v[74:75], v[20:21], v[100:103]
    v_mfma_f32_16x16x16_bf16 v[104:107], v[74:75], v[22:23], v[104:107]
    v_mul_f32 v92, v6, v92
    v_mul_f32 v96, v6, v96
    v_cvt_pk_bf16_f32 v132, v92, v96
    v_mul_f32 v93, v6, v93
    v_mul_f32 v97, v6, v97
    v_cvt_pk_bf16_f32 v133, v93, v97
    v_mul_f32 v94, v6, v94
    v_mul_f32 v98, v6, v98
    v_cvt_pk_bf16_f32 v134, v94, v98
    v_mul_f32 v95, v6, v95
    v_mul_f32 v99, v6, v99
    v_cvt_pk_bf16_f32 v135, v95, v99
    s_add_u32 s17, s48, 4096
    buffer_store_dwordx4 v[132:135], v0, s[8:11], s17 offen offset:1024
    s_add_u32 s46, s51, 33558528
    buffer_load_dwordx4 a[80:83], v0, s[28:31], s46 offen offset:0
    v_mul_f32 v100, v6, v100
    v_mul_f32 v104, v6, v104
    v_cvt_pk_bf16_f32 v136, v100, v104
    v_mul_f32 v101, v6, v101
    v_mul_f32 v105, v6, v105
    v_cvt_pk_bf16_f32 v137, v101, v105
    v_mul_f32 v102, v6, v102
    v_mul_f32 v106, v6, v106
    v_cvt_pk_bf16_f32 v138, v102, v106
    v_mul_f32 v103, v6, v103
    v_mul_f32 v107, v6, v107
    v_cvt_pk_bf16_f32 v139, v103, v107
    buffer_store_dwordx4 v[136:139], v0, s[8:11], s17 offen offset:3072
    buffer_load_dwordx4 a[84:87], v0, s[28:31], s46 offen offset:1024
    buffer_load_dwordx4 a[88:91], v0, s[28:31], s46 offen offset:2048
    buffer_load_dwordx4 a[92:95], v0, s[28:31], s46 offen offset:3072
    s_add_u32 s48, s48, 262144
    s_mov_b32 s49, 22528
    s_mov_b32 s66, -1
    s_cmp_ge_u32 s37, 64
    s_cbranch_scc1 LtaF_end
LtaF1:
    s_sub_u32 s17, s37, 33
    s_mul_i32 s18, s17, 43
    s_lshr_b32 s18, s18, 7
    s_mul_i32 s18, s18, 3
    s_cmp_eq_u32 s18, s17
    s_cselect_b32 s18, 1, 0
    s_cmp_lt_u32 s37, 34
    s_cselect_b32 s18, 1, s18
    s_cmp_eq_u32 s36, 0
    s_cselect_b32 s18, 1, s18
    s_and_b32 s18, s18, s61
    s_cbranch_scc0 LtaS1_in
LtaF1_in:
    s_and_b32 s17, s37, 7
    s_mul_i32 s17, s17, 131072
    s_add_u32 s47, s35, s17
    s_bfe_u32 s34, s37, 65539
    s_cmp_eq_u32 s39, 1
    s_cbranch_scc1 LtaF1_have
    s_waitcnt vmcnt(0)
    s_and_b32 s17, s49, s66
    s_cselect_b64 exec, 1, 0
    buffer_store_dword v3, v4, s[8:11], s43 offen
    s_andn2_b32 s17, s49, s66
    s_cselect_b64 exec, 1, 0
    buffer_store_dword v3, v4, s[8:11], s43 offen sc1
    s_mov_b64 exec, -1
    s_add_u32 s43, s43, s49
    s_mov_b32 s49, 0
    s_mov_b32 s16, 0
LtaF1_f_4:
    buffer_load_dword v2, v1, s[8:11], s42 offen sc1
    s_add_u32 s16, s16, 1
    s_cmp_gt_u32 s16, 100000
    s_cbranch_scc1 L_role_ta_abort
    s_waitcnt vmcnt(0)
    v_cmp_eq_u32 vcc, 0, v2
    s_nop 0
    s_cbranch_vccz LtaF1_fd_5
    s_sleep 4
    s_branch LtaF1_f_4
LtaF1_fd_5:
    s_add_u32 s46, s51, 0
    buffer_load_dwordx4 a[0:3], v0, s[8:11], s46 offen offset:0
    buffer_load_dwordx4 a[4:7], v0, s[8:11], s46 offen offset:1024
    buffer_load_dwordx4 a[8:11], v0, s[8:11], s46 offen offset:2048
    buffer_load_dwordx4 a[12:15], v0, s[8:11], s46 offen offset:3072
    s_add_u32 s46, s51, 4096
    buffer_load_dwordx4 a[16:19], v0, s[8:11], s46 offen offset:0
    buffer_load_dwordx4 a[20:23], v0, s[8:11], s46 offen offset:1024
    buffer_load_dwordx4 a[24:27], v0, s[8:11], s46 offen offset:2048
    buffer_load_dwordx4 a[28:31], v0, s[8:11], s46 offen offset:3072
    s_add_u32 s46, s51, 16777216
    buffer_load_dwordx4 a[32:35], v0, s[8:11], s46 offen offset:0
    buffer_load_dwordx4 a[36:39], v0, s[8:11], s46 offen offset:1024
    buffer_load_dwordx4 a[40:43], v0, s[8:11], s46 offen offset:2048
    buffer_load_dwordx4 a[44:47], v0, s[8:11], s46 offen offset:3072
    s_add_u32 s46, s51, 16781312
    buffer_load_dwordx4 a[48:51], v0, s[8:11], s46 offen offset:0
    buffer_load_dwordx4 a[52:55], v0, s[8:11], s46 offen offset:1024
    buffer_load_dwordx4 a[56:59], v0, s[8:11], s46 offen offset:2048
    buffer_load_dwordx4 a[60:63], v0, s[8:11], s46 offen offset:3072
    s_add_u32 s46, s51, 33554432
    buffer_load_dwordx4 a[64:67], v0, s[8:11], s46 offen offset:0
    buffer_load_dwordx4 a[68:71], v0, s[8:11], s46 offen offset:1024
    buffer_load_dwordx4 a[72:75], v0, s[8:11], s46 offen offset:2048
    buffer_load_dwordx4 a[76:79], v0, s[8:11], s46 offen offset:3072
    s_add_u32 s46, s51, 33558528
    buffer_load_dwordx4 a[80:83], v0, s[8:11], s46 offen offset:0
    buffer_load_dwordx4 a[84:87], v0, s[8:11], s46 offen offset:1024
    buffer_load_dwordx4 a[88:91], v0, s[8:11], s46 offen offset:2048
    buffer_load_dwordx4 a[92:95], v0, s[8:11], s46 offen offset:3072
LtaF1_have:
    s_add_u32 s17, s42, 22528
    buffer_load_dword v15, v1, s[8:11], s17 offen sc1
    buffer_load_dwordx4 v[52:55], v9, s[8:11], s47 offen offset:0 sc1
    buffer_load_dwordx4 v[56:59], v9, s[8:11], s47 offen offset:64 sc1
    buffer_load_dwordx4 v[60:63], v9, s[8:11], s47 offen offset:128 sc1
    buffer_load_dwordx4 v[64:67], v9, s[8:11], s47 offen offset:192 sc1
    buffer_load_dwordx2 v[68:69], v10, s[8:11], s47 offen offset:2048 sc1
    buffer_load_dwordx2 v[70:71], v10, s[8:11], s47 offen offset:2560 sc1
    buffer_load_dwordx2 v[72:73], v10, s[8:11], s47 offen offset:3072 sc1
    buffer_load_dwordx2 v[74:75], v10, s[8:11], s47 offen offset:3584 sc1
    s_waitcnt vmcnt(9)
    s_and_b32 s17, s49, s66
    s_cselect_b64 exec, 1, 0
    buffer_store_dword v3, v4, s[8:11], s43 offen
    s_andn2_b32 s17, s49, s66
    s_cselect_b64 exec, 1, 0
    buffer_store_dword v3, v4, s[8:11], s43 offen sc1
    s_mov_b64 exec, -1
    s_add_u32 s43, s43, s49
    s_mov_b32 s49, 0
    v_mfma_f32_16x16x32_bf16 v[32:35], a[32:35], a[0:3], 0
    v_mfma_f32_16x16x32_bf16 v[36:39], a[32:35], a[4:7], 0
    v_mfma_f32_16x16x32_bf16 v[40:43], a[36:39], a[4:7], 0
    v_mfma_f32_16x16x32_bf16 v[32:35], a[40:43], a[8:11], v[32:35]
    v_mfma_f32_16x16x32_bf16 v[36:39], a[40:43], a[12:15], v[36:39]
    v_mfma_f32_16x16x32_bf16 v[40:43], a[44:47], a[12:15], v[40:43]
    v_mfma_f32_16x16x32_bf16 v[32:35], a[48:51], a[16:19], v[32:35]
    v_mfma_f32_16x16x32_bf16 v[36:39], a[48:51], a[20:23], v[36:39]
    v_mfma_f32_16x16x32_bf16 v[40:43], a[52:55], a[20:23], v[40:43]
    v_mfma_f32_16x16x32_bf16 v[32:35], a[56:59], a[24:27], v[32:35]
    v_mfma_f32_16x16x32_bf16 v[36:39], a[56:59], a[28:31], v[36:39]
    v_mfma_f32_16x16x32_bf16 v[40:43], a[60:63], a[28:31], v[40:43]
    s_waitcnt vmcnt(2)
    v_cmp_eq_u32 vcc, 0, v15
    s_add_u32 s51, s51, 262144
    s_add_u32 s42, s42, 22528
    s_add_u32 s37, s37, 1
    s_cmp_eq_u64 vcc, 0
    s_cselect_b32 s39, 1, 0
    s_cmp_lt_u32 s37, 64
    s_cselect_b32 s39, s39, 0
    s_cmp_eq_u32 s39, 1
    s_cselect_b32 s30, 268435456, 0
    v_fma_f32 v32, v32, s52, v236
    v_fma_f32 v33, v33, s52, v237
    v_fma_f32 v34, v34, s52, v238
    v_fma_f32 v35, v35, s52, v239
    v_mul_f32 v36, s52, v36
    v_mul_f32 v37, s52, v37
    v_mul_f32 v38, s52, v38
    v_mul_f32 v39, s52, v39
    v_fma_f32 v40, v40, s52, v236
    v_fma_f32 v41, v41, s52, v237
    v_fma_f32 v42, v42, s52, v238
    v_fma_f32 v43, v43, s52, v239
    v_xor_b32 v5, s34, v52
    v_xor_b32 v6, s34, v56
    v_or_b32 v5, v5, v6
    v_xor_b32 v6, s34, v60
    v_or_b32 v5, v5, v6
    v_xor_b32 v6, s34, v64
    v_or_b32 v5, v5, v6
    v_xor_b32 v6, s34, v68
    v_or_b32 v5, v5, v6
    v_xor_b32 v6, s34, v70
    v_or_b32 v5, v5, v6
    v_xor_b32 v6, s34, v72
    v_or_b32 v5, v5, v6
    v_xor_b32 v6, s34, v74
    v_or_b32 v5, v5, v6
    v_and_b32 v5, 1, v5
    v_cmp_ne_u32 vcc, 0, v5
    s_nop 0
    s_cbranch_vccz LtaF1_r
    s_mov_b32 s16, 0
LtaF1_rp:
    buffer_load_dwordx4 v[52:55], v9, s[8:11], s47 offen offset:0 sc1
    buffer_load_dwordx4 v[56:59], v9, s[8:11], s47 offen offset:64 sc1
    buffer_load_dwordx4 v[60:63], v9, s[8:11], s47 offen offset:128 sc1
    buffer_load_dwordx4 v[64:67], v9, s[8:11], s47 offen offset:192 sc1
    buffer_load_dwordx2 v[68:69], v10, s[8:11], s47 offen offset:2048 sc1
    buffer_load_dwordx2 v[70:71], v10, s[8:11], s47 offen offset:2560 sc1
    buffer_load_dwordx2 v[72:73], v10, s[8:11], s47 offen offset:3072 sc1
    buffer_load_dwordx2 v[74:75], v10, s[8:11], s47 offen offset:3584 sc1
    s_add_u32 s16, s16, 1
    s_cmp_gt_u32 s16, 100000
    s_cbranch_scc1 L_role_ta_abort
    s_waitcnt vmcnt(0)
    v_xor_b32 v5, s34, v52
    v_xor_b32 v6, s34, v56
    v_or_b32 v5, v5, v6
    v_xor_b32 v6, s34, v60
    v_or_b32 v5, v5, v6
    v_xor_b32 v6, s34, v64
    v_or_b32 v5, v5, v6
    v_xor_b32 v6, s34, v68
    v_or_b32 v5, v5, v6
    v_xor_b32 v6, s34, v70
    v_or_b32 v5, v5, v6
    v_xor_b32 v6, s34, v72
    v_or_b32 v5, v5, v6
    v_xor_b32 v6, s34, v74
    v_or_b32 v5, v5, v6
    v_and_b32 v5, 1, v5
    v_cmp_ne_u32 vcc, 0, v5
    s_nop 0
    s_cbranch_vccz LtaF1_r
    s_sleep 2
    s_branch LtaF1_rp
LtaF1_r:
    s_and_b32 s17, s37, 3
    s_cmp_eq_u32 s17, 0
    s_cselect_b32 s17, s36, 0
    s_cmp_lg_u32 s17, 0
    s_cselect_b64 exec, 1, 0
    s_sub_u32 s17, s42, 22528
    buffer_store_dword v3, v4, s[8:11], s17 offen offset:384 sc1
    s_mov_b64 exec, -1
    s_add_u32 s46, s51, 0
    buffer_load_dwordx4 v[140:143], v0, s[28:31], s46 offen offset:0
    buffer_load_dwordx4 v[144:147], v0, s[28:31], s46 offen offset:1024
    v_mfma_f32_16x16x32_bf16 v[44:47], v[52:55], a[0:3], 0
    v_mfma_f32_16x16x32_bf16 v[48:51], v[52:55], a[4:7], 0
    v_mfma_f32_16x16x32_bf16 v[44:47], v[56:59], a[8:11], v[44:47]
    v_mfma_f32_16x16x32_bf16 v[48:51], v[56:59], a[12:15], v[48:51]
    v_mfma_f32_16x16x32_bf16 v[44:47], v[60:63], a[16:19], v[44:47]
    v_mfma_f32_16x16x32_bf16 v[48:51], v[60:63], a[20:23], v[48:51]
    v_mfma_f32_16x16x32_bf16 v[44:47], v[64:67], a[24:27], v[44:47]
    v_mfma_f32_16x16x32_bf16 v[48:51], v[64:67], a[28:31], v[48:51]
    v_max3_f32 v5, v32, v33, v34
    v_max_f32 v5, v5, v35
    s_nop 4
    v_mul_f32 v44, s52, v44
    v_mul_f32 v45, s52, v45
    v_max3_f32 v5, v5, v44, v45
    v_mov_b32 v6, v5
    buffer_load_dwordx4 v[148:151], v0, s[28:31], s46 offen offset:2048
    s_nop 0
    v_permlane32_swap_b32 v5, v6
    v_max_f32 v5, v5, v6
    v_mov_b32 v6, v5
    buffer_load_dwordx4 v[152:155], v0, s[28:31], s46 offen offset:3072
    s_nop 0
    v_permlane16_swap_b32 v5, v6
    v_max_f32 v5, v5, v6
    v_sub_f32 v32, v32, v5
    v_sub_f32 v33, v33, v5
    v_sub_f32 v34, v34, v5
    v_sub_f32 v35, v35, v5
    v_sub_f32 v44, v44, v5
    v_sub_f32 v45, v45, v5
    v_exp_f32 v32, v32
    v_exp_f32 v33, v33
    v_exp_f32 v34, v34
    v_exp_f32 v35, v35
    v_exp_f32 v44, v44
    v_exp_f32 v45, v45
    v_cvt_pk_bf16_f32 v24, v32, v33
    v_cvt_pk_bf16_f32 v25, v34, v35
    v_mov_b32 v26, 0
    v_mov_b32 v27, 0
    v_cvt_pk_bf16_f32 v20, v44, v45
    v_cvt_pk_bf16_f32 v23, v44, v45
    v_mfma_f32_16x16x32_bf16 v[28:31], v[16:19], v[24:27], 0
    v_mfma_f32_16x16x32_bf16 v[76:79], a[64:67], v[24:27], 0
    v_mfma_f32_16x16x32_bf16 v[80:83], a[68:71], v[24:27], 0
    s_add_u32 s46, s51, 4096
    buffer_load_dwordx4 v[156:159], v0, s[28:31], s46 offen offset:0
    v_mfma_f32_16x16x32_bf16 v[84:87], a[72:75], v[24:27], 0
    v_mfma_f32_16x16x32_bf16 v[88:91], a[76:79], v[24:27], 0
    buffer_load_dwordx4 v[160:163], v0, s[28:31], s46 offen offset:1024
    v_mfma_f32_16x16x32_bf16 v[92:95], a[80:83], v[24:27], 0
    v_mfma_f32_16x16x32_bf16 v[96:99], a[84:87], v[24:27], 0
    buffer_load_dwordx4 v[164:167], v0, s[28:31], s46 offen offset:2048
    v_mfma_f32_16x16x16_bf16 v[28:31], v[16:17], v[20:21], v[28:31]
    v_mfma_f32_16x16x32_bf16 v[100:103], a[88:91], v[24:27], 0
    v_mfma_f32_16x16x32_bf16 v[104:107], a[92:95], v[24:27], 0
    buffer_load_dwordx4 v[168:171], v0, s[28:31], s46 offen offset:3072
    v_mfma_f32_16x16x16_bf16 v[76:79], v[68:69], v[20:21], v[76:79]
    v_mfma_f32_16x16x16_bf16 v[80:83], v[68:69], v[22:23], v[80:83]
    s_nop 2
    v_rcp_f32 v6, v28
    v_mfma_f32_16x16x16_bf16 v[84:87], v[70:71], v[20:21], v[84:87]
    v_mfma_f32_16x16x16_bf16 v[88:91], v[70:71], v[22:23], v[88:91]
    s_nop 0
    v_mul_f32 v76, v6, v76
    v_mul_f32 v80, v6, v80
    v_cvt_pk_bf16_f32 v108, v76, v80
    v_mul_f32 v77, v6, v77
    v_mul_f32 v81, v6, v81
    v_cvt_pk_bf16_f32 v109, v77, v81
    v_mul_f32 v78, v6, v78
    v_mul_f32 v82, v6, v82
    v_cvt_pk_bf16_f32 v110, v78, v82
    v_mul_f32 v79, v6, v79
    v_mul_f32 v83, v6, v83
    v_cvt_pk_bf16_f32 v111, v79, v83
    s_add_u32 s17, s48, 0
    buffer_store_dwordx4 v[108:111], v0, s[8:11], s17 offen offset:0
    s_add_u32 s46, s51, 16777216
    buffer_load_dwordx4 v[172:175], v0, s[28:31], s46 offen offset:0
    v_mfma_f32_16x16x16_bf16 v[92:95], v[72:73], v[20:21], v[92:95]
    v_mfma_f32_16x16x16_bf16 v[96:99], v[72:73], v[22:23], v[96:99]
    v_mul_f32 v84, v6, v84
    v_mul_f32 v88, v6, v88
    v_cvt_pk_bf16_f32 v112, v84, v88
    v_mul_f32 v85, v6, v85
    v_mul_f32 v89, v6, v89
    v_cvt_pk_bf16_f32 v113, v85, v89
    v_mul_f32 v86, v6, v86
    v_mul_f32 v90, v6, v90
    v_cvt_pk_bf16_f32 v114, v86, v90
    v_mul_f32 v87, v6, v87
    v_mul_f32 v91, v6, v91
    v_cvt_pk_bf16_f32 v115, v87, v91
    buffer_store_dwordx4 v[112:115], v0, s[8:11], s17 offen offset:2048
    buffer_load_dwordx4 v[176:179], v0, s[28:31], s46 offen offset:1024
    v_mfma_f32_16x16x16_bf16 v[100:103], v[74:75], v[20:21], v[100:103]
    v_mfma_f32_16x16x16_bf16 v[104:107], v[74:75], v[22:23], v[104:107]
    v_mul_f32 v92, v6, v92
    v_mul_f32 v96, v6, v96
    v_cvt_pk_bf16_f32 v116, v92, v96
    v_mul_f32 v93, v6, v93
    v_mul_f32 v97, v6, v97
    v_cvt_pk_bf16_f32 v117, v93, v97
    v_mul_f32 v94, v6, v94
    v_mul_f32 v98, v6, v98
    v_cvt_pk_bf16_f32 v118, v94, v98
    v_mul_f32 v95, v6, v95
    v_mul_f32 v99, v6, v99
    v_cvt_pk_bf16_f32 v119, v95, v99
    s_add_u32 s17, s48, 4096
    buffer_store_dwordx4 v[116:119], v0, s[8:11], s17 offen offset:0
    buffer_load_dwordx4 v[180:183], v0, s[28:31], s46 offen offset:2048
    v_mul_f32 v100, v6, v100
    v_mul_f32 v104, v6, v104
    v_cvt_pk_bf16_f32 v120, v100, v104
    v_mul_f32 v101, v6, v101
    v_mul_f32 v105, v6, v105
    v_cvt_pk_bf16_f32 v121, v101, v105
    v_mul_f32 v102, v6, v102
    v_mul_f32 v106, v6, v106
    v_cvt_pk_bf16_f32 v122, v102, v106
    v_mul_f32 v103, v6, v103
    v_mul_f32 v107, v6, v107
    v_cvt_pk_bf16_f32 v123, v103, v107
    buffer_store_dwordx4 v[120:123], v0, s[8:11], s17 offen offset:2048
    buffer_load_dwordx4 v[184:187], v0, s[28:31], s46 offen offset:3072
    v_max3_f32 v5, v36, v37, v38
    v_max_f32 v5, v5, v39
    v_max3_f32 v5, v5, v40, v41
    v_max3_f32 v5, v5, v42, v43
    v_mul_f32 v48, s52, v48
    v_mul_f32 v49, s52, v49
    v_max3_f32 v5, v5, v48, v49
    v_mov_b32 v6, v5
    s_add_u32 s46, s51, 16781312
    buffer_load_dwordx4 v[188:191], v0, s[28:31], s46 offen offset:0
    v_permlane32_swap_b32 v5, v6
    v_max_f32 v5, v5, v6
    v_mov_b32 v6, v5
    buffer_load_dwordx4 v[192:195], v0, s[28:31], s46 offen offset:1024
    s_nop 0
    v_permlane16_swap_b32 v5, v6
    v_max_f32 v5, v5, v6
    v_sub_f32 v36, v36, v5
    v_sub_f32 v37, v37, v5
    v_sub_f32 v38, v38, v5
    v_sub_f32 v39, v39, v5
    v_sub_f32 v40, v40, v5
    v_sub_f32 v41, v41, v5
    v_sub_f32 v42, v42, v5
    v_sub_f32 v43, v43, v5
    v_sub_f32 v48, v48, v5
    v_sub_f32 v49, v49, v5
    v_exp_f32 v36, v36
    v_exp_f32 v37, v37
    v_exp_f32 v38, v38
    v_exp_f32 v39, v39
    v_exp_f32 v40, v40
    v_exp_f32 v41, v41
    v_exp_f32 v42, v42
    v_exp_f32 v43, v43
    v_exp_f32 v48, v48
    v_exp_f32 v49, v49
    v_cvt_pk_bf16_f32 v24, v36, v37
    v_cvt_pk_bf16_f32 v25, v38, v39
    v_cvt_pk_bf16_f32 v26, v40, v41
    v_cvt_pk_bf16_f32 v27, v42, v43
    v_cvt_pk_bf16_f32 v20, v48, v49
    v_cvt_pk_bf16_f32 v23, v48, v49
    v_mfma_f32_16x16x32_bf16 v[28:31], v[16:19], v[24:27], 0
    v_mfma_f32_16x16x32_bf16 v[76:79], a[64:67], v[24:27], 0
    v_mfma_f32_16x16x32_bf16 v[80:83], a[68:71], v[24:27], 0
    buffer_load_dwordx4 v[196:199], v0, s[28:31], s46 offen offset:2048
    v_mfma_f32_16x16x32_bf16 v[84:87], a[72:75], v[24:27], 0
    v_mfma_f32_16x16x32_bf16 v[88:91], a[76:79], v[24:27], 0
    buffer_load_dwordx4 v[200:203], v0, s[28:31], s46 offen offset:3072
    v_mfma_f32_16x16x32_bf16 v[92:95], a[80:83], v[24:27], 0
    v_mfma_f32_16x16x32_bf16 v[96:99], a[84:87], v[24:27], 0
    s_add_u32 s46, s51, 33554432
    buffer_load_dwordx4 v[204:207], v0, s[28:31], s46 offen offset:0
    v_mfma_f32_16x16x16_bf16 v[28:31], v[16:17], v[20:21], v[28:31]
    v_mfma_f32_16x16x32_bf16 v[100:103], a[88:91], v[24:27], 0
    v_mfma_f32_16x16x32_bf16 v[104:107], a[92:95], v[24:27], 0
    buffer_load_dwordx4 v[208:211], v0, s[28:31], s46 offen offset:1024
    v_mfma_f32_16x16x16_bf16 v[76:79], v[68:69], v[20:21], v[76:79]
    v_mfma_f32_16x16x16_bf16 v[80:83], v[68:69], v[22:23], v[80:83]
    s_nop 2
    v_rcp_f32 v6, v28
    v_mfma_f32_16x16x16_bf16 v[84:87], v[70:71], v[20:21], v[84:87]
    v_mfma_f32_16x16x16_bf16 v[88:91], v[70:71], v[22:23], v[88:91]
    s_nop 0
    v_mul_f32 v76, v6, v76
    v_mul_f32 v80, v6, v80
    v_cvt_pk_bf16_f32 v124, v76, v80
    v_mul_f32 v77, v6, v77
    v_mul_f32 v81, v6, v81
    v_cvt_pk_bf16_f32 v125, v77, v81
    v_mul_f32 v78, v6, v78
    v_mul_f32 v82, v6, v82
    v_cvt_pk_bf16_f32 v126, v78, v82
    v_mul_f32 v79, v6, v79
    v_mul_f32 v83, v6, v83
    v_cvt_pk_bf16_f32 v127, v79, v83
    s_add_u32 s17, s48, 0
    buffer_store_dwordx4 v[124:127], v0, s[8:11], s17 offen offset:1024
    buffer_load_dwordx4 v[212:215], v0, s[28:31], s46 offen offset:2048
    v_mfma_f32_16x16x16_bf16 v[92:95], v[72:73], v[20:21], v[92:95]
    v_mfma_f32_16x16x16_bf16 v[96:99], v[72:73], v[22:23], v[96:99]
    v_mul_f32 v84, v6, v84
    v_mul_f32 v88, v6, v88
    v_cvt_pk_bf16_f32 v128, v84, v88
    v_mul_f32 v85, v6, v85
    v_mul_f32 v89, v6, v89
    v_cvt_pk_bf16_f32 v129, v85, v89
    v_mul_f32 v86, v6, v86
    v_mul_f32 v90, v6, v90
    v_cvt_pk_bf16_f32 v130, v86, v90
    v_mul_f32 v87, v6, v87
    v_mul_f32 v91, v6, v91
    v_cvt_pk_bf16_f32 v131, v87, v91
    buffer_store_dwordx4 v[128:131], v0, s[8:11], s17 offen offset:3072
    buffer_load_dwordx4 v[216:219], v0, s[28:31], s46 offen offset:3072
    v_mfma_f32_16x16x16_bf16 v[100:103], v[74:75], v[20:21], v[100:103]
    v_mfma_f32_16x16x16_bf16 v[104:107], v[74:75], v[22:23], v[104:107]
    v_mul_f32 v92, v6, v92
    v_mul_f32 v96, v6, v96
    v_cvt_pk_bf16_f32 v132, v92, v96
    v_mul_f32 v93, v6, v93
    v_mul_f32 v97, v6, v97
    v_cvt_pk_bf16_f32 v133, v93, v97
    v_mul_f32 v94, v6, v94
    v_mul_f32 v98, v6, v98
    v_cvt_pk_bf16_f32 v134, v94, v98
    v_mul_f32 v95, v6, v95
    v_mul_f32 v99, v6, v99
    v_cvt_pk_bf16_f32 v135, v95, v99
    s_add_u32 s17, s48, 4096
    buffer_store_dwordx4 v[132:135], v0, s[8:11], s17 offen offset:1024
    s_add_u32 s46, s51, 33558528
    buffer_load_dwordx4 v[220:223], v0, s[28:31], s46 offen offset:0
    v_mul_f32 v100, v6, v100
    v_mul_f32 v104, v6, v104
    v_cvt_pk_bf16_f32 v136, v100, v104
    v_mul_f32 v101, v6, v101
    v_mul_f32 v105, v6, v105
    v_cvt_pk_bf16_f32 v137, v101, v105
    v_mul_f32 v102, v6, v102
    v_mul_f32 v106, v6, v106
    v_cvt_pk_bf16_f32 v138, v102, v106
    v_mul_f32 v103, v6, v103
    v_mul_f32 v107, v6, v107
    v_cvt_pk_bf16_f32 v139, v103, v107
    buffer_store_dwordx4 v[136:139], v0, s[8:11], s17 offen offset:3072
    buffer_load_dwordx4 v[224:227], v0, s[28:31], s46 offen offset:1024
    buffer_load_dwordx4 v[228:231], v0, s[28:31], s46 offen offset:2048
    buffer_load_dwordx4 v[232:235], v0, s[28:31], s46 offen offset:3072
    s_add_u32 s48, s48, 262144
    s_mov_b32 s49, 22528
    s_mov_b32 s66, -1
    s_cmp_ge_u32 s37, 64
    s_cbranch_scc1 LtaF_end
    s_branch LtaF0
LtaF_end:
    s_waitcnt vmcnt(0)
    s_and_b32 s17, s49, s66
    s_cselect_b64 exec, 1, 0
    buffer_store_dword v3, v4, s[8:11], s43 offen
    s_andn2_b32 s17, s49, s66
    s_cselect_b64 exec, 1, 0
    buffer_store_dword v3, v4, s[8:11], s43 offen sc1
    s_mov_b64 exec, -1
    s_add_u32 s43, s43, s49
    s_mov_b32 s49, 0
    s_branch L_role_ta_exit
LtaS0:
    s_sub_u32 s17, s37, 33
    s_mul_i32 s18, s17, 43
    s_lshr_b32 s18, s18, 7
    s_mul_i32 s18, s18, 3
    s_cmp_eq_u32 s18, s17
    s_cselect_b32 s18, 1, 0
    s_cmp_lt_u32 s37, 34
    s_cselect_b32 s18, 1, s18
    s_cmp_eq_u32 s36, 0
    s_cselect_b32 s18, 1, s18
    s_and_b32 s18, s18, s61
    s_cbranch_scc1 LtaF0_in
LtaS0_in:
    s_and_b32 s17, s37, 7
    s_mul_i32 s17, s17, 131072
    s_add_u32 s47, s35, s17
    s_bfe_u32 s34, s37, 65539
    s_cmp_eq_u32 s39, 1
    s_cbranch_scc1 LtaS0_have
    s_waitcnt vmcnt(0)
    s_and_b32 s17, s49, s66
    s_cselect_b64 exec, 1, 0
    buffer_store_dword v3, v4, s[8:11], s43 offen
    s_andn2_b32 s17, s49, s66
    s_cselect_b64 exec, 1, 0
    buffer_store_dword v3, v4, s[8:11], s43 offen sc1
    s_mov_b64 exec, -1
    s_add_u32 s43, s43, s49
    s_mov_b32 s49, 0
    s_mov_b32 s16, 0
LtaS0_f_6:
    buffer_load_dword v2, v1, s[8:11], s42 offen sc1
    s_add_u32 s16, s16, 1
    s_cmp_gt_u32 s16, 100000
    s_cbranch_scc1 L_role_ta_abort
    s_waitcnt vmcnt(0)
    v_cmp_eq_u32 vcc, 0, v2
    s_nop 0
    s_cbranch_vccz LtaS0_fd_7
    s_sleep 4
    s_branch LtaS0_f_6
LtaS0_fd_7:
    s_add_u32 s46, s51, 0
    buffer_load_dwordx4 v[140:143], v0, s[8:11], s46 offen offset:0
    buffer_load_dwordx4 v[144:147], v0, s[8:11], s46 offen offset:1024
    buffer_load_dwordx4 v[148:151], v0, s[8:11], s46 offen offset:2048
    buffer_load_dwordx4 v[152:155], v0, s[8:11], s46 offen offset:3072
    s_add_u32 s46, s51, 4096
    buffer_load_dwordx4 v[156:159], v0, s[8:11], s46 offen offset:0
    buffer_load_dwordx4 v[160:163], v0, s[8:11], s46 offen offset:1024
    buffer_load_dwordx4 v[164:167], v0, s[8:11], s46 offen offset:2048
    buffer_load_dwordx4 v[168:171], v0, s[8:11], s46 offen offset:3072
    s_add_u32 s46, s51, 16777216
    buffer_load_dwordx4 v[172:175], v0, s[8:11], s46 offen offset:0
    buffer_load_dwordx4 v[176:179], v0, s[8:11], s46 offen offset:1024
    buffer_load_dwordx4 v[180:183], v0, s[8:11], s46 offen offset:2048
    buffer_load_dwordx4 v[184:187], v0, s[8:11], s46 offen offset:3072
    s_add_u32 s46, s51, 16781312
    buffer_load_dwordx4 v[188:191], v0, s[8:11], s46 offen offset:0
    buffer_load_dwordx4 v[192:195], v0, s[8:11], s46 offen offset:1024
    buffer_load_dwordx4 v[196:199], v0, s[8:11], s46 offen offset:2048
    buffer_load_dwordx4 v[200:203], v0, s[8:11], s46 offen offset:3072
    s_add_u32 s46, s51, 33554432
    buffer_load_dwordx4 v[204:207], v0, s[8:11], s46 offen offset:0
    buffer_load_dwordx4 v[208:211], v0, s[8:11], s46 offen offset:1024
    buffer_load_dwordx4 v[212:215], v0, s[8:11], s46 offen offset:2048
    buffer_load_dwordx4 v[216:219], v0, s[8:11], s46 offen offset:3072
    s_add_u32 s46, s51, 33558528
    buffer_load_dwordx4 v[220:223], v0, s[8:11], s46 offen offset:0
    buffer_load_dwordx4 v[224:227], v0, s[8:11], s46 offen offset:1024
    buffer_load_dwordx4 v[228:231], v0, s[8:11], s46 offen offset:2048
    buffer_load_dwordx4 v[232:235], v0, s[8:11], s46 offen offset:3072
LtaS0_have:
    s_add_u32 s17, s42, 22528
    buffer_load_dword v15, v1, s[8:11], s17 offen sc1
    buffer_load_dwordx4 v[52:55], v9, s[8:11], s47 offen offset:0 sc1
    buffer_load_dwordx4 v[56:59], v9, s[8:11], s47 offen offset:64 sc1
    buffer_load_dwordx4 v[60:63], v9, s[8:11], s47 offen offset:128 sc1
    buffer_load_dwordx4 v[64:67], v9, s[8:11], s47 offen offset:192 sc1
    buffer_load_dwordx2 v[68:69], v10, s[8:11], s47 offen offset:2048 sc1
    buffer_load_dwordx2 v[70:71], v10, s[8:11], s47 offen offset:2560 sc1
    buffer_load_dwordx2 v[72:73], v10, s[8:11], s47 offen offset:3072 sc1
    buffer_load_dwordx2 v[74:75], v10, s[8:11], s47 offen offset:3584 sc1
    s_waitcnt vmcnt(9)
    s_and_b32 s17, s49, s66
    s_cselect_b64 exec, 1, 0
    buffer_store_dword v3, v4, s[8:11], s43 offen
    s_andn2_b32 s17, s49, s66
    s_cselect_b64 exec, 1, 0
    buffer_store_dword v3, v4, s[8:11], s43 offen sc1
    s_mov_b64 exec, -1
    s_add_u32 s43, s43, s49
    s_mov_b32 s49, 0
    v_mfma_f32_16x16x32_bf16 v[32:35], v[172:175], v[140:143], 0
    v_mfma_f32_16x16x32_bf16 v[36:39], v[172:175], v[144:147], 0
    v_mfma_f32_16x16x32_bf16 v[40:43], v[176:179], v[144:147], 0
    v_mfma_f32_16x16x32_bf16 v[32:35], v[180:183], v[148:151], v[32:35]
    v_mfma_f32_16x16x32_bf16 v[36:39], v[180:183], v[152:155], v[36:39]
    v_mfma_f32_16x16x32_bf16 v[40:43], v[184:187], v[152:155], v[40:43]
    v_mfma_f32_16x16x32_bf16 v[32:35], v[188:191], v[156:159], v[32:35]
    v_mfma_f32_16x16x32_bf16 v[36:39], v[188:191], v[160:163], v[36:39]
    v_mfma_f32_16x16x32_bf16 v[40:43], v[192:195], v[160:163], v[40:43]
    v_mfma_f32_16x16x32_bf16 v[32:35], v[196:199], v[164:167], v[32:35]
    v_mfma_f32_16x16x32_bf16 v[36:39], v[196:199], v[168:171], v[36:39]
    v_mfma_f32_16x16x32_bf16 v[40:43], v[200:203], v[168:171], v[40:43]
    s_waitcnt vmcnt(2)
    v_cmp_eq_u32 vcc, 0, v15
    s_add_u32 s51, s51, 262144
    s_add_u32 s42, s42, 22528
    s_add_u32 s37, s37, 1
    s_cmp_eq_u64 vcc, 0
    s_cselect_b32 s39, 1, 0
    s_cmp_lt_u32 s37, 64
    s_cselect_b32 s39, s39, 0
    s_cmp_eq_u32 s39, 1
    s_cselect_b32 s30, 268435456, 0
    v_fma_f32 v32, v32, s52, v236
    v_fma_f32 v33, v33, s52, v237
    v_fma_f32 v34, v34, s52, v238
    v_fma_f32 v35, v35, s52, v239
    v_mul_f32 v36, s52, v36
    v_mul_f32 v37, s52, v37
    v_mul_f32 v38, s52, v38
    v_mul_f32 v39, s52, v39
    v_fma_f32 v40, v40, s52, v236
    v_fma_f32 v41, v41, s52, v237
    v_fma_f32 v42, v42, s52, v238
    v_fma_f32 v43, v43, s52, v239
    v_xor_b32 v5, s34, v52
    v_xor_b32 v6, s34, v56
    v_or_b32 v5, v5, v6
    v_xor_b32 v6, s34, v60
    v_or_b32 v5, v5, v6
    v_xor_b32 v6, s34, v64
    v_or_b32 v5, v5, v6
    v_xor_b32 v6, s34, v68
    v_or_b32 v5, v5, v6
    v_xor_b32 v6, s34, v70
    v_or_b32 v5, v5, v6
    v_xor_b32 v6, s34, v72
    v_or_b32 v5, v5, v6
    v_xor_b32 v6, s34, v74
    v_or_b32 v5, v5, v6
    v_and_b32 v5, 1, v5
    v_cmp_ne_u32 vcc, 0, v5
    s_nop 0
    s_cbranch_vccz LtaS0_r
    s_mov_b32 s16, 0
LtaS0_rp:
    buffer_load_dwordx4 v[52:55], v9, s[8:11], s47 offen offset:0 sc1
    buffer_load_dwordx4 v[56:59], v9, s[8:11], s47 offen offset:64 sc1
    buffer_load_dwordx4 v[60:63], v9, s[8:11], s47 offen offset:128 sc1
    buffer_load_dwordx4 v[64:67], v9, s[8:11], s47 offen offset:192 sc1
    buffer_load_dwordx2 v[68:69], v10, s[8:11], s47 offen offset:2048 sc1
    buffer_load_dwordx2 v[70:71], v10, s[8:11], s47 offen offset:2560 sc1
    buffer_load_dwordx2 v[72:73], v10, s[8:11], s47 offen offset:3072 sc1
    buffer_load_dwordx2 v[74:75], v10, s[8:11], s47 offen offset:3584 sc1
    s_add_u32 s16, s16, 1
    s_cmp_gt_u32 s16, 100000
    s_cbranch_scc1 L_role_ta_abort
    s_waitcnt vmcnt(0)
    v_xor_b32 v5, s34, v52
    v_xor_b32 v6, s34, v56
    v_or_b32 v5, v5, v6
    v_xor_b32 v6, s34, v60
    v_or_b32 v5, v5, v6
    v_xor_b32 v6, s34, v64
    v_or_b32 v5, v5, v6
    v_xor_b32 v6, s34, v68
    v_or_b32 v5, v5, v6
    v_xor_b32 v6, s34, v70
    v_or_b32 v5, v5, v6
    v_xor_b32 v6, s34, v72
    v_or_b32 v5, v5, v6
    v_xor_b32 v6, s34, v74
    v_or_b32 v5, v5, v6
    v_and_b32 v5, 1, v5
    v_cmp_ne_u32 vcc, 0, v5
    s_nop 0
    s_cbranch_vccz LtaS0_r
    s_sleep 2
    s_branch LtaS0_rp
LtaS0_r:
    s_and_b32 s17, s37, 3
    s_cmp_eq_u32 s17, 0
    s_cselect_b32 s17, s36, 0
    s_cmp_lg_u32 s17, 0
    s_cselect_b64 exec, 1, 0
    s_sub_u32 s17, s42, 22528
    buffer_store_dword v3, v4, s[8:11], s17 offen offset:384 sc1
    s_mov_b64 exec, -1
    s_add_u32 s46, s51, 0
    buffer_load_dwordx4 a[0:3], v0, s[28:31], s46 offen offset:0
    buffer_load_dwordx4 a[4:7], v0, s[28:31], s46 offen offset:1024
    v_mfma_f32_16x16x32_bf16 v[44:47], v[52:55], v[140:143], 0
    v_mfma_f32_16x16x32_bf16 v[48:51], v[52:55], v[144:147], 0
    v_mfma_f32_16x16x32_bf16 v[44:47], v[56:59], v[148:151], v[44:47]
    v_mfma_f32_16x16x32_bf16 v[48:51], v[56:59], v[152:155], v[48:51]
    v_mfma_f32_16x16x32_bf16 v[44:47], v[60:63], v[156:159], v[44:47]
    v_mfma_f32_16x16x32_bf16 v[48:51], v[60:63], v[160:163], v[48:51]
    v_mfma_f32_16x16x32_bf16 v[44:47], v[64:67], v[164:167], v[44:47]
    v_mfma_f32_16x16x32_bf16 v[48:51], v[64:67], v[168:171], v[48:51]
    v_max3_f32 v5, v32, v33, v34
    v_max_f32 v5, v5, v35
    s_nop 4
    v_mul_f32 v44, s52, v44
    v_mul_f32 v45, s52, v45
    v_max3_f32 v5, v5, v44, v45
    v_mov_b32 v6, v5
    buffer_load_dwordx4 a[8:11], v0, s[28:31], s46 offen offset:2048
    s_nop 0
    v_permlane32_swap_b32 v5, v6
    v_max_f32 v5, v5, v6
    v_mov_b32 v6, v5
    buffer_load_dwordx4 a[12:15], v0, s[28:31], s46 offen offset:3072
    s_nop 0
    v_permlane16_swap_b32 v5, v6
    v_max_f32 v5, v5, v6
    v_sub_f32 v32, v32, v5
    v_sub_f32 v33, v33, v5
    v_sub_f32 v34, v34, v5
    v_sub_f32 v35, v35, v5
    v_sub_f32 v44, v44, v5
    v_sub_f32 v45, v45, v5
    v_exp_f32 v32, v32
    v_exp_f32 v33, v33
    v_exp_f32 v34, v34
    v_exp_f32 v35, v35
    v_exp_f32 v44, v44
    v_exp_f32 v45, v45
    v_cvt_pk_bf16_f32 v24, v32, v33
    v_cvt_pk_bf16_f32 v25, v34, v35
    v_mov_b32 v26, 0
    v_mov_b32 v27, 0
    v_cvt_pk_bf16_f32 v20, v44, v45
    v_cvt_pk_bf16_f32 v23, v44, v45
    v_mfma_f32_16x16x32_bf16 v[28:31], v[16:19], v[24:27], 0
    v_mfma_f32_16x16x32_bf16 v[76:79], v[204:207], v[24:27], 0
    v_mfma_f32_16x16x32_bf16 v[80:83], v[208:211], v[24:27], 0
    s_add_u32 s46, s51, 4096
    buffer_load_dwordx4 a[16:19], v0, s[28:31], s46 offen offset:0
    v_mfma_f32_16x16x32_bf16 v[84:87], v[212:215], v[24:27], 0
    v_mfma_f32_16x16x32_bf16 v[88:91], v[216:219], v[24:27], 0
    buffer_load_dwordx4 a[20:23], v0, s[28:31], s46 offen offset:1024
    v_mfma_f32_16x16x32_bf16 v[92:95], v[220:223], v[24:27], 0
    v_mfma_f32_16x16x32_bf16 v[96:99], v[224:227], v[24:27], 0
    buffer_load_dwordx4 a[24:27], v0, s[28:31], s46 offen offset:2048
    v_mfma_f32_16x16x16_bf16 v[28:31], v[16:17], v[20:21], v[28:31]
    v_mfma_f32_16x16x32_bf16 v[100:103], v[228:231], v[24:27], 0
    v_mfma_f32_16x16x32_bf16 v[104:107], v[232:235], v[24:27], 0
    buffer_load_dwordx4 a[28:31], v0, s[28:31], s46 offen offset:3072
    v_mfma_f32_16x16x16_bf16 v[76:79], v[68:69], v[20:21], v[76:79]
    v_mfma_f32_16x16x16_bf16 v[80:83], v[68:69], v[22:23], v[80:83]
    s_nop 2
    v_rcp_f32 v6, v28
    v_mfma_f32_16x16x16_bf16 v[84:87], v[70:71], v[20:21], v[84:87]
    v_mfma_f32_16x16x16_bf16 v[88:91], v[70:71], v[22:23], v[88:91]
    s_nop 0
    v_mul_f32 v76, v6, v76
    v_mul_f32 v80, v6, v80
    v_cvt_pk_bf16_f32 v108, v76, v80
    v_mul_f32 v77, v6, v77
    v_mul_f32 v81, v6, v81
    v_cvt_pk_bf16_f32 v109, v77, v81
    v_mul_f32 v78, v6, v78
    v_mul_f32 v82, v6, v82
    v_cvt_pk_bf16_f32 v110, v78, v82
    v_mul_f32 v79, v6, v79
    v_mul_f32 v83, v6, v83
    v_cvt_pk_bf16_f32 v111, v79, v83
    s_add_u32 s17, s48, 0
    buffer_store_dwordx4 v[108:111], v0, s[8:11], s17 offen offset:0 sc1
    s_add_u32 s46, s51, 16777216
    buffer_load_dwordx4 a[32:35], v0, s[28:31], s46 offen offset:0
    v_mfma_f32_16x16x16_bf16 v[92:95], v[72:73], v[20:21], v[92:95]
    v_mfma_f32_16x16x16_bf16 v[96:99], v[72:73], v[22:23], v[96:99]
    v_mul_f32 v84, v6, v84
    v_mul_f32 v88, v6, v88
    v_cvt_pk_bf16_f32 v112, v84, v88
    v_mul_f32 v85, v6, v85
    v_mul_f32 v89, v6, v89
    v_cvt_pk_bf16_f32 v113, v85, v89
    v_mul_f32 v86, v6, v86
    v_mul_f32 v90, v6, v90
    v_cvt_pk_bf16_f32 v114, v86, v90
    v_mul_f32 v87, v6, v87
    v_mul_f32 v91, v6, v91
    v_cvt_pk_bf16_f32 v115, v87, v91
    buffer_store_dwordx4 v[112:115], v0, s[8:11], s17 offen offset:2048 sc1
    buffer_load_dwordx4 a[36:39], v0, s[28:31], s46 offen offset:1024
    v_mfma_f32_16x16x16_bf16 v[100:103], v[74:75], v[20:21], v[100:103]
    v_mfma_f32_16x16x16_bf16 v[104:107], v[74:75], v[22:23], v[104:107]
    v_mul_f32 v92, v6, v92
    v_mul_f32 v96, v6, v96
    v_cvt_pk_bf16_f32 v116, v92, v96
    v_mul_f32 v93, v6, v93
    v_mul_f32 v97, v6, v97
    v_cvt_pk_bf16_f32 v117, v93, v97
    v_mul_f32 v94, v6, v94
    v_mul_f32 v98, v6, v98
    v_cvt_pk_bf16_f32 v118, v94, v98
    v_mul_f32 v95, v6, v95
    v_mul_f32 v99, v6, v99
    v_cvt_pk_bf16_f32 v119, v95, v99
    s_add_u32 s17, s48, 4096
    buffer_store_dwordx4 v[116:119], v0, s[8:11], s17 offen offset:0 sc1
    buffer_load_dwordx4 a[40:43], v0, s[28:31], s46 offen offset:2048
    v_mul_f32 v100, v6, v100
    v_mul_f32 v104, v6, v104
    v_cvt_pk_bf16_f32 v120, v100, v104
    v_mul_f32 v101, v6, v101
    v_mul_f32 v105, v6, v105
    v_cvt_pk_bf16_f32 v121, v101, v105
    v_mul_f32 v102, v6, v102
    v_mul_f32 v106, v6, v106
    v_cvt_pk_bf16_f32 v122, v102, v106
    v_mul_f32 v103, v6, v103
    v_mul_f32 v107, v6, v107
    v_cvt_pk_bf16_f32 v123, v103, v107
    buffer_store_dwordx4 v[120:123], v0, s[8:11], s17 offen offset:2048 sc1
    buffer_load_dwordx4 a[44:47], v0, s[28:31], s46 offen offset:3072
    v_max3_f32 v5, v36, v37, v38
    v_max_f32 v5, v5, v39
    v_max3_f32 v5, v5, v40, v41
    v_max3_f32 v5, v5, v42, v43
    v_mul_f32 v48, s52, v48
    v_mul_f32 v49, s52, v49
    v_max3_f32 v5, v5, v48, v49
    v_mov_b32 v6, v5
    s_add_u32 s46, s51, 16781312
    buffer_load_dwordx4 a[48:51], v0, s[28:31], s46 offen offset:0
    v_permlane32_swap_b32 v5, v6
    v_max_f32 v5, v5, v6
    v_mov_b32 v6, v5
    buffer_load_dwordx4 a[52:55], v0, s[28:31], s46 offen offset:1024
    s_nop 0
    v_permlane16_swap_b32 v5, v6
    v_max_f32 v5, v5, v6
    v_sub_f32 v36, v36, v5
    v_sub_f32 v37, v37, v5
    v_sub_f32 v38, v38, v5
    v_sub_f32 v39, v39, v5
    v_sub_f32 v40, v40, v5
    v_sub_f32 v41, v41, v5
    v_sub_f32 v42, v42, v5
    v_sub_f32 v43, v43, v5
    v_sub_f32 v48, v48, v5
    v_sub_f32 v49, v49, v5
    v_exp_f32 v36, v36
    v_exp_f32 v37, v37
    v_exp_f32 v38, v38
    v_exp_f32 v39, v39
    v_exp_f32 v40, v40
    v_exp_f32 v41, v41
    v_exp_f32 v42, v42
    v_exp_f32 v43, v43
    v_exp_f32 v48, v48
    v_exp_f32 v49, v49
    v_cvt_pk_bf16_f32 v24, v36, v37
    v_cvt_pk_bf16_f32 v25, v38, v39
    v_cvt_pk_bf16_f32 v26, v40, v41
    v_cvt_pk_bf16_f32 v27, v42, v43
    v_cvt_pk_bf16_f32 v20, v48, v49
    v_cvt_pk_bf16_f32 v23, v48, v49
    v_mfma_f32_16x16x32_bf16 v[28:31], v[16:19], v[24:27], 0
    v_mfma_f32_16x16x32_bf16 v[76:79], v[204:207], v[24:27], 0
    v_mfma_f32_16x16x32_bf16 v[80:83], v[208:211], v[24:27], 0
    buffer_load_dwordx4 a[56:59], v0, s[28:31], s46 offen offset:2048
    v_mfma_f32_16x16x32_bf16 v[84:87], v[212:215], v[24:27], 0
    v_mfma_f32_16x16x32_bf16 v[88:91], v[216:219], v[24:27], 0
    buffer_load_dwordx4 a[60:63], v0, s[28:31], s46 offen offset:3072
    v_mfma_f32_16x16x32_bf16 v[92:95], v[220:223], v[24:27], 0
    v_mfma_f32_16x16x32_bf16 v[96:99], v[224:227], v[24:27], 0
    s_add_u32 s46, s51, 33554432
    buffer_load_dwordx4 a[64:67], v0, s[28:31], s46 offen offset:0
    v_mfma_f32_16x16x16_bf16 v[28:31], v[16:17], v[20:21], v[28:31]
    v_mfma_f32_16x16x32_bf16 v[100:103], v[228:231], v[24:27], 0
    v_mfma_f32_16x16x32_bf16 v[104:107], v[232:235], v[24:27], 0
    buffer_load_dwordx4 a[68:71], v0, s[28:31], s46 offen offset:1024
    v_mfma_f32_16x16x16_bf16 v[76:79], v[68:69], v[20:21], v[76:79]
    v_mfma_f32_16x16x16_bf16 v[80:83], v[68:69], v[22:23], v[80:83]
    s_nop 2
    v_rcp_f32 v6, v28
    v_mfma_f32_16x16x16_bf16 v[84:87], v[70:71], v[20:21], v[84:87]
    v_mfma_f32_16x16x16_bf16 v[88:91], v[70:71], v[22:23], v[88:91]
    s_nop 0
    v_mul_f32 v76, v6, v76
    v_mul_f32 v80, v6, v80
    v_cvt_pk_bf16_f32 v124, v76, v80
    v_mul_f32 v77, v6, v77
    v_mul_f32 v81, v6, v81
    v_cvt_pk_bf16_f32 v125, v77, v81
    v_mul_f32 v78, v6, v78
    v_mul_f32 v82, v6, v82
    v_cvt_pk_bf16_f32 v126, v78, v82
    v_mul_f32 v79, v6, v79
    v_mul_f32 v83, v6, v83
    v_cvt_pk_bf16_f32 v127, v79, v83
    s_add_u32 s17, s48, 0
    buffer_store_dwordx4 v[124:127], v0, s[8:11], s17 offen offset:1024 sc1
    buffer_load_dwordx4 a[72:75], v0, s[28:31], s46 offen offset:2048
    v_mfma_f32_16x16x16_bf16 v[92:95], v[72:73], v[20:21], v[92:95]
    v_mfma_f32_16x16x16_bf16 v[96:99], v[72:73], v[22:23], v[96:99]
    v_mul_f32 v84, v6, v84
    v_mul_f32 v88, v6, v88
    v_cvt_pk_bf16_f32 v128, v84, v88
    v_mul_f32 v85, v6, v85
    v_mul_f32 v89, v6, v89
    v_cvt_pk_bf16_f32 v129, v85, v89
    v_mul_f32 v86, v6, v86
    v_mul_f32 v90, v6, v90
    v_cvt_pk_bf16_f32 v130, v86, v90
    v_mul_f32 v87, v6, v87
    v_mul_f32 v91, v6, v91
    v_cvt_pk_bf16_f32 v131, v87, v91
    buffer_store_dwordx4 v[128:131], v0, s[8:11], s17 offen offset:3072 sc1
    buffer_load_dwordx4 a[76:79], v0, s[28:31], s46 offen offset:3072
    v_mfma_f32_16x16x16_bf16 v[100:103], v[74:75], v[20:21], v[100:103]
    v_mfma_f32_16x16x16_bf16 v[104:107], v[74:75], v[22:23], v[104:107]
    v_mul_f32 v92, v6, v92
    v_mul_f32 v96, v6, v96
    v_cvt_pk_bf16_f32 v132, v92, v96
    v_mul_f32 v93, v6, v93
    v_mul_f32 v97, v6, v97
    v_cvt_pk_bf16_f32 v133, v93, v97
    v_mul_f32 v94, v6, v94
    v_mul_f32 v98, v6, v98
    v_cvt_pk_bf16_f32 v134, v94, v98
    v_mul_f32 v95, v6, v95
    v_mul_f32 v99, v6, v99
    v_cvt_pk_bf16_f32 v135, v95, v99
    s_add_u32 s17, s48, 4096
    buffer_store_dwordx4 v[132:135], v0, s[8:11], s17 offen offset:1024 sc1
    s_add_u32 s46, s51, 33558528
    buffer_load_dwordx4 a[80:83], v0, s[28:31], s46 offen offset:0
    v_mul_f32 v100, v6, v100
    v_mul_f32 v104, v6, v104
    v_cvt_pk_bf16_f32 v136, v100, v104
    v_mul_f32 v101, v6, v101
    v_mul_f32 v105, v6, v105
    v_cvt_pk_bf16_f32 v137, v101, v105
    v_mul_f32 v102, v6, v102
    v_mul_f32 v106, v6, v106
    v_cvt_pk_bf16_f32 v138, v102, v106
    v_mul_f32 v103, v6, v103
    v_mul_f32 v107, v6, v107
    v_cvt_pk_bf16_f32 v139, v103, v107
    buffer_store_dwordx4 v[136:139], v0, s[8:11], s17 offen offset:3072 sc1
    buffer_load_dwordx4 a[84:87], v0, s[28:31], s46 offen offset:1024
    buffer_load_dwordx4 a[88:91], v0, s[28:31], s46 offen offset:2048
    buffer_load_dwordx4 a[92:95], v0, s[28:31], s46 offen offset:3072
    s_add_u32 s48, s48, 262144
    s_mov_b32 s49, 22528
    s_mov_b32 s66, 0
    s_cmp_ge_u32 s37, 64
    s_cbranch_scc1 LtaS_end
LtaS1:
    s_sub_u32 s17, s37, 33
    s_mul_i32 s18, s17, 43
    s_lshr_b32 s18, s18, 7
    s_mul_i32 s18, s18, 3
    s_cmp_eq_u32 s18, s17
    s_cselect_b32 s18, 1, 0
    s_cmp_lt_u32 s37, 34
    s_cselect_b32 s18, 1, s18
    s_cmp_eq_u32 s36, 0
    s_cselect_b32 s18, 1, s18
    s_and_b32 s18, s18, s61
    s_cbranch_scc1 LtaF1_in
LtaS1_in:
    s_and_b32 s17, s37, 7
    s_mul_i32 s17, s17, 131072
    s_add_u32 s47, s35, s17
    s_bfe_u32 s34, s37, 65539
    s_cmp_eq_u32 s39, 1
    s_cbranch_scc1 LtaS1_have
    s_waitcnt vmcnt(0)
    s_and_b32 s17, s49, s66
    s_cselect_b64 exec, 1, 0
    buffer_store_dword v3, v4, s[8:11], s43 offen
    s_andn2_b32 s17, s49, s66
    s_cselect_b64 exec, 1, 0
    buffer_store_dword v3, v4, s[8:11], s43 offen sc1
    s_mov_b64 exec, -1
    s_add_u32 s43, s43, s49
    s_mov_b32 s49, 0
    s_mov_b32 s16, 0
LtaS1_f_8:
    buffer_load_dword v2, v1, s[8:11], s42 offen sc1
    s_add_u32 s16, s16, 1
    s_cmp_gt_u32 s16, 100000
    s_cbranch_scc1 L_role_ta_abort
    s_waitcnt vmcnt(0)
    v_cmp_eq_u32 vcc, 0, v2
    s_nop 0
    s_cbranch_vccz LtaS1_fd_9
    s_sleep 4
    s_branch LtaS1_f_8
LtaS1_fd_9:
    s_add_u32 s46, s51, 0
    buffer_load_dwordx4 a[0:3], v0, s[8:11], s46 offen offset:0
    buffer_load_dwordx4 a[4:7], v0, s[8:11], s46 offen offset:1024
    buffer_load_dwordx4 a[8:11], v0, s[8:11], s46 offen offset:2048
    buffer_load_dwordx4 a[12:15], v0, s[8:11], s46 offen offset:3072
    s_add_u32 s46, s51, 4096
    buffer_load_dwordx4 a[16:19], v0, s[8:11], s46 offen offset:0
    buffer_load_dwordx4 a[20:23], v0, s[8:11], s46 offen offset:1024
    buffer_load_dwordx4 a[24:27], v0, s[8:11], s46 offen offset:2048
    buffer_load_dwordx4 a[28:31], v0, s[8:11], s46 offen offset:3072
    s_add_u32 s46, s51, 16777216
    buffer_load_dwordx4 a[32:35], v0, s[8:11], s46 offen offset:0
    buffer_load_dwordx4 a[36:39], v0, s[8:11], s46 offen offset:1024
    buffer_load_dwordx4 a[40:43], v0, s[8:11], s46 offen offset:2048
    buffer_load_dwordx4 a[44:47], v0, s[8:11], s46 offen offset:3072
    s_add_u32 s46, s51, 16781312
    buffer_load_dwordx4 a[48:51], v0, s[8:11], s46 offen offset:0
    buffer_load_dwordx4 a[52:55], v0, s[8:11], s46 offen offset:1024
    buffer_load_dwordx4 a[56:59], v0, s[8:11], s46 offen offset:2048
    buffer_load_dwordx4 a[60:63], v0, s[8:11], s46 offen offset:3072
    s_add_u32 s46, s51, 33554432
    buffer_load_dwordx4 a[64:67], v0, s[8:11], s46 offen offset:0
    buffer_load_dwordx4 a[68:71], v0, s[8:11], s46 offen offset:1024
    buffer_load_dwordx4 a[72:75], v0, s[8:11], s46 offen offset:2048
    buffer_load_dwordx4 a[76:79], v0, s[8:11], s46 offen offset:3072
    s_add_u32 s46, s51, 33558528
    buffer_load_dwordx4 a[80:83], v0, s[8:11], s46 offen offset:0
    buffer_load_dwordx4 a[84:87], v0, s[8:11], s46 offen offset:1024
    buffer_load_dwordx4 a[88:91], v0, s[8:11], s46 offen offset:2048
    buffer_load_dwordx4 a[92:95], v0, s[8:11], s46 offen offset:3072
LtaS1_have:
    s_add_u32 s17, s42, 22528
    buffer_load_dword v15, v1, s[8:11], s17 offen sc1
    buffer_load_dwordx4 v[52:55], v9, s[8:11], s47 offen offset:0 sc1
    buffer_load_dwordx4 v[56:59], v9, s[8:11], s47 offen offset:64 sc1
    buffer_load_dwordx4 v[60:63], v9, s[8:11], s47 offen offset:128 sc1
    buffer_load_dwordx4 v[64:67], v9, s[8:11], s47 offen offset:192 sc1
    buffer_load_dwordx2 v[68:69], v10, s[8:11], s47 offen offset:2048 sc1
    buffer_load_dwordx2 v[70:71], v10, s[8:11], s47 offen offset:2560 sc1
    buffer_load_dwordx2 v[72:73], v10, s[8:11], s47 offen offset:3072 sc1
    buffer_load_dwordx2 v[74:75], v10, s[8:11], s47 offen offset:3584 sc1
    s_waitcnt vmcnt(9)
    s_and_b32 s17, s49, s66
    s_cselect_b64 exec, 1, 0
    buffer_store_dword v3, v4, s[8:11], s43 offen
    s_andn2_b32 s17, s49, s66
    s_cselect_b64 exec, 1, 0
    buffer_store_dword v3, v4, s[8:11], s43 offen sc1
    s_mov_b64 exec, -1
    s_add_u32 s43, s43, s49
    s_mov_b32 s49, 0
    v_mfma_f32_16x16x32_bf16 v[32:35], a[32:35], a[0:3], 0
    v_mfma_f32_16x16x32_bf16 v[36:39], a[32:35], a[4:7], 0
    v_mfma_f32_16x16x32_bf16 v[40:43], a[36:39], a[4:7], 0
    v_mfma_f32_16x16x32_bf16 v[32:35], a[40:43], a[8:11], v[32:35]
    v_mfma_f32_16x16x32_bf16 v[36:39], a[40:43], a[12:15], v[36:39]
    v_mfma_f32_16x16x32_bf16 v[40:43], a[44:47], a[12:15], v[40:43]
    v_mfma_f32_16x16x32_bf16 v[32:35], a[48:51], a[16:19], v[32:35]
    v_mfma_f32_16x16x32_bf16 v[36:39], a[48:51], a[20:23], v[36:39]
    v_mfma_f32_16x16x32_bf16 v[40:43], a[52:55], a[20:23], v[40:43]
    v_mfma_f32_16x16x32_bf16 v[32:35], a[56:59], a[24:27], v[32:35]
    v_mfma_f32_16x16x32_bf16 v[36:39], a[56:59], a[28:31], v[36:39]
    v_mfma_f32_16x16x32_bf16 v[40:43], a[60:63], a[28:31], v[40:43]
    s_waitcnt vmcnt(2)
    v_cmp_eq_u32 vcc, 0, v15
    s_add_u32 s51, s51, 262144
    s_add_u32 s42, s42, 22528
    s_add_u32 s37, s37, 1
    s_cmp_eq_u64 vcc, 0
    s_cselect_b32 s39, 1, 0
    s_cmp_lt_u32 s37, 64
    s_cselect_b32 s39, s39, 0
    s_cmp_eq_u32 s39, 1
    s_cselect_b32 s30, 268435456, 0
    v_fma_f32 v32, v32, s52, v236
    v_fma_f32 v33, v33, s52, v237
    v_fma_f32 v34, v34, s52, v238
    v_fma_f32 v35, v35, s52, v239
    v_mul_f32 v36, s52, v36
    v_mul_f32 v37, s52, v37
    v_mul_f32 v38, s52, v38
    v_mul_f32 v39, s52, v39
    v_fma_f32 v40, v40, s52, v236
    v_fma_f32 v41, v41, s52, v237
    v_fma_f32 v42, v42, s52, v238
    v_fma_f32 v43, v43, s52, v239
    v_xor_b32 v5, s34, v52
    v_xor_b32 v6, s34, v56
    v_or_b32 v5, v5, v6
    v_xor_b32 v6, s34, v60
    v_or_b32 v5, v5, v6
    v_xor_b32 v6, s34, v64
    v_or_b32 v5, v5, v6
    v_xor_b32 v6, s34, v68
    v_or_b32 v5, v5, v6
    v_xor_b32 v6, s34, v70
    v_or_b32 v5, v5, v6
    v_xor_b32 v6, s34, v72
    v_or_b32 v5, v5, v6
    v_xor_b32 v6, s34, v74
    v_or_b32 v5, v5, v6
    v_and_b32 v5, 1, v5
    v_cmp_ne_u32 vcc, 0, v5
    s_nop 0
    s_cbranch_vccz LtaS1_r
    s_mov_b32 s16, 0
LtaS1_rp:
    buffer_load_dwordx4 v[52:55], v9, s[8:11], s47 offen offset:0 sc1
    buffer_load_dwordx4 v[56:59], v9, s[8:11], s47 offen offset:64 sc1
    buffer_load_dwordx4 v[60:63], v9, s[8:11], s47 offen offset:128 sc1
    buffer_load_dwordx4 v[64:67], v9, s[8:11], s47 offen offset:192 sc1
    buffer_load_dwordx2 v[68:69], v10, s[8:11], s47 offen offset:2048 sc1
    buffer_load_dwordx2 v[70:71], v10, s[8:11], s47 offen offset:2560 sc1
    buffer_load_dwordx2 v[72:73], v10, s[8:11], s47 offen offset:3072 sc1
    buffer_load_dwordx2 v[74:75], v10, s[8:11], s47 offen offset:3584 sc1
    s_add_u32 s16, s16, 1
    s_cmp_gt_u32 s16, 100000
    s_cbranch_scc1 L_role_ta_abort
    s_waitcnt vmcnt(0)
    v_xor_b32 v5, s34, v52
    v_xor_b32 v6, s34, v56
    v_or_b32 v5, v5, v6
    v_xor_b32 v6, s34, v60
    v_or_b32 v5, v5, v6
    v_xor_b32 v6, s34, v64
    v_or_b32 v5, v5, v6
    v_xor_b32 v6, s34, v68
    v_or_b32 v5, v5, v6
    v_xor_b32 v6, s34, v70
    v_or_b32 v5, v5, v6
    v_xor_b32 v6, s34, v72
    v_or_b32 v5, v5, v6
    v_xor_b32 v6, s34, v74
    v_or_b32 v5, v5, v6
    v_and_b32 v5, 1, v5
    v_cmp_ne_u32 vcc, 0, v5
    s_nop 0
    s_cbranch_vccz LtaS1_r
    s_sleep 2
    s_branch LtaS1_rp
LtaS1_r:
    s_and_b32 s17, s37, 3
    s_cmp_eq_u32 s17, 0
    s_cselect_b32 s17, s36, 0
    s_cmp_lg_u32 s17, 0
    s_cselect_b64 exec, 1, 0
    s_sub_u32 s17, s42, 22528
    buffer_store_dword v3, v4, s[8:11], s17 offen offset:384 sc1
    s_mov_b64 exec, -1
    s_add_u32 s46, s51, 0
    buffer_load_dwordx4 v[140:143], v0, s[28:31], s46 offen offset:0
    buffer_load_dwordx4 v[144:147], v0, s[28:31], s46 offen offset:1024
    v_mfma_f32_16x16x32_bf16 v[44:47], v[52:55], a[0:3], 0
    v_mfma_f32_16x16x32_bf16 v[48:51], v[52:55], a[4:7], 0
    v_mfma_f32_16x16x32_bf16 v[44:47], v[56:59], a[8:11], v[44:47]
    v_mfma_f32_16x16x32_bf16 v[48:51], v[56:59], a[12:15], v[48:51]
    v_mfma_f32_16x16x32_bf16 v[44:47], v[60:63], a[16:19], v[44:47]
    v_mfma_f32_16x16x32_bf16 v[48:51], v[60:63], a[20:23], v[48:51]
    v_mfma_f32_16x16x32_bf16 v[44:47], v[64:67], a[24:27], v[44:47]
    v_mfma_f32_16x16x32_bf16 v[48:51], v[64:67], a[28:31], v[48:51]
    v_max3_f32 v5, v32, v33, v34
    v_max_f32 v5, v5, v35
    s_nop 4
    v_mul_f32 v44, s52, v44
    v_mul_f32 v45, s52, v45
    v_max3_f32 v5, v5, v44, v45
    v_mov_b32 v6, v5
    buffer_load_dwordx4 v[148:151], v0, s[28:31], s46 offen offset:2048
    s_nop 0
    v_permlane32_swap_b32 v5, v6
    v_max_f32 v5, v5, v6
    v_mov_b32 v6, v5
    buffer_load_dwordx4 v[152:155], v0, s[28:31], s46 offen offset:3072
    s_nop 0
    v_permlane16_swap_b32 v5, v6
    v_max_f32 v5, v5, v6
    v_sub_f32 v32, v32, v5
    v_sub_f32 v33, v33, v5
    v_sub_f32 v34, v34, v5
    v_sub_f32 v35, v35, v5
    v_sub_f32 v44, v44, v5
    v_sub_f32 v45, v45, v5
    v_exp_f32 v32, v32
    v_exp_f32 v33, v33
    v_exp_f32 v34, v34
    v_exp_f32 v35, v35
    v_exp_f32 v44, v44
    v_exp_f32 v45, v45
    v_cvt_pk_bf16_f32 v24, v32, v33
    v_cvt_pk_bf16_f32 v25, v34, v35
    v_mov_b32 v26, 0
    v_mov_b32 v27, 0
    v_cvt_pk_bf16_f32 v20, v44, v45
    v_cvt_pk_bf16_f32 v23, v44, v45
    v_mfma_f32_16x16x32_bf16 v[28:31], v[16:19], v[24:27], 0
    v_mfma_f32_16x16x32_bf16 v[76:79], a[64:67], v[24:27], 0
    v_mfma_f32_16x16x32_bf16 v[80:83], a[68:71], v[24:27], 0
    s_add_u32 s46, s51, 4096
    buffer_load_dwordx4 v[156:159], v0, s[28:31], s46 offen offset:0
    v_mfma_f32_16x16x32_bf16 v[84:87], a[72:75], v[24:27], 0
    v_mfma_f32_16x16x32_bf16 v[88:91], a[76:79], v[24:27], 0
    buffer_load_dwordx4 v[160:163], v0, s[28:31], s46 offen offset:1024
    v_mfma_f32_16x16x32_bf16 v[92:95], a[80:83], v[24:27], 0
    v_mfma_f32_16x16x32_bf16 v[96:99], a[84:87], v[24:27], 0
    buffer_load_dwordx4 v[164:167], v0, s[28:31], s46 offen offset:2048
    v_mfma_f32_16x16x16_bf16 v[28:31], v[16:17], v[20:21], v[28:31]
    v_mfma_f32_16x16x32_bf16 v[100:103], a[88:91], v[24:27], 0
    v_mfma_f32_16x16x32_bf16 v[104:107], a[92:95], v[24:27], 0
    buffer_load_dwordx4 v[168:171], v0, s[28:31], s46 offen offset:3072
    v_mfma_f32_16x16x16_bf16 v[76:79], v[68:69], v[20:21], v[76:79]
    v_mfma_f32_16x16x16_bf16 v[80:83], v[68:69], v[22:23], v[80:83]
    s_nop 2
    v_rcp_f32 v6, v28
    v_mfma_f32_16x16x16_bf16 v[84:87], v[70:71], v[20:21], v[84:87]
    v_mfma_f32_16x16x16_bf16 v[88:91], v[70:71], v[22:23], v[88:91]
    s_nop 0
    v_mul_f32 v76, v6, v76
    v_mul_f32 v80, v6, v80
    v_cvt_pk_bf16_f32 v108, v76, v80
    v_mul_f32 v77, v6, v77
    v_mul_f32 v81, v6, v81
    v_cvt_pk_bf16_f32 v109, v77, v81
    v_mul_f32 v78, v6, v78
    v_mul_f32 v82, v6, v82
    v_cvt_pk_bf16_f32 v110, v78, v82
    v_mul_f32 v79, v6, v79
    v_mul_f32 v83, v6, v83
    v_cvt_pk_bf16_f32 v111, v79, v83
    s_add_u32 s17, s48, 0
    buffer_store_dwordx4 v[108:111], v0, s[8:11], s17 offen offset:0 sc1
    s_add_u32 s46, s51, 16777216
    buffer_load_dwordx4 v[172:175], v0, s[28:31], s46 offen offset:0
    v_mfma_f32_16x16x16_bf16 v[92:95], v[72:73], v[20:21], v[92:95]
    v_mfma_f32_16x16x16_bf16 v[96:99], v[72:73], v[22:23], v[96:99]
    v_mul_f32 v84, v6, v84
    v_mul_f32 v88, v6, v88
    v_cvt_pk_bf16_f32 v112, v84, v88
    v_mul_f32 v85, v6, v85
    v_mul_f32 v89, v6, v89
    v_cvt_pk_bf16_f32 v113, v85, v89
    v_mul_f32 v86, v6, v86
    v_mul_f32 v90, v6, v90
    v_cvt_pk_bf16_f32 v114, v86, v90
    v_mul_f32 v87, v6, v87
    v_mul_f32 v91, v6, v91
    v_cvt_pk_bf16_f32 v115, v87, v91
    buffer_store_dwordx4 v[112:115], v0, s[8:11], s17 offen offset:2048 sc1
    buffer_load_dwordx4 v[176:179], v0, s[28:31], s46 offen offset:1024
    v_mfma_f32_16x16x16_bf16 v[100:103], v[74:75], v[20:21], v[100:103]
    v_mfma_f32_16x16x16_bf16 v[104:107], v[74:75], v[22:23], v[104:107]
    v_mul_f32 v92, v6, v92
    v_mul_f32 v96, v6, v96
    v_cvt_pk_bf16_f32 v116, v92, v96
    v_mul_f32 v93, v6, v93
    v_mul_f32 v97, v6, v97
    v_cvt_pk_bf16_f32 v117, v93, v97
    v_mul_f32 v94, v6, v94
    v_mul_f32 v98, v6, v98
    v_cvt_pk_bf16_f32 v118, v94, v98
    v_mul_f32 v95, v6, v95
    v_mul_f32 v99, v6, v99
    v_cvt_pk_bf16_f32 v119, v95, v99
    s_add_u32 s17, s48, 4096
    buffer_store_dwordx4 v[116:119], v0, s[8:11], s17 offen offset:0 sc1
    buffer_load_dwordx4 v[180:183], v0, s[28:31], s46 offen offset:2048
    v_mul_f32 v100, v6, v100
    v_mul_f32 v104, v6, v104
    v_cvt_pk_bf16_f32 v120, v100, v104
    v_mul_f32 v101, v6, v101
    v_mul_f32 v105, v6, v105
    v_cvt_pk_bf16_f32 v121, v101, v105
    v_mul_f32 v102, v6, v102
    v_mul_f32 v106, v6, v106
    v_cvt_pk_bf16_f32 v122, v102, v106
    v_mul_f32 v103, v6, v103
    v_mul_f32 v107, v6, v107
    v_cvt_pk_bf16_f32 v123, v103, v107
    buffer_store_dwordx4 v[120:123], v0, s[8:11], s17 offen offset:2048 sc1
    buffer_load_dwordx4 v[184:187], v0, s[28:31], s46 offen offset:3072
    v_max3_f32 v5, v36, v37, v38
    v_max_f32 v5, v5, v39
    v_max3_f32 v5, v5, v40, v41
    v_max3_f32 v5, v5, v42, v43
    v_mul_f32 v48, s52, v48
    v_mul_f32 v49, s52, v49
    v_max3_f32 v5, v5, v48, v49
    v_mov_b32 v6, v5
    s_add_u32 s46, s51, 16781312
    buffer_load_dwordx4 v[188:191], v0, s[28:31], s46 offen offset:0
    v_permlane32_swap_b32 v5, v6
    v_max_f32 v5, v5, v6
    v_mov_b32 v6, v5
    buffer_load_dwordx4 v[192:195], v0, s[28:31], s46 offen offset:1024
    s_nop 0
    v_permlane16_swap_b32 v5, v6
    v_max_f32 v5, v5, v6
    v_sub_f32 v36, v36, v5
    v_sub_f32 v37, v37, v5
    v_sub_f32 v38, v38, v5
    v_sub_f32 v39, v39, v5
    v_sub_f32 v40, v40, v5
    v_sub_f32 v41, v41, v5
    v_sub_f32 v42, v42, v5
    v_sub_f32 v43, v43, v5
    v_sub_f32 v48, v48, v5
    v_sub_f32 v49, v49, v5
    v_exp_f32 v36, v36
    v_exp_f32 v37, v37
    v_exp_f32 v38, v38
    v_exp_f32 v39, v39
    v_exp_f32 v40, v40
    v_exp_f32 v41, v41
    v_exp_f32 v42, v42
    v_exp_f32 v43, v43
    v_exp_f32 v48, v48
    v_exp_f32 v49, v49
    v_cvt_pk_bf16_f32 v24, v36, v37
    v_cvt_pk_bf16_f32 v25, v38, v39
    v_cvt_pk_bf16_f32 v26, v40, v41
    v_cvt_pk_bf16_f32 v27, v42, v43
    v_cvt_pk_bf16_f32 v20, v48, v49
    v_cvt_pk_bf16_f32 v23, v48, v49
    v_mfma_f32_16x16x32_bf16 v[28:31], v[16:19], v[24:27], 0
    v_mfma_f32_16x16x32_bf16 v[76:79], a[64:67], v[24:27], 0
    v_mfma_f32_16x16x32_bf16 v[80:83], a[68:71], v[24:27], 0
    buffer_load_dwordx4 v[196:199], v0, s[28:31], s46 offen offset:2048
    v_mfma_f32_16x16x32_bf16 v[84:87], a[72:75], v[24:27], 0
    v_mfma_f32_16x16x32_bf16 v[88:91], a[76:79], v[24:27], 0
    buffer_load_dwordx4 v[200:203], v0, s[28:31], s46 offen offset:3072
    v_mfma_f32_16x16x32_bf16 v[92:95], a[80:83], v[24:27], 0
    v_mfma_f32_16x16x32_bf16 v[96:99], a[84:87], v[24:27], 0
    s_add_u32 s46, s51, 33554432
    buffer_load_dwordx4 v[204:207], v0, s[28:31], s46 offen offset:0
    v_mfma_f32_16x16x16_bf16 v[28:31], v[16:17], v[20:21], v[28:31]
    v_mfma_f32_16x16x32_bf16 v[100:103], a[88:91], v[24:27], 0
    v_mfma_f32_16x16x32_bf16 v[104:107], a[92:95], v[24:27], 0
    buffer_load_dwordx4 v[208:211], v0, s[28:31], s46 offen offset:1024
    v_mfma_f32_16x16x16_bf16 v[76:79], v[68:69], v[20:21], v[76:79]
    v_mfma_f32_16x16x16_bf16 v[80:83], v[68:69], v[22:23], v[80:83]
    s_nop 2
    v_rcp_f32 v6, v28
    v_mfma_f32_16x16x16_bf16 v[84:87], v[70:71], v[20:21], v[84:87]
    v_mfma_f32_16x16x16_bf16 v[88:91], v[70:71], v[22:23], v[88:91]
    s_nop 0
    v_mul_f32 v76, v6, v76
    v_mul_f32 v80, v6, v80
    v_cvt_pk_bf16_f32 v124, v76, v80
    v_mul_f32 v77, v6, v77
    v_mul_f32 v81, v6, v81
    v_cvt_pk_bf16_f32 v125, v77, v81
    v_mul_f32 v78, v6, v78
    v_mul_f32 v82, v6, v82
    v_cvt_pk_bf16_f32 v126, v78, v82
    v_mul_f32 v79, v6, v79
    v_mul_f32 v83, v6, v83
    v_cvt_pk_bf16_f32 v127, v79, v83
    s_add_u32 s17, s48, 0
    buffer_store_dwordx4 v[124:127], v0, s[8:11], s17 offen offset:1024 sc1
    buffer_load_dwordx4 v[212:215], v0, s[28:31], s46 offen offset:2048
    v_mfma_f32_16x16x16_bf16 v[92:95], v[72:73], v[20:21], v[92:95]
    v_mfma_f32_16x16x16_bf16 v[96:99], v[72:73], v[22:23], v[96:99]
    v_mul_f32 v84, v6, v84
    v_mul_f32 v88, v6, v88
    v_cvt_pk_bf16_f32 v128, v84, v88
    v_mul_f32 v85, v6, v85
    v_mul_f32 v89, v6, v89
    v_cvt_pk_bf16_f32 v129, v85, v89
    v_mul_f32 v86, v6, v86
    v_mul_f32 v90, v6, v90
    v_cvt_pk_bf16_f32 v130, v86, v90
    v_mul_f32 v87, v6, v87
    v_mul_f32 v91, v6, v91
    v_cvt_pk_bf16_f32 v131, v87, v91
    buffer_store_dwordx4 v[128:131], v0, s[8:11], s17 offen offset:3072 sc1
    buffer_load_dwordx4 v[216:219], v0, s[28:31], s46 offen offset:3072
    v_mfma_f32_16x16x16_bf16 v[100:103], v[74:75], v[20:21], v[100:103]
    v_mfma_f32_16x16x16_bf16 v[104:107], v[74:75], v[22:23], v[104:107]
    v_mul_f32 v92, v6, v92
    v_mul_f32 v96, v6, v96
    v_cvt_pk_bf16_f32 v132, v92, v96
    v_mul_f32 v93, v6, v93
    v_mul_f32 v97, v6, v97
    v_cvt_pk_bf16_f32 v133, v93, v97
    v_mul_f32 v94, v6, v94
    v_mul_f32 v98, v6, v98
    v_cvt_pk_bf16_f32 v134, v94, v98
    v_mul_f32 v95, v6, v95
    v_mul_f32 v99, v6, v99
    v_cvt_pk_bf16_f32 v135, v95, v99
    s_add_u32 s17, s48, 4096
    buffer_store_dwordx4 v[132:135], v0, s[8:11], s17 offen offset:1024 sc1
    s_add_u32 s46, s51, 33558528
    buffer_load_dwordx4 v[220:223], v0, s[28:31], s46 offen offset:0
    v_mul_f32 v100, v6, v100
    v_mul_f32 v104, v6, v104
    v_cvt_pk_bf16_f32 v136, v100, v104
    v_mul_f32 v101, v6, v101
    v_mul_f32 v105, v6, v105
    v_cvt_pk_bf16_f32 v137, v101, v105
    v_mul_f32 v102, v6, v102
    v_mul_f32 v106, v6, v106
    v_cvt_pk_bf16_f32 v138, v102, v106
    v_mul_f32 v103, v6, v103
    v_mul_f32 v107, v6, v107
    v_cvt_pk_bf16_f32 v139, v103, v107
    buffer_store_dwordx4 v[136:139], v0, s[8:11], s17 offen offset:3072 sc1
    buffer_load_dwordx4 v[224:227], v0, s[28:31], s46 offen offset:1024
    buffer_load_dwordx4 v[228:231], v0, s[28:31], s46 offen offset:2048
    buffer_load_dwordx4 v[232:235], v0, s[28:31], s46 offen offset:3072
    s_add_u32 s48, s48, 262144
    s_mov_b32 s49, 22528
    s_mov_b32 s66, 0
    s_cmp_ge_u32 s37, 64
    s_cbranch_scc1 LtaS_end
    s_branch LtaS0
LtaS_end:
    s_waitcnt vmcnt(0)
    s_and_b32 s17, s49, s66
    s_cselect_b64 exec, 1, 0
    buffer_store_dword v3, v4, s[8:11], s43 offen
    s_andn2_b32 s17, s49, s66
    s_cselect_b64 exec, 1, 0
    buffer_store_dword v3, v4, s[8:11], s43 offen sc1
    s_mov_b64 exec, -1
    s_add_u32 s43, s43, s49
    s_mov_b32 s49, 0
    s_branch L_role_ta_exit
L_role_ta_abort:
    s_waitcnt lgkmcnt(0)
    s_mov_b64 exec, -1
    v_mov_b32 v0, 60
    s_lshl_b32 s5, s3, 8
    s_or_b32 s5, s5, s4
    s_or_b32 s5, s5, 0x10000
    v_mov_b32 v1, s5
    global_store_dword v0, v1, s[12:13]
    s_endpgm
L_role_ta_exit:
    s_and_b32 s6, s15, 7
    s_add_u32 s6, s6, s14
    s_cmp_lg_u32 s6, 0
    s_cbranch_scc1 L_role_ta_nowb
    s_waitcnt vmcnt(0)
    buffer_wbl2 sc1
    s_waitcnt vmcnt(0)
L_role_ta_nowb:
    s_endpgm
.p2align 6
L_role_r:
    s_mov_b32 s32, s3
    s_mov_b32 s15, s4
    v_and_b32 v10, 63, v0
    v_and_b32 v60, 15, v10
    v_lshrrev_b32 v61, 4, v10
    v_lshlrev_b32 v0, 4, v10
    v_lshlrev_b32 v8, 2, v10
    s_mul_i32 s17, s14, 26624
    s_add_u32 s17, s17, 57344
    v_add_u32 v9, s17, v0
    s_mov_b32 s54, 0xfffffffe
    s_mov_b32 s46, 0x3e0293ee
    s_mov_b32 s47, 0x3e0293ee
    s_mov_b32 s50, 0x00ff00ff
    s_mov_b32 s51, 0x00ff00ff
    s_mov_b32 s52, -1
    s_mov_b32 s53, 0
    s_mov_b32 s68, 0x3f803f80
    s_mov_b32 s69, 0x3f803f80
    s_mov_b32 s39, 0
    v_lshrrev_b32 v63, 2, v60
    v_and_b32 v64, 1, v60
    v_lshl_add_u32 v62, v63, 1, v64
    v_bfe_u32 v65, v60, 1, 1
    v_mov_b32 v1, 0x4444
    v_mov_b32 v63, 0xeeee
    v_cmp_eq_u32 vcc, 0, v65
    s_nop 1
    v_cndmask_b32 v1, v63, v1, vcc
    v_mul_u32_u24 v63, 576, v61
    v_lshl_add_u32 v2, v60, 2, v63
    s_lshl_b32 s17, s14, 6
    v_add_u32 v2, s17, v2
    v_mul_u32_u24 v63, 288, v62
    v_lshl_add_u32 v3, v61, 4, v63
    v_lshl_add_u32 v4, v61, 5, v63
    v_lshl_add_u32 v4, v65, 4, v4
    s_cmp_eq_u32 s32, 0
    s_cbranch_scc1 Lr_noord
    s_cmp_lg_u32 s14, 0
    s_cbranch_scc1 Lr_ord_d
    v_mov_b32 v63, 48
    s_mov_b32 s16, 0
Lr_ord:
    global_load_dword v64, v63, s[12:13] sc1
    s_add_u32 s16, s16, 1
    s_cmp_gt_u32 s16, 100000
    s_cbranch_scc1 Lr_abort
    s_waitcnt vmcnt(0)
    v_cmp_gt_u32 vcc, 16, v64
    s_nop 0
    s_cbranch_vccz Lr_ord_d
    s_sleep 32
    s_branch Lr_ord
Lr_ord_d:
    s_barrier
Lr_noord:
    s_load_dwordx2 s[20:21], s[0:1], 40
    s_mov_b32 s22, 4718592
    s_mov_b32 s23, 0x00020000
    s_waitcnt lgkmcnt(0)
    s_and_b32 s21, s21, 0xffff
    s_load_dwordx2 s[24:25], s[0:1], 48
    s_mov_b32 s26, 4718592
    s_mov_b32 s27, 0x00020000
    s_waitcnt lgkmcnt(0)
    s_and_b32 s25, s25, 0xffff
    s_load_dwordx2 s[28:29], s[0:1], 56
    s_mov_b32 s30, 4718592
    s_mov_b32 s31, 0x00020000
    s_waitcnt lgkmcnt(0)
    s_and_b32 s29, s29, 0xffff
    s_load_dwordx2 s[80:81], s[0:1], 64
    s_mov_b32 s82, 4718592
    s_mov_b32 s83, 0x00020000
    s_waitcnt lgkmcnt(0)
    s_and_b32 s81, s81, 0xffff
    v_lshlrev_b32 v71, 1, v61
    v_xor_b32 v71, v71, v60
    v_lshlrev_b32 v71, 4, v71
    v_lshl_add_u32 v62, v61, 13, v71
    v_xor_b32 v63, 128, v62
    v_lshrrev_b32 v64, 1, v61
    v_lshlrev_b32 v64, 3, v64
    v_and_b32 v65, 1, v61
    v_lshl_add_u32 v64, v65, 2, v64
    v_lshl_add_u32 v64, v64, 13, v71
    v_xor_b32 v65, 128, v64
    s_mul_i32 s57, s14, 1179648
    s_lshl_b32 s17, s15, 8
    s_add_u32 s57, s57, s17
    s_lshl_b32 s58, s14, 12
    v_lshrrev_b32 v71, 2, v60
    v_lshl_add_u32 v66, v61, 3, v71
    v_lshlrev_b32 v66, 8, v66
    v_bfe_u32 v67, v60, 1, 1
    s_lshl_b32 s17, s14, 2
    v_add_u32 v67, s17, v67
    v_lshlrev_b32 v71, 1, v71
    v_xor_b32 v67, v67, v71
    v_and_b32 v71, 1, v61
    v_lshlrev_b32 v71, 3, v71
    v_xor_b32 v67, v67, v71
    v_and_b32 v71, 1, v60
    v_lshl_add_u32 v66, v71, 3, v66
    v_xor_b32 v71, 2, v67
    v_lshl_add_u32 v67, v71, 4, v66
    v_xor_b32 v71, 2, v71
    v_lshl_add_u32 v66, v71, 4, v66
    v_lshrrev_b32 v71, 2, v60
    v_lshl_add_u32 v70, v61, 2, v71
    v_mul_u32_u24 v70, 1152, v70
    v_and_b32 v71, 3, v60
    v_lshl_add_u32 v70, v71, 3, v70
    s_mul_i32 s17, s14, 288
    v_add_u32 v70, s17, v70
    v_add_u32 v71, 0, v10
    v_mul_u32_u24 v59, 911, v71
    v_lshrrev_b32 v59, 16, v59
    v_mul_u32_u24 v60, 72, v59
    v_sub_u32 v71, v71, v60
    v_and_b32 v60, 1, v59
    v_lshlrev_b32 v60, 4, v60
    v_lshrrev_b32 v59, 1, v59
    v_lshl_add_u32 v60, v59, 2, v60
    v_mul_u32_u24 v60, 1152, v60
    v_lshl_add_u32 v50, v71, 4, v60
    v_add_u32 v71, 64, v10
    v_mul_u32_u24 v59, 911, v71
    v_lshrrev_b32 v59, 16, v59
    v_mul_u32_u24 v60, 72, v59
    v_sub_u32 v71, v71, v60
    v_and_b32 v60, 1, v59
    v_lshlrev_b32 v60, 4, v60
    v_lshrrev_b32 v59, 1, v59
    v_lshl_add_u32 v60, v59, 2, v60
    v_mul_u32_u24 v60, 1152, v60
    v_lshl_add_u32 v51, v71, 4, v60
    v_add_u32 v71, 128, v10
    v_mul_u32_u24 v59, 911, v71
    v_lshrrev_b32 v59, 16, v59
    v_mul_u32_u24 v60, 72, v59
    v_sub_u32 v71, v71, v60
    v_and_b32 v60, 1, v59
    v_lshlrev_b32 v60, 4, v60
    v_lshrrev_b32 v59, 1, v59
    v_lshl_add_u32 v60, v59, 2, v60
    v_mul_u32_u24 v60, 1152, v60
    v_lshl_add_u32 v52, v71, 4, v60
    v_add_u32 v71, 192, v10
    v_mul_u32_u24 v59, 911, v71
    v_lshrrev_b32 v59, 16, v59
    v_mul_u32_u24 v60, 72, v59
    v_sub_u32 v71, v71, v60
    v_and_b32 v60, 1, v59
    v_lshlrev_b32 v60, 4, v60
    v_lshrrev_b32 v59, 1, v59
    v_lshl_add_u32 v60, v59, 2, v60
    v_mul_u32_u24 v60, 1152, v60
    v_lshl_add_u32 v53, v71, 4, v60
    v_add_u32 v71, 256, v10
    v_mul_u32_u24 v59, 911, v71
    v_lshrrev_b32 v59, 16, v59
    v_mul_u32_u24 v60, 72, v59
    v_sub_u32 v71, v71, v60
    v_and_b32 v60, 1, v59
    v_lshlrev_b32 v60, 4, v60
    v_lshrrev_b32 v59, 1, v59
    v_lshl_add_u32 v60, v59, 2, v60
    v_mul_u32_u24 v60, 1152, v60
    v_lshl_add_u32 v54, v71, 4, v60
    s_lshr_b32 s17, s14, 1
    s_lshl_b32 s17, s17, 3
    s_and_b32 s18, s14, 1
    s_lshl_b32 s18, s18, 1
    s_add_u32 s17, s17, s18
    s_lshl_b32 s18, s15, 7
    s_add_u32 s17, s17, s18
    s_mul_i32 s59, s17, 1152
    s_mul_i32 s60, s14, 4608
    s_add_u32 m0, s58, 49152
    s_add_u32 s17, s57, 0
    buffer_load_dwordx4 v62, s[20:23], s17 offen lds
    s_add_u32 m0, s58, 50176
    s_add_u32 s17, s57, 32768
    buffer_load_dwordx4 v62, s[20:23], s17 offen lds
    s_add_u32 m0, s58, 51200
    s_add_u32 s17, s57, 65536
    buffer_load_dwordx4 v63, s[20:23], s17 offen lds
    s_add_u32 m0, s58, 52224
    s_add_u32 s17, s57, 98304
    buffer_load_dwordx4 v63, s[20:23], s17 offen lds
    s_add_u32 m0, s58, 65536
    s_add_u32 s17, s57, 0
    buffer_load_dwordx4 v62, s[24:27], s17 offen lds
    s_add_u32 m0, s58, 66560
    s_add_u32 s17, s57, 32768
    buffer_load_dwordx4 v62, s[24:27], s17 offen lds
    s_add_u32 m0, s58, 67584
    s_add_u32 s17, s57, 65536
    buffer_load_dwordx4 v63, s[24:27], s17 offen lds
    s_add_u32 m0, s58, 68608
    s_add_u32 s17, s57, 98304
    buffer_load_dwordx4 v63, s[24:27], s17 offen lds
    s_add_u32 m0, s58, 81920
    s_add_u32 s17, s57, 0
    buffer_load_dwordx4 v62, s[28:31], s17 offen lds
    s_add_u32 m0, s58, 82944
    s_add_u32 s17, s57, 32768
    buffer_load_dwordx4 v62, s[28:31], s17 offen lds
    s_add_u32 m0, s58, 83968
    s_add_u32 s17, s57, 65536
    buffer_load_dwordx4 v63, s[28:31], s17 offen lds
    s_add_u32 m0, s58, 84992
    s_add_u32 s17, s57, 98304
    buffer_load_dwordx4 v63, s[28:31], s17 offen lds
    s_add_u32 m0, s58, 98304
    s_add_u32 s17, s57, 131072
    buffer_load_dwordx4 v62, s[20:23], s17 offen lds
    s_add_u32 m0, s58, 99328
    s_add_u32 s17, s57, 163840
    buffer_load_dwordx4 v62, s[20:23], s17 offen lds
    s_add_u32 m0, s58, 100352
    s_add_u32 s17, s57, 196608
    buffer_load_dwordx4 v63, s[20:23], s17 offen lds
    s_add_u32 m0, s58, 101376
    s_add_u32 s17, s57, 229376
    buffer_load_dwordx4 v63, s[20:23], s17 offen lds
    s_add_u32 m0, s58, 114688
    s_add_u32 s17, s57, 131072
    buffer_load_dwordx4 v62, s[24:27], s17 offen lds
    s_add_u32 m0, s58, 115712
    s_add_u32 s17, s57, 163840
    buffer_load_dwordx4 v62, s[24:27], s17 offen lds
    s_add_u32 m0, s58, 116736
    s_add_u32 s17, s57, 196608
    buffer_load_dwordx4 v63, s[24:27], s17 offen lds
    s_add_u32 m0, s58, 117760
    s_add_u32 s17, s57, 229376
    buffer_load_dwordx4 v63, s[24:27], s17 offen lds
    s_add_u32 m0, s58, 131072
    s_add_u32 s17, s57, 131072
    buffer_load_dwordx4 v62, s[28:31], s17 offen lds
    s_add_u32 m0, s58, 132096
    s_add_u32 s17, s57, 163840
    buffer_load_dwordx4 v62, s[28:31], s17 offen lds
    s_add_u32 m0, s58, 133120
    s_add_u32 s17, s57, 196608
    buffer_load_dwordx4 v63, s[28:31], s17 offen lds
    s_add_u32 m0, s58, 134144
    s_add_u32 s17, s57, 229376
    buffer_load_dwordx4 v63, s[28:31], s17 offen lds
    s_add_u32 m0, s58, 147456
    s_add_u32 s17, s57, 262144
    buffer_load_dwordx4 v62, s[20:23], s17 offen lds
    s_add_u32 m0, s58, 148480
    s_add_u32 s17, s57, 294912
    buffer_load_dwordx4 v62, s[20:23], s17 offen lds
    s_add_u32 m0, s58, 149504
    s_add_u32 s17, s57, 327680
    buffer_load_dwordx4 v63, s[20:23], s17 offen lds
    s_add_u32 m0, s58, 150528
    s_add_u32 s17, s57, 360448
    buffer_load_dwordx4 v63, s[20:23], s17 offen lds
    s_add_u32 m0, s58, 0
    s_add_u32 s17, s57, 262144
    buffer_load_dwordx4 v62, s[24:27], s17 offen lds
    s_add_u32 m0, s58, 1024
    s_add_u32 s17, s57, 294912
    buffer_load_dwordx4 v62, s[24:27], s17 offen lds
    s_add_u32 m0, s58, 2048
    s_add_u32 s17, s57, 327680
    buffer_load_dwordx4 v63, s[24:27], s17 offen lds
    s_add_u32 m0, s58, 3072
    s_add_u32 s17, s57, 360448
    buffer_load_dwordx4 v63, s[24:27], s17 offen lds
    s_add_u32 m0, s58, 16384
    s_add_u32 s17, s57, 262144
    buffer_load_dwordx4 v62, s[28:31], s17 offen lds
    s_add_u32 m0, s58, 17408
    s_add_u32 s17, s57, 294912
    buffer_load_dwordx4 v62, s[28:31], s17 offen lds
    s_add_u32 m0, s58, 18432
    s_add_u32 s17, s57, 327680
    buffer_load_dwordx4 v63, s[28:31], s17 offen lds
    s_add_u32 m0, s58, 19456
    s_add_u32 s17, s57, 360448
    buffer_load_dwordx4 v63, s[28:31], s17 offen lds
    v_and_b32 v12, 15, v10
    v_lshrrev_b32 v13, 4, v10
    s_lshr_b32 s84, s15, 3
    s_bfe_u32 s85, s15, 0x20001
    s_and_b32 s86, s15, 1
    s_cmp_lt_u32 s14, 2
    s_cbranch_scc1 Lr_jab
    s_lshr_b32 s84, s15, 1
    s_and_b32 s84, s84, 3
Lr_jab:
    s_cmp_lt_u32 s15, 8
    s_cselect_b32 s62, 1, 0
    v_bfe_u32 v20, v12, 2, 1
    v_lshl_add_u32 v17, v20, 2, v13
    v_mul_u32_u24 v17, 12288, v17
    v_lshrrev_b32 v21, 3, v12
    v_lshlrev_b32 v21, 2, v21
    v_and_b32 v20, 3, v12
    v_add_u32 v21, v21, v20
    v_lshl_add_u32 v6, v21, 4, v17
    s_mul_i32 s17, s84, 2304
    s_lshl_b32 s18, s14, 10
    s_add_u32 s17, s17, s18
    s_lshl_b32 s18, s86, 7
    s_add_u32 s17, s17, s18
    s_lshl_b32 s18, s85, 8
    s_cmp_lt_u32 s14, 2
    s_cselect_b32 s18, s18, 0
    s_add_u32 s17, s17, s18
    v_add_u32 v6, s17, v6
    v_bfe_u32 v24, v12, 1, 2
    v_and_b32 v25, 1, v12
    v_lshrrev_b32 v26, 1, v13
    v_and_b32 v27, 1, v13
    s_cmp_lt_u32 s14, 2
    s_cbranch_scc0 Lr_jc
    s_lshl_b32 s17, s14, 2
    v_add_u32 v18, s17, v24
    v_lshlrev_b32 v7, 10, v18
    v_lshl_add_u32 v19, v27, 1, v25
    s_lshl_b32 s17, s84, 4
    s_lshl_b32 s18, s85, 2
    s_add_u32 s17, s17, s18
    v_add_u32 v19, s17, v19
    v_lshl_add_u32 v7, v19, 4, v7
    s_lshl_b32 s17, s86, 1
    v_add_u32 v19, s17, v26
    v_lshl_add_u32 v7, v19, 2, v7
    s_lshl_b32 s17, s85, 1
    v_add_u32 v19, s17, v25
    v_mul_u32_u24 v19, 576, v19
    v_lshl_add_u32 v19, v18, 4, v19
    v_lshl_add_u32 v19, v13, 1, v19
    s_mul_i32 s17, s84, 144
    s_lshl_b32 s18, s86, 3
    s_add_u32 s17, s17, s18
    v_add_u32 v19, s17, v19
    v_lshlrev_b32 v14, 1, v19
    v_add_u32 v15, 2, v14
    s_branch Lr_jd
Lr_jc:
    s_lshl_b32 s17, s86, 1
    v_add_u32 v18, s17, v26
    v_lshlrev_b32 v19, 2, v18
    v_lshl_add_u32 v19, v27, 1, v19
    v_add_u32 v19, v19, v25
    s_lshl_b32 s17, s84, 4
    v_add_u32 v19, s17, v19
    v_lshlrev_b32 v7, 4, v19
    v_lshl_add_u32 v7, v24, 2, v7
    v_add_u32 v7, 8192, v7
    v_lshl_add_u32 v19, v18, 1, v25
    v_mul_u32_u24 v19, 576, v19
    v_lshl_add_u32 v19, v27, 3, v19
    v_add_u32 v19, v19, v24
    s_mul_i32 s17, s84, 144
    s_add_u32 s17, s17, 128
    v_add_u32 v19, s17, v19
    v_lshlrev_b32 v14, 1, v19
    v_add_u32 v15, 8, v14
Lr_jd:
    s_mul_i32 s48, s32, 1048576
    s_add_u32 s48, s48, 4194304
    s_lshl_b32 s18, s14, 11
    s_lshl_b32 s19, s14, 8
    s_add_u32 s19, s19, 8192
    s_mul_i32 s17, s15, 12288
    s_add_u32 s17, s17, s48
    s_mul_i32 s38, s14, 2304
    s_add_u32 s38, s38, s17
    s_add_u32 s37, s48, 983040
    s_xor_b32 s36, s37, 16384
    s_add_u32 s34, s37, s18
    s_add_u32 s35, s37, s19
    s_mul_i32 s17, s32, 50331648
    s_lshl_b32 s19, s15, 13
    s_add_u32 s17, s17, s19
    s_add_u32 s40, s17, 61079552
    s_add_u32 s17, s17, s18
    s_add_u32 s41, s17, 60817408
    s_add_u32 s42, s17, 77594624
    s_mul_i32 s17, s32, 1048576
    s_lshl_b32 s19, s15, 12
    s_add_u32 s17, s17, s19
    s_lshl_b32 s19, s14, 9
    s_add_u32 s17, s17, s19
    s_add_u32 s45, s17, 27262976
    s_mov_b32 s86, s19
    s_mov_b32 s43, s45
    s_mov_b32 s66, 0
    s_mov_b32 s67, 1464320
    s_mov_b32 s78, 0xff
    s_mov_b32 s79, 0
    s_mul_i32 s17, s32, 1441792
    s_lshl_b32 s19, s15, 9
    s_add_u32 s17, s17, s19
    s_add_u32 s44, s17, 185600
    s_mov_b32 s33, 0
    s_load_dwordx2 s[88:89], s[0:1], 32
    s_mov_b32 s90, 9216
    s_mov_b32 s91, 0x00020000
    s_waitcnt lgkmcnt(0)
    s_and_b32 s89, s89, 0xffff
    s_cmp_eq_u32 s14, 3
    s_cbranch_scc1 Lr_mem0_done
    s_cmp_lt_u32 s14, 2
    s_cselect_b32 s17, 1, s62
    s_cmp_eq_u32 s17, 0
    s_cbranch_scc1 Lr_mem0_done
    s_mov_b64 exec, s[50:51]
    buffer_load_ushort v20, v14, s[88:91], 0 offen
    buffer_load_ushort v21, v15, s[88:91], 0 offen
    s_waitcnt vmcnt(0)
    v_lshl_or_b32 v20, v21, 16, v20
    v_min_u32 v20, s54, v20
    buffer_store_dword v20, v7, s[8:11], s37 offen sc1
    v_mov_b32 v20, -1
    buffer_store_dword v20, v7, s[8:11], s36 offen sc1
    s_mov_b64 exec, -1
Lr_mem0_done:
    v_mov_b32 v20, 1
    v_mov_b32 v21, 1
    v_mov_b32 v22, 1
    v_mov_b32 v23, 1
    s_xor_b32 s17, s38, 524288
    buffer_store_dwordx4 v[20:23], v0, s[8:11], s38 offen offset:0 sc1
    buffer_store_dwordx4 v[20:23], v0, s[8:11], s38 offen offset:1024 sc1
    buffer_store_dword v20, v8, s[8:11], s38 offen offset:2048 sc1
    buffer_store_dwordx4 v[20:23], v0, s[8:11], s17 offen offset:0 sc1
    buffer_store_dwordx4 v[20:23], v0, s[8:11], s17 offen offset:1024 sc1
    buffer_store_dword v20, v8, s[8:11], s17 offen offset:2048 sc1
    v_lshrrev_b32 v17, 1, v0
    s_mov_b32 s17, s45
    buffer_store_dwordx2 v[20:21], v17, s[8:11], s17 offen offset:2048 sc1
    s_mov_b64 exec, s[52:53]
    buffer_store_dwordx4 v[20:23], v0, s[8:11], s17 offen sc1
    s_mov_b64 exec, -1
    s_add_u32 s17, s17, 131072
    buffer_store_dwordx2 v[20:21], v17, s[8:11], s17 offen offset:2048 sc1
    s_mov_b64 exec, s[52:53]
    buffer_store_dwordx4 v[20:23], v0, s[8:11], s17 offen sc1
    s_mov_b64 exec, -1
    s_add_u32 s17, s17, 131072
    buffer_store_dwordx2 v[20:21], v17, s[8:11], s17 offen offset:2048 sc1
    s_mov_b64 exec, s[52:53]
    buffer_store_dwordx4 v[20:23], v0, s[8:11], s17 offen sc1
    s_mov_b64 exec, -1
    s_add_u32 s17, s17, 131072
    buffer_store_dwordx2 v[20:21], v17, s[8:11], s17 offen offset:2048 sc1
    s_mov_b64 exec, s[52:53]
    buffer_store_dwordx4 v[20:23], v0, s[8:11], s17 offen sc1
    s_mov_b64 exec, -1
    s_add_u32 s17, s17, 131072
    buffer_store_dwordx2 v[20:21], v17, s[8:11], s17 offen offset:2048 sc1
    s_mov_b64 exec, s[52:53]
    buffer_store_dwordx4 v[20:23], v0, s[8:11], s17 offen sc1
    s_mov_b64 exec, -1
    s_add_u32 s17, s17, 131072
    buffer_store_dwordx2 v[20:21], v17, s[8:11], s17 offen offset:2048 sc1
    s_mov_b64 exec, s[52:53]
    buffer_store_dwordx4 v[20:23], v0, s[8:11], s17 offen sc1
    s_mov_b64 exec, -1
    s_add_u32 s17, s17, 131072
    buffer_store_dwordx2 v[20:21], v17, s[8:11], s17 offen offset:2048 sc1
    s_mov_b64 exec, s[52:53]
    buffer_store_dwordx4 v[20:23], v0, s[8:11], s17 offen sc1
    s_mov_b64 exec, -1
    s_add_u32 s17, s17, 131072
    buffer_store_dwordx2 v[20:21], v17, s[8:11], s17 offen offset:2048 sc1
    s_mov_b64 exec, s[52:53]
    buffer_store_dwordx4 v[20:23], v0, s[8:11], s17 offen sc1
    s_mov_b64 exec, -1
    s_add_u32 s17, s17, 131072
    s_cmp_lg_u32 s14, 3
    s_cbranch_scc1 Lr_not_w3
    v_and_b32 v7, 12, v8
    v_and_b32 v17, 4, v10
    v_lshl_add_u32 v7, v17, 5, v7
    s_add_u32 s17, s44, 4294877568
    s_cmp_eq_u32 s32, 0
    s_cselect_b32 s67, s67, s17
    s_add_u32 s17, s44, 22656
    s_min_u32 s18, s17, s67
    s_sub_u32 s17, s17, s18
    v_add_u32 v7, s17, v7
    s_sub_u32 s17, s67, s18
    v_mov_b32 v17, s17
    v_cmp_gt_u32 vcc, 8, v10
    s_nop 1
    v_cndmask_b32 v7, v17, v7, vcc
    s_mov_b32 s67, s18
Lr_not_w3:
    v_lshlrev_b32 v5, 3, v0
    s_add_u32 s56, s40, 16777216
    s_waitcnt vmcnt(32)
    s_barrier
    s_cmp_lg_u32 s14, 0
    s_cbranch_scc1 Lr_noadd
    s_lshl_b32 s17, s32, 2
    s_add_u32 s17, s17, 192
    v_mov_b32 v48, s17
    v_mov_b32 v49, 1
    s_mov_b64 exec, 1
    global_atomic_add v48, v49, s[12:13]
    s_mov_b64 exec, -1
Lr_noadd:
    s_add_u32 m0, s58, 32768
    s_add_u32 s17, s57, 393216
    buffer_load_dwordx4 v62, s[20:23], s17 offen lds
    s_add_u32 m0, s58, 33792
    s_add_u32 s17, s57, 425984
    buffer_load_dwordx4 v62, s[20:23], s17 offen lds
    s_add_u32 m0, s58, 34816
    s_add_u32 s17, s57, 458752
    buffer_load_dwordx4 v63, s[20:23], s17 offen lds
    s_add_u32 m0, s58, 35840
    s_add_u32 s17, s57, 491520
    buffer_load_dwordx4 v63, s[20:23], s17 offen lds
    v_add_u32 v68, 49152, v66
    v_add_u32 v69, 49152, v67
    ds_read_b64_tr_b16 v[72:73], v68 offset:0
    ds_read_b64_tr_b16 v[74:75], v68 offset:1024
    ds_read_b64_tr_b16 v[76:77], v68 offset:8192
    ds_read_b64_tr_b16 v[78:79], v68 offset:9216
    ds_read_b64_tr_b16 v[80:81], v69 offset:0
    ds_read_b64_tr_b16 v[82:83], v69 offset:1024
    ds_read_b64_tr_b16 v[84:85], v69 offset:8192
    ds_read_b64_tr_b16 v[86:87], v69 offset:9216
    s_waitcnt lgkmcnt(0)
    s_waitcnt vmcnt(32)
    s_barrier
    s_add_u32 m0, s58, 49152
    s_add_u32 s17, s57, 393216
    buffer_load_dwordx4 v62, s[24:27], s17 offen lds
    s_add_u32 m0, s58, 50176
    s_add_u32 s17, s57, 425984
    buffer_load_dwordx4 v62, s[24:27], s17 offen lds
    s_add_u32 m0, s58, 51200
    s_add_u32 s17, s57, 458752
    buffer_load_dwordx4 v63, s[24:27], s17 offen lds
    s_add_u32 m0, s58, 52224
    s_add_u32 s17, s57, 491520
    buffer_load_dwordx4 v63, s[24:27], s17 offen lds
    v_add_u32 v68, 65536, v66
    v_add_u32 v69, 65536, v67
    ds_read_b64_tr_b16 v[88:89], v68 offset:0
    ds_read_b64_tr_b16 v[90:91], v68 offset:1024
    ds_read_b64_tr_b16 v[92:93], v68 offset:8192
    ds_read_b64_tr_b16 v[94:95], v68 offset:9216
    ds_read_b64_tr_b16 a[176:177], v69 offset:0
    ds_read_b64_tr_b16 a[178:179], v69 offset:1024
    ds_read_b64_tr_b16 a[180:181], v69 offset:8192
    ds_read_b64_tr_b16 a[182:183], v69 offset:9216
    s_waitcnt lgkmcnt(0)
    s_waitcnt vmcnt(32)
    s_barrier
    s_add_u32 m0, s58, 65536
    s_add_u32 s17, s57, 393216
    buffer_load_dwordx4 v62, s[28:31], s17 offen lds
    s_add_u32 m0, s58, 66560
    s_add_u32 s17, s57, 425984
    buffer_load_dwordx4 v62, s[28:31], s17 offen lds
    s_add_u32 m0, s58, 67584
    s_add_u32 s17, s57, 458752
    buffer_load_dwordx4 v63, s[28:31], s17 offen lds
    s_add_u32 m0, s58, 68608
    s_add_u32 s17, s57, 491520
    buffer_load_dwordx4 v63, s[28:31], s17 offen lds
    v_add_u32 v68, 81920, v66
    v_add_u32 v69, 81920, v67
    ds_read_b64_tr_b16 v[96:97], v68 offset:0
    ds_read_b64_tr_b16 v[98:99], v68 offset:1024
    ds_read_b64_tr_b16 v[100:101], v68 offset:8192
    ds_read_b64_tr_b16 v[102:103], v68 offset:9216
    ds_read_b64_tr_b16 v[104:105], v69 offset:0
    ds_read_b64_tr_b16 v[106:107], v69 offset:1024
    ds_read_b64_tr_b16 v[108:109], v69 offset:8192
    ds_read_b64_tr_b16 v[110:111], v69 offset:9216
    s_waitcnt lgkmcnt(0)
    s_waitcnt vmcnt(32)
    s_barrier
    s_add_u32 m0, s58, 81920
    s_add_u32 s17, s57, 524288
    buffer_load_dwordx4 v62, s[20:23], s17 offen lds
    s_add_u32 m0, s58, 82944
    s_add_u32 s17, s57, 557056
    buffer_load_dwordx4 v62, s[20:23], s17 offen lds
    s_add_u32 m0, s58, 83968
    s_add_u32 s17, s57, 589824
    buffer_load_dwordx4 v63, s[20:23], s17 offen lds
    s_add_u32 m0, s58, 84992
    s_add_u32 s17, s57, 622592
    buffer_load_dwordx4 v63, s[20:23], s17 offen lds
    v_add_u32 v68, 98304, v66
    v_add_u32 v69, 98304, v67
    ds_read_b64_tr_b16 v[112:113], v68 offset:0
    ds_read_b64_tr_b16 v[114:115], v68 offset:1024
    ds_read_b64_tr_b16 v[116:117], v68 offset:8192
    ds_read_b64_tr_b16 v[118:119], v68 offset:9216
    ds_read_b64_tr_b16 v[120:121], v69 offset:0
    ds_read_b64_tr_b16 v[122:123], v69 offset:1024
    ds_read_b64_tr_b16 v[124:125], v69 offset:8192
    ds_read_b64_tr_b16 v[126:127], v69 offset:9216
    s_waitcnt lgkmcnt(0)
    s_waitcnt vmcnt(32)
    s_barrier
    s_add_u32 m0, s58, 98304
    s_add_u32 s17, s57, 524288
    buffer_load_dwordx4 v62, s[24:27], s17 offen lds
    s_add_u32 m0, s58, 99328
    s_add_u32 s17, s57, 557056
    buffer_load_dwordx4 v62, s[24:27], s17 offen lds
    s_add_u32 m0, s58, 100352
    s_add_u32 s17, s57, 589824
    buffer_load_dwordx4 v63, s[24:27], s17 offen lds
    s_add_u32 m0, s58, 101376
    s_add_u32 s17, s57, 622592
    buffer_load_dwordx4 v63, s[24:27], s17 offen lds
    v_add_u32 v68, 114688, v66
    v_add_u32 v69, 114688, v67
    ds_read_b64_tr_b16 v[128:129], v68 offset:0
    ds_read_b64_tr_b16 v[130:131], v68 offset:1024
    ds_read_b64_tr_b16 v[132:133], v68 offset:8192
    ds_read_b64_tr_b16 v[134:135], v68 offset:9216
    ds_read_b64_tr_b16 a[184:185], v69 offset:0
    ds_read_b64_tr_b16 a[186:187], v69 offset:1024
    ds_read_b64_tr_b16 a[188:189], v69 offset:8192
    ds_read_b64_tr_b16 a[190:191], v69 offset:9216
    s_waitcnt lgkmcnt(0)
    s_waitcnt vmcnt(32)
    s_barrier
    s_add_u32 m0, s58, 114688
    s_add_u32 s17, s57, 524288
    buffer_load_dwordx4 v62, s[28:31], s17 offen lds
    s_add_u32 m0, s58, 115712
    s_add_u32 s17, s57, 557056
    buffer_load_dwordx4 v62, s[28:31], s17 offen lds
    s_add_u32 m0, s58, 116736
    s_add_u32 s17, s57, 589824
    buffer_load_dwordx4 v63, s[28:31], s17 offen lds
    s_add_u32 m0, s58, 117760
    s_add_u32 s17, s57, 622592
    buffer_load_dwordx4 v63, s[28:31], s17 offen lds
    v_add_u32 v68, 131072, v66
    v_add_u32 v69, 131072, v67
    ds_read_b64_tr_b16 v[136:137], v68 offset:0
    ds_read_b64_tr_b16 v[138:139], v68 offset:1024
    ds_read_b64_tr_b16 v[140:141], v68 offset:8192
    ds_read_b64_tr_b16 v[142:143], v68 offset:9216
    ds_read_b64_tr_b16 v[144:145], v69 offset:0
    ds_read_b64_tr_b16 v[146:147], v69 offset:1024
    ds_read_b64_tr_b16 v[148:149], v69 offset:8192
    ds_read_b64_tr_b16 v[150:151], v69 offset:9216
    s_waitcnt lgkmcnt(0)
    s_waitcnt vmcnt(32)
    s_barrier
    s_add_u32 m0, s58, 131072
    s_add_u32 s17, s57, 655360
    buffer_load_dwordx4 v62, s[20:23], s17 offen lds
    s_add_u32 m0, s58, 132096
    s_add_u32 s17, s57, 688128
    buffer_load_dwordx4 v62, s[20:23], s17 offen lds
    s_add_u32 m0, s58, 133120
    s_add_u32 s17, s57, 720896
    buffer_load_dwordx4 v63, s[20:23], s17 offen lds
    s_add_u32 m0, s58, 134144
    s_add_u32 s17, s57, 753664
    buffer_load_dwordx4 v63, s[20:23], s17 offen lds
    v_add_u32 v68, 147456, v66
    v_add_u32 v69, 147456, v67
    ds_read_b64_tr_b16 v[152:153], v68 offset:0
    ds_read_b64_tr_b16 v[154:155], v68 offset:1024
    ds_read_b64_tr_b16 v[156:157], v68 offset:8192
    ds_read_b64_tr_b16 v[158:159], v68 offset:9216
    ds_read_b64_tr_b16 v[160:161], v69 offset:0
    ds_read_b64_tr_b16 v[162:163], v69 offset:1024
    ds_read_b64_tr_b16 v[164:165], v69 offset:8192
    ds_read_b64_tr_b16 v[166:167], v69 offset:9216
    s_waitcnt lgkmcnt(0)
    s_waitcnt vmcnt(32)
    s_barrier
    s_add_u32 m0, s58, 147456
    s_add_u32 s17, s57, 655360
    buffer_load_dwordx4 v62, s[24:27], s17 offen lds
    s_add_u32 m0, s58, 148480
    s_add_u32 s17, s57, 688128
    buffer_load_dwordx4 v62, s[24:27], s17 offen lds
    s_add_u32 m0, s58, 149504
    s_add_u32 s17, s57, 720896
    buffer_load_dwordx4 v63, s[24:27], s17 offen lds
    s_add_u32 m0, s58, 150528
    s_add_u32 s17, s57, 753664
    buffer_load_dwordx4 v63, s[24:27], s17 offen lds
    v_add_u32 v68, 0, v66
    v_add_u32 v69, 0, v67
    ds_read_b64_tr_b16 v[168:169], v68 offset:0
    ds_read_b64_tr_b16 v[170:171], v68 offset:1024
    ds_read_b64_tr_b16 v[172:173], v68 offset:8192
    ds_read_b64_tr_b16 v[174:175], v68 offset:9216
    ds_read_b64_tr_b16 a[192:193], v69 offset:0
    ds_read_b64_tr_b16 a[194:195], v69 offset:1024
    ds_read_b64_tr_b16 a[196:197], v69 offset:8192
    ds_read_b64_tr_b16 a[198:199], v69 offset:9216
    s_waitcnt lgkmcnt(0)
    s_waitcnt vmcnt(32)
    s_barrier
    s_add_u32 m0, s58, 0
    s_add_u32 s17, s57, 655360
    buffer_load_dwordx4 v62, s[28:31], s17 offen lds
    s_add_u32 m0, s58, 1024
    s_add_u32 s17, s57, 688128
    buffer_load_dwordx4 v62, s[28:31], s17 offen lds
    s_add_u32 m0, s58, 2048
    s_add_u32 s17, s57, 720896
    buffer_load_dwordx4 v63, s[28:31], s17 offen lds
    s_add_u32 m0, s58, 3072
    s_add_u32 s17, s57, 753664
    buffer_load_dwordx4 v63, s[28:31], s17 offen lds
    v_add_u32 v68, 16384, v66
    v_add_u32 v69, 16384, v67
    ds_read_b64_tr_b16 v[176:177], v68 offset:0
    ds_read_b64_tr_b16 v[178:179], v68 offset:1024
    ds_read_b64_tr_b16 v[180:181], v68 offset:8192
    ds_read_b64_tr_b16 v[182:183], v68 offset:9216
    ds_read_b64_tr_b16 v[184:185], v69 offset:0
    ds_read_b64_tr_b16 v[186:187], v69 offset:1024
    ds_read_b64_tr_b16 v[188:189], v69 offset:8192
    ds_read_b64_tr_b16 v[190:191], v69 offset:9216
    s_waitcnt lgkmcnt(0)
    s_waitcnt vmcnt(32)
    s_barrier
    s_add_u32 m0, s58, 16384
    s_add_u32 s17, s57, 786432
    buffer_load_dwordx4 v62, s[20:23], s17 offen lds
    s_add_u32 m0, s58, 17408
    s_add_u32 s17, s57, 819200
    buffer_load_dwordx4 v62, s[20:23], s17 offen lds
    s_add_u32 m0, s58, 18432
    s_add_u32 s17, s57, 851968
    buffer_load_dwordx4 v63, s[20:23], s17 offen lds
    s_add_u32 m0, s58, 19456
    s_add_u32 s17, s57, 884736
    buffer_load_dwordx4 v63, s[20:23], s17 offen lds
    v_add_u32 v68, 32768, v66
    v_add_u32 v69, 32768, v67
    ds_read_b64_tr_b16 v[192:193], v68 offset:0
    ds_read_b64_tr_b16 v[194:195], v68 offset:1024
    ds_read_b64_tr_b16 v[196:197], v68 offset:8192
    ds_read_b64_tr_b16 v[198:199], v68 offset:9216
    ds_read_b64_tr_b16 v[200:201], v69 offset:0
    ds_read_b64_tr_b16 v[202:203], v69 offset:1024
    ds_read_b64_tr_b16 v[204:205], v69 offset:8192
    ds_read_b64_tr_b16 v[206:207], v69 offset:9216
    s_waitcnt lgkmcnt(0)
    s_waitcnt vmcnt(32)
    s_barrier
    s_add_u32 m0, s58, 32768
    s_add_u32 s17, s57, 786432
    buffer_load_dwordx4 v62, s[24:27], s17 offen lds
    s_add_u32 m0, s58, 33792
    s_add_u32 s17, s57, 819200
    buffer_load_dwordx4 v62, s[24:27], s17 offen lds
    s_add_u32 m0, s58, 34816
    s_add_u32 s17, s57, 851968
    buffer_load_dwordx4 v63, s[24:27], s17 offen lds
    s_add_u32 m0, s58, 35840
    s_add_u32 s17, s57, 884736
    buffer_load_dwordx4 v63, s[24:27], s17 offen lds
    v_add_u32 v68, 49152, v66
    v_add_u32 v69, 49152, v67
    ds_read_b64_tr_b16 v[208:209], v68 offset:0
    ds_read_b64_tr_b16 v[210:211], v68 offset:1024
    ds_read_b64_tr_b16 v[212:213], v68 offset:8192
    ds_read_b64_tr_b16 v[214:215], v68 offset:9216
    ds_read_b64_tr_b16 a[200:201], v69 offset:0
    ds_read_b64_tr_b16 a[202:203], v69 offset:1024
    ds_read_b64_tr_b16 a[204:205], v69 offset:8192
    ds_read_b64_tr_b16 a[206:207], v69 offset:9216
    s_waitcnt lgkmcnt(0)
    s_waitcnt vmcnt(32)
    s_barrier
    s_add_u32 m0, s58, 49152
    s_add_u32 s17, s57, 786432
    buffer_load_dwordx4 v62, s[28:31], s17 offen lds
    s_add_u32 m0, s58, 50176
    s_add_u32 s17, s57, 819200
    buffer_load_dwordx4 v62, s[28:31], s17 offen lds
    s_add_u32 m0, s58, 51200
    s_add_u32 s17, s57, 851968
    buffer_load_dwordx4 v63, s[28:31], s17 offen lds
    s_add_u32 m0, s58, 52224
    s_add_u32 s17, s57, 884736
    buffer_load_dwordx4 v63, s[28:31], s17 offen lds
    v_add_u32 v68, 65536, v66
    v_add_u32 v69, 65536, v67
    ds_read_b64_tr_b16 v[216:217], v68 offset:0
    ds_read_b64_tr_b16 v[218:219], v68 offset:1024
    ds_read_b64_tr_b16 v[220:221], v68 offset:8192
    ds_read_b64_tr_b16 v[222:223], v68 offset:9216
    ds_read_b64_tr_b16 v[224:225], v69 offset:0
    ds_read_b64_tr_b16 v[226:227], v69 offset:1024
    ds_read_b64_tr_b16 v[228:229], v69 offset:8192
    ds_read_b64_tr_b16 v[230:231], v69 offset:9216
    s_waitcnt lgkmcnt(0)
    s_waitcnt vmcnt(32)
    s_barrier
    s_add_u32 m0, s58, 65536
    s_add_u32 s17, s57, 917504
    buffer_load_dwordx4 v62, s[20:23], s17 offen lds
    s_add_u32 m0, s58, 66560
    s_add_u32 s17, s57, 950272
    buffer_load_dwordx4 v62, s[20:23], s17 offen lds
    s_add_u32 m0, s58, 67584
    s_add_u32 s17, s57, 983040
    buffer_load_dwordx4 v63, s[20:23], s17 offen lds
    s_add_u32 m0, s58, 68608
    s_add_u32 s17, s57, 1015808
    buffer_load_dwordx4 v63, s[20:23], s17 offen lds
    v_add_u32 v68, 81920, v66
    v_add_u32 v69, 81920, v67
    ds_read_b64_tr_b16 v[232:233], v68 offset:0
    ds_read_b64_tr_b16 v[234:235], v68 offset:1024
    ds_read_b64_tr_b16 v[236:237], v68 offset:8192
    ds_read_b64_tr_b16 v[238:239], v68 offset:9216
    ds_read_b64_tr_b16 v[240:241], v69 offset:0
    ds_read_b64_tr_b16 v[242:243], v69 offset:1024
    ds_read_b64_tr_b16 v[244:245], v69 offset:8192
    ds_read_b64_tr_b16 v[246:247], v69 offset:9216
    s_waitcnt lgkmcnt(0)
    s_waitcnt vmcnt(32)
    s_barrier
    s_add_u32 m0, s58, 81920
    s_add_u32 s17, s57, 917504
    buffer_load_dwordx4 v62, s[24:27], s17 offen lds
    s_add_u32 m0, s58, 82944
    s_add_u32 s17, s57, 950272
    buffer_load_dwordx4 v62, s[24:27], s17 offen lds
    s_add_u32 m0, s58, 83968
    s_add_u32 s17, s57, 983040
    buffer_load_dwordx4 v63, s[24:27], s17 offen lds
    s_add_u32 m0, s58, 84992
    s_add_u32 s17, s57, 1015808
    buffer_load_dwordx4 v63, s[24:27], s17 offen lds
    v_add_u32 v68, 98304, v66
    v_add_u32 v69, 98304, v67
    ds_read_b64_tr_b16 v[248:249], v68 offset:0
    ds_read_b64_tr_b16 v[250:251], v68 offset:1024
    ds_read_b64_tr_b16 v[252:253], v68 offset:8192
    ds_read_b64_tr_b16 v[254:255], v68 offset:9216
    ds_read_b64_tr_b16 a[208:209], v69 offset:0
    ds_read_b64_tr_b16 a[210:211], v69 offset:1024
    ds_read_b64_tr_b16 a[212:213], v69 offset:8192
    ds_read_b64_tr_b16 a[214:215], v69 offset:9216
    s_waitcnt lgkmcnt(0)
    s_waitcnt vmcnt(32)
    s_barrier
    s_add_u32 m0, s58, 98304
    s_add_u32 s17, s57, 917504
    buffer_load_dwordx4 v62, s[28:31], s17 offen lds
    s_add_u32 m0, s58, 99328
    s_add_u32 s17, s57, 950272
    buffer_load_dwordx4 v62, s[28:31], s17 offen lds
    s_add_u32 m0, s58, 100352
    s_add_u32 s17, s57, 983040
    buffer_load_dwordx4 v63, s[28:31], s17 offen lds
    s_add_u32 m0, s58, 101376
    s_add_u32 s17, s57, 1015808
    buffer_load_dwordx4 v63, s[28:31], s17 offen lds
    v_add_u32 v68, 114688, v66
    v_add_u32 v69, 114688, v67
    ds_read_b64_tr_b16 a[0:1], v68 offset:0
    ds_read_b64_tr_b16 a[2:3], v68 offset:1024
    ds_read_b64_tr_b16 a[4:5], v68 offset:8192
    ds_read_b64_tr_b16 a[6:7], v68 offset:9216
    ds_read_b64_tr_b16 a[8:9], v69 offset:0
    ds_read_b64_tr_b16 a[10:11], v69 offset:1024
    ds_read_b64_tr_b16 a[12:13], v69 offset:8192
    ds_read_b64_tr_b16 a[14:15], v69 offset:9216
    s_waitcnt lgkmcnt(0)
    s_waitcnt vmcnt(32)
    s_barrier
    s_add_u32 m0, s58, 114688
    s_add_u32 s17, s57, 1048576
    buffer_load_dwordx4 v64, s[20:23], s17 offen lds
    s_add_u32 m0, s58, 115712
    s_add_u32 s17, s57, 1056768
    buffer_load_dwordx4 v64, s[20:23], s17 offen lds
    s_add_u32 m0, s58, 116736
    s_add_u32 s17, s57, 1064960
    buffer_load_dwordx4 v65, s[20:23], s17 offen lds
    s_add_u32 m0, s58, 117760
    s_add_u32 s17, s57, 1073152
    buffer_load_dwordx4 v65, s[20:23], s17 offen lds
    v_add_u32 v68, 131072, v66
    v_add_u32 v69, 131072, v67
    ds_read_b64_tr_b16 a[16:17], v68 offset:0
    ds_read_b64_tr_b16 a[18:19], v68 offset:1024
    ds_read_b64_tr_b16 a[20:21], v68 offset:8192
    ds_read_b64_tr_b16 a[22:23], v68 offset:9216
    ds_read_b64_tr_b16 a[24:25], v69 offset:0
    ds_read_b64_tr_b16 a[26:27], v69 offset:1024
    ds_read_b64_tr_b16 a[28:29], v69 offset:8192
    ds_read_b64_tr_b16 a[30:31], v69 offset:9216
    s_waitcnt lgkmcnt(0)
    s_waitcnt vmcnt(32)
    s_barrier
    s_add_u32 m0, s58, 131072
    s_add_u32 s17, s57, 1048576
    buffer_load_dwordx4 v64, s[24:27], s17 offen lds
    s_add_u32 m0, s58, 132096
    s_add_u32 s17, s57, 1056768
    buffer_load_dwordx4 v64, s[24:27], s17 offen lds
    s_add_u32 m0, s58, 133120
    s_add_u32 s17, s57, 1064960
    buffer_load_dwordx4 v65, s[24:27], s17 offen lds
    s_add_u32 m0, s58, 134144
    s_add_u32 s17, s57, 1073152
    buffer_load_dwordx4 v65, s[24:27], s17 offen lds
    v_add_u32 v68, 147456, v66
    v_add_u32 v69, 147456, v67
    ds_read_b64_tr_b16 a[32:33], v68 offset:0
    ds_read_b64_tr_b16 a[34:35], v68 offset:1024
    ds_read_b64_tr_b16 a[36:37], v68 offset:8192
    ds_read_b64_tr_b16 a[38:39], v68 offset:9216
    ds_read_b64_tr_b16 a[216:217], v69 offset:0
    ds_read_b64_tr_b16 a[218:219], v69 offset:1024
    ds_read_b64_tr_b16 a[220:221], v69 offset:8192
    ds_read_b64_tr_b16 a[222:223], v69 offset:9216
    s_waitcnt lgkmcnt(0)
    s_waitcnt vmcnt(32)
    s_barrier
    s_add_u32 m0, s58, 147456
    s_add_u32 s17, s57, 1048576
    buffer_load_dwordx4 v64, s[28:31], s17 offen lds
    s_add_u32 m0, s58, 148480
    s_add_u32 s17, s57, 1056768
    buffer_load_dwordx4 v64, s[28:31], s17 offen lds
    s_add_u32 m0, s58, 149504
    s_add_u32 s17, s57, 1064960
    buffer_load_dwordx4 v65, s[28:31], s17 offen lds
    s_add_u32 m0, s58, 150528
    s_add_u32 s17, s57, 1073152
    buffer_load_dwordx4 v65, s[28:31], s17 offen lds
    v_add_u32 v68, 0, v66
    v_add_u32 v69, 0, v67
    ds_read_b64_tr_b16 a[40:41], v68 offset:0
    ds_read_b64_tr_b16 a[42:43], v68 offset:1024
    ds_read_b64_tr_b16 a[44:45], v68 offset:8192
    ds_read_b64_tr_b16 a[46:47], v68 offset:9216
    ds_read_b64_tr_b16 a[48:49], v69 offset:0
    ds_read_b64_tr_b16 a[50:51], v69 offset:1024
    ds_read_b64_tr_b16 a[52:53], v69 offset:8192
    ds_read_b64_tr_b16 a[54:55], v69 offset:9216
    s_waitcnt lgkmcnt(0)
    s_waitcnt vmcnt(32)
    s_barrier
    v_add_u32 v68, 16384, v66
    v_add_u32 v69, 16384, v67
    ds_read_b64_tr_b16 a[56:57], v68 offset:0
    ds_read_b64_tr_b16 a[58:59], v68 offset:1024
    ds_read_b64_tr_b16 a[60:61], v68 offset:8192
    ds_read_b64_tr_b16 a[62:63], v68 offset:9216
    ds_read_b64_tr_b16 a[64:65], v69 offset:0
    ds_read_b64_tr_b16 a[66:67], v69 offset:1024
    ds_read_b64_tr_b16 a[68:69], v69 offset:8192
    ds_read_b64_tr_b16 a[70:71], v69 offset:9216
    s_waitcnt lgkmcnt(0)
    s_waitcnt vmcnt(28)
    s_barrier
    v_add_u32 v68, 32768, v66
    v_add_u32 v69, 32768, v67
    ds_read_b64_tr_b16 a[72:73], v68 offset:0
    ds_read_b64_tr_b16 a[74:75], v68 offset:1024
    ds_read_b64_tr_b16 a[76:77], v68 offset:8192
    ds_read_b64_tr_b16 a[78:79], v68 offset:9216
    ds_read_b64_tr_b16 a[224:225], v69 offset:0
    ds_read_b64_tr_b16 a[226:227], v69 offset:1024
    ds_read_b64_tr_b16 a[228:229], v69 offset:8192
    ds_read_b64_tr_b16 a[230:231], v69 offset:9216
    s_waitcnt lgkmcnt(0)
    s_waitcnt vmcnt(24)
    s_barrier
    v_add_u32 v68, 49152, v66
    v_add_u32 v69, 49152, v67
    ds_read_b64_tr_b16 a[80:81], v68 offset:0
    ds_read_b64_tr_b16 a[82:83], v68 offset:1024
    ds_read_b64_tr_b16 a[84:85], v68 offset:8192
    ds_read_b64_tr_b16 a[86:87], v68 offset:9216
    ds_read_b64_tr_b16 a[88:89], v69 offset:0
    ds_read_b64_tr_b16 a[90:91], v69 offset:1024
    ds_read_b64_tr_b16 a[92:93], v69 offset:8192
    ds_read_b64_tr_b16 a[94:95], v69 offset:9216
    s_waitcnt lgkmcnt(0)
    s_waitcnt vmcnt(20)
    s_barrier
    s_add_u32 s17, s59, 0
    s_add_u32 m0, s60, 0
    s_nop 0
    buffer_load_dwordx4 v50, s[80:83], s17 offen lds
    s_add_u32 m0, s60, 1024
    s_nop 0
    buffer_load_dwordx4 v51, s[80:83], s17 offen lds
    s_add_u32 m0, s60, 2048
    s_nop 0
    buffer_load_dwordx4 v52, s[80:83], s17 offen lds
    s_add_u32 m0, s60, 3072
    s_nop 0
    buffer_load_dwordx4 v53, s[80:83], s17 offen lds
    s_add_u32 m0, s60, 4096
    s_mov_b64 exec, s[52:53]
    buffer_load_dwordx4 v54, s[80:83], s17 offen lds
    s_mov_b64 exec, -1
    v_add_u32 v68, 65536, v66
    v_add_u32 v69, 65536, v67
    ds_read_b64_tr_b16 a[96:97], v68 offset:0
    ds_read_b64_tr_b16 a[98:99], v68 offset:1024
    ds_read_b64_tr_b16 a[100:101], v68 offset:8192
    ds_read_b64_tr_b16 a[102:103], v68 offset:9216
    ds_read_b64_tr_b16 a[104:105], v69 offset:0
    ds_read_b64_tr_b16 a[106:107], v69 offset:1024
    ds_read_b64_tr_b16 a[108:109], v69 offset:8192
    ds_read_b64_tr_b16 a[110:111], v69 offset:9216
    s_waitcnt lgkmcnt(0)
    s_waitcnt vmcnt(21)
    s_barrier
    s_add_u32 s17, s59, 1152
    s_add_u32 m0, s60, 18432
    s_nop 0
    buffer_load_dwordx4 v50, s[80:83], s17 offen lds
    s_add_u32 m0, s60, 19456
    s_nop 0
    buffer_load_dwordx4 v51, s[80:83], s17 offen lds
    s_add_u32 m0, s60, 20480
    s_nop 0
    buffer_load_dwordx4 v52, s[80:83], s17 offen lds
    s_add_u32 m0, s60, 21504
    s_nop 0
    buffer_load_dwordx4 v53, s[80:83], s17 offen lds
    s_add_u32 m0, s60, 22528
    s_mov_b64 exec, s[52:53]
    buffer_load_dwordx4 v54, s[80:83], s17 offen lds
    s_mov_b64 exec, -1
    v_add_u32 v68, 81920, v66
    v_add_u32 v69, 81920, v67
    ds_read_b64_tr_b16 a[112:113], v68 offset:0
    ds_read_b64_tr_b16 a[114:115], v68 offset:1024
    ds_read_b64_tr_b16 a[116:117], v68 offset:8192
    ds_read_b64_tr_b16 a[118:119], v68 offset:9216
    ds_read_b64_tr_b16 a[232:233], v69 offset:0
    ds_read_b64_tr_b16 a[234:235], v69 offset:1024
    ds_read_b64_tr_b16 a[236:237], v69 offset:8192
    ds_read_b64_tr_b16 a[238:239], v69 offset:9216
    s_waitcnt lgkmcnt(0)
    s_waitcnt vmcnt(22)
    s_barrier
    s_add_u32 s17, s59, 36864
    s_add_u32 m0, s60, 36864
    s_nop 0
    buffer_load_dwordx4 v50, s[80:83], s17 offen lds
    s_add_u32 m0, s60, 37888
    s_nop 0
    buffer_load_dwordx4 v51, s[80:83], s17 offen lds
    s_add_u32 m0, s60, 38912
    s_nop 0
    buffer_load_dwordx4 v52, s[80:83], s17 offen lds
    s_add_u32 m0, s60, 39936
    s_nop 0
    buffer_load_dwordx4 v53, s[80:83], s17 offen lds
    s_add_u32 m0, s60, 40960
    s_mov_b64 exec, s[52:53]
    buffer_load_dwordx4 v54, s[80:83], s17 offen lds
    s_mov_b64 exec, -1
    v_add_u32 v68, 98304, v66
    v_add_u32 v69, 98304, v67
    ds_read_b64_tr_b16 a[120:121], v68 offset:0
    ds_read_b64_tr_b16 a[122:123], v68 offset:1024
    ds_read_b64_tr_b16 a[124:125], v68 offset:8192
    ds_read_b64_tr_b16 a[126:127], v68 offset:9216
    ds_read_b64_tr_b16 a[128:129], v69 offset:0
    ds_read_b64_tr_b16 a[130:131], v69 offset:1024
    ds_read_b64_tr_b16 a[132:133], v69 offset:8192
    ds_read_b64_tr_b16 a[134:135], v69 offset:9216
    s_waitcnt lgkmcnt(0)
    s_waitcnt vmcnt(23)
    s_barrier
    v_add_u32 v68, 114688, v66
    v_add_u32 v69, 114688, v67
    ds_read_b64_tr_b16 a[136:137], v68 offset:0
    ds_read_b64_tr_b16 a[138:139], v68 offset:1024
    ds_read_b64_tr_b16 a[140:141], v68 offset:8192
    ds_read_b64_tr_b16 a[142:143], v68 offset:9216
    ds_read_b64_tr_b16 a[144:145], v69 offset:0
    ds_read_b64_tr_b16 a[146:147], v69 offset:1024
    ds_read_b64_tr_b16 a[148:149], v69 offset:8192
    ds_read_b64_tr_b16 a[150:151], v69 offset:9216
    s_waitcnt lgkmcnt(0)
    s_waitcnt vmcnt(19)
    s_barrier
    v_add_u32 v68, 131072, v66
    v_add_u32 v69, 131072, v67
    ds_read_b64_tr_b16 a[152:153], v68 offset:0
    ds_read_b64_tr_b16 a[154:155], v68 offset:1024
    ds_read_b64_tr_b16 a[156:157], v68 offset:8192
    ds_read_b64_tr_b16 a[158:159], v68 offset:9216
    ds_read_b64_tr_b16 a[240:241], v69 offset:0
    ds_read_b64_tr_b16 a[242:243], v69 offset:1024
    ds_read_b64_tr_b16 a[244:245], v69 offset:8192
    ds_read_b64_tr_b16 a[246:247], v69 offset:9216
    s_waitcnt lgkmcnt(0)
    s_waitcnt vmcnt(15)
    s_barrier
    v_add_u32 v68, 147456, v66
    v_add_u32 v69, 147456, v67
    ds_read_b64_tr_b16 a[160:161], v68 offset:0
    ds_read_b64_tr_b16 a[162:163], v68 offset:1024
    ds_read_b64_tr_b16 a[164:165], v68 offset:8192
    ds_read_b64_tr_b16 a[166:167], v68 offset:9216
    ds_read_b64_tr_b16 a[168:169], v69 offset:0
    ds_read_b64_tr_b16 a[170:171], v69 offset:1024
    ds_read_b64_tr_b16 a[172:173], v69 offset:8192
    ds_read_b64_tr_b16 a[174:175], v69 offset:9216
    s_waitcnt lgkmcnt(0)
    s_barrier
    ds_write_b128 v9, a[176:179] offset:0
    ds_write_b128 v9, a[180:183] offset:1024
    ds_write_b128 v9, a[184:187] offset:2048
    ds_write_b128 v9, a[188:191] offset:3072
    ds_write_b128 v9, a[192:195] offset:4096
    ds_write_b128 v9, a[196:199] offset:5120
    ds_write_b128 v9, a[200:203] offset:6144
    ds_write_b128 v9, a[204:207] offset:7168
    ds_write_b128 v9, a[208:211] offset:8192
    ds_write_b128 v9, a[212:215] offset:9216
    ds_write_b128 v9, a[216:219] offset:10240
    ds_write_b128 v9, a[220:223] offset:11264
    ds_write_b128 v9, a[224:227] offset:12288
    ds_write_b128 v9, a[228:231] offset:13312
    ds_write_b128 v9, a[232:235] offset:14336
    ds_write_b128 v9, a[236:239] offset:15360
    ds_write_b128 v9, a[240:243] offset:16384
    ds_write_b128 v9, a[244:247] offset:17408
    s_waitcnt lgkmcnt(0)
    s_waitcnt vmcnt(10)
    s_barrier
    ds_read_b64_tr_b16 a[176:177], v70 offset:0
    ds_read_b64_tr_b16 a[192:193], v70 offset:32
    ds_read_b64_tr_b16 v[12:13], v70 offset:64
    ds_read_b64_tr_b16 a[208:209], v70 offset:96
    ds_read_b64_tr_b16 v[20:21], v70 offset:128
    ds_read_b64_tr_b16 a[224:225], v70 offset:160
    ds_read_b64_tr_b16 a[240:241], v70 offset:192
    ds_read_b64_tr_b16 v[28:29], v70 offset:224
    ds_read_b64_tr_b16 v[36:37], v70 offset:256
    s_waitcnt lgkmcnt(0)
    s_waitcnt vmcnt(5)
    s_barrier
    s_add_u32 s17, s59, 38016
    s_add_u32 m0, s60, 0
    s_nop 0
    buffer_load_dwordx4 v50, s[80:83], s17 offen lds
    s_add_u32 m0, s60, 1024
    s_nop 0
    buffer_load_dwordx4 v51, s[80:83], s17 offen lds
    s_add_u32 m0, s60, 2048
    s_nop 0
    buffer_load_dwordx4 v52, s[80:83], s17 offen lds
    s_add_u32 m0, s60, 3072
    s_nop 0
    buffer_load_dwordx4 v53, s[80:83], s17 offen lds
    s_add_u32 m0, s60, 4096
    s_mov_b64 exec, s[52:53]
    buffer_load_dwordx4 v54, s[80:83], s17 offen lds
    s_mov_b64 exec, -1
    ds_read_b64_tr_b16 a[178:179], v70 offset:18432
    ds_read_b64_tr_b16 a[194:195], v70 offset:18464
    ds_read_b64_tr_b16 v[14:15], v70 offset:18496
    ds_read_b64_tr_b16 a[210:211], v70 offset:18528
    ds_read_b64_tr_b16 v[22:23], v70 offset:18560
    ds_read_b64_tr_b16 a[226:227], v70 offset:18592
    ds_read_b64_tr_b16 a[242:243], v70 offset:18624
    ds_read_b64_tr_b16 v[30:31], v70 offset:18656
    ds_read_b64_tr_b16 v[38:39], v70 offset:18688
    s_waitcnt lgkmcnt(0)
    s_waitcnt vmcnt(5)
    s_barrier
    s_add_u32 s17, s59, 73728
    s_add_u32 m0, s60, 18432
    s_nop 0
    buffer_load_dwordx4 v50, s[80:83], s17 offen lds
    s_add_u32 m0, s60, 19456
    s_nop 0
    buffer_load_dwordx4 v51, s[80:83], s17 offen lds
    s_add_u32 m0, s60, 20480
    s_nop 0
    buffer_load_dwordx4 v52, s[80:83], s17 offen lds
    s_add_u32 m0, s60, 21504
    s_nop 0
    buffer_load_dwordx4 v53, s[80:83], s17 offen lds
    s_add_u32 m0, s60, 22528
    s_mov_b64 exec, s[52:53]
    buffer_load_dwordx4 v54, s[80:83], s17 offen lds
    s_mov_b64 exec, -1
    ds_read_b64_tr_b16 a[180:181], v70 offset:36864
    ds_read_b64_tr_b16 a[196:197], v70 offset:36896
    ds_read_b64_tr_b16 v[16:17], v70 offset:36928
    ds_read_b64_tr_b16 a[212:213], v70 offset:36960
    ds_read_b64_tr_b16 v[24:25], v70 offset:36992
    ds_read_b64_tr_b16 a[228:229], v70 offset:37024
    ds_read_b64_tr_b16 a[244:245], v70 offset:37056
    ds_read_b64_tr_b16 v[32:33], v70 offset:37088
    ds_read_b64_tr_b16 v[40:41], v70 offset:37120
    s_waitcnt lgkmcnt(0)
    s_waitcnt vmcnt(5)
    s_barrier
    s_add_u32 s17, s59, 74880
    s_add_u32 m0, s60, 36864
    s_nop 0
    buffer_load_dwordx4 v50, s[80:83], s17 offen lds
    s_add_u32 m0, s60, 37888
    s_nop 0
    buffer_load_dwordx4 v51, s[80:83], s17 offen lds
    s_add_u32 m0, s60, 38912
    s_nop 0
    buffer_load_dwordx4 v52, s[80:83], s17 offen lds
    s_add_u32 m0, s60, 39936
    s_nop 0
    buffer_load_dwordx4 v53, s[80:83], s17 offen lds
    s_add_u32 m0, s60, 40960
    s_mov_b64 exec, s[52:53]
    buffer_load_dwordx4 v54, s[80:83], s17 offen lds
    s_mov_b64 exec, -1
    ds_read_b64_tr_b16 a[182:183], v70 offset:0
    ds_read_b64_tr_b16 a[198:199], v70 offset:32
    ds_read_b64_tr_b16 v[18:19], v70 offset:64
    ds_read_b64_tr_b16 a[214:215], v70 offset:96
    ds_read_b64_tr_b16 v[26:27], v70 offset:128
    ds_read_b64_tr_b16 a[230:231], v70 offset:160
    ds_read_b64_tr_b16 a[246:247], v70 offset:192
    ds_read_b64_tr_b16 v[34:35], v70 offset:224
    ds_read_b64_tr_b16 v[42:43], v70 offset:256
    s_waitcnt lgkmcnt(0)
    ds_write_b128 v9, v[12:15] offset:18432
    ds_write_b128 v9, v[16:19] offset:19456
    ds_write_b128 v9, v[20:23] offset:20480
    ds_write_b128 v9, v[24:27] offset:21504
    ds_write_b128 v9, v[28:31] offset:22528
    ds_write_b128 v9, v[32:35] offset:23552
    ds_write_b128 v9, v[36:39] offset:24576
    ds_write_b128 v9, v[40:43] offset:25600
    s_waitcnt lgkmcnt(0)
    s_waitcnt vmcnt(5)
    s_barrier
    s_add_u32 s17, s59, 110592
    s_add_u32 m0, s60, 0
    s_nop 0
    buffer_load_dwordx4 v50, s[80:83], s17 offen lds
    s_add_u32 m0, s60, 1024
    s_nop 0
    buffer_load_dwordx4 v51, s[80:83], s17 offen lds
    s_add_u32 m0, s60, 2048
    s_nop 0
    buffer_load_dwordx4 v52, s[80:83], s17 offen lds
    s_add_u32 m0, s60, 3072
    s_nop 0
    buffer_load_dwordx4 v53, s[80:83], s17 offen lds
    s_add_u32 m0, s60, 4096
    s_mov_b64 exec, s[52:53]
    buffer_load_dwordx4 v54, s[80:83], s17 offen lds
    s_mov_b64 exec, -1
    ds_read_b64_tr_b16 a[184:185], v70 offset:18432
    ds_read_b64_tr_b16 v[12:13], v70 offset:18464
    ds_read_b64_tr_b16 a[200:201], v70 offset:18496
    ds_read_b64_tr_b16 a[216:217], v70 offset:18528
    ds_read_b64_tr_b16 v[20:21], v70 offset:18560
    ds_read_b64_tr_b16 a[232:233], v70 offset:18592
    ds_read_b64_tr_b16 v[28:29], v70 offset:18624
    ds_read_b64_tr_b16 a[248:249], v70 offset:18656
    ds_read_b64_tr_b16 v[36:37], v70 offset:18688
    s_waitcnt lgkmcnt(0)
    s_waitcnt vmcnt(5)
    s_barrier
    s_add_u32 s17, s59, 111744
    s_add_u32 m0, s60, 18432
    s_nop 0
    buffer_load_dwordx4 v50, s[80:83], s17 offen lds
    s_add_u32 m0, s60, 19456
    s_nop 0
    buffer_load_dwordx4 v51, s[80:83], s17 offen lds
    s_add_u32 m0, s60, 20480
    s_nop 0
    buffer_load_dwordx4 v52, s[80:83], s17 offen lds
    s_add_u32 m0, s60, 21504
    s_nop 0
    buffer_load_dwordx4 v53, s[80:83], s17 offen lds
    s_add_u32 m0, s60, 22528
    s_mov_b64 exec, s[52:53]
    buffer_load_dwordx4 v54, s[80:83], s17 offen lds
    s_mov_b64 exec, -1
    ds_read_b64_tr_b16 a[186:187], v70 offset:36864
    ds_read_b64_tr_b16 v[14:15], v70 offset:36896
    ds_read_b64_tr_b16 a[202:203], v70 offset:36928
    ds_read_b64_tr_b16 a[218:219], v70 offset:36960
    ds_read_b64_tr_b16 v[22:23], v70 offset:36992
    ds_read_b64_tr_b16 a[234:235], v70 offset:37024
    ds_read_b64_tr_b16 v[30:31], v70 offset:37056
    ds_read_b64_tr_b16 a[250:251], v70 offset:37088
    ds_read_b64_tr_b16 v[38:39], v70 offset:37120
    s_waitcnt lgkmcnt(0)
    s_waitcnt vmcnt(5)
    s_barrier
    ds_read_b64_tr_b16 a[188:189], v70 offset:0
    ds_read_b64_tr_b16 v[16:17], v70 offset:32
    ds_read_b64_tr_b16 a[204:205], v70 offset:64
    ds_read_b64_tr_b16 a[220:221], v70 offset:96
    ds_read_b64_tr_b16 v[24:25], v70 offset:128
    ds_read_b64_tr_b16 a[236:237], v70 offset:160
    ds_read_b64_tr_b16 v[32:33], v70 offset:192
    ds_read_b64_tr_b16 a[252:253], v70 offset:224
    ds_read_b64_tr_b16 v[40:41], v70 offset:256
    s_waitcnt lgkmcnt(0)
    s_waitcnt vmcnt(0)
    s_barrier
    ds_read_b64_tr_b16 a[190:191], v70 offset:18432
    ds_read_b64_tr_b16 v[18:19], v70 offset:18464
    ds_read_b64_tr_b16 a[206:207], v70 offset:18496
    ds_read_b64_tr_b16 a[222:223], v70 offset:18528
    ds_read_b64_tr_b16 v[26:27], v70 offset:18560
    ds_read_b64_tr_b16 a[238:239], v70 offset:18592
    ds_read_b64_tr_b16 v[34:35], v70 offset:18624
    ds_read_b64_tr_b16 a[254:255], v70 offset:18656
    ds_read_b64_tr_b16 v[42:43], v70 offset:18688
    s_waitcnt lgkmcnt(0)
    s_barrier
    s_lshl_b32 s17, s14, 13
    v_add_u32 v71, s17, v0
    ds_write_b128 v71, v[12:15] offset:24576
    ds_write_b128 v71, v[16:19] offset:25600
    ds_write_b128 v71, v[20:23] offset:26624
    ds_write_b128 v71, v[24:27] offset:27648
    ds_write_b128 v71, v[28:31] offset:28672
    ds_write_b128 v71, v[32:35] offset:29696
    ds_write_b128 v71, v[36:39] offset:30720
    ds_write_b128 v71, v[40:43] offset:31744
    s_waitcnt vmcnt(0) lgkmcnt(0)
    s_barrier
    s_add_u32 s17, s32, s14
    s_cmp_lg_u32 s17, 0
    s_cbranch_scc1 Lr_nold
    v_mov_b32 v63, 48
    v_mov_b32 v64, 1
    s_mov_b64 exec, 1
    global_atomic_add v63, v64, s[12:13]
    s_mov_b64 exec, -1
Lr_nold:
    s_add_u32 s57, s48, 0
    s_add_u32 s58, s48, 98304
    s_add_u32 s59, s48, 196608
    s_add_u32 s60, s48, 294912
    s_mov_b64 exec, 0xff
    v_lshlrev_b32 v12, 5, v8
    v_and_b32 v12, 128, v12
    v_lshrrev_b32 v13, 1, v8
    v_and_or_b32 v12, v13, 12, v12
    s_mov_b32 s16, 0
L_pure:
    global_load_dword v13, v12, s[12:13] sc1
    s_add_u32 s16, s16, 1
    s_cmp_gt_u32 s16, 100000
    s_cbranch_scc1 Lr_abort
    s_mov_b32 s6, 0
    s_waitcnt vmcnt(0)
    v_readlane_b32 s7, v13, 0
    s_nop 0
    s_add_u32 s6, s6, s7
    v_readlane_b32 s7, v13, 1
    s_nop 0
    s_add_u32 s6, s6, s7
    v_readlane_b32 s7, v13, 2
    s_nop 0
    s_add_u32 s6, s6, s7
    v_readlane_b32 s7, v13, 3
    s_nop 0
    s_add_u32 s6, s6, s7
    v_readlane_b32 s7, v13, 4
    s_nop 0
    s_add_u32 s6, s6, s7
    v_readlane_b32 s7, v13, 5
    s_nop 0
    s_add_u32 s6, s6, s7
    v_readlane_b32 s7, v13, 6
    s_nop 0
    s_add_u32 s6, s6, s7
    v_readlane_b32 s7, v13, 7
    s_nop 0
    s_add_u32 s6, s6, s7
    v_readlane_b32 s7, v13, s32
    s_nop 0
    s_cmp_ge_u32 s7, 32
    s_cselect_b32 s55, 1, 0
    s_cselect_b32 s6, 256, s6
    s_cmp_lt_u32 s6, 256
    s_cbranch_scc1 L_pure
    s_mov_b64 exec, -1
    s_lshl_b32 s6, s32, 2
    s_add_u32 s6, s6, 192
    s_cmp_lg_u32 s14, 0
    s_cbranch_scc1 L_team_d
    v_mov_b32 v12, s6
    s_mov_b32 s16, 0
L_team:
    global_load_dword v13, v12, s[12:13] sc1
    s_add_u32 s16, s16, 1
    s_cmp_gt_u32 s16, 100000
    s_cbranch_scc1 Lr_abort
    s_waitcnt vmcnt(0)
    v_cmp_gt_u32 vcc, 32, v13
    s_nop 0
    s_cbranch_vccz L_team_d
    s_sleep 8
    s_branch L_team
L_team_d:
    s_barrier
    s_cmp_lg_u32 s14, 0
    s_cbranch_scc1 L_rpool_d
    v_mov_b32 v12, 160
    s_mov_b32 s16, 0
L_rpool:
    global_load_dword v13, v12, s[12:13] sc1
    s_add_u32 s16, s16, 1
    s_cmp_gt_u32 s16, 100000
    s_cbranch_scc1 Lr_abort
    s_waitcnt vmcnt(0)
    v_cmp_gt_u32 vcc, 123, v13
    s_nop 0
    s_cbranch_vccz L_rpool_d
    s_sleep 8
    s_branch L_rpool
L_rpool_d:
    s_barrier
    s_barrier
    s_cmp_eq_u32 s55, 0
    s_cbranch_scc1 L_slow
    s_cmp_lg_u32 s14, 0
    s_cbranch_scc1 L_w1_1
    s_barrier
    s_mov_b32 m0, 9216
    s_nop 0
    buffer_load_dwordx4 v0, s[8:11], s41 offen offset:0 lds
    buffer_load_dwordx4 v0, s[8:11], s41 offen offset:1024 lds
    s_add_u32 s41, s41, 262144
    s_waitcnt vmcnt(0)
    buffer_load_dwordx4 v[44:47], v0, s[8:11], s34 offen sc1
    buffer_load_dwordx4 v[48:51], v0, s[8:11], s34 offen offset:1024 sc1
    buffer_load_dword v10, v8, s[8:11], s35 offen sc1
    ds_read_b128 v[56:59], v9 offset:0
    ds_read_b128 v[60:63], v9 offset:1024
    ds_read_b128 v[64:67], v9 offset:2048
    ds_read_b128 v[68:71], v9 offset:3072
    v_mov_b64 v[12:13], 0
    v_mov_b64 v[14:15], 0
    v_mov_b64 v[16:17], 0
    v_mov_b64 v[18:19], 0
    v_mov_b64 v[20:21], 0
    v_mov_b64 v[22:23], 0
    v_mov_b64 v[24:25], 0
    v_mov_b64 v[26:27], 0
    v_mov_b64 v[28:29], 0
    v_mov_b64 v[30:31], 0
    v_mov_b64 v[32:33], 0
    v_mov_b64 v[34:35], 0
    s_waitcnt lgkmcnt(0)
Lr0f_step:
    s_mov_b32 s16, 0
    s_mov_b64 s[70:71], 0
    s_mov_b64 s[72:73], 0
    s_mov_b64 s[74:75], 0
Lr0f_p2:
    s_mov_b64 exec, s[70:71]
    buffer_load_dwordx4 v[44:47], v0, s[8:11], s34 offen sc1
    s_mov_b64 exec, s[72:73]
    buffer_load_dwordx4 v[48:51], v0, s[8:11], s34 offen offset:1024 sc1
    s_mov_b64 exec, s[74:75]
    buffer_load_dword v10, v8, s[8:11], s35 offen sc1
    s_mov_b64 exec, -1
    s_add_u32 s16, s16, 1
    s_cmp_gt_u32 s16, 100000
    s_cbranch_scc1 Lr_abort
    s_waitcnt vmcnt(5)
    v_max3_u32 v11, v44, v45, v46
    v_max_u32 v11, v11, v47
    v_cmp_eq_u32 s[70:71], -1, v11
    s_waitcnt vmcnt(4)
    v_max3_u32 v11, v48, v49, v50
    v_max_u32 v11, v11, v51
    v_cmp_eq_u32 s[72:73], -1, v11
    s_waitcnt vmcnt(3)
    v_cmp_eq_u32 s[74:75], -1, v10
    s_or_b64 vcc, s[70:71], s[72:73]
    s_or_b64 vcc, vcc, s[74:75]
    s_cbranch_scc1 Lr0f_p2
    v_smfmac_f32_16x16x64_bf16 v[12:15], v[44:47], v[72:79], v1
    ds_write_b128 v0, v[44:47] offset:0
    v_smfmac_f32_16x16x64_bf16 v[16:19], v[44:47], v[80:87], v1
    ds_write_b128 v0, v[48:51] offset:1024
    v_smfmac_f32_16x16x64_bf16 v[20:23], v[44:47], v[88:95], v1
    ds_write_b32 v8, v10 offset:8192
    v_smfmac_f32_16x16x64_bf16 v[24:27], v[44:47], v[56:63], v1
    s_waitcnt lgkmcnt(0)
    s_barrier
    ds_read_b128 v[52:55], v0 offset:2048
    v_smfmac_f32_16x16x64_bf16 v[12:15], v[48:51], v[112:119], v1
    ds_read_b128 v[36:39], v0 offset:3072
    v_smfmac_f32_16x16x64_bf16 v[16:19], v[48:51], v[120:127], v1
    ds_read_b128 v[56:59], v9 offset:4096
    v_smfmac_f32_16x16x64_bf16 v[20:23], v[48:51], v[128:135], v1
    ds_read_b128 v[60:63], v9 offset:5120
    v_smfmac_f32_16x16x64_bf16 v[24:27], v[48:51], v[64:71], v1
    ds_read_b128 v[40:43], v0 offset:4096
    s_waitcnt lgkmcnt(4)
    v_smfmac_f32_16x16x64_bf16 v[12:15], v[52:55], v[152:159], v1
    v_smfmac_f32_16x16x64_bf16 v[16:19], v[52:55], v[160:167], v1
    ds_read_b128 v[64:67], v9 offset:6144
    v_smfmac_f32_16x16x64_bf16 v[20:23], v[52:55], v[168:175], v1
    ds_read_b128 v[68:71], v9 offset:7168
    s_waitcnt lgkmcnt(3)
    v_smfmac_f32_16x16x64_bf16 v[24:27], v[52:55], v[56:63], v1
    v_smfmac_f32_16x16x64_bf16 v[12:15], v[36:39], v[192:199], v1
    ds_read_b128 v[52:55], v0 offset:5120
    v_smfmac_f32_16x16x64_bf16 v[16:19], v[36:39], v[200:207], v1
    ds_read_b128 v[56:59], v9 offset:8192
    v_smfmac_f32_16x16x64_bf16 v[20:23], v[36:39], v[208:215], v1
    ds_read_b128 v[60:63], v9 offset:9216
    s_waitcnt lgkmcnt(3)
    v_smfmac_f32_16x16x64_bf16 v[24:27], v[36:39], v[64:71], v1
    v_smfmac_f32_16x16x64_bf16 v[12:15], v[40:43], v[232:239], v1
    buffer_load_dwordx4 v[36:39], v0, s[8:11], s42 offen
    v_smfmac_f32_16x16x64_bf16 v[16:19], v[40:43], v[240:247], v1
    ds_read_b128 v[64:67], v9 offset:10240
    v_smfmac_f32_16x16x64_bf16 v[20:23], v[40:43], v[248:255], v1
    ds_read_b128 v[68:71], v9 offset:11264
    s_waitcnt lgkmcnt(2)
    v_smfmac_f32_16x16x64_bf16 v[24:27], v[40:43], v[56:63], v1
    s_waitcnt vmcnt(1)
    ds_read_b128 v[44:47], v0 offset:6144
    v_smfmac_f32_16x16x64_bf16 v[12:15], v[52:55], a[16:23], v1
    buffer_load_dwordx4 v[40:43], v0, s[8:11], s42 offen offset:1024
    v_smfmac_f32_16x16x64_bf16 v[16:19], v[52:55], a[24:31], v1
    ds_read_b128 v[56:59], v9 offset:12288
    v_smfmac_f32_16x16x64_bf16 v[20:23], v[52:55], a[32:39], v1
    ds_read_b128 v[60:63], v9 offset:13312
    s_waitcnt lgkmcnt(3)
    v_smfmac_f32_16x16x64_bf16 v[24:27], v[52:55], v[64:71], v1
    ds_read_b128 v[48:51], v0 offset:7168
    s_waitcnt lgkmcnt(3)
    v_smfmac_f32_16x16x64_bf16 v[12:15], v[44:47], a[56:63], v1
    ds_read_b128 v[52:55], v0 offset:8192
    v_smfmac_f32_16x16x64_bf16 v[16:19], v[44:47], a[64:71], v1
    ds_read_b128 v[64:67], v9 offset:14336
    v_smfmac_f32_16x16x64_bf16 v[20:23], v[44:47], a[72:79], v1
    ds_read_b128 v[68:71], v9 offset:15360
    s_waitcnt lgkmcnt(4)
    v_smfmac_f32_16x16x64_bf16 v[24:27], v[44:47], v[56:63], v1
    s_waitcnt lgkmcnt(3)
    v_smfmac_f32_16x16x64_bf16 v[12:15], v[48:51], a[96:103], v1
    v_smfmac_f32_16x16x64_bf16 v[16:19], v[48:51], a[104:111], v1
    ds_read_b128 v[56:59], v9 offset:16384
    s_waitcnt lgkmcnt(3)
    v_smfmac_f32_16x16x64_bf16 v[12:15], v[52:55], a[136:143], v1
    ds_read_b128 v[60:63], v9 offset:17408
    v_smfmac_f32_16x16x64_bf16 v[16:19], v[52:55], a[144:151], v1
    v_smfmac_f32_16x16x64_bf16 v[20:23], v[48:51], a[112:119], v1
    s_waitcnt lgkmcnt(2)
    v_smfmac_f32_16x16x64_bf16 v[24:27], v[48:51], v[64:71], v1
    ds_read_b128 v[64:67], v0 offset:9216
    s_nop 1
    v_add_f32 v12, v12, v14
    v_smfmac_f32_16x16x64_bf16 v[20:23], v[52:55], a[152:159], v1
    ds_read_b128 v[68:71], v0 offset:10240
    v_add_f32 v16, v16, v18
    s_waitcnt lgkmcnt(2)
    v_smfmac_f32_16x16x64_bf16 v[24:27], v[52:55], v[56:63], v1
    ds_read_b128 v[56:59], v0 offset:11264
    v_add_f32 v13, v13, v15
    v_add_f32 v17, v17, v19
    v_cvt_pk_bf16_f32 v14, v12, v16
    v_cvt_pk_bf16_f32 v15, v13, v17
    ds_write_b32 v2, v14 offset:17408
    ds_write_b32 v2, v15 offset:17696
    v_smfmac_f32_16x16x64_bf16 v[28:31], v[52:55], a[160:167], v1
    ds_read_b128 v[60:63], v0 offset:12288
    v_add_f32 v20, v20, v22
    v_add_f32 v24, v24, v26
    v_add_f32 v21, v21, v23
    v_add_f32 v25, v25, v27
    v_smfmac_f32_16x16x64_bf16 v[32:35], v[52:55], a[168:175], v1
    ds_read_b128 v[12:15], v0 offset:0
    v_cvt_pk_bf16_f32 v22, v20, v24
    v_cvt_pk_bf16_f32 v23, v21, v25
    ds_write_b32 v2, v22 offset:19712
    ds_write_b32 v2, v23 offset:20000
    v_smfmac_f32_16x16x64_bf16 v[28:31], v[48:51], a[120:127], v1
    ds_read_b128 v[16:19], v0 offset:1024
    v_smfmac_f32_16x16x64_bf16 v[32:35], v[48:51], a[128:135], v1
    ds_read_b128 v[20:23], v0 offset:2048
    v_smfmac_f32_16x16x64_bf16 v[28:31], v[44:47], a[80:87], v1
    ds_read_b128 v[24:27], v0 offset:3072
    v_smfmac_f32_16x16x64_bf16 v[32:35], v[44:47], a[88:95], v1
    s_waitcnt lgkmcnt(3)
    s_barrier
    ds_read_b128 v[44:47], v3 offset:17408
    v_smfmac_f32_16x16x64_bf16 v[28:31], v[12:15], v[96:103], v1
    ds_read_b128 v[52:55], v0 offset:4096
    v_smfmac_f32_16x16x64_bf16 v[32:35], v[12:15], v[104:111], v1
    ds_read_b128 v[12:15], v3 offset:19712
    s_waitcnt lgkmcnt(5)
    v_smfmac_f32_16x16x64_bf16 v[28:31], v[16:19], v[136:143], v1
    ds_read_b128 v[48:51], v0 offset:5120
    v_smfmac_f32_16x16x64_bf16 v[32:35], v[16:19], v[144:151], v1
    s_waitcnt lgkmcnt(5)
    v_smfmac_f32_16x16x64_bf16 v[28:31], v[20:23], v[176:183], v1
    v_smfmac_f32_16x16x64_bf16 v[32:35], v[20:23], v[184:191], v1
    ds_read_b128 v[20:23], v3 offset:17472
    s_waitcnt lgkmcnt(5)
    v_smfmac_f32_16x16x64_bf16 v[28:31], v[24:27], v[216:223], v1
    v_smfmac_f32_16x16x64_bf16 v[32:35], v[24:27], v[224:231], v1
    s_waitcnt lgkmcnt(3)
    v_smfmac_f32_16x16x64_bf16 v[28:31], v[52:55], a[0:7], v1
    v_smfmac_f32_16x16x64_bf16 v[32:35], v[52:55], a[8:15], v1
    ds_read_b128 v[52:55], v3 offset:19776
    s_waitcnt lgkmcnt(2)
    v_smfmac_f32_16x16x64_bf16 v[28:31], v[48:51], a[40:47], v1
    v_smfmac_f32_16x16x64_bf16 v[32:35], v[48:51], a[48:55], v1
    ds_read_b128 v[48:51], v3 offset:17536
    v_mfma_f32_16x16x32_bf16 v[24:27], v[12:15], v[44:47], 0
    v_mfma_f32_16x16x32_bf16 v[12:15], v[64:67], v[44:47], 0
    ds_read_b128 v[64:67], v0 offset:13312
    v_mfma_f32_16x16x32_bf16 v[16:19], v[68:71], v[44:47], 0
    ds_read_b128 v[68:71], v0 offset:14336
    s_waitcnt lgkmcnt(3)
    v_mfma_f32_16x16x32_bf16 v[24:27], v[52:55], v[20:23], v[24:27]
    ds_read_b128 v[44:47], v3 offset:19840
    v_add_f32 v28, v28, v30
    v_add_f32 v29, v29, v31
    v_mfma_f32_16x16x32_bf16 v[12:15], v[56:59], v[20:23], v[12:15]
    ds_read_b128 v[52:55], v3 offset:17600
    v_add_f32 v32, v32, v34
    v_add_f32 v33, v33, v35
    v_mfma_f32_16x16x32_bf16 v[16:19], v[60:63], v[20:23], v[16:19]
    ds_read_b128 v[56:59], v0 offset:15360
    v_cvt_pk_bf16_f32 v30, v28, v29
    v_cvt_pk_bf16_f32 v31, v32, v33
    s_waitcnt lgkmcnt(2)
    v_mfma_f32_16x16x32_bf16 v[24:27], v[44:47], v[48:51], v[24:27]
    ds_read_b128 v[20:23], v3 offset:19904
    v_lshrrev_b32 v10, 8, v0
    v_mul_u32_u24 v10, 288, v10
    v_mfma_f32_16x16x32_bf16 v[12:15], v[64:67], v[48:51], v[12:15]
    ds_read_b128 v[60:63], v0 offset:16384
    v_and_b32 v11, 0xf0, v0
    v_add_u32 v10, v10, v11
    v_mfma_f32_16x16x32_bf16 v[16:19], v[68:71], v[48:51], v[16:19]
    ds_read_b128 v[32:35], v10 offset:19712
    v_lshrrev_b32 v11, 1, v0
    v_bfi_b32 v30, 1, s66, v30
    s_waitcnt lgkmcnt(2)
    v_mfma_f32_16x16x32_bf16 v[24:27], v[20:23], v[52:55], v[24:27]
    buffer_store_dwordx2 v[30:31], v11, s[8:11], s43 offen offset:2048 sc1
    v_mov_b32 v49, 0
    v_mov_b32 v50, 0
    v_mfma_f32_16x16x32_bf16 v[12:15], v[56:59], v[52:55], v[12:15]
    v_mov_b64 v[64:65], s[68:69]
    v_mov_b64 v[66:67], s[68:69]
    s_waitcnt lgkmcnt(1)
    v_mfma_f32_16x16x32_bf16 v[16:19], v[60:63], v[52:55], v[16:19]
    s_waitcnt lgkmcnt(0)
    v_bfi_b32 v32, 1, s66, v32
    s_mov_b64 exec, s[52:53]
    buffer_store_dwordx4 v[32:35], v0, s[8:11], s43 offen sc1
    s_mov_b64 exec, -1
    v_max3_f32 v10, v24, v25, v12
    v_max3_f32 v10, v10, v13, v14
    s_nop 0
    v_max3_f32 v10, v10, v15, v16
    v_max3_f32 v10, v10, v17, v18
    v_max_f32 v10, v10, v19
    v_mov_b32 v11, v10
    s_nop 1
    v_permlane32_swap_b32 v10, v11
    v_max_f32 v10, v10, v11
    v_mov_b32 v11, v10
    s_nop 1
    v_permlane16_swap_b32 v10, v11
    v_max_f32 v10, v10, v11
    v_mul_f32 v20, s46, v10
    v_pk_fma_f32 v[24:25], v[24:25], s[46:47], v[20:21] op_sel_hi:[1,1,0] neg_lo:[0,0,1] neg_hi:[0,0,1]
    v_pk_fma_f32 v[12:13], v[12:13], s[46:47], v[20:21] op_sel_hi:[1,1,0] neg_lo:[0,0,1] neg_hi:[0,0,1]
    v_exp_f32 v24, v24
    v_exp_f32 v25, v25
    v_pk_fma_f32 v[14:15], v[14:15], s[46:47], v[20:21] op_sel_hi:[1,1,0] neg_lo:[0,0,1] neg_hi:[0,0,1]
    v_exp_f32 v12, v12
    v_exp_f32 v13, v13
    v_pk_fma_f32 v[16:17], v[16:17], s[46:47], v[20:21] op_sel_hi:[1,1,0] neg_lo:[0,0,1] neg_hi:[0,0,1]
    v_cvt_pk_bf16_f32 v48, v24, v25
    v_exp_f32 v14, v14
    v_pk_fma_f32 v[18:19], v[18:19], s[46:47], v[20:21] op_sel_hi:[1,1,0] neg_lo:[0,0,1] neg_hi:[0,0,1]
    v_cvt_pk_bf16_f32 v51, v24, v25
    v_exp_f32 v15, v15
    v_cvt_pk_bf16_f32 v44, v12, v13
    v_exp_f32 v16, v16
    v_exp_f32 v17, v17
    v_cvt_pk_bf16_f32 v45, v14, v15
    v_exp_f32 v18, v18
    v_exp_f32 v19, v19
    v_cvt_pk_bf16_f32 v46, v16, v17
    v_cvt_pk_bf16_f32 v47, v18, v19
    v_mfma_f32_16x16x16_bf16 v[68:71], v[64:65], v[48:49], 0
    v_mfma_f32_16x16x16_bf16 v[52:55], v[30:31], v[48:49], 0
    v_mfma_f32_16x16x16_bf16 v[56:59], v[30:31], v[50:51], 0
    v_mfma_f32_16x16x32_bf16 v[68:71], v[64:67], v[44:47], v[68:71]
    s_waitcnt vmcnt(3)
    v_mfma_f32_16x16x32_bf16 v[52:55], v[36:39], v[44:47], v[52:55]
    s_waitcnt vmcnt(2)
    v_mfma_f32_16x16x32_bf16 v[56:59], v[40:43], v[44:47], v[56:59]
    ds_read_b128 v[36:39], v0 offset:30720
    ds_read_b128 v[40:43], v0 offset:31744
    ds_read_b128 v[60:63], v9 offset:24576
    s_nop 0
    v_rcp_f32 v10, v68
    s_nop 0
    v_pk_mul_f32 v[52:53], v[52:53], v[10:11] op_sel_hi:[1,0]
    s_nop 0
    v_pk_mul_f32 v[56:57], v[56:57], v[10:11] op_sel_hi:[1,0]
    v_cvt_pk_bf16_f32 v16, v52, v56
    v_cvt_pk_bf16_f32 v17, v53, v57
    v_pk_mul_f32 v[54:55], v[54:55], v[10:11] op_sel_hi:[1,0]
    v_pk_mul_f32 v[58:59], v[58:59], v[10:11] op_sel_hi:[1,0]
    v_cvt_pk_bf16_f32 v18, v54, v58
    v_cvt_pk_bf16_f32 v19, v55, v59
    ds_write_b128 v3, v[16:19] offset:22016
    ds_read_b128 v[64:67], v9 offset:25600
    v_mov_b64 v[12:13], 0
    v_mov_b64 v[14:15], 0
    v_mov_b64 v[20:21], 0
    v_mov_b64 v[22:23], 0
    v_mov_b64 v[24:25], 0
    v_mov_b64 v[26:27], 0
    v_mov_b64 v[32:33], 0
    v_mov_b64 v[34:35], 0
    v_mov_b64 v[44:45], 0
    v_mov_b64 v[46:47], 0
    v_mov_b64 v[48:49], 0
    v_mov_b64 v[50:51], 0
    s_waitcnt lgkmcnt(1)
    s_barrier
    ds_read_b128 v[52:55], v4 offset:22016
    ds_read_b128 v[56:59], v4 offset:22144
    v_mov_b64 v[68:69], 0
    v_mov_b64 v[70:71], 0
    v_mov_b64 v[28:29], 0
    v_mov_b64 v[30:31], 0
    v_mov_b64 v[16:17], 0
    v_mov_b64 v[18:19], 0
    s_cmp_eq_u32 s33, 63
    s_cbranch_scc1 Lr0f_last
    s_waitcnt lgkmcnt(1)
    v_smfmac_f32_16x16x64_bf16 v[28:31], v[52:55], v[60:67], v1
    ds_read_b128 v[60:63], v0 offset:24576
    s_waitcnt lgkmcnt(1)
    v_smfmac_f32_16x16x64_bf16 v[28:31], v[56:59], v[36:43], v1
    ds_read_b128 v[64:67], v0 offset:25600
    ds_read_b128 v[36:39], v9 offset:18432
    v_smfmac_f32_16x16x64_bf16 v[12:15], v[52:55], a[176:183], v1
    ds_read_b128 v[40:43], v9 offset:19456
    v_smfmac_f32_16x16x64_bf16 v[12:15], v[56:59], a[184:191], v1
    buffer_load_dwordx4 v0, s[8:11], s41 offen offset:0 lds
    v_smfmac_f32_16x16x64_bf16 v[20:23], v[52:55], a[192:199], v1
    s_nop 0
    v_add_f32 v28, v28, v30
    v_add_f32 v29, v29, v31
    s_waitcnt lgkmcnt(2)
    v_smfmac_f32_16x16x64_bf16 v[20:23], v[56:59], v[60:67], v1
    ds_read_b128 v[60:63], v9 offset:20480
    v_cvt_pk_bf16_f32 v28, v28, v29
    v_bfi_b32 v28, 1, s39, v28
    buffer_store_dword v28, v8, s[8:11], s38 offen offset:2048
    s_waitcnt lgkmcnt(1)
    v_smfmac_f32_16x16x64_bf16 v[24:27], v[52:55], v[36:43], v1
    ds_read_b128 v[64:67], v9 offset:21504
    ds_read_b128 v[36:39], v0 offset:26624
    v_add_f32 v12, v12, v14
    v_add_f32 v13, v13, v15
    v_smfmac_f32_16x16x64_bf16 v[24:27], v[56:59], a[200:207], v1
    ds_read_b128 v[40:43], v0 offset:27648
    v_cvt_pk_bf16_f32 v12, v12, v13
    v_bfi_b32 v12, 1, s39, v12
    v_smfmac_f32_16x16x64_bf16 v[32:35], v[52:55], a[208:215], v1
    buffer_load_dwordx4 v0, s[8:11], s41 offen offset:1024 lds
    v_add_f32 v20, v20, v22
    v_add_f32 v21, v21, v23
    v_smfmac_f32_16x16x64_bf16 v[32:35], v[56:59], a[216:223], v1
    v_cvt_pk_bf16_f32 v13, v20, v21
    s_waitcnt lgkmcnt(2)
    v_smfmac_f32_16x16x64_bf16 v[44:47], v[52:55], v[60:67], v1
    ds_read_b128 v[60:63], v0 offset:28672
    v_add_f32 v24, v24, v26
    v_add_f32 v25, v25, v27
    s_waitcnt lgkmcnt(1)
    v_smfmac_f32_16x16x64_bf16 v[44:47], v[56:59], v[36:43], v1
    ds_read_b128 v[64:67], v0 offset:29696
    ds_read_b128 v[36:39], v9 offset:22528
    v_cvt_pk_bf16_f32 v14, v24, v25
    v_smfmac_f32_16x16x64_bf16 v[48:51], v[52:55], a[224:231], v1
    ds_read_b128 v[40:43], v9 offset:23552
    v_add_f32 v32, v32, v34
    v_add_f32 v33, v33, v35
    v_smfmac_f32_16x16x64_bf16 v[48:51], v[56:59], a[232:239], v1
    v_cvt_pk_bf16_f32 v15, v32, v33
    buffer_store_dwordx4 v[12:15], v0, s[8:11], s38 offen offset:0
    v_smfmac_f32_16x16x64_bf16 v[68:71], v[52:55], a[240:247], v1
    v_add_f32 v44, v44, v46
    v_add_f32 v45, v45, v47
    s_waitcnt lgkmcnt(2)
    v_smfmac_f32_16x16x64_bf16 v[68:71], v[56:59], v[60:67], v1
    v_cvt_pk_bf16_f32 v44, v44, v45
    v_bfi_b32 v44, 1, s39, v44
    s_waitcnt lgkmcnt(0)
    v_smfmac_f32_16x16x64_bf16 v[16:19], v[52:55], v[36:43], v1
    v_add_f32 v48, v48, v50
    v_add_f32 v49, v49, v51
    v_smfmac_f32_16x16x64_bf16 v[16:19], v[56:59], a[248:255], v1
    v_cvt_pk_bf16_f32 v45, v48, v49
    v_add_f32 v68, v68, v70
    v_add_f32 v69, v69, v71
    v_cvt_pk_bf16_f32 v46, v68, v69
    s_nop 3
    v_add_f32 v16, v16, v18
    v_add_f32 v17, v17, v19
    v_cvt_pk_bf16_f32 v47, v16, v17
    buffer_store_dwordx4 v[44:47], v0, s[8:11], s38 offen offset:1024
    s_sleep 6
    buffer_load_dwordx4 v[52:55], v6, s[8:11], s57 offen sc1
    buffer_load_dwordx4 v[56:59], v6, s[8:11], s58 offen sc1
    buffer_load_dwordx4 v[60:63], v6, s[8:11], s59 offen sc1
    buffer_load_dwordx4 v[64:67], v6, s[8:11], s60 offen sc1
    v_bfe_u32 v10, v0, 4, 4
    v_mov_b32 v11, 0x3f80
    v_mov_b32 v40, 0x3f800000
    v_cmp_eq_u32 vcc, 0, v10
    v_cmp_eq_u32 s[48:49], 1, v10
    s_nop 0
    v_cndmask_b32 v36, 0, v11, vcc
    v_cndmask_b32 v36, v36, v40, s[48:49]
    v_cmp_eq_u32 vcc, 2, v10
    v_cmp_eq_u32 s[48:49], 3, v10
    s_nop 0
    v_cndmask_b32 v37, 0, v11, vcc
    v_cndmask_b32 v37, v37, v40, s[48:49]
    v_cmp_eq_u32 vcc, 4, v10
    v_cmp_eq_u32 s[48:49], 5, v10
    s_nop 0
    v_cndmask_b32 v38, 0, v11, vcc
    v_cndmask_b32 v38, v38, v40, s[48:49]
    v_cmp_eq_u32 vcc, 6, v10
    v_cmp_eq_u32 s[48:49], 7, v10
    s_nop 0
    v_cndmask_b32 v39, 0, v11, vcc
    v_cndmask_b32 v39, v39, v40, s[48:49]
    s_mov_b32 s16, 0
    s_mov_b64 s[70:71], 0
    s_mov_b64 s[72:73], 0
    s_mov_b64 s[74:75], 0
    s_mov_b64 s[76:77], 0
Lr0f_p1:
    s_mov_b64 exec, s[70:71]
    buffer_load_dwordx4 v[52:55], v6, s[8:11], s57 offen sc1
    s_mov_b64 exec, s[72:73]
    buffer_load_dwordx4 v[56:59], v6, s[8:11], s58 offen sc1
    s_mov_b64 exec, s[74:75]
    buffer_load_dwordx4 v[60:63], v6, s[8:11], s59 offen sc1
    s_mov_b64 exec, s[76:77]
    buffer_load_dwordx4 v[64:67], v6, s[8:11], s60 offen sc1
    s_mov_b64 exec, -1
    s_add_u32 s16, s16, 1
    s_cmp_gt_u32 s16, 100000
    s_cbranch_scc1 Lr_abort
    s_waitcnt vmcnt(7)
    v_and_b32 v11, 1, v52
    v_cmp_ne_u32 s[70:71], s39, v11
    v_mfma_f32_16x16x32_bf16 v[40:43], v[52:55], v[36:39], 0
    s_waitcnt vmcnt(6)
    v_and_b32 v11, 1, v56
    v_cmp_ne_u32 s[72:73], s39, v11
    v_mfma_f32_16x16x32_bf16 v[40:43], v[56:59], v[36:39], v[40:43]
    s_waitcnt vmcnt(5)
    v_and_b32 v11, 1, v60
    v_cmp_ne_u32 s[74:75], s39, v11
    v_mfma_f32_16x16x32_bf16 v[40:43], v[60:63], v[36:39], v[40:43]
    s_or_b64 vcc, s[70:71], s[72:73]
    s_waitcnt vmcnt(4)
    v_and_b32 v11, 1, v64
    v_cmp_ne_u32 s[76:77], s39, v11
    v_mfma_f32_16x16x32_bf16 v[40:43], v[64:67], v[36:39], v[40:43]
    s_or_b64 vcc, vcc, s[74:75]
    s_or_b64 vcc, vcc, s[76:77]
    s_cbranch_scc1 Lr0f_p1
    s_nop 4
    v_permlane16_swap_b32 v40, v42
    v_permlane16_swap_b32 v41, v43
    s_mov_b64 exec, s[50:51]
    v_add_f32 v40, v40, v42
    v_add_f32 v41, v41, v43
    v_cvt_pk_bf16_f32 v40, v40, v41
    v_min_u32 v40, s54, v40
    buffer_store_dword v40, v7, s[8:11], s36 offen
    v_mov_b32 v41, -1
    buffer_store_dword v41, v7, s[8:11], s37 offen
    s_mov_b64 exec, -1
    s_xor_b32 s34, s34, 16384
    s_xor_b32 s35, s35, 16384
    s_barrier
    s_sleep 2
    buffer_load_dwordx4 v[44:47], v0, s[8:11], s34 offen sc1
    buffer_load_dwordx4 v[48:51], v0, s[8:11], s34 offen offset:1024 sc1
    buffer_load_dword v10, v8, s[8:11], s35 offen sc1
    s_add_u32 s33, s33, 1
    s_bfe_u32 s39, s33, 0x10001
    s_xor_b32 s38, s38, 524288
    s_xor_b32 s57, s57, 524288
    s_xor_b32 s58, s58, 524288
    s_xor_b32 s59, s59, 524288
    s_xor_b32 s60, s60, 524288
    s_xor_b32 s36, s36, 16384
    s_xor_b32 s37, s37, 16384
    s_and_b32 s17, s33, 7
    s_mul_i32 s17, s17, 131072
    s_add_u32 s43, s45, s17
    s_bfe_u32 s66, s33, 65539
    s_add_u32 s67, s67, 22528
    s_add_u32 s42, s42, 262144
    s_add_u32 s41, s41, 262144
    s_add_u32 s40, s40, 262144
    s_add_u32 s44, s44, 22528
    s_waitcnt vmcnt(5)
    ds_read_b128 v[56:59], v9 offset:0
    ds_read_b128 v[60:63], v9 offset:1024
    ds_read_b128 v[64:67], v9 offset:2048
    ds_read_b128 v[68:71], v9 offset:3072
    v_mov_b64 v[12:13], 0
    v_mov_b64 v[14:15], 0
    v_mov_b64 v[16:17], 0
    v_mov_b64 v[18:19], 0
    v_mov_b64 v[20:21], 0
    v_mov_b64 v[22:23], 0
    v_mov_b64 v[24:25], 0
    v_mov_b64 v[26:27], 0
    v_mov_b64 v[28:29], 0
    v_mov_b64 v[30:31], 0
    v_mov_b64 v[32:33], 0
    v_mov_b64 v[34:35], 0
    s_waitcnt lgkmcnt(0)
    s_branch Lr0f_step
Lr0f_last:
    s_waitcnt vmcnt(0) lgkmcnt(0)
    s_branch Lr_exit
L_w1_1:
    s_cmp_lg_u32 s14, 1
    s_cbranch_scc1 L_w2_1
    s_barrier
    s_mov_b32 m0, 11264
    s_nop 0
    buffer_load_dwordx4 v0, s[8:11], s41 offen offset:0 lds
    buffer_load_dwordx4 v0, s[8:11], s41 offen offset:1024 lds
    s_add_u32 s41, s41, 262144
    s_waitcnt vmcnt(0)
    buffer_load_dwordx4 v[44:47], v0, s[8:11], s34 offen sc1
    buffer_load_dwordx4 v[48:51], v0, s[8:11], s34 offen offset:1024 sc1
    buffer_load_dword v10, v8, s[8:11], s35 offen sc1
    ds_read_b128 v[56:59], v9 offset:4096
    ds_read_b128 v[60:63], v9 offset:5120
    ds_read_b128 v[64:67], v9 offset:6144
    ds_read_b128 v[68:71], v9 offset:7168
    v_mov_b64 v[12:13], 0
    v_mov_b64 v[14:15], 0
    v_mov_b64 v[16:17], 0
    v_mov_b64 v[18:19], 0
    v_mov_b64 v[20:21], 0
    v_mov_b64 v[22:23], 0
    v_mov_b64 v[24:25], 0
    v_mov_b64 v[26:27], 0
    v_mov_b64 v[28:29], 0
    v_mov_b64 v[30:31], 0
    v_mov_b64 v[32:33], 0
    v_mov_b64 v[34:35], 0
    s_waitcnt lgkmcnt(0)
Lr1f_step:
    s_mov_b32 s16, 0
    s_mov_b64 s[70:71], 0
    s_mov_b64 s[72:73], 0
    s_mov_b64 s[74:75], 0
Lr1f_p2:
    s_mov_b64 exec, s[70:71]
    buffer_load_dwordx4 v[44:47], v0, s[8:11], s34 offen sc1
    s_mov_b64 exec, s[72:73]
    buffer_load_dwordx4 v[48:51], v0, s[8:11], s34 offen offset:1024 sc1
    s_mov_b64 exec, s[74:75]
    buffer_load_dword v10, v8, s[8:11], s35 offen sc1
    s_mov_b64 exec, -1
    s_add_u32 s16, s16, 1
    s_cmp_gt_u32 s16, 100000
    s_cbranch_scc1 Lr_abort
    s_waitcnt vmcnt(5)
    v_max3_u32 v11, v44, v45, v46
    v_max_u32 v11, v11, v47
    v_cmp_eq_u32 s[70:71], -1, v11
    s_waitcnt vmcnt(4)
    v_max3_u32 v11, v48, v49, v50
    v_max_u32 v11, v11, v51
    v_cmp_eq_u32 s[72:73], -1, v11
    s_waitcnt vmcnt(3)
    v_cmp_eq_u32 s[74:75], -1, v10
    s_or_b64 vcc, s[70:71], s[72:73]
    s_or_b64 vcc, vcc, s[74:75]
    s_cbranch_scc1 Lr1f_p2
    v_smfmac_f32_16x16x64_bf16 v[12:15], v[44:47], v[152:159], v1
    ds_write_b128 v0, v[44:47] offset:2048
    v_smfmac_f32_16x16x64_bf16 v[16:19], v[44:47], v[160:167], v1
    ds_write_b128 v0, v[48:51] offset:3072
    v_smfmac_f32_16x16x64_bf16 v[20:23], v[44:47], v[168:175], v1
    ds_write_b32 v8, v10 offset:8448
    v_smfmac_f32_16x16x64_bf16 v[24:27], v[44:47], v[56:63], v1
    s_waitcnt lgkmcnt(0)
    s_barrier
    ds_read_b128 v[52:55], v0 offset:0
    v_smfmac_f32_16x16x64_bf16 v[12:15], v[48:51], v[192:199], v1
    ds_read_b128 v[36:39], v0 offset:1024
    v_smfmac_f32_16x16x64_bf16 v[16:19], v[48:51], v[200:207], v1
    ds_read_b128 v[56:59], v9 offset:0
    v_smfmac_f32_16x16x64_bf16 v[20:23], v[48:51], v[208:215], v1
    ds_read_b128 v[60:63], v9 offset:1024
    v_smfmac_f32_16x16x64_bf16 v[24:27], v[48:51], v[64:71], v1
    ds_read_b128 v[40:43], v0 offset:4096
    s_waitcnt lgkmcnt(4)
    v_smfmac_f32_16x16x64_bf16 v[12:15], v[52:55], v[72:79], v1
    v_smfmac_f32_16x16x64_bf16 v[16:19], v[52:55], v[80:87], v1
    ds_read_b128 v[64:67], v9 offset:2048
    v_smfmac_f32_16x16x64_bf16 v[20:23], v[52:55], v[88:95], v1
    ds_read_b128 v[68:71], v9 offset:3072
    s_waitcnt lgkmcnt(3)
    v_smfmac_f32_16x16x64_bf16 v[24:27], v[52:55], v[56:63], v1
    v_smfmac_f32_16x16x64_bf16 v[12:15], v[36:39], v[112:119], v1
    ds_read_b128 v[52:55], v0 offset:5120
    v_smfmac_f32_16x16x64_bf16 v[16:19], v[36:39], v[120:127], v1
    ds_read_b128 v[56:59], v9 offset:8192
    v_smfmac_f32_16x16x64_bf16 v[20:23], v[36:39], v[128:135], v1
    ds_read_b128 v[60:63], v9 offset:9216
    s_waitcnt lgkmcnt(3)
    v_smfmac_f32_16x16x64_bf16 v[24:27], v[36:39], v[64:71], v1
    v_smfmac_f32_16x16x64_bf16 v[12:15], v[40:43], v[232:239], v1
    buffer_load_dwordx4 v[36:39], v0, s[8:11], s42 offen
    v_smfmac_f32_16x16x64_bf16 v[16:19], v[40:43], v[240:247], v1
    ds_read_b128 v[64:67], v9 offset:10240
    v_smfmac_f32_16x16x64_bf16 v[20:23], v[40:43], v[248:255], v1
    ds_read_b128 v[68:71], v9 offset:11264
    s_waitcnt lgkmcnt(2)
    v_smfmac_f32_16x16x64_bf16 v[24:27], v[40:43], v[56:63], v1
    s_waitcnt vmcnt(1)
    ds_read_b128 v[44:47], v0 offset:6144
    v_smfmac_f32_16x16x64_bf16 v[12:15], v[52:55], a[16:23], v1
    buffer_load_dwordx4 v[40:43], v0, s[8:11], s42 offen offset:1024
    v_smfmac_f32_16x16x64_bf16 v[16:19], v[52:55], a[24:31], v1
    ds_read_b128 v[56:59], v9 offset:12288
    v_smfmac_f32_16x16x64_bf16 v[20:23], v[52:55], a[32:39], v1
    ds_read_b128 v[60:63], v9 offset:13312
    s_waitcnt lgkmcnt(3)
    v_smfmac_f32_16x16x64_bf16 v[24:27], v[52:55], v[64:71], v1
    ds_read_b128 v[48:51], v0 offset:7168
    s_waitcnt lgkmcnt(3)
    v_smfmac_f32_16x16x64_bf16 v[12:15], v[44:47], a[56:63], v1
    ds_read_b128 v[52:55], v0 offset:8192
    v_smfmac_f32_16x16x64_bf16 v[16:19], v[44:47], a[64:71], v1
    ds_read_b128 v[64:67], v9 offset:14336
    v_smfmac_f32_16x16x64_bf16 v[20:23], v[44:47], a[72:79], v1
    ds_read_b128 v[68:71], v9 offset:15360
    s_waitcnt lgkmcnt(4)
    v_smfmac_f32_16x16x64_bf16 v[24:27], v[44:47], v[56:63], v1
    s_waitcnt lgkmcnt(3)
    v_smfmac_f32_16x16x64_bf16 v[12:15], v[48:51], a[96:103], v1
    v_smfmac_f32_16x16x64_bf16 v[16:19], v[48:51], a[104:111], v1
    ds_read_b128 v[56:59], v9 offset:16384
    s_waitcnt lgkmcnt(3)
    v_smfmac_f32_16x16x64_bf16 v[12:15], v[52:55], a[136:143], v1
    ds_read_b128 v[60:63], v9 offset:17408
    v_smfmac_f32_16x16x64_bf16 v[16:19], v[52:55], a[144:151], v1
    v_smfmac_f32_16x16x64_bf16 v[20:23], v[48:51], a[112:119], v1
    s_waitcnt lgkmcnt(2)
    v_smfmac_f32_16x16x64_bf16 v[24:27], v[48:51], v[64:71], v1
    ds_read_b128 v[64:67], v0 offset:9216
    s_nop 1
    v_add_f32 v12, v12, v14
    v_smfmac_f32_16x16x64_bf16 v[20:23], v[52:55], a[152:159], v1
    ds_read_b128 v[68:71], v0 offset:10240
    v_add_f32 v16, v16, v18
    s_waitcnt lgkmcnt(2)
    v_smfmac_f32_16x16x64_bf16 v[24:27], v[52:55], v[56:63], v1
    ds_read_b128 v[56:59], v0 offset:11264
    v_add_f32 v13, v13, v15
    v_add_f32 v17, v17, v19
    v_cvt_pk_bf16_f32 v14, v12, v16
    v_cvt_pk_bf16_f32 v15, v13, v17
    ds_write_b32 v2, v14 offset:17408
    ds_write_b32 v2, v15 offset:17696
    v_smfmac_f32_16x16x64_bf16 v[28:31], v[52:55], a[160:167], v1
    ds_read_b128 v[60:63], v0 offset:12288
    v_add_f32 v20, v20, v22
    v_add_f32 v24, v24, v26
    v_add_f32 v21, v21, v23
    v_add_f32 v25, v25, v27
    v_smfmac_f32_16x16x64_bf16 v[32:35], v[52:55], a[168:175], v1
    ds_read_b128 v[12:15], v0 offset:2048
    v_cvt_pk_bf16_f32 v22, v20, v24
    v_cvt_pk_bf16_f32 v23, v21, v25
    ds_write_b32 v2, v22 offset:19712
    ds_write_b32 v2, v23 offset:20000
    v_smfmac_f32_16x16x64_bf16 v[28:31], v[48:51], a[120:127], v1
    ds_read_b128 v[16:19], v0 offset:3072
    v_smfmac_f32_16x16x64_bf16 v[32:35], v[48:51], a[128:135], v1
    ds_read_b128 v[20:23], v0 offset:0
    v_smfmac_f32_16x16x64_bf16 v[28:31], v[44:47], a[80:87], v1
    ds_read_b128 v[24:27], v0 offset:1024
    v_smfmac_f32_16x16x64_bf16 v[32:35], v[44:47], a[88:95], v1
    s_waitcnt lgkmcnt(3)
    s_barrier
    ds_read_b128 v[44:47], v3 offset:17408
    v_smfmac_f32_16x16x64_bf16 v[28:31], v[12:15], v[176:183], v1
    ds_read_b128 v[52:55], v0 offset:4096
    v_smfmac_f32_16x16x64_bf16 v[32:35], v[12:15], v[184:191], v1
    ds_read_b128 v[12:15], v3 offset:19712
    s_waitcnt lgkmcnt(5)
    v_smfmac_f32_16x16x64_bf16 v[28:31], v[16:19], v[216:223], v1
    ds_read_b128 v[48:51], v0 offset:5120
    v_smfmac_f32_16x16x64_bf16 v[32:35], v[16:19], v[224:231], v1
    s_waitcnt lgkmcnt(5)
    v_smfmac_f32_16x16x64_bf16 v[28:31], v[20:23], v[96:103], v1
    v_smfmac_f32_16x16x64_bf16 v[32:35], v[20:23], v[104:111], v1
    ds_read_b128 v[20:23], v3 offset:17472
    s_waitcnt lgkmcnt(5)
    v_smfmac_f32_16x16x64_bf16 v[28:31], v[24:27], v[136:143], v1
    v_smfmac_f32_16x16x64_bf16 v[32:35], v[24:27], v[144:151], v1
    s_waitcnt lgkmcnt(3)
    v_smfmac_f32_16x16x64_bf16 v[28:31], v[52:55], a[0:7], v1
    v_smfmac_f32_16x16x64_bf16 v[32:35], v[52:55], a[8:15], v1
    ds_read_b128 v[52:55], v3 offset:19776
    s_waitcnt lgkmcnt(2)
    v_smfmac_f32_16x16x64_bf16 v[28:31], v[48:51], a[40:47], v1
    v_smfmac_f32_16x16x64_bf16 v[32:35], v[48:51], a[48:55], v1
    ds_read_b128 v[48:51], v3 offset:17536
    v_mfma_f32_16x16x32_bf16 v[24:27], v[12:15], v[44:47], 0
    v_mfma_f32_16x16x32_bf16 v[12:15], v[64:67], v[44:47], 0
    ds_read_b128 v[64:67], v0 offset:13312
    v_mfma_f32_16x16x32_bf16 v[16:19], v[68:71], v[44:47], 0
    ds_read_b128 v[68:71], v0 offset:14336
    s_waitcnt lgkmcnt(3)
    v_mfma_f32_16x16x32_bf16 v[24:27], v[52:55], v[20:23], v[24:27]
    ds_read_b128 v[44:47], v3 offset:19840
    v_add_f32 v28, v28, v30
    v_add_f32 v29, v29, v31
    v_mfma_f32_16x16x32_bf16 v[12:15], v[56:59], v[20:23], v[12:15]
    ds_read_b128 v[52:55], v3 offset:17600
    v_add_f32 v32, v32, v34
    v_add_f32 v33, v33, v35
    v_mfma_f32_16x16x32_bf16 v[16:19], v[60:63], v[20:23], v[16:19]
    ds_read_b128 v[56:59], v0 offset:15360
    v_cvt_pk_bf16_f32 v30, v28, v29
    v_cvt_pk_bf16_f32 v31, v32, v33
    s_waitcnt lgkmcnt(2)
    v_mfma_f32_16x16x32_bf16 v[24:27], v[44:47], v[48:51], v[24:27]
    ds_read_b128 v[20:23], v3 offset:19904
    v_lshrrev_b32 v10, 8, v0
    v_mul_u32_u24 v10, 288, v10
    v_mfma_f32_16x16x32_bf16 v[12:15], v[64:67], v[48:51], v[12:15]
    ds_read_b128 v[60:63], v0 offset:16384
    v_and_b32 v11, 0xf0, v0
    v_add_u32 v10, v10, v11
    v_mfma_f32_16x16x32_bf16 v[16:19], v[68:71], v[48:51], v[16:19]
    ds_read_b128 v[32:35], v10 offset:20288
    v_lshrrev_b32 v11, 1, v0
    v_bfi_b32 v30, 1, s66, v30
    s_waitcnt lgkmcnt(2)
    v_mfma_f32_16x16x32_bf16 v[24:27], v[20:23], v[52:55], v[24:27]
    buffer_store_dwordx2 v[30:31], v11, s[8:11], s43 offen offset:2048 sc1
    v_mov_b32 v49, 0
    v_mov_b32 v50, 0
    v_mfma_f32_16x16x32_bf16 v[12:15], v[56:59], v[52:55], v[12:15]
    v_mov_b64 v[64:65], s[68:69]
    v_mov_b64 v[66:67], s[68:69]
    s_waitcnt lgkmcnt(1)
    v_mfma_f32_16x16x32_bf16 v[16:19], v[60:63], v[52:55], v[16:19]
    s_waitcnt lgkmcnt(0)
    v_bfi_b32 v32, 1, s66, v32
    s_mov_b64 exec, s[52:53]
    buffer_store_dwordx4 v[32:35], v0, s[8:11], s43 offen sc1
    s_mov_b64 exec, -1
    v_max3_f32 v10, v24, v25, v12
    v_max3_f32 v10, v10, v13, v14
    s_nop 0
    v_max3_f32 v10, v10, v15, v16
    v_max3_f32 v10, v10, v17, v18
    v_max_f32 v10, v10, v19
    v_mov_b32 v11, v10
    s_nop 1
    v_permlane32_swap_b32 v10, v11
    v_max_f32 v10, v10, v11
    v_mov_b32 v11, v10
    s_nop 1
    v_permlane16_swap_b32 v10, v11
    v_max_f32 v10, v10, v11
    v_mul_f32 v20, s46, v10
    v_pk_fma_f32 v[24:25], v[24:25], s[46:47], v[20:21] op_sel_hi:[1,1,0] neg_lo:[0,0,1] neg_hi:[0,0,1]
    v_pk_fma_f32 v[12:13], v[12:13], s[46:47], v[20:21] op_sel_hi:[1,1,0] neg_lo:[0,0,1] neg_hi:[0,0,1]
    v_exp_f32 v24, v24
    v_exp_f32 v25, v25
    v_pk_fma_f32 v[14:15], v[14:15], s[46:47], v[20:21] op_sel_hi:[1,1,0] neg_lo:[0,0,1] neg_hi:[0,0,1]
    v_exp_f32 v12, v12
    v_exp_f32 v13, v13
    v_pk_fma_f32 v[16:17], v[16:17], s[46:47], v[20:21] op_sel_hi:[1,1,0] neg_lo:[0,0,1] neg_hi:[0,0,1]
    v_cvt_pk_bf16_f32 v48, v24, v25
    v_exp_f32 v14, v14
    v_pk_fma_f32 v[18:19], v[18:19], s[46:47], v[20:21] op_sel_hi:[1,1,0] neg_lo:[0,0,1] neg_hi:[0,0,1]
    v_cvt_pk_bf16_f32 v51, v24, v25
    v_exp_f32 v15, v15
    v_cvt_pk_bf16_f32 v44, v12, v13
    v_exp_f32 v16, v16
    v_exp_f32 v17, v17
    v_cvt_pk_bf16_f32 v45, v14, v15
    v_exp_f32 v18, v18
    v_exp_f32 v19, v19
    v_cvt_pk_bf16_f32 v46, v16, v17
    v_cvt_pk_bf16_f32 v47, v18, v19
    v_mfma_f32_16x16x16_bf16 v[68:71], v[64:65], v[48:49], 0
    v_mfma_f32_16x16x16_bf16 v[52:55], v[30:31], v[48:49], 0
    v_mfma_f32_16x16x16_bf16 v[56:59], v[30:31], v[50:51], 0
    v_mfma_f32_16x16x32_bf16 v[68:71], v[64:67], v[44:47], v[68:71]
    s_waitcnt vmcnt(3)
    v_mfma_f32_16x16x32_bf16 v[52:55], v[36:39], v[44:47], v[52:55]
    s_waitcnt vmcnt(2)
    v_mfma_f32_16x16x32_bf16 v[56:59], v[40:43], v[44:47], v[56:59]
    ds_read_b128 v[36:39], v0 offset:38912
    ds_read_b128 v[40:43], v0 offset:39936
    ds_read_b128 v[60:63], v9 offset:24576
    s_nop 0
    v_rcp_f32 v10, v68
    s_nop 0
    v_pk_mul_f32 v[52:53], v[52:53], v[10:11] op_sel_hi:[1,0]
    s_nop 0
    v_pk_mul_f32 v[56:57], v[56:57], v[10:11] op_sel_hi:[1,0]
    v_cvt_pk_bf16_f32 v16, v52, v56
    v_cvt_pk_bf16_f32 v17, v53, v57
    v_pk_mul_f32 v[54:55], v[54:55], v[10:11] op_sel_hi:[1,0]
    v_pk_mul_f32 v[58:59], v[58:59], v[10:11] op_sel_hi:[1,0]
    v_cvt_pk_bf16_f32 v18, v54, v58
    v_cvt_pk_bf16_f32 v19, v55, v59
    ds_write_b128 v3, v[16:19] offset:22080
    ds_read_b128 v[64:67], v9 offset:25600
    v_mov_b64 v[12:13], 0
    v_mov_b64 v[14:15], 0
    v_mov_b64 v[20:21], 0
    v_mov_b64 v[22:23], 0
    v_mov_b64 v[24:25], 0
    v_mov_b64 v[26:27], 0
    v_mov_b64 v[32:33], 0
    v_mov_b64 v[34:35], 0
    v_mov_b64 v[44:45], 0
    v_mov_b64 v[46:47], 0
    v_mov_b64 v[48:49], 0
    v_mov_b64 v[50:51], 0
    s_waitcnt lgkmcnt(1)
    s_barrier
    ds_read_b128 v[52:55], v4 offset:22016
    ds_read_b128 v[56:59], v4 offset:22144
    v_mov_b64 v[68:69], 0
    v_mov_b64 v[70:71], 0
    v_mov_b64 v[28:29], 0
    v_mov_b64 v[30:31], 0
    v_mov_b64 v[16:17], 0
    v_mov_b64 v[18:19], 0
    s_cmp_eq_u32 s33, 63
    s_cbranch_scc1 Lr1f_last
    s_waitcnt lgkmcnt(1)
    v_smfmac_f32_16x16x64_bf16 v[28:31], v[52:55], v[60:67], v1
    ds_read_b128 v[60:63], v0 offset:32768
    s_waitcnt lgkmcnt(1)
    v_smfmac_f32_16x16x64_bf16 v[28:31], v[56:59], v[36:43], v1
    ds_read_b128 v[64:67], v0 offset:33792
    ds_read_b128 v[36:39], v9 offset:18432
    v_smfmac_f32_16x16x64_bf16 v[12:15], v[52:55], a[176:183], v1
    ds_read_b128 v[40:43], v9 offset:19456
    v_smfmac_f32_16x16x64_bf16 v[12:15], v[56:59], a[184:191], v1
    buffer_load_dwordx4 v0, s[8:11], s41 offen offset:0 lds
    v_smfmac_f32_16x16x64_bf16 v[20:23], v[52:55], a[192:199], v1
    s_nop 0
    v_add_f32 v28, v28, v30
    v_add_f32 v29, v29, v31
    s_waitcnt lgkmcnt(2)
    v_smfmac_f32_16x16x64_bf16 v[20:23], v[56:59], v[60:67], v1
    ds_read_b128 v[60:63], v9 offset:20480
    v_cvt_pk_bf16_f32 v28, v28, v29
    v_bfi_b32 v28, 1, s39, v28
    buffer_store_dword v28, v8, s[8:11], s38 offen offset:2048
    s_waitcnt lgkmcnt(1)
    v_smfmac_f32_16x16x64_bf16 v[24:27], v[52:55], v[36:43], v1
    ds_read_b128 v[64:67], v9 offset:21504
    ds_read_b128 v[36:39], v0 offset:34816
    v_add_f32 v12, v12, v14
    v_add_f32 v13, v13, v15
    v_smfmac_f32_16x16x64_bf16 v[24:27], v[56:59], a[200:207], v1
    ds_read_b128 v[40:43], v0 offset:35840
    v_cvt_pk_bf16_f32 v12, v12, v13
    v_bfi_b32 v12, 1, s39, v12
    v_smfmac_f32_16x16x64_bf16 v[32:35], v[52:55], a[208:215], v1
    buffer_load_dwordx4 v0, s[8:11], s41 offen offset:1024 lds
    v_add_f32 v20, v20, v22
    v_add_f32 v21, v21, v23
    v_smfmac_f32_16x16x64_bf16 v[32:35], v[56:59], a[216:223], v1
    v_cvt_pk_bf16_f32 v13, v20, v21
    s_waitcnt lgkmcnt(2)
    v_smfmac_f32_16x16x64_bf16 v[44:47], v[52:55], v[60:67], v1
    ds_read_b128 v[60:63], v0 offset:36864
    v_add_f32 v24, v24, v26
    v_add_f32 v25, v25, v27
    s_waitcnt lgkmcnt(1)
    v_smfmac_f32_16x16x64_bf16 v[44:47], v[56:59], v[36:43], v1
    ds_read_b128 v[64:67], v0 offset:37888
    ds_read_b128 v[36:39], v9 offset:22528
    v_cvt_pk_bf16_f32 v14, v24, v25
    v_smfmac_f32_16x16x64_bf16 v[48:51], v[52:55], a[224:231], v1
    ds_read_b128 v[40:43], v9 offset:23552
    v_add_f32 v32, v32, v34
    v_add_f32 v33, v33, v35
    v_smfmac_f32_16x16x64_bf16 v[48:51], v[56:59], a[232:239], v1
    v_cvt_pk_bf16_f32 v15, v32, v33
    buffer_store_dwordx4 v[12:15], v0, s[8:11], s38 offen offset:0
    v_smfmac_f32_16x16x64_bf16 v[68:71], v[52:55], a[240:247], v1
    v_add_f32 v44, v44, v46
    v_add_f32 v45, v45, v47
    s_waitcnt lgkmcnt(2)
    v_smfmac_f32_16x16x64_bf16 v[68:71], v[56:59], v[60:67], v1
    v_cvt_pk_bf16_f32 v44, v44, v45
    v_bfi_b32 v44, 1, s39, v44
    s_waitcnt lgkmcnt(0)
    v_smfmac_f32_16x16x64_bf16 v[16:19], v[52:55], v[36:43], v1
    v_add_f32 v48, v48, v50
    v_add_f32 v49, v49, v51
    v_smfmac_f32_16x16x64_bf16 v[16:19], v[56:59], a[248:255], v1
    v_cvt_pk_bf16_f32 v45, v48, v49
    v_add_f32 v68, v68, v70
    v_add_f32 v69, v69, v71
    v_cvt_pk_bf16_f32 v46, v68, v69
    s_nop 3
    v_add_f32 v16, v16, v18
    v_add_f32 v17, v17, v19
    v_cvt_pk_bf16_f32 v47, v16, v17
    buffer_store_dwordx4 v[44:47], v0, s[8:11], s38 offen offset:1024
    s_sleep 6
    buffer_load_dwordx4 v[52:55], v6, s[8:11], s57 offen sc1
    buffer_load_dwordx4 v[56:59], v6, s[8:11], s58 offen sc1
    buffer_load_dwordx4 v[60:63], v6, s[8:11], s59 offen sc1
    buffer_load_dwordx4 v[64:67], v6, s[8:11], s60 offen sc1
    v_bfe_u32 v10, v0, 4, 4
    v_mov_b32 v11, 0x3f80
    v_mov_b32 v40, 0x3f800000
    v_cmp_eq_u32 vcc, 0, v10
    v_cmp_eq_u32 s[48:49], 1, v10
    s_nop 0
    v_cndmask_b32 v36, 0, v11, vcc
    v_cndmask_b32 v36, v36, v40, s[48:49]
    v_cmp_eq_u32 vcc, 2, v10
    v_cmp_eq_u32 s[48:49], 3, v10
    s_nop 0
    v_cndmask_b32 v37, 0, v11, vcc
    v_cndmask_b32 v37, v37, v40, s[48:49]
    v_cmp_eq_u32 vcc, 4, v10
    v_cmp_eq_u32 s[48:49], 5, v10
    s_nop 0
    v_cndmask_b32 v38, 0, v11, vcc
    v_cndmask_b32 v38, v38, v40, s[48:49]
    v_cmp_eq_u32 vcc, 6, v10
    v_cmp_eq_u32 s[48:49], 7, v10
    s_nop 0
    v_cndmask_b32 v39, 0, v11, vcc
    v_cndmask_b32 v39, v39, v40, s[48:49]
    s_mov_b32 s16, 0
    s_mov_b64 s[70:71], 0
    s_mov_b64 s[72:73], 0
    s_mov_b64 s[74:75], 0
    s_mov_b64 s[76:77], 0
Lr1f_p1:
    s_mov_b64 exec, s[70:71]
    buffer_load_dwordx4 v[52:55], v6, s[8:11], s57 offen sc1
    s_mov_b64 exec, s[72:73]
    buffer_load_dwordx4 v[56:59], v6, s[8:11], s58 offen sc1
    s_mov_b64 exec, s[74:75]
    buffer_load_dwordx4 v[60:63], v6, s[8:11], s59 offen sc1
    s_mov_b64 exec, s[76:77]
    buffer_load_dwordx4 v[64:67], v6, s[8:11], s60 offen sc1
    s_mov_b64 exec, -1
    s_add_u32 s16, s16, 1
    s_cmp_gt_u32 s16, 100000
    s_cbranch_scc1 Lr_abort
    s_waitcnt vmcnt(7)
    v_and_b32 v11, 1, v52
    v_cmp_ne_u32 s[70:71], s39, v11
    v_mfma_f32_16x16x32_bf16 v[40:43], v[52:55], v[36:39], 0
    s_waitcnt vmcnt(6)
    v_and_b32 v11, 1, v56
    v_cmp_ne_u32 s[72:73], s39, v11
    v_mfma_f32_16x16x32_bf16 v[40:43], v[56:59], v[36:39], v[40:43]
    s_waitcnt vmcnt(5)
    v_and_b32 v11, 1, v60
    v_cmp_ne_u32 s[74:75], s39, v11
    v_mfma_f32_16x16x32_bf16 v[40:43], v[60:63], v[36:39], v[40:43]
    s_or_b64 vcc, s[70:71], s[72:73]
    s_waitcnt vmcnt(4)
    v_and_b32 v11, 1, v64
    v_cmp_ne_u32 s[76:77], s39, v11
    v_mfma_f32_16x16x32_bf16 v[40:43], v[64:67], v[36:39], v[40:43]
    s_or_b64 vcc, vcc, s[74:75]
    s_or_b64 vcc, vcc, s[76:77]
    s_cbranch_scc1 Lr1f_p1
    s_nop 4
    v_permlane16_swap_b32 v40, v42
    v_permlane16_swap_b32 v41, v43
    s_mov_b64 exec, s[50:51]
    v_add_f32 v40, v40, v42
    v_add_f32 v41, v41, v43
    v_cvt_pk_bf16_f32 v40, v40, v41
    v_min_u32 v40, s54, v40
    buffer_store_dword v40, v7, s[8:11], s36 offen
    v_mov_b32 v41, -1
    buffer_store_dword v41, v7, s[8:11], s37 offen
    s_mov_b64 exec, -1
    s_xor_b32 s34, s34, 16384
    s_xor_b32 s35, s35, 16384
    s_barrier
    s_sleep 2
    buffer_load_dwordx4 v[44:47], v0, s[8:11], s34 offen sc1
    buffer_load_dwordx4 v[48:51], v0, s[8:11], s34 offen offset:1024 sc1
    buffer_load_dword v10, v8, s[8:11], s35 offen sc1
    s_add_u32 s33, s33, 1
    s_bfe_u32 s39, s33, 0x10001
    s_xor_b32 s38, s38, 524288
    s_xor_b32 s57, s57, 524288
    s_xor_b32 s58, s58, 524288
    s_xor_b32 s59, s59, 524288
    s_xor_b32 s60, s60, 524288
    s_xor_b32 s36, s36, 16384
    s_xor_b32 s37, s37, 16384
    s_and_b32 s17, s33, 7
    s_mul_i32 s17, s17, 131072
    s_add_u32 s43, s45, s17
    s_bfe_u32 s66, s33, 65539
    s_add_u32 s67, s67, 22528
    s_add_u32 s42, s42, 262144
    s_add_u32 s41, s41, 262144
    s_add_u32 s40, s40, 262144
    s_add_u32 s44, s44, 22528
    s_waitcnt vmcnt(5)
    ds_read_b128 v[56:59], v9 offset:4096
    ds_read_b128 v[60:63], v9 offset:5120
    ds_read_b128 v[64:67], v9 offset:6144
    ds_read_b128 v[68:71], v9 offset:7168
    v_mov_b64 v[12:13], 0
    v_mov_b64 v[14:15], 0
    v_mov_b64 v[16:17], 0
    v_mov_b64 v[18:19], 0
    v_mov_b64 v[20:21], 0
    v_mov_b64 v[22:23], 0
    v_mov_b64 v[24:25], 0
    v_mov_b64 v[26:27], 0
    v_mov_b64 v[28:29], 0
    v_mov_b64 v[30:31], 0
    v_mov_b64 v[32:33], 0
    v_mov_b64 v[34:35], 0
    s_waitcnt lgkmcnt(0)
    s_branch Lr1f_step
Lr1f_last:
    s_waitcnt vmcnt(0) lgkmcnt(0)
    s_branch Lr_exit
L_w2_1:
    s_cmp_lg_u32 s14, 2
    s_cbranch_scc1 L_w3_1
    s_barrier
    s_mov_b32 m0, 13312
    s_nop 0
    buffer_load_dwordx4 v0, s[8:11], s41 offen offset:0 lds
    buffer_load_dwordx4 v0, s[8:11], s41 offen offset:1024 lds
    s_add_u32 s41, s41, 262144
    s_waitcnt vmcnt(0)
    buffer_load_dwordx4 v[44:47], v0, s[8:11], s34 offen sc1
    buffer_load_dwordx4 v[48:51], v0, s[8:11], s34 offen offset:1024 sc1
    buffer_load_dword v10, v8, s[8:11], s35 offen sc1
    ds_read_b128 v[56:59], v9 offset:8192
    ds_read_b128 v[60:63], v9 offset:9216
    ds_read_b128 v[64:67], v9 offset:10240
    ds_read_b128 v[68:71], v9 offset:11264
    v_mov_b64 v[12:13], 0
    v_mov_b64 v[14:15], 0
    v_mov_b64 v[16:17], 0
    v_mov_b64 v[18:19], 0
    v_mov_b64 v[20:21], 0
    v_mov_b64 v[22:23], 0
    v_mov_b64 v[24:25], 0
    v_mov_b64 v[26:27], 0
    v_mov_b64 v[28:29], 0
    v_mov_b64 v[30:31], 0
    v_mov_b64 v[32:33], 0
    v_mov_b64 v[34:35], 0
    s_waitcnt lgkmcnt(0)
Lr2f_step:
    s_mov_b32 s16, 0
    s_mov_b64 s[70:71], 0
    s_mov_b64 s[72:73], 0
    s_mov_b64 s[74:75], 0
Lr2f_p2:
    s_mov_b64 exec, s[70:71]
    buffer_load_dwordx4 v[44:47], v0, s[8:11], s34 offen sc1
    s_mov_b64 exec, s[72:73]
    buffer_load_dwordx4 v[48:51], v0, s[8:11], s34 offen offset:1024 sc1
    s_mov_b64 exec, s[74:75]
    buffer_load_dword v10, v8, s[8:11], s35 offen sc1
    s_mov_b64 exec, -1
    s_add_u32 s16, s16, 1
    s_cmp_gt_u32 s16, 100000
    s_cbranch_scc1 Lr_abort
    s_waitcnt vmcnt(5)
    v_max3_u32 v11, v44, v45, v46
    v_max_u32 v11, v11, v47
    v_cmp_eq_u32 s[70:71], -1, v11
    s_waitcnt vmcnt(4)
    v_max3_u32 v11, v48, v49, v50
    v_max_u32 v11, v11, v51
    v_cmp_eq_u32 s[72:73], -1, v11
    s_waitcnt vmcnt(3)
    v_cmp_eq_u32 s[74:75], -1, v10
    s_or_b64 vcc, s[70:71], s[72:73]
    s_or_b64 vcc, vcc, s[74:75]
    s_cbranch_scc1 Lr2f_p2
    v_smfmac_f32_16x16x64_bf16 v[12:15], v[44:47], v[232:239], v1
    ds_write_b128 v0, v[44:47] offset:4096
    v_smfmac_f32_16x16x64_bf16 v[16:19], v[44:47], v[240:247], v1
    ds_write_b128 v0, v[48:51] offset:5120
    v_smfmac_f32_16x16x64_bf16 v[20:23], v[44:47], v[248:255], v1
    ds_write_b32 v8, v10 offset:8704
    v_smfmac_f32_16x16x64_bf16 v[24:27], v[44:47], v[56:63], v1
    s_waitcnt lgkmcnt(0)
    s_barrier
    ds_read_b128 v[52:55], v0 offset:0
    v_smfmac_f32_16x16x64_bf16 v[12:15], v[48:51], a[16:23], v1
    ds_read_b128 v[36:39], v0 offset:1024
    v_smfmac_f32_16x16x64_bf16 v[16:19], v[48:51], a[24:31], v1
    ds_read_b128 v[56:59], v9 offset:0
    v_smfmac_f32_16x16x64_bf16 v[20:23], v[48:51], a[32:39], v1
    ds_read_b128 v[60:63], v9 offset:1024
    v_smfmac_f32_16x16x64_bf16 v[24:27], v[48:51], v[64:71], v1
    ds_read_b128 v[40:43], v0 offset:2048
    s_waitcnt lgkmcnt(4)
    v_smfmac_f32_16x16x64_bf16 v[12:15], v[52:55], v[72:79], v1
    v_smfmac_f32_16x16x64_bf16 v[16:19], v[52:55], v[80:87], v1
    ds_read_b128 v[64:67], v9 offset:2048
    v_smfmac_f32_16x16x64_bf16 v[20:23], v[52:55], v[88:95], v1
    ds_read_b128 v[68:71], v9 offset:3072
    s_waitcnt lgkmcnt(3)
    v_smfmac_f32_16x16x64_bf16 v[24:27], v[52:55], v[56:63], v1
    v_smfmac_f32_16x16x64_bf16 v[12:15], v[36:39], v[112:119], v1
    ds_read_b128 v[52:55], v0 offset:3072
    v_smfmac_f32_16x16x64_bf16 v[16:19], v[36:39], v[120:127], v1
    ds_read_b128 v[56:59], v9 offset:4096
    v_smfmac_f32_16x16x64_bf16 v[20:23], v[36:39], v[128:135], v1
    ds_read_b128 v[60:63], v9 offset:5120
    s_waitcnt lgkmcnt(3)
    v_smfmac_f32_16x16x64_bf16 v[24:27], v[36:39], v[64:71], v1
    v_smfmac_f32_16x16x64_bf16 v[12:15], v[40:43], v[152:159], v1
    buffer_load_dwordx4 v[36:39], v0, s[8:11], s42 offen
    v_smfmac_f32_16x16x64_bf16 v[16:19], v[40:43], v[160:167], v1
    ds_read_b128 v[64:67], v9 offset:6144
    v_smfmac_f32_16x16x64_bf16 v[20:23], v[40:43], v[168:175], v1
    ds_read_b128 v[68:71], v9 offset:7168
    s_waitcnt lgkmcnt(2)
    v_smfmac_f32_16x16x64_bf16 v[24:27], v[40:43], v[56:63], v1
    s_waitcnt vmcnt(1)
    ds_read_b128 v[44:47], v0 offset:6144
    v_smfmac_f32_16x16x64_bf16 v[12:15], v[52:55], v[192:199], v1
    buffer_load_dwordx4 v[40:43], v0, s[8:11], s42 offen offset:1024
    v_smfmac_f32_16x16x64_bf16 v[16:19], v[52:55], v[200:207], v1
    ds_read_b128 v[56:59], v9 offset:12288
    v_smfmac_f32_16x16x64_bf16 v[20:23], v[52:55], v[208:215], v1
    ds_read_b128 v[60:63], v9 offset:13312
    s_waitcnt lgkmcnt(3)
    v_smfmac_f32_16x16x64_bf16 v[24:27], v[52:55], v[64:71], v1
    ds_read_b128 v[48:51], v0 offset:7168
    s_waitcnt lgkmcnt(3)
    v_smfmac_f32_16x16x64_bf16 v[12:15], v[44:47], a[56:63], v1
    ds_read_b128 v[52:55], v0 offset:8192
    v_smfmac_f32_16x16x64_bf16 v[16:19], v[44:47], a[64:71], v1
    ds_read_b128 v[64:67], v9 offset:14336
    v_smfmac_f32_16x16x64_bf16 v[20:23], v[44:47], a[72:79], v1
    ds_read_b128 v[68:71], v9 offset:15360
    s_waitcnt lgkmcnt(4)
    v_smfmac_f32_16x16x64_bf16 v[24:27], v[44:47], v[56:63], v1
    s_waitcnt lgkmcnt(3)
    v_smfmac_f32_16x16x64_bf16 v[12:15], v[48:51], a[96:103], v1
    v_smfmac_f32_16x16x64_bf16 v[16:19], v[48:51], a[104:111], v1
    ds_read_b128 v[56:59], v9 offset:16384
    s_waitcnt lgkmcnt(3)
    v_smfmac_f32_16x16x64_bf16 v[12:15], v[52:55], a[136:143], v1
    ds_read_b128 v[60:63], v9 offset:17408
    v_smfmac_f32_16x16x64_bf16 v[16:19], v[52:55], a[144:151], v1
    v_smfmac_f32_16x16x64_bf16 v[20:23], v[48:51], a[112:119], v1
    s_waitcnt lgkmcnt(2)
    v_smfmac_f32_16x16x64_bf16 v[24:27], v[48:51], v[64:71], v1
    ds_read_b128 v[64:67], v0 offset:9216
    s_nop 1
    v_add_f32 v12, v12, v14
    v_smfmac_f32_16x16x64_bf16 v[20:23], v[52:55], a[152:159], v1
    ds_read_b128 v[68:71], v0 offset:10240
    v_add_f32 v16, v16, v18
    s_waitcnt lgkmcnt(2)
    v_smfmac_f32_16x16x64_bf16 v[24:27], v[52:55], v[56:63], v1
    ds_read_b128 v[56:59], v0 offset:11264
    v_add_f32 v13, v13, v15
    v_add_f32 v17, v17, v19
    v_cvt_pk_bf16_f32 v14, v12, v16
    v_cvt_pk_bf16_f32 v15, v13, v17
    ds_write_b32 v2, v14 offset:17408
    ds_write_b32 v2, v15 offset:17696
    v_smfmac_f32_16x16x64_bf16 v[28:31], v[52:55], a[160:167], v1
    ds_read_b128 v[60:63], v0 offset:12288
    v_add_f32 v20, v20, v22
    v_add_f32 v24, v24, v26
    v_add_f32 v21, v21, v23
    v_add_f32 v25, v25, v27
    v_smfmac_f32_16x16x64_bf16 v[32:35], v[52:55], a[168:175], v1
    ds_read_b128 v[12:15], v0 offset:4096
    v_cvt_pk_bf16_f32 v22, v20, v24
    v_cvt_pk_bf16_f32 v23, v21, v25
    ds_write_b32 v2, v22 offset:19712
    ds_write_b32 v2, v23 offset:20000
    v_smfmac_f32_16x16x64_bf16 v[28:31], v[48:51], a[120:127], v1
    ds_read_b128 v[16:19], v0 offset:5120
    v_smfmac_f32_16x16x64_bf16 v[32:35], v[48:51], a[128:135], v1
    ds_read_b128 v[20:23], v0 offset:0
    v_smfmac_f32_16x16x64_bf16 v[28:31], v[44:47], a[80:87], v1
    ds_read_b128 v[24:27], v0 offset:1024
    v_smfmac_f32_16x16x64_bf16 v[32:35], v[44:47], a[88:95], v1
    s_waitcnt lgkmcnt(3)
    s_barrier
    ds_read_b128 v[44:47], v3 offset:17408
    v_smfmac_f32_16x16x64_bf16 v[28:31], v[12:15], a[0:7], v1
    ds_read_b128 v[52:55], v0 offset:2048
    v_smfmac_f32_16x16x64_bf16 v[32:35], v[12:15], a[8:15], v1
    ds_read_b128 v[12:15], v3 offset:19712
    s_waitcnt lgkmcnt(5)
    v_smfmac_f32_16x16x64_bf16 v[28:31], v[16:19], a[40:47], v1
    ds_read_b128 v[48:51], v0 offset:3072
    v_smfmac_f32_16x16x64_bf16 v[32:35], v[16:19], a[48:55], v1
    s_waitcnt lgkmcnt(5)
    v_smfmac_f32_16x16x64_bf16 v[28:31], v[20:23], v[96:103], v1
    v_smfmac_f32_16x16x64_bf16 v[32:35], v[20:23], v[104:111], v1
    ds_read_b128 v[20:23], v3 offset:17472
    s_waitcnt lgkmcnt(5)
    v_smfmac_f32_16x16x64_bf16 v[28:31], v[24:27], v[136:143], v1
    v_smfmac_f32_16x16x64_bf16 v[32:35], v[24:27], v[144:151], v1
    s_waitcnt lgkmcnt(3)
    v_smfmac_f32_16x16x64_bf16 v[28:31], v[52:55], v[176:183], v1
    v_smfmac_f32_16x16x64_bf16 v[32:35], v[52:55], v[184:191], v1
    ds_read_b128 v[52:55], v3 offset:19776
    s_waitcnt lgkmcnt(2)
    v_smfmac_f32_16x16x64_bf16 v[28:31], v[48:51], v[216:223], v1
    v_smfmac_f32_16x16x64_bf16 v[32:35], v[48:51], v[224:231], v1
    ds_read_b128 v[48:51], v3 offset:17536
    v_mfma_f32_16x16x32_bf16 v[24:27], v[12:15], v[44:47], 0
    v_mfma_f32_16x16x32_bf16 v[12:15], v[64:67], v[44:47], 0
    ds_read_b128 v[64:67], v0 offset:13312
    v_mfma_f32_16x16x32_bf16 v[16:19], v[68:71], v[44:47], 0
    ds_read_b128 v[68:71], v0 offset:14336
    s_waitcnt lgkmcnt(3)
    v_mfma_f32_16x16x32_bf16 v[24:27], v[52:55], v[20:23], v[24:27]
    ds_read_b128 v[44:47], v3 offset:19840
    v_add_f32 v28, v28, v30
    v_add_f32 v29, v29, v31
    v_mfma_f32_16x16x32_bf16 v[12:15], v[56:59], v[20:23], v[12:15]
    ds_read_b128 v[52:55], v3 offset:17600
    v_add_f32 v32, v32, v34
    v_add_f32 v33, v33, v35
    v_mfma_f32_16x16x32_bf16 v[16:19], v[60:63], v[20:23], v[16:19]
    ds_read_b128 v[56:59], v0 offset:15360
    v_cvt_pk_bf16_f32 v30, v28, v29
    v_cvt_pk_bf16_f32 v31, v32, v33
    s_waitcnt lgkmcnt(2)
    v_mfma_f32_16x16x32_bf16 v[24:27], v[44:47], v[48:51], v[24:27]
    ds_read_b128 v[20:23], v3 offset:19904
    v_lshrrev_b32 v10, 8, v0
    v_mul_u32_u24 v10, 288, v10
    v_mfma_f32_16x16x32_bf16 v[12:15], v[64:67], v[48:51], v[12:15]
    ds_read_b128 v[60:63], v0 offset:16384
    v_and_b32 v11, 0xf0, v0
    v_add_u32 v10, v10, v11
    v_mfma_f32_16x16x32_bf16 v[16:19], v[68:71], v[48:51], v[16:19]
    ds_read_b128 v[32:35], v10 offset:20864
    v_lshrrev_b32 v11, 1, v0
    v_bfi_b32 v30, 1, s66, v30
    s_waitcnt lgkmcnt(2)
    v_mfma_f32_16x16x32_bf16 v[24:27], v[20:23], v[52:55], v[24:27]
    buffer_store_dwordx2 v[30:31], v11, s[8:11], s43 offen offset:2048 sc1
    v_mov_b32 v49, 0
    v_mov_b32 v50, 0
    v_mfma_f32_16x16x32_bf16 v[12:15], v[56:59], v[52:55], v[12:15]
    v_mov_b64 v[64:65], s[68:69]
    v_mov_b64 v[66:67], s[68:69]
    s_waitcnt lgkmcnt(1)
    v_mfma_f32_16x16x32_bf16 v[16:19], v[60:63], v[52:55], v[16:19]
    s_waitcnt lgkmcnt(0)
    v_bfi_b32 v32, 1, s66, v32
    s_mov_b64 exec, s[52:53]
    buffer_store_dwordx4 v[32:35], v0, s[8:11], s43 offen sc1
    s_mov_b64 exec, -1
    v_max3_f32 v10, v24, v25, v12
    v_max3_f32 v10, v10, v13, v14
    s_nop 0
    v_max3_f32 v10, v10, v15, v16
    v_max3_f32 v10, v10, v17, v18
    v_max_f32 v10, v10, v19
    v_mov_b32 v11, v10
    s_nop 1
    v_permlane32_swap_b32 v10, v11
    v_max_f32 v10, v10, v11
    v_mov_b32 v11, v10
    s_nop 1
    v_permlane16_swap_b32 v10, v11
    v_max_f32 v10, v10, v11
    v_mul_f32 v20, s46, v10
    v_pk_fma_f32 v[24:25], v[24:25], s[46:47], v[20:21] op_sel_hi:[1,1,0] neg_lo:[0,0,1] neg_hi:[0,0,1]
    v_pk_fma_f32 v[12:13], v[12:13], s[46:47], v[20:21] op_sel_hi:[1,1,0] neg_lo:[0,0,1] neg_hi:[0,0,1]
    v_exp_f32 v24, v24
    v_exp_f32 v25, v25
    v_pk_fma_f32 v[14:15], v[14:15], s[46:47], v[20:21] op_sel_hi:[1,1,0] neg_lo:[0,0,1] neg_hi:[0,0,1]
    v_exp_f32 v12, v12
    v_exp_f32 v13, v13
    v_pk_fma_f32 v[16:17], v[16:17], s[46:47], v[20:21] op_sel_hi:[1,1,0] neg_lo:[0,0,1] neg_hi:[0,0,1]
    v_cvt_pk_bf16_f32 v48, v24, v25
    v_exp_f32 v14, v14
    v_pk_fma_f32 v[18:19], v[18:19], s[46:47], v[20:21] op_sel_hi:[1,1,0] neg_lo:[0,0,1] neg_hi:[0,0,1]
    v_cvt_pk_bf16_f32 v51, v24, v25
    v_exp_f32 v15, v15
    v_cvt_pk_bf16_f32 v44, v12, v13
    v_exp_f32 v16, v16
    v_exp_f32 v17, v17
    v_cvt_pk_bf16_f32 v45, v14, v15
    v_exp_f32 v18, v18
    v_exp_f32 v19, v19
    v_cvt_pk_bf16_f32 v46, v16, v17
    v_cvt_pk_bf16_f32 v47, v18, v19
    v_mfma_f32_16x16x16_bf16 v[68:71], v[64:65], v[48:49], 0
    v_mfma_f32_16x16x16_bf16 v[52:55], v[30:31], v[48:49], 0
    v_mfma_f32_16x16x16_bf16 v[56:59], v[30:31], v[50:51], 0
    v_mfma_f32_16x16x32_bf16 v[68:71], v[64:67], v[44:47], v[68:71]
    s_waitcnt vmcnt(3)
    v_mfma_f32_16x16x32_bf16 v[52:55], v[36:39], v[44:47], v[52:55]
    s_waitcnt vmcnt(2)
    v_mfma_f32_16x16x32_bf16 v[56:59], v[40:43], v[44:47], v[56:59]
    ds_read_b128 v[36:39], v0 offset:47104
    ds_read_b128 v[40:43], v0 offset:48128
    ds_read_b128 v[60:63], v9 offset:24576
    s_nop 0
    v_rcp_f32 v10, v68
    s_nop 0
    v_pk_mul_f32 v[52:53], v[52:53], v[10:11] op_sel_hi:[1,0]
    s_nop 0
    v_pk_mul_f32 v[56:57], v[56:57], v[10:11] op_sel_hi:[1,0]
    v_cvt_pk_bf16_f32 v16, v52, v56
    v_cvt_pk_bf16_f32 v17, v53, v57
    v_pk_mul_f32 v[54:55], v[54:55], v[10:11] op_sel_hi:[1,0]
    v_pk_mul_f32 v[58:59], v[58:59], v[10:11] op_sel_hi:[1,0]
    v_cvt_pk_bf16_f32 v18, v54, v58
    v_cvt_pk_bf16_f32 v19, v55, v59
    ds_write_b128 v3, v[16:19] offset:22144
    ds_read_b128 v[64:67], v9 offset:25600
    v_mov_b64 v[12:13], 0
    v_mov_b64 v[14:15], 0
    v_mov_b64 v[20:21], 0
    v_mov_b64 v[22:23], 0
    v_mov_b64 v[24:25], 0
    v_mov_b64 v[26:27], 0
    v_mov_b64 v[32:33], 0
    v_mov_b64 v[34:35], 0
    v_mov_b64 v[44:45], 0
    v_mov_b64 v[46:47], 0
    v_mov_b64 v[48:49], 0
    v_mov_b64 v[50:51], 0
    s_waitcnt lgkmcnt(1)
    s_barrier
    ds_read_b128 v[52:55], v4 offset:22016
    ds_read_b128 v[56:59], v4 offset:22144
    v_mov_b64 v[68:69], 0
    v_mov_b64 v[70:71], 0
    v_mov_b64 v[28:29], 0
    v_mov_b64 v[30:31], 0
    v_mov_b64 v[16:17], 0
    v_mov_b64 v[18:19], 0
    s_cmp_eq_u32 s33, 63
    s_cbranch_scc1 Lr2f_last
    s_waitcnt lgkmcnt(1)
    v_smfmac_f32_16x16x64_bf16 v[28:31], v[52:55], v[60:67], v1
    ds_read_b128 v[60:63], v0 offset:40960
    s_waitcnt lgkmcnt(1)
    v_smfmac_f32_16x16x64_bf16 v[28:31], v[56:59], v[36:43], v1
    ds_read_b128 v[64:67], v0 offset:41984
    ds_read_b128 v[36:39], v9 offset:18432
    v_smfmac_f32_16x16x64_bf16 v[12:15], v[52:55], a[176:183], v1
    ds_read_b128 v[40:43], v9 offset:19456
    v_smfmac_f32_16x16x64_bf16 v[12:15], v[56:59], a[184:191], v1
    buffer_load_dwordx4 v0, s[8:11], s41 offen offset:0 lds
    v_smfmac_f32_16x16x64_bf16 v[20:23], v[52:55], a[192:199], v1
    s_nop 0
    v_add_f32 v28, v28, v30
    v_add_f32 v29, v29, v31
    s_waitcnt lgkmcnt(2)
    v_smfmac_f32_16x16x64_bf16 v[20:23], v[56:59], v[60:67], v1
    ds_read_b128 v[60:63], v9 offset:20480
    v_cvt_pk_bf16_f32 v28, v28, v29
    v_bfi_b32 v28, 1, s39, v28
    buffer_store_dword v28, v8, s[8:11], s38 offen offset:2048
    s_waitcnt lgkmcnt(1)
    v_smfmac_f32_16x16x64_bf16 v[24:27], v[52:55], v[36:43], v1
    ds_read_b128 v[64:67], v9 offset:21504
    ds_read_b128 v[36:39], v0 offset:43008
    v_add_f32 v12, v12, v14
    v_add_f32 v13, v13, v15
    v_smfmac_f32_16x16x64_bf16 v[24:27], v[56:59], a[200:207], v1
    ds_read_b128 v[40:43], v0 offset:44032
    v_cvt_pk_bf16_f32 v12, v12, v13
    v_bfi_b32 v12, 1, s39, v12
    v_smfmac_f32_16x16x64_bf16 v[32:35], v[52:55], a[208:215], v1
    buffer_load_dwordx4 v0, s[8:11], s41 offen offset:1024 lds
    v_add_f32 v20, v20, v22
    v_add_f32 v21, v21, v23
    v_smfmac_f32_16x16x64_bf16 v[32:35], v[56:59], a[216:223], v1
    v_cvt_pk_bf16_f32 v13, v20, v21
    s_waitcnt lgkmcnt(2)
    v_smfmac_f32_16x16x64_bf16 v[44:47], v[52:55], v[60:67], v1
    ds_read_b128 v[60:63], v0 offset:45056
    v_add_f32 v24, v24, v26
    v_add_f32 v25, v25, v27
    s_waitcnt lgkmcnt(1)
    v_smfmac_f32_16x16x64_bf16 v[44:47], v[56:59], v[36:43], v1
    ds_read_b128 v[64:67], v0 offset:46080
    ds_read_b128 v[36:39], v9 offset:22528
    v_cvt_pk_bf16_f32 v14, v24, v25
    v_smfmac_f32_16x16x64_bf16 v[48:51], v[52:55], a[224:231], v1
    ds_read_b128 v[40:43], v9 offset:23552
    v_add_f32 v32, v32, v34
    v_add_f32 v33, v33, v35
    v_smfmac_f32_16x16x64_bf16 v[48:51], v[56:59], a[232:239], v1
    v_cvt_pk_bf16_f32 v15, v32, v33
    buffer_store_dwordx4 v[12:15], v0, s[8:11], s38 offen offset:0
    v_smfmac_f32_16x16x64_bf16 v[68:71], v[52:55], a[240:247], v1
    v_add_f32 v44, v44, v46
    v_add_f32 v45, v45, v47
    s_waitcnt lgkmcnt(2)
    v_smfmac_f32_16x16x64_bf16 v[68:71], v[56:59], v[60:67], v1
    v_cvt_pk_bf16_f32 v44, v44, v45
    v_bfi_b32 v44, 1, s39, v44
    s_waitcnt lgkmcnt(0)
    v_smfmac_f32_16x16x64_bf16 v[16:19], v[52:55], v[36:43], v1
    v_add_f32 v48, v48, v50
    v_add_f32 v49, v49, v51
    v_smfmac_f32_16x16x64_bf16 v[16:19], v[56:59], a[248:255], v1
    v_cvt_pk_bf16_f32 v45, v48, v49
    v_add_f32 v68, v68, v70
    v_add_f32 v69, v69, v71
    v_cvt_pk_bf16_f32 v46, v68, v69
    s_nop 3
    v_add_f32 v16, v16, v18
    v_add_f32 v17, v17, v19
    v_cvt_pk_bf16_f32 v47, v16, v17
    buffer_store_dwordx4 v[44:47], v0, s[8:11], s38 offen offset:1024
    s_cmp_eq_u32 s62, 0
    s_cbranch_scc1 Lr2f_nojob
    s_sleep 6
    buffer_load_dwordx4 v[52:55], v6, s[8:11], s57 offen sc1
    buffer_load_dwordx4 v[56:59], v6, s[8:11], s58 offen sc1
    buffer_load_dwordx4 v[60:63], v6, s[8:11], s59 offen sc1
    buffer_load_dwordx4 v[64:67], v6, s[8:11], s60 offen sc1
    v_bfe_u32 v10, v0, 4, 4
    v_mov_b32 v11, 0x3f80
    v_mov_b32 v40, 0x3f800000
    v_cmp_eq_u32 vcc, 0, v10
    v_cmp_eq_u32 s[48:49], 1, v10
    s_nop 0
    v_cndmask_b32 v36, 0, v11, vcc
    v_cndmask_b32 v36, v36, v40, s[48:49]
    v_cmp_eq_u32 vcc, 2, v10
    v_cmp_eq_u32 s[48:49], 3, v10
    s_nop 0
    v_cndmask_b32 v37, 0, v11, vcc
    v_cndmask_b32 v37, v37, v40, s[48:49]
    v_cmp_eq_u32 vcc, 4, v10
    v_cmp_eq_u32 s[48:49], 5, v10
    s_nop 0
    v_cndmask_b32 v38, 0, v11, vcc
    v_cndmask_b32 v38, v38, v40, s[48:49]
    v_cmp_eq_u32 vcc, 6, v10
    v_cmp_eq_u32 s[48:49], 7, v10
    s_nop 0
    v_cndmask_b32 v39, 0, v11, vcc
    v_cndmask_b32 v39, v39, v40, s[48:49]
    s_mov_b32 s16, 0
    s_mov_b64 s[70:71], 0
    s_mov_b64 s[72:73], 0
    s_mov_b64 s[74:75], 0
    s_mov_b64 s[76:77], 0
Lr2f_p1:
    s_mov_b64 exec, s[70:71]
    buffer_load_dwordx4 v[52:55], v6, s[8:11], s57 offen sc1
    s_mov_b64 exec, s[72:73]
    buffer_load_dwordx4 v[56:59], v6, s[8:11], s58 offen sc1
    s_mov_b64 exec, s[74:75]
    buffer_load_dwordx4 v[60:63], v6, s[8:11], s59 offen sc1
    s_mov_b64 exec, s[76:77]
    buffer_load_dwordx4 v[64:67], v6, s[8:11], s60 offen sc1
    s_mov_b64 exec, -1
    s_add_u32 s16, s16, 1
    s_cmp_gt_u32 s16, 100000
    s_cbranch_scc1 Lr_abort
    s_waitcnt vmcnt(7)
    v_xor_b32 v10, v52, v53
    v_xor_b32 v11, v54, v55
    v_or_b32 v10, v10, v11
    v_xor_b32 v11, v52, v54
    v_or_b32 v10, v10, v11
    v_xor_b32 v11, s39, v52
    v_or_b32 v10, v10, v11
    v_and_b32 v10, 1, v10
    v_cmp_ne_u32 s[70:71], 0, v10
    v_mfma_f32_16x16x32_bf16 v[40:43], v[52:55], v[36:39], 0
    s_waitcnt vmcnt(6)
    v_xor_b32 v10, v56, v57
    v_xor_b32 v11, v58, v59
    v_or_b32 v10, v10, v11
    v_xor_b32 v11, v56, v58
    v_or_b32 v10, v10, v11
    v_xor_b32 v11, s39, v56
    v_or_b32 v10, v10, v11
    v_and_b32 v10, 1, v10
    v_cmp_ne_u32 s[72:73], 0, v10
    v_mfma_f32_16x16x32_bf16 v[40:43], v[56:59], v[36:39], v[40:43]
    s_waitcnt vmcnt(5)
    v_xor_b32 v10, v60, v61
    v_xor_b32 v11, v62, v63
    v_or_b32 v10, v10, v11
    v_xor_b32 v11, v60, v62
    v_or_b32 v10, v10, v11
    v_xor_b32 v11, s39, v60
    v_or_b32 v10, v10, v11
    v_and_b32 v10, 1, v10
    v_cmp_ne_u32 s[74:75], 0, v10
    v_mfma_f32_16x16x32_bf16 v[40:43], v[60:63], v[36:39], v[40:43]
    s_or_b64 vcc, s[70:71], s[72:73]
    s_waitcnt vmcnt(4)
    v_xor_b32 v10, v64, v65
    v_xor_b32 v11, v66, v67
    v_or_b32 v10, v10, v11
    v_xor_b32 v11, v64, v66
    v_or_b32 v10, v10, v11
    v_xor_b32 v11, s39, v64
    v_or_b32 v10, v10, v11
    v_and_b32 v10, 1, v10
    v_cmp_ne_u32 s[76:77], 0, v10
    v_mfma_f32_16x16x32_bf16 v[40:43], v[64:67], v[36:39], v[40:43]
    s_or_b64 vcc, vcc, s[74:75]
    s_or_b64 vcc, vcc, s[76:77]
    s_cbranch_scc1 Lr2f_p1
    s_nop 4
    v_permlane16_swap_b32 v40, v42
    v_permlane16_swap_b32 v41, v43
    s_mov_b64 exec, s[50:51]
    v_add_f32 v40, v40, v42
    v_add_f32 v41, v41, v43
    v_cvt_pk_bf16_f32 v40, v40, v41
    v_min_u32 v40, s54, v40
    buffer_store_dword v40, v7, s[8:11], s36 offen
    v_mov_b32 v41, -1
    buffer_store_dword v41, v7, s[8:11], s37 offen
    s_mov_b64 exec, -1
    s_branch Lr2f_jobdone
Lr2f_nojob:
Lr2f_jobdone:
    s_xor_b32 s34, s34, 16384
    s_xor_b32 s35, s35, 16384
    s_barrier
    s_sleep 2
    buffer_load_dwordx4 v[44:47], v0, s[8:11], s34 offen sc1
    buffer_load_dwordx4 v[48:51], v0, s[8:11], s34 offen offset:1024 sc1
    buffer_load_dword v10, v8, s[8:11], s35 offen sc1
    s_add_u32 s33, s33, 1
    s_bfe_u32 s39, s33, 0x10001
    s_xor_b32 s38, s38, 524288
    s_xor_b32 s57, s57, 524288
    s_xor_b32 s58, s58, 524288
    s_xor_b32 s59, s59, 524288
    s_xor_b32 s60, s60, 524288
    s_xor_b32 s36, s36, 16384
    s_xor_b32 s37, s37, 16384
    s_and_b32 s17, s33, 7
    s_mul_i32 s17, s17, 131072
    s_add_u32 s43, s45, s17
    s_bfe_u32 s66, s33, 65539
    s_add_u32 s67, s67, 22528
    s_add_u32 s42, s42, 262144
    s_add_u32 s41, s41, 262144
    s_add_u32 s40, s40, 262144
    s_add_u32 s44, s44, 22528
    s_waitcnt vmcnt(6)
    ds_read_b128 v[56:59], v9 offset:8192
    ds_read_b128 v[60:63], v9 offset:9216
    ds_read_b128 v[64:67], v9 offset:10240
    ds_read_b128 v[68:71], v9 offset:11264
    v_mov_b64 v[12:13], 0
    v_mov_b64 v[14:15], 0
    v_mov_b64 v[16:17], 0
    v_mov_b64 v[18:19], 0
    v_mov_b64 v[20:21], 0
    v_mov_b64 v[22:23], 0
    v_mov_b64 v[24:25], 0
    v_mov_b64 v[26:27], 0
    v_mov_b64 v[28:29], 0
    v_mov_b64 v[30:31], 0
    v_mov_b64 v[32:33], 0
    v_mov_b64 v[34:35], 0
    s_waitcnt lgkmcnt(0)
    s_branch Lr2f_step
Lr2f_last:
    s_waitcnt vmcnt(0) lgkmcnt(0)
    s_branch Lr_exit
L_w3_1:
    s_mov_b32 s16, 0
    s_add_u32 s17, s44, 128
    v_and_b32 v11, 16, v8
    v_lshlrev_b32 v11, 3, v11
    v_and_or_b32 v11, v8, 12, v11
Lr3f_fw_10:
    buffer_load_dword v10, v11, s[8:11], s17 offen sc1
    s_add_u32 s16, s16, 1
    s_cmp_gt_u32 s16, 100000
    s_cbranch_scc1 Lr_abort
    s_waitcnt vmcnt(0)
    v_cmp_eq_u32 vcc, 0, v10
    s_nop 0
    s_cbranch_vccz Lr3f_fw_10d
    s_sleep 4
    s_branch Lr3f_fw_10
Lr3f_fw_10d:
    s_barrier
    s_mov_b32 m0, 15360
    s_nop 0
    buffer_load_dwordx4 v0, s[8:11], s41 offen offset:0 lds
    buffer_load_dwordx4 v0, s[8:11], s41 offen offset:1024 lds
    s_add_u32 s41, s41, 262144
    s_waitcnt vmcnt(0)
    buffer_load_dwordx4 v[44:47], v0, s[8:11], s34 offen sc1
    buffer_load_dwordx4 v[48:51], v0, s[8:11], s34 offen offset:1024 sc1
    buffer_load_dword v10, v8, s[8:11], s35 offen sc1
    ds_read_b128 v[56:59], v9 offset:12288
    ds_read_b128 v[60:63], v9 offset:13312
    ds_read_b128 v[64:67], v9 offset:14336
    ds_read_b128 v[68:71], v9 offset:15360
    v_mov_b64 v[12:13], 0
    v_mov_b64 v[14:15], 0
    v_mov_b64 v[16:17], 0
    v_mov_b64 v[18:19], 0
    v_mov_b64 v[20:21], 0
    v_mov_b64 v[22:23], 0
    v_mov_b64 v[24:25], 0
    v_mov_b64 v[26:27], 0
    v_mov_b64 v[28:29], 0
    v_mov_b64 v[30:31], 0
    v_mov_b64 v[32:33], 0
    v_mov_b64 v[34:35], 0
    s_waitcnt lgkmcnt(0)
Lr3f_step:
    s_mov_b32 s16, 0
    s_mov_b64 s[70:71], 0
    s_mov_b64 s[72:73], 0
    s_mov_b64 s[74:75], 0
Lr3f_p2:
    s_mov_b64 exec, s[70:71]
    buffer_load_dwordx4 v[44:47], v0, s[8:11], s34 offen sc1
    s_mov_b64 exec, s[72:73]
    buffer_load_dwordx4 v[48:51], v0, s[8:11], s34 offen offset:1024 sc1
    s_mov_b64 exec, s[74:75]
    buffer_load_dword v10, v8, s[8:11], s35 offen sc1
    s_mov_b64 exec, -1
    s_add_u32 s16, s16, 1
    s_cmp_gt_u32 s16, 100000
    s_cbranch_scc1 Lr_abort
    s_waitcnt vmcnt(5)
    v_max3_u32 v11, v44, v45, v46
    v_max_u32 v11, v11, v47
    v_cmp_eq_u32 s[70:71], -1, v11
    s_waitcnt vmcnt(4)
    v_max3_u32 v11, v48, v49, v50
    v_max_u32 v11, v11, v51
    v_cmp_eq_u32 s[72:73], -1, v11
    s_waitcnt vmcnt(3)
    v_cmp_eq_u32 s[74:75], -1, v10
    s_or_b64 vcc, s[70:71], s[72:73]
    s_or_b64 vcc, vcc, s[74:75]
    s_cbranch_scc1 Lr3f_p2
    v_smfmac_f32_16x16x64_bf16 v[12:15], v[44:47], a[56:63], v1
    ds_write_b128 v0, v[44:47] offset:6144
    v_smfmac_f32_16x16x64_bf16 v[16:19], v[44:47], a[64:71], v1
    ds_write_b128 v0, v[48:51] offset:7168
    v_smfmac_f32_16x16x64_bf16 v[20:23], v[44:47], a[72:79], v1
    ds_write_b32 v8, v10 offset:8960
    v_smfmac_f32_16x16x64_bf16 v[24:27], v[44:47], v[56:63], v1
    s_waitcnt lgkmcnt(0)
    s_barrier
    ds_read_b128 v[52:55], v0 offset:0
    v_smfmac_f32_16x16x64_bf16 v[12:15], v[48:51], a[96:103], v1
    ds_read_b128 v[36:39], v0 offset:1024
    v_smfmac_f32_16x16x64_bf16 v[16:19], v[48:51], a[104:111], v1
    ds_read_b128 v[56:59], v9 offset:0
    v_smfmac_f32_16x16x64_bf16 v[20:23], v[48:51], a[112:119], v1
    ds_read_b128 v[60:63], v9 offset:1024
    v_smfmac_f32_16x16x64_bf16 v[24:27], v[48:51], v[64:71], v1
    ds_read_b128 v[40:43], v0 offset:2048
    s_waitcnt lgkmcnt(4)
    v_smfmac_f32_16x16x64_bf16 v[12:15], v[52:55], v[72:79], v1
    buffer_load_dword v6, v7, s[8:11], s67 offen sc1
    v_smfmac_f32_16x16x64_bf16 v[16:19], v[52:55], v[80:87], v1
    ds_read_b128 v[64:67], v9 offset:2048
    v_smfmac_f32_16x16x64_bf16 v[20:23], v[52:55], v[88:95], v1
    ds_read_b128 v[68:71], v9 offset:3072
    s_waitcnt lgkmcnt(3)
    v_smfmac_f32_16x16x64_bf16 v[24:27], v[52:55], v[56:63], v1
    v_smfmac_f32_16x16x64_bf16 v[12:15], v[36:39], v[112:119], v1
    ds_read_b128 v[52:55], v0 offset:3072
    v_smfmac_f32_16x16x64_bf16 v[16:19], v[36:39], v[120:127], v1
    ds_read_b128 v[56:59], v9 offset:4096
    v_smfmac_f32_16x16x64_bf16 v[20:23], v[36:39], v[128:135], v1
    ds_read_b128 v[60:63], v9 offset:5120
    s_waitcnt lgkmcnt(3)
    v_smfmac_f32_16x16x64_bf16 v[24:27], v[36:39], v[64:71], v1
    v_smfmac_f32_16x16x64_bf16 v[12:15], v[40:43], v[152:159], v1
    buffer_load_dwordx4 v[36:39], v0, s[8:11], s42 offen
    v_smfmac_f32_16x16x64_bf16 v[16:19], v[40:43], v[160:167], v1
    ds_read_b128 v[64:67], v9 offset:6144
    v_smfmac_f32_16x16x64_bf16 v[20:23], v[40:43], v[168:175], v1
    ds_read_b128 v[68:71], v9 offset:7168
    s_waitcnt lgkmcnt(2)
    v_smfmac_f32_16x16x64_bf16 v[24:27], v[40:43], v[56:63], v1
    s_waitcnt vmcnt(2)
    ds_read_b128 v[44:47], v0 offset:4096
    v_smfmac_f32_16x16x64_bf16 v[12:15], v[52:55], v[192:199], v1
    buffer_load_dwordx4 v[40:43], v0, s[8:11], s42 offen offset:1024
    v_smfmac_f32_16x16x64_bf16 v[16:19], v[52:55], v[200:207], v1
    ds_read_b128 v[56:59], v9 offset:8192
    v_smfmac_f32_16x16x64_bf16 v[20:23], v[52:55], v[208:215], v1
    ds_read_b128 v[60:63], v9 offset:9216
    s_waitcnt lgkmcnt(3)
    v_smfmac_f32_16x16x64_bf16 v[24:27], v[52:55], v[64:71], v1
    ds_read_b128 v[48:51], v0 offset:5120
    s_waitcnt lgkmcnt(3)
    v_smfmac_f32_16x16x64_bf16 v[12:15], v[44:47], v[232:239], v1
    ds_read_b128 v[52:55], v0 offset:8192
    v_smfmac_f32_16x16x64_bf16 v[16:19], v[44:47], v[240:247], v1
    ds_read_b128 v[64:67], v9 offset:10240
    v_smfmac_f32_16x16x64_bf16 v[20:23], v[44:47], v[248:255], v1
    ds_read_b128 v[68:71], v9 offset:11264
    s_waitcnt lgkmcnt(4)
    v_smfmac_f32_16x16x64_bf16 v[24:27], v[44:47], v[56:63], v1
    s_waitcnt lgkmcnt(3)
    v_smfmac_f32_16x16x64_bf16 v[12:15], v[48:51], a[16:23], v1
    v_smfmac_f32_16x16x64_bf16 v[16:19], v[48:51], a[24:31], v1
    ds_read_b128 v[56:59], v9 offset:16384
    s_waitcnt lgkmcnt(3)
    v_smfmac_f32_16x16x64_bf16 v[12:15], v[52:55], a[136:143], v1
    ds_read_b128 v[60:63], v9 offset:17408
    v_smfmac_f32_16x16x64_bf16 v[16:19], v[52:55], a[144:151], v1
    v_smfmac_f32_16x16x64_bf16 v[20:23], v[48:51], a[32:39], v1
    s_waitcnt lgkmcnt(2)
    v_smfmac_f32_16x16x64_bf16 v[24:27], v[48:51], v[64:71], v1
    ds_read_b128 v[64:67], v0 offset:9216
    s_nop 1
    v_add_f32 v12, v12, v14
    v_smfmac_f32_16x16x64_bf16 v[20:23], v[52:55], a[152:159], v1
    ds_read_b128 v[68:71], v0 offset:10240
    v_add_f32 v16, v16, v18
    s_waitcnt lgkmcnt(2)
    v_smfmac_f32_16x16x64_bf16 v[24:27], v[52:55], v[56:63], v1
    ds_read_b128 v[56:59], v0 offset:11264
    v_add_f32 v13, v13, v15
    v_add_f32 v17, v17, v19
    v_cvt_pk_bf16_f32 v14, v12, v16
    v_cvt_pk_bf16_f32 v15, v13, v17
    ds_write_b32 v2, v14 offset:17408
    ds_write_b32 v2, v15 offset:17696
    v_smfmac_f32_16x16x64_bf16 v[28:31], v[52:55], a[160:167], v1
    ds_read_b128 v[60:63], v0 offset:12288
    v_add_f32 v20, v20, v22
    v_add_f32 v24, v24, v26
    v_add_f32 v21, v21, v23
    v_add_f32 v25, v25, v27
    v_smfmac_f32_16x16x64_bf16 v[32:35], v[52:55], a[168:175], v1
    ds_read_b128 v[12:15], v0 offset:6144
    v_cvt_pk_bf16_f32 v22, v20, v24
    v_cvt_pk_bf16_f32 v23, v21, v25
    ds_write_b32 v2, v22 offset:19712
    ds_write_b32 v2, v23 offset:20000
    v_smfmac_f32_16x16x64_bf16 v[28:31], v[48:51], a[40:47], v1
    ds_read_b128 v[16:19], v0 offset:7168
    v_smfmac_f32_16x16x64_bf16 v[32:35], v[48:51], a[48:55], v1
    ds_read_b128 v[20:23], v0 offset:0
    v_smfmac_f32_16x16x64_bf16 v[28:31], v[44:47], a[0:7], v1
    ds_read_b128 v[24:27], v0 offset:1024
    v_smfmac_f32_16x16x64_bf16 v[32:35], v[44:47], a[8:15], v1
    s_waitcnt lgkmcnt(3)
    s_barrier
    ds_read_b128 v[44:47], v3 offset:17408
    v_smfmac_f32_16x16x64_bf16 v[28:31], v[12:15], a[80:87], v1
    ds_read_b128 v[52:55], v0 offset:2048
    v_smfmac_f32_16x16x64_bf16 v[32:35], v[12:15], a[88:95], v1
    ds_read_b128 v[12:15], v3 offset:19712
    s_waitcnt lgkmcnt(5)
    v_smfmac_f32_16x16x64_bf16 v[28:31], v[16:19], a[120:127], v1
    ds_read_b128 v[48:51], v0 offset:3072
    v_smfmac_f32_16x16x64_bf16 v[32:35], v[16:19], a[128:135], v1
    s_waitcnt lgkmcnt(5)
    v_smfmac_f32_16x16x64_bf16 v[28:31], v[20:23], v[96:103], v1
    v_smfmac_f32_16x16x64_bf16 v[32:35], v[20:23], v[104:111], v1
    ds_read_b128 v[20:23], v3 offset:17472
    s_waitcnt lgkmcnt(5)
    v_smfmac_f32_16x16x64_bf16 v[28:31], v[24:27], v[136:143], v1
    v_smfmac_f32_16x16x64_bf16 v[32:35], v[24:27], v[144:151], v1
    s_waitcnt lgkmcnt(3)
    v_smfmac_f32_16x16x64_bf16 v[28:31], v[52:55], v[176:183], v1
    v_smfmac_f32_16x16x64_bf16 v[32:35], v[52:55], v[184:191], v1
    ds_read_b128 v[52:55], v3 offset:19776
    s_waitcnt lgkmcnt(2)
    v_smfmac_f32_16x16x64_bf16 v[28:31], v[48:51], v[216:223], v1
    v_smfmac_f32_16x16x64_bf16 v[32:35], v[48:51], v[224:231], v1
    ds_read_b128 v[48:51], v3 offset:17536
    v_mfma_f32_16x16x32_bf16 v[24:27], v[12:15], v[44:47], 0
    s_waitcnt vmcnt(2)
    v_cmp_eq_u32 vcc, 0, v6
    s_nop 0
    s_and_b64 vcc, vcc, s[78:79]
    s_cbranch_scc1 Lr3f_flbad
Lr3f_flok:
    s_mov_b32 m0, 24320
    s_nop 0
    buffer_load_dword v5, s[8:11], s40 offen lds
    buffer_load_dword v5, s[8:11], s56 offen lds
    s_mov_b32 m0, 15360
    v_mfma_f32_16x16x32_bf16 v[12:15], v[64:67], v[44:47], 0
    ds_read_b128 v[64:67], v0 offset:13312
    v_mfma_f32_16x16x32_bf16 v[16:19], v[68:71], v[44:47], 0
    ds_read_b128 v[68:71], v0 offset:14336
    s_waitcnt lgkmcnt(3)
    v_mfma_f32_16x16x32_bf16 v[24:27], v[52:55], v[20:23], v[24:27]
    ds_read_b128 v[44:47], v3 offset:19840
    v_add_f32 v28, v28, v30
    v_add_f32 v29, v29, v31
    v_mfma_f32_16x16x32_bf16 v[12:15], v[56:59], v[20:23], v[12:15]
    ds_read_b128 v[52:55], v3 offset:17600
    v_add_f32 v32, v32, v34
    v_add_f32 v33, v33, v35
    v_mfma_f32_16x16x32_bf16 v[16:19], v[60:63], v[20:23], v[16:19]
    ds_read_b128 v[56:59], v0 offset:15360
    v_cvt_pk_bf16_f32 v30, v28, v29
    v_cvt_pk_bf16_f32 v31, v32, v33
    s_waitcnt lgkmcnt(2)
    v_mfma_f32_16x16x32_bf16 v[24:27], v[44:47], v[48:51], v[24:27]
    ds_read_b128 v[20:23], v3 offset:19904
    v_lshrrev_b32 v10, 8, v0
    v_mul_u32_u24 v10, 288, v10
    v_mfma_f32_16x16x32_bf16 v[12:15], v[64:67], v[48:51], v[12:15]
    ds_read_b128 v[60:63], v0 offset:16384
    v_and_b32 v11, 0xf0, v0
    v_add_u32 v10, v10, v11
    v_mfma_f32_16x16x32_bf16 v[16:19], v[68:71], v[48:51], v[16:19]
    ds_read_b128 v[32:35], v10 offset:21440
    v_lshrrev_b32 v11, 1, v0
    v_bfi_b32 v30, 1, s66, v30
    s_waitcnt lgkmcnt(2)
    v_mfma_f32_16x16x32_bf16 v[24:27], v[20:23], v[52:55], v[24:27]
    buffer_store_dwordx2 v[30:31], v11, s[8:11], s43 offen offset:2048 sc1
    v_mov_b32 v49, 0
    v_mov_b32 v50, 0
    v_mfma_f32_16x16x32_bf16 v[12:15], v[56:59], v[52:55], v[12:15]
    v_mov_b64 v[64:65], s[68:69]
    v_mov_b64 v[66:67], s[68:69]
    s_waitcnt lgkmcnt(1)
    v_mfma_f32_16x16x32_bf16 v[16:19], v[60:63], v[52:55], v[16:19]
    s_waitcnt lgkmcnt(0)
    v_bfi_b32 v32, 1, s66, v32
    s_mov_b64 exec, s[52:53]
    buffer_store_dwordx4 v[32:35], v0, s[8:11], s43 offen sc1
    s_mov_b64 exec, -1
    v_max3_f32 v10, v24, v25, v12
    v_max3_f32 v10, v10, v13, v14
    s_nop 0
    v_max3_f32 v10, v10, v15, v16
    v_max3_f32 v10, v10, v17, v18
    v_max_f32 v10, v10, v19
    v_mov_b32 v11, v10
    s_nop 1
    v_permlane32_swap_b32 v10, v11
    v_max_f32 v10, v10, v11
    v_mov_b32 v11, v10
    s_nop 1
    v_permlane16_swap_b32 v10, v11
    v_max_f32 v10, v10, v11
    v_mul_f32 v20, s46, v10
    v_pk_fma_f32 v[24:25], v[24:25], s[46:47], v[20:21] op_sel_hi:[1,1,0] neg_lo:[0,0,1] neg_hi:[0,0,1]
    v_pk_fma_f32 v[12:13], v[12:13], s[46:47], v[20:21] op_sel_hi:[1,1,0] neg_lo:[0,0,1] neg_hi:[0,0,1]
    v_exp_f32 v24, v24
    v_exp_f32 v25, v25
    v_pk_fma_f32 v[14:15], v[14:15], s[46:47], v[20:21] op_sel_hi:[1,1,0] neg_lo:[0,0,1] neg_hi:[0,0,1]
    v_exp_f32 v12, v12
    v_exp_f32 v13, v13
    v_pk_fma_f32 v[16:17], v[16:17], s[46:47], v[20:21] op_sel_hi:[1,1,0] neg_lo:[0,0,1] neg_hi:[0,0,1]
    v_cvt_pk_bf16_f32 v48, v24, v25
    v_exp_f32 v14, v14
    v_pk_fma_f32 v[18:19], v[18:19], s[46:47], v[20:21] op_sel_hi:[1,1,0] neg_lo:[0,0,1] neg_hi:[0,0,1]
    v_cvt_pk_bf16_f32 v51, v24, v25
    v_exp_f32 v15, v15
    v_cvt_pk_bf16_f32 v44, v12, v13
    v_exp_f32 v16, v16
    v_exp_f32 v17, v17
    v_cvt_pk_bf16_f32 v45, v14, v15
    v_exp_f32 v18, v18
    v_exp_f32 v19, v19
    v_cvt_pk_bf16_f32 v46, v16, v17
    v_cvt_pk_bf16_f32 v47, v18, v19
    v_mfma_f32_16x16x16_bf16 v[68:71], v[64:65], v[48:49], 0
    v_mfma_f32_16x16x16_bf16 v[52:55], v[30:31], v[48:49], 0
    v_mfma_f32_16x16x16_bf16 v[56:59], v[30:31], v[50:51], 0
    v_mfma_f32_16x16x32_bf16 v[68:71], v[64:67], v[44:47], v[68:71]
    s_waitcnt vmcnt(5)
    v_mfma_f32_16x16x32_bf16 v[52:55], v[36:39], v[44:47], v[52:55]
    s_waitcnt vmcnt(4)
    v_mfma_f32_16x16x32_bf16 v[56:59], v[40:43], v[44:47], v[56:59]
    ds_read_b128 v[36:39], v0 offset:55296
    ds_read_b128 v[40:43], v0 offset:56320
    ds_read_b128 v[60:63], v9 offset:24576
    s_nop 0
    v_rcp_f32 v10, v68
    s_nop 0
    v_pk_mul_f32 v[52:53], v[52:53], v[10:11] op_sel_hi:[1,0]
    s_nop 0
    v_pk_mul_f32 v[56:57], v[56:57], v[10:11] op_sel_hi:[1,0]
    v_cvt_pk_bf16_f32 v16, v52, v56
    v_cvt_pk_bf16_f32 v17, v53, v57
    v_pk_mul_f32 v[54:55], v[54:55], v[10:11] op_sel_hi:[1,0]
    v_pk_mul_f32 v[58:59], v[58:59], v[10:11] op_sel_hi:[1,0]
    v_cvt_pk_bf16_f32 v18, v54, v58
    v_cvt_pk_bf16_f32 v19, v55, v59
    ds_write_b128 v3, v[16:19] offset:22208
    ds_read_b128 v[64:67], v9 offset:25600
    v_mov_b64 v[12:13], 0
    v_mov_b64 v[14:15], 0
    v_mov_b64 v[20:21], 0
    v_mov_b64 v[22:23], 0
    v_mov_b64 v[24:25], 0
    v_mov_b64 v[26:27], 0
    v_mov_b64 v[32:33], 0
    v_mov_b64 v[34:35], 0
    v_mov_b64 v[44:45], 0
    v_mov_b64 v[46:47], 0
    v_mov_b64 v[48:49], 0
    v_mov_b64 v[50:51], 0
    s_waitcnt lgkmcnt(1)
    s_barrier
    ds_read_b128 v[52:55], v4 offset:22016
    ds_read_b128 v[56:59], v4 offset:22144
    v_mov_b64 v[68:69], 0
    v_mov_b64 v[70:71], 0
    v_mov_b64 v[28:29], 0
    v_mov_b64 v[30:31], 0
    v_mov_b64 v[16:17], 0
    v_mov_b64 v[18:19], 0
    s_cmp_eq_u32 s33, 63
    s_cbranch_scc1 Lr3f_last
    s_waitcnt lgkmcnt(1)
    v_smfmac_f32_16x16x64_bf16 v[28:31], v[52:55], v[60:67], v1
    ds_read_b128 v[60:63], v0 offset:49152
    s_waitcnt lgkmcnt(1)
    v_smfmac_f32_16x16x64_bf16 v[28:31], v[56:59], v[36:43], v1
    ds_read_b128 v[64:67], v0 offset:50176
    ds_read_b128 v[36:39], v9 offset:18432
    v_smfmac_f32_16x16x64_bf16 v[12:15], v[52:55], a[176:183], v1
    ds_read_b128 v[40:43], v9 offset:19456
    v_smfmac_f32_16x16x64_bf16 v[12:15], v[56:59], a[184:191], v1
    buffer_load_dwordx4 v0, s[8:11], s41 offen offset:0 lds
    v_smfmac_f32_16x16x64_bf16 v[20:23], v[52:55], a[192:199], v1
    s_nop 0
    v_add_f32 v28, v28, v30
    v_add_f32 v29, v29, v31
    s_waitcnt lgkmcnt(2)
    v_smfmac_f32_16x16x64_bf16 v[20:23], v[56:59], v[60:67], v1
    ds_read_b128 v[60:63], v9 offset:20480
    v_cvt_pk_bf16_f32 v28, v28, v29
    v_bfi_b32 v28, 1, s39, v28
    buffer_store_dword v28, v8, s[8:11], s38 offen offset:2048
    s_waitcnt lgkmcnt(1)
    v_smfmac_f32_16x16x64_bf16 v[24:27], v[52:55], v[36:43], v1
    ds_read_b128 v[64:67], v9 offset:21504
    ds_read_b128 v[36:39], v0 offset:51200
    v_add_f32 v12, v12, v14
    v_add_f32 v13, v13, v15
    v_smfmac_f32_16x16x64_bf16 v[24:27], v[56:59], a[200:207], v1
    ds_read_b128 v[40:43], v0 offset:52224
    v_cvt_pk_bf16_f32 v12, v12, v13
    v_bfi_b32 v12, 1, s39, v12
    v_smfmac_f32_16x16x64_bf16 v[32:35], v[52:55], a[208:215], v1
    buffer_load_dwordx4 v0, s[8:11], s41 offen offset:1024 lds
    v_add_f32 v20, v20, v22
    v_add_f32 v21, v21, v23
    v_smfmac_f32_16x16x64_bf16 v[32:35], v[56:59], a[216:223], v1
    v_cvt_pk_bf16_f32 v13, v20, v21
    s_waitcnt lgkmcnt(2)
    v_smfmac_f32_16x16x64_bf16 v[44:47], v[52:55], v[60:67], v1
    ds_read_b128 v[60:63], v0 offset:53248
    v_add_f32 v24, v24, v26
    v_add_f32 v25, v25, v27
    s_waitcnt lgkmcnt(1)
    v_smfmac_f32_16x16x64_bf16 v[44:47], v[56:59], v[36:43], v1
    ds_read_b128 v[64:67], v0 offset:54272
    ds_read_b128 v[36:39], v9 offset:22528
    v_cvt_pk_bf16_f32 v14, v24, v25
    v_smfmac_f32_16x16x64_bf16 v[48:51], v[52:55], a[224:231], v1
    ds_read_b128 v[40:43], v9 offset:23552
    v_add_f32 v32, v32, v34
    v_add_f32 v33, v33, v35
    v_smfmac_f32_16x16x64_bf16 v[48:51], v[56:59], a[232:239], v1
    v_cvt_pk_bf16_f32 v15, v32, v33
    buffer_store_dwordx4 v[12:15], v0, s[8:11], s38 offen offset:0
    v_smfmac_f32_16x16x64_bf16 v[68:71], v[52:55], a[240:247], v1
    v_add_f32 v44, v44, v46
    v_add_f32 v45, v45, v47
    s_waitcnt lgkmcnt(2)
    v_smfmac_f32_16x16x64_bf16 v[68:71], v[56:59], v[60:67], v1
    v_cvt_pk_bf16_f32 v44, v44, v45
    v_bfi_b32 v44, 1, s39, v44
    s_waitcnt lgkmcnt(0)
    v_smfmac_f32_16x16x64_bf16 v[16:19], v[52:55], v[36:43], v1
    v_add_f32 v48, v48, v50
    v_add_f32 v49, v49, v51
    v_smfmac_f32_16x16x64_bf16 v[16:19], v[56:59], a[248:255], v1
    v_cvt_pk_bf16_f32 v45, v48, v49
    v_add_f32 v68, v68, v70
    v_add_f32 v69, v69, v71
    v_cvt_pk_bf16_f32 v46, v68, v69
    s_nop 3
    v_add_f32 v16, v16, v18
    v_add_f32 v17, v17, v19
    v_cvt_pk_bf16_f32 v47, v16, v17
    buffer_store_dwordx4 v[44:47], v0, s[8:11], s38 offen offset:1024
    s_xor_b32 s34, s34, 16384
    s_xor_b32 s35, s35, 16384
    s_barrier
    s_sleep 2
    buffer_load_dwordx4 v[44:47], v0, s[8:11], s34 offen sc1
    buffer_load_dwordx4 v[48:51], v0, s[8:11], s34 offen offset:1024 sc1
    buffer_load_dword v10, v8, s[8:11], s35 offen sc1
    s_add_u32 s33, s33, 1
    s_bfe_u32 s39, s33, 0x10001
    s_xor_b32 s38, s38, 524288
    s_and_b32 s17, s33, 7
    s_mul_i32 s17, s17, 131072
    s_add_u32 s43, s45, s17
    s_bfe_u32 s66, s33, 65539
    s_add_u32 s67, s67, 22528
    s_and_b32 s17, s33, 3
    s_cmp_eq_u32 s17, 3
    s_cselect_b32 s17, 1, 0
    s_cmp_eq_u32 s32, 0
    s_cselect_b32 s17, 1, s17
    s_cmp_ge_u32 s33, 7
    s_cselect_b32 s17, s17, 0
    s_cmp_lg_u32 s17, 0
    s_cselect_b64 s[78:79], -1, 0xff
    s_add_u32 s56, s56, 262144
    s_add_u32 s42, s42, 262144
    s_add_u32 s41, s41, 262144
    s_add_u32 s40, s40, 262144
    s_add_u32 s44, s44, 22528
    ds_read_b128 v[56:59], v9 offset:12288
    ds_read_b128 v[60:63], v9 offset:13312
    ds_read_b128 v[64:67], v9 offset:14336
    ds_read_b128 v[68:71], v9 offset:15360
    v_mov_b64 v[12:13], 0
    v_mov_b64 v[14:15], 0
    v_mov_b64 v[16:17], 0
    v_mov_b64 v[18:19], 0
    v_mov_b64 v[20:21], 0
    v_mov_b64 v[22:23], 0
    v_mov_b64 v[24:25], 0
    v_mov_b64 v[26:27], 0
    v_mov_b64 v[28:29], 0
    v_mov_b64 v[30:31], 0
    v_mov_b64 v[32:33], 0
    v_mov_b64 v[34:35], 0
    s_waitcnt lgkmcnt(0)
    s_branch Lr3f_step
Lr3f_flbad:
    s_cmp_eq_u32 s33, 63
    s_cbranch_scc1 Lr3f_flok
    s_mov_b32 s16, 0
Lr3f_flp:
    buffer_load_dword v6, v7, s[8:11], s67 offen sc1
    s_add_u32 s16, s16, 1
    s_cmp_gt_u32 s16, 100000
    s_cbranch_scc1 Lr_abort
    s_waitcnt vmcnt(0)
    v_cmp_eq_u32 vcc, 0, v6
    s_nop 0
    s_and_b64 vcc, vcc, s[78:79]
    s_cbranch_scc1 Lr3f_flp
    s_branch Lr3f_flok
Lr3f_last:
    s_waitcnt vmcnt(0) lgkmcnt(0)
    s_branch Lr_exit
L_slow:
    s_cmp_lg_u32 s14, 0
    s_cbranch_scc1 L_w1_0
    s_barrier
    s_mov_b32 m0, 9216
    s_nop 0
    buffer_load_dwordx4 v0, s[8:11], s41 offen offset:0 lds
    buffer_load_dwordx4 v0, s[8:11], s41 offen offset:1024 lds
    s_add_u32 s41, s41, 262144
    s_waitcnt vmcnt(0)
    buffer_load_dwordx4 v[44:47], v0, s[8:11], s34 offen sc1
    buffer_load_dwordx4 v[48:51], v0, s[8:11], s34 offen offset:1024 sc1
    buffer_load_dword v10, v8, s[8:11], s35 offen sc1
    ds_read_b128 v[56:59], v9 offset:0
    ds_read_b128 v[60:63], v9 offset:1024
    ds_read_b128 v[64:67], v9 offset:2048
    ds_read_b128 v[68:71], v9 offset:3072
    v_mov_b64 v[12:13], 0
    v_mov_b64 v[14:15], 0
    v_mov_b64 v[16:17], 0
    v_mov_b64 v[18:19], 0
    v_mov_b64 v[20:21], 0
    v_mov_b64 v[22:23], 0
    v_mov_b64 v[24:25], 0
    v_mov_b64 v[26:27], 0
    v_mov_b64 v[28:29], 0
    v_mov_b64 v[30:31], 0
    v_mov_b64 v[32:33], 0
    v_mov_b64 v[34:35], 0
    s_waitcnt lgkmcnt(0)
Lr0s_step:
    s_mov_b32 s16, 0
    s_mov_b64 s[70:71], 0
    s_mov_b64 s[72:73], 0
    s_mov_b64 s[74:75], 0
Lr0s_p2:
    s_mov_b64 exec, s[70:71]
    buffer_load_dwordx4 v[44:47], v0, s[8:11], s34 offen sc1
    s_mov_b64 exec, s[72:73]
    buffer_load_dwordx4 v[48:51], v0, s[8:11], s34 offen offset:1024 sc1
    s_mov_b64 exec, s[74:75]
    buffer_load_dword v10, v8, s[8:11], s35 offen sc1
    s_mov_b64 exec, -1
    s_add_u32 s16, s16, 1
    s_cmp_gt_u32 s16, 100000
    s_cbranch_scc1 Lr_abort
    s_waitcnt vmcnt(5)
    v_max3_u32 v11, v44, v45, v46
    v_max_u32 v11, v11, v47
    v_cmp_eq_u32 s[70:71], -1, v11
    s_waitcnt vmcnt(4)
    v_max3_u32 v11, v48, v49, v50
    v_max_u32 v11, v11, v51
    v_cmp_eq_u32 s[72:73], -1, v11
    s_waitcnt vmcnt(3)
    v_cmp_eq_u32 s[74:75], -1, v10
    s_or_b64 vcc, s[70:71], s[72:73]
    s_or_b64 vcc, vcc, s[74:75]
    s_cbranch_scc1 Lr0s_p2
    v_smfmac_f32_16x16x64_bf16 v[12:15], v[44:47], v[72:79], v1
    ds_write_b128 v0, v[44:47] offset:0
    v_smfmac_f32_16x16x64_bf16 v[16:19], v[44:47], v[80:87], v1
    ds_write_b128 v0, v[48:51] offset:1024
    v_smfmac_f32_16x16x64_bf16 v[20:23], v[44:47], v[88:95], v1
    ds_write_b32 v8, v10 offset:8192
    v_smfmac_f32_16x16x64_bf16 v[24:27], v[44:47], v[56:63], v1
    s_waitcnt lgkmcnt(0)
    s_barrier
    ds_read_b128 v[52:55], v0 offset:2048
    v_smfmac_f32_16x16x64_bf16 v[12:15], v[48:51], v[112:119], v1
    ds_read_b128 v[36:39], v0 offset:3072
    v_smfmac_f32_16x16x64_bf16 v[16:19], v[48:51], v[120:127], v1
    ds_read_b128 v[56:59], v9 offset:4096
    v_smfmac_f32_16x16x64_bf16 v[20:23], v[48:51], v[128:135], v1
    ds_read_b128 v[60:63], v9 offset:5120
    v_smfmac_f32_16x16x64_bf16 v[24:27], v[48:51], v[64:71], v1
    ds_read_b128 v[40:43], v0 offset:4096
    s_waitcnt lgkmcnt(4)
    v_smfmac_f32_16x16x64_bf16 v[12:15], v[52:55], v[152:159], v1
    v_smfmac_f32_16x16x64_bf16 v[16:19], v[52:55], v[160:167], v1
    ds_read_b128 v[64:67], v9 offset:6144
    v_smfmac_f32_16x16x64_bf16 v[20:23], v[52:55], v[168:175], v1
    ds_read_b128 v[68:71], v9 offset:7168
    s_waitcnt lgkmcnt(3)
    v_smfmac_f32_16x16x64_bf16 v[24:27], v[52:55], v[56:63], v1
    v_smfmac_f32_16x16x64_bf16 v[12:15], v[36:39], v[192:199], v1
    ds_read_b128 v[52:55], v0 offset:5120
    v_smfmac_f32_16x16x64_bf16 v[16:19], v[36:39], v[200:207], v1
    ds_read_b128 v[56:59], v9 offset:8192
    v_smfmac_f32_16x16x64_bf16 v[20:23], v[36:39], v[208:215], v1
    ds_read_b128 v[60:63], v9 offset:9216
    s_waitcnt lgkmcnt(3)
    v_smfmac_f32_16x16x64_bf16 v[24:27], v[36:39], v[64:71], v1
    v_smfmac_f32_16x16x64_bf16 v[12:15], v[40:43], v[232:239], v1
    buffer_load_dwordx4 v[36:39], v0, s[8:11], s42 offen
    v_smfmac_f32_16x16x64_bf16 v[16:19], v[40:43], v[240:247], v1
    ds_read_b128 v[64:67], v9 offset:10240
    v_smfmac_f32_16x16x64_bf16 v[20:23], v[40:43], v[248:255], v1
    ds_read_b128 v[68:71], v9 offset:11264
    s_waitcnt lgkmcnt(2)
    v_smfmac_f32_16x16x64_bf16 v[24:27], v[40:43], v[56:63], v1
    s_waitcnt vmcnt(1)
    ds_read_b128 v[44:47], v0 offset:6144
    v_smfmac_f32_16x16x64_bf16 v[12:15], v[52:55], a[16:23], v1
    buffer_load_dwordx4 v[40:43], v0, s[8:11], s42 offen offset:1024
    v_smfmac_f32_16x16x64_bf16 v[16:19], v[52:55], a[24:31], v1
    ds_read_b128 v[56:59], v9 offset:12288
    v_smfmac_f32_16x16x64_bf16 v[20:23], v[52:55], a[32:39], v1
    ds_read_b128 v[60:63], v9 offset:13312
    s_waitcnt lgkmcnt(3)
    v_smfmac_f32_16x16x64_bf16 v[24:27], v[52:55], v[64:71], v1
    ds_read_b128 v[48:51], v0 offset:7168
    s_waitcnt lgkmcnt(3)
    v_smfmac_f32_16x16x64_bf16 v[12:15], v[44:47], a[56:63], v1
    ds_read_b128 v[52:55], v0 offset:8192
    v_smfmac_f32_16x16x64_bf16 v[16:19], v[44:47], a[64:71], v1
    ds_read_b128 v[64:67], v9 offset:14336
    v_smfmac_f32_16x16x64_bf16 v[20:23], v[44:47], a[72:79], v1
    ds_read_b128 v[68:71], v9 offset:15360
    s_waitcnt lgkmcnt(4)
    v_smfmac_f32_16x16x64_bf16 v[24:27], v[44:47], v[56:63], v1
    s_waitcnt lgkmcnt(3)
    v_smfmac_f32_16x16x64_bf16 v[12:15], v[48:51], a[96:103], v1
    v_smfmac_f32_16x16x64_bf16 v[16:19], v[48:51], a[104:111], v1
    ds_read_b128 v[56:59], v9 offset:16384
    s_waitcnt lgkmcnt(3)
    v_smfmac_f32_16x16x64_bf16 v[12:15], v[52:55], a[136:143], v1
    ds_read_b128 v[60:63], v9 offset:17408
    v_smfmac_f32_16x16x64_bf16 v[16:19], v[52:55], a[144:151], v1
    v_smfmac_f32_16x16x64_bf16 v[20:23], v[48:51], a[112:119], v1
    s_waitcnt lgkmcnt(2)
    v_smfmac_f32_16x16x64_bf16 v[24:27], v[48:51], v[64:71], v1
    ds_read_b128 v[64:67], v0 offset:9216
    s_nop 1
    v_add_f32 v12, v12, v14
    v_smfmac_f32_16x16x64_bf16 v[20:23], v[52:55], a[152:159], v1
    ds_read_b128 v[68:71], v0 offset:10240
    v_add_f32 v16, v16, v18
    s_waitcnt lgkmcnt(2)
    v_smfmac_f32_16x16x64_bf16 v[24:27], v[52:55], v[56:63], v1
    ds_read_b128 v[56:59], v0 offset:11264
    v_add_f32 v13, v13, v15
    v_add_f32 v17, v17, v19
    v_cvt_pk_bf16_f32 v14, v12, v16
    v_cvt_pk_bf16_f32 v15, v13, v17
    ds_write_b32 v2, v14 offset:17408
    ds_write_b32 v2, v15 offset:17696
    v_smfmac_f32_16x16x64_bf16 v[28:31], v[52:55], a[160:167], v1
    ds_read_b128 v[60:63], v0 offset:12288
    v_add_f32 v20, v20, v22
    v_add_f32 v24, v24, v26
    v_add_f32 v21, v21, v23
    v_add_f32 v25, v25, v27
    v_smfmac_f32_16x16x64_bf16 v[32:35], v[52:55], a[168:175], v1
    ds_read_b128 v[12:15], v0 offset:0
    v_cvt_pk_bf16_f32 v22, v20, v24
    v_cvt_pk_bf16_f32 v23, v21, v25
    ds_write_b32 v2, v22 offset:19712
    ds_write_b32 v2, v23 offset:20000
    v_smfmac_f32_16x16x64_bf16 v[28:31], v[48:51], a[120:127], v1
    ds_read_b128 v[16:19], v0 offset:1024
    v_smfmac_f32_16x16x64_bf16 v[32:35], v[48:51], a[128:135], v1
    ds_read_b128 v[20:23], v0 offset:2048
    v_smfmac_f32_16x16x64_bf16 v[28:31], v[44:47], a[80:87], v1
    ds_read_b128 v[24:27], v0 offset:3072
    v_smfmac_f32_16x16x64_bf16 v[32:35], v[44:47], a[88:95], v1
    s_waitcnt lgkmcnt(3)
    s_barrier
    ds_read_b128 v[44:47], v3 offset:17408
    v_smfmac_f32_16x16x64_bf16 v[28:31], v[12:15], v[96:103], v1
    ds_read_b128 v[52:55], v0 offset:4096
    v_smfmac_f32_16x16x64_bf16 v[32:35], v[12:15], v[104:111], v1
    ds_read_b128 v[12:15], v3 offset:19712
    s_waitcnt lgkmcnt(5)
    v_smfmac_f32_16x16x64_bf16 v[28:31], v[16:19], v[136:143], v1
    ds_read_b128 v[48:51], v0 offset:5120
    v_smfmac_f32_16x16x64_bf16 v[32:35], v[16:19], v[144:151], v1
    s_waitcnt lgkmcnt(5)
    v_smfmac_f32_16x16x64_bf16 v[28:31], v[20:23], v[176:183], v1
    v_smfmac_f32_16x16x64_bf16 v[32:35], v[20:23], v[184:191], v1
    ds_read_b128 v[20:23], v3 offset:17472
    s_waitcnt lgkmcnt(5)
    v_smfmac_f32_16x16x64_bf16 v[28:31], v[24:27], v[216:223], v1
    v_smfmac_f32_16x16x64_bf16 v[32:35], v[24:27], v[224:231], v1
    s_waitcnt lgkmcnt(3)
    v_smfmac_f32_16x16x64_bf16 v[28:31], v[52:55], a[0:7], v1
    v_smfmac_f32_16x16x64_bf16 v[32:35], v[52:55], a[8:15], v1
    ds_read_b128 v[52:55], v3 offset:19776
    s_waitcnt lgkmcnt(2)
    v_smfmac_f32_16x16x64_bf16 v[28:31], v[48:51], a[40:47], v1
    v_smfmac_f32_16x16x64_bf16 v[32:35], v[48:51], a[48:55], v1
    ds_read_b128 v[48:51], v3 offset:17536
    v_mfma_f32_16x16x32_bf16 v[24:27], v[12:15], v[44:47], 0
    v_mfma_f32_16x16x32_bf16 v[12:15], v[64:67], v[44:47], 0
    ds_read_b128 v[64:67], v0 offset:13312
    v_mfma_f32_16x16x32_bf16 v[16:19], v[68:71], v[44:47], 0
    ds_read_b128 v[68:71], v0 offset:14336
    s_waitcnt lgkmcnt(3)
    v_mfma_f32_16x16x32_bf16 v[24:27], v[52:55], v[20:23], v[24:27]
    ds_read_b128 v[44:47], v3 offset:19840
    v_add_f32 v28, v28, v30
    v_add_f32 v29, v29, v31
    v_mfma_f32_16x16x32_bf16 v[12:15], v[56:59], v[20:23], v[12:15]
    ds_read_b128 v[52:55], v3 offset:17600
    v_add_f32 v32, v32, v34
    v_add_f32 v33, v33, v35
    v_mfma_f32_16x16x32_bf16 v[16:19], v[60:63], v[20:23], v[16:19]
    ds_read_b128 v[56:59], v0 offset:15360
    v_cvt_pk_bf16_f32 v30, v28, v29
    v_cvt_pk_bf16_f32 v31, v32, v33
    s_waitcnt lgkmcnt(2)
    v_mfma_f32_16x16x32_bf16 v[24:27], v[44:47], v[48:51], v[24:27]
    ds_read_b128 v[20:23], v3 offset:19904
    v_lshrrev_b32 v10, 8, v0
    v_mul_u32_u24 v10, 288, v10
    v_mfma_f32_16x16x32_bf16 v[12:15], v[64:67], v[48:51], v[12:15]
    ds_read_b128 v[60:63], v0 offset:16384
    v_and_b32 v11, 0xf0, v0
    v_add_u32 v10, v10, v11
    v_mfma_f32_16x16x32_bf16 v[16:19], v[68:71], v[48:51], v[16:19]
    ds_read_b128 v[32:35], v10 offset:19712
    v_lshrrev_b32 v11, 1, v0
    v_bfi_b32 v30, 1, s66, v30
    s_waitcnt lgkmcnt(2)
    v_mfma_f32_16x16x32_bf16 v[24:27], v[20:23], v[52:55], v[24:27]
    buffer_store_dwordx2 v[30:31], v11, s[8:11], s43 offen offset:2048 sc1
    v_mov_b32 v49, 0
    v_mov_b32 v50, 0
    v_mfma_f32_16x16x32_bf16 v[12:15], v[56:59], v[52:55], v[12:15]
    v_mov_b64 v[64:65], s[68:69]
    v_mov_b64 v[66:67], s[68:69]
    s_waitcnt lgkmcnt(1)
    v_mfma_f32_16x16x32_bf16 v[16:19], v[60:63], v[52:55], v[16:19]
    s_waitcnt lgkmcnt(0)
    v_bfi_b32 v32, 1, s66, v32
    s_mov_b64 exec, s[52:53]
    buffer_store_dwordx4 v[32:35], v0, s[8:11], s43 offen sc1
    s_mov_b64 exec, -1
    v_max3_f32 v10, v24, v25, v12
    v_max3_f32 v10, v10, v13, v14
    s_nop 0
    v_max3_f32 v10, v10, v15, v16
    v_max3_f32 v10, v10, v17, v18
    v_max_f32 v10, v10, v19
    v_mov_b32 v11, v10
    s_nop 1
    v_permlane32_swap_b32 v10, v11
    v_max_f32 v10, v10, v11
    v_mov_b32 v11, v10
    s_nop 1
    v_permlane16_swap_b32 v10, v11
    v_max_f32 v10, v10, v11
    v_mul_f32 v20, s46, v10
    v_pk_fma_f32 v[24:25], v[24:25], s[46:47], v[20:21] op_sel_hi:[1,1,0] neg_lo:[0,0,1] neg_hi:[0,0,1]
    v_pk_fma_f32 v[12:13], v[12:13], s[46:47], v[20:21] op_sel_hi:[1,1,0] neg_lo:[0,0,1] neg_hi:[0,0,1]
    v_exp_f32 v24, v24
    v_exp_f32 v25, v25
    v_pk_fma_f32 v[14:15], v[14:15], s[46:47], v[20:21] op_sel_hi:[1,1,0] neg_lo:[0,0,1] neg_hi:[0,0,1]
    v_exp_f32 v12, v12
    v_exp_f32 v13, v13
    v_pk_fma_f32 v[16:17], v[16:17], s[46:47], v[20:21] op_sel_hi:[1,1,0] neg_lo:[0,0,1] neg_hi:[0,0,1]
    v_cvt_pk_bf16_f32 v48, v24, v25
    v_exp_f32 v14, v14
    v_pk_fma_f32 v[18:19], v[18:19], s[46:47], v[20:21] op_sel_hi:[1,1,0] neg_lo:[0,0,1] neg_hi:[0,0,1]
    v_cvt_pk_bf16_f32 v51, v24, v25
    v_exp_f32 v15, v15
    v_cvt_pk_bf16_f32 v44, v12, v13
    v_exp_f32 v16, v16
    v_exp_f32 v17, v17
    v_cvt_pk_bf16_f32 v45, v14, v15
    v_exp_f32 v18, v18
    v_exp_f32 v19, v19
    v_cvt_pk_bf16_f32 v46, v16, v17
    v_cvt_pk_bf16_f32 v47, v18, v19
    v_mfma_f32_16x16x16_bf16 v[68:71], v[64:65], v[48:49], 0
    v_mfma_f32_16x16x16_bf16 v[52:55], v[30:31], v[48:49], 0
    v_mfma_f32_16x16x16_bf16 v[56:59], v[30:31], v[50:51], 0
    v_mfma_f32_16x16x32_bf16 v[68:71], v[64:67], v[44:47], v[68:71]
    s_waitcnt vmcnt(3)
    v_mfma_f32_16x16x32_bf16 v[52:55], v[36:39], v[44:47], v[52:55]
    s_waitcnt vmcnt(2)
    v_mfma_f32_16x16x32_bf16 v[56:59], v[40:43], v[44:47], v[56:59]
    ds_read_b128 v[36:39], v0 offset:30720
    ds_read_b128 v[40:43], v0 offset:31744
    ds_read_b128 v[60:63], v9 offset:24576
    s_nop 0
    v_rcp_f32 v10, v68
    s_nop 0
    v_pk_mul_f32 v[52:53], v[52:53], v[10:11] op_sel_hi:[1,0]
    s_nop 0
    v_pk_mul_f32 v[56:57], v[56:57], v[10:11] op_sel_hi:[1,0]
    v_cvt_pk_bf16_f32 v16, v52, v56
    v_cvt_pk_bf16_f32 v17, v53, v57
    v_pk_mul_f32 v[54:55], v[54:55], v[10:11] op_sel_hi:[1,0]
    v_pk_mul_f32 v[58:59], v[58:59], v[10:11] op_sel_hi:[1,0]
    v_cvt_pk_bf16_f32 v18, v54, v58
    v_cvt_pk_bf16_f32 v19, v55, v59
    ds_write_b128 v3, v[16:19] offset:22016
    ds_read_b128 v[64:67], v9 offset:25600
    v_mov_b64 v[12:13], 0
    v_mov_b64 v[14:15], 0
    v_mov_b64 v[20:21], 0
    v_mov_b64 v[22:23], 0
    v_mov_b64 v[24:25], 0
    v_mov_b64 v[26:27], 0
    v_mov_b64 v[32:33], 0
    v_mov_b64 v[34:35], 0
    v_mov_b64 v[44:45], 0
    v_mov_b64 v[46:47], 0
    v_mov_b64 v[48:49], 0
    v_mov_b64 v[50:51], 0
    s_waitcnt lgkmcnt(1)
    s_barrier
    ds_read_b128 v[52:55], v4 offset:22016
    ds_read_b128 v[56:59], v4 offset:22144
    v_mov_b64 v[68:69], 0
    v_mov_b64 v[70:71], 0
    v_mov_b64 v[28:29], 0
    v_mov_b64 v[30:31], 0
    v_mov_b64 v[16:17], 0
    v_mov_b64 v[18:19], 0
    s_cmp_eq_u32 s33, 63
    s_cbranch_scc1 Lr0s_last
    s_waitcnt lgkmcnt(1)
    v_smfmac_f32_16x16x64_bf16 v[28:31], v[52:55], v[60:67], v1
    ds_read_b128 v[60:63], v0 offset:24576
    s_waitcnt lgkmcnt(1)
    v_smfmac_f32_16x16x64_bf16 v[28:31], v[56:59], v[36:43], v1
    ds_read_b128 v[64:67], v0 offset:25600
    ds_read_b128 v[36:39], v9 offset:18432
    v_smfmac_f32_16x16x64_bf16 v[12:15], v[52:55], a[176:183], v1
    ds_read_b128 v[40:43], v9 offset:19456
    v_smfmac_f32_16x16x64_bf16 v[12:15], v[56:59], a[184:191], v1
    buffer_load_dwordx4 v0, s[8:11], s41 offen offset:0 lds
    v_smfmac_f32_16x16x64_bf16 v[20:23], v[52:55], a[192:199], v1
    s_nop 0
    v_add_f32 v28, v28, v30
    v_add_f32 v29, v29, v31
    s_waitcnt lgkmcnt(2)
    v_smfmac_f32_16x16x64_bf16 v[20:23], v[56:59], v[60:67], v1
    ds_read_b128 v[60:63], v9 offset:20480
    v_cvt_pk_bf16_f32 v28, v28, v29
    v_bfi_b32 v28, 1, s39, v28
    buffer_store_dword v28, v8, s[8:11], s38 offen offset:2048 sc1
    s_waitcnt lgkmcnt(1)
    v_smfmac_f32_16x16x64_bf16 v[24:27], v[52:55], v[36:43], v1
    ds_read_b128 v[64:67], v9 offset:21504
    ds_read_b128 v[36:39], v0 offset:26624
    v_add_f32 v12, v12, v14
    v_add_f32 v13, v13, v15
    v_smfmac_f32_16x16x64_bf16 v[24:27], v[56:59], a[200:207], v1
    ds_read_b128 v[40:43], v0 offset:27648
    v_cvt_pk_bf16_f32 v12, v12, v13
    v_bfi_b32 v12, 1, s39, v12
    v_smfmac_f32_16x16x64_bf16 v[32:35], v[52:55], a[208:215], v1
    buffer_load_dwordx4 v0, s[8:11], s41 offen offset:1024 lds
    v_add_f32 v20, v20, v22
    v_add_f32 v21, v21, v23
    v_smfmac_f32_16x16x64_bf16 v[32:35], v[56:59], a[216:223], v1
    v_cvt_pk_bf16_f32 v13, v20, v21
    s_waitcnt lgkmcnt(2)
    v_smfmac_f32_16x16x64_bf16 v[44:47], v[52:55], v[60:67], v1
    ds_read_b128 v[60:63], v0 offset:28672
    v_add_f32 v24, v24, v26
    v_add_f32 v25, v25, v27
    s_waitcnt lgkmcnt(1)
    v_smfmac_f32_16x16x64_bf16 v[44:47], v[56:59], v[36:43], v1
    ds_read_b128 v[64:67], v0 offset:29696
    ds_read_b128 v[36:39], v9 offset:22528
    v_cvt_pk_bf16_f32 v14, v24, v25
    v_smfmac_f32_16x16x64_bf16 v[48:51], v[52:55], a[224:231], v1
    ds_read_b128 v[40:43], v9 offset:23552
    v_add_f32 v32, v32, v34
    v_add_f32 v33, v33, v35
    v_smfmac_f32_16x16x64_bf16 v[48:51], v[56:59], a[232:239], v1
    v_cvt_pk_bf16_f32 v15, v32, v33
    buffer_store_dwordx4 v[12:15], v0, s[8:11], s38 offen offset:0 sc1
    v_smfmac_f32_16x16x64_bf16 v[68:71], v[52:55], a[240:247], v1
    v_add_f32 v44, v44, v46
    v_add_f32 v45, v45, v47
    s_waitcnt lgkmcnt(2)
    v_smfmac_f32_16x16x64_bf16 v[68:71], v[56:59], v[60:67], v1
    v_cvt_pk_bf16_f32 v44, v44, v45
    v_bfi_b32 v44, 1, s39, v44
    s_waitcnt lgkmcnt(0)
    v_smfmac_f32_16x16x64_bf16 v[16:19], v[52:55], v[36:43], v1
    v_add_f32 v48, v48, v50
    v_add_f32 v49, v49, v51
    v_smfmac_f32_16x16x64_bf16 v[16:19], v[56:59], a[248:255], v1
    v_cvt_pk_bf16_f32 v45, v48, v49
    v_add_f32 v68, v68, v70
    v_add_f32 v69, v69, v71
    v_cvt_pk_bf16_f32 v46, v68, v69
    s_nop 3
    v_add_f32 v16, v16, v18
    v_add_f32 v17, v17, v19
    v_cvt_pk_bf16_f32 v47, v16, v17
    buffer_store_dwordx4 v[44:47], v0, s[8:11], s38 offen offset:1024 sc1
    s_sleep 6
    buffer_load_dwordx4 v[52:55], v6, s[8:11], s57 offen sc1
    buffer_load_dwordx4 v[56:59], v6, s[8:11], s58 offen sc1
    buffer_load_dwordx4 v[60:63], v6, s[8:11], s59 offen sc1
    buffer_load_dwordx4 v[64:67], v6, s[8:11], s60 offen sc1
    v_bfe_u32 v10, v0, 4, 4
    v_mov_b32 v11, 0x3f80
    v_mov_b32 v40, 0x3f800000
    v_cmp_eq_u32 vcc, 0, v10
    v_cmp_eq_u32 s[48:49], 1, v10
    s_nop 0
    v_cndmask_b32 v36, 0, v11, vcc
    v_cndmask_b32 v36, v36, v40, s[48:49]
    v_cmp_eq_u32 vcc, 2, v10
    v_cmp_eq_u32 s[48:49], 3, v10
    s_nop 0
    v_cndmask_b32 v37, 0, v11, vcc
    v_cndmask_b32 v37, v37, v40, s[48:49]
    v_cmp_eq_u32 vcc, 4, v10
    v_cmp_eq_u32 s[48:49], 5, v10
    s_nop 0
    v_cndmask_b32 v38, 0, v11, vcc
    v_cndmask_b32 v38, v38, v40, s[48:49]
    v_cmp_eq_u32 vcc, 6, v10
    v_cmp_eq_u32 s[48:49], 7, v10
    s_nop 0
    v_cndmask_b32 v39, 0, v11, vcc
    v_cndmask_b32 v39, v39, v40, s[48:49]
    s_mov_b32 s16, 0
    s_mov_b64 s[70:71], 0
    s_mov_b64 s[72:73], 0
    s_mov_b64 s[74:75], 0
    s_mov_b64 s[76:77], 0
Lr0s_p1:
    s_mov_b64 exec, s[70:71]
    buffer_load_dwordx4 v[52:55], v6, s[8:11], s57 offen sc1
    s_mov_b64 exec, s[72:73]
    buffer_load_dwordx4 v[56:59], v6, s[8:11], s58 offen sc1
    s_mov_b64 exec, s[74:75]
    buffer_load_dwordx4 v[60:63], v6, s[8:11], s59 offen sc1
    s_mov_b64 exec, s[76:77]
    buffer_load_dwordx4 v[64:67], v6, s[8:11], s60 offen sc1
    s_mov_b64 exec, -1
    s_add_u32 s16, s16, 1
    s_cmp_gt_u32 s16, 100000
    s_cbranch_scc1 Lr_abort
    s_waitcnt vmcnt(7)
    v_and_b32 v11, 1, v52
    v_cmp_ne_u32 s[70:71], s39, v11
    v_mfma_f32_16x16x32_bf16 v[40:43], v[52:55], v[36:39], 0
    s_waitcnt vmcnt(6)
    v_and_b32 v11, 1, v56
    v_cmp_ne_u32 s[72:73], s39, v11
    v_mfma_f32_16x16x32_bf16 v[40:43], v[56:59], v[36:39], v[40:43]
    s_waitcnt vmcnt(5)
    v_and_b32 v11, 1, v60
    v_cmp_ne_u32 s[74:75], s39, v11
    v_mfma_f32_16x16x32_bf16 v[40:43], v[60:63], v[36:39], v[40:43]
    s_or_b64 vcc, s[70:71], s[72:73]
    s_waitcnt vmcnt(4)
    v_and_b32 v11, 1, v64
    v_cmp_ne_u32 s[76:77], s39, v11
    v_mfma_f32_16x16x32_bf16 v[40:43], v[64:67], v[36:39], v[40:43]
    s_or_b64 vcc, vcc, s[74:75]
    s_or_b64 vcc, vcc, s[76:77]
    s_cbranch_scc1 Lr0s_p1
    s_nop 4
    v_permlane16_swap_b32 v40, v42
    v_permlane16_swap_b32 v41, v43
    s_mov_b64 exec, s[50:51]
    v_add_f32 v40, v40, v42
    v_add_f32 v41, v41, v43
    v_cvt_pk_bf16_f32 v40, v40, v41
    v_min_u32 v40, s54, v40
    buffer_store_dword v40, v7, s[8:11], s36 offen sc1
    v_mov_b32 v41, -1
    buffer_store_dword v41, v7, s[8:11], s37 offen sc1
    s_mov_b64 exec, -1
    s_xor_b32 s34, s34, 16384
    s_xor_b32 s35, s35, 16384
    s_barrier
    s_sleep 2
    buffer_load_dwordx4 v[44:47], v0, s[8:11], s34 offen sc1
    buffer_load_dwordx4 v[48:51], v0, s[8:11], s34 offen offset:1024 sc1
    buffer_load_dword v10, v8, s[8:11], s35 offen sc1
    s_add_u32 s33, s33, 1
    s_bfe_u32 s39, s33, 0x10001
    s_xor_b32 s38, s38, 524288
    s_xor_b32 s57, s57, 524288
    s_xor_b32 s58, s58, 524288
    s_xor_b32 s59, s59, 524288
    s_xor_b32 s60, s60, 524288
    s_xor_b32 s36, s36, 16384
    s_xor_b32 s37, s37, 16384
    s_and_b32 s17, s33, 7
    s_mul_i32 s17, s17, 131072
    s_add_u32 s43, s45, s17
    s_bfe_u32 s66, s33, 65539
    s_add_u32 s67, s67, 22528
    s_add_u32 s42, s42, 262144
    s_add_u32 s41, s41, 262144
    s_add_u32 s40, s40, 262144
    s_add_u32 s44, s44, 22528
    s_waitcnt vmcnt(5)
    ds_read_b128 v[56:59], v9 offset:0
    ds_read_b128 v[60:63], v9 offset:1024
    ds_read_b128 v[64:67], v9 offset:2048
    ds_read_b128 v[68:71], v9 offset:3072
    v_mov_b64 v[12:13], 0
    v_mov_b64 v[14:15], 0
    v_mov_b64 v[16:17], 0
    v_mov_b64 v[18:19], 0
    v_mov_b64 v[20:21], 0
    v_mov_b64 v[22:23], 0
    v_mov_b64 v[24:25], 0
    v_mov_b64 v[26:27], 0
    v_mov_b64 v[28:29], 0
    v_mov_b64 v[30:31], 0
    v_mov_b64 v[32:33], 0
    v_mov_b64 v[34:35], 0
    s_waitcnt lgkmcnt(0)
    s_branch Lr0s_step
Lr0s_last:
    s_waitcnt vmcnt(0) lgkmcnt(0)
    s_branch Lr_exit
L_w1_0:
    s_cmp_lg_u32 s14, 1
    s_cbranch_scc1 L_w2_0
    s_barrier
    s_mov_b32 m0, 11264
    s_nop 0
    buffer_load_dwordx4 v0, s[8:11], s41 offen offset:0 lds
    buffer_load_dwordx4 v0, s[8:11], s41 offen offset:1024 lds
    s_add_u32 s41, s41, 262144
    s_waitcnt vmcnt(0)
    buffer_load_dwordx4 v[44:47], v0, s[8:11], s34 offen sc1
    buffer_load_dwordx4 v[48:51], v0, s[8:11], s34 offen offset:1024 sc1
    buffer_load_dword v10, v8, s[8:11], s35 offen sc1
    ds_read_b128 v[56:59], v9 offset:4096
    ds_read_b128 v[60:63], v9 offset:5120
    ds_read_b128 v[64:67], v9 offset:6144
    ds_read_b128 v[68:71], v9 offset:7168
    v_mov_b64 v[12:13], 0
    v_mov_b64 v[14:15], 0
    v_mov_b64 v[16:17], 0
    v_mov_b64 v[18:19], 0
    v_mov_b64 v[20:21], 0
    v_mov_b64 v[22:23], 0
    v_mov_b64 v[24:25], 0
    v_mov_b64 v[26:27], 0
    v_mov_b64 v[28:29], 0
    v_mov_b64 v[30:31], 0
    v_mov_b64 v[32:33], 0
    v_mov_b64 v[34:35], 0
    s_waitcnt lgkmcnt(0)
Lr1s_step:
    s_mov_b32 s16, 0
    s_mov_b64 s[70:71], 0
    s_mov_b64 s[72:73], 0
    s_mov_b64 s[74:75], 0
Lr1s_p2:
    s_mov_b64 exec, s[70:71]
    buffer_load_dwordx4 v[44:47], v0, s[8:11], s34 offen sc1
    s_mov_b64 exec, s[72:73]
    buffer_load_dwordx4 v[48:51], v0, s[8:11], s34 offen offset:1024 sc1
    s_mov_b64 exec, s[74:75]
    buffer_load_dword v10, v8, s[8:11], s35 offen sc1
    s_mov_b64 exec, -1
    s_add_u32 s16, s16, 1
    s_cmp_gt_u32 s16, 100000
    s_cbranch_scc1 Lr_abort
    s_waitcnt vmcnt(5)
    v_max3_u32 v11, v44, v45, v46
    v_max_u32 v11, v11, v47
    v_cmp_eq_u32 s[70:71], -1, v11
    s_waitcnt vmcnt(4)
    v_max3_u32 v11, v48, v49, v50
    v_max_u32 v11, v11, v51
    v_cmp_eq_u32 s[72:73], -1, v11
    s_waitcnt vmcnt(3)
    v_cmp_eq_u32 s[74:75], -1, v10
    s_or_b64 vcc, s[70:71], s[72:73]
    s_or_b64 vcc, vcc, s[74:75]
    s_cbranch_scc1 Lr1s_p2
    v_smfmac_f32_16x16x64_bf16 v[12:15], v[44:47], v[152:159], v1
    ds_write_b128 v0, v[44:47] offset:2048
    v_smfmac_f32_16x16x64_bf16 v[16:19], v[44:47], v[160:167], v1
    ds_write_b128 v0, v[48:51] offset:3072
    v_smfmac_f32_16x16x64_bf16 v[20:23], v[44:47], v[168:175], v1
    ds_write_b32 v8, v10 offset:8448
    v_smfmac_f32_16x16x64_bf16 v[24:27], v[44:47], v[56:63], v1
    s_waitcnt lgkmcnt(0)
    s_barrier
    ds_read_b128 v[52:55], v0 offset:0
    v_smfmac_f32_16x16x64_bf16 v[12:15], v[48:51], v[192:199], v1
    ds_read_b128 v[36:39], v0 offset:1024
    v_smfmac_f32_16x16x64_bf16 v[16:19], v[48:51], v[200:207], v1
    ds_read_b128 v[56:59], v9 offset:0
    v_smfmac_f32_16x16x64_bf16 v[20:23], v[48:51], v[208:215], v1
    ds_read_b128 v[60:63], v9 offset:1024
    v_smfmac_f32_16x16x64_bf16 v[24:27], v[48:51], v[64:71], v1
    ds_read_b128 v[40:43], v0 offset:4096
    s_waitcnt lgkmcnt(4)
    v_smfmac_f32_16x16x64_bf16 v[12:15], v[52:55], v[72:79], v1
    v_smfmac_f32_16x16x64_bf16 v[16:19], v[52:55], v[80:87], v1
    ds_read_b128 v[64:67], v9 offset:2048
    v_smfmac_f32_16x16x64_bf16 v[20:23], v[52:55], v[88:95], v1
    ds_read_b128 v[68:71], v9 offset:3072
    s_waitcnt lgkmcnt(3)
    v_smfmac_f32_16x16x64_bf16 v[24:27], v[52:55], v[56:63], v1
    v_smfmac_f32_16x16x64_bf16 v[12:15], v[36:39], v[112:119], v1
    ds_read_b128 v[52:55], v0 offset:5120
    v_smfmac_f32_16x16x64_bf16 v[16:19], v[36:39], v[120:127], v1
    ds_read_b128 v[56:59], v9 offset:8192
    v_smfmac_f32_16x16x64_bf16 v[20:23], v[36:39], v[128:135], v1
    ds_read_b128 v[60:63], v9 offset:9216
    s_waitcnt lgkmcnt(3)
    v_smfmac_f32_16x16x64_bf16 v[24:27], v[36:39], v[64:71], v1
    v_smfmac_f32_16x16x64_bf16 v[12:15], v[40:43], v[232:239], v1
    buffer_load_dwordx4 v[36:39], v0, s[8:11], s42 offen
    v_smfmac_f32_16x16x64_bf16 v[16:19], v[40:43], v[240:247], v1
    ds_read_b128 v[64:67], v9 offset:10240
    v_smfmac_f32_16x16x64_bf16 v[20:23], v[40:43], v[248:255], v1
    ds_read_b128 v[68:71], v9 offset:11264
    s_waitcnt lgkmcnt(2)
    v_smfmac_f32_16x16x64_bf16 v[24:27], v[40:43], v[56:63], v1
    s_waitcnt vmcnt(1)
    ds_read_b128 v[44:47], v0 offset:6144
    v_smfmac_f32_16x16x64_bf16 v[12:15], v[52:55], a[16:23], v1
    buffer_load_dwordx4 v[40:43], v0, s[8:11], s42 offen offset:1024
    v_smfmac_f32_16x16x64_bf16 v[16:19], v[52:55], a[24:31], v1
    ds_read_b128 v[56:59], v9 offset:12288
    v_smfmac_f32_16x16x64_bf16 v[20:23], v[52:55], a[32:39], v1
    ds_read_b128 v[60:63], v9 offset:13312
    s_waitcnt lgkmcnt(3)
    v_smfmac_f32_16x16x64_bf16 v[24:27], v[52:55], v[64:71], v1
    ds_read_b128 v[48:51], v0 offset:7168
    s_waitcnt lgkmcnt(3)
    v_smfmac_f32_16x16x64_bf16 v[12:15], v[44:47], a[56:63], v1
    ds_read_b128 v[52:55], v0 offset:8192
    v_smfmac_f32_16x16x64_bf16 v[16:19], v[44:47], a[64:71], v1
    ds_read_b128 v[64:67], v9 offset:14336
    v_smfmac_f32_16x16x64_bf16 v[20:23], v[44:47], a[72:79], v1
    ds_read_b128 v[68:71], v9 offset:15360
    s_waitcnt lgkmcnt(4)
    v_smfmac_f32_16x16x64_bf16 v[24:27], v[44:47], v[56:63], v1
    s_waitcnt lgkmcnt(3)
    v_smfmac_f32_16x16x64_bf16 v[12:15], v[48:51], a[96:103], v1
    v_smfmac_f32_16x16x64_bf16 v[16:19], v[48:51], a[104:111], v1
    ds_read_b128 v[56:59], v9 offset:16384
    s_waitcnt lgkmcnt(3)
    v_smfmac_f32_16x16x64_bf16 v[12:15], v[52:55], a[136:143], v1
    ds_read_b128 v[60:63], v9 offset:17408
    v_smfmac_f32_16x16x64_bf16 v[16:19], v[52:55], a[144:151], v1
    v_smfmac_f32_16x16x64_bf16 v[20:23], v[48:51], a[112:119], v1
    s_waitcnt lgkmcnt(2)
    v_smfmac_f32_16x16x64_bf16 v[24:27], v[48:51], v[64:71], v1
    ds_read_b128 v[64:67], v0 offset:9216
    s_nop 1
    v_add_f32 v12, v12, v14
    v_smfmac_f32_16x16x64_bf16 v[20:23], v[52:55], a[152:159], v1
    ds_read_b128 v[68:71], v0 offset:10240
    v_add_f32 v16, v16, v18
    s_waitcnt lgkmcnt(2)
    v_smfmac_f32_16x16x64_bf16 v[24:27], v[52:55], v[56:63], v1
    ds_read_b128 v[56:59], v0 offset:11264
    v_add_f32 v13, v13, v15
    v_add_f32 v17, v17, v19
    v_cvt_pk_bf16_f32 v14, v12, v16
    v_cvt_pk_bf16_f32 v15, v13, v17
    ds_write_b32 v2, v14 offset:17408
    ds_write_b32 v2, v15 offset:17696
    v_smfmac_f32_16x16x64_bf16 v[28:31], v[52:55], a[160:167], v1
    ds_read_b128 v[60:63], v0 offset:12288
    v_add_f32 v20, v20, v22
    v_add_f32 v24, v24, v26
    v_add_f32 v21, v21, v23
    v_add_f32 v25, v25, v27
    v_smfmac_f32_16x16x64_bf16 v[32:35], v[52:55], a[168:175], v1
    ds_read_b128 v[12:15], v0 offset:2048
    v_cvt_pk_bf16_f32 v22, v20, v24
    v_cvt_pk_bf16_f32 v23, v21, v25
    ds_write_b32 v2, v22 offset:19712
    ds_write_b32 v2, v23 offset:20000
    v_smfmac_f32_16x16x64_bf16 v[28:31], v[48:51], a[120:127], v1
    ds_read_b128 v[16:19], v0 offset:3072
    v_smfmac_f32_16x16x64_bf16 v[32:35], v[48:51], a[128:135], v1
    ds_read_b128 v[20:23], v0 offset:0
    v_smfmac_f32_16x16x64_bf16 v[28:31], v[44:47], a[80:87], v1
    ds_read_b128 v[24:27], v0 offset:1024
    v_smfmac_f32_16x16x64_bf16 v[32:35], v[44:47], a[88:95], v1
    s_waitcnt lgkmcnt(3)
    s_barrier
    ds_read_b128 v[44:47], v3 offset:17408
    v_smfmac_f32_16x16x64_bf16 v[28:31], v[12:15], v[176:183], v1
    ds_read_b128 v[52:55], v0 offset:4096
    v_smfmac_f32_16x16x64_bf16 v[32:35], v[12:15], v[184:191], v1
    ds_read_b128 v[12:15], v3 offset:19712
    s_waitcnt lgkmcnt(5)
    v_smfmac_f32_16x16x64_bf16 v[28:31], v[16:19], v[216:223], v1
    ds_read_b128 v[48:51], v0 offset:5120
    v_smfmac_f32_16x16x64_bf16 v[32:35], v[16:19], v[224:231], v1
    s_waitcnt lgkmcnt(5)
    v_smfmac_f32_16x16x64_bf16 v[28:31], v[20:23], v[96:103], v1
    v_smfmac_f32_16x16x64_bf16 v[32:35], v[20:23], v[104:111], v1
    ds_read_b128 v[20:23], v3 offset:17472
    s_waitcnt lgkmcnt(5)
    v_smfmac_f32_16x16x64_bf16 v[28:31], v[24:27], v[136:143], v1
    v_smfmac_f32_16x16x64_bf16 v[32:35], v[24:27], v[144:151], v1
    s_waitcnt lgkmcnt(3)
    v_smfmac_f32_16x16x64_bf16 v[28:31], v[52:55], a[0:7], v1
    v_smfmac_f32_16x16x64_bf16 v[32:35], v[52:55], a[8:15], v1
    ds_read_b128 v[52:55], v3 offset:19776
    s_waitcnt lgkmcnt(2)
    v_smfmac_f32_16x16x64_bf16 v[28:31], v[48:51], a[40:47], v1
    v_smfmac_f32_16x16x64_bf16 v[32:35], v[48:51], a[48:55], v1
    ds_read_b128 v[48:51], v3 offset:17536
    v_mfma_f32_16x16x32_bf16 v[24:27], v[12:15], v[44:47], 0
    v_mfma_f32_16x16x32_bf16 v[12:15], v[64:67], v[44:47], 0
    ds_read_b128 v[64:67], v0 offset:13312
    v_mfma_f32_16x16x32_bf16 v[16:19], v[68:71], v[44:47], 0
    ds_read_b128 v[68:71], v0 offset:14336
    s_waitcnt lgkmcnt(3)
    v_mfma_f32_16x16x32_bf16 v[24:27], v[52:55], v[20:23], v[24:27]
    ds_read_b128 v[44:47], v3 offset:19840
    v_add_f32 v28, v28, v30
    v_add_f32 v29, v29, v31
    v_mfma_f32_16x16x32_bf16 v[12:15], v[56:59], v[20:23], v[12:15]
    ds_read_b128 v[52:55], v3 offset:17600
    v_add_f32 v32, v32, v34
    v_add_f32 v33, v33, v35
    v_mfma_f32_16x16x32_bf16 v[16:19], v[60:63], v[20:23], v[16:19]
    ds_read_b128 v[56:59], v0 offset:15360
    v_cvt_pk_bf16_f32 v30, v28, v29
    v_cvt_pk_bf16_f32 v31, v32, v33
    s_waitcnt lgkmcnt(2)
    v_mfma_f32_16x16x32_bf16 v[24:27], v[44:47], v[48:51], v[24:27]
    ds_read_b128 v[20:23], v3 offset:19904
    v_lshrrev_b32 v10, 8, v0
    v_mul_u32_u24 v10, 288, v10
    v_mfma_f32_16x16x32_bf16 v[12:15], v[64:67], v[48:51], v[12:15]
    ds_read_b128 v[60:63], v0 offset:16384
    v_and_b32 v11, 0xf0, v0
    v_add_u32 v10, v10, v11
    v_mfma_f32_16x16x32_bf16 v[16:19], v[68:71], v[48:51], v[16:19]
    ds_read_b128 v[32:35], v10 offset:20288
    v_lshrrev_b32 v11, 1, v0
    v_bfi_b32 v30, 1, s66, v30
    s_waitcnt lgkmcnt(2)
    v_mfma_f32_16x16x32_bf16 v[24:27], v[20:23], v[52:55], v[24:27]
    buffer_store_dwordx2 v[30:31], v11, s[8:11], s43 offen offset:2048 sc1
    v_mov_b32 v49, 0
    v_mov_b32 v50, 0
    v_mfma_f32_16x16x32_bf16 v[12:15], v[56:59], v[52:55], v[12:15]
    v_mov_b64 v[64:65], s[68:69]
    v_mov_b64 v[66:67], s[68:69]
    s_waitcnt lgkmcnt(1)
    v_mfma_f32_16x16x32_bf16 v[16:19], v[60:63], v[52:55], v[16:19]
    s_waitcnt lgkmcnt(0)
    v_bfi_b32 v32, 1, s66, v32
    s_mov_b64 exec, s[52:53]
    buffer_store_dwordx4 v[32:35], v0, s[8:11], s43 offen sc1
    s_mov_b64 exec, -1
    v_max3_f32 v10, v24, v25, v12
    v_max3_f32 v10, v10, v13, v14
    s_nop 0
    v_max3_f32 v10, v10, v15, v16
    v_max3_f32 v10, v10, v17, v18
    v_max_f32 v10, v10, v19
    v_mov_b32 v11, v10
    s_nop 1
    v_permlane32_swap_b32 v10, v11
    v_max_f32 v10, v10, v11
    v_mov_b32 v11, v10
    s_nop 1
    v_permlane16_swap_b32 v10, v11
    v_max_f32 v10, v10, v11
    v_mul_f32 v20, s46, v10
    v_pk_fma_f32 v[24:25], v[24:25], s[46:47], v[20:21] op_sel_hi:[1,1,0] neg_lo:[0,0,1] neg_hi:[0,0,1]
    v_pk_fma_f32 v[12:13], v[12:13], s[46:47], v[20:21] op_sel_hi:[1,1,0] neg_lo:[0,0,1] neg_hi:[0,0,1]
    v_exp_f32 v24, v24
    v_exp_f32 v25, v25
    v_pk_fma_f32 v[14:15], v[14:15], s[46:47], v[20:21] op_sel_hi:[1,1,0] neg_lo:[0,0,1] neg_hi:[0,0,1]
    v_exp_f32 v12, v12
    v_exp_f32 v13, v13
    v_pk_fma_f32 v[16:17], v[16:17], s[46:47], v[20:21] op_sel_hi:[1,1,0] neg_lo:[0,0,1] neg_hi:[0,0,1]
    v_cvt_pk_bf16_f32 v48, v24, v25
    v_exp_f32 v14, v14
    v_pk_fma_f32 v[18:19], v[18:19], s[46:47], v[20:21] op_sel_hi:[1,1,0] neg_lo:[0,0,1] neg_hi:[0,0,1]
    v_cvt_pk_bf16_f32 v51, v24, v25
    v_exp_f32 v15, v15
    v_cvt_pk_bf16_f32 v44, v12, v13
    v_exp_f32 v16, v16
    v_exp_f32 v17, v17
    v_cvt_pk_bf16_f32 v45, v14, v15
    v_exp_f32 v18, v18
    v_exp_f32 v19, v19
    v_cvt_pk_bf16_f32 v46, v16, v17
    v_cvt_pk_bf16_f32 v47, v18, v19
    v_mfma_f32_16x16x16_bf16 v[68:71], v[64:65], v[48:49], 0
    v_mfma_f32_16x16x16_bf16 v[52:55], v[30:31], v[48:49], 0
    v_mfma_f32_16x16x16_bf16 v[56:59], v[30:31], v[50:51], 0
    v_mfma_f32_16x16x32_bf16 v[68:71], v[64:67], v[44:47], v[68:71]
    s_waitcnt vmcnt(3)
    v_mfma_f32_16x16x32_bf16 v[52:55], v[36:39], v[44:47], v[52:55]
    s_waitcnt vmcnt(2)
    v_mfma_f32_16x16x32_bf16 v[56:59], v[40:43], v[44:47], v[56:59]
    ds_read_b128 v[36:39], v0 offset:38912
    ds_read_b128 v[40:43], v0 offset:39936
    ds_read_b128 v[60:63], v9 offset:24576
    s_nop 0
    v_rcp_f32 v10, v68
    s_nop 0
    v_pk_mul_f32 v[52:53], v[52:53], v[10:11] op_sel_hi:[1,0]
    s_nop 0
    v_pk_mul_f32 v[56:57], v[56:57], v[10:11] op_sel_hi:[1,0]
    v_cvt_pk_bf16_f32 v16, v52, v56
    v_cvt_pk_bf16_f32 v17, v53, v57
    v_pk_mul_f32 v[54:55], v[54:55], v[10:11] op_sel_hi:[1,0]
    v_pk_mul_f32 v[58:59], v[58:59], v[10:11] op_sel_hi:[1,0]
    v_cvt_pk_bf16_f32 v18, v54, v58
    v_cvt_pk_bf16_f32 v19, v55, v59
    ds_write_b128 v3, v[16:19] offset:22080
    ds_read_b128 v[64:67], v9 offset:25600
    v_mov_b64 v[12:13], 0
    v_mov_b64 v[14:15], 0
    v_mov_b64 v[20:21], 0
    v_mov_b64 v[22:23], 0
    v_mov_b64 v[24:25], 0
    v_mov_b64 v[26:27], 0
    v_mov_b64 v[32:33], 0
    v_mov_b64 v[34:35], 0
    v_mov_b64 v[44:45], 0
    v_mov_b64 v[46:47], 0
    v_mov_b64 v[48:49], 0
    v_mov_b64 v[50:51], 0
    s_waitcnt lgkmcnt(1)
    s_barrier
    ds_read_b128 v[52:55], v4 offset:22016
    ds_read_b128 v[56:59], v4 offset:22144
    v_mov_b64 v[68:69], 0
    v_mov_b64 v[70:71], 0
    v_mov_b64 v[28:29], 0
    v_mov_b64 v[30:31], 0
    v_mov_b64 v[16:17], 0
    v_mov_b64 v[18:19], 0
    s_cmp_eq_u32 s33, 63
    s_cbranch_scc1 Lr1s_last
    s_waitcnt lgkmcnt(1)
    v_smfmac_f32_16x16x64_bf16 v[28:31], v[52:55], v[60:67], v1
    ds_read_b128 v[60:63], v0 offset:32768
    s_waitcnt lgkmcnt(1)
    v_smfmac_f32_16x16x64_bf16 v[28:31], v[56:59], v[36:43], v1
    ds_read_b128 v[64:67], v0 offset:33792
    ds_read_b128 v[36:39], v9 offset:18432
    v_smfmac_f32_16x16x64_bf16 v[12:15], v[52:55], a[176:183], v1
    ds_read_b128 v[40:43], v9 offset:19456
    v_smfmac_f32_16x16x64_bf16 v[12:15], v[56:59], a[184:191], v1
    buffer_load_dwordx4 v0, s[8:11], s41 offen offset:0 lds
    v_smfmac_f32_16x16x64_bf16 v[20:23], v[52:55], a[192:199], v1
    s_nop 0
    v_add_f32 v28, v28, v30
    v_add_f32 v29, v29, v31
    s_waitcnt lgkmcnt(2)
    v_smfmac_f32_16x16x64_bf16 v[20:23], v[56:59], v[60:67], v1
    ds_read_b128 v[60:63], v9 offset:20480
    v_cvt_pk_bf16_f32 v28, v28, v29
    v_bfi_b32 v28, 1, s39, v28
    buffer_store_dword v28, v8, s[8:11], s38 offen offset:2048 sc1
    s_waitcnt lgkmcnt(1)
    v_smfmac_f32_16x16x64_bf16 v[24:27], v[52:55], v[36:43], v1
    ds_read_b128 v[64:67], v9 offset:21504
    ds_read_b128 v[36:39], v0 offset:34816
    v_add_f32 v12, v12, v14
    v_add_f32 v13, v13, v15
    v_smfmac_f32_16x16x64_bf16 v[24:27], v[56:59], a[200:207], v1
    ds_read_b128 v[40:43], v0 offset:35840
    v_cvt_pk_bf16_f32 v12, v12, v13
    v_bfi_b32 v12, 1, s39, v12
    v_smfmac_f32_16x16x64_bf16 v[32:35], v[52:55], a[208:215], v1
    buffer_load_dwordx4 v0, s[8:11], s41 offen offset:1024 lds
    v_add_f32 v20, v20, v22
    v_add_f32 v21, v21, v23
    v_smfmac_f32_16x16x64_bf16 v[32:35], v[56:59], a[216:223], v1
    v_cvt_pk_bf16_f32 v13, v20, v21
    s_waitcnt lgkmcnt(2)
    v_smfmac_f32_16x16x64_bf16 v[44:47], v[52:55], v[60:67], v1
    ds_read_b128 v[60:63], v0 offset:36864
    v_add_f32 v24, v24, v26
    v_add_f32 v25, v25, v27
    s_waitcnt lgkmcnt(1)
    v_smfmac_f32_16x16x64_bf16 v[44:47], v[56:59], v[36:43], v1
    ds_read_b128 v[64:67], v0 offset:37888
    ds_read_b128 v[36:39], v9 offset:22528
    v_cvt_pk_bf16_f32 v14, v24, v25
    v_smfmac_f32_16x16x64_bf16 v[48:51], v[52:55], a[224:231], v1
    ds_read_b128 v[40:43], v9 offset:23552
    v_add_f32 v32, v32, v34
    v_add_f32 v33, v33, v35
    v_smfmac_f32_16x16x64_bf16 v[48:51], v[56:59], a[232:239], v1
    v_cvt_pk_bf16_f32 v15, v32, v33
    buffer_store_dwordx4 v[12:15], v0, s[8:11], s38 offen offset:0 sc1
    v_smfmac_f32_16x16x64_bf16 v[68:71], v[52:55], a[240:247], v1
    v_add_f32 v44, v44, v46
    v_add_f32 v45, v45, v47
    s_waitcnt lgkmcnt(2)
    v_smfmac_f32_16x16x64_bf16 v[68:71], v[56:59], v[60:67], v1
    v_cvt_pk_bf16_f32 v44, v44, v45
    v_bfi_b32 v44, 1, s39, v44
    s_waitcnt lgkmcnt(0)
    v_smfmac_f32_16x16x64_bf16 v[16:19], v[52:55], v[36:43], v1
    v_add_f32 v48, v48, v50
    v_add_f32 v49, v49, v51
    v_smfmac_f32_16x16x64_bf16 v[16:19], v[56:59], a[248:255], v1
    v_cvt_pk_bf16_f32 v45, v48, v49
    v_add_f32 v68, v68, v70
    v_add_f32 v69, v69, v71
    v_cvt_pk_bf16_f32 v46, v68, v69
    s_nop 3
    v_add_f32 v16, v16, v18
    v_add_f32 v17, v17, v19
    v_cvt_pk_bf16_f32 v47, v16, v17
    buffer_store_dwordx4 v[44:47], v0, s[8:11], s38 offen offset:1024 sc1
    s_sleep 6
    buffer_load_dwordx4 v[52:55], v6, s[8:11], s57 offen sc1
    buffer_load_dwordx4 v[56:59], v6, s[8:11], s58 offen sc1
    buffer_load_dwordx4 v[60:63], v6, s[8:11], s59 offen sc1
    buffer_load_dwordx4 v[64:67], v6, s[8:11], s60 offen sc1
    v_bfe_u32 v10, v0, 4, 4
    v_mov_b32 v11, 0x3f80
    v_mov_b32 v40, 0x3f800000
    v_cmp_eq_u32 vcc, 0, v10
    v_cmp_eq_u32 s[48:49], 1, v10
    s_nop 0
    v_cndmask_b32 v36, 0, v11, vcc
    v_cndmask_b32 v36, v36, v40, s[48:49]
    v_cmp_eq_u32 vcc, 2, v10
    v_cmp_eq_u32 s[48:49], 3, v10
    s_nop 0
    v_cndmask_b32 v37, 0, v11, vcc
    v_cndmask_b32 v37, v37, v40, s[48:49]
    v_cmp_eq_u32 vcc, 4, v10
    v_cmp_eq_u32 s[48:49], 5, v10
    s_nop 0
    v_cndmask_b32 v38, 0, v11, vcc
    v_cndmask_b32 v38, v38, v40, s[48:49]
    v_cmp_eq_u32 vcc, 6, v10
    v_cmp_eq_u32 s[48:49], 7, v10
    s_nop 0
    v_cndmask_b32 v39, 0, v11, vcc
    v_cndmask_b32 v39, v39, v40, s[48:49]
    s_mov_b32 s16, 0
    s_mov_b64 s[70:71], 0
    s_mov_b64 s[72:73], 0
    s_mov_b64 s[74:75], 0
    s_mov_b64 s[76:77], 0
Lr1s_p1:
    s_mov_b64 exec, s[70:71]
    buffer_load_dwordx4 v[52:55], v6, s[8:11], s57 offen sc1
    s_mov_b64 exec, s[72:73]
    buffer_load_dwordx4 v[56:59], v6, s[8:11], s58 offen sc1
    s_mov_b64 exec, s[74:75]
    buffer_load_dwordx4 v[60:63], v6, s[8:11], s59 offen sc1
    s_mov_b64 exec, s[76:77]
    buffer_load_dwordx4 v[64:67], v6, s[8:11], s60 offen sc1
    s_mov_b64 exec, -1
    s_add_u32 s16, s16, 1
    s_cmp_gt_u32 s16, 100000
    s_cbranch_scc1 Lr_abort
    s_waitcnt vmcnt(7)
    v_and_b32 v11, 1, v52
    v_cmp_ne_u32 s[70:71], s39, v11
    v_mfma_f32_16x16x32_bf16 v[40:43], v[52:55], v[36:39], 0
    s_waitcnt vmcnt(6)
    v_and_b32 v11, 1, v56
    v_cmp_ne_u32 s[72:73], s39, v11
    v_mfma_f32_16x16x32_bf16 v[40:43], v[56:59], v[36:39], v[40:43]
    s_waitcnt vmcnt(5)
    v_and_b32 v11, 1, v60
    v_cmp_ne_u32 s[74:75], s39, v11
    v_mfma_f32_16x16x32_bf16 v[40:43], v[60:63], v[36:39], v[40:43]
    s_or_b64 vcc, s[70:71], s[72:73]
    s_waitcnt vmcnt(4)
    v_and_b32 v11, 1, v64
    v_cmp_ne_u32 s[76:77], s39, v11
    v_mfma_f32_16x16x32_bf16 v[40:43], v[64:67], v[36:39], v[40:43]
    s_or_b64 vcc, vcc, s[74:75]
    s_or_b64 vcc, vcc, s[76:77]
    s_cbranch_scc1 Lr1s_p1
    s_nop 4
    v_permlane16_swap_b32 v40, v42
    v_permlane16_swap_b32 v41, v43
    s_mov_b64 exec, s[50:51]
    v_add_f32 v40, v40, v42
    v_add_f32 v41, v41, v43
    v_cvt_pk_bf16_f32 v40, v40, v41
    v_min_u32 v40, s54, v40
    buffer_store_dword v40, v7, s[8:11], s36 offen sc1
    v_mov_b32 v41, -1
    buffer_store_dword v41, v7, s[8:11], s37 offen sc1
    s_mov_b64 exec, -1
    s_xor_b32 s34, s34, 16384
    s_xor_b32 s35, s35, 16384
    s_barrier
    s_sleep 2
    buffer_load_dwordx4 v[44:47], v0, s[8:11], s34 offen sc1
    buffer_load_dwordx4 v[48:51], v0, s[8:11], s34 offen offset:1024 sc1
    buffer_load_dword v10, v8, s[8:11], s35 offen sc1
    s_add_u32 s33, s33, 1
    s_bfe_u32 s39, s33, 0x10001
    s_xor_b32 s38, s38, 524288
    s_xor_b32 s57, s57, 524288
    s_xor_b32 s58, s58, 524288
    s_xor_b32 s59, s59, 524288
    s_xor_b32 s60, s60, 524288
    s_xor_b32 s36, s36, 16384
    s_xor_b32 s37, s37, 16384
    s_and_b32 s17, s33, 7
    s_mul_i32 s17, s17, 131072
    s_add_u32 s43, s45, s17
    s_bfe_u32 s66, s33, 65539
    s_add_u32 s67, s67, 22528
    s_add_u32 s42, s42, 262144
    s_add_u32 s41, s41, 262144
    s_add_u32 s40, s40, 262144
    s_add_u32 s44, s44, 22528
    s_waitcnt vmcnt(5)
    ds_read_b128 v[56:59], v9 offset:4096
    ds_read_b128 v[60:63], v9 offset:5120
    ds_read_b128 v[64:67], v9 offset:6144
    ds_read_b128 v[68:71], v9 offset:7168
    v_mov_b64 v[12:13], 0
    v_mov_b64 v[14:15], 0
    v_mov_b64 v[16:17], 0
    v_mov_b64 v[18:19], 0
    v_mov_b64 v[20:21], 0
    v_mov_b64 v[22:23], 0
    v_mov_b64 v[24:25], 0
    v_mov_b64 v[26:27], 0
    v_mov_b64 v[28:29], 0
    v_mov_b64 v[30:31], 0
    v_mov_b64 v[32:33], 0
    v_mov_b64 v[34:35], 0
    s_waitcnt lgkmcnt(0)
    s_branch Lr1s_step
Lr1s_last:
    s_waitcnt vmcnt(0) lgkmcnt(0)
    s_branch Lr_exit
L_w2_0:
    s_cmp_lg_u32 s14, 2
    s_cbranch_scc1 L_w3_0
    s_barrier
    s_mov_b32 m0, 13312
    s_nop 0
    buffer_load_dwordx4 v0, s[8:11], s41 offen offset:0 lds
    buffer_load_dwordx4 v0, s[8:11], s41 offen offset:1024 lds
    s_add_u32 s41, s41, 262144
    s_waitcnt vmcnt(0)
    buffer_load_dwordx4 v[44:47], v0, s[8:11], s34 offen sc1
    buffer_load_dwordx4 v[48:51], v0, s[8:11], s34 offen offset:1024 sc1
    buffer_load_dword v10, v8, s[8:11], s35 offen sc1
    ds_read_b128 v[56:59], v9 offset:8192
    ds_read_b128 v[60:63], v9 offset:9216
    ds_read_b128 v[64:67], v9 offset:10240
    ds_read_b128 v[68:71], v9 offset:11264
    v_mov_b64 v[12:13], 0
    v_mov_b64 v[14:15], 0
    v_mov_b64 v[16:17], 0
    v_mov_b64 v[18:19], 0
    v_mov_b64 v[20:21], 0
    v_mov_b64 v[22:23], 0
    v_mov_b64 v[24:25], 0
    v_mov_b64 v[26:27], 0
    v_mov_b64 v[28:29], 0
    v_mov_b64 v[30:31], 0
    v_mov_b64 v[32:33], 0
    v_mov_b64 v[34:35], 0
    s_waitcnt lgkmcnt(0)
Lr2s_step:
    s_mov_b32 s16, 0
    s_mov_b64 s[70:71], 0
    s_mov_b64 s[72:73], 0
    s_mov_b64 s[74:75], 0
Lr2s_p2:
    s_mov_b64 exec, s[70:71]
    buffer_load_dwordx4 v[44:47], v0, s[8:11], s34 offen sc1
    s_mov_b64 exec, s[72:73]
    buffer_load_dwordx4 v[48:51], v0, s[8:11], s34 offen offset:1024 sc1
    s_mov_b64 exec, s[74:75]
    buffer_load_dword v10, v8, s[8:11], s35 offen sc1
    s_mov_b64 exec, -1
    s_add_u32 s16, s16, 1
    s_cmp_gt_u32 s16, 100000
    s_cbranch_scc1 Lr_abort
    s_waitcnt vmcnt(5)
    v_max3_u32 v11, v44, v45, v46
    v_max_u32 v11, v11, v47
    v_cmp_eq_u32 s[70:71], -1, v11
    s_waitcnt vmcnt(4)
    v_max3_u32 v11, v48, v49, v50
    v_max_u32 v11, v11, v51
    v_cmp_eq_u32 s[72:73], -1, v11
    s_waitcnt vmcnt(3)
    v_cmp_eq_u32 s[74:75], -1, v10
    s_or_b64 vcc, s[70:71], s[72:73]
    s_or_b64 vcc, vcc, s[74:75]
    s_cbranch_scc1 Lr2s_p2
    v_smfmac_f32_16x16x64_bf16 v[12:15], v[44:47], v[232:239], v1
    ds_write_b128 v0, v[44:47] offset:4096
    v_smfmac_f32_16x16x64_bf16 v[16:19], v[44:47], v[240:247], v1
    ds_write_b128 v0, v[48:51] offset:5120
    v_smfmac_f32_16x16x64_bf16 v[20:23], v[44:47], v[248:255], v1
    ds_write_b32 v8, v10 offset:8704
    v_smfmac_f32_16x16x64_bf16 v[24:27], v[44:47], v[56:63], v1
    s_waitcnt lgkmcnt(0)
    s_barrier
    ds_read_b128 v[52:55], v0 offset:0
    v_smfmac_f32_16x16x64_bf16 v[12:15], v[48:51], a[16:23], v1
    ds_read_b128 v[36:39], v0 offset:1024
    v_smfmac_f32_16x16x64_bf16 v[16:19], v[48:51], a[24:31], v1
    ds_read_b128 v[56:59], v9 offset:0
    v_smfmac_f32_16x16x64_bf16 v[20:23], v[48:51], a[32:39], v1
    ds_read_b128 v[60:63], v9 offset:1024
    v_smfmac_f32_16x16x64_bf16 v[24:27], v[48:51], v[64:71], v1
    ds_read_b128 v[40:43], v0 offset:2048
    s_waitcnt lgkmcnt(4)
    v_smfmac_f32_16x16x64_bf16 v[12:15], v[52:55], v[72:79], v1
    v_smfmac_f32_16x16x64_bf16 v[16:19], v[52:55], v[80:87], v1
    ds_read_b128 v[64:67], v9 offset:2048
    v_smfmac_f32_16x16x64_bf16 v[20:23], v[52:55], v[88:95], v1
    ds_read_b128 v[68:71], v9 offset:3072
    s_waitcnt lgkmcnt(3)
    v_smfmac_f32_16x16x64_bf16 v[24:27], v[52:55], v[56:63], v1
    v_smfmac_f32_16x16x64_bf16 v[12:15], v[36:39], v[112:119], v1
    ds_read_b128 v[52:55], v0 offset:3072
    v_smfmac_f32_16x16x64_bf16 v[16:19], v[36:39], v[120:127], v1
    ds_read_b128 v[56:59], v9 offset:4096
    v_smfmac_f32_16x16x64_bf16 v[20:23], v[36:39], v[128:135], v1
    ds_read_b128 v[60:63], v9 offset:5120
    s_waitcnt lgkmcnt(3)
    v_smfmac_f32_16x16x64_bf16 v[24:27], v[36:39], v[64:71], v1
    v_smfmac_f32_16x16x64_bf16 v[12:15], v[40:43], v[152:159], v1
    buffer_load_dwordx4 v[36:39], v0, s[8:11], s42 offen
    v_smfmac_f32_16x16x64_bf16 v[16:19], v[40:43], v[160:167], v1
    ds_read_b128 v[64:67], v9 offset:6144
    v_smfmac_f32_16x16x64_bf16 v[20:23], v[40:43], v[168:175], v1
    ds_read_b128 v[68:71], v9 offset:7168
    s_waitcnt lgkmcnt(2)
    v_smfmac_f32_16x16x64_bf16 v[24:27], v[40:43], v[56:63], v1
    s_waitcnt vmcnt(1)
    ds_read_b128 v[44:47], v0 offset:6144
    v_smfmac_f32_16x16x64_bf16 v[12:15], v[52:55], v[192:199], v1
    buffer_load_dwordx4 v[40:43], v0, s[8:11], s42 offen offset:1024
    v_smfmac_f32_16x16x64_bf16 v[16:19], v[52:55], v[200:207], v1
    ds_read_b128 v[56:59], v9 offset:12288
    v_smfmac_f32_16x16x64_bf16 v[20:23], v[52:55], v[208:215], v1
    ds_read_b128 v[60:63], v9 offset:13312
    s_waitcnt lgkmcnt(3)
    v_smfmac_f32_16x16x64_bf16 v[24:27], v[52:55], v[64:71], v1
    ds_read_b128 v[48:51], v0 offset:7168
    s_waitcnt lgkmcnt(3)
    v_smfmac_f32_16x16x64_bf16 v[12:15], v[44:47], a[56:63], v1
    ds_read_b128 v[52:55], v0 offset:8192
    v_smfmac_f32_16x16x64_bf16 v[16:19], v[44:47], a[64:71], v1
    ds_read_b128 v[64:67], v9 offset:14336
    v_smfmac_f32_16x16x64_bf16 v[20:23], v[44:47], a[72:79], v1
    ds_read_b128 v[68:71], v9 offset:15360
    s_waitcnt lgkmcnt(4)
    v_smfmac_f32_16x16x64_bf16 v[24:27], v[44:47], v[56:63], v1
    s_waitcnt lgkmcnt(3)
    v_smfmac_f32_16x16x64_bf16 v[12:15], v[48:51], a[96:103], v1
    v_smfmac_f32_16x16x64_bf16 v[16:19], v[48:51], a[104:111], v1
    ds_read_b128 v[56:59], v9 offset:16384
    s_waitcnt lgkmcnt(3)
    v_smfmac_f32_16x16x64_bf16 v[12:15], v[52:55], a[136:143], v1
    ds_read_b128 v[60:63], v9 offset:17408
    v_smfmac_f32_16x16x64_bf16 v[16:19], v[52:55], a[144:151], v1
    v_smfmac_f32_16x16x64_bf16 v[20:23], v[48:51], a[112:119], v1
    s_waitcnt lgkmcnt(2)
    v_smfmac_f32_16x16x64_bf16 v[24:27], v[48:51], v[64:71], v1
    ds_read_b128 v[64:67], v0 offset:9216
    s_nop 1
    v_add_f32 v12, v12, v14
    v_smfmac_f32_16x16x64_bf16 v[20:23], v[52:55], a[152:159], v1
    ds_read_b128 v[68:71], v0 offset:10240
    v_add_f32 v16, v16, v18
    s_waitcnt lgkmcnt(2)
    v_smfmac_f32_16x16x64_bf16 v[24:27], v[52:55], v[56:63], v1
    ds_read_b128 v[56:59], v0 offset:11264
    v_add_f32 v13, v13, v15
    v_add_f32 v17, v17, v19
    v_cvt_pk_bf16_f32 v14, v12, v16
    v_cvt_pk_bf16_f32 v15, v13, v17
    ds_write_b32 v2, v14 offset:17408
    ds_write_b32 v2, v15 offset:17696
    v_smfmac_f32_16x16x64_bf16 v[28:31], v[52:55], a[160:167], v1
    ds_read_b128 v[60:63], v0 offset:12288
    v_add_f32 v20, v20, v22
    v_add_f32 v24, v24, v26
    v_add_f32 v21, v21, v23
    v_add_f32 v25, v25, v27
    v_smfmac_f32_16x16x64_bf16 v[32:35], v[52:55], a[168:175], v1
    ds_read_b128 v[12:15], v0 offset:4096
    v_cvt_pk_bf16_f32 v22, v20, v24
    v_cvt_pk_bf16_f32 v23, v21, v25
    ds_write_b32 v2, v22 offset:19712
    ds_write_b32 v2, v23 offset:20000
    v_smfmac_f32_16x16x64_bf16 v[28:31], v[48:51], a[120:127], v1
    ds_read_b128 v[16:19], v0 offset:5120
    v_smfmac_f32_16x16x64_bf16 v[32:35], v[48:51], a[128:135], v1
    ds_read_b128 v[20:23], v0 offset:0
    v_smfmac_f32_16x16x64_bf16 v[28:31], v[44:47], a[80:87], v1
    ds_read_b128 v[24:27], v0 offset:1024
    v_smfmac_f32_16x16x64_bf16 v[32:35], v[44:47], a[88:95], v1
    s_waitcnt lgkmcnt(3)
    s_barrier
    ds_read_b128 v[44:47], v3 offset:17408
    v_smfmac_f32_16x16x64_bf16 v[28:31], v[12:15], a[0:7], v1
    ds_read_b128 v[52:55], v0 offset:2048
    v_smfmac_f32_16x16x64_bf16 v[32:35], v[12:15], a[8:15], v1
    ds_read_b128 v[12:15], v3 offset:19712
    s_waitcnt lgkmcnt(5)
    v_smfmac_f32_16x16x64_bf16 v[28:31], v[16:19], a[40:47], v1
    ds_read_b128 v[48:51], v0 offset:3072
    v_smfmac_f32_16x16x64_bf16 v[32:35], v[16:19], a[48:55], v1
    s_waitcnt lgkmcnt(5)
    v_smfmac_f32_16x16x64_bf16 v[28:31], v[20:23], v[96:103], v1
    v_smfmac_f32_16x16x64_bf16 v[32:35], v[20:23], v[104:111], v1
    ds_read_b128 v[20:23], v3 offset:17472
    s_waitcnt lgkmcnt(5)
    v_smfmac_f32_16x16x64_bf16 v[28:31], v[24:27], v[136:143], v1
    v_smfmac_f32_16x16x64_bf16 v[32:35], v[24:27], v[144:151], v1
    s_waitcnt lgkmcnt(3)
    v_smfmac_f32_16x16x64_bf16 v[28:31], v[52:55], v[176:183], v1
    v_smfmac_f32_16x16x64_bf16 v[32:35], v[52:55], v[184:191], v1
    ds_read_b128 v[52:55], v3 offset:19776
    s_waitcnt lgkmcnt(2)
    v_smfmac_f32_16x16x64_bf16 v[28:31], v[48:51], v[216:223], v1
    v_smfmac_f32_16x16x64_bf16 v[32:35], v[48:51], v[224:231], v1
    ds_read_b128 v[48:51], v3 offset:17536
    v_mfma_f32_16x16x32_bf16 v[24:27], v[12:15], v[44:47], 0
    v_mfma_f32_16x16x32_bf16 v[12:15], v[64:67], v[44:47], 0
    ds_read_b128 v[64:67], v0 offset:13312
    v_mfma_f32_16x16x32_bf16 v[16:19], v[68:71], v[44:47], 0
    ds_read_b128 v[68:71], v0 offset:14336
    s_waitcnt lgkmcnt(3)
    v_mfma_f32_16x16x32_bf16 v[24:27], v[52:55], v[20:23], v[24:27]
    ds_read_b128 v[44:47], v3 offset:19840
    v_add_f32 v28, v28, v30
    v_add_f32 v29, v29, v31
    v_mfma_f32_16x16x32_bf16 v[12:15], v[56:59], v[20:23], v[12:15]
    ds_read_b128 v[52:55], v3 offset:17600
    v_add_f32 v32, v32, v34
    v_add_f32 v33, v33, v35
    v_mfma_f32_16x16x32_bf16 v[16:19], v[60:63], v[20:23], v[16:19]
    ds_read_b128 v[56:59], v0 offset:15360
    v_cvt_pk_bf16_f32 v30, v28, v29
    v_cvt_pk_bf16_f32 v31, v32, v33
    s_waitcnt lgkmcnt(2)
    v_mfma_f32_16x16x32_bf16 v[24:27], v[44:47], v[48:51], v[24:27]
    ds_read_b128 v[20:23], v3 offset:19904
    v_lshrrev_b32 v10, 8, v0
    v_mul_u32_u24 v10, 288, v10
    v_mfma_f32_16x16x32_bf16 v[12:15], v[64:67], v[48:51], v[12:15]
    ds_read_b128 v[60:63], v0 offset:16384
    v_and_b32 v11, 0xf0, v0
    v_add_u32 v10, v10, v11
    v_mfma_f32_16x16x32_bf16 v[16:19], v[68:71], v[48:51], v[16:19]
    ds_read_b128 v[32:35], v10 offset:20864
    v_lshrrev_b32 v11, 1, v0
    v_bfi_b32 v30, 1, s66, v30
    s_waitcnt lgkmcnt(2)
    v_mfma_f32_16x16x32_bf16 v[24:27], v[20:23], v[52:55], v[24:27]
    buffer_store_dwordx2 v[30:31], v11, s[8:11], s43 offen offset:2048 sc1
    v_mov_b32 v49, 0
    v_mov_b32 v50, 0
    v_mfma_f32_16x16x32_bf16 v[12:15], v[56:59], v[52:55], v[12:15]
    v_mov_b64 v[64:65], s[68:69]
    v_mov_b64 v[66:67], s[68:69]
    s_waitcnt lgkmcnt(1)
    v_mfma_f32_16x16x32_bf16 v[16:19], v[60:63], v[52:55], v[16:19]
    s_waitcnt lgkmcnt(0)
    v_bfi_b32 v32, 1, s66, v32
    s_mov_b64 exec, s[52:53]
    buffer_store_dwordx4 v[32:35], v0, s[8:11], s43 offen sc1
    s_mov_b64 exec, -1
    v_max3_f32 v10, v24, v25, v12
    v_max3_f32 v10, v10, v13, v14
    s_nop 0
    v_max3_f32 v10, v10, v15, v16
    v_max3_f32 v10, v10, v17, v18
    v_max_f32 v10, v10, v19
    v_mov_b32 v11, v10
    s_nop 1
    v_permlane32_swap_b32 v10, v11
    v_max_f32 v10, v10, v11
    v_mov_b32 v11, v10
    s_nop 1
    v_permlane16_swap_b32 v10, v11
    v_max_f32 v10, v10, v11
    v_mul_f32 v20, s46, v10
    v_pk_fma_f32 v[24:25], v[24:25], s[46:47], v[20:21] op_sel_hi:[1,1,0] neg_lo:[0,0,1] neg_hi:[0,0,1]
    v_pk_fma_f32 v[12:13], v[12:13], s[46:47], v[20:21] op_sel_hi:[1,1,0] neg_lo:[0,0,1] neg_hi:[0,0,1]
    v_exp_f32 v24, v24
    v_exp_f32 v25, v25
    v_pk_fma_f32 v[14:15], v[14:15], s[46:47], v[20:21] op_sel_hi:[1,1,0] neg_lo:[0,0,1] neg_hi:[0,0,1]
    v_exp_f32 v12, v12
    v_exp_f32 v13, v13
    v_pk_fma_f32 v[16:17], v[16:17], s[46:47], v[20:21] op_sel_hi:[1,1,0] neg_lo:[0,0,1] neg_hi:[0,0,1]
    v_cvt_pk_bf16_f32 v48, v24, v25
    v_exp_f32 v14, v14
    v_pk_fma_f32 v[18:19], v[18:19], s[46:47], v[20:21] op_sel_hi:[1,1,0] neg_lo:[0,0,1] neg_hi:[0,0,1]
    v_cvt_pk_bf16_f32 v51, v24, v25
    v_exp_f32 v15, v15
    v_cvt_pk_bf16_f32 v44, v12, v13
    v_exp_f32 v16, v16
    v_exp_f32 v17, v17
    v_cvt_pk_bf16_f32 v45, v14, v15
    v_exp_f32 v18, v18
    v_exp_f32 v19, v19
    v_cvt_pk_bf16_f32 v46, v16, v17
    v_cvt_pk_bf16_f32 v47, v18, v19
    v_mfma_f32_16x16x16_bf16 v[68:71], v[64:65], v[48:49], 0
    v_mfma_f32_16x16x16_bf16 v[52:55], v[30:31], v[48:49], 0
    v_mfma_f32_16x16x16_bf16 v[56:59], v[30:31], v[50:51], 0
    v_mfma_f32_16x16x32_bf16 v[68:71], v[64:67], v[44:47], v[68:71]
    s_waitcnt vmcnt(3)
    v_mfma_f32_16x16x32_bf16 v[52:55], v[36:39], v[44:47], v[52:55]
    s_waitcnt vmcnt(2)
    v_mfma_f32_16x16x32_bf16 v[56:59], v[40:43], v[44:47], v[56:59]
    ds_read_b128 v[36:39], v0 offset:47104
    ds_read_b128 v[40:43], v0 offset:48128
    ds_read_b128 v[60:63], v9 offset:24576
    s_nop 0
    v_rcp_f32 v10, v68
    s_nop 0
    v_pk_mul_f32 v[52:53], v[52:53], v[10:11] op_sel_hi:[1,0]
    s_nop 0
    v_pk_mul_f32 v[56:57], v[56:57], v[10:11] op_sel_hi:[1,0]
    v_cvt_pk_bf16_f32 v16, v52, v56
    v_cvt_pk_bf16_f32 v17, v53, v57
    v_pk_mul_f32 v[54:55], v[54:55], v[10:11] op_sel_hi:[1,0]
    v_pk_mul_f32 v[58:59], v[58:59], v[10:11] op_sel_hi:[1,0]
    v_cvt_pk_bf16_f32 v18, v54, v58
    v_cvt_pk_bf16_f32 v19, v55, v59
    ds_write_b128 v3, v[16:19] offset:22144
    ds_read_b128 v[64:67], v9 offset:25600
    v_mov_b64 v[12:13], 0
    v_mov_b64 v[14:15], 0
    v_mov_b64 v[20:21], 0
    v_mov_b64 v[22:23], 0
    v_mov_b64 v[24:25], 0
    v_mov_b64 v[26:27], 0
    v_mov_b64 v[32:33], 0
    v_mov_b64 v[34:35], 0
    v_mov_b64 v[44:45], 0
    v_mov_b64 v[46:47], 0
    v_mov_b64 v[48:49], 0
    v_mov_b64 v[50:51], 0
    s_waitcnt lgkmcnt(1)
    s_barrier
    ds_read_b128 v[52:55], v4 offset:22016
    ds_read_b128 v[56:59], v4 offset:22144
    v_mov_b64 v[68:69], 0
    v_mov_b64 v[70:71], 0
    v_mov_b64 v[28:29], 0
    v_mov_b64 v[30:31], 0
    v_mov_b64 v[16:17], 0
    v_mov_b64 v[18:19], 0
    s_cmp_eq_u32 s33, 63
    s_cbranch_scc1 Lr2s_last
    s_waitcnt lgkmcnt(1)
    v_smfmac_f32_16x16x64_bf16 v[28:31], v[52:55], v[60:67], v1
    ds_read_b128 v[60:63], v0 offset:40960
    s_waitcnt lgkmcnt(1)
    v_smfmac_f32_16x16x64_bf16 v[28:31], v[56:59], v[36:43], v1
    ds_read_b128 v[64:67], v0 offset:41984
    ds_read_b128 v[36:39], v9 offset:18432
    v_smfmac_f32_16x16x64_bf16 v[12:15], v[52:55], a[176:183], v1
    ds_read_b128 v[40:43], v9 offset:19456
    v_smfmac_f32_16x16x64_bf16 v[12:15], v[56:59], a[184:191], v1
    buffer_load_dwordx4 v0, s[8:11], s41 offen offset:0 lds
    v_smfmac_f32_16x16x64_bf16 v[20:23], v[52:55], a[192:199], v1
    s_nop 0
    v_add_f32 v28, v28, v30
    v_add_f32 v29, v29, v31
    s_waitcnt lgkmcnt(2)
    v_smfmac_f32_16x16x64_bf16 v[20:23], v[56:59], v[60:67], v1
    ds_read_b128 v[60:63], v9 offset:20480
    v_cvt_pk_bf16_f32 v28, v28, v29
    v_bfi_b32 v28, 1, s39, v28
    buffer_store_dword v28, v8, s[8:11], s38 offen offset:2048 sc1
    s_waitcnt lgkmcnt(1)
    v_smfmac_f32_16x16x64_bf16 v[24:27], v[52:55], v[36:43], v1
    ds_read_b128 v[64:67], v9 offset:21504
    ds_read_b128 v[36:39], v0 offset:43008
    v_add_f32 v12, v12, v14
    v_add_f32 v13, v13, v15
    v_smfmac_f32_16x16x64_bf16 v[24:27], v[56:59], a[200:207], v1
    ds_read_b128 v[40:43], v0 offset:44032
    v_cvt_pk_bf16_f32 v12, v12, v13
    v_bfi_b32 v12, 1, s39, v12
    v_smfmac_f32_16x16x64_bf16 v[32:35], v[52:55], a[208:215], v1
    buffer_load_dwordx4 v0, s[8:11], s41 offen offset:1024 lds
    v_add_f32 v20, v20, v22
    v_add_f32 v21, v21, v23
    v_smfmac_f32_16x16x64_bf16 v[32:35], v[56:59], a[216:223], v1
    v_cvt_pk_bf16_f32 v13, v20, v21
    s_waitcnt lgkmcnt(2)
    v_smfmac_f32_16x16x64_bf16 v[44:47], v[52:55], v[60:67], v1
    ds_read_b128 v[60:63], v0 offset:45056
    v_add_f32 v24, v24, v26
    v_add_f32 v25, v25, v27
    s_waitcnt lgkmcnt(1)
    v_smfmac_f32_16x16x64_bf16 v[44:47], v[56:59], v[36:43], v1
    ds_read_b128 v[64:67], v0 offset:46080
    ds_read_b128 v[36:39], v9 offset:22528
    v_cvt_pk_bf16_f32 v14, v24, v25
    v_smfmac_f32_16x16x64_bf16 v[48:51], v[52:55], a[224:231], v1
    ds_read_b128 v[40:43], v9 offset:23552
    v_add_f32 v32, v32, v34
    v_add_f32 v33, v33, v35
    v_smfmac_f32_16x16x64_bf16 v[48:51], v[56:59], a[232:239], v1
    v_cvt_pk_bf16_f32 v15, v32, v33
    buffer_store_dwordx4 v[12:15], v0, s[8:11], s38 offen offset:0 sc1
    v_smfmac_f32_16x16x64_bf16 v[68:71], v[52:55], a[240:247], v1
    v_add_f32 v44, v44, v46
    v_add_f32 v45, v45, v47
    s_waitcnt lgkmcnt(2)
    v_smfmac_f32_16x16x64_bf16 v[68:71], v[56:59], v[60:67], v1
    v_cvt_pk_bf16_f32 v44, v44, v45
    v_bfi_b32 v44, 1, s39, v44
    s_waitcnt lgkmcnt(0)
    v_smfmac_f32_16x16x64_bf16 v[16:19], v[52:55], v[36:43], v1
    v_add_f32 v48, v48, v50
    v_add_f32 v49, v49, v51
    v_smfmac_f32_16x16x64_bf16 v[16:19], v[56:59], a[248:255], v1
    v_cvt_pk_bf16_f32 v45, v48, v49
    v_add_f32 v68, v68, v70
    v_add_f32 v69, v69, v71
    v_cvt_pk_bf16_f32 v46, v68, v69
    s_nop 3
    v_add_f32 v16, v16, v18
    v_add_f32 v17, v17, v19
    v_cvt_pk_bf16_f32 v47, v16, v17
    buffer_store_dwordx4 v[44:47], v0, s[8:11], s38 offen offset:1024 sc1
    s_cmp_eq_u32 s62, 0
    s_cbranch_scc1 Lr2s_nojob
    s_sleep 6
    buffer_load_dwordx4 v[52:55], v6, s[8:11], s57 offen sc1
    buffer_load_dwordx4 v[56:59], v6, s[8:11], s58 offen sc1
    buffer_load_dwordx4 v[60:63], v6, s[8:11], s59 offen sc1
    buffer_load_dwordx4 v[64:67], v6, s[8:11], s60 offen sc1
    v_bfe_u32 v10, v0, 4, 4
    v_mov_b32 v11, 0x3f80
    v_mov_b32 v40, 0x3f800000
    v_cmp_eq_u32 vcc, 0, v10
    v_cmp_eq_u32 s[48:49], 1, v10
    s_nop 0
    v_cndmask_b32 v36, 0, v11, vcc
    v_cndmask_b32 v36, v36, v40, s[48:49]
    v_cmp_eq_u32 vcc, 2, v10
    v_cmp_eq_u32 s[48:49], 3, v10
    s_nop 0
    v_cndmask_b32 v37, 0, v11, vcc
    v_cndmask_b32 v37, v37, v40, s[48:49]
    v_cmp_eq_u32 vcc, 4, v10
    v_cmp_eq_u32 s[48:49], 5, v10
    s_nop 0
    v_cndmask_b32 v38, 0, v11, vcc
    v_cndmask_b32 v38, v38, v40, s[48:49]
    v_cmp_eq_u32 vcc, 6, v10
    v_cmp_eq_u32 s[48:49], 7, v10
    s_nop 0
    v_cndmask_b32 v39, 0, v11, vcc
    v_cndmask_b32 v39, v39, v40, s[48:49]
    s_mov_b32 s16, 0
    s_mov_b64 s[70:71], 0
    s_mov_b64 s[72:73], 0
    s_mov_b64 s[74:75], 0
    s_mov_b64 s[76:77], 0
Lr2s_p1:
    s_mov_b64 exec, s[70:71]
    buffer_load_dwordx4 v[52:55], v6, s[8:11], s57 offen sc1
    s_mov_b64 exec, s[72:73]
    buffer_load_dwordx4 v[56:59], v6, s[8:11], s58 offen sc1
    s_mov_b64 exec, s[74:75]
    buffer_load_dwordx4 v[60:63], v6, s[8:11], s59 offen sc1
    s_mov_b64 exec, s[76:77]
    buffer_load_dwordx4 v[64:67], v6, s[8:11], s60 offen sc1
    s_mov_b64 exec, -1
    s_add_u32 s16, s16, 1
    s_cmp_gt_u32 s16, 100000
    s_cbranch_scc1 Lr_abort
    s_waitcnt vmcnt(7)
    v_xor_b32 v10, v52, v53
    v_xor_b32 v11, v54, v55
    v_or_b32 v10, v10, v11
    v_xor_b32 v11, v52, v54
    v_or_b32 v10, v10, v11
    v_xor_b32 v11, s39, v52
    v_or_b32 v10, v10, v11
    v_and_b32 v10, 1, v10
    v_cmp_ne_u32 s[70:71], 0, v10
    v_mfma_f32_16x16x32_bf16 v[40:43], v[52:55], v[36:39], 0
    s_waitcnt vmcnt(6)
    v_xor_b32 v10, v56, v57
    v_xor_b32 v11, v58, v59
    v_or_b32 v10, v10, v11
    v_xor_b32 v11, v56, v58
    v_or_b32 v10, v10, v11
    v_xor_b32 v11, s39, v56
    v_or_b32 v10, v10, v11
    v_and_b32 v10, 1, v10
    v_cmp_ne_u32 s[72:73], 0, v10
    v_mfma_f32_16x16x32_bf16 v[40:43], v[56:59], v[36:39], v[40:43]
    s_waitcnt vmcnt(5)
    v_xor_b32 v10, v60, v61
    v_xor_b32 v11, v62, v63
    v_or_b32 v10, v10, v11
    v_xor_b32 v11, v60, v62
    v_or_b32 v10, v10, v11
    v_xor_b32 v11, s39, v60
    v_or_b32 v10, v10, v11
    v_and_b32 v10, 1, v10
    v_cmp_ne_u32 s[74:75], 0, v10
    v_mfma_f32_16x16x32_bf16 v[40:43], v[60:63], v[36:39], v[40:43]
    s_or_b64 vcc, s[70:71], s[72:73]
    s_waitcnt vmcnt(4)
    v_xor_b32 v10, v64, v65
    v_xor_b32 v11, v66, v67
    v_or_b32 v10, v10, v11
    v_xor_b32 v11, v64, v66
    v_or_b32 v10, v10, v11
    v_xor_b32 v11, s39, v64
    v_or_b32 v10, v10, v11
    v_and_b32 v10, 1, v10
    v_cmp_ne_u32 s[76:77], 0, v10
    v_mfma_f32_16x16x32_bf16 v[40:43], v[64:67], v[36:39], v[40:43]
    s_or_b64 vcc, vcc, s[74:75]
    s_or_b64 vcc, vcc, s[76:77]
    s_cbranch_scc1 Lr2s_p1
    s_nop 4
    v_permlane16_swap_b32 v40, v42
    v_permlane16_swap_b32 v41, v43
    s_mov_b64 exec, s[50:51]
    v_add_f32 v40, v40, v42
    v_add_f32 v41, v41, v43
    v_cvt_pk_bf16_f32 v40, v40, v41
    v_min_u32 v40, s54, v40
    buffer_store_dword v40, v7, s[8:11], s36 offen sc1
    v_mov_b32 v41, -1
    buffer_store_dword v41, v7, s[8:11], s37 offen sc1
    s_mov_b64 exec, -1
    s_branch Lr2s_jobdone
Lr2s_nojob:
Lr2s_jobdone:
    s_xor_b32 s34, s34, 16384
    s_xor_b32 s35, s35, 16384
    s_barrier
    s_sleep 2
    buffer_load_dwordx4 v[44:47], v0, s[8:11], s34 offen sc1
    buffer_load_dwordx4 v[48:51], v0, s[8:11], s34 offen offset:1024 sc1
    buffer_load_dword v10, v8, s[8:11], s35 offen sc1
    s_add_u32 s33, s33, 1
    s_bfe_u32 s39, s33, 0x10001
    s_xor_b32 s38, s38, 524288
    s_xor_b32 s57, s57, 524288
    s_xor_b32 s58, s58, 524288
    s_xor_b32 s59, s59, 524288
    s_xor_b32 s60, s60, 524288
    s_xor_b32 s36, s36, 16384
    s_xor_b32 s37, s37, 16384
    s_and_b32 s17, s33, 7
    s_mul_i32 s17, s17, 131072
    s_add_u32 s43, s45, s17
    s_bfe_u32 s66, s33, 65539
    s_add_u32 s67, s67, 22528
    s_add_u32 s42, s42, 262144
    s_add_u32 s41, s41, 262144
    s_add_u32 s40, s40, 262144
    s_add_u32 s44, s44, 22528
    s_waitcnt vmcnt(6)
    ds_read_b128 v[56:59], v9 offset:8192
    ds_read_b128 v[60:63], v9 offset:9216
    ds_read_b128 v[64:67], v9 offset:10240
    ds_read_b128 v[68:71], v9 offset:11264
    v_mov_b64 v[12:13], 0
    v_mov_b64 v[14:15], 0
    v_mov_b64 v[16:17], 0
    v_mov_b64 v[18:19], 0
    v_mov_b64 v[20:21], 0
    v_mov_b64 v[22:23], 0
    v_mov_b64 v[24:25], 0
    v_mov_b64 v[26:27], 0
    v_mov_b64 v[28:29], 0
    v_mov_b64 v[30:31], 0
    v_mov_b64 v[32:33], 0
    v_mov_b64 v[34:35], 0
    s_waitcnt lgkmcnt(0)
    s_branch Lr2s_step
Lr2s_last:
    s_waitcnt vmcnt(0) lgkmcnt(0)
    s_branch Lr_exit
L_w3_0:
    s_mov_b32 s16, 0
    s_add_u32 s17, s44, 128
    v_and_b32 v11, 16, v8
    v_lshlrev_b32 v11, 3, v11
    v_and_or_b32 v11, v8, 12, v11
Lr3s_fw_11:
    buffer_load_dword v10, v11, s[8:11], s17 offen sc1
    s_add_u32 s16, s16, 1
    s_cmp_gt_u32 s16, 100000
    s_cbranch_scc1 Lr_abort
    s_waitcnt vmcnt(0)
    v_cmp_eq_u32 vcc, 0, v10
    s_nop 0
    s_cbranch_vccz Lr3s_fw_11d
    s_sleep 4
    s_branch Lr3s_fw_11
Lr3s_fw_11d:
    s_barrier
    s_mov_b32 m0, 15360
    s_nop 0
    buffer_load_dwordx4 v0, s[8:11], s41 offen offset:0 lds
    buffer_load_dwordx4 v0, s[8:11], s41 offen offset:1024 lds
    s_add_u32 s41, s41, 262144
    s_waitcnt vmcnt(0)
    buffer_load_dwordx4 v[44:47], v0, s[8:11], s34 offen sc1
    buffer_load_dwordx4 v[48:51], v0, s[8:11], s34 offen offset:1024 sc1
    buffer_load_dword v10, v8, s[8:11], s35 offen sc1
    ds_read_b128 v[56:59], v9 offset:12288
    ds_read_b128 v[60:63], v9 offset:13312
    ds_read_b128 v[64:67], v9 offset:14336
    ds_read_b128 v[68:71], v9 offset:15360
    v_mov_b64 v[12:13], 0
    v_mov_b64 v[14:15], 0
    v_mov_b64 v[16:17], 0
    v_mov_b64 v[18:19], 0
    v_mov_b64 v[20:21], 0
    v_mov_b64 v[22:23], 0
    v_mov_b64 v[24:25], 0
    v_mov_b64 v[26:27], 0
    v_mov_b64 v[28:29], 0
    v_mov_b64 v[30:31], 0
    v_mov_b64 v[32:33], 0
    v_mov_b64 v[34:35], 0
    s_waitcnt lgkmcnt(0)
Lr3s_step:
    s_mov_b32 s16, 0
    s_mov_b64 s[70:71], 0
    s_mov_b64 s[72:73], 0
    s_mov_b64 s[74:75], 0
Lr3s_p2:
    s_mov_b64 exec, s[70:71]
    buffer_load_dwordx4 v[44:47], v0, s[8:11], s34 offen sc1
    s_mov_b64 exec, s[72:73]
    buffer_load_dwordx4 v[48:51], v0, s[8:11], s34 offen offset:1024 sc1
    s_mov_b64 exec, s[74:75]
    buffer_load_dword v10, v8, s[8:11], s35 offen sc1
    s_mov_b64 exec, -1
    s_add_u32 s16, s16, 1
    s_cmp_gt_u32 s16, 100000
    s_cbranch_scc1 Lr_abort
    s_waitcnt vmcnt(5)
    v_max3_u32 v11, v44, v45, v46
    v_max_u32 v11, v11, v47
    v_cmp_eq_u32 s[70:71], -1, v11
    s_waitcnt vmcnt(4)
    v_max3_u32 v11, v48, v49, v50
    v_max_u32 v11, v11, v51
    v_cmp_eq_u32 s[72:73], -1, v11
    s_waitcnt vmcnt(3)
    v_cmp_eq_u32 s[74:75], -1, v10
    s_or_b64 vcc, s[70:71], s[72:73]
    s_or_b64 vcc, vcc, s[74:75]
    s_cbranch_scc1 Lr3s_p2
    v_smfmac_f32_16x16x64_bf16 v[12:15], v[44:47], a[56:63], v1
    ds_write_b128 v0, v[44:47] offset:6144
    v_smfmac_f32_16x16x64_bf16 v[16:19], v[44:47], a[64:71], v1
    ds_write_b128 v0, v[48:51] offset:7168
    v_smfmac_f32_16x16x64_bf16 v[20:23], v[44:47], a[72:79], v1
    ds_write_b32 v8, v10 offset:8960
    v_smfmac_f32_16x16x64_bf16 v[24:27], v[44:47], v[56:63], v1
    s_waitcnt lgkmcnt(0)
    s_barrier
    ds_read_b128 v[52:55], v0 offset:0
    v_smfmac_f32_16x16x64_bf16 v[12:15], v[48:51], a[96:103], v1
    ds_read_b128 v[36:39], v0 offset:1024
    v_smfmac_f32_16x16x64_bf16 v[16:19], v[48:51], a[104:111], v1
    ds_read_b128 v[56:59], v9 offset:0
    v_smfmac_f32_16x16x64_bf16 v[20:23], v[48:51], a[112:119], v1
    ds_read_b128 v[60:63], v9 offset:1024
    v_smfmac_f32_16x16x64_bf16 v[24:27], v[48:51], v[64:71], v1
    ds_read_b128 v[40:43], v0 offset:2048
    s_waitcnt lgkmcnt(4)
    v_smfmac_f32_16x16x64_bf16 v[12:15], v[52:55], v[72:79], v1
    buffer_load_dword v6, v7, s[8:11], s67 offen sc1
    v_smfmac_f32_16x16x64_bf16 v[16:19], v[52:55], v[80:87], v1
    ds_read_b128 v[64:67], v9 offset:2048
    v_smfmac_f32_16x16x64_bf16 v[20:23], v[52:55], v[88:95], v1
    ds_read_b128 v[68:71], v9 offset:3072
    s_waitcnt lgkmcnt(3)
    v_smfmac_f32_16x16x64_bf16 v[24:27], v[52:55], v[56:63], v1
    v_smfmac_f32_16x16x64_bf16 v[12:15], v[36:39], v[112:119], v1
    ds_read_b128 v[52:55], v0 offset:3072
    v_smfmac_f32_16x16x64_bf16 v[16:19], v[36:39], v[120:127], v1
    ds_read_b128 v[56:59], v9 offset:4096
    v_smfmac_f32_16x16x64_bf16 v[20:23], v[36:39], v[128:135], v1
    ds_read_b128 v[60:63], v9 offset:5120
    s_waitcnt lgkmcnt(3)
    v_smfmac_f32_16x16x64_bf16 v[24:27], v[36:39], v[64:71], v1
    v_smfmac_f32_16x16x64_bf16 v[12:15], v[40:43], v[152:159], v1
    buffer_load_dwordx4 v[36:39], v0, s[8:11], s42 offen
    v_smfmac_f32_16x16x64_bf16 v[16:19], v[40:43], v[160:167], v1
    ds_read_b128 v[64:67], v9 offset:6144
    v_smfmac_f32_16x16x64_bf16 v[20:23], v[40:43], v[168:175], v1
    ds_read_b128 v[68:71], v9 offset:7168
    s_waitcnt lgkmcnt(2)
    v_smfmac_f32_16x16x64_bf16 v[24:27], v[40:43], v[56:63], v1
    s_waitcnt vmcnt(2)
    ds_read_b128 v[44:47], v0 offset:4096
    v_smfmac_f32_16x16x64_bf16 v[12:15], v[52:55], v[192:199], v1
    buffer_load_dwordx4 v[40:43], v0, s[8:11], s42 offen offset:1024
    v_smfmac_f32_16x16x64_bf16 v[16:19], v[52:55], v[200:207], v1
    ds_read_b128 v[56:59], v9 offset:8192
    v_smfmac_f32_16x16x64_bf16 v[20:23], v[52:55], v[208:215], v1
    ds_read_b128 v[60:63], v9 offset:9216
    s_waitcnt lgkmcnt(3)
    v_smfmac_f32_16x16x64_bf16 v[24:27], v[52:55], v[64:71], v1
    ds_read_b128 v[48:51], v0 offset:5120
    s_waitcnt lgkmcnt(3)
    v_smfmac_f32_16x16x64_bf16 v[12:15], v[44:47], v[232:239], v1
    ds_read_b128 v[52:55], v0 offset:8192
    v_smfmac_f32_16x16x64_bf16 v[16:19], v[44:47], v[240:247], v1
    ds_read_b128 v[64:67], v9 offset:10240
    v_smfmac_f32_16x16x64_bf16 v[20:23], v[44:47], v[248:255], v1
    ds_read_b128 v[68:71], v9 offset:11264
    s_waitcnt lgkmcnt(4)
    v_smfmac_f32_16x16x64_bf16 v[24:27], v[44:47], v[56:63], v1
    s_waitcnt lgkmcnt(3)
    v_smfmac_f32_16x16x64_bf16 v[12:15], v[48:51], a[16:23], v1
    v_smfmac_f32_16x16x64_bf16 v[16:19], v[48:51], a[24:31], v1
    ds_read_b128 v[56:59], v9 offset:16384
    s_waitcnt lgkmcnt(3)
    v_smfmac_f32_16x16x64_bf16 v[12:15], v[52:55], a[136:143], v1
    ds_read_b128 v[60:63], v9 offset:17408
    v_smfmac_f32_16x16x64_bf16 v[16:19], v[52:55], a[144:151], v1
    v_smfmac_f32_16x16x64_bf16 v[20:23], v[48:51], a[32:39], v1
    s_waitcnt lgkmcnt(2)
    v_smfmac_f32_16x16x64_bf16 v[24:27], v[48:51], v[64:71], v1
    ds_read_b128 v[64:67], v0 offset:9216
    s_nop 1
    v_add_f32 v12, v12, v14
    v_smfmac_f32_16x16x64_bf16 v[20:23], v[52:55], a[152:159], v1
    ds_read_b128 v[68:71], v0 offset:10240
    v_add_f32 v16, v16, v18
    s_waitcnt lgkmcnt(2)
    v_smfmac_f32_16x16x64_bf16 v[24:27], v[52:55], v[56:63], v1
    ds_read_b128 v[56:59], v0 offset:11264
    v_add_f32 v13, v13, v15
    v_add_f32 v17, v17, v19
    v_cvt_pk_bf16_f32 v14, v12, v16
    v_cvt_pk_bf16_f32 v15, v13, v17
    ds_write_b32 v2, v14 offset:17408
    ds_write_b32 v2, v15 offset:17696
    v_smfmac_f32_16x16x64_bf16 v[28:31], v[52:55], a[160:167], v1
    ds_read_b128 v[60:63], v0 offset:12288
    v_add_f32 v20, v20, v22
    v_add_f32 v24, v24, v26
    v_add_f32 v21, v21, v23
    v_add_f32 v25, v25, v27
    v_smfmac_f32_16x16x64_bf16 v[32:35], v[52:55], a[168:175], v1
    ds_read_b128 v[12:15], v0 offset:6144
    v_cvt_pk_bf16_f32 v22, v20, v24
    v_cvt_pk_bf16_f32 v23, v21, v25
    ds_write_b32 v2, v22 offset:19712
    ds_write_b32 v2, v23 offset:20000
    v_smfmac_f32_16x16x64_bf16 v[28:31], v[48:51], a[40:47], v1
    ds_read_b128 v[16:19], v0 offset:7168
    v_smfmac_f32_16x16x64_bf16 v[32:35], v[48:51], a[48:55], v1
    ds_read_b128 v[20:23], v0 offset:0
    v_smfmac_f32_16x16x64_bf16 v[28:31], v[44:47], a[0:7], v1
    ds_read_b128 v[24:27], v0 offset:1024
    v_smfmac_f32_16x16x64_bf16 v[32:35], v[44:47], a[8:15], v1
    s_waitcnt lgkmcnt(3)
    s_barrier
    ds_read_b128 v[44:47], v3 offset:17408
    v_smfmac_f32_16x16x64_bf16 v[28:31], v[12:15], a[80:87], v1
    ds_read_b128 v[52:55], v0 offset:2048
    v_smfmac_f32_16x16x64_bf16 v[32:35], v[12:15], a[88:95], v1
    ds_read_b128 v[12:15], v3 offset:19712
    s_waitcnt lgkmcnt(5)
    v_smfmac_f32_16x16x64_bf16 v[28:31], v[16:19], a[120:127], v1
    ds_read_b128 v[48:51], v0 offset:3072
    v_smfmac_f32_16x16x64_bf16 v[32:35], v[16:19], a[128:135], v1
    s_waitcnt lgkmcnt(5)
    v_smfmac_f32_16x16x64_bf16 v[28:31], v[20:23], v[96:103], v1
    v_smfmac_f32_16x16x64_bf16 v[32:35], v[20:23], v[104:111], v1
    ds_read_b128 v[20:23], v3 offset:17472
    s_waitcnt lgkmcnt(5)
    v_smfmac_f32_16x16x64_bf16 v[28:31], v[24:27], v[136:143], v1
    v_smfmac_f32_16x16x64_bf16 v[32:35], v[24:27], v[144:151], v1
    s_waitcnt lgkmcnt(3)
    v_smfmac_f32_16x16x64_bf16 v[28:31], v[52:55], v[176:183], v1
    v_smfmac_f32_16x16x64_bf16 v[32:35], v[52:55], v[184:191], v1
    ds_read_b128 v[52:55], v3 offset:19776
    s_waitcnt lgkmcnt(2)
    v_smfmac_f32_16x16x64_bf16 v[28:31], v[48:51], v[216:223], v1
    v_smfmac_f32_16x16x64_bf16 v[32:35], v[48:51], v[224:231], v1
    ds_read_b128 v[48:51], v3 offset:17536
    v_mfma_f32_16x16x32_bf16 v[24:27], v[12:15], v[44:47], 0
    s_waitcnt vmcnt(2)
    v_cmp_eq_u32 vcc, 0, v6
    s_nop 0
    s_and_b64 vcc, vcc, s[78:79]
    s_cbranch_scc1 Lr3s_flbad
Lr3s_flok:
    s_mov_b32 m0, 24320
    s_nop 0
    buffer_load_dword v5, s[8:11], s40 offen lds
    buffer_load_dword v5, s[8:11], s56 offen lds
    s_mov_b32 m0, 15360
    v_mfma_f32_16x16x32_bf16 v[12:15], v[64:67], v[44:47], 0
    ds_read_b128 v[64:67], v0 offset:13312
    v_mfma_f32_16x16x32_bf16 v[16:19], v[68:71], v[44:47], 0
    ds_read_b128 v[68:71], v0 offset:14336
    s_waitcnt lgkmcnt(3)
    v_mfma_f32_16x16x32_bf16 v[24:27], v[52:55], v[20:23], v[24:27]
    ds_read_b128 v[44:47], v3 offset:19840
    v_add_f32 v28, v28, v30
    v_add_f32 v29, v29, v31
    v_mfma_f32_16x16x32_bf16 v[12:15], v[56:59], v[20:23], v[12:15]
    ds_read_b128 v[52:55], v3 offset:17600
    v_add_f32 v32, v32, v34
    v_add_f32 v33, v33, v35
    v_mfma_f32_16x16x32_bf16 v[16:19], v[60:63], v[20:23], v[16:19]
    ds_read_b128 v[56:59], v0 offset:15360
    v_cvt_pk_bf16_f32 v30, v28, v29
    v_cvt_pk_bf16_f32 v31, v32, v33
    s_waitcnt lgkmcnt(2)
    v_mfma_f32_16x16x32_bf16 v[24:27], v[44:47], v[48:51], v[24:27]
    ds_read_b128 v[20:23], v3 offset:19904
    v_lshrrev_b32 v10, 8, v0
    v_mul_u32_u24 v10, 288, v10
    v_mfma_f32_16x16x32_bf16 v[12:15], v[64:67], v[48:51], v[12:15]
    ds_read_b128 v[60:63], v0 offset:16384
    v_and_b32 v11, 0xf0, v0
    v_add_u32 v10, v10, v11
    v_mfma_f32_16x16x32_bf16 v[16:19], v[68:71], v[48:51], v[16:19]
    ds_read_b128 v[32:35], v10 offset:21440
    v_lshrrev_b32 v11, 1, v0
    v_bfi_b32 v30, 1, s66, v30
    s_waitcnt lgkmcnt(2)
    v_mfma_f32_16x16x32_bf16 v[24:27], v[20:23], v[52:55], v[24:27]
    buffer_store_dwordx2 v[30:31], v11, s[8:11], s43 offen offset:2048 sc1
    v_mov_b32 v49, 0
    v_mov_b32 v50, 0
    v_mfma_f32_16x16x32_bf16 v[12:15], v[56:59], v[52:55], v[12:15]
    v_mov_b64 v[64:65], s[68:69]
    v_mov_b64 v[66:67], s[68:69]
    s_waitcnt lgkmcnt(1)
    v_mfma_f32_16x16x32_bf16 v[16:19], v[60:63], v[52:55], v[16:19]
    s_waitcnt lgkmcnt(0)
    v_bfi_b32 v32, 1, s66, v32
    s_mov_b64 exec, s[52:53]
    buffer_store_dwordx4 v[32:35], v0, s[8:11], s43 offen sc1
    s_mov_b64 exec, -1
    v_max3_f32 v10, v24, v25, v12
    v_max3_f32 v10, v10, v13, v14
    s_nop 0
    v_max3_f32 v10, v10, v15, v16
    v_max3_f32 v10, v10, v17, v18
    v_max_f32 v10, v10, v19
    v_mov_b32 v11, v10
    s_nop 1
    v_permlane32_swap_b32 v10, v11
    v_max_f32 v10, v10, v11
    v_mov_b32 v11, v10
    s_nop 1
    v_permlane16_swap_b32 v10, v11
    v_max_f32 v10, v10, v11
    v_mul_f32 v20, s46, v10
    v_pk_fma_f32 v[24:25], v[24:25], s[46:47], v[20:21] op_sel_hi:[1,1,0] neg_lo:[0,0,1] neg_hi:[0,0,1]
    v_pk_fma_f32 v[12:13], v[12:13], s[46:47], v[20:21] op_sel_hi:[1,1,0] neg_lo:[0,0,1] neg_hi:[0,0,1]
    v_exp_f32 v24, v24
    v_exp_f32 v25, v25
    v_pk_fma_f32 v[14:15], v[14:15], s[46:47], v[20:21] op_sel_hi:[1,1,0] neg_lo:[0,0,1] neg_hi:[0,0,1]
    v_exp_f32 v12, v12
    v_exp_f32 v13, v13
    v_pk_fma_f32 v[16:17], v[16:17], s[46:47], v[20:21] op_sel_hi:[1,1,0] neg_lo:[0,0,1] neg_hi:[0,0,1]
    v_cvt_pk_bf16_f32 v48, v24, v25
    v_exp_f32 v14, v14
    v_pk_fma_f32 v[18:19], v[18:19], s[46:47], v[20:21] op_sel_hi:[1,1,0] neg_lo:[0,0,1] neg_hi:[0,0,1]
    v_cvt_pk_bf16_f32 v51, v24, v25
    v_exp_f32 v15, v15
    v_cvt_pk_bf16_f32 v44, v12, v13
    v_exp_f32 v16, v16
    v_exp_f32 v17, v17
    v_cvt_pk_bf16_f32 v45, v14, v15
    v_exp_f32 v18, v18
    v_exp_f32 v19, v19
    v_cvt_pk_bf16_f32 v46, v16, v17
    v_cvt_pk_bf16_f32 v47, v18, v19
    v_mfma_f32_16x16x16_bf16 v[68:71], v[64:65], v[48:49], 0
    v_mfma_f32_16x16x16_bf16 v[52:55], v[30:31], v[48:49], 0
    v_mfma_f32_16x16x16_bf16 v[56:59], v[30:31], v[50:51], 0
    v_mfma_f32_16x16x32_bf16 v[68:71], v[64:67], v[44:47], v[68:71]
    s_waitcnt vmcnt(5)
    v_mfma_f32_16x16x32_bf16 v[52:55], v[36:39], v[44:47], v[52:55]
    s_waitcnt vmcnt(4)
    v_mfma_f32_16x16x32_bf16 v[56:59], v[40:43], v[44:47], v[56:59]
    ds_read_b128 v[36:39], v0 offset:55296
    ds_read_b128 v[40:43], v0 offset:56320
    ds_read_b128 v[60:63], v9 offset:24576
    s_nop 0
    v_rcp_f32 v10, v68
    s_nop 0
    v_pk_mul_f32 v[52:53], v[52:53], v[10:11] op_sel_hi:[1,0]
    s_nop 0
    v_pk_mul_f32 v[56:57], v[56:57], v[10:11] op_sel_hi:[1,0]
    v_cvt_pk_bf16_f32 v16, v52, v56
    v_cvt_pk_bf16_f32 v17, v53, v57
    v_pk_mul_f32 v[54:55], v[54:55], v[10:11] op_sel_hi:[1,0]
    v_pk_mul_f32 v[58:59], v[58:59], v[10:11] op_sel_hi:[1,0]
    v_cvt_pk_bf16_f32 v18, v54, v58
    v_cvt_pk_bf16_f32 v19, v55, v59
    ds_write_b128 v3, v[16:19] offset:22208
    ds_read_b128 v[64:67], v9 offset:25600
    v_mov_b64 v[12:13], 0
    v_mov_b64 v[14:15], 0
    v_mov_b64 v[20:21], 0
    v_mov_b64 v[22:23], 0
    v_mov_b64 v[24:25], 0
    v_mov_b64 v[26:27], 0
    v_mov_b64 v[32:33], 0
    v_mov_b64 v[34:35], 0
    v_mov_b64 v[44:45], 0
    v_mov_b64 v[46:47], 0
    v_mov_b64 v[48:49], 0
    v_mov_b64 v[50:51], 0
    s_waitcnt lgkmcnt(1)
    s_barrier
    ds_read_b128 v[52:55], v4 offset:22016
    ds_read_b128 v[56:59], v4 offset:22144
    v_mov_b64 v[68:69], 0
    v_mov_b64 v[70:71], 0
    v_mov_b64 v[28:29], 0
    v_mov_b64 v[30:31], 0
    v_mov_b64 v[16:17], 0
    v_mov_b64 v[18:19], 0
    s_cmp_eq_u32 s33, 63
    s_cbranch_scc1 Lr3s_last
    s_waitcnt lgkmcnt(1)
    v_smfmac_f32_16x16x64_bf16 v[28:31], v[52:55], v[60:67], v1
    ds_read_b128 v[60:63], v0 offset:49152
    s_waitcnt lgkmcnt(1)
    v_smfmac_f32_16x16x64_bf16 v[28:31], v[56:59], v[36:43], v1
    ds_read_b128 v[64:67], v0 offset:50176
    ds_read_b128 v[36:39], v9 offset:18432
    v_smfmac_f32_16x16x64_bf16 v[12:15], v[52:55], a[176:183], v1
    ds_read_b128 v[40:43], v9 offset:19456
    v_smfmac_f32_16x16x64_bf16 v[12:15], v[56:59], a[184:191], v1
    buffer_load_dwordx4 v0, s[8:11], s41 offen offset:0 lds
    v_smfmac_f32_16x16x64_bf16 v[20:23], v[52:55], a[192:199], v1
    s_nop 0
    v_add_f32 v28, v28, v30
    v_add_f32 v29, v29, v31
    s_waitcnt lgkmcnt(2)
    v_smfmac_f32_16x16x64_bf16 v[20:23], v[56:59], v[60:67], v1
    ds_read_b128 v[60:63], v9 offset:20480
    v_cvt_pk_bf16_f32 v28, v28, v29
    v_bfi_b32 v28, 1, s39, v28
    buffer_store_dword v28, v8, s[8:11], s38 offen offset:2048 sc1
    s_waitcnt lgkmcnt(1)
    v_smfmac_f32_16x16x64_bf16 v[24:27], v[52:55], v[36:43], v1
    ds_read_b128 v[64:67], v9 offset:21504
    ds_read_b128 v[36:39], v0 offset:51200
    v_add_f32 v12, v12, v14
    v_add_f32 v13, v13, v15
    v_smfmac_f32_16x16x64_bf16 v[24:27], v[56:59], a[200:207], v1
    ds_read_b128 v[40:43], v0 offset:52224
    v_cvt_pk_bf16_f32 v12, v12, v13
    v_bfi_b32 v12, 1, s39, v12
    v_smfmac_f32_16x16x64_bf16 v[32:35], v[52:55], a[208:215], v1
    buffer_load_dwordx4 v0, s[8:11], s41 offen offset:1024 lds
    v_add_f32 v20, v20, v22
    v_add_f32 v21, v21, v23
    v_smfmac_f32_16x16x64_bf16 v[32:35], v[56:59], a[216:223], v1
    v_cvt_pk_bf16_f32 v13, v20, v21
    s_waitcnt lgkmcnt(2)
    v_smfmac_f32_16x16x64_bf16 v[44:47], v[52:55], v[60:67], v1
    ds_read_b128 v[60:63], v0 offset:53248
    v_add_f32 v24, v24, v26
    v_add_f32 v25, v25, v27
    s_waitcnt lgkmcnt(1)
    v_smfmac_f32_16x16x64_bf16 v[44:47], v[56:59], v[36:43], v1
    ds_read_b128 v[64:67], v0 offset:54272
    ds_read_b128 v[36:39], v9 offset:22528
    v_cvt_pk_bf16_f32 v14, v24, v25
    v_smfmac_f32_16x16x64_bf16 v[48:51], v[52:55], a[224:231], v1
    ds_read_b128 v[40:43], v9 offset:23552
    v_add_f32 v32, v32, v34
    v_add_f32 v33, v33, v35
    v_smfmac_f32_16x16x64_bf16 v[48:51], v[56:59], a[232:239], v1
    v_cvt_pk_bf16_f32 v15, v32, v33
    buffer_store_dwordx4 v[12:15], v0, s[8:11], s38 offen offset:0 sc1
    v_smfmac_f32_16x16x64_bf16 v[68:71], v[52:55], a[240:247], v1
    v_add_f32 v44, v44, v46
    v_add_f32 v45, v45, v47
    s_waitcnt lgkmcnt(2)
    v_smfmac_f32_16x16x64_bf16 v[68:71], v[56:59], v[60:67], v1
    v_cvt_pk_bf16_f32 v44, v44, v45
    v_bfi_b32 v44, 1, s39, v44
    s_waitcnt lgkmcnt(0)
    v_smfmac_f32_16x16x64_bf16 v[16:19], v[52:55], v[36:43], v1
    v_add_f32 v48, v48, v50
    v_add_f32 v49, v49, v51
    v_smfmac_f32_16x16x64_bf16 v[16:19], v[56:59], a[248:255], v1
    v_cvt_pk_bf16_f32 v45, v48, v49
    v_add_f32 v68, v68, v70
    v_add_f32 v69, v69, v71
    v_cvt_pk_bf16_f32 v46, v68, v69
    s_nop 3
    v_add_f32 v16, v16, v18
    v_add_f32 v17, v17, v19
    v_cvt_pk_bf16_f32 v47, v16, v17
    buffer_store_dwordx4 v[44:47], v0, s[8:11], s38 offen offset:1024 sc1
    s_xor_b32 s34, s34, 16384
    s_xor_b32 s35, s35, 16384
    s_barrier
    s_sleep 2
    buffer_load_dwordx4 v[44:47], v0, s[8:11], s34 offen sc1
    buffer_load_dwordx4 v[48:51], v0, s[8:11], s34 offen offset:1024 sc1
    buffer_load_dword v10, v8, s[8:11], s35 offen sc1
    s_add_u32 s33, s33, 1
    s_bfe_u32 s39, s33, 0x10001
    s_xor_b32 s38, s38, 524288
    s_and_b32 s17, s33, 7
    s_mul_i32 s17, s17, 131072
    s_add_u32 s43, s45, s17
    s_bfe_u32 s66, s33, 65539
    s_add_u32 s67, s67, 22528
    s_and_b32 s17, s33, 3
    s_cmp_eq_u32 s17, 3
    s_cselect_b32 s17, 1, 0
    s_cmp_eq_u32 s32, 0
    s_cselect_b32 s17, 1, s17
    s_cmp_ge_u32 s33, 7
    s_cselect_b32 s17, s17, 0
    s_cmp_lg_u32 s17, 0
    s_cselect_b64 s[78:79], -1, 0xff
    s_add_u32 s56, s56, 262144
    s_add_u32 s42, s42, 262144
    s_add_u32 s41, s41, 262144
    s_add_u32 s40, s40, 262144
    s_add_u32 s44, s44, 22528
    ds_read_b128 v[56:59], v9 offset:12288
    ds_read_b128 v[60:63], v9 offset:13312
    ds_read_b128 v[64:67], v9 offset:14336
    ds_read_b128 v[68:71], v9 offset:15360
    v_mov_b64 v[12:13], 0
    v_mov_b64 v[14:15], 0
    v_mov_b64 v[16:17], 0
    v_mov_b64 v[18:19], 0
    v_mov_b64 v[20:21], 0
    v_mov_b64 v[22:23], 0
    v_mov_b64 v[24:25], 0
    v_mov_b64 v[26:27], 0
    v_mov_b64 v[28:29], 0
    v_mov_b64 v[30:31], 0
    v_mov_b64 v[32:33], 0
    v_mov_b64 v[34:35], 0
    s_waitcnt lgkmcnt(0)
    s_branch Lr3s_step
Lr3s_flbad:
    s_cmp_eq_u32 s33, 63
    s_cbranch_scc1 Lr3s_flok
    s_mov_b32 s16, 0
Lr3s_flp:
    buffer_load_dword v6, v7, s[8:11], s67 offen sc1
    s_add_u32 s16, s16, 1
    s_cmp_gt_u32 s16, 100000
    s_cbranch_scc1 Lr_abort
    s_waitcnt vmcnt(0)
    v_cmp_eq_u32 vcc, 0, v6
    s_nop 0
    s_and_b64 vcc, vcc, s[78:79]
    s_cbranch_scc1 Lr3s_flp
    s_branch Lr3s_flok
Lr3s_last:
    s_waitcnt vmcnt(0) lgkmcnt(0)
    s_branch Lr_exit
Lr_abort:
    s_waitcnt lgkmcnt(0)
    s_mov_b64 exec, -1
    v_mov_b32 v0, 60
    s_lshl_b32 s5, s3, 8
    s_or_b32 s5, s5, s4
    s_or_b32 s5, s5, 0x10000
    v_mov_b32 v1, s5
    global_store_dword v0, v1, s[12:13]
    s_endpgm
Lr_exit:
    s_add_u32 s6, s15, s14
    s_cmp_lg_u32 s6, 0
    s_cbranch_scc1 Lr_nowb
    s_waitcnt vmcnt(0)
    buffer_wbl2 sc1
    s_waitcnt vmcnt(0)
Lr_nowb:
    s_endpgm
.section .rodata,"a"
.p2align 6
.amdhsa_kernel interleave_layers__sliding_local_dilated__memory_aug_recurrent_mem_tr__prompt_kernel
  .amdhsa_next_free_vgpr 512
  .amdhsa_next_free_sgpr 102
  .amdhsa_accum_offset 256
  .amdhsa_group_segment_fixed_size 0
  .amdhsa_kernarg_size 104
  .amdhsa_user_sgpr_count 2
  .amdhsa_user_sgpr_kernarg_segment_ptr 1
  .amdhsa_system_sgpr_workgroup_id_x 1
.end_amdhsa_kernel
```
